```python
import torch

def _softmax(x, axis=-1):
    return torch.softmax(x, dim=axis)
def _gelu(x):
    return torch.nn.functional.gelu(x, approximate="tanh")
def _silu(x):
    return torch.nn.functional.silu(x)
def _sigmoid(x):
    return torch.sigmoid(x)
def _layernorm(x, axis=-1, eps=1e-5):
    m = x.mean(dim=axis, keepdim=True)
    v = x.var(dim=axis, keepdim=True, unbiased=False)
    return (x - m) / torch.sqrt(v + eps)
def _scatter_add(tgt, idx, src, axis=0):
    return tgt.clone().index_add_(axis, idx, src)
def _segment_sum(src, seg, n):
    out = torch.zeros((n,) + src.shape[1:], dtype=src.dtype)
    return out.index_add_(0, seg, src)
def _pad(x, pw):
    flat = tuple(v for pair in reversed(pw) for v in pair)
    return torch.nn.functional.pad(x, flat)

kernel_name = 'standalone__mha_block_cached__near_ridge'

def setup_inputs():

    _w = (lambda a: (lambda t: t.to(torch.bfloat16) if t.is_floating_point() else t)(torch.as_tensor(a)))
    B, Sq, D = 32, 192, 448
    H, Sk, Dh = 16, 512, 256
    return {
        "x": _w((lambda *s: torch.randn(*s, dtype=torch.bfloat16) * 0.8)(B, Sq, D)),
        "k_cache": _w((lambda *s: torch.randn(*s, dtype=torch.bfloat16) * 0.8)(B, H, Sk, Dh)),
        "v_cache": _w((lambda *s: torch.randn(*s, dtype=torch.bfloat16) * 0.05)(B, H, Sk, Dh)),
        "wq": _w((lambda *s: torch.randn(*s, dtype=torch.bfloat16) * 0.8)(D, H * Dh) * (D ** -0.5)),
        "wo": _w((lambda *s: torch.randn(*s, dtype=torch.bfloat16) * 0.05)(H * Dh, D) * ((H * Dh) ** -0.5)),
    }

def reference(x, k_cache, v_cache, wq, wo):
    B, Sq, D = x.shape
    H, Dh = 16, 256
    q = (lambda x, *d: x.permute(*d))((x @ wq).reshape(B, Sq, H, Dh), 0, 2, 1, 3)
    scores = torch.einsum("bhqd,bhkd->bhqk", q, k_cache) * (Dh ** -0.5)
    p = _softmax(scores, axis=-1)
    o = torch.einsum("bhqk,bhkd->bhqd", p, v_cache)
    return (lambda x, *d: x.permute(*d))(o, 0, 2, 1, 3).reshape(B, Sq, H * Dh) @ wo
```

```asm
; @launch grid=(256,1,1) block=(256,1,1) lds=163840
.amdgcn_target "amdgcn-amd-amdhsa--gfx950"
.text
.globl standalone__mha_block_cached__near_ridge_kernel
.p2align 8
.type standalone__mha_block_cached__near_ridge_kernel,@function
standalone__mha_block_cached__near_ridge_kernel:
  s_cmp_lt_u32 s2, 256
  s_cbranch_scc1 L_go
  s_endpgm
L_go:
  s_load_dwordx8 s[72:79], s[0:1], 0
  s_load_dwordx8 s[80:87], s[0:1], 32
  v_lshrrev_b32 v241, 6, v0
  v_and_b32 v240, 63, v0
  v_readfirstlane_b32 s34, v241
  s_and_b32 s36, s2, 7
  s_lshr_b32 s37, s2, 3
  s_and_b32 s35, s36, 0
  s_lshl_b32 s35, s35, 3
  s_and_b32 s38, s37, 7
  s_add_u32 s35, s35, s38
  s_lshr_b32 s41, s36, 0
  s_lshl_b32 s41, s41, 2
  s_lshr_b32 s38, s37, 3
  s_add_u32 s41, s41, s38
  s_lshl_b32 s28, s34, 12
  s_mov_b32 s30, -896
  s_mov_b32 s31, 6144
  v_lshrrev_b32 v241, 5, v240
  v_bfe_u32 v244, v240, 2, 2
  v_lshl_add_u32 v244, v241, 2, v244
  v_lshlrev_b32 v241, 1, v241
  v_xor_b32 v241, v241, v240
  v_and_b32 v241, 3, v241
  v_lshlrev_b32 v245, 4, v241
  v_bfe_u32 v241, v240, 4, 1
  v_lshl_add_u32 v245, v241, 6, v245
  s_mul_i32 s36, s34, 48
  v_add_u32 v241, s36, v244
  v_mul_u32_u24 v241, 896, v241
  v_add_u32 v233, v241, v245
  s_and_b32 s36, s34, 1
  s_lshl_b32 s36, s36, 4
  s_lshr_b32 s37, s34, 1
  s_lshl_b32 s37, s37, 2
  s_add_u32 s36, s36, s37
  v_lshrrev_b32 v241, 2, v244
  v_lshlrev_b32 v241, 3, v241
  v_and_b32 v242, 3, v244
  v_add3_u32 v241, v241, v242, s36
  v_lshlrev_b32 v241, 13, v241
  v_add_u32 v232, v241, v245
  s_waitcnt lgkmcnt(0)
  s_mul_i32 s36, s41, 172032
  s_add_u32 s4, s72, s36
  s_addc_u32 s5, s73, 0
  s_sub_u32 s4, s4, 3072
  s_subb_u32 s5, s5, 0
  s_mov_b32 s6, 175104
  s_mov_b32 s7, 131072
  s_lshl_b32 s36, s35, 10
  s_add_u32 s16, s78, s36
  s_addc_u32 s17, s79, 0
  s_sub_u32 s16, s16, 3072
  s_subb_u32 s17, s17, 0
  s_sub_u32 s18, 3673088, s36
  s_mov_b32 s19, 131072
  s_add_u32 m0, s28, 0
  s_mov_b32 s29, 3072
  buffer_load_dwordx4 v233, s[4:7], s29 offen offset:0 lds
  s_mov_b32 s29, 9216
  buffer_load_dwordx4 v233, s[4:7], s29 offen offset:1024 lds
  s_mov_b32 s29, 15360
  buffer_load_dwordx4 v233, s[4:7], s29 offen offset:2048 lds
  s_mov_b32 s29, 21504
  buffer_load_dwordx4 v233, s[4:7], s29 offen offset:3072 lds
  s_add_u32 m0, s28, 16384
  s_mov_b32 s29, 31744
  buffer_load_dwordx4 v233, s[4:7], s29 offen offset:0 lds
  s_mov_b32 s29, 37888
  buffer_load_dwordx4 v233, s[4:7], s29 offen offset:1024 lds
  s_mov_b32 s29, 1152
  buffer_load_dwordx4 v233, s[4:7], s29 offen offset:2048 lds
  s_mov_b32 s29, 7296
  buffer_load_dwordx4 v233, s[4:7], s29 offen offset:3072 lds
  s_add_u32 m0, s28, 32768
  s_mov_b32 s29, 3072
  buffer_load_dwordx4 v232, s[16:19], s29 offen offset:0 lds
  s_add_u32 s29, s29, s30
  buffer_load_dwordx4 v232, s[16:19], s29 offen offset:1024 lds
  s_add_u32 s29, s29, s30
  buffer_load_dwordx4 v232, s[16:19], s29 offen offset:2048 lds
  s_add_u32 s29, s29, s30
  buffer_load_dwordx4 v232, s[16:19], s29 offen offset:3072 lds
  s_getpc_b64 s[88:89]
L_pc:
  s_lshr_b32 s36, s2, 3
  s_lshl_b32 s36, s36, 2
  s_add_u32 s36, s36, s34
  s_lshl_b32 s36, s36, 10
  v_lshlrev_b32 v241, 4, v240
  v_add_u32 v247, s36, v241
  s_mov_b32 s90, L_code_end-L_pc
  s_mov_b32 s91, 131072
  buffer_load_dwordx4 a[252:255], v247, s[88:91], 0 offen offset:0
  s_add_u32 m0, s28, 49152
  s_mov_b32 s29, 265216
  buffer_load_dwordx4 v232, s[16:19], s29 offen offset:0 lds
  s_add_u32 s29, s29, s30
  buffer_load_dwordx4 v232, s[16:19], s29 offen offset:1024 lds
  s_add_u32 s29, s29, s30
  buffer_load_dwordx4 v232, s[16:19], s29 offen offset:2048 lds
  s_add_u32 s29, s29, s30
  buffer_load_dwordx4 v232, s[16:19], s29 offen offset:3072 lds
  s_add_u32 m0, s28, 65536
  s_mov_b32 s29, 17536
  buffer_load_dwordx4 v233, s[4:7], s29 offen offset:0 lds
  s_mov_b32 s29, 23680
  buffer_load_dwordx4 v233, s[4:7], s29 offen offset:1024 lds
  s_mov_b32 s29, 29824
  buffer_load_dwordx4 v233, s[4:7], s29 offen offset:2048 lds
  s_mov_b32 s29, 35968
  buffer_load_dwordx4 v233, s[4:7], s29 offen offset:3072 lds
  s_add_u32 m0, s28, 81920
  s_mov_b32 s29, 527360
  buffer_load_dwordx4 v232, s[16:19], s29 offen offset:0 lds
  s_add_u32 s29, s29, s30
  buffer_load_dwordx4 v232, s[16:19], s29 offen offset:1024 lds
  s_add_u32 s29, s29, s30
  buffer_load_dwordx4 v232, s[16:19], s29 offen offset:2048 lds
  s_add_u32 s29, s29, s30
  buffer_load_dwordx4 v232, s[16:19], s29 offen offset:3072 lds
  v_lshlrev_b32 v241, 9, v244
  v_add_u32 v241, s28, v241
  v_add_u32 v231, v241, v245
  v_bfe_u32 v242, v240, 2, 1
  v_lshlrev_b32 v241, 1, v242
  v_lshrrev_b32 v243, 4, v240
  v_xor_b32 v241, v241, v243
  v_lshlrev_b32 v241, 4, v241
  v_lshl_add_u32 v241, v242, 9, v241
  v_and_b32 v242, 3, v240
  v_lshl_add_u32 v241, v242, 6, v241
  v_bfe_u32 v242, v240, 3, 1
  v_lshl_add_u32 v229, v242, 12, v241
  v_lshl_add_u32 v237, v242, 10, v241
  v_add_u32 v237, s28, v237
  v_and_b32 v241, 3, v240
  v_lshlrev_b32 v241, 3, v241
  v_bfe_u32 v242, v240, 2, 2
  v_lshl_add_u32 v241, v242, 6, v241
  v_bfe_u32 v242, v240, 4, 1
  v_mul_u32_u24 v242, 544, v242
  v_add_u32 v241, v241, v242
  v_lshrrev_b32 v242, 5, v240
  v_lshl_add_u32 v230, v242, 12, v241
  s_lshl_b32 s36, s41, 3
  s_add_u32 s36, s36, s35
  s_lshl_b32 s37, s36, 19
  s_add_u32 s8, s74, s37
  s_addc_u32 s9, s75, 0
  s_sub_u32 s8, s8, 3072
  s_subb_u32 s9, s9, 0
  s_mov_b32 s10, 527360
  s_mov_b32 s11, 131072
  s_add_u32 s12, s76, s37
  s_addc_u32 s13, s77, 0
  s_sub_u32 s12, s12, 3072
  s_subb_u32 s13, s13, 0
  s_mov_b32 s14, 527360
  s_mov_b32 s15, 131072
  s_mul_i32 s37, s36, 172032
  s_add_u32 s20, s86, s37
  s_addc_u32 s21, s87, 0
  s_mov_b32 s22, 172032
  s_mov_b32 s23, 131072
  s_mul_i32 s37, s35, 458752
  s_add_u32 s24, s80, s37
  s_addc_u32 s25, s81, 0
  s_mov_b32 s26, 458752
  s_mov_b32 s27, 131072
  s_mov_b32 s46, s86
  s_mov_b32 s47, s87
  s_mov_b32 s48, s84
  s_mov_b32 s49, s85
  s_mov_b32 s32, 0
  s_mov_b32 s33, 0
  s_mov_b32 s44, 0x3db8aa3b
  s_mov_b32 s45, 0x3db8aa3b
  s_mov_b32 s40, 0x5d800000
  s_mov_b32 s96, s80
  s_mov_b32 s97, s81
  s_mov_b32 s98, 3670016
  s_mov_b32 s99, 131072
  s_lshl_b32 s37, s2, 2
  s_add_u32 s37, s37, s34
  s_mul_i32 s100, s37, 3584
  v_lshlrev_b32 v234, 4, v240
  s_lshl_b32 s38, s35, 3
  s_lshl_b32 s37, s41, 3
  s_add_u32 s60, s84, s37
  s_addc_u32 s61, s85, 0
  s_sub_u32 s60, s60, s38
  s_subb_u32 s61, s61, 0
  s_add_u32 s62, s38, 8
  s_mov_b32 s63, 131072
  s_mul_i32 s37, s41, 1376256
  s_add_u32 s64, s86, s37
  s_addc_u32 s65, s87, 0
  s_mov_b32 s66, 1376256
  s_mov_b32 s67, 131072
  s_mul_i32 s37, s41, 172032
  s_add_u32 s68, s82, s37
  s_addc_u32 s69, s83, 0
  s_mov_b32 s70, 172032
  s_mov_b32 s71, 131072
  s_lshl_b32 s37, s41, 10
  s_add_u32 s37, s37, 50331648
  s_add_u32 s76, s86, s37
  s_addc_u32 s77, s87, 0
  s_mov_b32 s78, 896
  s_mov_b32 s79, 131072
  v_add_u32 v241, s28, v240
  v_cmp_eq_u32 vcc, 0, v241
  v_mov_b32 v242, 0x80000000
  v_mov_b32 v241, s38
  v_cndmask_b32 v246, v242, v241, vcc
  s_mov_b32 s38, s35
  s_cmp_ge_u32 s38, 7
  s_cselect_b32 s39, 7, 0
  s_sub_u32 s38, s38, s39
  s_add_u32 s38, s38, 1
  s_cmp_ge_u32 s38, 7
  s_cselect_b32 s39, 7, 0
  s_sub_u32 s38, s38, s39
  s_lshl_b32 s52, s38, 7
  s_add_u32 s38, s38, 1
  s_cmp_ge_u32 s38, 7
  s_cselect_b32 s39, 7, 0
  s_sub_u32 s38, s38, s39
  s_lshl_b32 s53, s38, 7
  s_add_u32 s38, s38, 1
  s_cmp_ge_u32 s38, 7
  s_cselect_b32 s39, 7, 0
  s_sub_u32 s38, s38, s39
  s_lshl_b32 s54, s38, 7
  s_add_u32 s38, s38, 1
  s_cmp_ge_u32 s38, 7
  s_cselect_b32 s39, 7, 0
  s_sub_u32 s38, s38, s39
  s_lshl_b32 s55, s38, 7
  s_add_u32 s38, s38, 1
  s_cmp_ge_u32 s38, 7
  s_cselect_b32 s39, 7, 0
  s_sub_u32 s38, s38, s39
  s_lshl_b32 s56, s38, 7
  s_add_u32 s38, s38, 1
  s_cmp_ge_u32 s38, 7
  s_cselect_b32 s39, 7, 0
  s_sub_u32 s38, s38, s39
  s_lshl_b32 s57, s38, 7
  s_add_u32 s38, s38, 1
  s_cmp_ge_u32 s38, 7
  s_cselect_b32 s39, 7, 0
  s_sub_u32 s38, s38, s39
  s_lshl_b32 s58, s38, 7
  s_mul_i32 s38, s58, 192
  s_mov_b32 s87, 127
  s_mov_b32 s59, 0
  s_add_u32 s36, s35, 6
  s_cmp_ge_u32 s36, 7
  s_cselect_b32 s39, 7, 0
  s_sub_u32 s36, s36, s39
  s_mul_i32 s80, s36, 172032
  s_add_u32 s80, s80, s38
  s_add_u32 s36, s35, 5
  s_cmp_ge_u32 s36, 7
  s_cselect_b32 s39, 7, 0
  s_sub_u32 s36, s36, s39
  s_mul_i32 s81, s36, 172032
  s_add_u32 s81, s81, s38
  s_add_u32 s36, s35, 4
  s_cmp_ge_u32 s36, 7
  s_cselect_b32 s39, 7, 0
  s_sub_u32 s36, s36, s39
  s_mul_i32 s82, s36, 172032
  s_add_u32 s82, s82, s38
  s_add_u32 s36, s35, 3
  s_cmp_ge_u32 s36, 7
  s_cselect_b32 s39, 7, 0
  s_sub_u32 s36, s36, s39
  s_mul_i32 s83, s36, 172032
  s_add_u32 s83, s83, s38
  s_add_u32 s36, s35, 2
  s_cmp_ge_u32 s36, 7
  s_cselect_b32 s39, 7, 0
  s_sub_u32 s36, s36, s39
  s_mul_i32 s84, s36, 172032
  s_add_u32 s84, s84, s38
  s_add_u32 s36, s35, 1
  s_cmp_ge_u32 s36, 7
  s_cselect_b32 s39, 7, 0
  s_sub_u32 s36, s36, s39
  s_mul_i32 s85, s36, 172032
  s_add_u32 s85, s85, s38
  s_add_u32 s86, s38, 1204224
  v_bfe_u32 v244, v240, 2, 2
  v_lshrrev_b32 v242, 4, v240
  v_cmp_eq_u32 vcc, v244, v242
  v_and_b32 v241, 1, v240
  v_lshlrev_b32 v241, 4, v241
  v_mov_b32 v244, 16256
  v_lshlrev_b32 v241, v241, v244
  v_cndmask_b32 v241, 0, v241, vcc
  v_and_b32 v242, 2, v240
  v_cmp_eq_u32 vcc, 0, v242
  v_mov_b32 v248, 0
  v_mov_b32 v249, 0
  v_cndmask_b32 v250, 0, v241, vcc
  v_sub_u32 v251, v241, v250
  v_mov_b32 v252, 0
  v_mov_b32 v253, 0
  s_memrealtime s[72:73]
  s_waitcnt lgkmcnt(0)
  s_or_b32 s72, s72, 1
  v_accvgpr_write_b32 a248, s72
  v_accvgpr_write_b32 a249, s73
  v_accvgpr_write_b32 a250, 0
  v_accvgpr_write_b32 a251, 0
  s_waitcnt vmcnt(13)
  s_barrier
  v_add_u32 v228, 32768, v230
  v_xor_b32 v239, 32, v228
  ds_read_b64_tr_b16 a[192:193], v228 offset:0
  ds_read_b64_tr_b16 a[194:195], v228 offset:8192
  ds_read_b64_tr_b16 a[196:197], v239 offset:0
  ds_read_b64_tr_b16 a[198:199], v239 offset:8192
  v_add_u32 v238, 0, v237
  ds_read_b128 v[168:171], v238 offset:0
  ds_read_b128 v[180:183], v238 offset:256
  ds_read_b128 v[172:175], v238 offset:2048
  ds_read_b128 v[184:187], v238 offset:2304
  v_add_u32 v238, 16384, v237
  ds_read_b128 v[176:179], v238 offset:0
  ds_read_b128 v[188:191], v238 offset:256
  ds_read_b128 v[192:195], v238 offset:2048
  ds_read_b128 v[204:207], v238 offset:2304
  s_waitcnt lgkmcnt(8)
  ds_read_b64_tr_b16 a[200:201], v228 offset:256
  ds_read_b64_tr_b16 a[202:203], v228 offset:8448
  ds_read_b64_tr_b16 a[204:205], v239 offset:256
  ds_read_b64_tr_b16 a[206:207], v239 offset:8448
  ds_read_b64_tr_b16 a[208:209], v228 offset:1024
  ds_read_b64_tr_b16 a[210:211], v228 offset:9216
  s_waitcnt lgkmcnt(6)
  s_waitcnt lgkmcnt(15)
  v_mfma_f32_16x16x32_bf16 v[0:3], a[192:195], v[168:171], 0
  s_waitcnt vmcnt(8)
  ds_read_b64_tr_b16 a[212:213], v239 offset:1024
  v_mfma_f32_16x16x32_bf16 v[4:7], a[192:195], v[172:175], 0
  s_barrier
  ds_read_b64_tr_b16 a[214:215], v239 offset:9216
  v_mfma_f32_16x16x32_bf16 v[8:11], a[192:195], v[176:179], 0
  s_waitcnt lgkmcnt(15)
  v_mfma_f32_16x16x32_bf16 v[12:15], a[196:199], v[168:171], 0
  s_add_u32 m0, s28, 98304
  ds_read_b64_tr_b16 a[216:217], v228 offset:1280
  v_mfma_f32_16x16x32_bf16 v[16:19], a[196:199], v[172:175], 0
  s_mov_b32 s29, 789504
  buffer_load_dwordx4 v232, s[16:19], s29 offen offset:0 lds
  v_mfma_f32_16x16x32_bf16 v[20:23], a[196:199], v[176:179], 0
  s_waitcnt lgkmcnt(7)
  ds_read_b64_tr_b16 a[218:219], v228 offset:9472
  v_mfma_f32_16x16x32_bf16 v[24:27], a[200:203], v[168:171], 0
  s_add_u32 s29, s29, s30
  ds_read_b64_tr_b16 a[220:221], v239 offset:1280
  v_mfma_f32_16x16x32_bf16 v[28:31], a[200:203], v[172:175], 0
  buffer_load_dwordx4 v232, s[16:19], s29 offen offset:1024 lds
  v_mfma_f32_16x16x32_bf16 v[32:35], a[200:203], v[176:179], 0
  s_waitcnt lgkmcnt(7)
  ds_read_b64_tr_b16 a[222:223], v239 offset:9472
  v_mfma_f32_16x16x32_bf16 v[36:39], a[204:207], v[168:171], 0
  s_add_u32 s29, s29, s30
  ds_read_b64_tr_b16 a[192:193], v228 offset:2048
  v_mfma_f32_16x16x32_bf16 v[40:43], a[204:207], v[172:175], 0
  ds_read_b64_tr_b16 a[194:195], v228 offset:10240
  v_mfma_f32_16x16x32_bf16 v[44:47], a[204:207], v[176:179], 0
  s_waitcnt lgkmcnt(8)
  v_mfma_f32_16x16x32_bf16 v[48:51], a[208:211], v[168:171], 0
  ds_read_b64_tr_b16 a[196:197], v239 offset:2048
  v_mfma_f32_16x16x32_bf16 v[52:55], a[208:211], v[172:175], 0
  buffer_load_dwordx4 v232, s[16:19], s29 offen offset:2048 lds
  v_mfma_f32_16x16x32_bf16 v[56:59], a[208:211], v[176:179], 0
  s_waitcnt lgkmcnt(7)
  ds_read_b64_tr_b16 a[198:199], v239 offset:10240
  v_mfma_f32_16x16x32_bf16 v[60:63], a[212:215], v[168:171], 0
  s_add_u32 s29, s29, s30
  ds_read_b64_tr_b16 a[200:201], v228 offset:2304
  v_mfma_f32_16x16x32_bf16 v[64:67], a[212:215], v[172:175], 0
  buffer_load_dwordx4 v232, s[16:19], s29 offen offset:3072 lds
  v_mfma_f32_16x16x32_bf16 v[68:71], a[212:215], v[176:179], 0
  s_waitcnt lgkmcnt(7)
  ds_read_b64_tr_b16 a[202:203], v228 offset:10496
  v_mfma_f32_16x16x32_bf16 v[72:75], a[216:219], v[168:171], 0
  s_add_u32 m0, s28, 114688
  ds_read_b64_tr_b16 a[204:205], v239 offset:2304
  v_mfma_f32_16x16x32_bf16 v[76:79], a[216:219], v[172:175], 0
  s_mov_b32 s29, 3328
  buffer_load_dwordx4 v233, s[4:7], s29 offen offset:0 lds
  v_mfma_f32_16x16x32_bf16 v[80:83], a[216:219], v[176:179], 0
  s_waitcnt lgkmcnt(7)
  ds_read_b64_tr_b16 a[206:207], v239 offset:10496
  v_mfma_f32_16x16x32_bf16 v[84:87], a[220:223], v[168:171], 0
  s_mov_b32 s29, 9472
  ds_read_b64_tr_b16 a[208:209], v228 offset:3072
  v_mfma_f32_16x16x32_bf16 v[88:91], a[220:223], v[172:175], 0
  buffer_load_dwordx4 v233, s[4:7], s29 offen offset:1024 lds
  v_mfma_f32_16x16x32_bf16 v[92:95], a[220:223], v[176:179], 0
  s_waitcnt lgkmcnt(7)
  ds_read_b64_tr_b16 a[210:211], v228 offset:11264
  v_mfma_f32_16x16x32_bf16 v[96:99], a[192:195], v[168:171], 0
  s_mov_b32 s29, 15616
  ds_read_b64_tr_b16 a[212:213], v239 offset:3072
  v_mfma_f32_16x16x32_bf16 v[100:103], a[192:195], v[172:175], 0
  ds_read_b64_tr_b16 a[214:215], v239 offset:11264
  v_mfma_f32_16x16x32_bf16 v[104:107], a[192:195], v[176:179], 0
  s_waitcnt lgkmcnt(8)
  v_mfma_f32_16x16x32_bf16 v[108:111], a[196:199], v[168:171], 0
  ds_read_b64_tr_b16 a[216:217], v228 offset:3328
  v_mfma_f32_16x16x32_bf16 v[112:115], a[196:199], v[172:175], 0
  buffer_load_dwordx4 v233, s[4:7], s29 offen offset:2048 lds
  v_mfma_f32_16x16x32_bf16 v[116:119], a[196:199], v[176:179], 0
  s_waitcnt lgkmcnt(7)
  ds_read_b64_tr_b16 a[218:219], v228 offset:11520
  v_mfma_f32_16x16x32_bf16 v[120:123], a[200:203], v[168:171], 0
  s_mov_b32 s29, 21760
  ds_read_b64_tr_b16 a[220:221], v239 offset:3328
  v_mfma_f32_16x16x32_bf16 v[124:127], a[200:203], v[172:175], 0
  buffer_load_dwordx4 v233, s[4:7], s29 offen offset:3072 lds
  v_mfma_f32_16x16x32_bf16 v[128:131], a[200:203], v[176:179], 0
  s_waitcnt lgkmcnt(7)
  ds_read_b64_tr_b16 a[222:223], v239 offset:11520
  v_add_u32 v228, 49152, v230
  v_mfma_f32_16x16x32_bf16 v[132:135], a[204:207], v[168:171], 0
  s_add_u32 m0, s28, 131072
  ds_read_b64_tr_b16 a[192:193], v228 offset:0
  v_xor_b32 v239, 32, v228
  v_mfma_f32_16x16x32_bf16 v[136:139], a[204:207], v[172:175], 0
  s_mov_b32 s29, 32000
  buffer_load_dwordx4 v233, s[4:7], s29 offen offset:0 lds
  v_mfma_f32_16x16x32_bf16 v[140:143], a[204:207], v[176:179], 0
  s_waitcnt lgkmcnt(7)
  ds_read_b64_tr_b16 a[194:195], v228 offset:8192
  v_mfma_f32_16x16x32_bf16 v[144:147], a[208:211], v[168:171], 0
  s_mov_b32 s29, 38144
  ds_read_b64_tr_b16 a[196:197], v239 offset:0
  v_mfma_f32_16x16x32_bf16 v[148:151], a[208:211], v[172:175], 0
  buffer_load_dwordx4 v233, s[4:7], s29 offen offset:1024 lds
  v_mfma_f32_16x16x32_bf16 v[152:155], a[208:211], v[176:179], 0
  s_waitcnt lgkmcnt(7)
  ds_read_b64_tr_b16 a[198:199], v239 offset:8192
  v_mfma_f32_16x16x32_bf16 v[156:159], a[212:215], v[168:171], 0
  s_mov_b32 s29, 1408
  ds_read_b64_tr_b16 a[200:201], v228 offset:256
  v_mfma_f32_16x16x32_bf16 v[160:163], a[212:215], v[172:175], 0
  ds_read_b64_tr_b16 a[202:203], v228 offset:8448
  v_mfma_f32_16x16x32_bf16 v[164:167], a[212:215], v[176:179], 0
  s_waitcnt lgkmcnt(8)
  v_mfma_f32_16x16x32_bf16 a[224:227], a[216:219], v[168:171], 0
  ds_read_b64_tr_b16 a[204:205], v239 offset:256
  v_mfma_f32_16x16x32_bf16 a[228:231], a[216:219], v[172:175], 0
  buffer_load_dwordx4 v233, s[4:7], s29 offen offset:2048 lds
  v_mfma_f32_16x16x32_bf16 a[232:235], a[216:219], v[176:179], 0
  s_waitcnt lgkmcnt(7)
  ds_read_b64_tr_b16 a[206:207], v239 offset:8448
  v_mfma_f32_16x16x32_bf16 a[236:239], a[220:223], v[168:171], 0
  s_mov_b32 s29, 7552
  ds_read_b64_tr_b16 a[208:209], v228 offset:1024
  v_mfma_f32_16x16x32_bf16 a[240:243], a[220:223], v[172:175], 0
  buffer_load_dwordx4 v233, s[4:7], s29 offen offset:3072 lds
  v_mfma_f32_16x16x32_bf16 a[244:247], a[220:223], v[176:179], 0
  s_waitcnt lgkmcnt(7)
  ds_read_b64_tr_b16 a[210:211], v228 offset:9216
  v_mfma_f32_16x16x32_bf16 v[0:3], a[192:195], v[180:183], v[0:3]
  s_waitcnt vmcnt(12)
  ds_read_b64_tr_b16 a[212:213], v239 offset:1024
  v_mfma_f32_16x16x32_bf16 v[4:7], a[192:195], v[184:187], v[4:7]
  s_barrier
  ds_read_b64_tr_b16 a[214:215], v239 offset:9216
  v_add_u32 v238, 65536, v237
  v_mfma_f32_16x16x32_bf16 v[8:11], a[192:195], v[188:191], v[8:11]
  s_waitcnt lgkmcnt(8)
  ds_read_b128 v[196:199], v238 offset:0
  v_mfma_f32_16x16x32_bf16 v[12:15], a[196:199], v[180:183], v[12:15]
  s_add_u32 m0, s28, 147456
  ds_read_b128 v[208:211], v238 offset:256
  v_mfma_f32_16x16x32_bf16 v[16:19], a[196:199], v[184:187], v[16:19]
  s_mov_b32 s29, 1051648
  buffer_load_dwordx4 v232, s[16:19], s29 offen offset:0 lds
  v_mfma_f32_16x16x32_bf16 v[20:23], a[196:199], v[188:191], v[20:23]
  s_waitcnt lgkmcnt(8)
  ds_read_b128 v[200:203], v238 offset:2048
  v_mfma_f32_16x16x32_bf16 v[24:27], a[200:203], v[180:183], v[24:27]
  s_add_u32 s29, s29, s30
  ds_read_b128 v[212:215], v238 offset:2304
  v_mfma_f32_16x16x32_bf16 v[28:31], a[200:203], v[184:187], v[28:31]
  buffer_load_dwordx4 v232, s[16:19], s29 offen offset:1024 lds
  v_mfma_f32_16x16x32_bf16 v[32:35], a[200:203], v[188:191], v[32:35]
  s_waitcnt lgkmcnt(8)
  ds_read_b64_tr_b16 a[216:217], v228 offset:1280
  v_mfma_f32_16x16x32_bf16 v[36:39], a[204:207], v[180:183], v[36:39]
  s_add_u32 s29, s29, s30
  ds_read_b64_tr_b16 a[218:219], v228 offset:9472
  v_mfma_f32_16x16x32_bf16 v[40:43], a[204:207], v[184:187], v[40:43]
  ds_read_b64_tr_b16 a[220:221], v239 offset:1280
  v_mfma_f32_16x16x32_bf16 v[44:47], a[204:207], v[188:191], v[44:47]
  s_waitcnt lgkmcnt(9)
  ds_read_b64_tr_b16 a[222:223], v239 offset:9472
  v_mfma_f32_16x16x32_bf16 v[48:51], a[208:211], v[180:183], v[48:51]
  ds_read_b64_tr_b16 a[192:193], v228 offset:2048
  v_mfma_f32_16x16x32_bf16 v[52:55], a[208:211], v[184:187], v[52:55]
  buffer_load_dwordx4 v232, s[16:19], s29 offen offset:2048 lds
  v_mfma_f32_16x16x32_bf16 v[56:59], a[208:211], v[188:191], v[56:59]
  s_waitcnt lgkmcnt(9)
  ds_read_b64_tr_b16 a[194:195], v228 offset:10240
  v_mfma_f32_16x16x32_bf16 v[60:63], a[212:215], v[180:183], v[60:63]
  s_add_u32 s29, s29, s30
  ds_read_b64_tr_b16 a[196:197], v239 offset:2048
  v_mfma_f32_16x16x32_bf16 v[64:67], a[212:215], v[184:187], v[64:67]
  buffer_load_dwordx4 v232, s[16:19], s29 offen offset:3072 lds
  v_mfma_f32_16x16x32_bf16 v[68:71], a[212:215], v[188:191], v[68:71]
  s_waitcnt lgkmcnt(5)
  ds_read_b64_tr_b16 a[198:199], v239 offset:10240
  v_mfma_f32_16x16x32_bf16 v[72:75], a[216:219], v[180:183], v[72:75]
  s_add_u32 m0, s28, 0
  ds_read_b64_tr_b16 a[200:201], v228 offset:2304
  v_mfma_f32_16x16x32_bf16 v[76:79], a[216:219], v[184:187], v[76:79]
  s_mov_b32 s29, 1313792
  buffer_load_dwordx4 v232, s[16:19], s29 offen offset:0 lds
  v_mfma_f32_16x16x32_bf16 v[80:83], a[216:219], v[188:191], v[80:83]
  s_waitcnt lgkmcnt(5)
  ds_read_b64_tr_b16 a[202:203], v228 offset:10496
  v_mfma_f32_16x16x32_bf16 v[84:87], a[220:223], v[180:183], v[84:87]
  s_add_u32 s29, s29, s30
  ds_read_b64_tr_b16 a[204:205], v239 offset:2304
  v_mfma_f32_16x16x32_bf16 v[88:91], a[220:223], v[184:187], v[88:91]
  buffer_load_dwordx4 v232, s[16:19], s29 offen offset:1024 lds
  v_mfma_f32_16x16x32_bf16 v[92:95], a[220:223], v[188:191], v[92:95]
  s_waitcnt lgkmcnt(5)
  ds_read_b64_tr_b16 a[206:207], v239 offset:10496
  v_mfma_f32_16x16x32_bf16 v[96:99], a[192:195], v[180:183], v[96:99]
  s_add_u32 s29, s29, s30
  ds_read_b64_tr_b16 a[208:209], v228 offset:3072
  v_mfma_f32_16x16x32_bf16 v[100:103], a[192:195], v[184:187], v[100:103]
  ds_read_b64_tr_b16 a[210:211], v228 offset:11264
  v_mfma_f32_16x16x32_bf16 v[104:107], a[192:195], v[188:191], v[104:107]
  s_waitcnt lgkmcnt(6)
  ds_read_b64_tr_b16 a[212:213], v239 offset:3072
  v_mfma_f32_16x16x32_bf16 v[108:111], a[196:199], v[180:183], v[108:111]
  ds_read_b64_tr_b16 a[214:215], v239 offset:11264
  v_mfma_f32_16x16x32_bf16 v[112:115], a[196:199], v[184:187], v[112:115]
  buffer_load_dwordx4 v232, s[16:19], s29 offen offset:2048 lds
  v_mfma_f32_16x16x32_bf16 v[116:119], a[196:199], v[188:191], v[116:119]
  s_waitcnt lgkmcnt(6)
  ds_read_b64_tr_b16 a[216:217], v228 offset:3328
  v_mfma_f32_16x16x32_bf16 v[120:123], a[200:203], v[180:183], v[120:123]
  s_add_u32 s29, s29, s30
  ds_read_b64_tr_b16 a[218:219], v228 offset:11520
  v_mfma_f32_16x16x32_bf16 v[124:127], a[200:203], v[184:187], v[124:127]
  buffer_load_dwordx4 v232, s[16:19], s29 offen offset:3072 lds
  v_mfma_f32_16x16x32_bf16 v[128:131], a[200:203], v[188:191], v[128:131]
  s_waitcnt lgkmcnt(6)
  ds_read_b64_tr_b16 a[220:221], v239 offset:3328
  v_mfma_f32_16x16x32_bf16 v[132:135], a[204:207], v[180:183], v[132:135]
  s_add_u32 m0, s28, 16384
  ds_read_b64_tr_b16 a[222:223], v239 offset:11520
  v_add_u32 v228, 81920, v230
  v_mfma_f32_16x16x32_bf16 v[136:139], a[204:207], v[184:187], v[136:139]
  s_mov_b32 s29, 3072
  buffer_load_dwordx4 v231, s[8:11], s29 offen offset:0 nt lds
  v_mfma_f32_16x16x32_bf16 v[140:143], a[204:207], v[188:191], v[140:143]
  s_waitcnt lgkmcnt(6)
  ds_read_b64_tr_b16 a[192:193], v228 offset:0
  v_xor_b32 v239, 32, v228
  v_mfma_f32_16x16x32_bf16 v[144:147], a[208:211], v[180:183], v[144:147]
  s_add_u32 s29, s29, s30
  ds_read_b64_tr_b16 a[194:195], v228 offset:8192
  v_mfma_f32_16x16x32_bf16 v[148:151], a[208:211], v[184:187], v[148:151]
  buffer_load_dwordx4 v231, s[8:11], s29 offen offset:1024 nt lds
  v_mfma_f32_16x16x32_bf16 v[152:155], a[208:211], v[188:191], v[152:155]
  s_waitcnt lgkmcnt(6)
  ds_read_b64_tr_b16 a[196:197], v239 offset:0
  v_mfma_f32_16x16x32_bf16 v[156:159], a[212:215], v[180:183], v[156:159]
  s_add_u32 s29, s29, s30
  ds_read_b64_tr_b16 a[198:199], v239 offset:8192
  v_mfma_f32_16x16x32_bf16 v[160:163], a[212:215], v[184:187], v[160:163]
  ds_read_b64_tr_b16 a[200:201], v228 offset:256
  v_mfma_f32_16x16x32_bf16 v[164:167], a[212:215], v[188:191], v[164:167]
  s_waitcnt lgkmcnt(7)
  ds_read_b64_tr_b16 a[202:203], v228 offset:8448
  v_mfma_f32_16x16x32_bf16 a[224:227], a[216:219], v[180:183], a[224:227]
  ds_read_b64_tr_b16 a[204:205], v239 offset:256
  v_mfma_f32_16x16x32_bf16 a[228:231], a[216:219], v[184:187], a[228:231]
  buffer_load_dwordx4 v231, s[8:11], s29 offen offset:2048 nt lds
  v_mfma_f32_16x16x32_bf16 a[232:235], a[216:219], v[188:191], a[232:235]
  s_waitcnt lgkmcnt(7)
  ds_read_b64_tr_b16 a[206:207], v239 offset:8448
  v_mfma_f32_16x16x32_bf16 a[236:239], a[220:223], v[180:183], a[236:239]
  s_add_u32 s29, s29, s30
  ds_read_b64_tr_b16 a[208:209], v228 offset:1024
  v_mfma_f32_16x16x32_bf16 a[240:243], a[220:223], v[184:187], a[240:243]
  buffer_load_dwordx4 v231, s[8:11], s29 offen offset:3072 nt lds
  v_mfma_f32_16x16x32_bf16 a[244:247], a[220:223], v[188:191], a[244:247]
  s_waitcnt lgkmcnt(7)
  ds_read_b64_tr_b16 a[210:211], v228 offset:9216
  v_mfma_f32_16x16x32_bf16 v[0:3], a[192:195], v[192:195], v[0:3]
  s_waitcnt vmcnt(12)
  ds_read_b64_tr_b16 a[212:213], v239 offset:1024
  v_mfma_f32_16x16x32_bf16 v[4:7], a[192:195], v[196:199], v[4:7]
  s_barrier
  ds_read_b64_tr_b16 a[214:215], v239 offset:9216
  v_add_u32 v238, 114688, v237
  v_mfma_f32_16x16x32_bf16 v[8:11], a[192:195], v[200:203], v[8:11]
  s_waitcnt lgkmcnt(8)
  ds_read_b128 a[0:3], v238 offset:0
  v_mfma_f32_16x16x32_bf16 v[12:15], a[196:199], v[192:195], v[12:15]
  s_add_u32 m0, s28, 32768
  ds_read_b128 a[12:15], v238 offset:256
  v_mfma_f32_16x16x32_bf16 v[16:19], a[196:199], v[196:199], v[16:19]
  s_mov_b32 s29, 17792
  buffer_load_dwordx4 v233, s[4:7], s29 offen offset:0 lds
  v_mfma_f32_16x16x32_bf16 v[20:23], a[196:199], v[200:203], v[20:23]
  s_waitcnt lgkmcnt(8)
  ds_read_b128 a[4:7], v238 offset:2048
  v_mfma_f32_16x16x32_bf16 v[24:27], a[200:203], v[192:195], v[24:27]
  s_mov_b32 s29, 23936
  ds_read_b128 a[16:19], v238 offset:2304
  v_add_u32 v238, 131072, v237
  v_mfma_f32_16x16x32_bf16 v[28:31], a[200:203], v[196:199], v[28:31]
  buffer_load_dwordx4 v233, s[4:7], s29 offen offset:1024 lds
  v_mfma_f32_16x16x32_bf16 v[32:35], a[200:203], v[200:203], v[32:35]
  s_waitcnt lgkmcnt(8)
  ds_read_b64_tr_b16 a[216:217], v228 offset:1280
  v_mfma_f32_16x16x32_bf16 v[36:39], a[204:207], v[192:195], v[36:39]
  s_mov_b32 s29, 30080
  ds_read_b64_tr_b16 a[218:219], v228 offset:9472
  v_mfma_f32_16x16x32_bf16 v[40:43], a[204:207], v[196:199], v[40:43]
  ds_read_b64_tr_b16 a[220:221], v239 offset:1280
  v_mfma_f32_16x16x32_bf16 v[44:47], a[204:207], v[200:203], v[44:47]
  s_waitcnt lgkmcnt(9)
  ds_read_b64_tr_b16 a[222:223], v239 offset:9472
  v_mfma_f32_16x16x32_bf16 v[48:51], a[208:211], v[192:195], v[48:51]
  ds_read_b128 a[8:11], v238 offset:0
  v_mfma_f32_16x16x32_bf16 v[52:55], a[208:211], v[196:199], v[52:55]
  buffer_load_dwordx4 v233, s[4:7], s29 offen offset:2048 lds
  v_mfma_f32_16x16x32_bf16 v[56:59], a[208:211], v[200:203], v[56:59]
  s_waitcnt lgkmcnt(9)
  ds_read_b64_tr_b16 a[192:193], v228 offset:2048
  v_mfma_f32_16x16x32_bf16 v[60:63], a[212:215], v[192:195], v[60:63]
  s_mov_b32 s29, 36224
  ds_read_b64_tr_b16 a[194:195], v228 offset:10240
  v_mfma_f32_16x16x32_bf16 v[64:67], a[212:215], v[196:199], v[64:67]
  buffer_load_dwordx4 v233, s[4:7], s29 offen offset:3072 lds
  v_mfma_f32_16x16x32_bf16 v[68:71], a[212:215], v[200:203], v[68:71]
  s_waitcnt lgkmcnt(5)
  ds_read_b64_tr_b16 a[196:197], v239 offset:2048
  v_mfma_f32_16x16x32_bf16 v[72:75], a[216:219], v[192:195], v[72:75]
  s_add_u32 m0, s28, 49152
  ds_read_b64_tr_b16 a[198:199], v239 offset:10240
  v_mfma_f32_16x16x32_bf16 v[76:79], a[216:219], v[196:199], v[76:79]
  s_mov_b32 s29, 1575936
  buffer_load_dwordx4 v232, s[16:19], s29 offen offset:0 lds
  v_mfma_f32_16x16x32_bf16 v[80:83], a[216:219], v[200:203], v[80:83]
  s_waitcnt lgkmcnt(5)
  ds_read_b64_tr_b16 a[200:201], v228 offset:2304
  v_mfma_f32_16x16x32_bf16 v[84:87], a[220:223], v[192:195], v[84:87]
  s_add_u32 s29, s29, s30
  ds_read_b64_tr_b16 a[202:203], v228 offset:10496
  v_mfma_f32_16x16x32_bf16 v[88:91], a[220:223], v[196:199], v[88:91]
  buffer_load_dwordx4 v232, s[16:19], s29 offen offset:1024 lds
  v_mfma_f32_16x16x32_bf16 v[92:95], a[220:223], v[200:203], v[92:95]
  s_waitcnt lgkmcnt(4)
  ds_read_b64_tr_b16 a[204:205], v239 offset:2304
  v_mfma_f32_16x16x32_bf16 v[96:99], a[192:195], v[192:195], v[96:99]
  s_add_u32 s29, s29, s30
  ds_read_b64_tr_b16 a[206:207], v239 offset:10496
  v_mfma_f32_16x16x32_bf16 v[100:103], a[192:195], v[196:199], v[100:103]
  ds_read_b64_tr_b16 a[208:209], v228 offset:3072
  v_mfma_f32_16x16x32_bf16 v[104:107], a[192:195], v[200:203], v[104:107]
  s_waitcnt lgkmcnt(5)
  ds_read_b64_tr_b16 a[210:211], v228 offset:11264
  v_mfma_f32_16x16x32_bf16 v[108:111], a[196:199], v[192:195], v[108:111]
  ds_read_b128 a[20:23], v238 offset:256
  v_mfma_f32_16x16x32_bf16 v[112:115], a[196:199], v[196:199], v[112:115]
  buffer_load_dwordx4 v232, s[16:19], s29 offen offset:2048 lds
  v_mfma_f32_16x16x32_bf16 v[116:119], a[196:199], v[200:203], v[116:119]
  s_waitcnt lgkmcnt(5)
  ds_read_b64_tr_b16 a[212:213], v239 offset:3072
  v_mfma_f32_16x16x32_bf16 v[120:123], a[200:203], v[192:195], v[120:123]
  s_add_u32 s29, s29, s30
  ds_read_b64_tr_b16 a[214:215], v239 offset:11264
  v_mfma_f32_16x16x32_bf16 v[124:127], a[200:203], v[196:199], v[124:127]
  buffer_load_dwordx4 v232, s[16:19], s29 offen offset:3072 lds
  v_mfma_f32_16x16x32_bf16 v[128:131], a[200:203], v[200:203], v[128:131]
  s_waitcnt lgkmcnt(5)
  ds_read_b64_tr_b16 a[216:217], v228 offset:3328
  v_mfma_f32_16x16x32_bf16 v[132:135], a[204:207], v[192:195], v[132:135]
  s_add_u32 m0, s28, 65536
  ds_read_b64_tr_b16 a[218:219], v228 offset:11520
  v_mfma_f32_16x16x32_bf16 v[136:139], a[204:207], v[196:199], v[136:139]
  s_mov_b32 s29, 19456
  buffer_load_dwordx4 v231, s[8:11], s29 offen offset:0 nt lds
  v_mfma_f32_16x16x32_bf16 v[140:143], a[204:207], v[200:203], v[140:143]
  s_waitcnt lgkmcnt(5)
  ds_read_b64_tr_b16 a[220:221], v239 offset:3328
  v_mfma_f32_16x16x32_bf16 v[144:147], a[208:211], v[192:195], v[144:147]
  s_add_u32 s29, s29, s30
  ds_read_b64_tr_b16 a[222:223], v239 offset:11520
  v_add_u32 v228, 98304, v230
  v_mfma_f32_16x16x32_bf16 v[148:151], a[208:211], v[196:199], v[148:151]
  buffer_load_dwordx4 v231, s[8:11], s29 offen offset:1024 nt lds
  v_mfma_f32_16x16x32_bf16 v[152:155], a[208:211], v[200:203], v[152:155]
  s_waitcnt lgkmcnt(4)
  ds_read_b64_tr_b16 a[192:193], v228 offset:0
  v_xor_b32 v239, 32, v228
  v_mfma_f32_16x16x32_bf16 v[156:159], a[212:215], v[192:195], v[156:159]
  s_add_u32 s29, s29, s30
  ds_read_b64_tr_b16 a[194:195], v228 offset:8192
  v_mfma_f32_16x16x32_bf16 v[160:163], a[212:215], v[196:199], v[160:163]
  ds_read_b64_tr_b16 a[196:197], v239 offset:0
  ds_read_b128 a[24:27], v238 offset:2048
  v_mfma_f32_16x16x32_bf16 v[164:167], a[212:215], v[200:203], v[164:167]
  s_waitcnt lgkmcnt(6)
  ds_read_b64_tr_b16 a[198:199], v239 offset:8192
  v_mfma_f32_16x16x32_bf16 a[224:227], a[216:219], v[192:195], a[224:227]
  ds_read_b128 a[36:39], v238 offset:2304
  v_mfma_f32_16x16x32_bf16 a[228:231], a[216:219], v[196:199], a[228:231]
  buffer_load_dwordx4 v231, s[8:11], s29 offen offset:2048 nt lds
  v_mfma_f32_16x16x32_bf16 a[232:235], a[216:219], v[200:203], a[232:235]
  s_waitcnt lgkmcnt(6)
  ds_read_b64_tr_b16 a[200:201], v228 offset:256
  v_mfma_f32_16x16x32_bf16 a[236:239], a[220:223], v[192:195], a[236:239]
  s_add_u32 s29, s29, s30
  ds_read_b64_tr_b16 a[202:203], v228 offset:8448
  v_mfma_f32_16x16x32_bf16 a[240:243], a[220:223], v[196:199], a[240:243]
  buffer_load_dwordx4 v231, s[8:11], s29 offen offset:3072 nt lds
  v_mfma_f32_16x16x32_bf16 a[244:247], a[220:223], v[200:203], a[244:247]
  s_waitcnt lgkmcnt(2)
  ds_read_b64_tr_b16 a[204:205], v239 offset:256
  v_mfma_f32_16x16x32_bf16 v[0:3], a[192:195], v[204:207], v[0:3]
  s_waitcnt vmcnt(20)
  ds_read_b64_tr_b16 a[206:207], v239 offset:8448
  v_mfma_f32_16x16x32_bf16 v[4:7], a[192:195], v[208:211], v[4:7]
  s_barrier
  ds_read_b64_tr_b16 a[208:209], v228 offset:1024
  v_mfma_f32_16x16x32_bf16 v[8:11], a[192:195], v[212:215], v[8:11]
  s_waitcnt lgkmcnt(15)
  ds_read_b64_tr_b16 a[210:211], v228 offset:9216
  v_mfma_f32_16x16x32_bf16 v[12:15], a[196:199], v[204:207], v[12:15]
  s_add_u32 m0, s28, 81920
  ds_read_b64_tr_b16 a[212:213], v239 offset:1024
  v_mfma_f32_16x16x32_bf16 v[16:19], a[196:199], v[208:211], v[16:19]
  s_mov_b32 s29, 1838080
  buffer_load_dwordx4 v232, s[16:19], s29 offen offset:0 lds
  v_mfma_f32_16x16x32_bf16 v[20:23], a[196:199], v[212:215], v[20:23]
  s_waitcnt lgkmcnt(5)
  ds_read_b64_tr_b16 a[214:215], v239 offset:9216
  v_mfma_f32_16x16x32_bf16 v[24:27], a[200:203], v[204:207], v[24:27]
  s_add_u32 s29, s29, s30
  ds_read_b64_tr_b16 a[216:217], v228 offset:1280
  v_mfma_f32_16x16x32_bf16 v[28:31], a[200:203], v[208:211], v[28:31]
  ds_read_b64_tr_b16 a[218:219], v228 offset:9472
  v_mfma_f32_16x16x32_bf16 v[32:35], a[200:203], v[212:215], v[32:35]
  s_waitcnt lgkmcnt(6)
  ds_read_b64_tr_b16 a[220:221], v239 offset:1280
  v_mfma_f32_16x16x32_bf16 v[36:39], a[204:207], v[204:207], v[36:39]
  ds_read_b64_tr_b16 a[222:223], v239 offset:9472
  v_mfma_f32_16x16x32_bf16 v[40:43], a[204:207], v[208:211], v[40:43]
  buffer_load_dwordx4 v232, s[16:19], s29 offen offset:1024 lds
  v_mfma_f32_16x16x32_bf16 v[44:47], a[204:207], v[212:215], v[44:47]
  s_waitcnt lgkmcnt(6)
  ds_read_b64_tr_b16 a[192:193], v228 offset:2048
  v_mfma_f32_16x16x32_bf16 v[48:51], a[208:211], v[204:207], v[48:51]
  s_add_u32 s29, s29, s30
  ds_read_b64_tr_b16 a[194:195], v228 offset:10240
  v_mfma_f32_16x16x32_bf16 v[52:55], a[208:211], v[208:211], v[52:55]
  ds_read_b64_tr_b16 a[196:197], v239 offset:2048
  v_mfma_f32_16x16x32_bf16 v[56:59], a[208:211], v[212:215], v[56:59]
  s_waitcnt lgkmcnt(7)
  ds_read_b64_tr_b16 a[198:199], v239 offset:10240
  v_mfma_f32_16x16x32_bf16 v[60:63], a[212:215], v[204:207], v[60:63]
  ds_read_b64_tr_b16 a[200:201], v228 offset:2304
  v_mfma_f32_16x16x32_bf16 v[64:67], a[212:215], v[208:211], v[64:67]
  buffer_load_dwordx4 v232, s[16:19], s29 offen offset:2048 lds
  v_mfma_f32_16x16x32_bf16 v[68:71], a[212:215], v[212:215], v[68:71]
  s_waitcnt lgkmcnt(7)
  ds_read_b64_tr_b16 a[202:203], v228 offset:10496
  v_mfma_f32_16x16x32_bf16 v[72:75], a[216:219], v[204:207], v[72:75]
  s_add_u32 s29, s29, s30
  ds_read_b64_tr_b16 a[204:205], v239 offset:2304
  v_mfma_f32_16x16x32_bf16 v[76:79], a[216:219], v[208:211], v[76:79]
  ds_read_b64_tr_b16 a[206:207], v239 offset:10496
  v_mfma_f32_16x16x32_bf16 v[80:83], a[216:219], v[212:215], v[80:83]
  s_waitcnt lgkmcnt(8)
  v_mfma_f32_16x16x32_bf16 v[84:87], a[220:223], v[204:207], v[84:87]
  ds_read_b64_tr_b16 a[208:209], v228 offset:3072
  v_mfma_f32_16x16x32_bf16 v[88:91], a[220:223], v[208:211], v[88:91]
  buffer_load_dwordx4 v232, s[16:19], s29 offen offset:3072 lds
  v_mfma_f32_16x16x32_bf16 v[92:95], a[220:223], v[212:215], v[92:95]
  s_waitcnt lgkmcnt(7)
  ds_read_b64_tr_b16 a[210:211], v228 offset:11264
  v_mfma_f32_16x16x32_bf16 v[96:99], a[192:195], v[204:207], v[96:99]
  s_add_u32 m0, s28, 114688
  ds_read_b64_tr_b16 a[212:213], v239 offset:3072
  v_mfma_f32_16x16x32_bf16 v[100:103], a[192:195], v[208:211], v[100:103]
  s_mov_b32 s29, 3072
  ds_read_b64_tr_b16 a[214:215], v239 offset:11264
  v_mfma_f32_16x16x32_bf16 v[104:107], a[192:195], v[212:215], v[104:107]
  s_waitcnt lgkmcnt(8)
  v_mfma_f32_16x16x32_bf16 v[108:111], a[196:199], v[204:207], v[108:111]
  ds_read_b64_tr_b16 a[216:217], v228 offset:3328
  v_mfma_f32_16x16x32_bf16 v[112:115], a[196:199], v[208:211], v[112:115]
  buffer_load_dwordx4 v231, s[12:15], s29 offen offset:0 nt lds
  v_mfma_f32_16x16x32_bf16 v[116:119], a[196:199], v[212:215], v[116:119]
  s_waitcnt lgkmcnt(7)
  ds_read_b64_tr_b16 a[218:219], v228 offset:11520
  v_mfma_f32_16x16x32_bf16 v[120:123], a[200:203], v[204:207], v[120:123]
  s_add_u32 s29, s29, s30
  ds_read_b64_tr_b16 a[220:221], v239 offset:3328
  v_mfma_f32_16x16x32_bf16 v[124:127], a[200:203], v[208:211], v[124:127]
  ds_read_b64_tr_b16 a[222:223], v239 offset:11520
  v_add_u32 v228, 147456, v230
  v_mfma_f32_16x16x32_bf16 v[128:131], a[200:203], v[212:215], v[128:131]
  s_waitcnt lgkmcnt(8)
  v_xor_b32 v239, 32, v228
  v_mfma_f32_16x16x32_bf16 v[132:135], a[204:207], v[204:207], v[132:135]
  ds_read_b64_tr_b16 a[192:193], v228 offset:0
  v_mfma_f32_16x16x32_bf16 v[136:139], a[204:207], v[208:211], v[136:139]
  buffer_load_dwordx4 v231, s[12:15], s29 offen offset:1024 nt lds
  v_mfma_f32_16x16x32_bf16 v[140:143], a[204:207], v[212:215], v[140:143]
  s_waitcnt lgkmcnt(7)
  ds_read_b64_tr_b16 a[194:195], v228 offset:8192
  v_mfma_f32_16x16x32_bf16 v[144:147], a[208:211], v[204:207], v[144:147]
  s_add_u32 s29, s29, s30
  ds_read_b64_tr_b16 a[196:197], v239 offset:0
  v_mfma_f32_16x16x32_bf16 v[148:151], a[208:211], v[208:211], v[148:151]
  ds_read_b64_tr_b16 a[198:199], v239 offset:8192
  v_mfma_f32_16x16x32_bf16 v[152:155], a[208:211], v[212:215], v[152:155]
  s_waitcnt lgkmcnt(8)
  v_mfma_f32_16x16x32_bf16 v[156:159], a[212:215], v[204:207], v[156:159]
  ds_read_b64_tr_b16 a[200:201], v228 offset:256
  v_mfma_f32_16x16x32_bf16 v[160:163], a[212:215], v[208:211], v[160:163]
  buffer_load_dwordx4 v231, s[12:15], s29 offen offset:2048 nt lds
  v_mfma_f32_16x16x32_bf16 v[164:167], a[212:215], v[212:215], v[164:167]
  s_waitcnt lgkmcnt(7)
  ds_read_b64_tr_b16 a[202:203], v228 offset:8448
  v_mfma_f32_16x16x32_bf16 a[224:227], a[216:219], v[204:207], a[224:227]
  s_add_u32 s29, s29, s30
  ds_read_b64_tr_b16 a[204:205], v239 offset:256
  v_mfma_f32_16x16x32_bf16 a[228:231], a[216:219], v[208:211], a[228:231]
  ds_read_b64_tr_b16 a[206:207], v239 offset:8448
  v_mfma_f32_16x16x32_bf16 a[232:235], a[216:219], v[212:215], a[232:235]
  s_waitcnt lgkmcnt(8)
  v_mfma_f32_16x16x32_bf16 a[236:239], a[220:223], v[204:207], a[236:239]
  ds_read_b64_tr_b16 a[208:209], v228 offset:1024
  v_mfma_f32_16x16x32_bf16 a[240:243], a[220:223], v[208:211], a[240:243]
  buffer_load_dwordx4 v231, s[12:15], s29 offen offset:3072 nt lds
  v_mfma_f32_16x16x32_bf16 a[244:247], a[220:223], v[212:215], a[244:247]
  s_waitcnt lgkmcnt(7)
  ds_read_b64_tr_b16 a[210:211], v228 offset:9216
  v_mfma_f32_16x16x32_bf16 v[0:3], a[192:195], a[0:3], v[0:3]
  s_waitcnt vmcnt(16)
  ds_read_b64_tr_b16 a[212:213], v239 offset:1024
  v_mfma_f32_16x16x32_bf16 v[4:7], a[192:195], a[4:7], v[4:7]
  s_barrier
  ds_read_b64_tr_b16 a[214:215], v239 offset:9216
  v_add_u32 v238, 32768, v237
  v_mfma_f32_16x16x32_bf16 v[8:11], a[192:195], a[8:11], v[8:11]
  s_waitcnt lgkmcnt(8)
  ds_read_b128 a[28:31], v238 offset:0
  v_mfma_f32_16x16x32_bf16 v[12:15], a[196:199], a[0:3], v[12:15]
  s_add_u32 m0, s28, 131072
  ds_read_b128 a[40:43], v238 offset:256
  v_mfma_f32_16x16x32_bf16 v[16:19], a[196:199], a[4:7], v[16:19]
  s_mov_b32 s29, 3584
  buffer_load_dwordx4 v233, s[4:7], s29 offen offset:0 lds
  v_mfma_f32_16x16x32_bf16 v[20:23], a[196:199], a[8:11], v[20:23]
  s_waitcnt lgkmcnt(8)
  ds_read_b128 a[32:35], v238 offset:2048
  v_mfma_f32_16x16x32_bf16 v[24:27], a[200:203], a[0:3], v[24:27]
  s_mov_b32 s29, 9728
  ds_read_b128 a[44:47], v238 offset:2304
  v_mfma_f32_16x16x32_bf16 v[28:31], a[200:203], a[4:7], v[28:31]
  ds_read_b64_tr_b16 a[216:217], v228 offset:1280
  v_mfma_f32_16x16x32_bf16 v[32:35], a[200:203], a[8:11], v[32:35]
  s_waitcnt lgkmcnt(9)
  ds_read_b64_tr_b16 a[218:219], v228 offset:9472
  v_mfma_f32_16x16x32_bf16 v[36:39], a[204:207], a[0:3], v[36:39]
  ds_read_b64_tr_b16 a[220:221], v239 offset:1280
  v_mfma_f32_16x16x32_bf16 v[40:43], a[204:207], a[4:7], v[40:43]
  buffer_load_dwordx4 v233, s[4:7], s29 offen offset:1024 lds
  v_mfma_f32_16x16x32_bf16 v[44:47], a[204:207], a[8:11], v[44:47]
  s_waitcnt lgkmcnt(9)
  ds_read_b64_tr_b16 a[222:223], v239 offset:9472
  v_mfma_f32_16x16x32_bf16 v[48:51], a[208:211], a[0:3], v[48:51]
  s_mov_b32 s29, 15872
  ds_read_b64_tr_b16 a[192:193], v228 offset:2048
  v_mfma_f32_16x16x32_bf16 v[52:55], a[208:211], a[4:7], v[52:55]
  ds_read_b64_tr_b16 a[194:195], v228 offset:10240
  v_mfma_f32_16x16x32_bf16 v[56:59], a[208:211], a[8:11], v[56:59]
  s_waitcnt lgkmcnt(10)
  ds_read_b64_tr_b16 a[196:197], v239 offset:2048
  v_mfma_f32_16x16x32_bf16 v[60:63], a[212:215], a[0:3], v[60:63]
  ds_read_b64_tr_b16 a[198:199], v239 offset:10240
  v_mfma_f32_16x16x32_bf16 v[64:67], a[212:215], a[4:7], v[64:67]
  buffer_load_dwordx4 v233, s[4:7], s29 offen offset:2048 lds
  v_mfma_f32_16x16x32_bf16 v[68:71], a[212:215], a[8:11], v[68:71]
  s_waitcnt lgkmcnt(6)
  ds_read_b64_tr_b16 a[200:201], v228 offset:2304
  v_mfma_f32_16x16x32_bf16 v[72:75], a[216:219], a[0:3], v[72:75]
  s_mov_b32 s29, 22016
  ds_read_b64_tr_b16 a[202:203], v228 offset:10496
  v_mfma_f32_16x16x32_bf16 v[76:79], a[216:219], a[4:7], v[76:79]
  ds_read_b64_tr_b16 a[204:205], v239 offset:2304
  v_mfma_f32_16x16x32_bf16 v[80:83], a[216:219], a[8:11], v[80:83]
  s_waitcnt lgkmcnt(7)
  ds_read_b64_tr_b16 a[206:207], v239 offset:10496
  v_mfma_f32_16x16x32_bf16 v[84:87], a[220:223], a[0:3], v[84:87]
  ds_read_b64_tr_b16 a[208:209], v228 offset:3072
  v_mfma_f32_16x16x32_bf16 v[88:91], a[220:223], a[4:7], v[88:91]
  buffer_load_dwordx4 v233, s[4:7], s29 offen offset:3072 lds
  v_mfma_f32_16x16x32_bf16 v[92:95], a[220:223], a[8:11], v[92:95]
  s_waitcnt lgkmcnt(7)
  ds_read_b64_tr_b16 a[210:211], v228 offset:11264
  v_mfma_f32_16x16x32_bf16 v[96:99], a[192:195], a[0:3], v[96:99]
  s_add_u32 m0, s28, 98304
  ds_read_b64_tr_b16 a[212:213], v239 offset:3072
  v_mfma_f32_16x16x32_bf16 v[100:103], a[192:195], a[4:7], v[100:103]
  s_mov_b32 s29, 32256
  ds_read_b64_tr_b16 a[214:215], v239 offset:11264
  v_mfma_f32_16x16x32_bf16 v[104:107], a[192:195], a[8:11], v[104:107]
  s_waitcnt lgkmcnt(8)
  v_mfma_f32_16x16x32_bf16 v[108:111], a[196:199], a[0:3], v[108:111]
  ds_read_b64_tr_b16 a[216:217], v228 offset:3328
  v_mfma_f32_16x16x32_bf16 v[112:115], a[196:199], a[4:7], v[112:115]
  buffer_load_dwordx4 v233, s[4:7], s29 offen offset:0 lds
  v_mfma_f32_16x16x32_bf16 v[116:119], a[196:199], a[8:11], v[116:119]
  s_waitcnt lgkmcnt(7)
  ds_read_b64_tr_b16 a[218:219], v228 offset:11520
  v_mfma_f32_16x16x32_bf16 v[120:123], a[200:203], a[0:3], v[120:123]
  s_mov_b32 s29, 38400
  ds_read_b64_tr_b16 a[220:221], v239 offset:3328
  v_mfma_f32_16x16x32_bf16 v[124:127], a[200:203], a[4:7], v[124:127]
  ds_read_b64_tr_b16 a[222:223], v239 offset:11520
  v_add_u32 v228, 0, v230
  v_mfma_f32_16x16x32_bf16 v[128:131], a[200:203], a[8:11], v[128:131]
  s_waitcnt lgkmcnt(8)
  v_xor_b32 v239, 32, v228
  v_mfma_f32_16x16x32_bf16 v[132:135], a[204:207], a[0:3], v[132:135]
  ds_read_b64_tr_b16 a[192:193], v228 offset:0
  v_mfma_f32_16x16x32_bf16 v[136:139], a[204:207], a[4:7], v[136:139]
  buffer_load_dwordx4 v233, s[4:7], s29 offen offset:1024 lds
  v_mfma_f32_16x16x32_bf16 v[140:143], a[204:207], a[8:11], v[140:143]
  s_waitcnt lgkmcnt(7)
  ds_read_b64_tr_b16 a[194:195], v228 offset:8192
  v_mfma_f32_16x16x32_bf16 v[144:147], a[208:211], a[0:3], v[144:147]
  s_mov_b32 s29, 1664
  ds_read_b64_tr_b16 a[196:197], v239 offset:0
  v_mfma_f32_16x16x32_bf16 v[148:151], a[208:211], a[4:7], v[148:151]
  ds_read_b64_tr_b16 a[198:199], v239 offset:8192
  v_mfma_f32_16x16x32_bf16 v[152:155], a[208:211], a[8:11], v[152:155]
  s_waitcnt lgkmcnt(8)
  v_mfma_f32_16x16x32_bf16 v[156:159], a[212:215], a[0:3], v[156:159]
  ds_read_b64_tr_b16 a[200:201], v228 offset:256
  v_mfma_f32_16x16x32_bf16 v[160:163], a[212:215], a[4:7], v[160:163]
  buffer_load_dwordx4 v233, s[4:7], s29 offen offset:2048 lds
  v_mfma_f32_16x16x32_bf16 v[164:167], a[212:215], a[8:11], v[164:167]
  s_waitcnt lgkmcnt(7)
  ds_read_b64_tr_b16 a[202:203], v228 offset:8448
  v_mfma_f32_16x16x32_bf16 a[224:227], a[216:219], a[0:3], a[224:227]
  s_mov_b32 s29, 7808
  ds_read_b64_tr_b16 a[204:205], v239 offset:256
  v_mfma_f32_16x16x32_bf16 a[228:231], a[216:219], a[4:7], a[228:231]
  ds_read_b64_tr_b16 a[206:207], v239 offset:8448
  v_mfma_f32_16x16x32_bf16 a[232:235], a[216:219], a[8:11], a[232:235]
  s_waitcnt lgkmcnt(8)
  v_mfma_f32_16x16x32_bf16 a[236:239], a[220:223], a[0:3], a[236:239]
  ds_read_b64_tr_b16 a[208:209], v228 offset:1024
  v_mfma_f32_16x16x32_bf16 a[240:243], a[220:223], a[4:7], a[240:243]
  buffer_load_dwordx4 v233, s[4:7], s29 offen offset:3072 lds
  v_mfma_f32_16x16x32_bf16 a[244:247], a[220:223], a[8:11], a[244:247]
  s_waitcnt lgkmcnt(7)
  ds_read_b64_tr_b16 a[210:211], v228 offset:9216
  v_mfma_f32_16x16x32_bf16 v[0:3], a[192:195], a[12:15], v[0:3]
  s_waitcnt vmcnt(20)
  ds_read_b64_tr_b16 a[212:213], v239 offset:1024
  v_mfma_f32_16x16x32_bf16 v[4:7], a[192:195], a[16:19], v[4:7]
  s_barrier
  ds_read_b64_tr_b16 a[214:215], v239 offset:9216
  v_mfma_f32_16x16x32_bf16 v[8:11], a[192:195], a[20:23], v[8:11]
  s_waitcnt lgkmcnt(8)
  v_mfma_f32_16x16x32_bf16 v[12:15], a[196:199], a[12:15], v[12:15]
  s_add_u32 m0, s28, 147456
  ds_read_b64_tr_b16 a[216:217], v228 offset:1280
  v_mfma_f32_16x16x32_bf16 v[16:19], a[196:199], a[16:19], v[16:19]
  s_mov_b32 s29, 2100224
  buffer_load_dwordx4 v232, s[16:19], s29 offen offset:0 lds
  v_mfma_f32_16x16x32_bf16 v[20:23], a[196:199], a[20:23], v[20:23]
  s_waitcnt lgkmcnt(7)
  ds_read_b64_tr_b16 a[218:219], v228 offset:9472
  v_mfma_f32_16x16x32_bf16 v[24:27], a[200:203], a[12:15], v[24:27]
  s_add_u32 s29, s29, s30
  ds_read_b64_tr_b16 a[220:221], v239 offset:1280
  v_mfma_f32_16x16x32_bf16 v[28:31], a[200:203], a[16:19], v[28:31]
  ds_read_b64_tr_b16 a[222:223], v239 offset:9472
  v_mfma_f32_16x16x32_bf16 v[32:35], a[200:203], a[20:23], v[32:35]
  s_waitcnt lgkmcnt(8)
  v_mfma_f32_16x16x32_bf16 v[36:39], a[204:207], a[12:15], v[36:39]
  ds_read_b64_tr_b16 a[192:193], v228 offset:2048
  v_mfma_f32_16x16x32_bf16 v[40:43], a[204:207], a[16:19], v[40:43]
  buffer_load_dwordx4 v232, s[16:19], s29 offen offset:1024 lds
  v_mfma_f32_16x16x32_bf16 v[44:47], a[204:207], a[20:23], v[44:47]
  s_waitcnt lgkmcnt(7)
  ds_read_b64_tr_b16 a[194:195], v228 offset:10240
  v_mfma_f32_16x16x32_bf16 v[48:51], a[208:211], a[12:15], v[48:51]
  s_add_u32 s29, s29, s30
  ds_read_b64_tr_b16 a[196:197], v239 offset:2048
  v_mfma_f32_16x16x32_bf16 v[52:55], a[208:211], a[16:19], v[52:55]
  ds_read_b64_tr_b16 a[198:199], v239 offset:10240
  v_mfma_f32_16x16x32_bf16 v[56:59], a[208:211], a[20:23], v[56:59]
  s_waitcnt lgkmcnt(8)
  v_mfma_f32_16x16x32_bf16 v[60:63], a[212:215], a[12:15], v[60:63]
  ds_read_b64_tr_b16 a[200:201], v228 offset:2304
  v_mfma_f32_16x16x32_bf16 v[64:67], a[212:215], a[16:19], v[64:67]
  buffer_load_dwordx4 v232, s[16:19], s29 offen offset:2048 lds
  v_mfma_f32_16x16x32_bf16 v[68:71], a[212:215], a[20:23], v[68:71]
  s_waitcnt lgkmcnt(7)
  ds_read_b64_tr_b16 a[202:203], v228 offset:10496
  v_mfma_f32_16x16x32_bf16 v[72:75], a[216:219], a[12:15], v[72:75]
  s_add_u32 s29, s29, s30
  ds_read_b64_tr_b16 a[204:205], v239 offset:2304
  v_mfma_f32_16x16x32_bf16 v[76:79], a[216:219], a[16:19], v[76:79]
  ds_read_b64_tr_b16 a[206:207], v239 offset:10496
  v_mfma_f32_16x16x32_bf16 v[80:83], a[216:219], a[20:23], v[80:83]
  s_waitcnt lgkmcnt(8)
  v_mfma_f32_16x16x32_bf16 v[84:87], a[220:223], a[12:15], v[84:87]
  ds_read_b64_tr_b16 a[208:209], v228 offset:3072
  v_mfma_f32_16x16x32_bf16 v[88:91], a[220:223], a[16:19], v[88:91]
  buffer_load_dwordx4 v232, s[16:19], s29 offen offset:3072 lds
  v_mfma_f32_16x16x32_bf16 v[92:95], a[220:223], a[20:23], v[92:95]
  s_waitcnt lgkmcnt(7)
  ds_read_b64_tr_b16 a[210:211], v228 offset:11264
  v_mfma_f32_16x16x32_bf16 v[96:99], a[192:195], a[12:15], v[96:99]
  s_add_u32 m0, s28, 32768
  ds_read_b64_tr_b16 a[212:213], v239 offset:3072
  v_mfma_f32_16x16x32_bf16 v[100:103], a[192:195], a[16:19], v[100:103]
  s_mov_b32 s29, 2362368
  ds_read_b64_tr_b16 a[214:215], v239 offset:11264
  v_mfma_f32_16x16x32_bf16 v[104:107], a[192:195], a[20:23], v[104:107]
  s_waitcnt lgkmcnt(8)
  v_mfma_f32_16x16x32_bf16 v[108:111], a[196:199], a[12:15], v[108:111]
  ds_read_b64_tr_b16 a[216:217], v228 offset:3328
  v_mfma_f32_16x16x32_bf16 v[112:115], a[196:199], a[16:19], v[112:115]
  buffer_load_dwordx4 v232, s[16:19], s29 offen offset:0 lds
  v_mfma_f32_16x16x32_bf16 v[116:119], a[196:199], a[20:23], v[116:119]
  s_waitcnt lgkmcnt(7)
  ds_read_b64_tr_b16 a[218:219], v228 offset:11520
  v_mfma_f32_16x16x32_bf16 v[120:123], a[200:203], a[12:15], v[120:123]
  s_add_u32 s29, s29, s30
  ds_read_b64_tr_b16 a[220:221], v239 offset:3328
  v_mfma_f32_16x16x32_bf16 v[124:127], a[200:203], a[16:19], v[124:127]
  ds_read_b64_tr_b16 a[222:223], v239 offset:11520
  v_add_u32 v228, 49152, v230
  v_mfma_f32_16x16x32_bf16 v[128:131], a[200:203], a[20:23], v[128:131]
  s_waitcnt lgkmcnt(8)
  v_xor_b32 v239, 32, v228
  v_mfma_f32_16x16x32_bf16 v[132:135], a[204:207], a[12:15], v[132:135]
  ds_read_b64_tr_b16 a[192:193], v228 offset:0
  v_mfma_f32_16x16x32_bf16 v[136:139], a[204:207], a[16:19], v[136:139]
  buffer_load_dwordx4 v232, s[16:19], s29 offen offset:1024 lds
  v_mfma_f32_16x16x32_bf16 v[140:143], a[204:207], a[20:23], v[140:143]
  s_waitcnt lgkmcnt(7)
  ds_read_b64_tr_b16 a[194:195], v228 offset:8192
  v_mfma_f32_16x16x32_bf16 v[144:147], a[208:211], a[12:15], v[144:147]
  s_add_u32 s29, s29, s30
  ds_read_b64_tr_b16 a[196:197], v239 offset:0
  v_mfma_f32_16x16x32_bf16 v[148:151], a[208:211], a[16:19], v[148:151]
  ds_read_b64_tr_b16 a[198:199], v239 offset:8192
  v_mfma_f32_16x16x32_bf16 v[152:155], a[208:211], a[20:23], v[152:155]
  s_waitcnt lgkmcnt(8)
  v_mfma_f32_16x16x32_bf16 v[156:159], a[212:215], a[12:15], v[156:159]
  ds_read_b64_tr_b16 a[200:201], v228 offset:256
  v_mfma_f32_16x16x32_bf16 v[160:163], a[212:215], a[16:19], v[160:163]
  buffer_load_dwordx4 v232, s[16:19], s29 offen offset:2048 lds
  v_mfma_f32_16x16x32_bf16 v[164:167], a[212:215], a[20:23], v[164:167]
  s_waitcnt lgkmcnt(7)
  ds_read_b64_tr_b16 a[202:203], v228 offset:8448
  v_mfma_f32_16x16x32_bf16 a[224:227], a[216:219], a[12:15], a[224:227]
  s_add_u32 s29, s29, s30
  ds_read_b64_tr_b16 a[204:205], v239 offset:256
  v_mfma_f32_16x16x32_bf16 a[228:231], a[216:219], a[16:19], a[228:231]
  ds_read_b64_tr_b16 a[206:207], v239 offset:8448
  v_mfma_f32_16x16x32_bf16 a[232:235], a[216:219], a[20:23], a[232:235]
  s_waitcnt lgkmcnt(8)
  v_mfma_f32_16x16x32_bf16 a[236:239], a[220:223], a[12:15], a[236:239]
  ds_read_b64_tr_b16 a[208:209], v228 offset:1024
  v_mfma_f32_16x16x32_bf16 a[240:243], a[220:223], a[16:19], a[240:243]
  buffer_load_dwordx4 v232, s[16:19], s29 offen offset:3072 lds
  v_mfma_f32_16x16x32_bf16 a[244:247], a[220:223], a[20:23], a[244:247]
  s_waitcnt lgkmcnt(7)
  ds_read_b64_tr_b16 a[210:211], v228 offset:9216
  v_mfma_f32_16x16x32_bf16 v[0:3], a[192:195], a[24:27], v[0:3]
  s_waitcnt vmcnt(8)
  ds_read_b64_tr_b16 a[212:213], v239 offset:1024
  v_mfma_f32_16x16x32_bf16 v[4:7], a[192:195], a[28:31], v[4:7]
  s_barrier
  ds_read_b64_tr_b16 a[214:215], v239 offset:9216
  v_add_u32 v238, 131072, v237
  v_mfma_f32_16x16x32_bf16 v[8:11], a[192:195], a[32:35], v[8:11]
  s_waitcnt lgkmcnt(8)
  ds_read_b128 a[48:51], v238 offset:0
  v_mfma_f32_16x16x32_bf16 v[12:15], a[196:199], a[24:27], v[12:15]
  s_add_u32 m0, s28, 0
  ds_read_b128 a[60:63], v238 offset:256
  v_mfma_f32_16x16x32_bf16 v[16:19], a[196:199], a[28:31], v[16:19]
  s_mov_b32 s29, 18048
  ds_read_b128 a[52:55], v238 offset:2048
  v_mfma_f32_16x16x32_bf16 v[20:23], a[196:199], a[32:35], v[20:23]
  s_waitcnt lgkmcnt(9)
  ds_read_b128 a[64:67], v238 offset:2304
  v_add_u32 v238, 98304, v237
  v_mfma_f32_16x16x32_bf16 v[24:27], a[200:203], a[24:27], v[24:27]
  ds_read_b128 a[56:59], v238 offset:0
  v_mfma_f32_16x16x32_bf16 v[28:31], a[200:203], a[28:31], v[28:31]
  buffer_load_dwordx4 v233, s[4:7], s29 offen offset:0 lds
  v_mfma_f32_16x16x32_bf16 v[32:35], a[200:203], a[32:35], v[32:35]
  s_waitcnt lgkmcnt(9)
  ds_read_b64_tr_b16 a[216:217], v228 offset:1280
  v_mfma_f32_16x16x32_bf16 v[36:39], a[204:207], a[24:27], v[36:39]
  s_mov_b32 s29, 24192
  ds_read_b64_tr_b16 a[218:219], v228 offset:9472
  v_mfma_f32_16x16x32_bf16 v[40:43], a[204:207], a[28:31], v[40:43]
  ds_read_b64_tr_b16 a[220:221], v239 offset:1280
  v_mfma_f32_16x16x32_bf16 v[44:47], a[204:207], a[32:35], v[44:47]
  s_waitcnt lgkmcnt(10)
  ds_read_b64_tr_b16 a[222:223], v239 offset:9472
  v_mfma_f32_16x16x32_bf16 v[48:51], a[208:211], a[24:27], v[48:51]
  ds_read_b128 a[68:71], v238 offset:256
  v_mfma_f32_16x16x32_bf16 v[52:55], a[208:211], a[28:31], v[52:55]
  ds_read_b64_tr_b16 a[192:193], v228 offset:2048
  v_mfma_f32_16x16x32_bf16 v[56:59], a[208:211], a[32:35], v[56:59]
  s_waitcnt lgkmcnt(11)
  ds_read_b64_tr_b16 a[194:195], v228 offset:10240
  v_mfma_f32_16x16x32_bf16 v[60:63], a[212:215], a[24:27], v[60:63]
  ds_read_b128 a[72:75], v238 offset:2048
  v_mfma_f32_16x16x32_bf16 v[64:67], a[212:215], a[28:31], v[64:67]
  ds_read_b64_tr_b16 a[196:197], v239 offset:2048
  v_mfma_f32_16x16x32_bf16 v[68:71], a[212:215], a[32:35], v[68:71]
  s_waitcnt lgkmcnt(7)
  ds_read_b64_tr_b16 a[198:199], v239 offset:10240
  v_mfma_f32_16x16x32_bf16 v[72:75], a[216:219], a[24:27], v[72:75]
  ds_read_b128 a[84:87], v238 offset:2304
  v_mfma_f32_16x16x32_bf16 v[76:79], a[216:219], a[28:31], v[76:79]
  buffer_load_dwordx4 v233, s[4:7], s29 offen offset:1024 lds
  v_mfma_f32_16x16x32_bf16 v[80:83], a[216:219], a[32:35], v[80:83]
  s_waitcnt lgkmcnt(7)
  ds_read_b64_tr_b16 a[200:201], v228 offset:2304
  v_mfma_f32_16x16x32_bf16 v[84:87], a[220:223], a[24:27], v[84:87]
  s_mov_b32 s29, 30336
  ds_read_b64_tr_b16 a[202:203], v228 offset:10496
  v_mfma_f32_16x16x32_bf16 v[88:91], a[220:223], a[28:31], v[88:91]
  ds_read_b64_tr_b16 a[204:205], v239 offset:2304
  v_mfma_f32_16x16x32_bf16 v[92:95], a[220:223], a[32:35], v[92:95]
  s_waitcnt lgkmcnt(7)
  ds_read_b64_tr_b16 a[206:207], v239 offset:10496
  v_mfma_f32_16x16x32_bf16 v[96:99], a[192:195], a[24:27], v[96:99]
  ds_read_b64_tr_b16 a[208:209], v228 offset:3072
  v_mfma_f32_16x16x32_bf16 v[100:103], a[192:195], a[28:31], v[100:103]
  ds_read_b64_tr_b16 a[210:211], v228 offset:11264
  v_mfma_f32_16x16x32_bf16 v[104:107], a[192:195], a[32:35], v[104:107]
  s_waitcnt lgkmcnt(7)
  ds_read_b64_tr_b16 a[212:213], v239 offset:3072
  v_mfma_f32_16x16x32_bf16 v[108:111], a[196:199], a[24:27], v[108:111]
  ds_read_b64_tr_b16 a[214:215], v239 offset:11264
  v_mfma_f32_16x16x32_bf16 v[112:115], a[196:199], a[28:31], v[112:115]
  ds_read_b64_tr_b16 a[216:217], v228 offset:3328
  v_mfma_f32_16x16x32_bf16 v[116:119], a[196:199], a[32:35], v[116:119]
  s_waitcnt lgkmcnt(7)
  ds_read_b64_tr_b16 a[218:219], v228 offset:11520
  v_mfma_f32_16x16x32_bf16 v[120:123], a[200:203], a[24:27], v[120:123]
  ds_read_b64_tr_b16 a[220:221], v239 offset:3328
  v_mfma_f32_16x16x32_bf16 v[124:127], a[200:203], a[28:31], v[124:127]
  buffer_load_dwordx4 v233, s[4:7], s29 offen offset:2048 lds
  v_mfma_f32_16x16x32_bf16 v[128:131], a[200:203], a[32:35], v[128:131]
  s_waitcnt lgkmcnt(7)
  ds_read_b64_tr_b16 a[222:223], v239 offset:11520
  v_add_u32 v228, 81920, v230
  v_mfma_f32_16x16x32_bf16 v[132:135], a[204:207], a[24:27], v[132:135]
  s_mov_b32 s29, 36480
  ds_read_b64_tr_b16 a[192:193], v228 offset:0
  v_xor_b32 v239, 32, v228
  v_mfma_f32_16x16x32_bf16 v[136:139], a[204:207], a[28:31], v[136:139]
  ds_read_b64_tr_b16 a[194:195], v228 offset:8192
  v_mfma_f32_16x16x32_bf16 v[140:143], a[204:207], a[32:35], v[140:143]
  s_waitcnt lgkmcnt(8)
  v_mfma_f32_16x16x32_bf16 v[144:147], a[208:211], a[24:27], v[144:147]
  ds_read_b64_tr_b16 a[196:197], v239 offset:0
  v_mfma_f32_16x16x32_bf16 v[148:151], a[208:211], a[28:31], v[148:151]
  ds_read_b64_tr_b16 a[198:199], v239 offset:8192
  v_mfma_f32_16x16x32_bf16 v[152:155], a[208:211], a[32:35], v[152:155]
  s_waitcnt lgkmcnt(8)
  v_mfma_f32_16x16x32_bf16 v[156:159], a[212:215], a[24:27], v[156:159]
  ds_read_b64_tr_b16 a[200:201], v228 offset:256
  v_mfma_f32_16x16x32_bf16 v[160:163], a[212:215], a[28:31], v[160:163]
  ds_read_b64_tr_b16 a[202:203], v228 offset:8448
  v_mfma_f32_16x16x32_bf16 v[164:167], a[212:215], a[32:35], v[164:167]
  s_waitcnt lgkmcnt(8)
  v_mfma_f32_16x16x32_bf16 a[224:227], a[216:219], a[24:27], a[224:227]
  ds_read_b64_tr_b16 a[204:205], v239 offset:256
  v_mfma_f32_16x16x32_bf16 a[228:231], a[216:219], a[28:31], a[228:231]
  buffer_load_dwordx4 v233, s[4:7], s29 offen offset:3072 lds
  v_mfma_f32_16x16x32_bf16 a[232:235], a[216:219], a[32:35], a[232:235]
  s_waitcnt lgkmcnt(7)
  ds_read_b64_tr_b16 a[206:207], v239 offset:8448
  v_mfma_f32_16x16x32_bf16 a[236:239], a[220:223], a[24:27], a[236:239]
  ds_read_b64_tr_b16 a[208:209], v228 offset:1024
  v_mfma_f32_16x16x32_bf16 a[240:243], a[220:223], a[28:31], a[240:243]
  ds_read_b64_tr_b16 a[210:211], v228 offset:9216
  v_mfma_f32_16x16x32_bf16 a[244:247], a[220:223], a[32:35], a[244:247]
  s_waitcnt lgkmcnt(8)
  v_mfma_f32_16x16x32_bf16 v[0:3], a[192:195], a[36:39], v[0:3]
  s_waitcnt vmcnt(8)
  ds_read_b64_tr_b16 a[212:213], v239 offset:1024
  v_mfma_f32_16x16x32_bf16 v[4:7], a[192:195], a[40:43], v[4:7]
  s_barrier
  ds_read_b64_tr_b16 a[214:215], v239 offset:9216
  v_mfma_f32_16x16x32_bf16 v[8:11], a[192:195], a[44:47], v[8:11]
  s_waitcnt lgkmcnt(8)
  v_mfma_f32_16x16x32_bf16 v[12:15], a[196:199], a[36:39], v[12:15]
  s_add_u32 m0, s28, 49152
  ds_read_b64_tr_b16 a[216:217], v228 offset:1280
  v_mfma_f32_16x16x32_bf16 v[16:19], a[196:199], a[40:43], v[16:19]
  s_mov_b32 s29, 2624512
  buffer_load_dwordx4 v232, s[16:19], s29 offen offset:0 lds
  v_mfma_f32_16x16x32_bf16 v[20:23], a[196:199], a[44:47], v[20:23]
  s_waitcnt lgkmcnt(7)
  ds_read_b64_tr_b16 a[218:219], v228 offset:9472
  v_mfma_f32_16x16x32_bf16 v[24:27], a[200:203], a[36:39], v[24:27]
  s_add_u32 s29, s29, s30
  ds_read_b64_tr_b16 a[220:221], v239 offset:1280
  v_mfma_f32_16x16x32_bf16 v[28:31], a[200:203], a[40:43], v[28:31]
  ds_read_b64_tr_b16 a[222:223], v239 offset:9472
  v_mfma_f32_16x16x32_bf16 v[32:35], a[200:203], a[44:47], v[32:35]
  s_waitcnt lgkmcnt(8)
  v_mfma_f32_16x16x32_bf16 v[36:39], a[204:207], a[36:39], v[36:39]
  ds_read_b64_tr_b16 a[192:193], v228 offset:2048
  v_mfma_f32_16x16x32_bf16 v[40:43], a[204:207], a[40:43], v[40:43]
  buffer_load_dwordx4 v232, s[16:19], s29 offen offset:1024 lds
  v_mfma_f32_16x16x32_bf16 v[44:47], a[204:207], a[44:47], v[44:47]
  s_waitcnt lgkmcnt(7)
  ds_read_b64_tr_b16 a[194:195], v228 offset:10240
  v_mfma_f32_16x16x32_bf16 v[48:51], a[208:211], a[36:39], v[48:51]
  s_add_u32 s29, s29, s30
  ds_read_b64_tr_b16 a[196:197], v239 offset:2048
  v_mfma_f32_16x16x32_bf16 v[52:55], a[208:211], a[40:43], v[52:55]
  ds_read_b64_tr_b16 a[198:199], v239 offset:10240
  v_mfma_f32_16x16x32_bf16 v[56:59], a[208:211], a[44:47], v[56:59]
  s_waitcnt lgkmcnt(8)
  v_mfma_f32_16x16x32_bf16 v[60:63], a[212:215], a[36:39], v[60:63]
  ds_read_b64_tr_b16 a[200:201], v228 offset:2304
  v_mfma_f32_16x16x32_bf16 v[64:67], a[212:215], a[40:43], v[64:67]
  buffer_load_dwordx4 v232, s[16:19], s29 offen offset:2048 lds
  v_mfma_f32_16x16x32_bf16 v[68:71], a[212:215], a[44:47], v[68:71]
  s_waitcnt lgkmcnt(7)
  ds_read_b64_tr_b16 a[202:203], v228 offset:10496
  v_mfma_f32_16x16x32_bf16 v[72:75], a[216:219], a[36:39], v[72:75]
  s_add_u32 s29, s29, s30
  ds_read_b64_tr_b16 a[204:205], v239 offset:2304
  v_mfma_f32_16x16x32_bf16 v[76:79], a[216:219], a[40:43], v[76:79]
  ds_read_b64_tr_b16 a[206:207], v239 offset:10496
  v_mfma_f32_16x16x32_bf16 v[80:83], a[216:219], a[44:47], v[80:83]
  s_waitcnt lgkmcnt(8)
  v_mfma_f32_16x16x32_bf16 v[84:87], a[220:223], a[36:39], v[84:87]
  ds_read_b64_tr_b16 a[208:209], v228 offset:3072
  v_mfma_f32_16x16x32_bf16 v[88:91], a[220:223], a[40:43], v[88:91]
  buffer_load_dwordx4 v232, s[16:19], s29 offen offset:3072 lds
  v_mfma_f32_16x16x32_bf16 v[92:95], a[220:223], a[44:47], v[92:95]
  s_waitcnt lgkmcnt(7)
  ds_read_b64_tr_b16 a[210:211], v228 offset:11264
  v_mfma_f32_16x16x32_bf16 v[96:99], a[192:195], a[36:39], v[96:99]
  s_add_u32 m0, s28, 131072
  ds_read_b64_tr_b16 a[212:213], v239 offset:3072
  v_mfma_f32_16x16x32_bf16 v[100:103], a[192:195], a[40:43], v[100:103]
  s_mov_b32 s29, 2886656
  ds_read_b64_tr_b16 a[214:215], v239 offset:11264
  v_mfma_f32_16x16x32_bf16 v[104:107], a[192:195], a[44:47], v[104:107]
  s_waitcnt lgkmcnt(8)
  v_mfma_f32_16x16x32_bf16 v[108:111], a[196:199], a[36:39], v[108:111]
  ds_read_b64_tr_b16 a[216:217], v228 offset:3328
  v_mfma_f32_16x16x32_bf16 v[112:115], a[196:199], a[40:43], v[112:115]
  buffer_load_dwordx4 v232, s[16:19], s29 offen offset:0 lds
  v_mfma_f32_16x16x32_bf16 v[116:119], a[196:199], a[44:47], v[116:119]
  s_waitcnt lgkmcnt(7)
  ds_read_b64_tr_b16 a[218:219], v228 offset:11520
  v_mfma_f32_16x16x32_bf16 v[120:123], a[200:203], a[36:39], v[120:123]
  s_add_u32 s29, s29, s30
  ds_read_b64_tr_b16 a[220:221], v239 offset:3328
  v_mfma_f32_16x16x32_bf16 v[124:127], a[200:203], a[40:43], v[124:127]
  ds_read_b64_tr_b16 a[222:223], v239 offset:11520
  v_add_u32 v228, 147456, v230
  v_mfma_f32_16x16x32_bf16 v[128:131], a[200:203], a[44:47], v[128:131]
  s_waitcnt lgkmcnt(8)
  v_xor_b32 v239, 32, v228
  v_mfma_f32_16x16x32_bf16 v[132:135], a[204:207], a[36:39], v[132:135]
  ds_read_b64_tr_b16 a[192:193], v228 offset:0
  v_mfma_f32_16x16x32_bf16 v[136:139], a[204:207], a[40:43], v[136:139]
  buffer_load_dwordx4 v232, s[16:19], s29 offen offset:1024 lds
  v_mfma_f32_16x16x32_bf16 v[140:143], a[204:207], a[44:47], v[140:143]
  s_waitcnt lgkmcnt(7)
  ds_read_b64_tr_b16 a[194:195], v228 offset:8192
  v_mfma_f32_16x16x32_bf16 v[144:147], a[208:211], a[36:39], v[144:147]
  s_add_u32 s29, s29, s30
  ds_read_b64_tr_b16 a[196:197], v239 offset:0
  v_mfma_f32_16x16x32_bf16 v[148:151], a[208:211], a[40:43], v[148:151]
  ds_read_b64_tr_b16 a[198:199], v239 offset:8192
  v_mfma_f32_16x16x32_bf16 v[152:155], a[208:211], a[44:47], v[152:155]
  s_waitcnt lgkmcnt(8)
  v_mfma_f32_16x16x32_bf16 v[156:159], a[212:215], a[36:39], v[156:159]
  ds_read_b64_tr_b16 a[200:201], v228 offset:256
  v_mfma_f32_16x16x32_bf16 v[160:163], a[212:215], a[40:43], v[160:163]
  buffer_load_dwordx4 v232, s[16:19], s29 offen offset:2048 lds
  v_mfma_f32_16x16x32_bf16 v[164:167], a[212:215], a[44:47], v[164:167]
  s_waitcnt lgkmcnt(7)
  ds_read_b64_tr_b16 a[202:203], v228 offset:8448
  v_mfma_f32_16x16x32_bf16 a[224:227], a[216:219], a[36:39], a[224:227]
  s_add_u32 s29, s29, s30
  ds_read_b64_tr_b16 a[204:205], v239 offset:256
  v_mfma_f32_16x16x32_bf16 a[228:231], a[216:219], a[40:43], a[228:231]
  ds_read_b64_tr_b16 a[206:207], v239 offset:8448
  v_mfma_f32_16x16x32_bf16 a[232:235], a[216:219], a[44:47], a[232:235]
  s_waitcnt lgkmcnt(8)
  v_mfma_f32_16x16x32_bf16 a[236:239], a[220:223], a[36:39], a[236:239]
  ds_read_b64_tr_b16 a[208:209], v228 offset:1024
  v_mfma_f32_16x16x32_bf16 a[240:243], a[220:223], a[40:43], a[240:243]
  buffer_load_dwordx4 v232, s[16:19], s29 offen offset:3072 lds
  v_mfma_f32_16x16x32_bf16 a[244:247], a[220:223], a[44:47], a[244:247]
  s_waitcnt lgkmcnt(7)
  ds_read_b64_tr_b16 a[210:211], v228 offset:9216
  v_mfma_f32_16x16x32_bf16 v[0:3], a[192:195], a[48:51], v[0:3]
  s_waitcnt vmcnt(8)
  ds_read_b64_tr_b16 a[212:213], v239 offset:1024
  v_mfma_f32_16x16x32_bf16 v[4:7], a[192:195], a[52:55], v[4:7]
  s_barrier
  ds_read_b64_tr_b16 a[214:215], v239 offset:9216
  v_add_u32 v238, 0, v237
  v_mfma_f32_16x16x32_bf16 v[8:11], a[192:195], a[56:59], v[8:11]
  s_waitcnt lgkmcnt(8)
  ds_read_b128 a[76:79], v238 offset:0
  v_mfma_f32_16x16x32_bf16 v[12:15], a[196:199], a[48:51], v[12:15]
  s_add_u32 m0, s28, 98304
  ds_read_b128 a[88:91], v238 offset:256
  v_mfma_f32_16x16x32_bf16 v[16:19], a[196:199], a[52:55], v[16:19]
  s_mov_b32 s29, 3840
  ds_read_b128 a[80:83], v238 offset:2048
  v_mfma_f32_16x16x32_bf16 v[20:23], a[196:199], a[56:59], v[20:23]
  s_waitcnt lgkmcnt(9)
  ds_read_b128 a[92:95], v238 offset:2304
  v_mfma_f32_16x16x32_bf16 v[24:27], a[200:203], a[48:51], v[24:27]
  ds_read_b64_tr_b16 a[216:217], v228 offset:1280
  v_mfma_f32_16x16x32_bf16 v[28:31], a[200:203], a[52:55], v[28:31]
  buffer_load_dwordx4 v233, s[4:7], s29 offen offset:0 lds
  v_mfma_f32_16x16x32_bf16 v[32:35], a[200:203], a[56:59], v[32:35]
  s_waitcnt lgkmcnt(9)
  ds_read_b64_tr_b16 a[218:219], v228 offset:9472
  v_mfma_f32_16x16x32_bf16 v[36:39], a[204:207], a[48:51], v[36:39]
  s_mov_b32 s29, 9984
  ds_read_b64_tr_b16 a[220:221], v239 offset:1280
  v_mfma_f32_16x16x32_bf16 v[40:43], a[204:207], a[52:55], v[40:43]
  ds_read_b64_tr_b16 a[222:223], v239 offset:9472
  v_mfma_f32_16x16x32_bf16 v[44:47], a[204:207], a[56:59], v[44:47]
  s_waitcnt lgkmcnt(10)
  ds_read_b64_tr_b16 a[192:193], v228 offset:2048
  v_mfma_f32_16x16x32_bf16 v[48:51], a[208:211], a[48:51], v[48:51]
  ds_read_b64_tr_b16 a[194:195], v228 offset:10240
  v_mfma_f32_16x16x32_bf16 v[52:55], a[208:211], a[52:55], v[52:55]
  buffer_load_dwordx4 v233, s[4:7], s29 offen offset:1024 lds
  v_mfma_f32_16x16x32_bf16 v[56:59], a[208:211], a[56:59], v[56:59]
  s_waitcnt lgkmcnt(10)
  ds_read_b64_tr_b16 a[196:197], v239 offset:2048
  v_mfma_f32_16x16x32_bf16 v[60:63], a[212:215], a[48:51], v[60:63]
  s_mov_b32 s29, 16128
  ds_read_b64_tr_b16 a[198:199], v239 offset:10240
  v_mfma_f32_16x16x32_bf16 v[64:67], a[212:215], a[52:55], v[64:67]
  ds_read_b64_tr_b16 a[200:201], v228 offset:2304
  v_mfma_f32_16x16x32_bf16 v[68:71], a[212:215], a[56:59], v[68:71]
  s_waitcnt lgkmcnt(7)
  ds_read_b64_tr_b16 a[202:203], v228 offset:10496
  v_mfma_f32_16x16x32_bf16 v[72:75], a[216:219], a[48:51], v[72:75]
  ds_read_b64_tr_b16 a[204:205], v239 offset:2304
  v_mfma_f32_16x16x32_bf16 v[76:79], a[216:219], a[52:55], v[76:79]
  ds_read_b64_tr_b16 a[206:207], v239 offset:10496
  v_mfma_f32_16x16x32_bf16 v[80:83], a[216:219], a[56:59], v[80:83]
  s_waitcnt lgkmcnt(8)
  v_mfma_f32_16x16x32_bf16 v[84:87], a[220:223], a[48:51], v[84:87]
  ds_read_b64_tr_b16 a[208:209], v228 offset:3072
  v_mfma_f32_16x16x32_bf16 v[88:91], a[220:223], a[52:55], v[88:91]
  buffer_load_dwordx4 v233, s[4:7], s29 offen offset:2048 lds
  v_mfma_f32_16x16x32_bf16 v[92:95], a[220:223], a[56:59], v[92:95]
  s_waitcnt lgkmcnt(7)
  ds_read_b64_tr_b16 a[210:211], v228 offset:11264
  v_mfma_f32_16x16x32_bf16 v[96:99], a[192:195], a[48:51], v[96:99]
  s_mov_b32 s29, 22272
  ds_read_b64_tr_b16 a[212:213], v239 offset:3072
  v_mfma_f32_16x16x32_bf16 v[100:103], a[192:195], a[52:55], v[100:103]
  ds_read_b64_tr_b16 a[214:215], v239 offset:11264
  v_mfma_f32_16x16x32_bf16 v[104:107], a[192:195], a[56:59], v[104:107]
  s_waitcnt lgkmcnt(8)
  v_mfma_f32_16x16x32_bf16 v[108:111], a[196:199], a[48:51], v[108:111]
  ds_read_b64_tr_b16 a[216:217], v228 offset:3328
  v_mfma_f32_16x16x32_bf16 v[112:115], a[196:199], a[52:55], v[112:115]
  buffer_load_dwordx4 v233, s[4:7], s29 offen offset:3072 lds
  v_mfma_f32_16x16x32_bf16 v[116:119], a[196:199], a[56:59], v[116:119]
  s_waitcnt lgkmcnt(7)
  ds_read_b64_tr_b16 a[218:219], v228 offset:11520
  v_mfma_f32_16x16x32_bf16 v[120:123], a[200:203], a[48:51], v[120:123]
  s_add_u32 m0, s28, 81920
  ds_read_b64_tr_b16 a[220:221], v239 offset:3328
  v_mfma_f32_16x16x32_bf16 v[124:127], a[200:203], a[52:55], v[124:127]
  s_mov_b32 s29, 32512
  ds_read_b64_tr_b16 a[222:223], v239 offset:11520
  v_add_u32 v228, 32768, v230
  v_mfma_f32_16x16x32_bf16 v[128:131], a[200:203], a[56:59], v[128:131]
  s_waitcnt lgkmcnt(8)
  v_xor_b32 v239, 32, v228
  v_mfma_f32_16x16x32_bf16 v[132:135], a[204:207], a[48:51], v[132:135]
  ds_read_b64_tr_b16 a[192:193], v228 offset:0
  v_mfma_f32_16x16x32_bf16 v[136:139], a[204:207], a[52:55], v[136:139]
  ds_read_b64_tr_b16 a[194:195], v228 offset:8192
  v_mfma_f32_16x16x32_bf16 v[140:143], a[204:207], a[56:59], v[140:143]
  s_waitcnt lgkmcnt(8)
  v_mfma_f32_16x16x32_bf16 v[144:147], a[208:211], a[48:51], v[144:147]
  ds_read_b64_tr_b16 a[196:197], v239 offset:0
  v_mfma_f32_16x16x32_bf16 v[148:151], a[208:211], a[52:55], v[148:151]
  buffer_load_dwordx4 v233, s[4:7], s29 offen offset:0 lds
  v_mfma_f32_16x16x32_bf16 v[152:155], a[208:211], a[56:59], v[152:155]
  s_waitcnt lgkmcnt(7)
  ds_read_b64_tr_b16 a[198:199], v239 offset:8192
  v_mfma_f32_16x16x32_bf16 v[156:159], a[212:215], a[48:51], v[156:159]
  s_mov_b32 s29, 38656
  ds_read_b64_tr_b16 a[200:201], v228 offset:256
  v_mfma_f32_16x16x32_bf16 v[160:163], a[212:215], a[52:55], v[160:163]
  ds_read_b64_tr_b16 a[202:203], v228 offset:8448
  v_mfma_f32_16x16x32_bf16 v[164:167], a[212:215], a[56:59], v[164:167]
  s_waitcnt lgkmcnt(8)
  v_mfma_f32_16x16x32_bf16 a[224:227], a[216:219], a[48:51], a[224:227]
  ds_read_b64_tr_b16 a[204:205], v239 offset:256
  v_mfma_f32_16x16x32_bf16 a[228:231], a[216:219], a[52:55], a[228:231]
  buffer_load_dwordx4 v233, s[4:7], s29 offen offset:1024 lds
  v_mfma_f32_16x16x32_bf16 a[232:235], a[216:219], a[56:59], a[232:235]
  s_waitcnt lgkmcnt(7)
  ds_read_b64_tr_b16 a[206:207], v239 offset:8448
  v_mfma_f32_16x16x32_bf16 a[236:239], a[220:223], a[48:51], a[236:239]
  ds_read_b64_tr_b16 a[208:209], v228 offset:1024
  v_mfma_f32_16x16x32_bf16 a[240:243], a[220:223], a[52:55], a[240:243]
  ds_read_b64_tr_b16 a[210:211], v228 offset:9216
  v_mfma_f32_16x16x32_bf16 a[244:247], a[220:223], a[56:59], a[244:247]
  s_waitcnt lgkmcnt(8)
  v_mfma_f32_16x16x32_bf16 v[0:3], a[192:195], a[60:63], v[0:3]
  s_waitcnt vmcnt(10)
  ds_read_b64_tr_b16 a[212:213], v239 offset:1024
  v_mfma_f32_16x16x32_bf16 v[4:7], a[192:195], a[64:67], v[4:7]
  s_barrier
  ds_read_b64_tr_b16 a[214:215], v239 offset:9216
  v_mfma_f32_16x16x32_bf16 v[8:11], a[192:195], a[68:71], v[8:11]
  s_waitcnt lgkmcnt(8)
  v_mfma_f32_16x16x32_bf16 v[12:15], a[196:199], a[60:63], v[12:15]
  s_add_u32 m0, s28, 147456
  ds_read_b64_tr_b16 a[216:217], v228 offset:1280
  v_mfma_f32_16x16x32_bf16 v[16:19], a[196:199], a[64:67], v[16:19]
  s_mov_b32 s29, 3148800
  buffer_load_dwordx4 v232, s[16:19], s29 offen offset:0 lds
  v_mfma_f32_16x16x32_bf16 v[20:23], a[196:199], a[68:71], v[20:23]
  s_waitcnt lgkmcnt(7)
  ds_read_b64_tr_b16 a[218:219], v228 offset:9472
  v_mfma_f32_16x16x32_bf16 v[24:27], a[200:203], a[60:63], v[24:27]
  s_add_u32 s29, s29, s30
  ds_read_b64_tr_b16 a[220:221], v239 offset:1280
  v_mfma_f32_16x16x32_bf16 v[28:31], a[200:203], a[64:67], v[28:31]
  ds_read_b64_tr_b16 a[222:223], v239 offset:9472
  v_mfma_f32_16x16x32_bf16 v[32:35], a[200:203], a[68:71], v[32:35]
  s_waitcnt lgkmcnt(8)
  v_mfma_f32_16x16x32_bf16 v[36:39], a[204:207], a[60:63], v[36:39]
  ds_read_b64_tr_b16 a[192:193], v228 offset:2048
  v_mfma_f32_16x16x32_bf16 v[40:43], a[204:207], a[64:67], v[40:43]
  buffer_load_dwordx4 v232, s[16:19], s29 offen offset:1024 lds
  v_mfma_f32_16x16x32_bf16 v[44:47], a[204:207], a[68:71], v[44:47]
  s_waitcnt lgkmcnt(7)
  ds_read_b64_tr_b16 a[194:195], v228 offset:10240
  v_mfma_f32_16x16x32_bf16 v[48:51], a[208:211], a[60:63], v[48:51]
  s_add_u32 s29, s29, s30
  ds_read_b64_tr_b16 a[196:197], v239 offset:2048
  v_mfma_f32_16x16x32_bf16 v[52:55], a[208:211], a[64:67], v[52:55]
  ds_read_b64_tr_b16 a[198:199], v239 offset:10240
  v_mfma_f32_16x16x32_bf16 v[56:59], a[208:211], a[68:71], v[56:59]
  s_waitcnt lgkmcnt(8)
  v_mfma_f32_16x16x32_bf16 v[60:63], a[212:215], a[60:63], v[60:63]
  ds_read_b64_tr_b16 a[200:201], v228 offset:2304
  v_mfma_f32_16x16x32_bf16 v[64:67], a[212:215], a[64:67], v[64:67]
  buffer_load_dwordx4 v232, s[16:19], s29 offen offset:2048 lds
  v_mfma_f32_16x16x32_bf16 v[68:71], a[212:215], a[68:71], v[68:71]
  s_waitcnt lgkmcnt(7)
  ds_read_b64_tr_b16 a[202:203], v228 offset:10496
  v_mfma_f32_16x16x32_bf16 v[72:75], a[216:219], a[60:63], v[72:75]
  s_add_u32 s29, s29, s30
  ds_read_b64_tr_b16 a[204:205], v239 offset:2304
  v_mfma_f32_16x16x32_bf16 v[76:79], a[216:219], a[64:67], v[76:79]
  ds_read_b64_tr_b16 a[206:207], v239 offset:10496
  v_mfma_f32_16x16x32_bf16 v[80:83], a[216:219], a[68:71], v[80:83]
  s_waitcnt lgkmcnt(8)
  v_mfma_f32_16x16x32_bf16 v[84:87], a[220:223], a[60:63], v[84:87]
  ds_read_b64_tr_b16 a[208:209], v228 offset:3072
  v_mfma_f32_16x16x32_bf16 v[88:91], a[220:223], a[64:67], v[88:91]
  buffer_load_dwordx4 v232, s[16:19], s29 offen offset:3072 lds
  v_mfma_f32_16x16x32_bf16 v[92:95], a[220:223], a[68:71], v[92:95]
  s_waitcnt lgkmcnt(7)
  ds_read_b64_tr_b16 a[210:211], v228 offset:11264
  v_mfma_f32_16x16x32_bf16 v[96:99], a[192:195], a[60:63], v[96:99]
  s_add_u32 m0, s28, 0
  ds_read_b64_tr_b16 a[212:213], v239 offset:3072
  v_mfma_f32_16x16x32_bf16 v[100:103], a[192:195], a[64:67], v[100:103]
  s_mov_b32 s29, 3410944
  ds_read_b64_tr_b16 a[214:215], v239 offset:11264
  v_mfma_f32_16x16x32_bf16 v[104:107], a[192:195], a[68:71], v[104:107]
  s_waitcnt lgkmcnt(8)
  v_mfma_f32_16x16x32_bf16 v[108:111], a[196:199], a[60:63], v[108:111]
  ds_read_b64_tr_b16 a[216:217], v228 offset:3328
  v_mfma_f32_16x16x32_bf16 v[112:115], a[196:199], a[64:67], v[112:115]
  buffer_load_dwordx4 v232, s[16:19], s29 offen offset:0 lds
  v_mfma_f32_16x16x32_bf16 v[116:119], a[196:199], a[68:71], v[116:119]
  s_waitcnt lgkmcnt(7)
  ds_read_b64_tr_b16 a[218:219], v228 offset:11520
  v_mfma_f32_16x16x32_bf16 v[120:123], a[200:203], a[60:63], v[120:123]
  s_add_u32 s29, s29, s30
  ds_read_b64_tr_b16 a[220:221], v239 offset:3328
  v_mfma_f32_16x16x32_bf16 v[124:127], a[200:203], a[64:67], v[124:127]
  ds_read_b64_tr_b16 a[222:223], v239 offset:11520
  v_add_u32 v228, 49152, v230
  v_mfma_f32_16x16x32_bf16 v[128:131], a[200:203], a[68:71], v[128:131]
  s_waitcnt lgkmcnt(8)
  v_xor_b32 v239, 32, v228
  v_mfma_f32_16x16x32_bf16 v[132:135], a[204:207], a[60:63], v[132:135]
  ds_read_b64_tr_b16 a[192:193], v228 offset:0
  v_mfma_f32_16x16x32_bf16 v[136:139], a[204:207], a[64:67], v[136:139]
  buffer_load_dwordx4 v232, s[16:19], s29 offen offset:1024 lds
  v_mfma_f32_16x16x32_bf16 v[140:143], a[204:207], a[68:71], v[140:143]
  s_waitcnt lgkmcnt(7)
  ds_read_b64_tr_b16 a[194:195], v228 offset:8192
  v_mfma_f32_16x16x32_bf16 v[144:147], a[208:211], a[60:63], v[144:147]
  s_add_u32 s29, s29, s30
  ds_read_b64_tr_b16 a[196:197], v239 offset:0
  v_mfma_f32_16x16x32_bf16 v[148:151], a[208:211], a[64:67], v[148:151]
  ds_read_b64_tr_b16 a[198:199], v239 offset:8192
  v_mfma_f32_16x16x32_bf16 v[152:155], a[208:211], a[68:71], v[152:155]
  s_waitcnt lgkmcnt(8)
  v_mfma_f32_16x16x32_bf16 v[156:159], a[212:215], a[60:63], v[156:159]
  ds_read_b64_tr_b16 a[200:201], v228 offset:256
  v_mfma_f32_16x16x32_bf16 v[160:163], a[212:215], a[64:67], v[160:163]
  buffer_load_dwordx4 v232, s[16:19], s29 offen offset:2048 lds
  v_mfma_f32_16x16x32_bf16 v[164:167], a[212:215], a[68:71], v[164:167]
  s_waitcnt lgkmcnt(7)
  ds_read_b64_tr_b16 a[202:203], v228 offset:8448
  v_mfma_f32_16x16x32_bf16 a[224:227], a[216:219], a[60:63], a[224:227]
  s_add_u32 s29, s29, s30
  ds_read_b64_tr_b16 a[204:205], v239 offset:256
  v_mfma_f32_16x16x32_bf16 a[228:231], a[216:219], a[64:67], a[228:231]
  ds_read_b64_tr_b16 a[206:207], v239 offset:8448
  v_mfma_f32_16x16x32_bf16 a[232:235], a[216:219], a[68:71], a[232:235]
  s_waitcnt lgkmcnt(8)
  v_mfma_f32_16x16x32_bf16 a[236:239], a[220:223], a[60:63], a[236:239]
  ds_read_b64_tr_b16 a[208:209], v228 offset:1024
  v_mfma_f32_16x16x32_bf16 a[240:243], a[220:223], a[64:67], a[240:243]
  buffer_load_dwordx4 v232, s[16:19], s29 offen offset:3072 lds
  v_mfma_f32_16x16x32_bf16 a[244:247], a[220:223], a[68:71], a[244:247]
  s_waitcnt lgkmcnt(7)
  ds_read_b64_tr_b16 a[210:211], v228 offset:9216
  v_mfma_f32_16x16x32_bf16 v[0:3], a[192:195], a[72:75], v[0:3]
  s_waitcnt vmcnt(8)
  ds_read_b64_tr_b16 a[212:213], v239 offset:1024
  v_mfma_f32_16x16x32_bf16 v[4:7], a[192:195], a[76:79], v[4:7]
  s_barrier
  ds_read_b64_tr_b16 a[214:215], v239 offset:9216
  v_add_u32 v238, 98304, v237
  v_mfma_f32_16x16x32_bf16 v[8:11], a[192:195], a[80:83], v[8:11]
  s_waitcnt lgkmcnt(8)
  ds_read_b128 v[168:171], v238 offset:0
  v_mfma_f32_16x16x32_bf16 v[12:15], a[196:199], a[72:75], v[12:15]
  s_add_u32 m0, s28, 32768
  ds_read_b128 v[180:183], v238 offset:256
  v_mfma_f32_16x16x32_bf16 v[16:19], a[196:199], a[76:79], v[16:19]
  s_mov_b32 s29, 35840
  ds_read_b128 v[172:175], v238 offset:2048
  v_mfma_f32_16x16x32_bf16 v[20:23], a[196:199], a[80:83], v[20:23]
  s_waitcnt lgkmcnt(9)
  ds_read_b128 v[184:187], v238 offset:2304
  v_add_u32 v238, 81920, v237
  v_mfma_f32_16x16x32_bf16 v[24:27], a[200:203], a[72:75], v[24:27]
  ds_read_b128 v[176:179], v238 offset:0
  v_mfma_f32_16x16x32_bf16 v[28:31], a[200:203], a[76:79], v[28:31]
  buffer_load_dwordx4 v231, s[8:11], s29 offen offset:0 nt lds
  v_mfma_f32_16x16x32_bf16 v[32:35], a[200:203], a[80:83], v[32:35]
  s_waitcnt lgkmcnt(9)
  ds_read_b64_tr_b16 a[216:217], v228 offset:1280
  v_mfma_f32_16x16x32_bf16 v[36:39], a[204:207], a[72:75], v[36:39]
  s_add_u32 s29, s29, s30
  ds_read_b64_tr_b16 a[218:219], v228 offset:9472
  v_mfma_f32_16x16x32_bf16 v[40:43], a[204:207], a[76:79], v[40:43]
  ds_read_b64_tr_b16 a[220:221], v239 offset:1280
  v_mfma_f32_16x16x32_bf16 v[44:47], a[204:207], a[80:83], v[44:47]
  s_waitcnt lgkmcnt(10)
  ds_read_b64_tr_b16 a[222:223], v239 offset:9472
  v_mfma_f32_16x16x32_bf16 v[48:51], a[208:211], a[72:75], v[48:51]
  ds_read_b128 v[188:191], v238 offset:256
  v_mfma_f32_16x16x32_bf16 v[52:55], a[208:211], a[76:79], v[52:55]
  ds_read_b64_tr_b16 a[192:193], v228 offset:2048
  v_mfma_f32_16x16x32_bf16 v[56:59], a[208:211], a[80:83], v[56:59]
  s_waitcnt lgkmcnt(11)
  ds_read_b64_tr_b16 a[194:195], v228 offset:10240
  v_mfma_f32_16x16x32_bf16 v[60:63], a[212:215], a[72:75], v[60:63]
  ds_read_b64_tr_b16 a[196:197], v239 offset:2048
  v_mfma_f32_16x16x32_bf16 v[64:67], a[212:215], a[76:79], v[64:67]
  ds_read_b64_tr_b16 a[198:199], v239 offset:10240
  v_mfma_f32_16x16x32_bf16 v[68:71], a[212:215], a[80:83], v[68:71]
  s_waitcnt lgkmcnt(7)
  ds_read_b64_tr_b16 a[200:201], v228 offset:2304
  v_mfma_f32_16x16x32_bf16 v[72:75], a[216:219], a[72:75], v[72:75]
  ds_read_b64_tr_b16 a[202:203], v228 offset:10496
  v_mfma_f32_16x16x32_bf16 v[76:79], a[216:219], a[76:79], v[76:79]
  buffer_load_dwordx4 v231, s[8:11], s29 offen offset:1024 nt lds
  v_mfma_f32_16x16x32_bf16 v[80:83], a[216:219], a[80:83], v[80:83]
  s_waitcnt lgkmcnt(7)
  ds_read_b64_tr_b16 a[204:205], v239 offset:2304
  v_mfma_f32_16x16x32_bf16 v[84:87], a[220:223], a[72:75], v[84:87]
  s_add_u32 s29, s29, s30
  ds_read_b64_tr_b16 a[206:207], v239 offset:10496
  v_mfma_f32_16x16x32_bf16 v[88:91], a[220:223], a[76:79], v[88:91]
  ds_read_b64_tr_b16 a[208:209], v228 offset:3072
  v_mfma_f32_16x16x32_bf16 v[92:95], a[220:223], a[80:83], v[92:95]
  s_waitcnt lgkmcnt(7)
  ds_read_b64_tr_b16 a[210:211], v228 offset:11264
  v_mfma_f32_16x16x32_bf16 v[96:99], a[192:195], a[72:75], v[96:99]
  ds_read_b64_tr_b16 a[212:213], v239 offset:3072
  v_mfma_f32_16x16x32_bf16 v[100:103], a[192:195], a[76:79], v[100:103]
  ds_read_b64_tr_b16 a[214:215], v239 offset:11264
  v_mfma_f32_16x16x32_bf16 v[104:107], a[192:195], a[80:83], v[104:107]
  s_waitcnt lgkmcnt(8)
  v_mfma_f32_16x16x32_bf16 v[108:111], a[196:199], a[72:75], v[108:111]
  ds_read_b64_tr_b16 a[216:217], v228 offset:3328
  v_mfma_f32_16x16x32_bf16 v[112:115], a[196:199], a[76:79], v[112:115]
  ds_read_b64_tr_b16 a[218:219], v228 offset:11520
  v_mfma_f32_16x16x32_bf16 v[116:119], a[196:199], a[80:83], v[116:119]
  s_waitcnt lgkmcnt(8)
  v_mfma_f32_16x16x32_bf16 v[120:123], a[200:203], a[72:75], v[120:123]
  ds_read_b64_tr_b16 a[220:221], v239 offset:3328
  v_mfma_f32_16x16x32_bf16 v[124:127], a[200:203], a[76:79], v[124:127]
  buffer_load_dwordx4 v231, s[8:11], s29 offen offset:2048 nt lds
  v_mfma_f32_16x16x32_bf16 v[128:131], a[200:203], a[80:83], v[128:131]
  s_waitcnt lgkmcnt(7)
  ds_read_b64_tr_b16 a[222:223], v239 offset:11520
  v_add_u32 v228, 131072, v230
  v_mfma_f32_16x16x32_bf16 v[132:135], a[204:207], a[72:75], v[132:135]
  s_add_u32 s29, s29, s30
  ds_read_b64_tr_b16 a[192:193], v228 offset:0
  v_xor_b32 v239, 32, v228
  v_mfma_f32_16x16x32_bf16 v[136:139], a[204:207], a[76:79], v[136:139]
  ds_read_b64_tr_b16 a[194:195], v228 offset:8192
  v_mfma_f32_16x16x32_bf16 v[140:143], a[204:207], a[80:83], v[140:143]
  s_waitcnt lgkmcnt(8)
  v_mfma_f32_16x16x32_bf16 v[144:147], a[208:211], a[72:75], v[144:147]
  ds_read_b64_tr_b16 a[196:197], v239 offset:0
  v_mfma_f32_16x16x32_bf16 v[148:151], a[208:211], a[76:79], v[148:151]
  ds_read_b64_tr_b16 a[198:199], v239 offset:8192
  v_mfma_f32_16x16x32_bf16 v[152:155], a[208:211], a[80:83], v[152:155]
  s_waitcnt lgkmcnt(8)
  v_mfma_f32_16x16x32_bf16 v[156:159], a[212:215], a[72:75], v[156:159]
  ds_read_b64_tr_b16 a[200:201], v228 offset:256
  v_mfma_f32_16x16x32_bf16 v[160:163], a[212:215], a[76:79], v[160:163]
  ds_read_b64_tr_b16 a[202:203], v228 offset:8448
  v_mfma_f32_16x16x32_bf16 v[164:167], a[212:215], a[80:83], v[164:167]
  s_waitcnt lgkmcnt(8)
  v_mfma_f32_16x16x32_bf16 a[224:227], a[216:219], a[72:75], a[224:227]
  ds_read_b64_tr_b16 a[204:205], v239 offset:256
  v_mfma_f32_16x16x32_bf16 a[228:231], a[216:219], a[76:79], a[228:231]
  buffer_load_dwordx4 v231, s[8:11], s29 offen offset:3072 nt lds
  v_mfma_f32_16x16x32_bf16 a[232:235], a[216:219], a[80:83], a[232:235]
  s_waitcnt lgkmcnt(7)
  ds_read_b64_tr_b16 a[206:207], v239 offset:8448
  v_mfma_f32_16x16x32_bf16 a[236:239], a[220:223], a[72:75], a[236:239]
  ds_read_b64_tr_b16 a[208:209], v228 offset:1024
  v_mfma_f32_16x16x32_bf16 a[240:243], a[220:223], a[76:79], a[240:243]
  ds_read_b64_tr_b16 a[210:211], v228 offset:9216
  v_mfma_f32_16x16x32_bf16 a[244:247], a[220:223], a[80:83], a[244:247]
  s_waitcnt lgkmcnt(8)
  v_mfma_f32_16x16x32_bf16 v[0:3], a[192:195], a[84:87], v[0:3]
  s_waitcnt vmcnt(8)
  ds_read_b64_tr_b16 a[212:213], v239 offset:1024
  v_mfma_f32_16x16x32_bf16 v[4:7], a[192:195], a[88:91], v[4:7]
  s_barrier
  ds_read_b64_tr_b16 a[214:215], v239 offset:9216
  v_mfma_f32_16x16x32_bf16 v[8:11], a[192:195], a[92:95], v[8:11]
  s_waitcnt lgkmcnt(8)
  v_mfma_f32_16x16x32_bf16 v[12:15], a[196:199], a[84:87], v[12:15]
  s_add_u32 m0, s28, 49152
  ds_read_b64_tr_b16 a[216:217], v228 offset:1280
  v_mfma_f32_16x16x32_bf16 v[16:19], a[196:199], a[88:91], v[16:19]
  s_mov_b32 s29, 19456
  buffer_load_dwordx4 v231, s[12:15], s29 offen offset:0 nt lds
  v_mfma_f32_16x16x32_bf16 v[20:23], a[196:199], a[92:95], v[20:23]
  s_waitcnt lgkmcnt(7)
  ds_read_b64_tr_b16 a[218:219], v228 offset:9472
  v_mfma_f32_16x16x32_bf16 v[24:27], a[200:203], a[84:87], v[24:27]
  s_add_u32 s29, s29, s30
  ds_read_b64_tr_b16 a[220:221], v239 offset:1280
  v_mfma_f32_16x16x32_bf16 v[28:31], a[200:203], a[88:91], v[28:31]
  ds_read_b64_tr_b16 a[222:223], v239 offset:9472
  v_mfma_f32_16x16x32_bf16 v[32:35], a[200:203], a[92:95], v[32:35]
  s_waitcnt lgkmcnt(8)
  v_mfma_f32_16x16x32_bf16 v[36:39], a[204:207], a[84:87], v[36:39]
  ds_read_b64_tr_b16 a[192:193], v228 offset:2048
  v_mfma_f32_16x16x32_bf16 v[40:43], a[204:207], a[88:91], v[40:43]
  buffer_load_dwordx4 v231, s[12:15], s29 offen offset:1024 nt lds
  v_mfma_f32_16x16x32_bf16 v[44:47], a[204:207], a[92:95], v[44:47]
  s_waitcnt lgkmcnt(7)
  ds_read_b64_tr_b16 a[194:195], v228 offset:10240
  v_mfma_f32_16x16x32_bf16 v[48:51], a[208:211], a[84:87], v[48:51]
  s_add_u32 s29, s29, s30
  ds_read_b64_tr_b16 a[196:197], v239 offset:2048
  v_mfma_f32_16x16x32_bf16 v[52:55], a[208:211], a[88:91], v[52:55]
  ds_read_b64_tr_b16 a[198:199], v239 offset:10240
  v_mfma_f32_16x16x32_bf16 v[56:59], a[208:211], a[92:95], v[56:59]
  s_waitcnt lgkmcnt(8)
  v_mfma_f32_16x16x32_bf16 v[60:63], a[212:215], a[84:87], v[60:63]
  ds_read_b64_tr_b16 a[200:201], v228 offset:2304
  v_mfma_f32_16x16x32_bf16 v[64:67], a[212:215], a[88:91], v[64:67]
  buffer_load_dwordx4 v231, s[12:15], s29 offen offset:2048 nt lds
  v_mfma_f32_16x16x32_bf16 v[68:71], a[212:215], a[92:95], v[68:71]
  s_waitcnt lgkmcnt(7)
  ds_read_b64_tr_b16 a[202:203], v228 offset:10496
  v_mfma_f32_16x16x32_bf16 v[72:75], a[216:219], a[84:87], v[72:75]
  s_add_u32 s29, s29, s30
  ds_read_b64_tr_b16 a[204:205], v239 offset:2304
  v_mfma_f32_16x16x32_bf16 v[76:79], a[216:219], a[88:91], v[76:79]
  ds_read_b64_tr_b16 a[206:207], v239 offset:10496
  v_mfma_f32_16x16x32_bf16 v[80:83], a[216:219], a[92:95], v[80:83]
  s_waitcnt lgkmcnt(8)
  v_mfma_f32_16x16x32_bf16 v[84:87], a[220:223], a[84:87], v[84:87]
  ds_read_b64_tr_b16 a[208:209], v228 offset:3072
  v_mfma_f32_16x16x32_bf16 v[88:91], a[220:223], a[88:91], v[88:91]
  buffer_load_dwordx4 v231, s[12:15], s29 offen offset:3072 nt lds
  v_mfma_f32_16x16x32_bf16 v[92:95], a[220:223], a[92:95], v[92:95]
  s_waitcnt lgkmcnt(7)
  ds_read_b64_tr_b16 a[210:211], v228 offset:11264
  v_mfma_f32_16x16x32_bf16 v[96:99], a[192:195], a[84:87], v[96:99]
  s_add_u32 m0, s28, 98304
  ds_read_b64_tr_b16 a[212:213], v239 offset:3072
  v_mfma_f32_16x16x32_bf16 v[100:103], a[192:195], a[88:91], v[100:103]
  s_mov_b32 s29, 3072
  ds_read_b64_tr_b16 a[214:215], v239 offset:11264
  v_mfma_f32_16x16x32_bf16 v[104:107], a[192:195], a[92:95], v[104:107]
  s_waitcnt lgkmcnt(8)
  v_mfma_f32_16x16x32_bf16 v[108:111], a[196:199], a[84:87], v[108:111]
  ds_read_b64_tr_b16 a[216:217], v228 offset:3328
  v_mfma_f32_16x16x32_bf16 v[112:115], a[196:199], a[88:91], v[112:115]
  buffer_load_dwordx4 v233, s[4:7], s29 offen offset:0 lds
  v_mfma_f32_16x16x32_bf16 v[116:119], a[196:199], a[92:95], v[116:119]
  s_waitcnt lgkmcnt(7)
  ds_read_b64_tr_b16 a[218:219], v228 offset:11520
  v_mfma_f32_16x16x32_bf16 v[120:123], a[200:203], a[84:87], v[120:123]
  s_mov_b32 s29, 9216
  ds_read_b64_tr_b16 a[220:221], v239 offset:3328
  v_mfma_f32_16x16x32_bf16 v[124:127], a[200:203], a[88:91], v[124:127]
  ds_read_b64_tr_b16 a[222:223], v239 offset:11520
  v_add_u32 v228, 147456, v230
  v_mfma_f32_16x16x32_bf16 v[128:131], a[200:203], a[92:95], v[128:131]
  s_waitcnt lgkmcnt(8)
  v_xor_b32 v239, 32, v228
  v_mfma_f32_16x16x32_bf16 v[132:135], a[204:207], a[84:87], v[132:135]
  ds_read_b64_tr_b16 a[192:193], v228 offset:0
  v_mfma_f32_16x16x32_bf16 v[136:139], a[204:207], a[88:91], v[136:139]
  buffer_load_dwordx4 v233, s[4:7], s29 offen offset:1024 lds
  v_mfma_f32_16x16x32_bf16 v[140:143], a[204:207], a[92:95], v[140:143]
  s_waitcnt lgkmcnt(7)
  ds_read_b64_tr_b16 a[194:195], v228 offset:8192
  v_mfma_f32_16x16x32_bf16 v[144:147], a[208:211], a[84:87], v[144:147]
  s_mov_b32 s29, 15360
  ds_read_b64_tr_b16 a[196:197], v239 offset:0
  v_mfma_f32_16x16x32_bf16 v[148:151], a[208:211], a[88:91], v[148:151]
  ds_read_b64_tr_b16 a[198:199], v239 offset:8192
  v_mfma_f32_16x16x32_bf16 v[152:155], a[208:211], a[92:95], v[152:155]
  s_waitcnt lgkmcnt(8)
  v_mfma_f32_16x16x32_bf16 v[156:159], a[212:215], a[84:87], v[156:159]
  ds_read_b64_tr_b16 a[200:201], v228 offset:256
  v_mfma_f32_16x16x32_bf16 v[160:163], a[212:215], a[88:91], v[160:163]
  buffer_load_dwordx4 v233, s[4:7], s29 offen offset:2048 lds
  v_mfma_f32_16x16x32_bf16 v[164:167], a[212:215], a[92:95], v[164:167]
  s_waitcnt lgkmcnt(7)
  ds_read_b64_tr_b16 a[202:203], v228 offset:8448
  v_mfma_f32_16x16x32_bf16 a[224:227], a[216:219], a[84:87], a[224:227]
  s_mov_b32 s29, 21504
  ds_read_b64_tr_b16 a[204:205], v239 offset:256
  v_mfma_f32_16x16x32_bf16 a[228:231], a[216:219], a[88:91], a[228:231]
  ds_read_b64_tr_b16 a[206:207], v239 offset:8448
  v_mfma_f32_16x16x32_bf16 a[232:235], a[216:219], a[92:95], a[232:235]
  s_waitcnt lgkmcnt(8)
  v_mfma_f32_16x16x32_bf16 a[236:239], a[220:223], a[84:87], a[236:239]
  ds_read_b64_tr_b16 a[208:209], v228 offset:1024
  v_mfma_f32_16x16x32_bf16 a[240:243], a[220:223], a[88:91], a[240:243]
  buffer_load_dwordx4 v233, s[4:7], s29 offen offset:3072 lds
  v_mfma_f32_16x16x32_bf16 a[244:247], a[220:223], a[92:95], a[244:247]
  s_waitcnt lgkmcnt(7)
  ds_read_b64_tr_b16 a[210:211], v228 offset:9216
  v_mfma_f32_16x16x32_bf16 v[0:3], a[192:195], v[168:171], v[0:3]
  s_waitcnt vmcnt(12)
  ds_read_b64_tr_b16 a[212:213], v239 offset:1024
  v_mfma_f32_16x16x32_bf16 v[4:7], a[192:195], v[172:175], v[4:7]
  s_barrier
  ds_read_b64_tr_b16 a[214:215], v239 offset:9216
  v_mfma_f32_16x16x32_bf16 v[8:11], a[192:195], v[176:179], v[8:11]
  s_waitcnt lgkmcnt(8)
  v_mfma_f32_16x16x32_bf16 v[12:15], a[196:199], v[168:171], v[12:15]
  s_add_u32 m0, s28, 81920
  ds_read_b64_tr_b16 a[216:217], v228 offset:1280
  v_mfma_f32_16x16x32_bf16 v[16:19], a[196:199], v[172:175], v[16:19]
  s_mov_b32 s29, 52224
  ds_read_b64_tr_b16 a[218:219], v228 offset:9472
  v_mfma_f32_16x16x32_bf16 v[20:23], a[196:199], v[176:179], v[20:23]
  s_waitcnt lgkmcnt(8)
  v_mfma_f32_16x16x32_bf16 v[24:27], a[200:203], v[168:171], v[24:27]
  ds_read_b64_tr_b16 a[220:221], v239 offset:1280
  v_mfma_f32_16x16x32_bf16 v[28:31], a[200:203], v[172:175], v[28:31]
  buffer_load_dwordx4 v231, s[8:11], s29 offen offset:0 nt lds
  v_mfma_f32_16x16x32_bf16 v[32:35], a[200:203], v[176:179], v[32:35]
  s_waitcnt lgkmcnt(7)
  ds_read_b64_tr_b16 a[222:223], v239 offset:9472
  v_mfma_f32_16x16x32_bf16 v[36:39], a[204:207], v[168:171], v[36:39]
  s_add_u32 s29, s29, s30
  ds_read_b64_tr_b16 a[192:193], v228 offset:2048
  v_mfma_f32_16x16x32_bf16 v[40:43], a[204:207], v[172:175], v[40:43]
  ds_read_b64_tr_b16 a[194:195], v228 offset:10240
  v_mfma_f32_16x16x32_bf16 v[44:47], a[204:207], v[176:179], v[44:47]
  s_waitcnt lgkmcnt(8)
  v_mfma_f32_16x16x32_bf16 v[48:51], a[208:211], v[168:171], v[48:51]
  ds_read_b64_tr_b16 a[196:197], v239 offset:2048
  v_mfma_f32_16x16x32_bf16 v[52:55], a[208:211], v[172:175], v[52:55]
  ds_read_b64_tr_b16 a[198:199], v239 offset:10240
  v_mfma_f32_16x16x32_bf16 v[56:59], a[208:211], v[176:179], v[56:59]
  s_waitcnt lgkmcnt(8)
  v_mfma_f32_16x16x32_bf16 v[60:63], a[212:215], v[168:171], v[60:63]
  ds_read_b64_tr_b16 a[200:201], v228 offset:2304
  v_mfma_f32_16x16x32_bf16 v[64:67], a[212:215], v[172:175], v[64:67]
  ds_read_b64_tr_b16 a[202:203], v228 offset:10496
  v_mfma_f32_16x16x32_bf16 v[68:71], a[212:215], v[176:179], v[68:71]
  s_waitcnt lgkmcnt(8)
  v_mfma_f32_16x16x32_bf16 v[72:75], a[216:219], v[168:171], v[72:75]
  ds_read_b64_tr_b16 a[204:205], v239 offset:2304
  v_mfma_f32_16x16x32_bf16 v[76:79], a[216:219], v[172:175], v[76:79]
  buffer_load_dwordx4 v231, s[8:11], s29 offen offset:1024 nt lds
  v_mfma_f32_16x16x32_bf16 v[80:83], a[216:219], v[176:179], v[80:83]
  s_waitcnt lgkmcnt(7)
  ds_read_b64_tr_b16 a[206:207], v239 offset:10496
  v_mfma_f32_16x16x32_bf16 v[84:87], a[220:223], v[168:171], v[84:87]
  s_add_u32 s29, s29, s30
  ds_read_b64_tr_b16 a[208:209], v228 offset:3072
  v_mfma_f32_16x16x32_bf16 v[88:91], a[220:223], v[172:175], v[88:91]
  ds_read_b64_tr_b16 a[210:211], v228 offset:11264
  v_mfma_f32_16x16x32_bf16 v[92:95], a[220:223], v[176:179], v[92:95]
  s_waitcnt lgkmcnt(8)
  v_mfma_f32_16x16x32_bf16 v[96:99], a[192:195], v[168:171], v[96:99]
  ds_read_b64_tr_b16 a[212:213], v239 offset:3072
  v_mfma_f32_16x16x32_bf16 v[100:103], a[192:195], v[172:175], v[100:103]
  ds_read_b64_tr_b16 a[214:215], v239 offset:11264
  v_mfma_f32_16x16x32_bf16 v[104:107], a[192:195], v[176:179], v[104:107]
  s_waitcnt lgkmcnt(8)
  v_mfma_f32_16x16x32_bf16 v[108:111], a[196:199], v[168:171], v[108:111]
  ds_read_b64_tr_b16 a[216:217], v228 offset:3328
  v_mfma_f32_16x16x32_bf16 v[112:115], a[196:199], v[172:175], v[112:115]
  ds_read_b64_tr_b16 a[218:219], v228 offset:11520
  v_mfma_f32_16x16x32_bf16 v[116:119], a[196:199], v[176:179], v[116:119]
  s_waitcnt lgkmcnt(8)
  v_mfma_f32_16x16x32_bf16 v[120:123], a[200:203], v[168:171], v[120:123]
  ds_read_b64_tr_b16 a[220:221], v239 offset:3328
  v_mfma_f32_16x16x32_bf16 v[124:127], a[200:203], v[172:175], v[124:127]
  buffer_load_dwordx4 v231, s[8:11], s29 offen offset:2048 nt lds
  v_mfma_f32_16x16x32_bf16 v[128:131], a[200:203], v[176:179], v[128:131]
  s_waitcnt lgkmcnt(7)
  ds_read_b64_tr_b16 a[222:223], v239 offset:11520
  v_add_u32 v228, 0, v230
  v_mfma_f32_16x16x32_bf16 v[132:135], a[204:207], v[168:171], v[132:135]
  s_add_u32 s29, s29, s30
  ds_read_b64_tr_b16 a[192:193], v228 offset:0
  v_xor_b32 v239, 32, v228
  v_mfma_f32_16x16x32_bf16 v[136:139], a[204:207], v[172:175], v[136:139]
  ds_read_b64_tr_b16 a[194:195], v228 offset:8192
  v_mfma_f32_16x16x32_bf16 v[140:143], a[204:207], v[176:179], v[140:143]
  s_waitcnt lgkmcnt(8)
  v_mfma_f32_16x16x32_bf16 v[144:147], a[208:211], v[168:171], v[144:147]
  ds_read_b64_tr_b16 a[196:197], v239 offset:0
  v_mfma_f32_16x16x32_bf16 v[148:151], a[208:211], v[172:175], v[148:151]
  ds_read_b64_tr_b16 a[198:199], v239 offset:8192
  v_mfma_f32_16x16x32_bf16 v[152:155], a[208:211], v[176:179], v[152:155]
  s_waitcnt lgkmcnt(8)
  v_mfma_f32_16x16x32_bf16 v[156:159], a[212:215], v[168:171], v[156:159]
  ds_read_b64_tr_b16 a[200:201], v228 offset:256
  v_mfma_f32_16x16x32_bf16 v[160:163], a[212:215], v[172:175], v[160:163]
  ds_read_b64_tr_b16 a[202:203], v228 offset:8448
  v_mfma_f32_16x16x32_bf16 v[164:167], a[212:215], v[176:179], v[164:167]
  s_waitcnt lgkmcnt(8)
  v_mfma_f32_16x16x32_bf16 a[224:227], a[216:219], v[168:171], a[224:227]
  ds_read_b64_tr_b16 a[204:205], v239 offset:256
  v_mfma_f32_16x16x32_bf16 a[228:231], a[216:219], v[172:175], a[228:231]
  buffer_load_dwordx4 v231, s[8:11], s29 offen offset:3072 nt lds
  v_mfma_f32_16x16x32_bf16 a[232:235], a[216:219], v[176:179], a[232:235]
  s_waitcnt lgkmcnt(7)
  ds_read_b64_tr_b16 a[206:207], v239 offset:8448
  v_mfma_f32_16x16x32_bf16 a[236:239], a[220:223], v[168:171], a[236:239]
  ds_read_b64_tr_b16 a[208:209], v228 offset:1024
  v_mfma_f32_16x16x32_bf16 a[240:243], a[220:223], v[172:175], a[240:243]
  ds_read_b64_tr_b16 a[210:211], v228 offset:9216
  v_mfma_f32_16x16x32_bf16 a[244:247], a[220:223], v[176:179], a[244:247]
  s_waitcnt lgkmcnt(8)
  v_mfma_f32_16x16x32_bf16 v[0:3], a[192:195], v[180:183], v[0:3]
  s_waitcnt vmcnt(63)
  ds_read_b64_tr_b16 a[212:213], v239 offset:1024
  v_mfma_f32_16x16x32_bf16 v[4:7], a[192:195], v[184:187], v[4:7]
  s_barrier
  ds_read_b64_tr_b16 a[214:215], v239 offset:9216
  v_mfma_f32_16x16x32_bf16 v[8:11], a[192:195], v[188:191], v[8:11]
  s_waitcnt lgkmcnt(8)
  v_mfma_f32_16x16x32_bf16 v[12:15], a[196:199], v[180:183], v[12:15]
  s_add_u32 m0, s28, 131072
  ds_read_b64_tr_b16 a[216:217], v228 offset:1280
  v_mfma_f32_16x16x32_bf16 v[16:19], a[196:199], v[184:187], v[16:19]
  s_mov_b32 s29, 35840
  ds_read_b64_tr_b16 a[218:219], v228 offset:9472
  v_mfma_f32_16x16x32_bf16 v[20:23], a[196:199], v[188:191], v[20:23]
  s_waitcnt lgkmcnt(8)
  v_mfma_f32_16x16x32_bf16 v[24:27], a[200:203], v[180:183], v[24:27]
  ds_read_b64_tr_b16 a[220:221], v239 offset:1280
  v_mfma_f32_16x16x32_bf16 v[28:31], a[200:203], v[184:187], v[28:31]
  buffer_load_dwordx4 v231, s[12:15], s29 offen offset:0 nt lds
  v_mfma_f32_16x16x32_bf16 v[32:35], a[200:203], v[188:191], v[32:35]
  s_waitcnt lgkmcnt(7)
  ds_read_b64_tr_b16 a[222:223], v239 offset:9472
  v_mfma_f32_16x16x32_bf16 v[36:39], a[204:207], v[180:183], v[36:39]
  s_add_u32 s29, s29, s30
  ds_read_b64_tr_b16 a[192:193], v228 offset:2048
  v_mfma_f32_16x16x32_bf16 v[40:43], a[204:207], v[184:187], v[40:43]
  ds_read_b64_tr_b16 a[194:195], v228 offset:10240
  v_mfma_f32_16x16x32_bf16 v[44:47], a[204:207], v[188:191], v[44:47]
  s_waitcnt lgkmcnt(8)
  v_mfma_f32_16x16x32_bf16 v[48:51], a[208:211], v[180:183], v[48:51]
  ds_read_b64_tr_b16 a[196:197], v239 offset:2048
  v_mfma_f32_16x16x32_bf16 v[52:55], a[208:211], v[184:187], v[52:55]
  ds_read_b64_tr_b16 a[198:199], v239 offset:10240
  v_mfma_f32_16x16x32_bf16 v[56:59], a[208:211], v[188:191], v[56:59]
  s_waitcnt lgkmcnt(8)
  v_mfma_f32_16x16x32_bf16 v[60:63], a[212:215], v[180:183], v[60:63]
  ds_read_b64_tr_b16 a[200:201], v228 offset:2304
  v_mfma_f32_16x16x32_bf16 v[64:67], a[212:215], v[184:187], v[64:67]
  ds_read_b64_tr_b16 a[202:203], v228 offset:10496
  v_mfma_f32_16x16x32_bf16 v[68:71], a[212:215], v[188:191], v[68:71]
  s_waitcnt lgkmcnt(8)
  v_mfma_f32_16x16x32_bf16 v[72:75], a[216:219], v[180:183], v[72:75]
  ds_read_b64_tr_b16 a[204:205], v239 offset:2304
  v_mfma_f32_16x16x32_bf16 v[76:79], a[216:219], v[184:187], v[76:79]
  buffer_load_dwordx4 v231, s[12:15], s29 offen offset:1024 nt lds
  v_mfma_f32_16x16x32_bf16 v[80:83], a[216:219], v[188:191], v[80:83]
  s_waitcnt lgkmcnt(7)
  ds_read_b64_tr_b16 a[206:207], v239 offset:10496
  v_mfma_f32_16x16x32_bf16 v[84:87], a[220:223], v[180:183], v[84:87]
  s_add_u32 s29, s29, s30
  ds_read_b64_tr_b16 a[208:209], v228 offset:3072
  v_mfma_f32_16x16x32_bf16 v[88:91], a[220:223], v[184:187], v[88:91]
  ds_read_b64_tr_b16 a[210:211], v228 offset:11264
  v_mfma_f32_16x16x32_bf16 v[92:95], a[220:223], v[188:191], v[92:95]
  s_waitcnt lgkmcnt(8)
  v_mfma_f32_16x16x32_bf16 v[96:99], a[192:195], v[180:183], v[96:99]
  ds_read_b64_tr_b16 a[212:213], v239 offset:3072
  v_mfma_f32_16x16x32_bf16 v[100:103], a[192:195], v[184:187], v[100:103]
  ds_read_b64_tr_b16 a[214:215], v239 offset:11264
  v_mfma_f32_16x16x32_bf16 v[104:107], a[192:195], v[188:191], v[104:107]
  s_waitcnt lgkmcnt(8)
  v_mfma_f32_16x16x32_bf16 v[108:111], a[196:199], v[180:183], v[108:111]
  ds_read_b64_tr_b16 a[216:217], v228 offset:3328
  v_mfma_f32_16x16x32_bf16 v[112:115], a[196:199], v[184:187], v[112:115]
  ds_read_b64_tr_b16 a[218:219], v228 offset:11520
  v_mfma_f32_16x16x32_bf16 v[116:119], a[196:199], v[188:191], v[116:119]
  s_waitcnt lgkmcnt(8)
  v_mfma_f32_16x16x32_bf16 v[120:123], a[200:203], v[180:183], v[120:123]
  ds_read_b64_tr_b16 a[220:221], v239 offset:3328
  v_mfma_f32_16x16x32_bf16 v[124:127], a[200:203], v[184:187], v[124:127]
  buffer_load_dwordx4 v231, s[12:15], s29 offen offset:2048 nt lds
  v_mfma_f32_16x16x32_bf16 v[128:131], a[200:203], v[188:191], v[128:131]
  s_waitcnt lgkmcnt(7)
  ds_read_b64_tr_b16 a[222:223], v239 offset:11520
  v_add_u32 v228, 16384, v229
  v_mfma_f32_16x16x32_bf16 v[132:135], a[204:207], v[180:183], v[132:135]
  s_add_u32 s29, s29, s30
  ds_read_b128 a[192:195], v228 offset:0
  v_mfma_f32_16x16x32_bf16 v[136:139], a[204:207], v[184:187], v[136:139]
  v_mfma_f32_16x16x32_bf16 v[140:143], a[204:207], v[188:191], v[140:143]
  s_waitcnt lgkmcnt(7)
  v_mfma_f32_16x16x32_bf16 v[144:147], a[208:211], v[180:183], v[144:147]
  ds_read_b128 a[196:199], v228 offset:256
  v_mfma_f32_16x16x32_bf16 v[148:151], a[208:211], v[184:187], v[148:151]
  v_mfma_f32_16x16x32_bf16 v[152:155], a[208:211], v[188:191], v[152:155]
  s_waitcnt lgkmcnt(6)
  v_mfma_f32_16x16x32_bf16 v[156:159], a[212:215], v[180:183], v[156:159]
  ds_read_b128 a[200:203], v228 offset:1024
  v_mfma_f32_16x16x32_bf16 v[160:163], a[212:215], v[184:187], v[160:163]
  v_mfma_f32_16x16x32_bf16 v[164:167], a[212:215], v[188:191], v[164:167]
  s_waitcnt lgkmcnt(5)
  v_mfma_f32_16x16x32_bf16 a[224:227], a[216:219], v[180:183], a[224:227]
  ds_read_b128 a[204:207], v228 offset:1280
  v_mfma_f32_16x16x32_bf16 a[228:231], a[216:219], v[184:187], a[228:231]
  buffer_load_dwordx4 v231, s[12:15], s29 offen offset:3072 nt lds
  v_mfma_f32_16x16x32_bf16 a[232:235], a[216:219], v[188:191], a[232:235]
  s_waitcnt lgkmcnt(4)
  v_mfma_f32_16x16x32_bf16 a[236:239], a[220:223], v[180:183], a[236:239]
  ds_read_b128 a[208:211], v228 offset:2048
  v_mfma_f32_16x16x32_bf16 a[240:243], a[220:223], v[184:187], a[240:243]
  v_mfma_f32_16x16x32_bf16 a[244:247], a[220:223], v[188:191], a[244:247]
  buffer_load_dwordx4 a[252:255], v247, s[88:91], 0 offen offset:0
  v_mov_b32 v238, v234
  s_barrier
.p2align 3
  s_add_u32 m0, s28, 147456
  s_mov_b32 s29, 68608
  buffer_load_dwordx4 v231, s[8:11], s29 offen offset:0 nt lds
.p2align 3
  v_pk_mul_f32 v[0:1], v[0:1], s[44:45]
  v_pk_mul_f32 v[2:3], v[2:3], s[44:45]
  v_pk_mul_f32 v[12:13], v[12:13], s[44:45]
  v_pk_mul_f32 v[14:15], v[14:15], s[44:45]
  v_cvt_pk_bf16_f32 v0, v0, v1
  v_cvt_pk_bf16_f32 v1, v2, v3
  v_cvt_pk_bf16_f32 v12, v12, v13
  v_cvt_pk_bf16_f32 v13, v14, v15
  v_pk_mul_f32 v[4:5], v[4:5], s[44:45]
  v_pk_mul_f32 v[6:7], v[6:7], s[44:45]
  v_pk_mul_f32 v[16:17], v[16:17], s[44:45]
  v_pk_mul_f32 v[18:19], v[18:19], s[44:45]
  v_permlane32_swap_b32 v0, v12
  v_permlane32_swap_b32 v1, v13
  v_cvt_pk_bf16_f32 v4, v4, v5
  v_cvt_pk_bf16_f32 v5, v6, v7
  v_cvt_pk_bf16_f32 v16, v16, v17
  v_cvt_pk_bf16_f32 v17, v18, v19
  v_permlane16_swap_b32 v0, v12
  v_permlane16_swap_b32 v1, v13
  v_pk_mul_f32 v[8:9], v[8:9], s[44:45]
  v_pk_mul_f32 v[10:11], v[10:11], s[44:45]
  v_pk_mul_f32 v[20:21], v[20:21], s[44:45]
  v_pk_mul_f32 v[22:23], v[22:23], s[44:45]
  v_permlane32_swap_b32 v4, v16
  v_permlane32_swap_b32 v5, v17
  v_cvt_pk_bf16_f32 v8, v8, v9
  v_cvt_pk_bf16_f32 v9, v10, v11
  v_cvt_pk_bf16_f32 v20, v20, v21
  v_cvt_pk_bf16_f32 v21, v22, v23
  v_permlane16_swap_b32 v4, v16
  v_permlane16_swap_b32 v5, v17
  v_accvgpr_write_b32 a0, v0
  v_accvgpr_write_b32 a1, v1
  v_accvgpr_write_b32 a2, v12
  v_accvgpr_write_b32 a3, v13
  v_pk_mul_f32 v[24:25], v[24:25], s[44:45]
  v_pk_mul_f32 v[26:27], v[26:27], s[44:45]
  v_pk_mul_f32 v[36:37], v[36:37], s[44:45]
  v_pk_mul_f32 v[38:39], v[38:39], s[44:45]
  v_permlane32_swap_b32 v8, v20
  v_permlane32_swap_b32 v9, v21
  v_cvt_pk_bf16_f32 v24, v24, v25
  v_cvt_pk_bf16_f32 v25, v26, v27
  v_cvt_pk_bf16_f32 v36, v36, v37
  v_cvt_pk_bf16_f32 v37, v38, v39
  v_permlane16_swap_b32 v8, v20
  v_permlane16_swap_b32 v9, v21
  s_add_u32 s29, s29, s30
  buffer_load_dwordx4 v231, s[8:11], s29 offen offset:1024 nt lds
.p2align 3
  v_accvgpr_write_b32 a4, v4
  v_accvgpr_write_b32 a5, v5
  v_accvgpr_write_b32 a6, v16
  v_accvgpr_write_b32 a7, v17
  v_pk_mul_f32 v[28:29], v[28:29], s[44:45]
  v_pk_mul_f32 v[30:31], v[30:31], s[44:45]
  v_pk_mul_f32 v[40:41], v[40:41], s[44:45]
  v_pk_mul_f32 v[42:43], v[42:43], s[44:45]
  v_permlane32_swap_b32 v24, v36
  v_permlane32_swap_b32 v25, v37
  v_cvt_pk_bf16_f32 v28, v28, v29
  v_cvt_pk_bf16_f32 v29, v30, v31
  v_cvt_pk_bf16_f32 v40, v40, v41
  v_cvt_pk_bf16_f32 v41, v42, v43
  v_permlane16_swap_b32 v24, v36
  v_permlane16_swap_b32 v25, v37
  v_accvgpr_write_b32 a8, v8
  v_accvgpr_write_b32 a9, v9
  v_accvgpr_write_b32 a10, v20
  v_accvgpr_write_b32 a11, v21
  v_pk_mul_f32 v[32:33], v[32:33], s[44:45]
  v_pk_mul_f32 v[34:35], v[34:35], s[44:45]
  v_pk_mul_f32 v[44:45], v[44:45], s[44:45]
  v_pk_mul_f32 v[46:47], v[46:47], s[44:45]
  v_permlane32_swap_b32 v28, v40
  v_permlane32_swap_b32 v29, v41
  v_cvt_pk_bf16_f32 v32, v32, v33
  v_cvt_pk_bf16_f32 v33, v34, v35
  v_cvt_pk_bf16_f32 v44, v44, v45
  v_cvt_pk_bf16_f32 v45, v46, v47
  v_permlane16_swap_b32 v28, v40
  v_permlane16_swap_b32 v29, v41
  v_accvgpr_write_b32 a12, v24
  v_accvgpr_write_b32 a13, v25
  v_accvgpr_write_b32 a14, v36
  v_accvgpr_write_b32 a15, v37
  v_pk_mul_f32 v[48:49], v[48:49], s[44:45]
  v_pk_mul_f32 v[50:51], v[50:51], s[44:45]
  v_pk_mul_f32 v[60:61], v[60:61], s[44:45]
  v_pk_mul_f32 v[62:63], v[62:63], s[44:45]
  v_permlane32_swap_b32 v32, v44
  v_permlane32_swap_b32 v33, v45
  v_cvt_pk_bf16_f32 v48, v48, v49
  v_cvt_pk_bf16_f32 v49, v50, v51
  v_cvt_pk_bf16_f32 v60, v60, v61
  v_cvt_pk_bf16_f32 v61, v62, v63
  v_permlane16_swap_b32 v32, v44
  v_permlane16_swap_b32 v33, v45
  s_add_u32 s29, s29, s30
  buffer_load_dwordx4 v231, s[8:11], s29 offen offset:2048 nt lds
.p2align 3
  v_accvgpr_write_b32 a16, v28
  v_accvgpr_write_b32 a17, v29
  v_accvgpr_write_b32 a18, v40
  v_accvgpr_write_b32 a19, v41
  v_pk_mul_f32 v[52:53], v[52:53], s[44:45]
  v_pk_mul_f32 v[54:55], v[54:55], s[44:45]
  v_pk_mul_f32 v[64:65], v[64:65], s[44:45]
  v_pk_mul_f32 v[66:67], v[66:67], s[44:45]
  v_permlane32_swap_b32 v48, v60
  v_permlane32_swap_b32 v49, v61
  v_cvt_pk_bf16_f32 v52, v52, v53
  v_cvt_pk_bf16_f32 v53, v54, v55
  v_cvt_pk_bf16_f32 v64, v64, v65
  v_cvt_pk_bf16_f32 v65, v66, v67
  v_permlane16_swap_b32 v48, v60
  v_permlane16_swap_b32 v49, v61
  v_accvgpr_write_b32 a20, v32
  v_accvgpr_write_b32 a21, v33
  v_accvgpr_write_b32 a22, v44
  v_accvgpr_write_b32 a23, v45
  v_pk_mul_f32 v[56:57], v[56:57], s[44:45]
  v_pk_mul_f32 v[58:59], v[58:59], s[44:45]
  v_pk_mul_f32 v[68:69], v[68:69], s[44:45]
  v_pk_mul_f32 v[70:71], v[70:71], s[44:45]
  v_permlane32_swap_b32 v52, v64
  v_permlane32_swap_b32 v53, v65
  v_cvt_pk_bf16_f32 v56, v56, v57
  v_cvt_pk_bf16_f32 v57, v58, v59
  v_cvt_pk_bf16_f32 v68, v68, v69
  v_cvt_pk_bf16_f32 v69, v70, v71
  v_permlane16_swap_b32 v52, v64
  v_permlane16_swap_b32 v53, v65
  v_accvgpr_write_b32 a24, v48
  v_accvgpr_write_b32 a25, v49
  v_accvgpr_write_b32 a26, v60
  v_accvgpr_write_b32 a27, v61
  v_pk_mul_f32 v[72:73], v[72:73], s[44:45]
  v_pk_mul_f32 v[74:75], v[74:75], s[44:45]
  v_pk_mul_f32 v[84:85], v[84:85], s[44:45]
  v_pk_mul_f32 v[86:87], v[86:87], s[44:45]
  v_permlane32_swap_b32 v56, v68
  v_permlane32_swap_b32 v57, v69
  v_cvt_pk_bf16_f32 v72, v72, v73
  v_cvt_pk_bf16_f32 v73, v74, v75
  v_cvt_pk_bf16_f32 v84, v84, v85
  v_cvt_pk_bf16_f32 v85, v86, v87
  v_permlane16_swap_b32 v56, v68
  v_permlane16_swap_b32 v57, v69
  v_accvgpr_write_b32 a28, v52
  s_add_u32 s29, s29, s30
  buffer_load_dwordx4 v231, s[8:11], s29 offen offset:3072 nt lds
.p2align 3
  v_accvgpr_write_b32 a29, v53
  v_accvgpr_write_b32 a30, v64
  v_accvgpr_write_b32 a31, v65
  v_pk_mul_f32 v[76:77], v[76:77], s[44:45]
  v_pk_mul_f32 v[78:79], v[78:79], s[44:45]
  v_pk_mul_f32 v[88:89], v[88:89], s[44:45]
  v_pk_mul_f32 v[90:91], v[90:91], s[44:45]
  v_permlane32_swap_b32 v72, v84
  v_permlane32_swap_b32 v73, v85
  v_cvt_pk_bf16_f32 v76, v76, v77
  v_cvt_pk_bf16_f32 v77, v78, v79
  v_cvt_pk_bf16_f32 v88, v88, v89
  v_cvt_pk_bf16_f32 v89, v90, v91
  v_permlane16_swap_b32 v72, v84
  v_permlane16_swap_b32 v73, v85
  v_accvgpr_write_b32 a32, v56
  v_accvgpr_write_b32 a33, v57
  v_accvgpr_write_b32 a34, v68
  v_accvgpr_write_b32 a35, v69
  v_pk_mul_f32 v[80:81], v[80:81], s[44:45]
  v_pk_mul_f32 v[82:83], v[82:83], s[44:45]
  v_pk_mul_f32 v[92:93], v[92:93], s[44:45]
  v_pk_mul_f32 v[94:95], v[94:95], s[44:45]
  v_permlane32_swap_b32 v76, v88
  v_permlane32_swap_b32 v77, v89
  v_cvt_pk_bf16_f32 v80, v80, v81
  v_cvt_pk_bf16_f32 v81, v82, v83
  v_cvt_pk_bf16_f32 v92, v92, v93
  v_cvt_pk_bf16_f32 v93, v94, v95
  v_permlane16_swap_b32 v76, v88
  v_permlane16_swap_b32 v77, v89
  v_accvgpr_write_b32 a36, v72
  v_accvgpr_write_b32 a37, v73
  v_accvgpr_write_b32 a38, v84
  v_accvgpr_write_b32 a39, v85
  v_pk_mul_f32 v[96:97], v[96:97], s[44:45]
  v_pk_mul_f32 v[98:99], v[98:99], s[44:45]
  v_pk_mul_f32 v[108:109], v[108:109], s[44:45]
  v_pk_mul_f32 v[110:111], v[110:111], s[44:45]
  v_permlane32_swap_b32 v80, v92
  v_permlane32_swap_b32 v81, v93
  v_cvt_pk_bf16_f32 v96, v96, v97
  v_cvt_pk_bf16_f32 v97, v98, v99
  v_cvt_pk_bf16_f32 v108, v108, v109
  v_cvt_pk_bf16_f32 v109, v110, v111
  v_permlane16_swap_b32 v80, v92
  v_permlane16_swap_b32 v81, v93
  v_accvgpr_write_b32 a40, v76
  s_add_u32 m0, s28, 0
  s_mov_b32 s29, 52224
  buffer_load_dwordx4 v231, s[12:15], s29 offen offset:0 nt lds
.p2align 3
  v_accvgpr_write_b32 a41, v77
  v_accvgpr_write_b32 a42, v88
  v_accvgpr_write_b32 a43, v89
  v_pk_mul_f32 v[100:101], v[100:101], s[44:45]
  v_pk_mul_f32 v[102:103], v[102:103], s[44:45]
  v_pk_mul_f32 v[112:113], v[112:113], s[44:45]
  v_pk_mul_f32 v[114:115], v[114:115], s[44:45]
  v_permlane32_swap_b32 v96, v108
  v_permlane32_swap_b32 v97, v109
  v_cvt_pk_bf16_f32 v100, v100, v101
  v_cvt_pk_bf16_f32 v101, v102, v103
  v_cvt_pk_bf16_f32 v112, v112, v113
  v_cvt_pk_bf16_f32 v113, v114, v115
  v_permlane16_swap_b32 v96, v108
  v_permlane16_swap_b32 v97, v109
  v_accvgpr_write_b32 a44, v80
  v_accvgpr_write_b32 a45, v81
  v_accvgpr_write_b32 a46, v92
  v_accvgpr_write_b32 a47, v93
  v_pk_mul_f32 v[104:105], v[104:105], s[44:45]
  v_pk_mul_f32 v[106:107], v[106:107], s[44:45]
  v_pk_mul_f32 v[116:117], v[116:117], s[44:45]
  v_pk_mul_f32 v[118:119], v[118:119], s[44:45]
  v_permlane32_swap_b32 v100, v112
  v_permlane32_swap_b32 v101, v113
  v_cvt_pk_bf16_f32 v104, v104, v105
  v_cvt_pk_bf16_f32 v105, v106, v107
  v_cvt_pk_bf16_f32 v116, v116, v117
  v_cvt_pk_bf16_f32 v117, v118, v119
  v_permlane16_swap_b32 v100, v112
  v_permlane16_swap_b32 v101, v113
  v_accvgpr_write_b32 a48, v96
  v_accvgpr_write_b32 a49, v97
  v_accvgpr_write_b32 a50, v108
  v_accvgpr_write_b32 a51, v109
  v_pk_mul_f32 v[120:121], v[120:121], s[44:45]
  v_pk_mul_f32 v[122:123], v[122:123], s[44:45]
  v_pk_mul_f32 v[132:133], v[132:133], s[44:45]
  v_pk_mul_f32 v[134:135], v[134:135], s[44:45]
  v_permlane32_swap_b32 v104, v116
  v_permlane32_swap_b32 v105, v117
  v_cvt_pk_bf16_f32 v120, v120, v121
  v_cvt_pk_bf16_f32 v121, v122, v123
  v_cvt_pk_bf16_f32 v132, v132, v133
  v_cvt_pk_bf16_f32 v133, v134, v135
  v_permlane16_swap_b32 v104, v116
  v_permlane16_swap_b32 v105, v117
  v_accvgpr_write_b32 a52, v100
  v_accvgpr_write_b32 a53, v101
  s_add_u32 s29, s29, s30
  buffer_load_dwordx4 v231, s[12:15], s29 offen offset:1024 nt lds
.p2align 3
  v_accvgpr_write_b32 a54, v112
  v_accvgpr_write_b32 a55, v113
  v_pk_mul_f32 v[124:125], v[124:125], s[44:45]
  v_pk_mul_f32 v[126:127], v[126:127], s[44:45]
  v_pk_mul_f32 v[136:137], v[136:137], s[44:45]
  v_pk_mul_f32 v[138:139], v[138:139], s[44:45]
  v_permlane32_swap_b32 v120, v132
  v_permlane32_swap_b32 v121, v133
  v_cvt_pk_bf16_f32 v124, v124, v125
  v_cvt_pk_bf16_f32 v125, v126, v127
  v_cvt_pk_bf16_f32 v136, v136, v137
  v_cvt_pk_bf16_f32 v137, v138, v139
  v_permlane16_swap_b32 v120, v132
  v_permlane16_swap_b32 v121, v133
  v_accvgpr_write_b32 a56, v104
  v_accvgpr_write_b32 a57, v105
  v_accvgpr_write_b32 a58, v116
  v_accvgpr_write_b32 a59, v117
  v_pk_mul_f32 v[128:129], v[128:129], s[44:45]
  v_pk_mul_f32 v[130:131], v[130:131], s[44:45]
  v_pk_mul_f32 v[140:141], v[140:141], s[44:45]
  v_pk_mul_f32 v[142:143], v[142:143], s[44:45]
  v_permlane32_swap_b32 v124, v136
  v_permlane32_swap_b32 v125, v137
  v_cvt_pk_bf16_f32 v128, v128, v129
  v_cvt_pk_bf16_f32 v129, v130, v131
  v_cvt_pk_bf16_f32 v140, v140, v141
  v_cvt_pk_bf16_f32 v141, v142, v143
  v_permlane16_swap_b32 v124, v136
  v_permlane16_swap_b32 v125, v137
  v_accvgpr_write_b32 a60, v120
  v_accvgpr_write_b32 a61, v121
  v_accvgpr_write_b32 a62, v132
  v_accvgpr_write_b32 a63, v133
  v_pk_mul_f32 v[144:145], v[144:145], s[44:45]
  v_pk_mul_f32 v[146:147], v[146:147], s[44:45]
  v_pk_mul_f32 v[156:157], v[156:157], s[44:45]
  v_pk_mul_f32 v[158:159], v[158:159], s[44:45]
  v_permlane32_swap_b32 v128, v140
  v_permlane32_swap_b32 v129, v141
  v_cvt_pk_bf16_f32 v144, v144, v145
  v_cvt_pk_bf16_f32 v145, v146, v147
  v_cvt_pk_bf16_f32 v156, v156, v157
  v_cvt_pk_bf16_f32 v157, v158, v159
  v_permlane16_swap_b32 v128, v140
  v_permlane16_swap_b32 v129, v141
  v_accvgpr_write_b32 a64, v124
  v_accvgpr_write_b32 a65, v125
  s_add_u32 s29, s29, s30
  buffer_load_dwordx4 v231, s[12:15], s29 offen offset:2048 nt lds
.p2align 3
  v_accvgpr_write_b32 a66, v136
  v_accvgpr_write_b32 a67, v137
  v_pk_mul_f32 v[148:149], v[148:149], s[44:45]
  v_pk_mul_f32 v[150:151], v[150:151], s[44:45]
  v_pk_mul_f32 v[160:161], v[160:161], s[44:45]
  v_pk_mul_f32 v[162:163], v[162:163], s[44:45]
  v_permlane32_swap_b32 v144, v156
  v_permlane32_swap_b32 v145, v157
  v_cvt_pk_bf16_f32 v148, v148, v149
  v_cvt_pk_bf16_f32 v149, v150, v151
  v_cvt_pk_bf16_f32 v160, v160, v161
  v_cvt_pk_bf16_f32 v161, v162, v163
  v_permlane16_swap_b32 v144, v156
  v_permlane16_swap_b32 v145, v157
  v_accvgpr_write_b32 a68, v128
  v_accvgpr_write_b32 a69, v129
  v_accvgpr_write_b32 a70, v140
  v_accvgpr_write_b32 a71, v141
  v_pk_mul_f32 v[152:153], v[152:153], s[44:45]
  v_pk_mul_f32 v[154:155], v[154:155], s[44:45]
  v_pk_mul_f32 v[164:165], v[164:165], s[44:45]
  v_pk_mul_f32 v[166:167], v[166:167], s[44:45]
  v_permlane32_swap_b32 v148, v160
  v_permlane32_swap_b32 v149, v161
  v_cvt_pk_bf16_f32 v152, v152, v153
  v_cvt_pk_bf16_f32 v153, v154, v155
  v_cvt_pk_bf16_f32 v164, v164, v165
  v_cvt_pk_bf16_f32 v165, v166, v167
  v_permlane16_swap_b32 v148, v160
  v_permlane16_swap_b32 v149, v161
  v_accvgpr_write_b32 a72, v144
  v_accvgpr_write_b32 a73, v145
  v_accvgpr_write_b32 a74, v156
  v_accvgpr_write_b32 a75, v157
  v_accvgpr_read_b32 v0, a224
  v_accvgpr_read_b32 v1, a225
  v_accvgpr_read_b32 v2, a226
  v_accvgpr_read_b32 v3, a227
  v_accvgpr_read_b32 v12, a236
  v_accvgpr_read_b32 v13, a237
  v_accvgpr_read_b32 v14, a238
  v_accvgpr_read_b32 v15, a239
  v_permlane32_swap_b32 v152, v164
  v_permlane32_swap_b32 v153, v165
  v_pk_mul_f32 v[0:1], v[0:1], s[44:45]
  v_pk_mul_f32 v[2:3], v[2:3], s[44:45]
  v_pk_mul_f32 v[12:13], v[12:13], s[44:45]
  v_pk_mul_f32 v[14:15], v[14:15], s[44:45]
  v_cvt_pk_bf16_f32 v0, v0, v1
  s_add_u32 s29, s29, s30
  buffer_load_dwordx4 v231, s[12:15], s29 offen offset:3072 nt lds
.p2align 3
  v_cvt_pk_bf16_f32 v1, v2, v3
  v_cvt_pk_bf16_f32 v12, v12, v13
  v_cvt_pk_bf16_f32 v13, v14, v15
  v_permlane16_swap_b32 v152, v164
  v_permlane16_swap_b32 v153, v165
  v_accvgpr_write_b32 a76, v148
  v_accvgpr_write_b32 a77, v149
  v_accvgpr_write_b32 a78, v160
  v_accvgpr_write_b32 a79, v161
  v_accvgpr_read_b32 v24, a228
  v_accvgpr_read_b32 v25, a229
  v_accvgpr_read_b32 v26, a230
  v_accvgpr_read_b32 v27, a231
  v_accvgpr_read_b32 v36, a240
  v_accvgpr_read_b32 v37, a241
  v_accvgpr_read_b32 v38, a242
  v_accvgpr_read_b32 v39, a243
  v_permlane32_swap_b32 v0, v12
  v_permlane32_swap_b32 v1, v13
  v_pk_mul_f32 v[24:25], v[24:25], s[44:45]
  v_pk_mul_f32 v[26:27], v[26:27], s[44:45]
  v_pk_mul_f32 v[36:37], v[36:37], s[44:45]
  v_pk_mul_f32 v[38:39], v[38:39], s[44:45]
  v_cvt_pk_bf16_f32 v24, v24, v25
  v_cvt_pk_bf16_f32 v25, v26, v27
  v_cvt_pk_bf16_f32 v36, v36, v37
  v_cvt_pk_bf16_f32 v37, v38, v39
  v_permlane16_swap_b32 v0, v12
  v_permlane16_swap_b32 v1, v13
  v_accvgpr_write_b32 a80, v152
  v_accvgpr_write_b32 a81, v153
  v_accvgpr_write_b32 a82, v164
  v_accvgpr_write_b32 a83, v165
  v_accvgpr_read_b32 v48, a232
  v_accvgpr_read_b32 v49, a233
  v_accvgpr_read_b32 v50, a234
  v_accvgpr_read_b32 v51, a235
  v_accvgpr_read_b32 v60, a244
  v_accvgpr_read_b32 v61, a245
  v_accvgpr_read_b32 v62, a246
  v_accvgpr_read_b32 v63, a247
  v_permlane32_swap_b32 v24, v36
  v_permlane32_swap_b32 v25, v37
  v_pk_mul_f32 v[48:49], v[48:49], s[44:45]
  v_pk_mul_f32 v[50:51], v[50:51], s[44:45]
  v_pk_mul_f32 v[60:61], v[60:61], s[44:45]
  v_pk_mul_f32 v[62:63], v[62:63], s[44:45]
  v_cvt_pk_bf16_f32 v48, v48, v49
  v_cvt_pk_bf16_f32 v49, v50, v51
  v_cvt_pk_bf16_f32 v60, v60, v61
  v_cvt_pk_bf16_f32 v61, v62, v63
  v_permlane16_swap_b32 v24, v36
  v_permlane16_swap_b32 v25, v37
  v_accvgpr_write_b32 a84, v0
  v_accvgpr_write_b32 a85, v1
  v_accvgpr_write_b32 a86, v12
  v_accvgpr_write_b32 a87, v13
  v_permlane32_swap_b32 v48, v60
  v_permlane32_swap_b32 v49, v61
  s_nop 0
  v_permlane16_swap_b32 v48, v60
  v_permlane16_swap_b32 v49, v61
  v_accvgpr_write_b32 a88, v24
  v_accvgpr_write_b32 a89, v25
  v_accvgpr_write_b32 a90, v36
  v_accvgpr_write_b32 a91, v37
  v_accvgpr_write_b32 a92, v48
  v_accvgpr_write_b32 a93, v49
  v_accvgpr_write_b32 a94, v60
  v_accvgpr_write_b32 a95, v61
  s_waitcnt lgkmcnt(4)
  v_mfma_f32_16x16x32_bf16 v[168:171], a[192:195], a[0:3], 0
  s_waitcnt vmcnt(63)
  ds_read_b128 a[212:215], v228 offset:2304
  v_mfma_f32_16x16x32_bf16 v[176:179], a[192:195], a[4:7], 0
  s_barrier
  v_mfma_f32_16x16x32_bf16 v[184:187], a[192:195], a[8:11], 0
  s_waitcnt lgkmcnt(4)
  v_mov_b32 v234, 0
  v_mov_b32 v235, 0
  v_mfma_f32_16x16x32_bf16 v[168:171], a[196:199], a[12:15], v[168:171]
  ds_read_b128 a[216:219], v228 offset:3072
  v_mov_b32 v236, 0
  v_mfma_f32_16x16x32_bf16 v[176:179], a[196:199], a[16:19], v[176:179]
  buffer_atomic_cmpswap_x2 a[248:251], v246, s[60:63], 0 offen sc0 sc1
  v_mfma_f32_16x16x32_bf16 v[184:187], a[196:199], a[20:23], v[184:187]
  s_waitcnt lgkmcnt(4)
  v_mfma_f32_16x16x32_bf16 v[168:171], a[200:203], a[24:27], v[168:171]
  ds_read_b128 a[220:223], v228 offset:3328
  v_mfma_f32_16x16x32_bf16 v[176:179], a[200:203], a[28:31], v[176:179]
  v_mfma_f32_16x16x32_bf16 v[184:187], a[200:203], a[32:35], v[184:187]
  s_waitcnt lgkmcnt(4)
  v_mfma_f32_16x16x32_bf16 v[168:171], a[204:207], a[36:39], v[168:171]
  ds_read_b128 a[192:195], v228 offset:8192
  v_mfma_f32_16x16x32_bf16 v[176:179], a[204:207], a[40:43], v[176:179]
  v_mfma_f32_16x16x32_bf16 v[184:187], a[204:207], a[44:47], v[184:187]
  s_waitcnt lgkmcnt(4)
  v_mfma_f32_16x16x32_bf16 v[168:171], a[208:211], a[48:51], v[168:171]
  ds_read_b128 a[196:199], v228 offset:8448
  v_mfma_f32_16x16x32_bf16 v[176:179], a[208:211], a[52:55], v[176:179]
  v_mfma_f32_16x16x32_bf16 v[184:187], a[208:211], a[56:59], v[184:187]
  s_waitcnt lgkmcnt(4)
  v_mfma_f32_16x16x32_bf16 v[168:171], a[212:215], a[60:63], v[168:171]
  ds_read_b128 a[200:203], v228 offset:9216
  v_mfma_f32_16x16x32_bf16 v[176:179], a[212:215], a[64:67], v[176:179]
  buffer_load_dwordx4 a[252:255], v238, s[96:99], s100 offen offset:0
  v_mfma_f32_16x16x32_bf16 v[184:187], a[212:215], a[68:71], v[184:187]
  s_waitcnt lgkmcnt(4)
  v_mfma_f32_16x16x32_bf16 v[168:171], a[216:219], a[72:75], v[168:171]
  ds_read_b128 a[204:207], v228 offset:9472
  v_mfma_f32_16x16x32_bf16 v[176:179], a[216:219], a[76:79], v[176:179]
  v_mfma_f32_16x16x32_bf16 v[184:187], a[216:219], a[80:83], v[184:187]
  s_waitcnt lgkmcnt(4)
  v_mfma_f32_16x16x32_bf16 v[168:171], a[220:223], a[84:87], v[168:171]
  ds_read_b128 a[208:211], v228 offset:10240
  v_mfma_f32_16x16x32_bf16 v[176:179], a[220:223], a[88:91], v[176:179]
  v_mfma_f32_16x16x32_bf16 v[184:187], a[220:223], a[92:95], v[184:187]
  s_waitcnt lgkmcnt(4)
  v_mfma_f32_16x16x32_bf16 v[172:175], a[192:195], a[0:3], 0
  ds_read_b128 a[212:215], v228 offset:10496
  v_mfma_f32_16x16x32_bf16 v[180:183], a[192:195], a[4:7], 0
  s_nop 0
  v_max3_f32 v240, v168, v169, v170
  v_mfma_f32_16x16x32_bf16 v[188:191], a[192:195], a[8:11], 0
  s_waitcnt lgkmcnt(4)
  v_max3_f32 v241, v176, v177, v178
  v_max_f32 v240, v240, v171
  v_mfma_f32_16x16x32_bf16 v[172:175], a[196:199], a[12:15], v[172:175]
  ds_read_b128 a[216:219], v228 offset:11264
  v_max3_f32 v242, v184, v185, v186
  v_mfma_f32_16x16x32_bf16 v[180:183], a[196:199], a[16:19], v[180:183]
  v_max_f32 v241, v241, v179
  v_max_f32 v242, v242, v187
  v_mfma_f32_16x16x32_bf16 v[188:191], a[196:199], a[20:23], v[188:191]
  s_waitcnt lgkmcnt(4)
  v_mov_b32 v243, v240
  v_mov_b32 v244, v241
  v_mfma_f32_16x16x32_bf16 v[172:175], a[200:203], a[24:27], v[172:175]
  ds_read_b128 a[220:223], v228 offset:11520
  v_add_u32 v228, 65536, v229
  v_mfma_f32_16x16x32_bf16 v[180:183], a[200:203], a[28:31], v[180:183]
  buffer_load_dwordx4 a[252:255], v238, s[96:99], s100 offen offset:1024
  v_mfma_f32_16x16x32_bf16 v[188:191], a[200:203], a[32:35], v[188:191]
  s_waitcnt lgkmcnt(4)
  v_permlane32_swap_b32 v240, v243
  v_mfma_f32_16x16x32_bf16 v[172:175], a[204:207], a[36:39], v[172:175]
  ds_read_b128 a[192:195], v228 offset:0
  v_mov_b32 v245, v242
  v_mfma_f32_16x16x32_bf16 v[180:183], a[204:207], a[40:43], v[180:183]
  v_permlane32_swap_b32 v241, v244
  v_mfma_f32_16x16x32_bf16 v[188:191], a[204:207], a[44:47], v[188:191]
  s_waitcnt lgkmcnt(4)
  v_permlane32_swap_b32 v242, v245
  v_mfma_f32_16x16x32_bf16 v[172:175], a[208:211], a[48:51], v[172:175]
  ds_read_b128 a[196:199], v228 offset:256
  v_max_f32 v240, v240, v243
  v_mfma_f32_16x16x32_bf16 v[180:183], a[208:211], a[52:55], v[180:183]
  v_max_f32 v241, v241, v244
  v_max_f32 v242, v242, v245
  v_mfma_f32_16x16x32_bf16 v[188:191], a[208:211], a[56:59], v[188:191]
  s_waitcnt lgkmcnt(4)
  v_mov_b32 v243, v240
  v_mov_b32 v244, v241
  v_mfma_f32_16x16x32_bf16 v[172:175], a[212:215], a[60:63], v[172:175]
  ds_read_b128 a[200:203], v228 offset:1024
  v_mov_b32 v245, v242
  v_mfma_f32_16x16x32_bf16 v[180:183], a[212:215], a[64:67], v[180:183]
  v_permlane16_swap_b32 v240, v243
  v_mfma_f32_16x16x32_bf16 v[188:191], a[212:215], a[68:71], v[188:191]
  s_waitcnt lgkmcnt(4)
  v_permlane16_swap_b32 v241, v244
  v_mfma_f32_16x16x32_bf16 v[172:175], a[216:219], a[72:75], v[172:175]
  ds_read_b128 a[204:207], v228 offset:1280
  v_max_f32 v240, v240, v243
  v_mfma_f32_16x16x32_bf16 v[180:183], a[216:219], a[76:79], v[180:183]
  v_max_f32 v241, v241, v244
  v_sub_f32 v216, 0, v240
  v_mfma_f32_16x16x32_bf16 v[188:191], a[216:219], a[80:83], v[188:191]
  s_waitcnt lgkmcnt(4)
  v_sub_f32 v220, 0, v241
  v_sub_f32 v217, 0, v240
  v_mfma_f32_16x16x32_bf16 v[172:175], a[220:223], a[84:87], v[172:175]
  ds_read_b128 a[208:211], v228 offset:2048
  v_sub_f32 v221, 0, v241
  v_mfma_f32_16x16x32_bf16 v[180:183], a[220:223], a[88:91], v[180:183]
  v_sub_f32 v218, 0, v240
  v_sub_f32 v222, 0, v241
  v_permlane16_swap_b32 v242, v245
  v_max_f32 v242, v242, v245
  v_sub_f32 v224, 0, v242
  v_sub_f32 v225, 0, v242
  v_sub_f32 v226, 0, v242
  v_sub_f32 v219, 0, v240
  v_sub_f32 v223, 0, v241
  v_sub_f32 v227, 0, v242
  v_mfma_f32_16x16x32_bf16 v[188:191], a[220:223], a[92:95], v[188:191]
  s_waitcnt lgkmcnt(4)
  v_add_f32 v168, v216, v168
  v_add_f32 v169, v216, v169
  v_mfma_f32_16x16x32_bf16 v[192:195], a[192:195], a[0:3], v[216:219]
  s_waitcnt vmcnt(63)
  ds_read_b128 a[212:215], v228 offset:2304
  v_add_f32 v170, v216, v170
  v_mfma_f32_16x16x32_bf16 v[200:203], a[192:195], a[4:7], v[220:223]
  s_barrier
  v_add_f32 v171, v216, v171
  v_add_f32 v176, v220, v176
  v_mfma_f32_16x16x32_bf16 v[208:211], a[192:195], a[8:11], v[224:227]
  s_waitcnt lgkmcnt(4)
  v_add_f32 v177, v220, v177
  v_add_f32 v178, v220, v178
  v_mfma_f32_16x16x32_bf16 v[192:195], a[196:199], a[12:15], v[192:195]
  ds_read_b128 a[216:219], v228 offset:3072
  v_add_f32 v179, v220, v179
  v_mfma_f32_16x16x32_bf16 v[200:203], a[196:199], a[16:19], v[200:203]
  v_add_f32 v184, v224, v184
  v_add_f32 v185, v224, v185
  v_mfma_f32_16x16x32_bf16 v[208:211], a[196:199], a[20:23], v[208:211]
  s_waitcnt lgkmcnt(4)
  v_add_f32 v186, v224, v186
  v_add_f32 v187, v224, v187
  v_mfma_f32_16x16x32_bf16 v[192:195], a[200:203], a[24:27], v[192:195]
  ds_read_b128 a[220:223], v228 offset:3328
  v_add_f32 v172, v216, v172
  v_mfma_f32_16x16x32_bf16 v[200:203], a[200:203], a[28:31], v[200:203]
  v_add_f32 v173, v216, v173
  v_add_f32 v174, v216, v174
  v_mfma_f32_16x16x32_bf16 v[208:211], a[200:203], a[32:35], v[208:211]
  s_waitcnt lgkmcnt(4)
  v_add_f32 v175, v216, v175
  v_add_f32 v180, v220, v180
  v_mfma_f32_16x16x32_bf16 v[192:195], a[204:207], a[36:39], v[192:195]
  ds_read_b128 a[192:195], v228 offset:8192
  v_add_f32 v181, v220, v181
  v_mfma_f32_16x16x32_bf16 v[200:203], a[204:207], a[40:43], v[200:203]
  v_add_f32 v182, v220, v182
  v_add_f32 v183, v220, v183
  v_mfma_f32_16x16x32_bf16 v[208:211], a[204:207], a[44:47], v[208:211]
  s_waitcnt lgkmcnt(4)
  v_add_f32 v188, v224, v188
  v_add_f32 v189, v224, v189
  v_mfma_f32_16x16x32_bf16 v[192:195], a[208:211], a[48:51], v[192:195]
  ds_read_b128 a[196:199], v228 offset:8448
  v_add_f32 v190, v224, v190
  v_mfma_f32_16x16x32_bf16 v[200:203], a[208:211], a[52:55], v[200:203]
  v_exp_f32 v168, v168
  v_mfma_f32_16x16x32_bf16 v[208:211], a[208:211], a[56:59], v[208:211]
  s_waitcnt lgkmcnt(4)
  v_exp_f32 v169, v169
  v_mfma_f32_16x16x32_bf16 v[192:195], a[212:215], a[60:63], v[192:195]
  ds_read_b128 a[200:203], v228 offset:9216
  v_add_f32 v234, v168, v234
  v_mfma_f32_16x16x32_bf16 v[200:203], a[212:215], a[64:67], v[200:203]
  buffer_load_dwordx4 a[252:255], v238, s[96:99], s100 offen offset:2048
  v_mfma_f32_16x16x32_bf16 v[208:211], a[212:215], a[68:71], v[208:211]
  s_waitcnt lgkmcnt(4)
  v_exp_f32 v170, v170
  v_mfma_f32_16x16x32_bf16 v[192:195], a[216:219], a[72:75], v[192:195]
  ds_read_b128 a[204:207], v228 offset:9472
  v_add_f32 v234, v169, v234
  v_mfma_f32_16x16x32_bf16 v[200:203], a[216:219], a[76:79], v[200:203]
  v_exp_f32 v171, v171
  v_mfma_f32_16x16x32_bf16 v[208:211], a[216:219], a[80:83], v[208:211]
  s_waitcnt lgkmcnt(4)
  v_exp_f32 v176, v176
  v_mfma_f32_16x16x32_bf16 v[192:195], a[220:223], a[84:87], v[192:195]
  ds_read_b128 a[208:211], v228 offset:10240
  v_cvt_pk_bf16_f32 v168, v168, v169
  v_mfma_f32_16x16x32_bf16 v[200:203], a[220:223], a[88:91], v[200:203]
  v_exp_f32 v177, v177
  v_mfma_f32_16x16x32_bf16 v[208:211], a[220:223], a[92:95], v[208:211]
  s_waitcnt lgkmcnt(4)
  v_exp_f32 v178, v178
  v_mfma_f32_16x16x32_bf16 v[196:199], a[192:195], a[0:3], v[216:219]
  ds_read_b128 a[212:215], v228 offset:10496
  v_add_f32 v234, v170, v234
  v_mfma_f32_16x16x32_bf16 v[204:207], a[192:195], a[4:7], v[220:223]
  v_exp_f32 v179, v179
  v_mfma_f32_16x16x32_bf16 v[212:215], a[192:195], a[8:11], v[224:227]
  s_waitcnt lgkmcnt(4)
  v_exp_f32 v184, v184
  v_mfma_f32_16x16x32_bf16 v[196:199], a[196:199], a[12:15], v[196:199]
  ds_read_b128 a[216:219], v228 offset:11264
  v_add_f32 v234, v171, v234
  v_mfma_f32_16x16x32_bf16 v[204:207], a[196:199], a[16:19], v[204:207]
  v_cvt_pk_bf16_f32 v169, v170, v171
  v_add_f32 v235, v176, v235
  v_mfma_f32_16x16x32_bf16 v[212:215], a[196:199], a[20:23], v[212:215]
  s_waitcnt lgkmcnt(4)
  v_exp_f32 v185, v185
  v_mfma_f32_16x16x32_bf16 v[196:199], a[200:203], a[24:27], v[196:199]
  ds_read_b128 a[220:223], v228 offset:11520
  v_add_u32 v228, 114688, v230
  v_mfma_f32_16x16x32_bf16 v[204:207], a[200:203], a[28:31], v[204:207]
  buffer_load_dwordx4 a[252:255], v238, s[96:99], s100 offen offset:3072
  v_mfma_f32_16x16x32_bf16 v[212:215], a[200:203], a[32:35], v[212:215]
  s_waitcnt lgkmcnt(4)
  v_xor_b32 v239, 32, v228
  v_mfma_f32_16x16x32_bf16 v[196:199], a[204:207], a[36:39], v[196:199]
  ds_read_b64_tr_b16 a[192:193], v228 offset:0
  v_add_f32 v235, v177, v235
  v_mfma_f32_16x16x32_bf16 v[204:207], a[204:207], a[40:43], v[204:207]
  ds_read_b64_tr_b16 a[194:195], v228 offset:8192
  v_cvt_pk_bf16_f32 v176, v176, v177
  v_mfma_f32_16x16x32_bf16 v[212:215], a[204:207], a[44:47], v[212:215]
  s_waitcnt lgkmcnt(5)
  v_exp_f32 v186, v186
  v_mfma_f32_16x16x32_bf16 v[196:199], a[208:211], a[48:51], v[196:199]
  ds_read_b64_tr_b16 a[196:197], v239 offset:0
  v_add_f32 v235, v178, v235
  v_mfma_f32_16x16x32_bf16 v[204:207], a[208:211], a[52:55], v[204:207]
  ds_read_b64_tr_b16 a[198:199], v239 offset:8192
  v_add_f32 v235, v179, v235
  v_mfma_f32_16x16x32_bf16 v[212:215], a[208:211], a[56:59], v[212:215]
  s_waitcnt lgkmcnt(6)
  v_exp_f32 v187, v187
  v_mfma_f32_16x16x32_bf16 v[196:199], a[212:215], a[60:63], v[196:199]
  ds_read_b64_tr_b16 a[200:201], v228 offset:256
  v_cvt_pk_bf16_f32 v177, v178, v179
  v_mfma_f32_16x16x32_bf16 v[204:207], a[212:215], a[64:67], v[204:207]
  ds_read_b64_tr_b16 a[202:203], v228 offset:8448
  v_add_f32 v236, v184, v236
  v_mfma_f32_16x16x32_bf16 v[212:215], a[212:215], a[68:71], v[212:215]
  s_waitcnt lgkmcnt(7)
  v_exp_f32 v172, v172
  v_mfma_f32_16x16x32_bf16 v[196:199], a[216:219], a[72:75], v[196:199]
  ds_read_b64_tr_b16 a[204:205], v239 offset:256
  v_add_f32 v236, v185, v236
  v_mfma_f32_16x16x32_bf16 v[204:207], a[216:219], a[76:79], v[204:207]
  ds_read_b64_tr_b16 a[206:207], v239 offset:8448
  v_cvt_pk_bf16_f32 v184, v184, v185
  v_mfma_f32_16x16x32_bf16 v[212:215], a[216:219], a[80:83], v[212:215]
  s_waitcnt lgkmcnt(8)
  v_exp_f32 v173, v173
  v_mfma_f32_16x16x32_bf16 v[196:199], a[220:223], a[84:87], v[196:199]
  ds_read_b64_tr_b16 a[208:209], v228 offset:1024
  v_add_f32 v236, v186, v236
  v_mfma_f32_16x16x32_bf16 v[204:207], a[220:223], a[88:91], v[204:207]
  ds_read_b64_tr_b16 a[210:211], v228 offset:9216
  v_add_f32 v236, v187, v236
  v_exp_f32 v174, v174
  v_exp_f32 v175, v175
  v_exp_f32 v180, v180
  v_exp_f32 v181, v181
  v_exp_f32 v182, v182
  v_exp_f32 v183, v183
  v_exp_f32 v188, v188
  v_exp_f32 v189, v189
  v_exp_f32 v190, v190
  v_cvt_pk_bf16_f32 v185, v186, v187
  v_add_f32 v234, v172, v234
  v_add_f32 v234, v173, v234
  v_cvt_pk_bf16_f32 v170, v172, v173
  v_add_f32 v234, v174, v234
  v_add_f32 v234, v175, v234
  v_cvt_pk_bf16_f32 v171, v174, v175
  v_add_f32 v235, v180, v235
  v_add_f32 v235, v181, v235
  v_cvt_pk_bf16_f32 v178, v180, v181
  v_add_f32 v235, v182, v235
  v_add_f32 v235, v183, v235
  v_cvt_pk_bf16_f32 v179, v182, v183
  v_add_f32 v236, v188, v236
  v_add_f32 v236, v189, v236
  v_cvt_pk_bf16_f32 v186, v188, v189
  v_add_f32 v236, v190, v236
  v_add_f32 v191, v224, v191
  v_exp_f32 v191, v191
  s_nop 0
  v_add_f32 v236, v191, v236
  v_cvt_pk_bf16_f32 v187, v190, v191
  v_mfma_f32_16x16x32_bf16 v[212:215], a[220:223], a[92:95], v[212:215]
  s_waitcnt lgkmcnt(8)
  v_exp_f32 v192, v192
  v_mfma_f32_16x16x32_bf16 v[0:3], a[192:195], v[168:171], 0
  s_waitcnt vmcnt(30)
  ds_read_b64_tr_b16 a[212:213], v239 offset:1024
  v_add_f32 v234, v192, v234
  v_mfma_f32_16x16x32_bf16 v[4:7], a[192:195], v[176:179], 0
  s_barrier
  ds_read_b64_tr_b16 a[214:215], v239 offset:9216
  v_mfma_f32_16x16x32_bf16 v[8:11], a[192:195], v[184:187], 0
  s_waitcnt lgkmcnt(8)
  v_exp_f32 v193, v193
  v_mfma_f32_16x16x32_bf16 v[12:15], a[196:199], v[168:171], 0
  s_add_u32 m0, s28, 16384
  ds_read_b64_tr_b16 a[216:217], v228 offset:1280
  v_add_f32 v234, v193, v234
  v_mfma_f32_16x16x32_bf16 v[16:19], a[196:199], v[176:179], 0
  s_mov_b32 s29, 31744
  ds_read_b64_tr_b16 a[218:219], v228 offset:9472
  v_cvt_pk_bf16_f32 v192, v192, v193
  v_mfma_f32_16x16x32_bf16 v[20:23], a[196:199], v[184:187], 0
  s_waitcnt lgkmcnt(8)
  v_exp_f32 v194, v194
  v_mfma_f32_16x16x32_bf16 v[24:27], a[200:203], v[168:171], 0
  ds_read_b64_tr_b16 a[220:221], v239 offset:1280
  v_add_f32 v234, v194, v234
  v_mfma_f32_16x16x32_bf16 v[28:31], a[200:203], v[176:179], 0
  buffer_load_dwordx4 v233, s[4:7], s29 offen offset:0 lds
  v_mfma_f32_16x16x32_bf16 v[32:35], a[200:203], v[184:187], 0
  s_waitcnt lgkmcnt(7)
  ds_read_b64_tr_b16 a[222:223], v239 offset:9472
  v_mfma_f32_16x16x32_bf16 v[36:39], a[204:207], v[168:171], 0
  s_mov_b32 s29, 37888
  ds_read_b64_tr_b16 a[192:193], v228 offset:2048
  v_mfma_f32_16x16x32_bf16 v[40:43], a[204:207], v[176:179], 0
  ds_read_b64_tr_b16 a[194:195], v228 offset:10240
  v_mfma_f32_16x16x32_bf16 v[44:47], a[204:207], v[184:187], 0
  s_waitcnt lgkmcnt(8)
  v_exp_f32 v195, v195
  v_mfma_f32_16x16x32_bf16 v[48:51], a[208:211], v[168:171], 0
  ds_read_b64_tr_b16 a[196:197], v239 offset:2048
  v_add_f32 v234, v195, v234
  v_mfma_f32_16x16x32_bf16 v[52:55], a[208:211], v[176:179], 0
  ds_read_b64_tr_b16 a[198:199], v239 offset:10240
  v_cvt_pk_bf16_f32 v193, v194, v195
  v_mfma_f32_16x16x32_bf16 v[56:59], a[208:211], v[184:187], 0
  s_waitcnt lgkmcnt(8)
  v_exp_f32 v200, v200
  v_mfma_f32_16x16x32_bf16 v[60:63], a[212:215], v[168:171], 0
  ds_read_b64_tr_b16 a[200:201], v228 offset:2304
  v_add_f32 v235, v200, v235
  v_mfma_f32_16x16x32_bf16 v[64:67], a[212:215], v[176:179], 0
  ds_read_b64_tr_b16 a[202:203], v228 offset:10496
  v_mfma_f32_16x16x32_bf16 v[68:71], a[212:215], v[184:187], 0
  s_waitcnt lgkmcnt(8)
  v_exp_f32 v201, v201
  v_mfma_f32_16x16x32_bf16 v[72:75], a[216:219], v[168:171], 0
  ds_read_b64_tr_b16 a[204:205], v239 offset:2304
  v_add_f32 v235, v201, v235
  v_mfma_f32_16x16x32_bf16 v[76:79], a[216:219], v[176:179], 0
  buffer_load_dwordx4 v233, s[4:7], s29 offen offset:1024 lds
  v_mfma_f32_16x16x32_bf16 v[80:83], a[216:219], v[184:187], 0
  s_waitcnt lgkmcnt(7)
  ds_read_b64_tr_b16 a[206:207], v239 offset:10496
  v_cvt_pk_bf16_f32 v200, v200, v201
  v_mfma_f32_16x16x32_bf16 v[84:87], a[220:223], v[168:171], 0
  s_mov_b32 s29, 1152
  ds_read_b64_tr_b16 a[208:209], v228 offset:3072
  v_mfma_f32_16x16x32_bf16 v[88:91], a[220:223], v[176:179], 0
  ds_read_b64_tr_b16 a[210:211], v228 offset:11264
  v_mfma_f32_16x16x32_bf16 v[92:95], a[220:223], v[184:187], 0
  s_waitcnt lgkmcnt(8)
  v_exp_f32 v202, v202
  v_mfma_f32_16x16x32_bf16 v[96:99], a[192:195], v[168:171], 0
  ds_read_b64_tr_b16 a[212:213], v239 offset:3072
  v_add_f32 v235, v202, v235
  v_mfma_f32_16x16x32_bf16 v[100:103], a[192:195], v[176:179], 0
  ds_read_b64_tr_b16 a[214:215], v239 offset:11264
  v_mfma_f32_16x16x32_bf16 v[104:107], a[192:195], v[184:187], 0
  s_waitcnt lgkmcnt(8)
  v_exp_f32 v203, v203
  v_mfma_f32_16x16x32_bf16 v[108:111], a[196:199], v[168:171], 0
  ds_read_b64_tr_b16 a[216:217], v228 offset:3328
  v_add_f32 v235, v203, v235
  v_mfma_f32_16x16x32_bf16 v[112:115], a[196:199], v[176:179], 0
  ds_read_b64_tr_b16 a[218:219], v228 offset:11520
  v_cvt_pk_bf16_f32 v201, v202, v203
  v_mfma_f32_16x16x32_bf16 v[116:119], a[196:199], v[184:187], 0
  s_waitcnt lgkmcnt(8)
  v_exp_f32 v208, v208
  v_mfma_f32_16x16x32_bf16 v[120:123], a[200:203], v[168:171], 0
  ds_read_b64_tr_b16 a[220:221], v239 offset:3328
  v_add_f32 v236, v208, v236
  v_mfma_f32_16x16x32_bf16 v[124:127], a[200:203], v[176:179], 0
  buffer_load_dwordx4 v233, s[4:7], s29 offen offset:2048 lds
  v_mfma_f32_16x16x32_bf16 v[128:131], a[200:203], v[184:187], 0
  s_waitcnt lgkmcnt(7)
  ds_read_b64_tr_b16 a[222:223], v239 offset:11520
  v_add_u32 v228, 32768, v229
  v_mfma_f32_16x16x32_bf16 v[132:135], a[204:207], v[168:171], 0
  s_mov_b32 s29, 7296
  ds_read_b128 a[192:195], v228 offset:0
  v_mfma_f32_16x16x32_bf16 v[136:139], a[204:207], v[176:179], 0
  v_exp_f32 v209, v209
  v_mfma_f32_16x16x32_bf16 v[140:143], a[204:207], v[184:187], 0
  s_waitcnt lgkmcnt(7)
  v_exp_f32 v210, v210
  v_mfma_f32_16x16x32_bf16 v[144:147], a[208:211], v[168:171], 0
  ds_read_b128 a[196:199], v228 offset:256
  v_add_f32 v236, v209, v236
  v_mfma_f32_16x16x32_bf16 v[148:151], a[208:211], v[176:179], 0
  v_exp_f32 v211, v211
  v_mfma_f32_16x16x32_bf16 v[152:155], a[208:211], v[184:187], 0
  s_waitcnt lgkmcnt(6)
  v_exp_f32 v196, v196
  v_mfma_f32_16x16x32_bf16 v[156:159], a[212:215], v[168:171], 0
  ds_read_b128 a[200:203], v228 offset:1024
  v_cvt_pk_bf16_f32 v208, v208, v209
  v_mfma_f32_16x16x32_bf16 v[160:163], a[212:215], v[176:179], 0
  v_exp_f32 v197, v197
  v_mfma_f32_16x16x32_bf16 v[164:167], a[212:215], v[184:187], 0
  s_waitcnt lgkmcnt(5)
  v_exp_f32 v198, v198
  v_mfma_f32_16x16x32_bf16 a[224:227], a[216:219], v[168:171], 0
  ds_read_b128 a[204:207], v228 offset:1280
  v_add_f32 v236, v210, v236
  v_mfma_f32_16x16x32_bf16 a[228:231], a[216:219], v[176:179], 0
  buffer_load_dwordx4 v233, s[4:7], s29 offen offset:3072 lds
  v_mfma_f32_16x16x32_bf16 a[232:235], a[216:219], v[184:187], 0
  s_waitcnt lgkmcnt(4)
  v_exp_f32 v199, v199
  v_mfma_f32_16x16x32_bf16 a[236:239], a[220:223], v[168:171], 0
  ds_read_b128 a[208:211], v228 offset:2048
  v_add_f32 v236, v211, v236
  v_mfma_f32_16x16x32_bf16 a[240:243], a[220:223], v[176:179], 0
  v_exp_f32 v204, v204
  v_mfma_f32_16x16x32_bf16 a[244:247], a[220:223], v[184:187], 0
  s_waitcnt lgkmcnt(4)
  v_exp_f32 v205, v205
  v_mfma_f32_16x16x32_bf16 v[168:171], a[192:195], a[0:3], v[216:219]
  s_waitcnt vmcnt(30)
  ds_read_b128 a[212:215], v228 offset:2304
  v_cvt_pk_bf16_f32 v209, v210, v211
  v_mfma_f32_16x16x32_bf16 v[176:179], a[192:195], a[4:7], v[220:223]
  s_barrier
  v_exp_f32 v206, v206
  v_mfma_f32_16x16x32_bf16 v[184:187], a[192:195], a[8:11], v[224:227]
  s_waitcnt lgkmcnt(4)
  v_exp_f32 v207, v207
  v_mfma_f32_16x16x32_bf16 v[168:171], a[196:199], a[12:15], v[168:171]
  s_add_u32 m0, s28, 65536
  ds_read_b128 a[216:219], v228 offset:3072
  v_add_f32 v234, v196, v234
  v_mfma_f32_16x16x32_bf16 v[176:179], a[196:199], a[16:19], v[176:179]
  s_mov_b32 s29, 3584
  v_exp_f32 v212, v212
  v_mfma_f32_16x16x32_bf16 v[184:187], a[196:199], a[20:23], v[184:187]
  s_waitcnt lgkmcnt(4)
  v_exp_f32 v213, v213
  v_mfma_f32_16x16x32_bf16 v[168:171], a[200:203], a[24:27], v[168:171]
  ds_read_b128 a[220:223], v228 offset:3328
  v_add_f32 v234, v197, v234
  v_mfma_f32_16x16x32_bf16 v[176:179], a[200:203], a[28:31], v[176:179]
  buffer_load_dwordx4 v232, s[16:19], s29 offen offset:0 lds
  v_mfma_f32_16x16x32_bf16 v[184:187], a[200:203], a[32:35], v[184:187]
  s_waitcnt lgkmcnt(4)
  v_cvt_pk_bf16_f32 v194, v196, v197
  v_add_f32 v234, v198, v234
  v_mfma_f32_16x16x32_bf16 v[168:171], a[204:207], a[36:39], v[168:171]
  s_add_u32 s29, s29, s30
  ds_read_b128 a[192:195], v228 offset:8192
  v_add_f32 v234, v199, v234
  v_mfma_f32_16x16x32_bf16 v[176:179], a[204:207], a[40:43], v[176:179]
  v_exp_f32 v214, v214
  v_mfma_f32_16x16x32_bf16 v[184:187], a[204:207], a[44:47], v[184:187]
  s_waitcnt lgkmcnt(4)
  v_exp_f32 v215, v215
  v_mfma_f32_16x16x32_bf16 v[168:171], a[208:211], a[48:51], v[168:171]
  ds_read_b128 a[196:199], v228 offset:8448
  v_cvt_pk_bf16_f32 v195, v198, v199
  v_mfma_f32_16x16x32_bf16 v[176:179], a[208:211], a[52:55], v[176:179]
  v_add_f32 v235, v204, v235
  v_add_f32 v236, v212, v236
  v_mfma_f32_16x16x32_bf16 v[184:187], a[208:211], a[56:59], v[184:187]
  s_waitcnt lgkmcnt(4)
  v_add_f32 v235, v205, v235
  v_add_f32 v236, v213, v236
  v_mfma_f32_16x16x32_bf16 v[168:171], a[212:215], a[60:63], v[168:171]
  ds_read_b128 a[200:203], v228 offset:9216
  v_cvt_pk_bf16_f32 v202, v204, v205
  v_mfma_f32_16x16x32_bf16 v[176:179], a[212:215], a[64:67], v[176:179]
  v_add_f32 v235, v206, v235
  v_cvt_pk_bf16_f32 v210, v212, v213
  v_mfma_f32_16x16x32_bf16 v[184:187], a[212:215], a[68:71], v[184:187]
  s_waitcnt lgkmcnt(4)
  v_add_f32 v235, v207, v235
  v_add_f32 v236, v214, v236
  v_mfma_f32_16x16x32_bf16 v[168:171], a[216:219], a[72:75], v[168:171]
  ds_read_b128 a[204:207], v228 offset:9472
  v_cvt_pk_bf16_f32 v203, v206, v207
  v_mfma_f32_16x16x32_bf16 v[176:179], a[216:219], a[76:79], v[176:179]
  buffer_load_dwordx4 v232, s[16:19], s29 offen offset:1024 lds
  v_mfma_f32_16x16x32_bf16 v[184:187], a[216:219], a[80:83], v[184:187]
  s_waitcnt lgkmcnt(4)
  v_add_f32 v236, v215, v236
  v_mfma_f32_16x16x32_bf16 v[168:171], a[220:223], a[84:87], v[168:171]
  s_add_u32 s29, s29, s30
  ds_read_b128 a[208:211], v228 offset:10240
  v_cvt_pk_bf16_f32 v211, v214, v215
  v_mfma_f32_16x16x32_bf16 v[176:179], a[220:223], a[88:91], v[176:179]
  v_mfma_f32_16x16x32_bf16 v[184:187], a[220:223], a[92:95], v[184:187]
  s_waitcnt lgkmcnt(4)
  v_mfma_f32_16x16x32_bf16 v[172:175], a[192:195], a[0:3], v[216:219]
  ds_read_b128 a[212:215], v228 offset:10496
  v_mfma_f32_16x16x32_bf16 v[180:183], a[192:195], a[4:7], v[220:223]
  v_exp_f32 v168, v168
  v_mfma_f32_16x16x32_bf16 v[188:191], a[192:195], a[8:11], v[224:227]
  s_waitcnt lgkmcnt(4)
  v_exp_f32 v169, v169
  v_mfma_f32_16x16x32_bf16 v[172:175], a[196:199], a[12:15], v[172:175]
  ds_read_b128 a[216:219], v228 offset:11264
  v_add_f32 v234, v168, v234
  v_mfma_f32_16x16x32_bf16 v[180:183], a[196:199], a[16:19], v[180:183]
  v_exp_f32 v170, v170
  v_mfma_f32_16x16x32_bf16 v[188:191], a[196:199], a[20:23], v[188:191]
  s_waitcnt lgkmcnt(4)
  v_exp_f32 v171, v171
  v_mfma_f32_16x16x32_bf16 v[172:175], a[200:203], a[24:27], v[172:175]
  ds_read_b128 a[220:223], v228 offset:11520
  v_add_u32 v228, 49152, v230
  v_mfma_f32_16x16x32_bf16 v[180:183], a[200:203], a[28:31], v[180:183]
  buffer_load_dwordx4 v232, s[16:19], s29 offen offset:2048 lds
  v_mfma_f32_16x16x32_bf16 v[188:191], a[200:203], a[32:35], v[188:191]
  s_waitcnt lgkmcnt(4)
  v_xor_b32 v239, 32, v228
  v_mfma_f32_16x16x32_bf16 v[172:175], a[204:207], a[36:39], v[172:175]
  s_add_u32 s29, s29, s30
  ds_read_b64_tr_b16 a[192:193], v228 offset:0
  v_add_f32 v234, v169, v234
  v_mfma_f32_16x16x32_bf16 v[180:183], a[204:207], a[40:43], v[180:183]
  ds_read_b64_tr_b16 a[194:195], v228 offset:8192
  v_cvt_pk_bf16_f32 v168, v168, v169
  v_mfma_f32_16x16x32_bf16 v[188:191], a[204:207], a[44:47], v[188:191]
  s_waitcnt lgkmcnt(5)
  v_exp_f32 v176, v176
  v_mfma_f32_16x16x32_bf16 v[172:175], a[208:211], a[48:51], v[172:175]
  ds_read_b64_tr_b16 a[196:197], v239 offset:0
  v_add_f32 v234, v170, v234
  v_mfma_f32_16x16x32_bf16 v[180:183], a[208:211], a[52:55], v[180:183]
  ds_read_b64_tr_b16 a[198:199], v239 offset:8192
  v_add_f32 v234, v171, v234
  v_mfma_f32_16x16x32_bf16 v[188:191], a[208:211], a[56:59], v[188:191]
  s_waitcnt lgkmcnt(6)
  v_exp_f32 v177, v177
  v_mfma_f32_16x16x32_bf16 v[172:175], a[212:215], a[60:63], v[172:175]
  ds_read_b64_tr_b16 a[200:201], v228 offset:256
  v_cvt_pk_bf16_f32 v169, v170, v171
  v_mfma_f32_16x16x32_bf16 v[180:183], a[212:215], a[64:67], v[180:183]
  ds_read_b64_tr_b16 a[202:203], v228 offset:8448
  v_add_f32 v235, v176, v235
  v_mfma_f32_16x16x32_bf16 v[188:191], a[212:215], a[68:71], v[188:191]
  s_waitcnt lgkmcnt(7)
  v_exp_f32 v178, v178
  v_mfma_f32_16x16x32_bf16 v[172:175], a[216:219], a[72:75], v[172:175]
  ds_read_b64_tr_b16 a[204:205], v239 offset:256
  v_add_f32 v235, v177, v235
  v_mfma_f32_16x16x32_bf16 v[180:183], a[216:219], a[76:79], v[180:183]
  buffer_load_dwordx4 v232, s[16:19], s29 offen offset:3072 lds
  v_mfma_f32_16x16x32_bf16 v[188:191], a[216:219], a[80:83], v[188:191]
  s_waitcnt lgkmcnt(7)
  ds_read_b64_tr_b16 a[206:207], v239 offset:8448
  v_cvt_pk_bf16_f32 v176, v176, v177
  v_mfma_f32_16x16x32_bf16 v[172:175], a[220:223], a[84:87], v[172:175]
  ds_read_b64_tr_b16 a[208:209], v228 offset:1024
  v_add_f32 v235, v178, v235
  v_mfma_f32_16x16x32_bf16 v[180:183], a[220:223], a[88:91], v[180:183]
  ds_read_b64_tr_b16 a[210:211], v228 offset:9216
  v_mfma_f32_16x16x32_bf16 v[188:191], a[220:223], a[92:95], v[188:191]
  s_waitcnt lgkmcnt(8)
  v_exp_f32 v179, v179
  v_mfma_f32_16x16x32_bf16 v[0:3], a[192:195], v[192:195], v[0:3]
  s_waitcnt vmcnt(26)
  ds_read_b64_tr_b16 a[212:213], v239 offset:1024
  v_add_f32 v235, v179, v235
  v_mfma_f32_16x16x32_bf16 v[4:7], a[192:195], v[200:203], v[4:7]
  s_barrier
  ds_read_b64_tr_b16 a[214:215], v239 offset:9216
  v_cvt_pk_bf16_f32 v177, v178, v179
  v_mfma_f32_16x16x32_bf16 v[8:11], a[192:195], v[208:211], v[8:11]
  s_waitcnt lgkmcnt(8)
  v_exp_f32 v184, v184
  v_mfma_f32_16x16x32_bf16 v[12:15], a[196:199], v[192:195], v[12:15]
  s_add_u32 m0, s28, 114688
  ds_read_b64_tr_b16 a[216:217], v228 offset:1280
  v_add_f32 v236, v184, v236
  v_mfma_f32_16x16x32_bf16 v[16:19], a[196:199], v[200:203], v[16:19]
  s_mov_b32 s29, 265728
  ds_read_b64_tr_b16 a[218:219], v228 offset:9472
  v_mfma_f32_16x16x32_bf16 v[20:23], a[196:199], v[208:211], v[20:23]
  s_waitcnt lgkmcnt(8)
  v_exp_f32 v185, v185
  v_mfma_f32_16x16x32_bf16 v[24:27], a[200:203], v[192:195], v[24:27]
  ds_read_b64_tr_b16 a[220:221], v239 offset:1280
  v_add_f32 v236, v185, v236
  v_mfma_f32_16x16x32_bf16 v[28:31], a[200:203], v[200:203], v[28:31]
  buffer_load_dwordx4 v232, s[16:19], s29 offen offset:0 lds
  v_mfma_f32_16x16x32_bf16 v[32:35], a[200:203], v[208:211], v[32:35]
  s_waitcnt lgkmcnt(7)
  ds_read_b64_tr_b16 a[222:223], v239 offset:9472
  v_cvt_pk_bf16_f32 v184, v184, v185
  v_mfma_f32_16x16x32_bf16 v[36:39], a[204:207], v[192:195], v[36:39]
  s_add_u32 s29, s29, s30
  ds_read_b64_tr_b16 a[192:193], v228 offset:2048
  v_mfma_f32_16x16x32_bf16 v[40:43], a[204:207], v[200:203], v[40:43]
  ds_read_b64_tr_b16 a[194:195], v228 offset:10240
  v_mfma_f32_16x16x32_bf16 v[44:47], a[204:207], v[208:211], v[44:47]
  s_waitcnt lgkmcnt(8)
  v_exp_f32 v186, v186
  v_mfma_f32_16x16x32_bf16 v[48:51], a[208:211], v[192:195], v[48:51]
  ds_read_b64_tr_b16 a[196:197], v239 offset:2048
  v_add_f32 v236, v186, v236
  v_mfma_f32_16x16x32_bf16 v[52:55], a[208:211], v[200:203], v[52:55]
  ds_read_b64_tr_b16 a[198:199], v239 offset:10240
  v_mfma_f32_16x16x32_bf16 v[56:59], a[208:211], v[208:211], v[56:59]
  s_waitcnt lgkmcnt(8)
  v_exp_f32 v187, v187
  v_mfma_f32_16x16x32_bf16 v[60:63], a[212:215], v[192:195], v[60:63]
  ds_read_b64_tr_b16 a[200:201], v228 offset:2304
  v_add_f32 v236, v187, v236
  v_mfma_f32_16x16x32_bf16 v[64:67], a[212:215], v[200:203], v[64:67]
  ds_read_b64_tr_b16 a[202:203], v228 offset:10496
  v_cvt_pk_bf16_f32 v185, v186, v187
  v_mfma_f32_16x16x32_bf16 v[68:71], a[212:215], v[208:211], v[68:71]
  s_waitcnt lgkmcnt(8)
  v_exp_f32 v172, v172
  v_mfma_f32_16x16x32_bf16 v[72:75], a[216:219], v[192:195], v[72:75]
  ds_read_b64_tr_b16 a[204:205], v239 offset:2304
  v_add_f32 v234, v172, v234
  v_mfma_f32_16x16x32_bf16 v[76:79], a[216:219], v[200:203], v[76:79]
  buffer_load_dwordx4 v232, s[16:19], s29 offen offset:1024 lds
  v_mfma_f32_16x16x32_bf16 v[80:83], a[216:219], v[208:211], v[80:83]
  s_waitcnt lgkmcnt(7)
  ds_read_b64_tr_b16 a[206:207], v239 offset:10496
  v_mfma_f32_16x16x32_bf16 v[84:87], a[220:223], v[192:195], v[84:87]
  s_add_u32 s29, s29, s30
  ds_read_b64_tr_b16 a[208:209], v228 offset:3072
  v_mfma_f32_16x16x32_bf16 v[88:91], a[220:223], v[200:203], v[88:91]
  ds_read_b64_tr_b16 a[210:211], v228 offset:11264
  v_mfma_f32_16x16x32_bf16 v[92:95], a[220:223], v[208:211], v[92:95]
  s_waitcnt lgkmcnt(8)
  v_exp_f32 v173, v173
  v_mfma_f32_16x16x32_bf16 v[96:99], a[192:195], v[192:195], v[96:99]
  ds_read_b64_tr_b16 a[212:213], v239 offset:3072
  v_add_f32 v234, v173, v234
  v_mfma_f32_16x16x32_bf16 v[100:103], a[192:195], v[200:203], v[100:103]
  ds_read_b64_tr_b16 a[214:215], v239 offset:11264
  v_cvt_pk_bf16_f32 v170, v172, v173
  v_mfma_f32_16x16x32_bf16 v[104:107], a[192:195], v[208:211], v[104:107]
  s_waitcnt lgkmcnt(8)
  v_exp_f32 v174, v174
  v_mfma_f32_16x16x32_bf16 v[108:111], a[196:199], v[192:195], v[108:111]
  ds_read_b64_tr_b16 a[216:217], v228 offset:3328
  v_add_f32 v234, v174, v234
  v_mfma_f32_16x16x32_bf16 v[112:115], a[196:199], v[200:203], v[112:115]
  ds_read_b64_tr_b16 a[218:219], v228 offset:11520
  v_mfma_f32_16x16x32_bf16 v[116:119], a[196:199], v[208:211], v[116:119]
  s_waitcnt lgkmcnt(8)
  v_exp_f32 v175, v175
  v_mfma_f32_16x16x32_bf16 v[120:123], a[200:203], v[192:195], v[120:123]
  ds_read_b64_tr_b16 a[220:221], v239 offset:3328
  v_add_f32 v234, v175, v234
  v_mfma_f32_16x16x32_bf16 v[124:127], a[200:203], v[200:203], v[124:127]
  buffer_load_dwordx4 v232, s[16:19], s29 offen offset:2048 lds
  v_mfma_f32_16x16x32_bf16 v[128:131], a[200:203], v[208:211], v[128:131]
  s_waitcnt lgkmcnt(7)
  ds_read_b64_tr_b16 a[222:223], v239 offset:11520
  v_add_u32 v228, 81920, v229
  v_mfma_f32_16x16x32_bf16 v[132:135], a[204:207], v[192:195], v[132:135]
  s_add_u32 s29, s29, s30
  ds_read_b128 a[192:195], v228 offset:0
  v_cvt_pk_bf16_f32 v171, v174, v175
  v_mfma_f32_16x16x32_bf16 v[136:139], a[204:207], v[200:203], v[136:139]
  v_exp_f32 v180, v180
  v_mfma_f32_16x16x32_bf16 v[140:143], a[204:207], v[208:211], v[140:143]
  s_waitcnt lgkmcnt(7)
  v_exp_f32 v181, v181
  v_mfma_f32_16x16x32_bf16 v[144:147], a[208:211], v[192:195], v[144:147]
  ds_read_b128 a[196:199], v228 offset:256
  v_add_f32 v235, v180, v235
  v_mfma_f32_16x16x32_bf16 v[148:151], a[208:211], v[200:203], v[148:151]
  v_exp_f32 v182, v182
  v_mfma_f32_16x16x32_bf16 v[152:155], a[208:211], v[208:211], v[152:155]
  s_waitcnt lgkmcnt(6)
  v_exp_f32 v183, v183
  v_mfma_f32_16x16x32_bf16 v[156:159], a[212:215], v[192:195], v[156:159]
  ds_read_b128 a[200:203], v228 offset:1024
  v_add_f32 v235, v181, v235
  v_mfma_f32_16x16x32_bf16 v[160:163], a[212:215], v[200:203], v[160:163]
  v_exp_f32 v188, v188
  v_mfma_f32_16x16x32_bf16 v[164:167], a[212:215], v[208:211], v[164:167]
  s_waitcnt lgkmcnt(5)
  v_exp_f32 v189, v189
  v_mfma_f32_16x16x32_bf16 a[224:227], a[216:219], v[192:195], a[224:227]
  ds_read_b128 a[204:207], v228 offset:1280
  v_cvt_pk_bf16_f32 v178, v180, v181
  v_mfma_f32_16x16x32_bf16 a[228:231], a[216:219], v[200:203], a[228:231]
  buffer_load_dwordx4 v232, s[16:19], s29 offen offset:3072 lds
  v_mfma_f32_16x16x32_bf16 a[232:235], a[216:219], v[208:211], a[232:235]
  s_waitcnt lgkmcnt(4)
  v_exp_f32 v190, v190
  v_mfma_f32_16x16x32_bf16 a[236:239], a[220:223], v[192:195], a[236:239]
  ds_read_b128 a[208:211], v228 offset:2048
  v_add_f32 v235, v182, v235
  v_mfma_f32_16x16x32_bf16 a[240:243], a[220:223], v[200:203], a[240:243]
  v_exp_f32 v191, v191
  v_mfma_f32_16x16x32_bf16 a[244:247], a[220:223], v[208:211], a[244:247]
  s_waitcnt lgkmcnt(4)
  v_add_f32 v235, v183, v235
  v_add_f32 v236, v188, v236
  v_mfma_f32_16x16x32_bf16 v[192:195], a[192:195], a[0:3], v[216:219]
  s_waitcnt vmcnt(26)
  ds_read_b128 a[212:215], v228 offset:2304
  v_cvt_pk_bf16_f32 v179, v182, v183
  v_mfma_f32_16x16x32_bf16 v[200:203], a[192:195], a[4:7], v[220:223]
  s_barrier
  v_add_f32 v236, v189, v236
  v_mfma_f32_16x16x32_bf16 v[208:211], a[192:195], a[8:11], v[224:227]
  s_waitcnt lgkmcnt(4)
  v_cvt_pk_bf16_f32 v186, v188, v189
  v_add_f32 v236, v190, v236
  v_mfma_f32_16x16x32_bf16 v[192:195], a[196:199], a[12:15], v[192:195]
  s_add_u32 m0, s28, 32768
  ds_read_b128 a[216:219], v228 offset:3072
  v_add_f32 v236, v191, v236
  v_mfma_f32_16x16x32_bf16 v[200:203], a[196:199], a[16:19], v[200:203]
  s_mov_b32 s29, 17536
  v_cvt_pk_bf16_f32 v187, v190, v191
  v_mfma_f32_16x16x32_bf16 v[208:211], a[196:199], a[20:23], v[208:211]
  s_waitcnt lgkmcnt(4)
  v_mfma_f32_16x16x32_bf16 v[192:195], a[200:203], a[24:27], v[192:195]
  ds_read_b128 a[220:223], v228 offset:3328
  v_mfma_f32_16x16x32_bf16 v[200:203], a[200:203], a[28:31], v[200:203]
  buffer_load_dwordx4 v233, s[4:7], s29 offen offset:0 lds
  v_mfma_f32_16x16x32_bf16 v[208:211], a[200:203], a[32:35], v[208:211]
  s_waitcnt lgkmcnt(4)
  v_mfma_f32_16x16x32_bf16 v[192:195], a[204:207], a[36:39], v[192:195]
  s_mov_b32 s29, 23680
  ds_read_b128 a[192:195], v228 offset:8192
  v_mfma_f32_16x16x32_bf16 v[200:203], a[204:207], a[40:43], v[200:203]
  v_mfma_f32_16x16x32_bf16 v[208:211], a[204:207], a[44:47], v[208:211]
  s_waitcnt lgkmcnt(4)
  v_mfma_f32_16x16x32_bf16 v[192:195], a[208:211], a[48:51], v[192:195]
  ds_read_b128 a[196:199], v228 offset:8448
  v_mfma_f32_16x16x32_bf16 v[200:203], a[208:211], a[52:55], v[200:203]
  v_mfma_f32_16x16x32_bf16 v[208:211], a[208:211], a[56:59], v[208:211]
  s_waitcnt lgkmcnt(4)
  v_mfma_f32_16x16x32_bf16 v[192:195], a[212:215], a[60:63], v[192:195]
  ds_read_b128 a[200:203], v228 offset:9216
  v_mfma_f32_16x16x32_bf16 v[200:203], a[212:215], a[64:67], v[200:203]
  v_mfma_f32_16x16x32_bf16 v[208:211], a[212:215], a[68:71], v[208:211]
  s_waitcnt lgkmcnt(4)
  v_mfma_f32_16x16x32_bf16 v[192:195], a[216:219], a[72:75], v[192:195]
  ds_read_b128 a[204:207], v228 offset:9472
  v_mfma_f32_16x16x32_bf16 v[200:203], a[216:219], a[76:79], v[200:203]
  buffer_load_dwordx4 v233, s[4:7], s29 offen offset:1024 lds
  v_mfma_f32_16x16x32_bf16 v[208:211], a[216:219], a[80:83], v[208:211]
  s_waitcnt lgkmcnt(4)
  v_mfma_f32_16x16x32_bf16 v[192:195], a[220:223], a[84:87], v[192:195]
  s_mov_b32 s29, 29824
  ds_read_b128 a[208:211], v228 offset:10240
  v_mfma_f32_16x16x32_bf16 v[200:203], a[220:223], a[88:91], v[200:203]
  v_mfma_f32_16x16x32_bf16 v[208:211], a[220:223], a[92:95], v[208:211]
  s_waitcnt lgkmcnt(4)
  v_mfma_f32_16x16x32_bf16 v[196:199], a[192:195], a[0:3], v[216:219]
  ds_read_b128 a[212:215], v228 offset:10496
  v_mfma_f32_16x16x32_bf16 v[204:207], a[192:195], a[4:7], v[220:223]
  v_exp_f32 v192, v192
  v_mfma_f32_16x16x32_bf16 v[212:215], a[192:195], a[8:11], v[224:227]
  s_waitcnt lgkmcnt(4)
  v_exp_f32 v193, v193
  v_mfma_f32_16x16x32_bf16 v[196:199], a[196:199], a[12:15], v[196:199]
  ds_read_b128 a[216:219], v228 offset:11264
  v_add_f32 v234, v192, v234
  v_mfma_f32_16x16x32_bf16 v[204:207], a[196:199], a[16:19], v[204:207]
  v_exp_f32 v194, v194
  v_mfma_f32_16x16x32_bf16 v[212:215], a[196:199], a[20:23], v[212:215]
  s_waitcnt lgkmcnt(4)
  v_exp_f32 v195, v195
  v_mfma_f32_16x16x32_bf16 v[196:199], a[200:203], a[24:27], v[196:199]
  ds_read_b128 a[220:223], v228 offset:11520
  v_add_u32 v228, 131072, v230
  v_mfma_f32_16x16x32_bf16 v[204:207], a[200:203], a[28:31], v[204:207]
  buffer_load_dwordx4 v233, s[4:7], s29 offen offset:2048 lds
  v_mfma_f32_16x16x32_bf16 v[212:215], a[200:203], a[32:35], v[212:215]
  s_waitcnt lgkmcnt(4)
  v_xor_b32 v239, 32, v228
  v_mfma_f32_16x16x32_bf16 v[196:199], a[204:207], a[36:39], v[196:199]
  s_mov_b32 s29, 35968
  ds_read_b64_tr_b16 a[192:193], v228 offset:0
  v_add_f32 v234, v193, v234
  v_mfma_f32_16x16x32_bf16 v[204:207], a[204:207], a[40:43], v[204:207]
  ds_read_b64_tr_b16 a[194:195], v228 offset:8192
  v_cvt_pk_bf16_f32 v192, v192, v193
  v_mfma_f32_16x16x32_bf16 v[212:215], a[204:207], a[44:47], v[212:215]
  s_waitcnt lgkmcnt(5)
  v_exp_f32 v200, v200
  v_mfma_f32_16x16x32_bf16 v[196:199], a[208:211], a[48:51], v[196:199]
  ds_read_b64_tr_b16 a[196:197], v239 offset:0
  v_add_f32 v234, v194, v234
  v_mfma_f32_16x16x32_bf16 v[204:207], a[208:211], a[52:55], v[204:207]
  ds_read_b64_tr_b16 a[198:199], v239 offset:8192
  v_add_f32 v234, v195, v234
  v_mfma_f32_16x16x32_bf16 v[212:215], a[208:211], a[56:59], v[212:215]
  s_waitcnt lgkmcnt(6)
  v_exp_f32 v201, v201
  v_mfma_f32_16x16x32_bf16 v[196:199], a[212:215], a[60:63], v[196:199]
  ds_read_b64_tr_b16 a[200:201], v228 offset:256
  v_cvt_pk_bf16_f32 v193, v194, v195
  v_mfma_f32_16x16x32_bf16 v[204:207], a[212:215], a[64:67], v[204:207]
  ds_read_b64_tr_b16 a[202:203], v228 offset:8448
  v_add_f32 v235, v200, v235
  v_mfma_f32_16x16x32_bf16 v[212:215], a[212:215], a[68:71], v[212:215]
  s_waitcnt lgkmcnt(7)
  v_exp_f32 v202, v202
  v_mfma_f32_16x16x32_bf16 v[196:199], a[216:219], a[72:75], v[196:199]
  ds_read_b64_tr_b16 a[204:205], v239 offset:256
  v_add_f32 v235, v201, v235
  v_mfma_f32_16x16x32_bf16 v[204:207], a[216:219], a[76:79], v[204:207]
  buffer_load_dwordx4 v233, s[4:7], s29 offen offset:3072 lds
  v_mfma_f32_16x16x32_bf16 v[212:215], a[216:219], a[80:83], v[212:215]
  s_waitcnt lgkmcnt(7)
  ds_read_b64_tr_b16 a[206:207], v239 offset:8448
  v_cvt_pk_bf16_f32 v200, v200, v201
  v_mfma_f32_16x16x32_bf16 v[196:199], a[220:223], a[84:87], v[196:199]
  ds_read_b64_tr_b16 a[208:209], v228 offset:1024
  v_add_f32 v235, v202, v235
  v_mfma_f32_16x16x32_bf16 v[204:207], a[220:223], a[88:91], v[204:207]
  ds_read_b64_tr_b16 a[210:211], v228 offset:9216
  v_mfma_f32_16x16x32_bf16 v[212:215], a[220:223], a[92:95], v[212:215]
  s_waitcnt lgkmcnt(8)
  v_exp_f32 v203, v203
  v_mfma_f32_16x16x32_bf16 v[0:3], a[192:195], v[168:171], v[0:3]
  ds_read_b64_tr_b16 a[212:213], v239 offset:1024
  v_add_f32 v235, v203, v235
  v_mfma_f32_16x16x32_bf16 v[4:7], a[192:195], v[176:179], v[4:7]
  ds_read_b64_tr_b16 a[214:215], v239 offset:9216
  v_cvt_pk_bf16_f32 v201, v202, v203
  v_mfma_f32_16x16x32_bf16 v[8:11], a[192:195], v[184:187], v[8:11]
  s_waitcnt lgkmcnt(8)
  v_exp_f32 v208, v208
  v_mfma_f32_16x16x32_bf16 v[12:15], a[196:199], v[168:171], v[12:15]
  ds_read_b64_tr_b16 a[216:217], v228 offset:1280
  v_add_f32 v236, v208, v236
  v_mfma_f32_16x16x32_bf16 v[16:19], a[196:199], v[176:179], v[16:19]
  ds_read_b64_tr_b16 a[218:219], v228 offset:9472
  v_mfma_f32_16x16x32_bf16 v[20:23], a[196:199], v[184:187], v[20:23]
  s_waitcnt lgkmcnt(8)
  v_exp_f32 v209, v209
  v_mfma_f32_16x16x32_bf16 v[24:27], a[200:203], v[168:171], v[24:27]
  ds_read_b64_tr_b16 a[220:221], v239 offset:1280
  v_add_f32 v236, v209, v236
  v_mfma_f32_16x16x32_bf16 v[28:31], a[200:203], v[176:179], v[28:31]
  ds_read_b64_tr_b16 a[222:223], v239 offset:9472
  v_cvt_pk_bf16_f32 v208, v208, v209
  v_mfma_f32_16x16x32_bf16 v[32:35], a[200:203], v[184:187], v[32:35]
  s_waitcnt lgkmcnt(8)
  v_exp_f32 v210, v210
  v_mfma_f32_16x16x32_bf16 v[36:39], a[204:207], v[168:171], v[36:39]
  ds_read_b64_tr_b16 a[192:193], v228 offset:2048
  v_add_f32 v236, v210, v236
  v_mfma_f32_16x16x32_bf16 v[40:43], a[204:207], v[176:179], v[40:43]
  ds_read_b64_tr_b16 a[194:195], v228 offset:10240
  v_mfma_f32_16x16x32_bf16 v[44:47], a[204:207], v[184:187], v[44:47]
  s_waitcnt lgkmcnt(8)
  v_exp_f32 v211, v211
  v_mfma_f32_16x16x32_bf16 v[48:51], a[208:211], v[168:171], v[48:51]
  ds_read_b64_tr_b16 a[196:197], v239 offset:2048
  v_add_f32 v236, v211, v236
  v_mfma_f32_16x16x32_bf16 v[52:55], a[208:211], v[176:179], v[52:55]
  ds_read_b64_tr_b16 a[198:199], v239 offset:10240
  v_cvt_pk_bf16_f32 v209, v210, v211
  v_mfma_f32_16x16x32_bf16 v[56:59], a[208:211], v[184:187], v[56:59]
  s_waitcnt lgkmcnt(8)
  v_exp_f32 v196, v196
  v_mfma_f32_16x16x32_bf16 v[60:63], a[212:215], v[168:171], v[60:63]
  ds_read_b64_tr_b16 a[200:201], v228 offset:2304
  v_add_f32 v234, v196, v234
  v_mfma_f32_16x16x32_bf16 v[64:67], a[212:215], v[176:179], v[64:67]
  ds_read_b64_tr_b16 a[202:203], v228 offset:10496
  v_mfma_f32_16x16x32_bf16 v[68:71], a[212:215], v[184:187], v[68:71]
  s_waitcnt lgkmcnt(8)
  v_exp_f32 v197, v197
  v_mfma_f32_16x16x32_bf16 v[72:75], a[216:219], v[168:171], v[72:75]
  ds_read_b64_tr_b16 a[204:205], v239 offset:2304
  v_add_f32 v234, v197, v234
  v_mfma_f32_16x16x32_bf16 v[76:79], a[216:219], v[176:179], v[76:79]
  ds_read_b64_tr_b16 a[206:207], v239 offset:10496
  v_cvt_pk_bf16_f32 v194, v196, v197
  v_mfma_f32_16x16x32_bf16 v[80:83], a[216:219], v[184:187], v[80:83]
  s_waitcnt lgkmcnt(8)
  v_exp_f32 v198, v198
  v_mfma_f32_16x16x32_bf16 v[84:87], a[220:223], v[168:171], v[84:87]
  ds_read_b64_tr_b16 a[208:209], v228 offset:3072
  v_add_f32 v234, v198, v234
  v_mfma_f32_16x16x32_bf16 v[88:91], a[220:223], v[176:179], v[88:91]
  ds_read_b64_tr_b16 a[210:211], v228 offset:11264
  v_mfma_f32_16x16x32_bf16 v[92:95], a[220:223], v[184:187], v[92:95]
  s_waitcnt lgkmcnt(8)
  v_exp_f32 v199, v199
  v_mfma_f32_16x16x32_bf16 v[96:99], a[192:195], v[168:171], v[96:99]
  ds_read_b64_tr_b16 a[212:213], v239 offset:3072
  v_add_f32 v234, v199, v234
  v_mfma_f32_16x16x32_bf16 v[100:103], a[192:195], v[176:179], v[100:103]
  ds_read_b64_tr_b16 a[214:215], v239 offset:11264
  v_cvt_pk_bf16_f32 v195, v198, v199
  v_mfma_f32_16x16x32_bf16 v[104:107], a[192:195], v[184:187], v[104:107]
  s_waitcnt lgkmcnt(8)
  v_exp_f32 v204, v204
  v_mfma_f32_16x16x32_bf16 v[108:111], a[196:199], v[168:171], v[108:111]
  s_waitcnt vmcnt(25)
  ds_read_b64_tr_b16 a[216:217], v228 offset:3328
  v_add_f32 v235, v204, v235
  v_mfma_f32_16x16x32_bf16 v[112:115], a[196:199], v[176:179], v[112:115]
  s_barrier
  ds_read_b64_tr_b16 a[218:219], v228 offset:11520
  v_mfma_f32_16x16x32_bf16 v[116:119], a[196:199], v[184:187], v[116:119]
  s_waitcnt lgkmcnt(8)
  v_exp_f32 v205, v205
  v_mfma_f32_16x16x32_bf16 v[120:123], a[200:203], v[168:171], v[120:123]
  ds_read_b64_tr_b16 a[220:221], v239 offset:3328
  v_add_f32 v235, v205, v235
  v_mfma_f32_16x16x32_bf16 v[124:127], a[200:203], v[176:179], v[124:127]
  ds_read_b64_tr_b16 a[222:223], v239 offset:11520
  v_add_u32 v228, 147456, v229
  v_mfma_f32_16x16x32_bf16 v[128:131], a[200:203], v[184:187], v[128:131]
  s_waitcnt lgkmcnt(8)
  v_exp_f32 v206, v206
  v_mfma_f32_16x16x32_bf16 v[132:135], a[204:207], v[168:171], v[132:135]
  ds_read_b128 a[192:195], v228 offset:0
  v_cvt_pk_bf16_f32 v202, v204, v205
  v_mfma_f32_16x16x32_bf16 v[136:139], a[204:207], v[176:179], v[136:139]
  v_exp_f32 v207, v207
  v_mfma_f32_16x16x32_bf16 v[140:143], a[204:207], v[184:187], v[140:143]
  s_waitcnt lgkmcnt(7)
  v_exp_f32 v212, v212
  v_mfma_f32_16x16x32_bf16 v[144:147], a[208:211], v[168:171], v[144:147]
  ds_read_b128 a[196:199], v228 offset:256
  v_add_f32 v235, v206, v235
  v_mfma_f32_16x16x32_bf16 v[148:151], a[208:211], v[176:179], v[148:151]
  v_exp_f32 v213, v213
  v_mfma_f32_16x16x32_bf16 v[152:155], a[208:211], v[184:187], v[152:155]
  s_waitcnt lgkmcnt(6)
  v_exp_f32 v214, v214
  v_mfma_f32_16x16x32_bf16 v[156:159], a[212:215], v[168:171], v[156:159]
  ds_read_b128 a[200:203], v228 offset:1024
  v_add_f32 v235, v207, v235
  v_mfma_f32_16x16x32_bf16 v[160:163], a[212:215], v[176:179], v[160:163]
  v_exp_f32 v215, v215
  v_mfma_f32_16x16x32_bf16 v[164:167], a[212:215], v[184:187], v[164:167]
  s_waitcnt lgkmcnt(5)
  v_cvt_pk_bf16_f32 v203, v206, v207
  v_add_f32 v236, v212, v236
  v_mfma_f32_16x16x32_bf16 a[224:227], a[216:219], v[168:171], a[224:227]
  ds_read_b128 a[204:207], v228 offset:1280
  v_add_f32 v236, v213, v236
  v_mfma_f32_16x16x32_bf16 a[228:231], a[216:219], v[176:179], a[228:231]
  v_cvt_pk_bf16_f32 v210, v212, v213
  v_add_f32 v236, v214, v236
  v_mfma_f32_16x16x32_bf16 a[232:235], a[216:219], v[184:187], a[232:235]
  s_waitcnt lgkmcnt(4)
  v_add_f32 v236, v215, v236
  v_mfma_f32_16x16x32_bf16 a[236:239], a[220:223], v[168:171], a[236:239]
  ds_read_b128 a[208:211], v228 offset:2048
  v_cvt_pk_bf16_f32 v211, v214, v215
  v_mfma_f32_16x16x32_bf16 a[240:243], a[220:223], v[176:179], a[240:243]
  v_mfma_f32_16x16x32_bf16 a[244:247], a[220:223], v[184:187], a[244:247]
  s_waitcnt lgkmcnt(4)
  v_mfma_f32_16x16x32_bf16 v[168:171], a[192:195], a[0:3], v[216:219]
  s_add_u32 m0, s28, 49152
  ds_read_b128 a[212:215], v228 offset:2304
  v_mfma_f32_16x16x32_bf16 v[176:179], a[192:195], a[4:7], v[220:223]
  s_mov_b32 s29, 84992
  v_mfma_f32_16x16x32_bf16 v[184:187], a[192:195], a[8:11], v[224:227]
  s_waitcnt lgkmcnt(4)
  v_mfma_f32_16x16x32_bf16 v[168:171], a[196:199], a[12:15], v[168:171]
  ds_read_b128 a[216:219], v228 offset:3072
  v_mfma_f32_16x16x32_bf16 v[176:179], a[196:199], a[16:19], v[176:179]
  v_mfma_f32_16x16x32_bf16 v[184:187], a[196:199], a[20:23], v[184:187]
  s_waitcnt lgkmcnt(4)
  v_mfma_f32_16x16x32_bf16 v[168:171], a[200:203], a[24:27], v[168:171]
  ds_read_b128 a[220:223], v228 offset:3328
  v_mfma_f32_16x16x32_bf16 v[176:179], a[200:203], a[28:31], v[176:179]
  buffer_load_dwordx4 v231, s[8:11], s29 offen offset:0 nt lds
  v_mfma_f32_16x16x32_bf16 v[184:187], a[200:203], a[32:35], v[184:187]
  s_waitcnt lgkmcnt(4)
  v_mfma_f32_16x16x32_bf16 v[168:171], a[204:207], a[36:39], v[168:171]
  s_add_u32 s29, s29, s30
  ds_read_b128 a[192:195], v228 offset:8192
  v_mfma_f32_16x16x32_bf16 v[176:179], a[204:207], a[40:43], v[176:179]
  v_mfma_f32_16x16x32_bf16 v[184:187], a[204:207], a[44:47], v[184:187]
  s_waitcnt lgkmcnt(4)
  v_mfma_f32_16x16x32_bf16 v[168:171], a[208:211], a[48:51], v[168:171]
  ds_read_b128 a[196:199], v228 offset:8448
  v_mfma_f32_16x16x32_bf16 v[176:179], a[208:211], a[52:55], v[176:179]
  buffer_load_dwordx4 v231, s[8:11], s29 offen offset:1024 nt lds
  v_mfma_f32_16x16x32_bf16 v[184:187], a[208:211], a[56:59], v[184:187]
  s_waitcnt lgkmcnt(4)
  v_mfma_f32_16x16x32_bf16 v[168:171], a[212:215], a[60:63], v[168:171]
  s_add_u32 s29, s29, s30
  ds_read_b128 a[200:203], v228 offset:9216
  v_mfma_f32_16x16x32_bf16 v[176:179], a[212:215], a[64:67], v[176:179]
  v_mfma_f32_16x16x32_bf16 v[184:187], a[212:215], a[68:71], v[184:187]
  s_waitcnt lgkmcnt(4)
  v_mfma_f32_16x16x32_bf16 v[168:171], a[216:219], a[72:75], v[168:171]
  ds_read_b128 a[204:207], v228 offset:9472
  v_mfma_f32_16x16x32_bf16 v[176:179], a[216:219], a[76:79], v[176:179]
  buffer_load_dwordx4 v231, s[8:11], s29 offen offset:2048 nt lds
  v_mfma_f32_16x16x32_bf16 v[184:187], a[216:219], a[80:83], v[184:187]
  s_waitcnt lgkmcnt(4)
  v_mfma_f32_16x16x32_bf16 v[168:171], a[220:223], a[84:87], v[168:171]
  s_add_u32 s29, s29, s30
  ds_read_b128 a[208:211], v228 offset:10240
  v_mfma_f32_16x16x32_bf16 v[176:179], a[220:223], a[88:91], v[176:179]
  v_mfma_f32_16x16x32_bf16 v[184:187], a[220:223], a[92:95], v[184:187]
  s_waitcnt lgkmcnt(4)
  v_mfma_f32_16x16x32_bf16 v[172:175], a[192:195], a[0:3], v[216:219]
  ds_read_b128 a[212:215], v228 offset:10496
  v_mfma_f32_16x16x32_bf16 v[180:183], a[192:195], a[4:7], v[220:223]
  buffer_load_dwordx4 v231, s[8:11], s29 offen offset:3072 nt lds
  v_mfma_f32_16x16x32_bf16 v[188:191], a[192:195], a[8:11], v[224:227]
  s_waitcnt lgkmcnt(4)
  v_exp_f32 v168, v168
  v_mfma_f32_16x16x32_bf16 v[172:175], a[196:199], a[12:15], v[172:175]
  s_waitcnt vmcnt(25)
  ds_read_b128 a[216:219], v228 offset:11264
  v_add_f32 v234, v168, v234
  v_mfma_f32_16x16x32_bf16 v[180:183], a[196:199], a[16:19], v[180:183]
  s_barrier
  v_exp_f32 v169, v169
  v_mfma_f32_16x16x32_bf16 v[188:191], a[196:199], a[20:23], v[188:191]
  s_waitcnt lgkmcnt(4)
  v_exp_f32 v170, v170
  v_mfma_f32_16x16x32_bf16 v[172:175], a[200:203], a[24:27], v[172:175]
  ds_read_b128 a[220:223], v228 offset:11520
  v_add_u32 v228, 0, v230
  v_mfma_f32_16x16x32_bf16 v[180:183], a[200:203], a[28:31], v[180:183]
  v_xor_b32 v239, 32, v228
  v_mfma_f32_16x16x32_bf16 v[188:191], a[200:203], a[32:35], v[188:191]
  s_waitcnt lgkmcnt(4)
  v_exp_f32 v171, v171
  v_mfma_f32_16x16x32_bf16 v[172:175], a[204:207], a[36:39], v[172:175]
  ds_read_b64_tr_b16 a[192:193], v228 offset:0
  v_add_f32 v234, v169, v234
  v_mfma_f32_16x16x32_bf16 v[180:183], a[204:207], a[40:43], v[180:183]
  ds_read_b64_tr_b16 a[194:195], v228 offset:8192
  v_cvt_pk_bf16_f32 v168, v168, v169
  v_mfma_f32_16x16x32_bf16 v[188:191], a[204:207], a[44:47], v[188:191]
  s_waitcnt lgkmcnt(5)
  v_exp_f32 v176, v176
  v_mfma_f32_16x16x32_bf16 v[172:175], a[208:211], a[48:51], v[172:175]
  ds_read_b64_tr_b16 a[196:197], v239 offset:0
  v_add_f32 v234, v170, v234
  v_mfma_f32_16x16x32_bf16 v[180:183], a[208:211], a[52:55], v[180:183]
  ds_read_b64_tr_b16 a[198:199], v239 offset:8192
  v_add_f32 v234, v171, v234
  v_mfma_f32_16x16x32_bf16 v[188:191], a[208:211], a[56:59], v[188:191]
  s_waitcnt lgkmcnt(6)
  v_exp_f32 v177, v177
  v_mfma_f32_16x16x32_bf16 v[172:175], a[212:215], a[60:63], v[172:175]
  ds_read_b64_tr_b16 a[200:201], v228 offset:256
  v_cvt_pk_bf16_f32 v169, v170, v171
  v_mfma_f32_16x16x32_bf16 v[180:183], a[212:215], a[64:67], v[180:183]
  ds_read_b64_tr_b16 a[202:203], v228 offset:8448
  v_add_f32 v235, v176, v235
  v_mfma_f32_16x16x32_bf16 v[188:191], a[212:215], a[68:71], v[188:191]
  s_waitcnt lgkmcnt(7)
  v_exp_f32 v178, v178
  v_mfma_f32_16x16x32_bf16 v[172:175], a[216:219], a[72:75], v[172:175]
  ds_read_b64_tr_b16 a[204:205], v239 offset:256
  v_add_f32 v235, v177, v235
  v_mfma_f32_16x16x32_bf16 v[180:183], a[216:219], a[76:79], v[180:183]
  ds_read_b64_tr_b16 a[206:207], v239 offset:8448
  v_cvt_pk_bf16_f32 v176, v176, v177
  v_mfma_f32_16x16x32_bf16 v[188:191], a[216:219], a[80:83], v[188:191]
  s_waitcnt lgkmcnt(8)
  v_exp_f32 v179, v179
  v_mfma_f32_16x16x32_bf16 v[172:175], a[220:223], a[84:87], v[172:175]
  ds_read_b64_tr_b16 a[208:209], v228 offset:1024
  v_add_f32 v235, v178, v235
  v_mfma_f32_16x16x32_bf16 v[180:183], a[220:223], a[88:91], v[180:183]
  ds_read_b64_tr_b16 a[210:211], v228 offset:9216
  v_add_f32 v235, v179, v235
  v_mfma_f32_16x16x32_bf16 v[188:191], a[220:223], a[92:95], v[188:191]
  s_waitcnt lgkmcnt(8)
  v_exp_f32 v184, v184
  v_mfma_f32_16x16x32_bf16 v[0:3], a[192:195], v[192:195], v[0:3]
  s_add_u32 m0, s28, 81920
  ds_read_b64_tr_b16 a[212:213], v239 offset:1024
  v_cvt_pk_bf16_f32 v177, v178, v179
  v_mfma_f32_16x16x32_bf16 v[4:7], a[192:195], v[200:203], v[4:7]
  s_mov_b32 s29, 68608
  ds_read_b64_tr_b16 a[214:215], v239 offset:9216
  v_add_f32 v236, v184, v236
  v_mfma_f32_16x16x32_bf16 v[8:11], a[192:195], v[208:211], v[8:11]
  s_waitcnt lgkmcnt(8)
  v_exp_f32 v185, v185
  v_mfma_f32_16x16x32_bf16 v[12:15], a[196:199], v[192:195], v[12:15]
  ds_read_b64_tr_b16 a[216:217], v228 offset:1280
  v_add_f32 v236, v185, v236
  v_mfma_f32_16x16x32_bf16 v[16:19], a[196:199], v[200:203], v[16:19]
  ds_read_b64_tr_b16 a[218:219], v228 offset:9472
  v_cvt_pk_bf16_f32 v184, v184, v185
  v_mfma_f32_16x16x32_bf16 v[20:23], a[196:199], v[208:211], v[20:23]
  s_waitcnt lgkmcnt(8)
  v_exp_f32 v186, v186
  v_mfma_f32_16x16x32_bf16 v[24:27], a[200:203], v[192:195], v[24:27]
  ds_read_b64_tr_b16 a[220:221], v239 offset:1280
  v_add_f32 v236, v186, v236
  v_mfma_f32_16x16x32_bf16 v[28:31], a[200:203], v[200:203], v[28:31]
  buffer_load_dwordx4 v231, s[12:15], s29 offen offset:0 nt lds
  v_mfma_f32_16x16x32_bf16 v[32:35], a[200:203], v[208:211], v[32:35]
  s_waitcnt lgkmcnt(7)
  ds_read_b64_tr_b16 a[222:223], v239 offset:9472
  v_mfma_f32_16x16x32_bf16 v[36:39], a[204:207], v[192:195], v[36:39]
  s_add_u32 s29, s29, s30
  ds_read_b64_tr_b16 a[192:193], v228 offset:2048
  v_mfma_f32_16x16x32_bf16 v[40:43], a[204:207], v[200:203], v[40:43]
  ds_read_b64_tr_b16 a[194:195], v228 offset:10240
  v_mfma_f32_16x16x32_bf16 v[44:47], a[204:207], v[208:211], v[44:47]
  s_waitcnt lgkmcnt(8)
  v_exp_f32 v187, v187
  v_mfma_f32_16x16x32_bf16 v[48:51], a[208:211], v[192:195], v[48:51]
  ds_read_b64_tr_b16 a[196:197], v239 offset:2048
  v_add_f32 v236, v187, v236
  v_mfma_f32_16x16x32_bf16 v[52:55], a[208:211], v[200:203], v[52:55]
  buffer_load_dwordx4 v231, s[12:15], s29 offen offset:1024 nt lds
  v_mfma_f32_16x16x32_bf16 v[56:59], a[208:211], v[208:211], v[56:59]
  s_waitcnt lgkmcnt(7)
  ds_read_b64_tr_b16 a[198:199], v239 offset:10240
  v_cvt_pk_bf16_f32 v185, v186, v187
  v_mfma_f32_16x16x32_bf16 v[60:63], a[212:215], v[192:195], v[60:63]
  s_add_u32 s29, s29, s30
  ds_read_b64_tr_b16 a[200:201], v228 offset:2304
  v_mfma_f32_16x16x32_bf16 v[64:67], a[212:215], v[200:203], v[64:67]
  ds_read_b64_tr_b16 a[202:203], v228 offset:10496
  v_mfma_f32_16x16x32_bf16 v[68:71], a[212:215], v[208:211], v[68:71]
  s_waitcnt lgkmcnt(8)
  v_exp_f32 v172, v172
  v_mfma_f32_16x16x32_bf16 v[72:75], a[216:219], v[192:195], v[72:75]
  ds_read_b64_tr_b16 a[204:205], v239 offset:2304
  v_add_f32 v234, v172, v234
  v_mfma_f32_16x16x32_bf16 v[76:79], a[216:219], v[200:203], v[76:79]
  buffer_load_dwordx4 v231, s[12:15], s29 offen offset:2048 nt lds
  v_mfma_f32_16x16x32_bf16 v[80:83], a[216:219], v[208:211], v[80:83]
  s_waitcnt lgkmcnt(7)
  ds_read_b64_tr_b16 a[206:207], v239 offset:10496
  v_mfma_f32_16x16x32_bf16 v[84:87], a[220:223], v[192:195], v[84:87]
  s_add_u32 s29, s29, s30
  ds_read_b64_tr_b16 a[208:209], v228 offset:3072
  v_mfma_f32_16x16x32_bf16 v[88:91], a[220:223], v[200:203], v[88:91]
  ds_read_b64_tr_b16 a[210:211], v228 offset:11264
  v_mfma_f32_16x16x32_bf16 v[92:95], a[220:223], v[208:211], v[92:95]
  s_waitcnt lgkmcnt(8)
  v_exp_f32 v173, v173
  v_mfma_f32_16x16x32_bf16 v[96:99], a[192:195], v[192:195], v[96:99]
  ds_read_b64_tr_b16 a[212:213], v239 offset:3072
  v_add_f32 v234, v173, v234
  v_mfma_f32_16x16x32_bf16 v[100:103], a[192:195], v[200:203], v[100:103]
  buffer_load_dwordx4 v231, s[12:15], s29 offen offset:3072 nt lds
  v_mfma_f32_16x16x32_bf16 v[104:107], a[192:195], v[208:211], v[104:107]
  s_waitcnt lgkmcnt(7)
  ds_read_b64_tr_b16 a[214:215], v239 offset:11264
  v_cvt_pk_bf16_f32 v170, v172, v173
  v_mfma_f32_16x16x32_bf16 v[108:111], a[196:199], v[192:195], v[108:111]
  s_waitcnt vmcnt(4)
  ds_read_b64_tr_b16 a[216:217], v228 offset:3328
  v_mfma_f32_16x16x32_bf16 v[112:115], a[196:199], v[200:203], v[112:115]
  s_barrier
  ds_read_b64_tr_b16 a[218:219], v228 offset:11520
  v_mfma_f32_16x16x32_bf16 v[116:119], a[196:199], v[208:211], v[116:119]
  s_waitcnt lgkmcnt(8)
  v_exp_f32 v174, v174
  v_mfma_f32_16x16x32_bf16 v[120:123], a[200:203], v[192:195], v[120:123]
  ds_read_b64_tr_b16 a[220:221], v239 offset:3328
  v_add_f32 v234, v174, v234
  v_mfma_f32_16x16x32_bf16 v[124:127], a[200:203], v[200:203], v[124:127]
  ds_read_b64_tr_b16 a[222:223], v239 offset:11520
  v_add_u32 v228, 49152, v229
  v_mfma_f32_16x16x32_bf16 v[128:131], a[200:203], v[208:211], v[128:131]
  s_waitcnt lgkmcnt(8)
  v_exp_f32 v175, v175
  v_mfma_f32_16x16x32_bf16 v[132:135], a[204:207], v[192:195], v[132:135]
  ds_read_b128 a[192:195], v228 offset:0
  v_add_f32 v234, v175, v234
  v_mfma_f32_16x16x32_bf16 v[136:139], a[204:207], v[200:203], v[136:139]
  v_exp_f32 v180, v180
  v_mfma_f32_16x16x32_bf16 v[140:143], a[204:207], v[208:211], v[140:143]
  s_waitcnt lgkmcnt(7)
  v_exp_f32 v181, v181
  v_mfma_f32_16x16x32_bf16 v[144:147], a[208:211], v[192:195], v[144:147]
  ds_read_b128 a[196:199], v228 offset:256
  v_cvt_pk_bf16_f32 v171, v174, v175
  v_mfma_f32_16x16x32_bf16 v[148:151], a[208:211], v[200:203], v[148:151]
  v_exp_f32 v182, v182
  v_mfma_f32_16x16x32_bf16 v[152:155], a[208:211], v[208:211], v[152:155]
  s_waitcnt lgkmcnt(6)
  v_exp_f32 v183, v183
  v_mfma_f32_16x16x32_bf16 v[156:159], a[212:215], v[192:195], v[156:159]
  ds_read_b128 a[200:203], v228 offset:1024
  v_add_f32 v235, v180, v235
  v_mfma_f32_16x16x32_bf16 v[160:163], a[212:215], v[200:203], v[160:163]
  v_exp_f32 v188, v188
  v_mfma_f32_16x16x32_bf16 v[164:167], a[212:215], v[208:211], v[164:167]
  s_waitcnt lgkmcnt(5)
  v_exp_f32 v189, v189
  v_mfma_f32_16x16x32_bf16 a[224:227], a[216:219], v[192:195], a[224:227]
  ds_read_b128 a[204:207], v228 offset:1280
  v_add_f32 v235, v181, v235
  v_mfma_f32_16x16x32_bf16 a[228:231], a[216:219], v[200:203], a[228:231]
  v_exp_f32 v190, v190
  v_mfma_f32_16x16x32_bf16 a[232:235], a[216:219], v[208:211], a[232:235]
  s_waitcnt lgkmcnt(4)
  v_exp_f32 v191, v191
  v_mfma_f32_16x16x32_bf16 a[236:239], a[220:223], v[192:195], a[236:239]
  ds_read_b128 a[208:211], v228 offset:2048
  v_cvt_pk_bf16_f32 v178, v180, v181
  v_mfma_f32_16x16x32_bf16 a[240:243], a[220:223], v[200:203], a[240:243]
  v_add_f32 v235, v182, v235
  v_add_f32 v236, v188, v236
  v_mfma_f32_16x16x32_bf16 a[244:247], a[220:223], v[208:211], a[244:247]
  s_waitcnt lgkmcnt(4)
  v_add_f32 v235, v183, v235
  v_add_f32 v236, v189, v236
  v_mfma_f32_16x16x32_bf16 v[192:195], a[192:195], a[0:3], v[216:219]
  s_add_u32 m0, s28, 131072
  ds_read_b128 a[212:215], v228 offset:2304
  v_cvt_pk_bf16_f32 v179, v182, v183
  v_mfma_f32_16x16x32_bf16 v[200:203], a[192:195], a[4:7], v[220:223]
  s_mov_b32 s29, 101376
  v_cvt_pk_bf16_f32 v186, v188, v189
  v_add_f32 v236, v190, v236
  v_mfma_f32_16x16x32_bf16 v[208:211], a[192:195], a[8:11], v[224:227]
  s_waitcnt lgkmcnt(4)
  v_add_f32 v236, v191, v236
  v_mfma_f32_16x16x32_bf16 v[192:195], a[196:199], a[12:15], v[192:195]
  ds_read_b128 a[216:219], v228 offset:3072
  v_cvt_pk_bf16_f32 v187, v190, v191
  v_mfma_f32_16x16x32_bf16 v[200:203], a[196:199], a[16:19], v[200:203]
  v_mfma_f32_16x16x32_bf16 v[208:211], a[196:199], a[20:23], v[208:211]
  s_waitcnt lgkmcnt(4)
  v_mfma_f32_16x16x32_bf16 v[192:195], a[200:203], a[24:27], v[192:195]
  ds_read_b128 a[220:223], v228 offset:3328
  v_mfma_f32_16x16x32_bf16 v[200:203], a[200:203], a[28:31], v[200:203]
  buffer_load_dwordx4 v231, s[8:11], s29 offen offset:0 nt lds
  v_mfma_f32_16x16x32_bf16 v[208:211], a[200:203], a[32:35], v[208:211]
  s_waitcnt lgkmcnt(4)
  v_mfma_f32_16x16x32_bf16 v[192:195], a[204:207], a[36:39], v[192:195]
  s_add_u32 s29, s29, s30
  ds_read_b128 a[192:195], v228 offset:8192
  v_mfma_f32_16x16x32_bf16 v[200:203], a[204:207], a[40:43], v[200:203]
  v_mfma_f32_16x16x32_bf16 v[208:211], a[204:207], a[44:47], v[208:211]
  s_waitcnt lgkmcnt(4)
  v_mfma_f32_16x16x32_bf16 v[192:195], a[208:211], a[48:51], v[192:195]
  ds_read_b128 a[196:199], v228 offset:8448
  v_mfma_f32_16x16x32_bf16 v[200:203], a[208:211], a[52:55], v[200:203]
  buffer_load_dwordx4 v231, s[8:11], s29 offen offset:1024 nt lds
  v_mfma_f32_16x16x32_bf16 v[208:211], a[208:211], a[56:59], v[208:211]
  s_waitcnt lgkmcnt(4)
  v_mfma_f32_16x16x32_bf16 v[192:195], a[212:215], a[60:63], v[192:195]
  s_add_u32 s29, s29, s30
  ds_read_b128 a[200:203], v228 offset:9216
  v_mfma_f32_16x16x32_bf16 v[200:203], a[212:215], a[64:67], v[200:203]
  v_mfma_f32_16x16x32_bf16 v[208:211], a[212:215], a[68:71], v[208:211]
  s_waitcnt lgkmcnt(4)
  v_mfma_f32_16x16x32_bf16 v[192:195], a[216:219], a[72:75], v[192:195]
  ds_read_b128 a[204:207], v228 offset:9472
  v_mfma_f32_16x16x32_bf16 v[200:203], a[216:219], a[76:79], v[200:203]
  buffer_load_dwordx4 v231, s[8:11], s29 offen offset:2048 nt lds
  v_mfma_f32_16x16x32_bf16 v[208:211], a[216:219], a[80:83], v[208:211]
  s_waitcnt lgkmcnt(4)
  v_mfma_f32_16x16x32_bf16 v[192:195], a[220:223], a[84:87], v[192:195]
  s_add_u32 s29, s29, s30
  ds_read_b128 a[208:211], v228 offset:10240
  v_mfma_f32_16x16x32_bf16 v[200:203], a[220:223], a[88:91], v[200:203]
  v_mfma_f32_16x16x32_bf16 v[208:211], a[220:223], a[92:95], v[208:211]
  s_waitcnt lgkmcnt(4)
  v_mfma_f32_16x16x32_bf16 v[196:199], a[192:195], a[0:3], v[216:219]
  ds_read_b128 a[212:215], v228 offset:10496
  v_mfma_f32_16x16x32_bf16 v[204:207], a[192:195], a[4:7], v[220:223]
  buffer_load_dwordx4 v231, s[8:11], s29 offen offset:3072 nt lds
  v_mfma_f32_16x16x32_bf16 v[212:215], a[192:195], a[8:11], v[224:227]
  s_waitcnt lgkmcnt(4)
  v_exp_f32 v192, v192
  v_mfma_f32_16x16x32_bf16 v[196:199], a[196:199], a[12:15], v[196:199]
  s_waitcnt vmcnt(4)
  ds_read_b128 a[216:219], v228 offset:11264
  v_add_f32 v234, v192, v234
  v_mfma_f32_16x16x32_bf16 v[204:207], a[196:199], a[16:19], v[204:207]
  s_barrier
  v_exp_f32 v193, v193
  v_mfma_f32_16x16x32_bf16 v[212:215], a[196:199], a[20:23], v[212:215]
  s_waitcnt lgkmcnt(4)
  v_exp_f32 v194, v194
  v_mfma_f32_16x16x32_bf16 v[196:199], a[200:203], a[24:27], v[196:199]
  ds_read_b128 a[220:223], v228 offset:11520
  v_add_u32 v228, 81920, v230
  v_mfma_f32_16x16x32_bf16 v[204:207], a[200:203], a[28:31], v[204:207]
  v_xor_b32 v239, 32, v228
  v_mfma_f32_16x16x32_bf16 v[212:215], a[200:203], a[32:35], v[212:215]
  s_waitcnt lgkmcnt(4)
  v_exp_f32 v195, v195
  v_mfma_f32_16x16x32_bf16 v[196:199], a[204:207], a[36:39], v[196:199]
  ds_read_b64_tr_b16 a[192:193], v228 offset:0
  v_add_f32 v234, v193, v234
  v_mfma_f32_16x16x32_bf16 v[204:207], a[204:207], a[40:43], v[204:207]
  ds_read_b64_tr_b16 a[194:195], v228 offset:8192
  v_cvt_pk_bf16_f32 v192, v192, v193
  v_mfma_f32_16x16x32_bf16 v[212:215], a[204:207], a[44:47], v[212:215]
  s_waitcnt lgkmcnt(5)
  v_exp_f32 v200, v200
  v_mfma_f32_16x16x32_bf16 v[196:199], a[208:211], a[48:51], v[196:199]
  ds_read_b64_tr_b16 a[196:197], v239 offset:0
  v_add_f32 v234, v194, v234
  v_mfma_f32_16x16x32_bf16 v[204:207], a[208:211], a[52:55], v[204:207]
  ds_read_b64_tr_b16 a[198:199], v239 offset:8192
  v_add_f32 v234, v195, v234
  v_mfma_f32_16x16x32_bf16 v[212:215], a[208:211], a[56:59], v[212:215]
  s_waitcnt lgkmcnt(6)
  v_exp_f32 v201, v201
  v_mfma_f32_16x16x32_bf16 v[196:199], a[212:215], a[60:63], v[196:199]
  ds_read_b64_tr_b16 a[200:201], v228 offset:256
  v_cvt_pk_bf16_f32 v193, v194, v195
  v_mfma_f32_16x16x32_bf16 v[204:207], a[212:215], a[64:67], v[204:207]
  ds_read_b64_tr_b16 a[202:203], v228 offset:8448
  v_add_f32 v235, v200, v235
  v_mfma_f32_16x16x32_bf16 v[212:215], a[212:215], a[68:71], v[212:215]
  s_waitcnt lgkmcnt(7)
  v_exp_f32 v202, v202
  v_mfma_f32_16x16x32_bf16 v[196:199], a[216:219], a[72:75], v[196:199]
  ds_read_b64_tr_b16 a[204:205], v239 offset:256
  v_add_f32 v235, v201, v235
  v_mfma_f32_16x16x32_bf16 v[204:207], a[216:219], a[76:79], v[204:207]
  ds_read_b64_tr_b16 a[206:207], v239 offset:8448
  v_cvt_pk_bf16_f32 v200, v200, v201
  v_mfma_f32_16x16x32_bf16 v[212:215], a[216:219], a[80:83], v[212:215]
  s_waitcnt lgkmcnt(8)
  v_exp_f32 v203, v203
  v_mfma_f32_16x16x32_bf16 v[196:199], a[220:223], a[84:87], v[196:199]
  ds_read_b64_tr_b16 a[208:209], v228 offset:1024
  v_add_f32 v235, v202, v235
  v_mfma_f32_16x16x32_bf16 v[204:207], a[220:223], a[88:91], v[204:207]
  ds_read_b64_tr_b16 a[210:211], v228 offset:9216
  v_add_f32 v235, v203, v235
  v_mfma_f32_16x16x32_bf16 v[212:215], a[220:223], a[92:95], v[212:215]
  s_waitcnt lgkmcnt(8)
  v_exp_f32 v208, v208
  v_mfma_f32_16x16x32_bf16 v[0:3], a[192:195], v[168:171], v[0:3]
  s_add_u32 m0, s28, 147456
  ds_read_b64_tr_b16 a[212:213], v239 offset:1024
  v_cvt_pk_bf16_f32 v201, v202, v203
  v_mfma_f32_16x16x32_bf16 v[4:7], a[192:195], v[176:179], v[4:7]
  s_mov_b32 s29, 84992
  ds_read_b64_tr_b16 a[214:215], v239 offset:9216
  v_add_f32 v236, v208, v236
  v_mfma_f32_16x16x32_bf16 v[8:11], a[192:195], v[184:187], v[8:11]
  s_waitcnt lgkmcnt(8)
  v_exp_f32 v209, v209
  v_mfma_f32_16x16x32_bf16 v[12:15], a[196:199], v[168:171], v[12:15]
  ds_read_b64_tr_b16 a[216:217], v228 offset:1280
  v_add_f32 v236, v209, v236
  v_mfma_f32_16x16x32_bf16 v[16:19], a[196:199], v[176:179], v[16:19]
  ds_read_b64_tr_b16 a[218:219], v228 offset:9472
  v_cvt_pk_bf16_f32 v208, v208, v209
  v_mfma_f32_16x16x32_bf16 v[20:23], a[196:199], v[184:187], v[20:23]
  s_waitcnt lgkmcnt(8)
  v_exp_f32 v210, v210
  v_mfma_f32_16x16x32_bf16 v[24:27], a[200:203], v[168:171], v[24:27]
  ds_read_b64_tr_b16 a[220:221], v239 offset:1280
  v_add_f32 v236, v210, v236
  v_mfma_f32_16x16x32_bf16 v[28:31], a[200:203], v[176:179], v[28:31]
  buffer_load_dwordx4 v231, s[12:15], s29 offen offset:0 nt lds
  v_mfma_f32_16x16x32_bf16 v[32:35], a[200:203], v[184:187], v[32:35]
  s_waitcnt lgkmcnt(7)
  ds_read_b64_tr_b16 a[222:223], v239 offset:9472
  v_mfma_f32_16x16x32_bf16 v[36:39], a[204:207], v[168:171], v[36:39]
  s_add_u32 s29, s29, s30
  ds_read_b64_tr_b16 a[192:193], v228 offset:2048
  v_mfma_f32_16x16x32_bf16 v[40:43], a[204:207], v[176:179], v[40:43]
  ds_read_b64_tr_b16 a[194:195], v228 offset:10240
  v_mfma_f32_16x16x32_bf16 v[44:47], a[204:207], v[184:187], v[44:47]
  s_waitcnt lgkmcnt(8)
  v_exp_f32 v211, v211
  v_mfma_f32_16x16x32_bf16 v[48:51], a[208:211], v[168:171], v[48:51]
  ds_read_b64_tr_b16 a[196:197], v239 offset:2048
  v_add_f32 v236, v211, v236
  v_mfma_f32_16x16x32_bf16 v[52:55], a[208:211], v[176:179], v[52:55]
  buffer_load_dwordx4 v231, s[12:15], s29 offen offset:1024 nt lds
  v_mfma_f32_16x16x32_bf16 v[56:59], a[208:211], v[184:187], v[56:59]
  s_waitcnt lgkmcnt(7)
  ds_read_b64_tr_b16 a[198:199], v239 offset:10240
  v_cvt_pk_bf16_f32 v209, v210, v211
  v_mfma_f32_16x16x32_bf16 v[60:63], a[212:215], v[168:171], v[60:63]
  s_add_u32 s29, s29, s30
  ds_read_b64_tr_b16 a[200:201], v228 offset:2304
  v_mfma_f32_16x16x32_bf16 v[64:67], a[212:215], v[176:179], v[64:67]
  ds_read_b64_tr_b16 a[202:203], v228 offset:10496
  v_mfma_f32_16x16x32_bf16 v[68:71], a[212:215], v[184:187], v[68:71]
  s_waitcnt lgkmcnt(8)
  v_exp_f32 v196, v196
  v_mfma_f32_16x16x32_bf16 v[72:75], a[216:219], v[168:171], v[72:75]
  ds_read_b64_tr_b16 a[204:205], v239 offset:2304
  v_add_f32 v234, v196, v234
  v_mfma_f32_16x16x32_bf16 v[76:79], a[216:219], v[176:179], v[76:79]
  buffer_load_dwordx4 v231, s[12:15], s29 offen offset:2048 nt lds
  v_mfma_f32_16x16x32_bf16 v[80:83], a[216:219], v[184:187], v[80:83]
  s_waitcnt lgkmcnt(7)
  ds_read_b64_tr_b16 a[206:207], v239 offset:10496
  v_mfma_f32_16x16x32_bf16 v[84:87], a[220:223], v[168:171], v[84:87]
  s_add_u32 s29, s29, s30
  ds_read_b64_tr_b16 a[208:209], v228 offset:3072
  v_mfma_f32_16x16x32_bf16 v[88:91], a[220:223], v[176:179], v[88:91]
  ds_read_b64_tr_b16 a[210:211], v228 offset:11264
  v_mfma_f32_16x16x32_bf16 v[92:95], a[220:223], v[184:187], v[92:95]
  s_waitcnt lgkmcnt(8)
  v_exp_f32 v197, v197
  v_mfma_f32_16x16x32_bf16 v[96:99], a[192:195], v[168:171], v[96:99]
  ds_read_b64_tr_b16 a[212:213], v239 offset:3072
  v_add_f32 v234, v197, v234
  v_mfma_f32_16x16x32_bf16 v[100:103], a[192:195], v[176:179], v[100:103]
  buffer_load_dwordx4 v231, s[12:15], s29 offen offset:3072 nt lds
  v_mfma_f32_16x16x32_bf16 v[104:107], a[192:195], v[184:187], v[104:107]
  s_waitcnt lgkmcnt(7)
  ds_read_b64_tr_b16 a[214:215], v239 offset:11264
  v_cvt_pk_bf16_f32 v194, v196, v197
  v_mfma_f32_16x16x32_bf16 v[108:111], a[196:199], v[168:171], v[108:111]
  s_waitcnt vmcnt(4)
  ds_read_b64_tr_b16 a[216:217], v228 offset:3328
  v_mfma_f32_16x16x32_bf16 v[112:115], a[196:199], v[176:179], v[112:115]
  s_barrier
  ds_read_b64_tr_b16 a[218:219], v228 offset:11520
  v_mfma_f32_16x16x32_bf16 v[116:119], a[196:199], v[184:187], v[116:119]
  s_waitcnt lgkmcnt(8)
  v_exp_f32 v198, v198
  v_mfma_f32_16x16x32_bf16 v[120:123], a[200:203], v[168:171], v[120:123]
  ds_read_b64_tr_b16 a[220:221], v239 offset:3328
  v_add_f32 v234, v198, v234
  v_mfma_f32_16x16x32_bf16 v[124:127], a[200:203], v[176:179], v[124:127]
  ds_read_b64_tr_b16 a[222:223], v239 offset:11520
  v_add_u32 v228, 131072, v229
  v_mfma_f32_16x16x32_bf16 v[128:131], a[200:203], v[184:187], v[128:131]
  s_waitcnt lgkmcnt(8)
  v_exp_f32 v199, v199
  v_mfma_f32_16x16x32_bf16 v[132:135], a[204:207], v[168:171], v[132:135]
  ds_read_b128 a[192:195], v228 offset:0
  v_add_f32 v234, v199, v234
  v_mfma_f32_16x16x32_bf16 v[136:139], a[204:207], v[176:179], v[136:139]
  v_exp_f32 v204, v204
  v_mfma_f32_16x16x32_bf16 v[140:143], a[204:207], v[184:187], v[140:143]
  s_waitcnt lgkmcnt(7)
  v_exp_f32 v205, v205
  v_mfma_f32_16x16x32_bf16 v[144:147], a[208:211], v[168:171], v[144:147]
  ds_read_b128 a[196:199], v228 offset:256
  v_cvt_pk_bf16_f32 v195, v198, v199
  v_mfma_f32_16x16x32_bf16 v[148:151], a[208:211], v[176:179], v[148:151]
  v_exp_f32 v206, v206
  v_mfma_f32_16x16x32_bf16 v[152:155], a[208:211], v[184:187], v[152:155]
  s_waitcnt lgkmcnt(6)
  v_exp_f32 v207, v207
  v_mfma_f32_16x16x32_bf16 v[156:159], a[212:215], v[168:171], v[156:159]
  ds_read_b128 a[200:203], v228 offset:1024
  v_add_f32 v235, v204, v235
  v_mfma_f32_16x16x32_bf16 v[160:163], a[212:215], v[176:179], v[160:163]
  v_exp_f32 v212, v212
  v_mfma_f32_16x16x32_bf16 v[164:167], a[212:215], v[184:187], v[164:167]
  s_waitcnt lgkmcnt(5)
  v_exp_f32 v213, v213
  v_mfma_f32_16x16x32_bf16 a[224:227], a[216:219], v[168:171], a[224:227]
  ds_read_b128 a[204:207], v228 offset:1280
  v_add_f32 v235, v205, v235
  v_mfma_f32_16x16x32_bf16 a[228:231], a[216:219], v[176:179], a[228:231]
  v_exp_f32 v214, v214
  v_mfma_f32_16x16x32_bf16 a[232:235], a[216:219], v[184:187], a[232:235]
  s_waitcnt lgkmcnt(4)
  v_exp_f32 v215, v215
  v_mfma_f32_16x16x32_bf16 a[236:239], a[220:223], v[168:171], a[236:239]
  ds_read_b128 a[208:211], v228 offset:2048
  v_cvt_pk_bf16_f32 v202, v204, v205
  v_mfma_f32_16x16x32_bf16 a[240:243], a[220:223], v[176:179], a[240:243]
  v_add_f32 v235, v206, v235
  v_add_f32 v236, v212, v236
  v_mfma_f32_16x16x32_bf16 a[244:247], a[220:223], v[184:187], a[244:247]
  s_waitcnt lgkmcnt(4)
  v_add_f32 v235, v207, v235
  v_add_f32 v236, v213, v236
  v_mfma_f32_16x16x32_bf16 v[168:171], a[192:195], a[0:3], v[216:219]
  s_add_u32 m0, s28, 0
  ds_read_b128 a[212:215], v228 offset:2304
  v_cvt_pk_bf16_f32 v203, v206, v207
  v_mfma_f32_16x16x32_bf16 v[176:179], a[192:195], a[4:7], v[220:223]
  s_mov_b32 s29, 117760
  v_cvt_pk_bf16_f32 v210, v212, v213
  v_add_f32 v236, v214, v236
  v_mfma_f32_16x16x32_bf16 v[184:187], a[192:195], a[8:11], v[224:227]
  s_waitcnt lgkmcnt(4)
  v_add_f32 v236, v215, v236
  v_mfma_f32_16x16x32_bf16 v[168:171], a[196:199], a[12:15], v[168:171]
  ds_read_b128 a[216:219], v228 offset:3072
  v_cvt_pk_bf16_f32 v211, v214, v215
  v_mfma_f32_16x16x32_bf16 v[176:179], a[196:199], a[16:19], v[176:179]
  v_mfma_f32_16x16x32_bf16 v[184:187], a[196:199], a[20:23], v[184:187]
  s_waitcnt lgkmcnt(4)
  v_mfma_f32_16x16x32_bf16 v[168:171], a[200:203], a[24:27], v[168:171]
  ds_read_b128 a[220:223], v228 offset:3328
  v_mfma_f32_16x16x32_bf16 v[176:179], a[200:203], a[28:31], v[176:179]
  buffer_load_dwordx4 v231, s[8:11], s29 offen offset:0 nt lds
  v_mfma_f32_16x16x32_bf16 v[184:187], a[200:203], a[32:35], v[184:187]
  s_waitcnt lgkmcnt(4)
  v_mfma_f32_16x16x32_bf16 v[168:171], a[204:207], a[36:39], v[168:171]
  s_add_u32 s29, s29, s30
  ds_read_b128 a[192:195], v228 offset:8192
  v_mfma_f32_16x16x32_bf16 v[176:179], a[204:207], a[40:43], v[176:179]
  v_mfma_f32_16x16x32_bf16 v[184:187], a[204:207], a[44:47], v[184:187]
  s_waitcnt lgkmcnt(4)
  v_mfma_f32_16x16x32_bf16 v[168:171], a[208:211], a[48:51], v[168:171]
  ds_read_b128 a[196:199], v228 offset:8448
  v_mfma_f32_16x16x32_bf16 v[176:179], a[208:211], a[52:55], v[176:179]
  buffer_load_dwordx4 v231, s[8:11], s29 offen offset:1024 nt lds
  v_mfma_f32_16x16x32_bf16 v[184:187], a[208:211], a[56:59], v[184:187]
  s_waitcnt lgkmcnt(4)
  v_mfma_f32_16x16x32_bf16 v[168:171], a[212:215], a[60:63], v[168:171]
  s_add_u32 s29, s29, s30
  ds_read_b128 a[200:203], v228 offset:9216
  v_mfma_f32_16x16x32_bf16 v[176:179], a[212:215], a[64:67], v[176:179]
  v_mfma_f32_16x16x32_bf16 v[184:187], a[212:215], a[68:71], v[184:187]
  s_waitcnt lgkmcnt(4)
  v_mfma_f32_16x16x32_bf16 v[168:171], a[216:219], a[72:75], v[168:171]
  ds_read_b128 a[204:207], v228 offset:9472
  v_mfma_f32_16x16x32_bf16 v[176:179], a[216:219], a[76:79], v[176:179]
  buffer_load_dwordx4 v231, s[8:11], s29 offen offset:2048 nt lds
  v_mfma_f32_16x16x32_bf16 v[184:187], a[216:219], a[80:83], v[184:187]
  s_waitcnt lgkmcnt(4)
  v_mfma_f32_16x16x32_bf16 v[168:171], a[220:223], a[84:87], v[168:171]
  s_add_u32 s29, s29, s30
  ds_read_b128 a[208:211], v228 offset:10240
  v_mfma_f32_16x16x32_bf16 v[176:179], a[220:223], a[88:91], v[176:179]
  v_mfma_f32_16x16x32_bf16 v[184:187], a[220:223], a[92:95], v[184:187]
  s_waitcnt lgkmcnt(4)
  v_mfma_f32_16x16x32_bf16 v[172:175], a[192:195], a[0:3], v[216:219]
  ds_read_b128 a[212:215], v228 offset:10496
  v_mfma_f32_16x16x32_bf16 v[180:183], a[192:195], a[4:7], v[220:223]
  buffer_load_dwordx4 v231, s[8:11], s29 offen offset:3072 nt lds
  v_mfma_f32_16x16x32_bf16 v[188:191], a[192:195], a[8:11], v[224:227]
  s_waitcnt lgkmcnt(4)
  v_exp_f32 v168, v168
  v_mfma_f32_16x16x32_bf16 v[172:175], a[196:199], a[12:15], v[172:175]
  s_waitcnt vmcnt(4)
  ds_read_b128 a[216:219], v228 offset:11264
  v_add_f32 v234, v168, v234
  v_mfma_f32_16x16x32_bf16 v[180:183], a[196:199], a[16:19], v[180:183]
  s_barrier
  v_exp_f32 v169, v169
  v_mfma_f32_16x16x32_bf16 v[188:191], a[196:199], a[20:23], v[188:191]
  s_waitcnt lgkmcnt(4)
  v_exp_f32 v170, v170
  v_mfma_f32_16x16x32_bf16 v[172:175], a[200:203], a[24:27], v[172:175]
  ds_read_b128 a[220:223], v228 offset:11520
  v_add_u32 v228, 147456, v230
  v_mfma_f32_16x16x32_bf16 v[180:183], a[200:203], a[28:31], v[180:183]
  v_xor_b32 v239, 32, v228
  v_mfma_f32_16x16x32_bf16 v[188:191], a[200:203], a[32:35], v[188:191]
  s_waitcnt lgkmcnt(4)
  v_exp_f32 v171, v171
  v_mfma_f32_16x16x32_bf16 v[172:175], a[204:207], a[36:39], v[172:175]
  ds_read_b64_tr_b16 a[192:193], v228 offset:0
  v_add_f32 v234, v169, v234
  v_mfma_f32_16x16x32_bf16 v[180:183], a[204:207], a[40:43], v[180:183]
  ds_read_b64_tr_b16 a[194:195], v228 offset:8192
  v_cvt_pk_bf16_f32 v168, v168, v169
  v_mfma_f32_16x16x32_bf16 v[188:191], a[204:207], a[44:47], v[188:191]
  s_waitcnt lgkmcnt(5)
  v_exp_f32 v176, v176
  v_mfma_f32_16x16x32_bf16 v[172:175], a[208:211], a[48:51], v[172:175]
  ds_read_b64_tr_b16 a[196:197], v239 offset:0
  v_add_f32 v234, v170, v234
  v_mfma_f32_16x16x32_bf16 v[180:183], a[208:211], a[52:55], v[180:183]
  ds_read_b64_tr_b16 a[198:199], v239 offset:8192
  v_add_f32 v234, v171, v234
  v_mfma_f32_16x16x32_bf16 v[188:191], a[208:211], a[56:59], v[188:191]
  s_waitcnt lgkmcnt(6)
  v_exp_f32 v177, v177
  v_mfma_f32_16x16x32_bf16 v[172:175], a[212:215], a[60:63], v[172:175]
  ds_read_b64_tr_b16 a[200:201], v228 offset:256
  v_cvt_pk_bf16_f32 v169, v170, v171
  v_mfma_f32_16x16x32_bf16 v[180:183], a[212:215], a[64:67], v[180:183]
  ds_read_b64_tr_b16 a[202:203], v228 offset:8448
  v_add_f32 v235, v176, v235
  v_mfma_f32_16x16x32_bf16 v[188:191], a[212:215], a[68:71], v[188:191]
  s_waitcnt lgkmcnt(7)
  v_exp_f32 v178, v178
  v_mfma_f32_16x16x32_bf16 v[172:175], a[216:219], a[72:75], v[172:175]
  ds_read_b64_tr_b16 a[204:205], v239 offset:256
  v_add_f32 v235, v177, v235
  v_mfma_f32_16x16x32_bf16 v[180:183], a[216:219], a[76:79], v[180:183]
  ds_read_b64_tr_b16 a[206:207], v239 offset:8448
  v_cvt_pk_bf16_f32 v176, v176, v177
  v_mfma_f32_16x16x32_bf16 v[188:191], a[216:219], a[80:83], v[188:191]
  s_waitcnt lgkmcnt(8)
  v_exp_f32 v179, v179
  v_mfma_f32_16x16x32_bf16 v[172:175], a[220:223], a[84:87], v[172:175]
  ds_read_b64_tr_b16 a[208:209], v228 offset:1024
  v_add_f32 v235, v178, v235
  v_mfma_f32_16x16x32_bf16 v[180:183], a[220:223], a[88:91], v[180:183]
  ds_read_b64_tr_b16 a[210:211], v228 offset:9216
  v_add_f32 v235, v179, v235
  v_mfma_f32_16x16x32_bf16 v[188:191], a[220:223], a[92:95], v[188:191]
  s_waitcnt lgkmcnt(8)
  v_exp_f32 v184, v184
  v_mfma_f32_16x16x32_bf16 v[0:3], a[192:195], v[192:195], v[0:3]
  s_add_u32 m0, s28, 49152
  ds_read_b64_tr_b16 a[212:213], v239 offset:1024
  v_cvt_pk_bf16_f32 v177, v178, v179
  v_mfma_f32_16x16x32_bf16 v[4:7], a[192:195], v[200:203], v[4:7]
  s_mov_b32 s29, 101376
  ds_read_b64_tr_b16 a[214:215], v239 offset:9216
  v_add_f32 v236, v184, v236
  v_mfma_f32_16x16x32_bf16 v[8:11], a[192:195], v[208:211], v[8:11]
  s_waitcnt lgkmcnt(8)
  v_exp_f32 v185, v185
  v_mfma_f32_16x16x32_bf16 v[12:15], a[196:199], v[192:195], v[12:15]
  ds_read_b64_tr_b16 a[216:217], v228 offset:1280
  v_add_f32 v236, v185, v236
  v_mfma_f32_16x16x32_bf16 v[16:19], a[196:199], v[200:203], v[16:19]
  ds_read_b64_tr_b16 a[218:219], v228 offset:9472
  v_cvt_pk_bf16_f32 v184, v184, v185
  v_mfma_f32_16x16x32_bf16 v[20:23], a[196:199], v[208:211], v[20:23]
  s_waitcnt lgkmcnt(8)
  v_exp_f32 v186, v186
  v_mfma_f32_16x16x32_bf16 v[24:27], a[200:203], v[192:195], v[24:27]
  ds_read_b64_tr_b16 a[220:221], v239 offset:1280
  v_add_f32 v236, v186, v236
  v_mfma_f32_16x16x32_bf16 v[28:31], a[200:203], v[200:203], v[28:31]
  buffer_load_dwordx4 v231, s[12:15], s29 offen offset:0 nt lds
  v_mfma_f32_16x16x32_bf16 v[32:35], a[200:203], v[208:211], v[32:35]
  s_waitcnt lgkmcnt(7)
  ds_read_b64_tr_b16 a[222:223], v239 offset:9472
  v_mfma_f32_16x16x32_bf16 v[36:39], a[204:207], v[192:195], v[36:39]
  s_add_u32 s29, s29, s30
  ds_read_b64_tr_b16 a[192:193], v228 offset:2048
  v_mfma_f32_16x16x32_bf16 v[40:43], a[204:207], v[200:203], v[40:43]
  ds_read_b64_tr_b16 a[194:195], v228 offset:10240
  v_mfma_f32_16x16x32_bf16 v[44:47], a[204:207], v[208:211], v[44:47]
  s_waitcnt lgkmcnt(8)
  v_exp_f32 v187, v187
  v_mfma_f32_16x16x32_bf16 v[48:51], a[208:211], v[192:195], v[48:51]
  ds_read_b64_tr_b16 a[196:197], v239 offset:2048
  v_add_f32 v236, v187, v236
  v_mfma_f32_16x16x32_bf16 v[52:55], a[208:211], v[200:203], v[52:55]
  buffer_load_dwordx4 v231, s[12:15], s29 offen offset:1024 nt lds
  v_mfma_f32_16x16x32_bf16 v[56:59], a[208:211], v[208:211], v[56:59]
  s_waitcnt lgkmcnt(7)
  ds_read_b64_tr_b16 a[198:199], v239 offset:10240
  v_cvt_pk_bf16_f32 v185, v186, v187
  v_mfma_f32_16x16x32_bf16 v[60:63], a[212:215], v[192:195], v[60:63]
  s_add_u32 s29, s29, s30
  ds_read_b64_tr_b16 a[200:201], v228 offset:2304
  v_mfma_f32_16x16x32_bf16 v[64:67], a[212:215], v[200:203], v[64:67]
  ds_read_b64_tr_b16 a[202:203], v228 offset:10496
  v_mfma_f32_16x16x32_bf16 v[68:71], a[212:215], v[208:211], v[68:71]
  s_waitcnt lgkmcnt(8)
  v_exp_f32 v172, v172
  v_mfma_f32_16x16x32_bf16 v[72:75], a[216:219], v[192:195], v[72:75]
  ds_read_b64_tr_b16 a[204:205], v239 offset:2304
  v_add_f32 v234, v172, v234
  v_mfma_f32_16x16x32_bf16 v[76:79], a[216:219], v[200:203], v[76:79]
  buffer_load_dwordx4 v231, s[12:15], s29 offen offset:2048 nt lds
  v_mfma_f32_16x16x32_bf16 v[80:83], a[216:219], v[208:211], v[80:83]
  s_waitcnt lgkmcnt(7)
  ds_read_b64_tr_b16 a[206:207], v239 offset:10496
  v_mfma_f32_16x16x32_bf16 v[84:87], a[220:223], v[192:195], v[84:87]
  s_add_u32 s29, s29, s30
  ds_read_b64_tr_b16 a[208:209], v228 offset:3072
  v_mfma_f32_16x16x32_bf16 v[88:91], a[220:223], v[200:203], v[88:91]
  ds_read_b64_tr_b16 a[210:211], v228 offset:11264
  v_mfma_f32_16x16x32_bf16 v[92:95], a[220:223], v[208:211], v[92:95]
  s_waitcnt lgkmcnt(8)
  v_exp_f32 v173, v173
  v_mfma_f32_16x16x32_bf16 v[96:99], a[192:195], v[192:195], v[96:99]
  ds_read_b64_tr_b16 a[212:213], v239 offset:3072
  v_add_f32 v234, v173, v234
  v_mfma_f32_16x16x32_bf16 v[100:103], a[192:195], v[200:203], v[100:103]
  buffer_load_dwordx4 v231, s[12:15], s29 offen offset:3072 nt lds
  v_mfma_f32_16x16x32_bf16 v[104:107], a[192:195], v[208:211], v[104:107]
  s_waitcnt lgkmcnt(7)
  ds_read_b64_tr_b16 a[214:215], v239 offset:11264
  v_cvt_pk_bf16_f32 v170, v172, v173
  v_mfma_f32_16x16x32_bf16 v[108:111], a[196:199], v[192:195], v[108:111]
  s_waitcnt vmcnt(4)
  ds_read_b64_tr_b16 a[216:217], v228 offset:3328
  v_mfma_f32_16x16x32_bf16 v[112:115], a[196:199], v[200:203], v[112:115]
  s_barrier
  ds_read_b64_tr_b16 a[218:219], v228 offset:11520
  v_mfma_f32_16x16x32_bf16 v[116:119], a[196:199], v[208:211], v[116:119]
  s_waitcnt lgkmcnt(8)
  v_exp_f32 v174, v174
  v_mfma_f32_16x16x32_bf16 v[120:123], a[200:203], v[192:195], v[120:123]
  ds_read_b64_tr_b16 a[220:221], v239 offset:3328
  v_add_f32 v234, v174, v234
  v_mfma_f32_16x16x32_bf16 v[124:127], a[200:203], v[200:203], v[124:127]
  ds_read_b64_tr_b16 a[222:223], v239 offset:11520
  v_add_u32 v228, 0, v229
  v_mfma_f32_16x16x32_bf16 v[128:131], a[200:203], v[208:211], v[128:131]
  s_waitcnt lgkmcnt(8)
  v_exp_f32 v175, v175
  v_mfma_f32_16x16x32_bf16 v[132:135], a[204:207], v[192:195], v[132:135]
  ds_read_b128 a[192:195], v228 offset:0
  v_add_f32 v234, v175, v234
  v_mfma_f32_16x16x32_bf16 v[136:139], a[204:207], v[200:203], v[136:139]
  v_exp_f32 v180, v180
  v_mfma_f32_16x16x32_bf16 v[140:143], a[204:207], v[208:211], v[140:143]
  s_waitcnt lgkmcnt(7)
  v_exp_f32 v181, v181
  v_mfma_f32_16x16x32_bf16 v[144:147], a[208:211], v[192:195], v[144:147]
  ds_read_b128 a[196:199], v228 offset:256
  v_cvt_pk_bf16_f32 v171, v174, v175
  v_mfma_f32_16x16x32_bf16 v[148:151], a[208:211], v[200:203], v[148:151]
  v_exp_f32 v182, v182
  v_mfma_f32_16x16x32_bf16 v[152:155], a[208:211], v[208:211], v[152:155]
  s_waitcnt lgkmcnt(6)
  v_exp_f32 v183, v183
  v_mfma_f32_16x16x32_bf16 v[156:159], a[212:215], v[192:195], v[156:159]
  ds_read_b128 a[200:203], v228 offset:1024
  v_add_f32 v235, v180, v235
  v_mfma_f32_16x16x32_bf16 v[160:163], a[212:215], v[200:203], v[160:163]
  v_exp_f32 v188, v188
  v_mfma_f32_16x16x32_bf16 v[164:167], a[212:215], v[208:211], v[164:167]
  s_waitcnt lgkmcnt(5)
  v_exp_f32 v189, v189
  v_mfma_f32_16x16x32_bf16 a[224:227], a[216:219], v[192:195], a[224:227]
  ds_read_b128 a[204:207], v228 offset:1280
  v_add_f32 v235, v181, v235
  v_mfma_f32_16x16x32_bf16 a[228:231], a[216:219], v[200:203], a[228:231]
  v_exp_f32 v190, v190
  v_mfma_f32_16x16x32_bf16 a[232:235], a[216:219], v[208:211], a[232:235]
  s_waitcnt lgkmcnt(4)
  v_exp_f32 v191, v191
  v_mfma_f32_16x16x32_bf16 a[236:239], a[220:223], v[192:195], a[236:239]
  ds_read_b128 a[208:211], v228 offset:2048
  v_cvt_pk_bf16_f32 v178, v180, v181
  v_mfma_f32_16x16x32_bf16 a[240:243], a[220:223], v[200:203], a[240:243]
  v_add_f32 v235, v182, v235
  v_add_f32 v236, v188, v236
  v_mfma_f32_16x16x32_bf16 a[244:247], a[220:223], v[208:211], a[244:247]
  s_waitcnt lgkmcnt(4)
  v_add_f32 v235, v183, v235
  v_add_f32 v236, v189, v236
  v_mfma_f32_16x16x32_bf16 v[192:195], a[192:195], a[0:3], v[216:219]
  s_add_u32 m0, s28, 81920
  ds_read_b128 a[212:215], v228 offset:2304
  v_cvt_pk_bf16_f32 v179, v182, v183
  v_mfma_f32_16x16x32_bf16 v[200:203], a[192:195], a[4:7], v[220:223]
  s_mov_b32 s29, 134144
  v_cvt_pk_bf16_f32 v186, v188, v189
  v_add_f32 v236, v190, v236
  v_mfma_f32_16x16x32_bf16 v[208:211], a[192:195], a[8:11], v[224:227]
  s_waitcnt lgkmcnt(4)
  v_add_f32 v236, v191, v236
  v_mfma_f32_16x16x32_bf16 v[192:195], a[196:199], a[12:15], v[192:195]
  ds_read_b128 a[216:219], v228 offset:3072
  v_cvt_pk_bf16_f32 v187, v190, v191
  v_mfma_f32_16x16x32_bf16 v[200:203], a[196:199], a[16:19], v[200:203]
  v_mfma_f32_16x16x32_bf16 v[208:211], a[196:199], a[20:23], v[208:211]
  s_waitcnt lgkmcnt(4)
  v_mfma_f32_16x16x32_bf16 v[192:195], a[200:203], a[24:27], v[192:195]
  ds_read_b128 a[220:223], v228 offset:3328
  v_mfma_f32_16x16x32_bf16 v[200:203], a[200:203], a[28:31], v[200:203]
  buffer_load_dwordx4 v231, s[8:11], s29 offen offset:0 nt lds
  v_mfma_f32_16x16x32_bf16 v[208:211], a[200:203], a[32:35], v[208:211]
  s_waitcnt lgkmcnt(4)
  v_mfma_f32_16x16x32_bf16 v[192:195], a[204:207], a[36:39], v[192:195]
  s_add_u32 s29, s29, s30
  ds_read_b128 a[192:195], v228 offset:8192
  v_mfma_f32_16x16x32_bf16 v[200:203], a[204:207], a[40:43], v[200:203]
  v_mfma_f32_16x16x32_bf16 v[208:211], a[204:207], a[44:47], v[208:211]
  s_waitcnt lgkmcnt(4)
  v_mfma_f32_16x16x32_bf16 v[192:195], a[208:211], a[48:51], v[192:195]
  ds_read_b128 a[196:199], v228 offset:8448
  v_mfma_f32_16x16x32_bf16 v[200:203], a[208:211], a[52:55], v[200:203]
  buffer_load_dwordx4 v231, s[8:11], s29 offen offset:1024 nt lds
  v_mfma_f32_16x16x32_bf16 v[208:211], a[208:211], a[56:59], v[208:211]
  s_waitcnt lgkmcnt(4)
  v_mfma_f32_16x16x32_bf16 v[192:195], a[212:215], a[60:63], v[192:195]
  s_add_u32 s29, s29, s30
  ds_read_b128 a[200:203], v228 offset:9216
  v_mfma_f32_16x16x32_bf16 v[200:203], a[212:215], a[64:67], v[200:203]
  v_mfma_f32_16x16x32_bf16 v[208:211], a[212:215], a[68:71], v[208:211]
  s_waitcnt lgkmcnt(4)
  v_mfma_f32_16x16x32_bf16 v[192:195], a[216:219], a[72:75], v[192:195]
  ds_read_b128 a[204:207], v228 offset:9472
  v_mfma_f32_16x16x32_bf16 v[200:203], a[216:219], a[76:79], v[200:203]
  buffer_load_dwordx4 v231, s[8:11], s29 offen offset:2048 nt lds
  v_mfma_f32_16x16x32_bf16 v[208:211], a[216:219], a[80:83], v[208:211]
  s_waitcnt lgkmcnt(4)
  v_mfma_f32_16x16x32_bf16 v[192:195], a[220:223], a[84:87], v[192:195]
  s_add_u32 s29, s29, s30
  ds_read_b128 a[208:211], v228 offset:10240
  v_mfma_f32_16x16x32_bf16 v[200:203], a[220:223], a[88:91], v[200:203]
  v_mfma_f32_16x16x32_bf16 v[208:211], a[220:223], a[92:95], v[208:211]
  s_waitcnt lgkmcnt(4)
  v_mfma_f32_16x16x32_bf16 v[196:199], a[192:195], a[0:3], v[216:219]
  ds_read_b128 a[212:215], v228 offset:10496
  v_mfma_f32_16x16x32_bf16 v[204:207], a[192:195], a[4:7], v[220:223]
  buffer_load_dwordx4 v231, s[8:11], s29 offen offset:3072 nt lds
  v_mfma_f32_16x16x32_bf16 v[212:215], a[192:195], a[8:11], v[224:227]
  s_waitcnt lgkmcnt(4)
  v_exp_f32 v192, v192
  v_mfma_f32_16x16x32_bf16 v[196:199], a[196:199], a[12:15], v[196:199]
  s_waitcnt vmcnt(4)
  ds_read_b128 a[216:219], v228 offset:11264
  v_add_f32 v234, v192, v234
  v_mfma_f32_16x16x32_bf16 v[204:207], a[196:199], a[16:19], v[204:207]
  s_barrier
  v_exp_f32 v193, v193
  v_mfma_f32_16x16x32_bf16 v[212:215], a[196:199], a[20:23], v[212:215]
  s_waitcnt lgkmcnt(4)
  v_exp_f32 v194, v194
  v_mfma_f32_16x16x32_bf16 v[196:199], a[200:203], a[24:27], v[196:199]
  ds_read_b128 a[220:223], v228 offset:11520
  v_add_u32 v228, 49152, v230
  v_mfma_f32_16x16x32_bf16 v[204:207], a[200:203], a[28:31], v[204:207]
  v_xor_b32 v239, 32, v228
  v_mfma_f32_16x16x32_bf16 v[212:215], a[200:203], a[32:35], v[212:215]
  s_waitcnt lgkmcnt(4)
  v_exp_f32 v195, v195
  v_mfma_f32_16x16x32_bf16 v[196:199], a[204:207], a[36:39], v[196:199]
  ds_read_b64_tr_b16 a[192:193], v228 offset:0
  v_add_f32 v234, v193, v234
  v_mfma_f32_16x16x32_bf16 v[204:207], a[204:207], a[40:43], v[204:207]
  ds_read_b64_tr_b16 a[194:195], v228 offset:8192
  v_cvt_pk_bf16_f32 v192, v192, v193
  v_mfma_f32_16x16x32_bf16 v[212:215], a[204:207], a[44:47], v[212:215]
  s_waitcnt lgkmcnt(5)
  v_exp_f32 v200, v200
  v_mfma_f32_16x16x32_bf16 v[196:199], a[208:211], a[48:51], v[196:199]
  ds_read_b64_tr_b16 a[196:197], v239 offset:0
  v_add_f32 v234, v194, v234
  v_mfma_f32_16x16x32_bf16 v[204:207], a[208:211], a[52:55], v[204:207]
  ds_read_b64_tr_b16 a[198:199], v239 offset:8192
  v_add_f32 v234, v195, v234
  v_mfma_f32_16x16x32_bf16 v[212:215], a[208:211], a[56:59], v[212:215]
  s_waitcnt lgkmcnt(6)
  v_exp_f32 v201, v201
  v_mfma_f32_16x16x32_bf16 v[196:199], a[212:215], a[60:63], v[196:199]
  ds_read_b64_tr_b16 a[200:201], v228 offset:256
  v_cvt_pk_bf16_f32 v193, v194, v195
  v_mfma_f32_16x16x32_bf16 v[204:207], a[212:215], a[64:67], v[204:207]
  ds_read_b64_tr_b16 a[202:203], v228 offset:8448
  v_add_f32 v235, v200, v235
  v_mfma_f32_16x16x32_bf16 v[212:215], a[212:215], a[68:71], v[212:215]
  s_waitcnt lgkmcnt(7)
  v_exp_f32 v202, v202
  v_mfma_f32_16x16x32_bf16 v[196:199], a[216:219], a[72:75], v[196:199]
  ds_read_b64_tr_b16 a[204:205], v239 offset:256
  v_add_f32 v235, v201, v235
  v_mfma_f32_16x16x32_bf16 v[204:207], a[216:219], a[76:79], v[204:207]
  ds_read_b64_tr_b16 a[206:207], v239 offset:8448
  v_cvt_pk_bf16_f32 v200, v200, v201
  v_mfma_f32_16x16x32_bf16 v[212:215], a[216:219], a[80:83], v[212:215]
  s_waitcnt lgkmcnt(8)
  v_exp_f32 v203, v203
  v_mfma_f32_16x16x32_bf16 v[196:199], a[220:223], a[84:87], v[196:199]
  ds_read_b64_tr_b16 a[208:209], v228 offset:1024
  v_add_f32 v235, v202, v235
  v_mfma_f32_16x16x32_bf16 v[204:207], a[220:223], a[88:91], v[204:207]
  ds_read_b64_tr_b16 a[210:211], v228 offset:9216
  v_add_f32 v235, v203, v235
  v_mfma_f32_16x16x32_bf16 v[212:215], a[220:223], a[92:95], v[212:215]
  s_waitcnt lgkmcnt(8)
  v_exp_f32 v208, v208
  v_mfma_f32_16x16x32_bf16 v[0:3], a[192:195], v[168:171], v[0:3]
  s_add_u32 m0, s28, 131072
  ds_read_b64_tr_b16 a[212:213], v239 offset:1024
  v_cvt_pk_bf16_f32 v201, v202, v203
  v_mfma_f32_16x16x32_bf16 v[4:7], a[192:195], v[176:179], v[4:7]
  s_mov_b32 s29, 117760
  ds_read_b64_tr_b16 a[214:215], v239 offset:9216
  v_add_f32 v236, v208, v236
  v_mfma_f32_16x16x32_bf16 v[8:11], a[192:195], v[184:187], v[8:11]
  s_waitcnt lgkmcnt(8)
  v_exp_f32 v209, v209
  v_mfma_f32_16x16x32_bf16 v[12:15], a[196:199], v[168:171], v[12:15]
  ds_read_b64_tr_b16 a[216:217], v228 offset:1280
  v_add_f32 v236, v209, v236
  v_mfma_f32_16x16x32_bf16 v[16:19], a[196:199], v[176:179], v[16:19]
  ds_read_b64_tr_b16 a[218:219], v228 offset:9472
  v_cvt_pk_bf16_f32 v208, v208, v209
  v_mfma_f32_16x16x32_bf16 v[20:23], a[196:199], v[184:187], v[20:23]
  s_waitcnt lgkmcnt(8)
  v_exp_f32 v210, v210
  v_mfma_f32_16x16x32_bf16 v[24:27], a[200:203], v[168:171], v[24:27]
  ds_read_b64_tr_b16 a[220:221], v239 offset:1280
  v_add_f32 v236, v210, v236
  v_mfma_f32_16x16x32_bf16 v[28:31], a[200:203], v[176:179], v[28:31]
  buffer_load_dwordx4 v231, s[12:15], s29 offen offset:0 nt lds
  v_mfma_f32_16x16x32_bf16 v[32:35], a[200:203], v[184:187], v[32:35]
  s_waitcnt lgkmcnt(7)
  ds_read_b64_tr_b16 a[222:223], v239 offset:9472
  v_mfma_f32_16x16x32_bf16 v[36:39], a[204:207], v[168:171], v[36:39]
  s_add_u32 s29, s29, s30
  ds_read_b64_tr_b16 a[192:193], v228 offset:2048
  v_mfma_f32_16x16x32_bf16 v[40:43], a[204:207], v[176:179], v[40:43]
  ds_read_b64_tr_b16 a[194:195], v228 offset:10240
  v_mfma_f32_16x16x32_bf16 v[44:47], a[204:207], v[184:187], v[44:47]
  s_waitcnt lgkmcnt(8)
  v_exp_f32 v211, v211
  v_mfma_f32_16x16x32_bf16 v[48:51], a[208:211], v[168:171], v[48:51]
  ds_read_b64_tr_b16 a[196:197], v239 offset:2048
  v_add_f32 v236, v211, v236
  v_mfma_f32_16x16x32_bf16 v[52:55], a[208:211], v[176:179], v[52:55]
  buffer_load_dwordx4 v231, s[12:15], s29 offen offset:1024 nt lds
  v_mfma_f32_16x16x32_bf16 v[56:59], a[208:211], v[184:187], v[56:59]
  s_waitcnt lgkmcnt(7)
  ds_read_b64_tr_b16 a[198:199], v239 offset:10240
  v_cvt_pk_bf16_f32 v209, v210, v211
  v_mfma_f32_16x16x32_bf16 v[60:63], a[212:215], v[168:171], v[60:63]
  s_add_u32 s29, s29, s30
  ds_read_b64_tr_b16 a[200:201], v228 offset:2304
  v_mfma_f32_16x16x32_bf16 v[64:67], a[212:215], v[176:179], v[64:67]
  ds_read_b64_tr_b16 a[202:203], v228 offset:10496
  v_mfma_f32_16x16x32_bf16 v[68:71], a[212:215], v[184:187], v[68:71]
  s_waitcnt lgkmcnt(8)
  v_exp_f32 v196, v196
  v_mfma_f32_16x16x32_bf16 v[72:75], a[216:219], v[168:171], v[72:75]
  ds_read_b64_tr_b16 a[204:205], v239 offset:2304
  v_add_f32 v234, v196, v234
  v_mfma_f32_16x16x32_bf16 v[76:79], a[216:219], v[176:179], v[76:79]
  buffer_load_dwordx4 v231, s[12:15], s29 offen offset:2048 nt lds
  v_mfma_f32_16x16x32_bf16 v[80:83], a[216:219], v[184:187], v[80:83]
  s_waitcnt lgkmcnt(7)
  ds_read_b64_tr_b16 a[206:207], v239 offset:10496
  v_mfma_f32_16x16x32_bf16 v[84:87], a[220:223], v[168:171], v[84:87]
  s_add_u32 s29, s29, s30
  ds_read_b64_tr_b16 a[208:209], v228 offset:3072
  v_mfma_f32_16x16x32_bf16 v[88:91], a[220:223], v[176:179], v[88:91]
  ds_read_b64_tr_b16 a[210:211], v228 offset:11264
  v_mfma_f32_16x16x32_bf16 v[92:95], a[220:223], v[184:187], v[92:95]
  s_waitcnt lgkmcnt(8)
  v_exp_f32 v197, v197
  v_mfma_f32_16x16x32_bf16 v[96:99], a[192:195], v[168:171], v[96:99]
  ds_read_b64_tr_b16 a[212:213], v239 offset:3072
  v_add_f32 v234, v197, v234
  v_mfma_f32_16x16x32_bf16 v[100:103], a[192:195], v[176:179], v[100:103]
  buffer_load_dwordx4 v231, s[12:15], s29 offen offset:3072 nt lds
  v_mfma_f32_16x16x32_bf16 v[104:107], a[192:195], v[184:187], v[104:107]
  s_waitcnt lgkmcnt(7)
  ds_read_b64_tr_b16 a[214:215], v239 offset:11264
  v_cvt_pk_bf16_f32 v194, v196, v197
  v_mfma_f32_16x16x32_bf16 v[108:111], a[196:199], v[168:171], v[108:111]
  s_waitcnt vmcnt(4)
  ds_read_b64_tr_b16 a[216:217], v228 offset:3328
  v_mfma_f32_16x16x32_bf16 v[112:115], a[196:199], v[176:179], v[112:115]
  s_barrier
  ds_read_b64_tr_b16 a[218:219], v228 offset:11520
  v_mfma_f32_16x16x32_bf16 v[116:119], a[196:199], v[184:187], v[116:119]
  s_waitcnt lgkmcnt(8)
  v_exp_f32 v198, v198
  v_mfma_f32_16x16x32_bf16 v[120:123], a[200:203], v[168:171], v[120:123]
  ds_read_b64_tr_b16 a[220:221], v239 offset:3328
  v_add_f32 v234, v198, v234
  v_mfma_f32_16x16x32_bf16 v[124:127], a[200:203], v[176:179], v[124:127]
  ds_read_b64_tr_b16 a[222:223], v239 offset:11520
  v_add_u32 v228, 81920, v229
  v_mfma_f32_16x16x32_bf16 v[128:131], a[200:203], v[184:187], v[128:131]
  s_waitcnt lgkmcnt(8)
  v_exp_f32 v199, v199
  v_mfma_f32_16x16x32_bf16 v[132:135], a[204:207], v[168:171], v[132:135]
  ds_read_b128 a[192:195], v228 offset:0
  v_add_f32 v234, v199, v234
  v_mfma_f32_16x16x32_bf16 v[136:139], a[204:207], v[176:179], v[136:139]
  v_exp_f32 v204, v204
  v_mfma_f32_16x16x32_bf16 v[140:143], a[204:207], v[184:187], v[140:143]
  s_waitcnt lgkmcnt(7)
  v_exp_f32 v205, v205
  v_mfma_f32_16x16x32_bf16 v[144:147], a[208:211], v[168:171], v[144:147]
  ds_read_b128 a[196:199], v228 offset:256
  v_cvt_pk_bf16_f32 v195, v198, v199
  v_mfma_f32_16x16x32_bf16 v[148:151], a[208:211], v[176:179], v[148:151]
  v_exp_f32 v206, v206
  v_mfma_f32_16x16x32_bf16 v[152:155], a[208:211], v[184:187], v[152:155]
  s_waitcnt lgkmcnt(6)
  v_exp_f32 v207, v207
  v_mfma_f32_16x16x32_bf16 v[156:159], a[212:215], v[168:171], v[156:159]
  ds_read_b128 a[200:203], v228 offset:1024
  v_add_f32 v235, v204, v235
  v_mfma_f32_16x16x32_bf16 v[160:163], a[212:215], v[176:179], v[160:163]
  v_exp_f32 v212, v212
  v_mfma_f32_16x16x32_bf16 v[164:167], a[212:215], v[184:187], v[164:167]
  s_waitcnt lgkmcnt(5)
  v_exp_f32 v213, v213
  v_mfma_f32_16x16x32_bf16 a[224:227], a[216:219], v[168:171], a[224:227]
  ds_read_b128 a[204:207], v228 offset:1280
  v_add_f32 v235, v205, v235
  v_mfma_f32_16x16x32_bf16 a[228:231], a[216:219], v[176:179], a[228:231]
  v_exp_f32 v214, v214
  v_mfma_f32_16x16x32_bf16 a[232:235], a[216:219], v[184:187], a[232:235]
  s_waitcnt lgkmcnt(4)
  v_exp_f32 v215, v215
  v_mfma_f32_16x16x32_bf16 a[236:239], a[220:223], v[168:171], a[236:239]
  ds_read_b128 a[208:211], v228 offset:2048
  v_cvt_pk_bf16_f32 v202, v204, v205
  v_mfma_f32_16x16x32_bf16 a[240:243], a[220:223], v[176:179], a[240:243]
  v_add_f32 v235, v206, v235
  v_add_f32 v236, v212, v236
  v_mfma_f32_16x16x32_bf16 a[244:247], a[220:223], v[184:187], a[244:247]
  s_waitcnt lgkmcnt(4)
  v_add_f32 v235, v207, v235
  v_add_f32 v236, v213, v236
  v_mfma_f32_16x16x32_bf16 v[168:171], a[192:195], a[0:3], v[216:219]
  s_add_u32 m0, s28, 147456
  ds_read_b128 a[212:215], v228 offset:2304
  v_cvt_pk_bf16_f32 v203, v206, v207
  v_mfma_f32_16x16x32_bf16 v[176:179], a[192:195], a[4:7], v[220:223]
  s_mov_b32 s29, 150528
  v_cvt_pk_bf16_f32 v210, v212, v213
  v_add_f32 v236, v214, v236
  v_mfma_f32_16x16x32_bf16 v[184:187], a[192:195], a[8:11], v[224:227]
  s_waitcnt lgkmcnt(4)
  v_add_f32 v236, v215, v236
  v_mfma_f32_16x16x32_bf16 v[168:171], a[196:199], a[12:15], v[168:171]
  ds_read_b128 a[216:219], v228 offset:3072
  v_cvt_pk_bf16_f32 v211, v214, v215
  v_mfma_f32_16x16x32_bf16 v[176:179], a[196:199], a[16:19], v[176:179]
  v_mfma_f32_16x16x32_bf16 v[184:187], a[196:199], a[20:23], v[184:187]
  s_waitcnt lgkmcnt(4)
  v_mfma_f32_16x16x32_bf16 v[168:171], a[200:203], a[24:27], v[168:171]
  ds_read_b128 a[220:223], v228 offset:3328
  v_mfma_f32_16x16x32_bf16 v[176:179], a[200:203], a[28:31], v[176:179]
  buffer_load_dwordx4 v231, s[8:11], s29 offen offset:0 nt lds
  v_mfma_f32_16x16x32_bf16 v[184:187], a[200:203], a[32:35], v[184:187]
  s_waitcnt lgkmcnt(4)
  v_mfma_f32_16x16x32_bf16 v[168:171], a[204:207], a[36:39], v[168:171]
  s_add_u32 s29, s29, s30
  ds_read_b128 a[192:195], v228 offset:8192
  v_mfma_f32_16x16x32_bf16 v[176:179], a[204:207], a[40:43], v[176:179]
  v_mfma_f32_16x16x32_bf16 v[184:187], a[204:207], a[44:47], v[184:187]
  s_waitcnt lgkmcnt(4)
  v_mfma_f32_16x16x32_bf16 v[168:171], a[208:211], a[48:51], v[168:171]
  ds_read_b128 a[196:199], v228 offset:8448
  v_mfma_f32_16x16x32_bf16 v[176:179], a[208:211], a[52:55], v[176:179]
  buffer_load_dwordx4 v231, s[8:11], s29 offen offset:1024 nt lds
  v_mfma_f32_16x16x32_bf16 v[184:187], a[208:211], a[56:59], v[184:187]
  s_waitcnt lgkmcnt(4)
  v_mfma_f32_16x16x32_bf16 v[168:171], a[212:215], a[60:63], v[168:171]
  s_add_u32 s29, s29, s30
  ds_read_b128 a[200:203], v228 offset:9216
  v_mfma_f32_16x16x32_bf16 v[176:179], a[212:215], a[64:67], v[176:179]
  v_mfma_f32_16x16x32_bf16 v[184:187], a[212:215], a[68:71], v[184:187]
  s_waitcnt lgkmcnt(4)
  v_mfma_f32_16x16x32_bf16 v[168:171], a[216:219], a[72:75], v[168:171]
  ds_read_b128 a[204:207], v228 offset:9472
  v_mfma_f32_16x16x32_bf16 v[176:179], a[216:219], a[76:79], v[176:179]
  buffer_load_dwordx4 v231, s[8:11], s29 offen offset:2048 nt lds
  v_mfma_f32_16x16x32_bf16 v[184:187], a[216:219], a[80:83], v[184:187]
  s_waitcnt lgkmcnt(4)
  v_mfma_f32_16x16x32_bf16 v[168:171], a[220:223], a[84:87], v[168:171]
  s_add_u32 s29, s29, s30
  ds_read_b128 a[208:211], v228 offset:10240
  v_mfma_f32_16x16x32_bf16 v[176:179], a[220:223], a[88:91], v[176:179]
  v_mfma_f32_16x16x32_bf16 v[184:187], a[220:223], a[92:95], v[184:187]
  s_waitcnt lgkmcnt(4)
  v_mfma_f32_16x16x32_bf16 v[172:175], a[192:195], a[0:3], v[216:219]
  ds_read_b128 a[212:215], v228 offset:10496
  v_mfma_f32_16x16x32_bf16 v[180:183], a[192:195], a[4:7], v[220:223]
  buffer_load_dwordx4 v231, s[8:11], s29 offen offset:3072 nt lds
  v_mfma_f32_16x16x32_bf16 v[188:191], a[192:195], a[8:11], v[224:227]
  s_waitcnt lgkmcnt(4)
  v_exp_f32 v168, v168
  v_mfma_f32_16x16x32_bf16 v[172:175], a[196:199], a[12:15], v[172:175]
  s_waitcnt vmcnt(4)
  ds_read_b128 a[216:219], v228 offset:11264
  v_add_f32 v234, v168, v234
  v_mfma_f32_16x16x32_bf16 v[180:183], a[196:199], a[16:19], v[180:183]
  s_barrier
  v_exp_f32 v169, v169
  v_mfma_f32_16x16x32_bf16 v[188:191], a[196:199], a[20:23], v[188:191]
  s_waitcnt lgkmcnt(4)
  v_exp_f32 v170, v170
  v_mfma_f32_16x16x32_bf16 v[172:175], a[200:203], a[24:27], v[172:175]
  ds_read_b128 a[220:223], v228 offset:11520
  v_add_u32 v228, 131072, v230
  v_mfma_f32_16x16x32_bf16 v[180:183], a[200:203], a[28:31], v[180:183]
  v_xor_b32 v239, 32, v228
  v_mfma_f32_16x16x32_bf16 v[188:191], a[200:203], a[32:35], v[188:191]
  s_waitcnt lgkmcnt(4)
  v_exp_f32 v171, v171
  v_mfma_f32_16x16x32_bf16 v[172:175], a[204:207], a[36:39], v[172:175]
  ds_read_b64_tr_b16 a[192:193], v228 offset:0
  v_add_f32 v234, v169, v234
  v_mfma_f32_16x16x32_bf16 v[180:183], a[204:207], a[40:43], v[180:183]
  ds_read_b64_tr_b16 a[194:195], v228 offset:8192
  v_cvt_pk_bf16_f32 v168, v168, v169
  v_mfma_f32_16x16x32_bf16 v[188:191], a[204:207], a[44:47], v[188:191]
  s_waitcnt lgkmcnt(5)
  v_exp_f32 v176, v176
  v_mfma_f32_16x16x32_bf16 v[172:175], a[208:211], a[48:51], v[172:175]
  ds_read_b64_tr_b16 a[196:197], v239 offset:0
  v_add_f32 v234, v170, v234
  v_mfma_f32_16x16x32_bf16 v[180:183], a[208:211], a[52:55], v[180:183]
  ds_read_b64_tr_b16 a[198:199], v239 offset:8192
  v_add_f32 v234, v171, v234
  v_mfma_f32_16x16x32_bf16 v[188:191], a[208:211], a[56:59], v[188:191]
  s_waitcnt lgkmcnt(6)
  v_exp_f32 v177, v177
  v_mfma_f32_16x16x32_bf16 v[172:175], a[212:215], a[60:63], v[172:175]
  ds_read_b64_tr_b16 a[200:201], v228 offset:256
  v_cvt_pk_bf16_f32 v169, v170, v171
  v_mfma_f32_16x16x32_bf16 v[180:183], a[212:215], a[64:67], v[180:183]
  ds_read_b64_tr_b16 a[202:203], v228 offset:8448
  v_add_f32 v235, v176, v235
  v_mfma_f32_16x16x32_bf16 v[188:191], a[212:215], a[68:71], v[188:191]
  s_waitcnt lgkmcnt(7)
  v_exp_f32 v178, v178
  v_mfma_f32_16x16x32_bf16 v[172:175], a[216:219], a[72:75], v[172:175]
  ds_read_b64_tr_b16 a[204:205], v239 offset:256
  v_add_f32 v235, v177, v235
  v_mfma_f32_16x16x32_bf16 v[180:183], a[216:219], a[76:79], v[180:183]
  ds_read_b64_tr_b16 a[206:207], v239 offset:8448
  v_cvt_pk_bf16_f32 v176, v176, v177
  v_mfma_f32_16x16x32_bf16 v[188:191], a[216:219], a[80:83], v[188:191]
  s_waitcnt lgkmcnt(8)
  v_exp_f32 v179, v179
  v_mfma_f32_16x16x32_bf16 v[172:175], a[220:223], a[84:87], v[172:175]
  ds_read_b64_tr_b16 a[208:209], v228 offset:1024
  v_add_f32 v235, v178, v235
  v_mfma_f32_16x16x32_bf16 v[180:183], a[220:223], a[88:91], v[180:183]
  ds_read_b64_tr_b16 a[210:211], v228 offset:9216
  v_add_f32 v235, v179, v235
  v_mfma_f32_16x16x32_bf16 v[188:191], a[220:223], a[92:95], v[188:191]
  s_waitcnt lgkmcnt(8)
  v_exp_f32 v184, v184
  v_mfma_f32_16x16x32_bf16 v[0:3], a[192:195], v[192:195], v[0:3]
  s_add_u32 m0, s28, 0
  ds_read_b64_tr_b16 a[212:213], v239 offset:1024
  v_cvt_pk_bf16_f32 v177, v178, v179
  v_mfma_f32_16x16x32_bf16 v[4:7], a[192:195], v[200:203], v[4:7]
  s_mov_b32 s29, 134144
  ds_read_b64_tr_b16 a[214:215], v239 offset:9216
  v_add_f32 v236, v184, v236
  v_mfma_f32_16x16x32_bf16 v[8:11], a[192:195], v[208:211], v[8:11]
  s_waitcnt lgkmcnt(8)
  v_exp_f32 v185, v185
  v_mfma_f32_16x16x32_bf16 v[12:15], a[196:199], v[192:195], v[12:15]
  ds_read_b64_tr_b16 a[216:217], v228 offset:1280
  v_add_f32 v236, v185, v236
  v_mfma_f32_16x16x32_bf16 v[16:19], a[196:199], v[200:203], v[16:19]
  buffer_load_dwordx4 a[252:255], v247, s[88:91], 0 offen offset:0
  v_mfma_f32_16x16x32_bf16 v[20:23], a[196:199], v[208:211], v[20:23]
  s_waitcnt lgkmcnt(7)
  ds_read_b64_tr_b16 a[218:219], v228 offset:9472
  v_cvt_pk_bf16_f32 v184, v184, v185
  v_mfma_f32_16x16x32_bf16 v[24:27], a[200:203], v[192:195], v[24:27]
  ds_read_b64_tr_b16 a[220:221], v239 offset:1280
  v_mfma_f32_16x16x32_bf16 v[28:31], a[200:203], v[200:203], v[28:31]
  buffer_load_dwordx4 v231, s[12:15], s29 offen offset:0 nt lds
  v_mfma_f32_16x16x32_bf16 v[32:35], a[200:203], v[208:211], v[32:35]
  s_waitcnt lgkmcnt(7)
  ds_read_b64_tr_b16 a[222:223], v239 offset:9472
  v_mfma_f32_16x16x32_bf16 v[36:39], a[204:207], v[192:195], v[36:39]
  s_add_u32 s29, s29, s30
  ds_read_b64_tr_b16 a[192:193], v228 offset:2048
  v_mfma_f32_16x16x32_bf16 v[40:43], a[204:207], v[200:203], v[40:43]
  ds_read_b64_tr_b16 a[194:195], v228 offset:10240
  v_mfma_f32_16x16x32_bf16 v[44:47], a[204:207], v[208:211], v[44:47]
  s_waitcnt lgkmcnt(8)
  v_exp_f32 v186, v186
  v_mfma_f32_16x16x32_bf16 v[48:51], a[208:211], v[192:195], v[48:51]
  ds_read_b64_tr_b16 a[196:197], v239 offset:2048
  v_add_f32 v236, v186, v236
  v_mfma_f32_16x16x32_bf16 v[52:55], a[208:211], v[200:203], v[52:55]
  buffer_load_dwordx4 v231, s[12:15], s29 offen offset:1024 nt lds
  v_mfma_f32_16x16x32_bf16 v[56:59], a[208:211], v[208:211], v[56:59]
  s_waitcnt lgkmcnt(7)
  ds_read_b64_tr_b16 a[198:199], v239 offset:10240
  v_mfma_f32_16x16x32_bf16 v[60:63], a[212:215], v[192:195], v[60:63]
  s_add_u32 s29, s29, s30
  ds_read_b64_tr_b16 a[200:201], v228 offset:2304
  v_mfma_f32_16x16x32_bf16 v[64:67], a[212:215], v[200:203], v[64:67]
  ds_read_b64_tr_b16 a[202:203], v228 offset:10496
  v_mfma_f32_16x16x32_bf16 v[68:71], a[212:215], v[208:211], v[68:71]
  s_waitcnt lgkmcnt(8)
  v_exp_f32 v187, v187
  v_mfma_f32_16x16x32_bf16 v[72:75], a[216:219], v[192:195], v[72:75]
  ds_read_b64_tr_b16 a[204:205], v239 offset:2304
  v_add_f32 v236, v187, v236
  v_mfma_f32_16x16x32_bf16 v[76:79], a[216:219], v[200:203], v[76:79]
  buffer_load_dwordx4 v231, s[12:15], s29 offen offset:2048 nt lds
  v_mfma_f32_16x16x32_bf16 v[80:83], a[216:219], v[208:211], v[80:83]
  s_waitcnt lgkmcnt(7)
  ds_read_b64_tr_b16 a[206:207], v239 offset:10496
  v_cvt_pk_bf16_f32 v185, v186, v187
  v_mfma_f32_16x16x32_bf16 v[84:87], a[220:223], v[192:195], v[84:87]
  s_add_u32 s29, s29, s30
  ds_read_b64_tr_b16 a[208:209], v228 offset:3072
  v_mfma_f32_16x16x32_bf16 v[88:91], a[220:223], v[200:203], v[88:91]
  ds_read_b64_tr_b16 a[210:211], v228 offset:11264
  v_mfma_f32_16x16x32_bf16 v[92:95], a[220:223], v[208:211], v[92:95]
  s_waitcnt lgkmcnt(8)
  v_exp_f32 v172, v172
  v_mfma_f32_16x16x32_bf16 v[96:99], a[192:195], v[192:195], v[96:99]
  ds_read_b64_tr_b16 a[212:213], v239 offset:3072
  v_add_f32 v234, v172, v234
  v_mfma_f32_16x16x32_bf16 v[100:103], a[192:195], v[200:203], v[100:103]
  buffer_load_dwordx4 v231, s[12:15], s29 offen offset:3072 nt lds
  v_mfma_f32_16x16x32_bf16 v[104:107], a[192:195], v[208:211], v[104:107]
  s_waitcnt lgkmcnt(7)
  ds_read_b64_tr_b16 a[214:215], v239 offset:11264
  v_mfma_f32_16x16x32_bf16 v[108:111], a[196:199], v[192:195], v[108:111]
  s_waitcnt vmcnt(5)
  ds_read_b64_tr_b16 a[216:217], v228 offset:3328
  v_mfma_f32_16x16x32_bf16 v[112:115], a[196:199], v[200:203], v[112:115]
  s_barrier
  ds_read_b64_tr_b16 a[218:219], v228 offset:11520
  v_mfma_f32_16x16x32_bf16 v[116:119], a[196:199], v[208:211], v[116:119]
  s_waitcnt lgkmcnt(8)
  v_exp_f32 v173, v173
  v_mfma_f32_16x16x32_bf16 v[120:123], a[200:203], v[192:195], v[120:123]
  ds_read_b64_tr_b16 a[220:221], v239 offset:3328
  v_add_f32 v234, v173, v234
  v_mfma_f32_16x16x32_bf16 v[124:127], a[200:203], v[200:203], v[124:127]
  ds_read_b64_tr_b16 a[222:223], v239 offset:11520
  v_add_u32 v228, 147456, v229
  v_mfma_f32_16x16x32_bf16 v[128:131], a[200:203], v[208:211], v[128:131]
  s_waitcnt lgkmcnt(8)
  v_exp_f32 v174, v174
  v_mfma_f32_16x16x32_bf16 v[132:135], a[204:207], v[192:195], v[132:135]
  ds_read_b128 a[192:195], v228 offset:0
  v_cvt_pk_bf16_f32 v170, v172, v173
  v_mfma_f32_16x16x32_bf16 v[136:139], a[204:207], v[200:203], v[136:139]
  v_exp_f32 v175, v175
  v_mfma_f32_16x16x32_bf16 v[140:143], a[204:207], v[208:211], v[140:143]
  s_waitcnt lgkmcnt(7)
  v_exp_f32 v180, v180
  v_mfma_f32_16x16x32_bf16 v[144:147], a[208:211], v[192:195], v[144:147]
  ds_read_b128 a[196:199], v228 offset:256
  v_add_f32 v234, v174, v234
  v_mfma_f32_16x16x32_bf16 v[148:151], a[208:211], v[200:203], v[148:151]
  v_exp_f32 v181, v181
  v_mfma_f32_16x16x32_bf16 v[152:155], a[208:211], v[208:211], v[152:155]
  s_waitcnt lgkmcnt(6)
  v_exp_f32 v182, v182
  v_mfma_f32_16x16x32_bf16 v[156:159], a[212:215], v[192:195], v[156:159]
  ds_read_b128 a[200:203], v228 offset:1024
  v_add_f32 v234, v175, v234
  v_mfma_f32_16x16x32_bf16 v[160:163], a[212:215], v[200:203], v[160:163]
  v_exp_f32 v183, v183
  v_mfma_f32_16x16x32_bf16 v[164:167], a[212:215], v[208:211], v[164:167]
  s_waitcnt lgkmcnt(5)
  v_exp_f32 v188, v188
  v_mfma_f32_16x16x32_bf16 a[224:227], a[216:219], v[192:195], a[224:227]
  ds_read_b128 a[204:207], v228 offset:1280
  v_cvt_pk_bf16_f32 v171, v174, v175
  v_mfma_f32_16x16x32_bf16 a[228:231], a[216:219], v[200:203], a[228:231]
  v_exp_f32 v189, v189
  v_mfma_f32_16x16x32_bf16 a[232:235], a[216:219], v[208:211], a[232:235]
  s_waitcnt lgkmcnt(4)
  v_exp_f32 v190, v190
  v_mfma_f32_16x16x32_bf16 a[236:239], a[220:223], v[192:195], a[236:239]
  ds_read_b128 a[208:211], v228 offset:2048
  v_add_f32 v235, v180, v235
  v_mfma_f32_16x16x32_bf16 a[240:243], a[220:223], v[200:203], a[240:243]
  v_exp_f32 v191, v191
  v_mfma_f32_16x16x32_bf16 a[244:247], a[220:223], v[208:211], a[244:247]
  s_waitcnt lgkmcnt(4)
  v_add_f32 v235, v181, v235
  v_add_f32 v236, v188, v236
  v_mfma_f32_16x16x32_bf16 v[192:195], a[192:195], a[0:3], v[216:219]
  s_add_u32 m0, s28, 49152
  ds_read_b128 a[212:215], v228 offset:2304
  v_cvt_pk_bf16_f32 v178, v180, v181
  v_mfma_f32_16x16x32_bf16 v[200:203], a[192:195], a[4:7], v[220:223]
  s_mov_b32 s29, 166912
  v_add_f32 v235, v182, v235
  v_add_f32 v236, v189, v236
  v_mfma_f32_16x16x32_bf16 v[208:211], a[192:195], a[8:11], v[224:227]
  s_waitcnt lgkmcnt(4)
  v_add_f32 v235, v183, v235
  v_cvt_pk_bf16_f32 v186, v188, v189
  v_mfma_f32_16x16x32_bf16 v[192:195], a[196:199], a[12:15], v[192:195]
  ds_read_b128 a[216:219], v228 offset:3072
  v_cvt_pk_bf16_f32 v179, v182, v183
  v_mfma_f32_16x16x32_bf16 v[200:203], a[196:199], a[16:19], v[200:203]
  v_add_f32 v236, v190, v236
  v_mfma_f32_16x16x32_bf16 v[208:211], a[196:199], a[20:23], v[208:211]
  s_waitcnt lgkmcnt(4)
  v_add_f32 v236, v191, v236
  v_mfma_f32_16x16x32_bf16 v[192:195], a[200:203], a[24:27], v[192:195]
  ds_read_b128 a[220:223], v228 offset:3328
  v_cvt_pk_bf16_f32 v187, v190, v191
  v_mfma_f32_16x16x32_bf16 v[200:203], a[200:203], a[28:31], v[200:203]
  buffer_load_dwordx4 v231, s[8:11], s29 offen offset:0 nt lds
  v_mfma_f32_16x16x32_bf16 v[208:211], a[200:203], a[32:35], v[208:211]
  s_waitcnt lgkmcnt(4)
  v_mfma_f32_16x16x32_bf16 v[192:195], a[204:207], a[36:39], v[192:195]
  s_add_u32 s29, s29, s30
  ds_read_b128 a[192:195], v228 offset:8192
  v_mfma_f32_16x16x32_bf16 v[200:203], a[204:207], a[40:43], v[200:203]
  v_mfma_f32_16x16x32_bf16 v[208:211], a[204:207], a[44:47], v[208:211]
  s_waitcnt lgkmcnt(4)
  v_mfma_f32_16x16x32_bf16 v[192:195], a[208:211], a[48:51], v[192:195]
  ds_read_b128 a[196:199], v228 offset:8448
  v_mfma_f32_16x16x32_bf16 v[200:203], a[208:211], a[52:55], v[200:203]
  buffer_load_dwordx4 v231, s[8:11], s29 offen offset:1024 nt lds
  v_mfma_f32_16x16x32_bf16 v[208:211], a[208:211], a[56:59], v[208:211]
  s_waitcnt lgkmcnt(4)
  v_mfma_f32_16x16x32_bf16 v[192:195], a[212:215], a[60:63], v[192:195]
  s_add_u32 s29, s29, s30
  ds_read_b128 a[200:203], v228 offset:9216
  v_mfma_f32_16x16x32_bf16 v[200:203], a[212:215], a[64:67], v[200:203]
  v_mfma_f32_16x16x32_bf16 v[208:211], a[212:215], a[68:71], v[208:211]
  s_waitcnt lgkmcnt(4)
  v_mfma_f32_16x16x32_bf16 v[192:195], a[216:219], a[72:75], v[192:195]
  ds_read_b128 a[204:207], v228 offset:9472
  v_mfma_f32_16x16x32_bf16 v[200:203], a[216:219], a[76:79], v[200:203]
  buffer_load_dwordx4 v231, s[8:11], s29 offen offset:2048 nt lds
  v_mfma_f32_16x16x32_bf16 v[208:211], a[216:219], a[80:83], v[208:211]
  s_waitcnt lgkmcnt(4)
  v_mfma_f32_16x16x32_bf16 v[192:195], a[220:223], a[84:87], v[192:195]
  s_add_u32 s29, s29, s30
  ds_read_b128 a[208:211], v228 offset:10240
  v_mfma_f32_16x16x32_bf16 v[200:203], a[220:223], a[88:91], v[200:203]
  v_mfma_f32_16x16x32_bf16 v[208:211], a[220:223], a[92:95], v[208:211]
  s_waitcnt lgkmcnt(4)
  v_mfma_f32_16x16x32_bf16 v[196:199], a[192:195], a[0:3], v[216:219]
  ds_read_b128 a[212:215], v228 offset:10496
  v_mfma_f32_16x16x32_bf16 v[204:207], a[192:195], a[4:7], v[220:223]
  buffer_load_dwordx4 v231, s[8:11], s29 offen offset:3072 nt lds
  v_mfma_f32_16x16x32_bf16 v[212:215], a[192:195], a[8:11], v[224:227]
  s_waitcnt lgkmcnt(4)
  v_exp_f32 v192, v192
  v_mfma_f32_16x16x32_bf16 v[196:199], a[196:199], a[12:15], v[196:199]
  s_waitcnt vmcnt(4)
  ds_read_b128 a[216:219], v228 offset:11264
  v_add_f32 v234, v192, v234
  v_mfma_f32_16x16x32_bf16 v[204:207], a[196:199], a[16:19], v[204:207]
  s_barrier
  v_exp_f32 v193, v193
  v_mfma_f32_16x16x32_bf16 v[212:215], a[196:199], a[20:23], v[212:215]
  s_waitcnt lgkmcnt(4)
  v_exp_f32 v194, v194
  v_mfma_f32_16x16x32_bf16 v[196:199], a[200:203], a[24:27], v[196:199]
  ds_read_b128 a[220:223], v228 offset:11520
  v_add_u32 v228, 0, v230
  v_mfma_f32_16x16x32_bf16 v[204:207], a[200:203], a[28:31], v[204:207]
  v_xor_b32 v239, 32, v228
  v_mfma_f32_16x16x32_bf16 v[212:215], a[200:203], a[32:35], v[212:215]
  s_waitcnt lgkmcnt(4)
  v_exp_f32 v195, v195
  v_mfma_f32_16x16x32_bf16 v[196:199], a[204:207], a[36:39], v[196:199]
  ds_read_b64_tr_b16 a[192:193], v228 offset:0
  v_add_f32 v234, v193, v234
  v_mfma_f32_16x16x32_bf16 v[204:207], a[204:207], a[40:43], v[204:207]
  ds_read_b64_tr_b16 a[194:195], v228 offset:8192
  v_cvt_pk_bf16_f32 v192, v192, v193
  v_mfma_f32_16x16x32_bf16 v[212:215], a[204:207], a[44:47], v[212:215]
  s_waitcnt lgkmcnt(5)
  v_exp_f32 v200, v200
  v_mfma_f32_16x16x32_bf16 v[196:199], a[208:211], a[48:51], v[196:199]
  ds_read_b64_tr_b16 a[196:197], v239 offset:0
  v_add_f32 v234, v194, v234
  v_mfma_f32_16x16x32_bf16 v[204:207], a[208:211], a[52:55], v[204:207]
  ds_read_b64_tr_b16 a[198:199], v239 offset:8192
  v_add_f32 v234, v195, v234
  v_mfma_f32_16x16x32_bf16 v[212:215], a[208:211], a[56:59], v[212:215]
  s_waitcnt lgkmcnt(6)
  v_exp_f32 v201, v201
  v_mfma_f32_16x16x32_bf16 v[196:199], a[212:215], a[60:63], v[196:199]
  ds_read_b64_tr_b16 a[200:201], v228 offset:256
  v_cvt_pk_bf16_f32 v193, v194, v195
  v_mfma_f32_16x16x32_bf16 v[204:207], a[212:215], a[64:67], v[204:207]
  ds_read_b64_tr_b16 a[202:203], v228 offset:8448
  v_add_f32 v235, v200, v235
  v_mfma_f32_16x16x32_bf16 v[212:215], a[212:215], a[68:71], v[212:215]
  s_waitcnt lgkmcnt(7)
  v_exp_f32 v202, v202
  v_mfma_f32_16x16x32_bf16 v[196:199], a[216:219], a[72:75], v[196:199]
  ds_read_b64_tr_b16 a[204:205], v239 offset:256
  v_add_f32 v235, v201, v235
  v_mfma_f32_16x16x32_bf16 v[204:207], a[216:219], a[76:79], v[204:207]
  ds_read_b64_tr_b16 a[206:207], v239 offset:8448
  v_cvt_pk_bf16_f32 v200, v200, v201
  v_mfma_f32_16x16x32_bf16 v[212:215], a[216:219], a[80:83], v[212:215]
  s_waitcnt lgkmcnt(8)
  v_exp_f32 v203, v203
  v_mfma_f32_16x16x32_bf16 v[196:199], a[220:223], a[84:87], v[196:199]
  ds_read_b64_tr_b16 a[208:209], v228 offset:1024
  v_add_f32 v235, v202, v235
  v_mfma_f32_16x16x32_bf16 v[204:207], a[220:223], a[88:91], v[204:207]
  ds_read_b64_tr_b16 a[210:211], v228 offset:9216
  v_add_f32 v235, v203, v235
  v_mfma_f32_16x16x32_bf16 v[212:215], a[220:223], a[92:95], v[212:215]
  s_waitcnt lgkmcnt(8)
  v_exp_f32 v208, v208
  v_mfma_f32_16x16x32_bf16 v[0:3], a[192:195], v[168:171], v[0:3]
  s_add_u32 m0, s28, 81920
  ds_read_b64_tr_b16 a[212:213], v239 offset:1024
  v_cvt_pk_bf16_f32 v201, v202, v203
  v_mfma_f32_16x16x32_bf16 v[4:7], a[192:195], v[176:179], v[4:7]
  s_mov_b32 s29, 150528
  ds_read_b64_tr_b16 a[214:215], v239 offset:9216
  v_add_f32 v236, v208, v236
  v_mfma_f32_16x16x32_bf16 v[8:11], a[192:195], v[184:187], v[8:11]
  s_waitcnt lgkmcnt(8)
  v_exp_f32 v209, v209
  v_mfma_f32_16x16x32_bf16 v[12:15], a[196:199], v[168:171], v[12:15]
  ds_read_b64_tr_b16 a[216:217], v228 offset:1280
  v_add_f32 v236, v209, v236
  v_mfma_f32_16x16x32_bf16 v[16:19], a[196:199], v[176:179], v[16:19]
  ds_read_b64_tr_b16 a[218:219], v228 offset:9472
  v_cvt_pk_bf16_f32 v208, v208, v209
  v_mfma_f32_16x16x32_bf16 v[20:23], a[196:199], v[184:187], v[20:23]
  s_waitcnt lgkmcnt(8)
  v_exp_f32 v210, v210
  v_mfma_f32_16x16x32_bf16 v[24:27], a[200:203], v[168:171], v[24:27]
  ds_read_b64_tr_b16 a[220:221], v239 offset:1280
  v_add_f32 v236, v210, v236
  v_mfma_f32_16x16x32_bf16 v[28:31], a[200:203], v[176:179], v[28:31]
  buffer_load_dwordx4 v231, s[12:15], s29 offen offset:0 nt lds
  v_mfma_f32_16x16x32_bf16 v[32:35], a[200:203], v[184:187], v[32:35]
  s_waitcnt lgkmcnt(7)
  ds_read_b64_tr_b16 a[222:223], v239 offset:9472
  v_mfma_f32_16x16x32_bf16 v[36:39], a[204:207], v[168:171], v[36:39]
  s_add_u32 s29, s29, s30
  ds_read_b64_tr_b16 a[192:193], v228 offset:2048
  v_mfma_f32_16x16x32_bf16 v[40:43], a[204:207], v[176:179], v[40:43]
  ds_read_b64_tr_b16 a[194:195], v228 offset:10240
  v_mfma_f32_16x16x32_bf16 v[44:47], a[204:207], v[184:187], v[44:47]
  s_waitcnt lgkmcnt(8)
  v_exp_f32 v211, v211
  v_mfma_f32_16x16x32_bf16 v[48:51], a[208:211], v[168:171], v[48:51]
  ds_read_b64_tr_b16 a[196:197], v239 offset:2048
  v_add_f32 v236, v211, v236
  v_mfma_f32_16x16x32_bf16 v[52:55], a[208:211], v[176:179], v[52:55]
  buffer_load_dwordx4 v231, s[12:15], s29 offen offset:1024 nt lds
  v_mfma_f32_16x16x32_bf16 v[56:59], a[208:211], v[184:187], v[56:59]
  s_waitcnt lgkmcnt(7)
  ds_read_b64_tr_b16 a[198:199], v239 offset:10240
  v_cvt_pk_bf16_f32 v209, v210, v211
  v_mfma_f32_16x16x32_bf16 v[60:63], a[212:215], v[168:171], v[60:63]
  s_add_u32 s29, s29, s30
  ds_read_b64_tr_b16 a[200:201], v228 offset:2304
  v_mfma_f32_16x16x32_bf16 v[64:67], a[212:215], v[176:179], v[64:67]
  ds_read_b64_tr_b16 a[202:203], v228 offset:10496
  v_mfma_f32_16x16x32_bf16 v[68:71], a[212:215], v[184:187], v[68:71]
  s_waitcnt lgkmcnt(8)
  v_exp_f32 v196, v196
  v_mfma_f32_16x16x32_bf16 v[72:75], a[216:219], v[168:171], v[72:75]
  ds_read_b64_tr_b16 a[204:205], v239 offset:2304
  v_add_f32 v234, v196, v234
  v_mfma_f32_16x16x32_bf16 v[76:79], a[216:219], v[176:179], v[76:79]
  buffer_load_dwordx4 v231, s[12:15], s29 offen offset:2048 nt lds
  v_mfma_f32_16x16x32_bf16 v[80:83], a[216:219], v[184:187], v[80:83]
  s_waitcnt lgkmcnt(7)
  ds_read_b64_tr_b16 a[206:207], v239 offset:10496
  v_mfma_f32_16x16x32_bf16 v[84:87], a[220:223], v[168:171], v[84:87]
  s_add_u32 s29, s29, s30
  ds_read_b64_tr_b16 a[208:209], v228 offset:3072
  v_mfma_f32_16x16x32_bf16 v[88:91], a[220:223], v[176:179], v[88:91]
  ds_read_b64_tr_b16 a[210:211], v228 offset:11264
  v_mfma_f32_16x16x32_bf16 v[92:95], a[220:223], v[184:187], v[92:95]
  s_waitcnt lgkmcnt(8)
  v_exp_f32 v197, v197
  v_mfma_f32_16x16x32_bf16 v[96:99], a[192:195], v[168:171], v[96:99]
  ds_read_b64_tr_b16 a[212:213], v239 offset:3072
  v_add_f32 v234, v197, v234
  v_mfma_f32_16x16x32_bf16 v[100:103], a[192:195], v[176:179], v[100:103]
  buffer_load_dwordx4 v231, s[12:15], s29 offen offset:3072 nt lds
  v_mfma_f32_16x16x32_bf16 v[104:107], a[192:195], v[184:187], v[104:107]
  s_waitcnt lgkmcnt(7)
  ds_read_b64_tr_b16 a[214:215], v239 offset:11264
  v_cvt_pk_bf16_f32 v194, v196, v197
  v_mfma_f32_16x16x32_bf16 v[108:111], a[196:199], v[168:171], v[108:111]
  s_waitcnt vmcnt(4)
  ds_read_b64_tr_b16 a[216:217], v228 offset:3328
  v_mfma_f32_16x16x32_bf16 v[112:115], a[196:199], v[176:179], v[112:115]
  s_barrier
  ds_read_b64_tr_b16 a[218:219], v228 offset:11520
  v_mfma_f32_16x16x32_bf16 v[116:119], a[196:199], v[184:187], v[116:119]
  s_waitcnt lgkmcnt(8)
  v_exp_f32 v198, v198
  v_mfma_f32_16x16x32_bf16 v[120:123], a[200:203], v[168:171], v[120:123]
  ds_read_b64_tr_b16 a[220:221], v239 offset:3328
  v_add_f32 v234, v198, v234
  v_mfma_f32_16x16x32_bf16 v[124:127], a[200:203], v[176:179], v[124:127]
  ds_read_b64_tr_b16 a[222:223], v239 offset:11520
  v_add_u32 v228, 49152, v229
  v_mfma_f32_16x16x32_bf16 v[128:131], a[200:203], v[184:187], v[128:131]
  s_waitcnt lgkmcnt(8)
  v_exp_f32 v199, v199
  v_mfma_f32_16x16x32_bf16 v[132:135], a[204:207], v[168:171], v[132:135]
  ds_read_b128 a[192:195], v228 offset:0
  v_add_f32 v234, v199, v234
  v_mfma_f32_16x16x32_bf16 v[136:139], a[204:207], v[176:179], v[136:139]
  v_exp_f32 v204, v204
  v_mfma_f32_16x16x32_bf16 v[140:143], a[204:207], v[184:187], v[140:143]
  s_waitcnt lgkmcnt(7)
  v_exp_f32 v205, v205
  v_mfma_f32_16x16x32_bf16 v[144:147], a[208:211], v[168:171], v[144:147]
  ds_read_b128 a[196:199], v228 offset:256
  v_cvt_pk_bf16_f32 v195, v198, v199
  v_mfma_f32_16x16x32_bf16 v[148:151], a[208:211], v[176:179], v[148:151]
  v_exp_f32 v206, v206
  v_mfma_f32_16x16x32_bf16 v[152:155], a[208:211], v[184:187], v[152:155]
  s_waitcnt lgkmcnt(6)
  v_exp_f32 v207, v207
  v_mfma_f32_16x16x32_bf16 v[156:159], a[212:215], v[168:171], v[156:159]
  ds_read_b128 a[200:203], v228 offset:1024
  v_add_f32 v235, v204, v235
  v_mfma_f32_16x16x32_bf16 v[160:163], a[212:215], v[176:179], v[160:163]
  v_exp_f32 v212, v212
  v_mfma_f32_16x16x32_bf16 v[164:167], a[212:215], v[184:187], v[164:167]
  s_waitcnt lgkmcnt(5)
  v_exp_f32 v213, v213
  v_mfma_f32_16x16x32_bf16 a[224:227], a[216:219], v[168:171], a[224:227]
  ds_read_b128 a[204:207], v228 offset:1280
  v_add_f32 v235, v205, v235
  v_mfma_f32_16x16x32_bf16 a[228:231], a[216:219], v[176:179], a[228:231]
  v_exp_f32 v214, v214
  v_mfma_f32_16x16x32_bf16 a[232:235], a[216:219], v[184:187], a[232:235]
  s_waitcnt lgkmcnt(4)
  v_exp_f32 v215, v215
  v_mfma_f32_16x16x32_bf16 a[236:239], a[220:223], v[168:171], a[236:239]
  ds_read_b128 a[208:211], v228 offset:2048
  v_cvt_pk_bf16_f32 v202, v204, v205
  v_mfma_f32_16x16x32_bf16 a[240:243], a[220:223], v[176:179], a[240:243]
  v_add_f32 v235, v206, v235
  v_add_f32 v236, v212, v236
  v_mfma_f32_16x16x32_bf16 a[244:247], a[220:223], v[184:187], a[244:247]
  s_waitcnt lgkmcnt(4)
  v_add_f32 v235, v207, v235
  v_add_f32 v236, v213, v236
  v_mfma_f32_16x16x32_bf16 v[168:171], a[192:195], a[0:3], v[216:219]
  s_add_u32 m0, s28, 131072
  ds_read_b128 a[212:215], v228 offset:2304
  v_cvt_pk_bf16_f32 v203, v206, v207
  v_mfma_f32_16x16x32_bf16 v[176:179], a[192:195], a[4:7], v[220:223]
  s_mov_b32 s29, 183296
  v_cvt_pk_bf16_f32 v210, v212, v213
  v_add_f32 v236, v214, v236
  v_mfma_f32_16x16x32_bf16 v[184:187], a[192:195], a[8:11], v[224:227]
  s_waitcnt lgkmcnt(4)
  v_add_f32 v236, v215, v236
  v_mfma_f32_16x16x32_bf16 v[168:171], a[196:199], a[12:15], v[168:171]
  ds_read_b128 a[216:219], v228 offset:3072
  v_cvt_pk_bf16_f32 v211, v214, v215
  v_mfma_f32_16x16x32_bf16 v[176:179], a[196:199], a[16:19], v[176:179]
  v_mfma_f32_16x16x32_bf16 v[184:187], a[196:199], a[20:23], v[184:187]
  s_waitcnt lgkmcnt(4)
  v_mfma_f32_16x16x32_bf16 v[168:171], a[200:203], a[24:27], v[168:171]
  ds_read_b128 a[220:223], v228 offset:3328
  v_mfma_f32_16x16x32_bf16 v[176:179], a[200:203], a[28:31], v[176:179]
  buffer_load_dwordx4 v231, s[8:11], s29 offen offset:0 nt lds
  v_mfma_f32_16x16x32_bf16 v[184:187], a[200:203], a[32:35], v[184:187]
  s_waitcnt lgkmcnt(4)
  v_mfma_f32_16x16x32_bf16 v[168:171], a[204:207], a[36:39], v[168:171]
  s_add_u32 s29, s29, s30
  ds_read_b128 a[192:195], v228 offset:8192
  v_mfma_f32_16x16x32_bf16 v[176:179], a[204:207], a[40:43], v[176:179]
  v_mfma_f32_16x16x32_bf16 v[184:187], a[204:207], a[44:47], v[184:187]
  s_waitcnt lgkmcnt(4)
  v_mfma_f32_16x16x32_bf16 v[168:171], a[208:211], a[48:51], v[168:171]
  ds_read_b128 a[196:199], v228 offset:8448
  v_mfma_f32_16x16x32_bf16 v[176:179], a[208:211], a[52:55], v[176:179]
  buffer_load_dwordx4 v231, s[8:11], s29 offen offset:1024 nt lds
  v_mfma_f32_16x16x32_bf16 v[184:187], a[208:211], a[56:59], v[184:187]
  s_waitcnt lgkmcnt(4)
  v_mfma_f32_16x16x32_bf16 v[168:171], a[212:215], a[60:63], v[168:171]
  s_add_u32 s29, s29, s30
  ds_read_b128 a[200:203], v228 offset:9216
  v_mfma_f32_16x16x32_bf16 v[176:179], a[212:215], a[64:67], v[176:179]
  v_mfma_f32_16x16x32_bf16 v[184:187], a[212:215], a[68:71], v[184:187]
  s_waitcnt lgkmcnt(4)
  v_mfma_f32_16x16x32_bf16 v[168:171], a[216:219], a[72:75], v[168:171]
  ds_read_b128 a[204:207], v228 offset:9472
  v_mfma_f32_16x16x32_bf16 v[176:179], a[216:219], a[76:79], v[176:179]
  buffer_load_dwordx4 v231, s[8:11], s29 offen offset:2048 nt lds
  v_mfma_f32_16x16x32_bf16 v[184:187], a[216:219], a[80:83], v[184:187]
  s_waitcnt lgkmcnt(4)
  v_mfma_f32_16x16x32_bf16 v[168:171], a[220:223], a[84:87], v[168:171]
  s_add_u32 s29, s29, s30
  ds_read_b128 a[208:211], v228 offset:10240
  v_mfma_f32_16x16x32_bf16 v[176:179], a[220:223], a[88:91], v[176:179]
  v_mfma_f32_16x16x32_bf16 v[184:187], a[220:223], a[92:95], v[184:187]
  s_waitcnt lgkmcnt(4)
  v_mfma_f32_16x16x32_bf16 v[172:175], a[192:195], a[0:3], v[216:219]
  ds_read_b128 a[212:215], v228 offset:10496
  v_mfma_f32_16x16x32_bf16 v[180:183], a[192:195], a[4:7], v[220:223]
  buffer_load_dwordx4 v231, s[8:11], s29 offen offset:3072 nt lds
  v_mfma_f32_16x16x32_bf16 v[188:191], a[192:195], a[8:11], v[224:227]
  s_waitcnt lgkmcnt(4)
  v_exp_f32 v168, v168
  v_mfma_f32_16x16x32_bf16 v[172:175], a[196:199], a[12:15], v[172:175]
  s_waitcnt vmcnt(4)
  ds_read_b128 a[216:219], v228 offset:11264
  v_add_f32 v234, v168, v234
  v_mfma_f32_16x16x32_bf16 v[180:183], a[196:199], a[16:19], v[180:183]
  s_barrier
  v_exp_f32 v169, v169
  v_mfma_f32_16x16x32_bf16 v[188:191], a[196:199], a[20:23], v[188:191]
  s_waitcnt lgkmcnt(4)
  v_exp_f32 v170, v170
  v_mfma_f32_16x16x32_bf16 v[172:175], a[200:203], a[24:27], v[172:175]
  ds_read_b128 a[220:223], v228 offset:11520
  v_add_u32 v228, 81920, v230
  v_mfma_f32_16x16x32_bf16 v[180:183], a[200:203], a[28:31], v[180:183]
  v_xor_b32 v239, 32, v228
  v_mfma_f32_16x16x32_bf16 v[188:191], a[200:203], a[32:35], v[188:191]
  s_waitcnt lgkmcnt(4)
  v_exp_f32 v171, v171
  v_mfma_f32_16x16x32_bf16 v[172:175], a[204:207], a[36:39], v[172:175]
  ds_read_b64_tr_b16 a[192:193], v228 offset:0
  v_add_f32 v234, v169, v234
  v_mfma_f32_16x16x32_bf16 v[180:183], a[204:207], a[40:43], v[180:183]
  ds_read_b64_tr_b16 a[194:195], v228 offset:8192
  v_cvt_pk_bf16_f32 v168, v168, v169
  v_mfma_f32_16x16x32_bf16 v[188:191], a[204:207], a[44:47], v[188:191]
  s_waitcnt lgkmcnt(5)
  v_exp_f32 v176, v176
  v_mfma_f32_16x16x32_bf16 v[172:175], a[208:211], a[48:51], v[172:175]
  ds_read_b64_tr_b16 a[196:197], v239 offset:0
  v_add_f32 v234, v170, v234
  v_mfma_f32_16x16x32_bf16 v[180:183], a[208:211], a[52:55], v[180:183]
  ds_read_b64_tr_b16 a[198:199], v239 offset:8192
  v_add_f32 v234, v171, v234
  v_mfma_f32_16x16x32_bf16 v[188:191], a[208:211], a[56:59], v[188:191]
  s_waitcnt lgkmcnt(6)
  v_exp_f32 v177, v177
  v_mfma_f32_16x16x32_bf16 v[172:175], a[212:215], a[60:63], v[172:175]
  ds_read_b64_tr_b16 a[200:201], v228 offset:256
  v_cvt_pk_bf16_f32 v169, v170, v171
  v_mfma_f32_16x16x32_bf16 v[180:183], a[212:215], a[64:67], v[180:183]
  ds_read_b64_tr_b16 a[202:203], v228 offset:8448
  v_add_f32 v235, v176, v235
  v_mfma_f32_16x16x32_bf16 v[188:191], a[212:215], a[68:71], v[188:191]
  s_waitcnt lgkmcnt(7)
  v_exp_f32 v178, v178
  v_mfma_f32_16x16x32_bf16 v[172:175], a[216:219], a[72:75], v[172:175]
  ds_read_b64_tr_b16 a[204:205], v239 offset:256
  v_add_f32 v235, v177, v235
  v_mfma_f32_16x16x32_bf16 v[180:183], a[216:219], a[76:79], v[180:183]
  ds_read_b64_tr_b16 a[206:207], v239 offset:8448
  v_cvt_pk_bf16_f32 v176, v176, v177
  v_mfma_f32_16x16x32_bf16 v[188:191], a[216:219], a[80:83], v[188:191]
  s_waitcnt lgkmcnt(8)
  v_exp_f32 v179, v179
  v_mfma_f32_16x16x32_bf16 v[172:175], a[220:223], a[84:87], v[172:175]
  ds_read_b64_tr_b16 a[208:209], v228 offset:1024
  v_add_f32 v235, v178, v235
  v_mfma_f32_16x16x32_bf16 v[180:183], a[220:223], a[88:91], v[180:183]
  ds_read_b64_tr_b16 a[210:211], v228 offset:9216
  v_add_f32 v235, v179, v235
  v_mfma_f32_16x16x32_bf16 v[188:191], a[220:223], a[92:95], v[188:191]
  s_waitcnt lgkmcnt(8)
  v_exp_f32 v184, v184
  v_mfma_f32_16x16x32_bf16 v[0:3], a[192:195], v[192:195], v[0:3]
  s_add_u32 m0, s28, 147456
  ds_read_b64_tr_b16 a[212:213], v239 offset:1024
  v_cvt_pk_bf16_f32 v177, v178, v179
  v_mfma_f32_16x16x32_bf16 v[4:7], a[192:195], v[200:203], v[4:7]
  s_mov_b32 s29, 166912
  ds_read_b64_tr_b16 a[214:215], v239 offset:9216
  v_add_f32 v236, v184, v236
  v_mfma_f32_16x16x32_bf16 v[8:11], a[192:195], v[208:211], v[8:11]
  s_waitcnt lgkmcnt(8)
  v_exp_f32 v185, v185
  v_mfma_f32_16x16x32_bf16 v[12:15], a[196:199], v[192:195], v[12:15]
  ds_read_b64_tr_b16 a[216:217], v228 offset:1280
  v_add_f32 v236, v185, v236
  v_mfma_f32_16x16x32_bf16 v[16:19], a[196:199], v[200:203], v[16:19]
  ds_read_b64_tr_b16 a[218:219], v228 offset:9472
  v_cvt_pk_bf16_f32 v184, v184, v185
  v_mfma_f32_16x16x32_bf16 v[20:23], a[196:199], v[208:211], v[20:23]
  s_waitcnt lgkmcnt(8)
  v_exp_f32 v186, v186
  v_mfma_f32_16x16x32_bf16 v[24:27], a[200:203], v[192:195], v[24:27]
  ds_read_b64_tr_b16 a[220:221], v239 offset:1280
  v_add_f32 v236, v186, v236
  v_mfma_f32_16x16x32_bf16 v[28:31], a[200:203], v[200:203], v[28:31]
  buffer_load_dwordx4 v231, s[12:15], s29 offen offset:0 nt lds
  v_mfma_f32_16x16x32_bf16 v[32:35], a[200:203], v[208:211], v[32:35]
  s_waitcnt lgkmcnt(7)
  ds_read_b64_tr_b16 a[222:223], v239 offset:9472
  v_mfma_f32_16x16x32_bf16 v[36:39], a[204:207], v[192:195], v[36:39]
  s_add_u32 s29, s29, s30
  ds_read_b64_tr_b16 a[192:193], v228 offset:2048
  v_mfma_f32_16x16x32_bf16 v[40:43], a[204:207], v[200:203], v[40:43]
  ds_read_b64_tr_b16 a[194:195], v228 offset:10240
  v_mfma_f32_16x16x32_bf16 v[44:47], a[204:207], v[208:211], v[44:47]
  s_waitcnt lgkmcnt(8)
  v_exp_f32 v187, v187
  v_mfma_f32_16x16x32_bf16 v[48:51], a[208:211], v[192:195], v[48:51]
  ds_read_b64_tr_b16 a[196:197], v239 offset:2048
  v_add_f32 v236, v187, v236
  v_mfma_f32_16x16x32_bf16 v[52:55], a[208:211], v[200:203], v[52:55]
  buffer_load_dwordx4 v231, s[12:15], s29 offen offset:1024 nt lds
  v_mfma_f32_16x16x32_bf16 v[56:59], a[208:211], v[208:211], v[56:59]
  s_waitcnt lgkmcnt(7)
  ds_read_b64_tr_b16 a[198:199], v239 offset:10240
  v_cvt_pk_bf16_f32 v185, v186, v187
  v_mfma_f32_16x16x32_bf16 v[60:63], a[212:215], v[192:195], v[60:63]
  s_add_u32 s29, s29, s30
  ds_read_b64_tr_b16 a[200:201], v228 offset:2304
  v_mfma_f32_16x16x32_bf16 v[64:67], a[212:215], v[200:203], v[64:67]
  ds_read_b64_tr_b16 a[202:203], v228 offset:10496
  v_mfma_f32_16x16x32_bf16 v[68:71], a[212:215], v[208:211], v[68:71]
  s_waitcnt lgkmcnt(8)
  v_exp_f32 v172, v172
  v_mfma_f32_16x16x32_bf16 v[72:75], a[216:219], v[192:195], v[72:75]
  ds_read_b64_tr_b16 a[204:205], v239 offset:2304
  v_add_f32 v234, v172, v234
  v_mfma_f32_16x16x32_bf16 v[76:79], a[216:219], v[200:203], v[76:79]
  buffer_load_dwordx4 v231, s[12:15], s29 offen offset:2048 nt lds
  v_mfma_f32_16x16x32_bf16 v[80:83], a[216:219], v[208:211], v[80:83]
  s_waitcnt lgkmcnt(7)
  ds_read_b64_tr_b16 a[206:207], v239 offset:10496
  v_mfma_f32_16x16x32_bf16 v[84:87], a[220:223], v[192:195], v[84:87]
  s_add_u32 s29, s29, s30
  ds_read_b64_tr_b16 a[208:209], v228 offset:3072
  v_mfma_f32_16x16x32_bf16 v[88:91], a[220:223], v[200:203], v[88:91]
  ds_read_b64_tr_b16 a[210:211], v228 offset:11264
  v_mfma_f32_16x16x32_bf16 v[92:95], a[220:223], v[208:211], v[92:95]
  s_waitcnt lgkmcnt(8)
  v_exp_f32 v173, v173
  v_mfma_f32_16x16x32_bf16 v[96:99], a[192:195], v[192:195], v[96:99]
  ds_read_b64_tr_b16 a[212:213], v239 offset:3072
  v_add_f32 v234, v173, v234
  v_mfma_f32_16x16x32_bf16 v[100:103], a[192:195], v[200:203], v[100:103]
  buffer_load_dwordx4 v231, s[12:15], s29 offen offset:3072 nt lds
  v_mfma_f32_16x16x32_bf16 v[104:107], a[192:195], v[208:211], v[104:107]
  s_waitcnt lgkmcnt(7)
  ds_read_b64_tr_b16 a[214:215], v239 offset:11264
  v_cvt_pk_bf16_f32 v170, v172, v173
  v_mfma_f32_16x16x32_bf16 v[108:111], a[196:199], v[192:195], v[108:111]
  s_waitcnt vmcnt(4)
  ds_read_b64_tr_b16 a[216:217], v228 offset:3328
  v_mfma_f32_16x16x32_bf16 v[112:115], a[196:199], v[200:203], v[112:115]
  s_barrier
  ds_read_b64_tr_b16 a[218:219], v228 offset:11520
  v_mfma_f32_16x16x32_bf16 v[116:119], a[196:199], v[208:211], v[116:119]
  s_waitcnt lgkmcnt(8)
  v_exp_f32 v174, v174
  v_mfma_f32_16x16x32_bf16 v[120:123], a[200:203], v[192:195], v[120:123]
  ds_read_b64_tr_b16 a[220:221], v239 offset:3328
  v_add_f32 v234, v174, v234
  v_mfma_f32_16x16x32_bf16 v[124:127], a[200:203], v[200:203], v[124:127]
  ds_read_b64_tr_b16 a[222:223], v239 offset:11520
  v_add_u32 v228, 131072, v229
  v_mfma_f32_16x16x32_bf16 v[128:131], a[200:203], v[208:211], v[128:131]
  s_waitcnt lgkmcnt(8)
  v_exp_f32 v175, v175
  v_mfma_f32_16x16x32_bf16 v[132:135], a[204:207], v[192:195], v[132:135]
  ds_read_b128 a[192:195], v228 offset:0
  v_add_f32 v234, v175, v234
  v_mfma_f32_16x16x32_bf16 v[136:139], a[204:207], v[200:203], v[136:139]
  v_exp_f32 v180, v180
  v_mfma_f32_16x16x32_bf16 v[140:143], a[204:207], v[208:211], v[140:143]
  s_waitcnt lgkmcnt(7)
  v_exp_f32 v181, v181
  v_mfma_f32_16x16x32_bf16 v[144:147], a[208:211], v[192:195], v[144:147]
  ds_read_b128 a[196:199], v228 offset:256
  v_cvt_pk_bf16_f32 v171, v174, v175
  v_mfma_f32_16x16x32_bf16 v[148:151], a[208:211], v[200:203], v[148:151]
  v_exp_f32 v182, v182
  v_mfma_f32_16x16x32_bf16 v[152:155], a[208:211], v[208:211], v[152:155]
  s_waitcnt lgkmcnt(6)
  v_exp_f32 v183, v183
  v_mfma_f32_16x16x32_bf16 v[156:159], a[212:215], v[192:195], v[156:159]
  ds_read_b128 a[200:203], v228 offset:1024
  v_add_f32 v235, v180, v235
  v_mfma_f32_16x16x32_bf16 v[160:163], a[212:215], v[200:203], v[160:163]
  v_exp_f32 v188, v188
  v_mfma_f32_16x16x32_bf16 v[164:167], a[212:215], v[208:211], v[164:167]
  s_waitcnt lgkmcnt(5)
  v_exp_f32 v189, v189
  v_mfma_f32_16x16x32_bf16 a[224:227], a[216:219], v[192:195], a[224:227]
  ds_read_b128 a[204:207], v228 offset:1280
  v_add_f32 v235, v181, v235
  v_mfma_f32_16x16x32_bf16 a[228:231], a[216:219], v[200:203], a[228:231]
  v_exp_f32 v190, v190
  v_mfma_f32_16x16x32_bf16 a[232:235], a[216:219], v[208:211], a[232:235]
  s_waitcnt lgkmcnt(4)
  v_exp_f32 v191, v191
  v_mfma_f32_16x16x32_bf16 a[236:239], a[220:223], v[192:195], a[236:239]
  ds_read_b128 a[208:211], v228 offset:2048
  v_cvt_pk_bf16_f32 v178, v180, v181
  v_mfma_f32_16x16x32_bf16 a[240:243], a[220:223], v[200:203], a[240:243]
  v_add_f32 v235, v182, v235
  v_add_f32 v236, v188, v236
  v_mfma_f32_16x16x32_bf16 a[244:247], a[220:223], v[208:211], a[244:247]
  s_waitcnt lgkmcnt(4)
  v_add_f32 v235, v183, v235
  v_add_f32 v236, v189, v236
  v_mfma_f32_16x16x32_bf16 v[192:195], a[192:195], a[0:3], v[216:219]
  s_add_u32 m0, s28, 0
  ds_read_b128 a[212:215], v228 offset:2304
  v_cvt_pk_bf16_f32 v179, v182, v183
  v_mfma_f32_16x16x32_bf16 v[200:203], a[192:195], a[4:7], v[220:223]
  s_mov_b32 s29, 199680
  v_cvt_pk_bf16_f32 v186, v188, v189
  v_add_f32 v236, v190, v236
  v_mfma_f32_16x16x32_bf16 v[208:211], a[192:195], a[8:11], v[224:227]
  s_waitcnt lgkmcnt(4)
  v_add_f32 v236, v191, v236
  v_mfma_f32_16x16x32_bf16 v[192:195], a[196:199], a[12:15], v[192:195]
  ds_read_b128 a[216:219], v228 offset:3072
  v_cvt_pk_bf16_f32 v187, v190, v191
  v_mfma_f32_16x16x32_bf16 v[200:203], a[196:199], a[16:19], v[200:203]
  v_mfma_f32_16x16x32_bf16 v[208:211], a[196:199], a[20:23], v[208:211]
  s_waitcnt lgkmcnt(4)
  v_mfma_f32_16x16x32_bf16 v[192:195], a[200:203], a[24:27], v[192:195]
  ds_read_b128 a[220:223], v228 offset:3328
  v_mfma_f32_16x16x32_bf16 v[200:203], a[200:203], a[28:31], v[200:203]
  buffer_load_dwordx4 v231, s[8:11], s29 offen offset:0 nt lds
  v_mfma_f32_16x16x32_bf16 v[208:211], a[200:203], a[32:35], v[208:211]
  s_waitcnt lgkmcnt(4)
  v_mfma_f32_16x16x32_bf16 v[192:195], a[204:207], a[36:39], v[192:195]
  s_add_u32 s29, s29, s30
  ds_read_b128 a[192:195], v228 offset:8192
  v_mfma_f32_16x16x32_bf16 v[200:203], a[204:207], a[40:43], v[200:203]
  v_mfma_f32_16x16x32_bf16 v[208:211], a[204:207], a[44:47], v[208:211]
  s_waitcnt lgkmcnt(4)
  v_mfma_f32_16x16x32_bf16 v[192:195], a[208:211], a[48:51], v[192:195]
  ds_read_b128 a[196:199], v228 offset:8448
  v_mfma_f32_16x16x32_bf16 v[200:203], a[208:211], a[52:55], v[200:203]
  buffer_load_dwordx4 v231, s[8:11], s29 offen offset:1024 nt lds
  v_mfma_f32_16x16x32_bf16 v[208:211], a[208:211], a[56:59], v[208:211]
  s_waitcnt lgkmcnt(4)
  v_mfma_f32_16x16x32_bf16 v[192:195], a[212:215], a[60:63], v[192:195]
  s_add_u32 s29, s29, s30
  ds_read_b128 a[200:203], v228 offset:9216
  v_mfma_f32_16x16x32_bf16 v[200:203], a[212:215], a[64:67], v[200:203]
  v_mfma_f32_16x16x32_bf16 v[208:211], a[212:215], a[68:71], v[208:211]
  s_waitcnt lgkmcnt(4)
  v_mfma_f32_16x16x32_bf16 v[192:195], a[216:219], a[72:75], v[192:195]
  ds_read_b128 a[204:207], v228 offset:9472
  v_mfma_f32_16x16x32_bf16 v[200:203], a[216:219], a[76:79], v[200:203]
  buffer_load_dwordx4 v231, s[8:11], s29 offen offset:2048 nt lds
  v_mfma_f32_16x16x32_bf16 v[208:211], a[216:219], a[80:83], v[208:211]
  s_waitcnt lgkmcnt(4)
  v_mfma_f32_16x16x32_bf16 v[192:195], a[220:223], a[84:87], v[192:195]
  s_add_u32 s29, s29, s30
  ds_read_b128 a[208:211], v228 offset:10240
  v_mfma_f32_16x16x32_bf16 v[200:203], a[220:223], a[88:91], v[200:203]
  v_mfma_f32_16x16x32_bf16 v[208:211], a[220:223], a[92:95], v[208:211]
  s_waitcnt lgkmcnt(4)
  v_mfma_f32_16x16x32_bf16 v[196:199], a[192:195], a[0:3], v[216:219]
  ds_read_b128 a[212:215], v228 offset:10496
  v_mfma_f32_16x16x32_bf16 v[204:207], a[192:195], a[4:7], v[220:223]
  buffer_load_dwordx4 v231, s[8:11], s29 offen offset:3072 nt lds
  v_mfma_f32_16x16x32_bf16 v[212:215], a[192:195], a[8:11], v[224:227]
  s_waitcnt lgkmcnt(4)
  v_exp_f32 v192, v192
  v_mfma_f32_16x16x32_bf16 v[196:199], a[196:199], a[12:15], v[196:199]
  s_waitcnt vmcnt(4)
  ds_read_b128 a[216:219], v228 offset:11264
  v_add_f32 v234, v192, v234
  v_mfma_f32_16x16x32_bf16 v[204:207], a[196:199], a[16:19], v[204:207]
  s_barrier
  v_exp_f32 v193, v193
  v_mfma_f32_16x16x32_bf16 v[212:215], a[196:199], a[20:23], v[212:215]
  s_waitcnt lgkmcnt(4)
  v_exp_f32 v194, v194
  v_mfma_f32_16x16x32_bf16 v[196:199], a[200:203], a[24:27], v[196:199]
  ds_read_b128 a[220:223], v228 offset:11520
  v_add_u32 v228, 147456, v230
  v_mfma_f32_16x16x32_bf16 v[204:207], a[200:203], a[28:31], v[204:207]
  v_xor_b32 v239, 32, v228
  v_mfma_f32_16x16x32_bf16 v[212:215], a[200:203], a[32:35], v[212:215]
  s_waitcnt lgkmcnt(4)
  v_exp_f32 v195, v195
  v_mfma_f32_16x16x32_bf16 v[196:199], a[204:207], a[36:39], v[196:199]
  ds_read_b64_tr_b16 a[192:193], v228 offset:0
  v_add_f32 v234, v193, v234
  v_mfma_f32_16x16x32_bf16 v[204:207], a[204:207], a[40:43], v[204:207]
  ds_read_b64_tr_b16 a[194:195], v228 offset:8192
  v_cvt_pk_bf16_f32 v192, v192, v193
  v_mfma_f32_16x16x32_bf16 v[212:215], a[204:207], a[44:47], v[212:215]
  s_waitcnt lgkmcnt(5)
  v_exp_f32 v200, v200
  v_mfma_f32_16x16x32_bf16 v[196:199], a[208:211], a[48:51], v[196:199]
  ds_read_b64_tr_b16 a[196:197], v239 offset:0
  v_add_f32 v234, v194, v234
  v_mfma_f32_16x16x32_bf16 v[204:207], a[208:211], a[52:55], v[204:207]
  ds_read_b64_tr_b16 a[198:199], v239 offset:8192
  v_add_f32 v234, v195, v234
  v_mfma_f32_16x16x32_bf16 v[212:215], a[208:211], a[56:59], v[212:215]
  s_waitcnt lgkmcnt(6)
  v_exp_f32 v201, v201
  v_mfma_f32_16x16x32_bf16 v[196:199], a[212:215], a[60:63], v[196:199]
  ds_read_b64_tr_b16 a[200:201], v228 offset:256
  v_cvt_pk_bf16_f32 v193, v194, v195
  v_mfma_f32_16x16x32_bf16 v[204:207], a[212:215], a[64:67], v[204:207]
  ds_read_b64_tr_b16 a[202:203], v228 offset:8448
  v_add_f32 v235, v200, v235
  v_mfma_f32_16x16x32_bf16 v[212:215], a[212:215], a[68:71], v[212:215]
  s_waitcnt lgkmcnt(7)
  v_exp_f32 v202, v202
  v_mfma_f32_16x16x32_bf16 v[196:199], a[216:219], a[72:75], v[196:199]
  ds_read_b64_tr_b16 a[204:205], v239 offset:256
  v_add_f32 v235, v201, v235
  v_mfma_f32_16x16x32_bf16 v[204:207], a[216:219], a[76:79], v[204:207]
  ds_read_b64_tr_b16 a[206:207], v239 offset:8448
  v_cvt_pk_bf16_f32 v200, v200, v201
  v_mfma_f32_16x16x32_bf16 v[212:215], a[216:219], a[80:83], v[212:215]
  s_waitcnt lgkmcnt(8)
  v_exp_f32 v203, v203
  v_mfma_f32_16x16x32_bf16 v[196:199], a[220:223], a[84:87], v[196:199]
  ds_read_b64_tr_b16 a[208:209], v228 offset:1024
  v_add_f32 v235, v202, v235
  v_mfma_f32_16x16x32_bf16 v[204:207], a[220:223], a[88:91], v[204:207]
  ds_read_b64_tr_b16 a[210:211], v228 offset:9216
  v_add_f32 v235, v203, v235
  v_mfma_f32_16x16x32_bf16 v[212:215], a[220:223], a[92:95], v[212:215]
  s_waitcnt lgkmcnt(8)
  v_exp_f32 v208, v208
  v_mfma_f32_16x16x32_bf16 v[0:3], a[192:195], v[168:171], v[0:3]
  s_add_u32 m0, s28, 49152
  ds_read_b64_tr_b16 a[212:213], v239 offset:1024
  v_cvt_pk_bf16_f32 v201, v202, v203
  v_mfma_f32_16x16x32_bf16 v[4:7], a[192:195], v[176:179], v[4:7]
  s_mov_b32 s29, 183296
  ds_read_b64_tr_b16 a[214:215], v239 offset:9216
  v_add_f32 v236, v208, v236
  v_mfma_f32_16x16x32_bf16 v[8:11], a[192:195], v[184:187], v[8:11]
  s_waitcnt lgkmcnt(8)
  v_exp_f32 v209, v209
  v_mfma_f32_16x16x32_bf16 v[12:15], a[196:199], v[168:171], v[12:15]
  ds_read_b64_tr_b16 a[216:217], v228 offset:1280
  v_add_f32 v236, v209, v236
  v_mfma_f32_16x16x32_bf16 v[16:19], a[196:199], v[176:179], v[16:19]
  ds_read_b64_tr_b16 a[218:219], v228 offset:9472
  v_cvt_pk_bf16_f32 v208, v208, v209
  v_mfma_f32_16x16x32_bf16 v[20:23], a[196:199], v[184:187], v[20:23]
  s_waitcnt lgkmcnt(8)
  v_exp_f32 v210, v210
  v_mfma_f32_16x16x32_bf16 v[24:27], a[200:203], v[168:171], v[24:27]
  ds_read_b64_tr_b16 a[220:221], v239 offset:1280
  v_add_f32 v236, v210, v236
  v_mfma_f32_16x16x32_bf16 v[28:31], a[200:203], v[176:179], v[28:31]
  buffer_load_dwordx4 v231, s[12:15], s29 offen offset:0 nt lds
  v_mfma_f32_16x16x32_bf16 v[32:35], a[200:203], v[184:187], v[32:35]
  s_waitcnt lgkmcnt(7)
  ds_read_b64_tr_b16 a[222:223], v239 offset:9472
  v_mfma_f32_16x16x32_bf16 v[36:39], a[204:207], v[168:171], v[36:39]
  s_add_u32 s29, s29, s30
  ds_read_b64_tr_b16 a[192:193], v228 offset:2048
  v_mfma_f32_16x16x32_bf16 v[40:43], a[204:207], v[176:179], v[40:43]
  ds_read_b64_tr_b16 a[194:195], v228 offset:10240
  v_mfma_f32_16x16x32_bf16 v[44:47], a[204:207], v[184:187], v[44:47]
  s_waitcnt lgkmcnt(8)
  v_exp_f32 v211, v211
  v_mfma_f32_16x16x32_bf16 v[48:51], a[208:211], v[168:171], v[48:51]
  ds_read_b64_tr_b16 a[196:197], v239 offset:2048
  v_add_f32 v236, v211, v236
  v_mfma_f32_16x16x32_bf16 v[52:55], a[208:211], v[176:179], v[52:55]
  buffer_load_dwordx4 v231, s[12:15], s29 offen offset:1024 nt lds
  v_mfma_f32_16x16x32_bf16 v[56:59], a[208:211], v[184:187], v[56:59]
  s_waitcnt lgkmcnt(7)
  ds_read_b64_tr_b16 a[198:199], v239 offset:10240
  v_cvt_pk_bf16_f32 v209, v210, v211
  v_mfma_f32_16x16x32_bf16 v[60:63], a[212:215], v[168:171], v[60:63]
  s_add_u32 s29, s29, s30
  ds_read_b64_tr_b16 a[200:201], v228 offset:2304
  v_mfma_f32_16x16x32_bf16 v[64:67], a[212:215], v[176:179], v[64:67]
  ds_read_b64_tr_b16 a[202:203], v228 offset:10496
  v_mfma_f32_16x16x32_bf16 v[68:71], a[212:215], v[184:187], v[68:71]
  s_waitcnt lgkmcnt(8)
  v_exp_f32 v196, v196
  v_mfma_f32_16x16x32_bf16 v[72:75], a[216:219], v[168:171], v[72:75]
  ds_read_b64_tr_b16 a[204:205], v239 offset:2304
  v_add_f32 v234, v196, v234
  v_mfma_f32_16x16x32_bf16 v[76:79], a[216:219], v[176:179], v[76:79]
  buffer_load_dwordx4 v231, s[12:15], s29 offen offset:2048 nt lds
  v_mfma_f32_16x16x32_bf16 v[80:83], a[216:219], v[184:187], v[80:83]
  s_waitcnt lgkmcnt(7)
  ds_read_b64_tr_b16 a[206:207], v239 offset:10496
  v_mfma_f32_16x16x32_bf16 v[84:87], a[220:223], v[168:171], v[84:87]
  s_add_u32 s29, s29, s30
  ds_read_b64_tr_b16 a[208:209], v228 offset:3072
  v_mfma_f32_16x16x32_bf16 v[88:91], a[220:223], v[176:179], v[88:91]
  ds_read_b64_tr_b16 a[210:211], v228 offset:11264
  v_mfma_f32_16x16x32_bf16 v[92:95], a[220:223], v[184:187], v[92:95]
  s_waitcnt lgkmcnt(8)
  v_exp_f32 v197, v197
  v_mfma_f32_16x16x32_bf16 v[96:99], a[192:195], v[168:171], v[96:99]
  ds_read_b64_tr_b16 a[212:213], v239 offset:3072
  v_add_f32 v234, v197, v234
  v_mfma_f32_16x16x32_bf16 v[100:103], a[192:195], v[176:179], v[100:103]
  buffer_load_dwordx4 v231, s[12:15], s29 offen offset:3072 nt lds
  v_mfma_f32_16x16x32_bf16 v[104:107], a[192:195], v[184:187], v[104:107]
  s_waitcnt lgkmcnt(7)
  ds_read_b64_tr_b16 a[214:215], v239 offset:11264
  v_cvt_pk_bf16_f32 v194, v196, v197
  v_mfma_f32_16x16x32_bf16 v[108:111], a[196:199], v[168:171], v[108:111]
  s_waitcnt vmcnt(4)
  ds_read_b64_tr_b16 a[216:217], v228 offset:3328
  v_mfma_f32_16x16x32_bf16 v[112:115], a[196:199], v[176:179], v[112:115]
  s_barrier
  ds_read_b64_tr_b16 a[218:219], v228 offset:11520
  v_mfma_f32_16x16x32_bf16 v[116:119], a[196:199], v[184:187], v[116:119]
  s_waitcnt lgkmcnt(8)
  v_exp_f32 v198, v198
  v_mfma_f32_16x16x32_bf16 v[120:123], a[200:203], v[168:171], v[120:123]
  ds_read_b64_tr_b16 a[220:221], v239 offset:3328
  v_add_f32 v234, v198, v234
  v_mfma_f32_16x16x32_bf16 v[124:127], a[200:203], v[176:179], v[124:127]
  ds_read_b64_tr_b16 a[222:223], v239 offset:11520
  v_add_u32 v228, 0, v229
  v_mfma_f32_16x16x32_bf16 v[128:131], a[200:203], v[184:187], v[128:131]
  s_waitcnt lgkmcnt(8)
  v_exp_f32 v199, v199
  v_mfma_f32_16x16x32_bf16 v[132:135], a[204:207], v[168:171], v[132:135]
  ds_read_b128 a[192:195], v228 offset:0
  v_add_f32 v234, v199, v234
  v_mfma_f32_16x16x32_bf16 v[136:139], a[204:207], v[176:179], v[136:139]
  v_exp_f32 v204, v204
  v_mfma_f32_16x16x32_bf16 v[140:143], a[204:207], v[184:187], v[140:143]
  s_waitcnt lgkmcnt(7)
  v_exp_f32 v205, v205
  v_mfma_f32_16x16x32_bf16 v[144:147], a[208:211], v[168:171], v[144:147]
  ds_read_b128 a[196:199], v228 offset:256
  v_cvt_pk_bf16_f32 v195, v198, v199
  v_mfma_f32_16x16x32_bf16 v[148:151], a[208:211], v[176:179], v[148:151]
  v_exp_f32 v206, v206
  v_mfma_f32_16x16x32_bf16 v[152:155], a[208:211], v[184:187], v[152:155]
  s_waitcnt lgkmcnt(6)
  v_exp_f32 v207, v207
  v_mfma_f32_16x16x32_bf16 v[156:159], a[212:215], v[168:171], v[156:159]
  ds_read_b128 a[200:203], v228 offset:1024
  v_add_f32 v235, v204, v235
  v_mfma_f32_16x16x32_bf16 v[160:163], a[212:215], v[176:179], v[160:163]
  v_exp_f32 v212, v212
  v_mfma_f32_16x16x32_bf16 v[164:167], a[212:215], v[184:187], v[164:167]
  s_waitcnt lgkmcnt(5)
  v_exp_f32 v213, v213
  v_mfma_f32_16x16x32_bf16 a[224:227], a[216:219], v[168:171], a[224:227]
  ds_read_b128 a[204:207], v228 offset:1280
  v_add_f32 v235, v205, v235
  v_mfma_f32_16x16x32_bf16 a[228:231], a[216:219], v[176:179], a[228:231]
  v_exp_f32 v214, v214
  v_mfma_f32_16x16x32_bf16 a[232:235], a[216:219], v[184:187], a[232:235]
  s_waitcnt lgkmcnt(4)
  v_exp_f32 v215, v215
  v_mfma_f32_16x16x32_bf16 a[236:239], a[220:223], v[168:171], a[236:239]
  ds_read_b128 a[208:211], v228 offset:2048
  v_cvt_pk_bf16_f32 v202, v204, v205
  v_mfma_f32_16x16x32_bf16 a[240:243], a[220:223], v[176:179], a[240:243]
  v_add_f32 v235, v206, v235
  v_add_f32 v236, v212, v236
  v_mfma_f32_16x16x32_bf16 a[244:247], a[220:223], v[184:187], a[244:247]
  s_waitcnt lgkmcnt(4)
  v_add_f32 v235, v207, v235
  v_add_f32 v236, v213, v236
  v_mfma_f32_16x16x32_bf16 v[168:171], a[192:195], a[0:3], v[216:219]
  s_add_u32 m0, s28, 81920
  ds_read_b128 a[212:215], v228 offset:2304
  v_cvt_pk_bf16_f32 v203, v206, v207
  v_mfma_f32_16x16x32_bf16 v[176:179], a[192:195], a[4:7], v[220:223]
  s_mov_b32 s29, 216064
  v_cvt_pk_bf16_f32 v210, v212, v213
  v_add_f32 v236, v214, v236
  v_mfma_f32_16x16x32_bf16 v[184:187], a[192:195], a[8:11], v[224:227]
  s_waitcnt lgkmcnt(4)
  v_add_f32 v236, v215, v236
  v_mfma_f32_16x16x32_bf16 v[168:171], a[196:199], a[12:15], v[168:171]
  ds_read_b128 a[216:219], v228 offset:3072
  v_cvt_pk_bf16_f32 v211, v214, v215
  v_mfma_f32_16x16x32_bf16 v[176:179], a[196:199], a[16:19], v[176:179]
  v_mfma_f32_16x16x32_bf16 v[184:187], a[196:199], a[20:23], v[184:187]
  s_waitcnt lgkmcnt(4)
  v_mfma_f32_16x16x32_bf16 v[168:171], a[200:203], a[24:27], v[168:171]
  ds_read_b128 a[220:223], v228 offset:3328
  v_mfma_f32_16x16x32_bf16 v[176:179], a[200:203], a[28:31], v[176:179]
  buffer_load_dwordx4 v231, s[8:11], s29 offen offset:0 nt lds
  v_mfma_f32_16x16x32_bf16 v[184:187], a[200:203], a[32:35], v[184:187]
  s_waitcnt lgkmcnt(4)
  v_mfma_f32_16x16x32_bf16 v[168:171], a[204:207], a[36:39], v[168:171]
  s_add_u32 s29, s29, s30
  ds_read_b128 a[192:195], v228 offset:8192
  v_mfma_f32_16x16x32_bf16 v[176:179], a[204:207], a[40:43], v[176:179]
  v_mfma_f32_16x16x32_bf16 v[184:187], a[204:207], a[44:47], v[184:187]
  s_waitcnt lgkmcnt(4)
  v_mfma_f32_16x16x32_bf16 v[168:171], a[208:211], a[48:51], v[168:171]
  ds_read_b128 a[196:199], v228 offset:8448
  v_mfma_f32_16x16x32_bf16 v[176:179], a[208:211], a[52:55], v[176:179]
  buffer_load_dwordx4 v231, s[8:11], s29 offen offset:1024 nt lds
  v_mfma_f32_16x16x32_bf16 v[184:187], a[208:211], a[56:59], v[184:187]
  s_waitcnt lgkmcnt(4)
  v_mfma_f32_16x16x32_bf16 v[168:171], a[212:215], a[60:63], v[168:171]
  s_add_u32 s29, s29, s30
  ds_read_b128 a[200:203], v228 offset:9216
  v_mfma_f32_16x16x32_bf16 v[176:179], a[212:215], a[64:67], v[176:179]
  v_mfma_f32_16x16x32_bf16 v[184:187], a[212:215], a[68:71], v[184:187]
  s_waitcnt lgkmcnt(4)
  v_mfma_f32_16x16x32_bf16 v[168:171], a[216:219], a[72:75], v[168:171]
  ds_read_b128 a[204:207], v228 offset:9472
  v_mfma_f32_16x16x32_bf16 v[176:179], a[216:219], a[76:79], v[176:179]
  buffer_load_dwordx4 v231, s[8:11], s29 offen offset:2048 nt lds
  v_mfma_f32_16x16x32_bf16 v[184:187], a[216:219], a[80:83], v[184:187]
  s_waitcnt lgkmcnt(4)
  v_mfma_f32_16x16x32_bf16 v[168:171], a[220:223], a[84:87], v[168:171]
  s_add_u32 s29, s29, s30
  ds_read_b128 a[208:211], v228 offset:10240
  v_mfma_f32_16x16x32_bf16 v[176:179], a[220:223], a[88:91], v[176:179]
  v_mfma_f32_16x16x32_bf16 v[184:187], a[220:223], a[92:95], v[184:187]
  s_waitcnt lgkmcnt(4)
  v_mfma_f32_16x16x32_bf16 v[172:175], a[192:195], a[0:3], v[216:219]
  ds_read_b128 a[212:215], v228 offset:10496
  v_mfma_f32_16x16x32_bf16 v[180:183], a[192:195], a[4:7], v[220:223]
  buffer_load_dwordx4 v231, s[8:11], s29 offen offset:3072 nt lds
  v_mfma_f32_16x16x32_bf16 v[188:191], a[192:195], a[8:11], v[224:227]
  s_waitcnt lgkmcnt(4)
  v_exp_f32 v168, v168
  v_mfma_f32_16x16x32_bf16 v[172:175], a[196:199], a[12:15], v[172:175]
  s_waitcnt vmcnt(4)
  ds_read_b128 a[216:219], v228 offset:11264
  v_add_f32 v234, v168, v234
  v_mfma_f32_16x16x32_bf16 v[180:183], a[196:199], a[16:19], v[180:183]
  s_barrier
  v_exp_f32 v169, v169
  v_mfma_f32_16x16x32_bf16 v[188:191], a[196:199], a[20:23], v[188:191]
  s_waitcnt lgkmcnt(4)
  v_exp_f32 v170, v170
  v_mfma_f32_16x16x32_bf16 v[172:175], a[200:203], a[24:27], v[172:175]
  ds_read_b128 a[220:223], v228 offset:11520
  v_add_u32 v228, 49152, v230
  v_mfma_f32_16x16x32_bf16 v[180:183], a[200:203], a[28:31], v[180:183]
  v_xor_b32 v239, 32, v228
  v_mfma_f32_16x16x32_bf16 v[188:191], a[200:203], a[32:35], v[188:191]
  s_waitcnt lgkmcnt(4)
  v_exp_f32 v171, v171
  v_mfma_f32_16x16x32_bf16 v[172:175], a[204:207], a[36:39], v[172:175]
  ds_read_b64_tr_b16 a[192:193], v228 offset:0
  v_add_f32 v234, v169, v234
  v_mfma_f32_16x16x32_bf16 v[180:183], a[204:207], a[40:43], v[180:183]
  ds_read_b64_tr_b16 a[194:195], v228 offset:8192
  v_cvt_pk_bf16_f32 v168, v168, v169
  v_mfma_f32_16x16x32_bf16 v[188:191], a[204:207], a[44:47], v[188:191]
  s_waitcnt lgkmcnt(5)
  v_exp_f32 v176, v176
  v_mfma_f32_16x16x32_bf16 v[172:175], a[208:211], a[48:51], v[172:175]
  ds_read_b64_tr_b16 a[196:197], v239 offset:0
  v_add_f32 v234, v170, v234
  v_mfma_f32_16x16x32_bf16 v[180:183], a[208:211], a[52:55], v[180:183]
  ds_read_b64_tr_b16 a[198:199], v239 offset:8192
  v_add_f32 v234, v171, v234
  v_mfma_f32_16x16x32_bf16 v[188:191], a[208:211], a[56:59], v[188:191]
  s_waitcnt lgkmcnt(6)
  v_exp_f32 v177, v177
  v_mfma_f32_16x16x32_bf16 v[172:175], a[212:215], a[60:63], v[172:175]
  ds_read_b64_tr_b16 a[200:201], v228 offset:256
  v_cvt_pk_bf16_f32 v169, v170, v171
  v_mfma_f32_16x16x32_bf16 v[180:183], a[212:215], a[64:67], v[180:183]
  ds_read_b64_tr_b16 a[202:203], v228 offset:8448
  v_add_f32 v235, v176, v235
  v_mfma_f32_16x16x32_bf16 v[188:191], a[212:215], a[68:71], v[188:191]
  s_waitcnt lgkmcnt(7)
  v_exp_f32 v178, v178
  v_mfma_f32_16x16x32_bf16 v[172:175], a[216:219], a[72:75], v[172:175]
  ds_read_b64_tr_b16 a[204:205], v239 offset:256
  v_add_f32 v235, v177, v235
  v_mfma_f32_16x16x32_bf16 v[180:183], a[216:219], a[76:79], v[180:183]
  ds_read_b64_tr_b16 a[206:207], v239 offset:8448
  v_cvt_pk_bf16_f32 v176, v176, v177
  v_mfma_f32_16x16x32_bf16 v[188:191], a[216:219], a[80:83], v[188:191]
  s_waitcnt lgkmcnt(8)
  v_exp_f32 v179, v179
  v_mfma_f32_16x16x32_bf16 v[172:175], a[220:223], a[84:87], v[172:175]
  ds_read_b64_tr_b16 a[208:209], v228 offset:1024
  v_add_f32 v235, v178, v235
  v_mfma_f32_16x16x32_bf16 v[180:183], a[220:223], a[88:91], v[180:183]
  ds_read_b64_tr_b16 a[210:211], v228 offset:9216
  v_add_f32 v235, v179, v235
  v_mfma_f32_16x16x32_bf16 v[188:191], a[220:223], a[92:95], v[188:191]
  s_waitcnt lgkmcnt(8)
  v_exp_f32 v184, v184
  v_mfma_f32_16x16x32_bf16 v[0:3], a[192:195], v[192:195], v[0:3]
  s_add_u32 m0, s28, 131072
  ds_read_b64_tr_b16 a[212:213], v239 offset:1024
  v_cvt_pk_bf16_f32 v177, v178, v179
  v_mfma_f32_16x16x32_bf16 v[4:7], a[192:195], v[200:203], v[4:7]
  s_mov_b32 s29, 199680
  ds_read_b64_tr_b16 a[214:215], v239 offset:9216
  v_add_f32 v236, v184, v236
  v_mfma_f32_16x16x32_bf16 v[8:11], a[192:195], v[208:211], v[8:11]
  s_waitcnt lgkmcnt(8)
  v_exp_f32 v185, v185
  v_mfma_f32_16x16x32_bf16 v[12:15], a[196:199], v[192:195], v[12:15]
  ds_read_b64_tr_b16 a[216:217], v228 offset:1280
  v_add_f32 v236, v185, v236
  v_mfma_f32_16x16x32_bf16 v[16:19], a[196:199], v[200:203], v[16:19]
  ds_read_b64_tr_b16 a[218:219], v228 offset:9472
  v_cvt_pk_bf16_f32 v184, v184, v185
  v_mfma_f32_16x16x32_bf16 v[20:23], a[196:199], v[208:211], v[20:23]
  s_waitcnt lgkmcnt(8)
  v_exp_f32 v186, v186
  v_mfma_f32_16x16x32_bf16 v[24:27], a[200:203], v[192:195], v[24:27]
  ds_read_b64_tr_b16 a[220:221], v239 offset:1280
  v_add_f32 v236, v186, v236
  v_mfma_f32_16x16x32_bf16 v[28:31], a[200:203], v[200:203], v[28:31]
  buffer_load_dwordx4 v231, s[12:15], s29 offen offset:0 nt lds
  v_mfma_f32_16x16x32_bf16 v[32:35], a[200:203], v[208:211], v[32:35]
  s_waitcnt lgkmcnt(7)
  ds_read_b64_tr_b16 a[222:223], v239 offset:9472
  v_mfma_f32_16x16x32_bf16 v[36:39], a[204:207], v[192:195], v[36:39]
  s_add_u32 s29, s29, s30
  ds_read_b64_tr_b16 a[192:193], v228 offset:2048
  v_mfma_f32_16x16x32_bf16 v[40:43], a[204:207], v[200:203], v[40:43]
  ds_read_b64_tr_b16 a[194:195], v228 offset:10240
  v_mfma_f32_16x16x32_bf16 v[44:47], a[204:207], v[208:211], v[44:47]
  s_waitcnt lgkmcnt(8)
  v_exp_f32 v187, v187
  v_mfma_f32_16x16x32_bf16 v[48:51], a[208:211], v[192:195], v[48:51]
  ds_read_b64_tr_b16 a[196:197], v239 offset:2048
  v_add_f32 v236, v187, v236
  v_mfma_f32_16x16x32_bf16 v[52:55], a[208:211], v[200:203], v[52:55]
  buffer_load_dwordx4 v231, s[12:15], s29 offen offset:1024 nt lds
  v_mfma_f32_16x16x32_bf16 v[56:59], a[208:211], v[208:211], v[56:59]
  s_waitcnt lgkmcnt(7)
  ds_read_b64_tr_b16 a[198:199], v239 offset:10240
  v_cvt_pk_bf16_f32 v185, v186, v187
  v_mfma_f32_16x16x32_bf16 v[60:63], a[212:215], v[192:195], v[60:63]
  s_add_u32 s29, s29, s30
  ds_read_b64_tr_b16 a[200:201], v228 offset:2304
  v_mfma_f32_16x16x32_bf16 v[64:67], a[212:215], v[200:203], v[64:67]
  ds_read_b64_tr_b16 a[202:203], v228 offset:10496
  v_mfma_f32_16x16x32_bf16 v[68:71], a[212:215], v[208:211], v[68:71]
  s_waitcnt lgkmcnt(8)
  v_exp_f32 v172, v172
  v_mfma_f32_16x16x32_bf16 v[72:75], a[216:219], v[192:195], v[72:75]
  ds_read_b64_tr_b16 a[204:205], v239 offset:2304
  v_add_f32 v234, v172, v234
  v_mfma_f32_16x16x32_bf16 v[76:79], a[216:219], v[200:203], v[76:79]
  buffer_load_dwordx4 v231, s[12:15], s29 offen offset:2048 nt lds
  v_mfma_f32_16x16x32_bf16 v[80:83], a[216:219], v[208:211], v[80:83]
  s_waitcnt lgkmcnt(7)
  ds_read_b64_tr_b16 a[206:207], v239 offset:10496
  v_mfma_f32_16x16x32_bf16 v[84:87], a[220:223], v[192:195], v[84:87]
  s_add_u32 s29, s29, s30
  ds_read_b64_tr_b16 a[208:209], v228 offset:3072
  v_mfma_f32_16x16x32_bf16 v[88:91], a[220:223], v[200:203], v[88:91]
  ds_read_b64_tr_b16 a[210:211], v228 offset:11264
  v_mfma_f32_16x16x32_bf16 v[92:95], a[220:223], v[208:211], v[92:95]
  s_waitcnt lgkmcnt(8)
  v_exp_f32 v173, v173
  v_mfma_f32_16x16x32_bf16 v[96:99], a[192:195], v[192:195], v[96:99]
  ds_read_b64_tr_b16 a[212:213], v239 offset:3072
  v_add_f32 v234, v173, v234
  v_mfma_f32_16x16x32_bf16 v[100:103], a[192:195], v[200:203], v[100:103]
  buffer_load_dwordx4 v231, s[12:15], s29 offen offset:3072 nt lds
  v_mfma_f32_16x16x32_bf16 v[104:107], a[192:195], v[208:211], v[104:107]
  s_waitcnt lgkmcnt(7)
  ds_read_b64_tr_b16 a[214:215], v239 offset:11264
  v_cvt_pk_bf16_f32 v170, v172, v173
  v_mfma_f32_16x16x32_bf16 v[108:111], a[196:199], v[192:195], v[108:111]
  s_waitcnt vmcnt(4)
  ds_read_b64_tr_b16 a[216:217], v228 offset:3328
  v_mfma_f32_16x16x32_bf16 v[112:115], a[196:199], v[200:203], v[112:115]
  s_barrier
  ds_read_b64_tr_b16 a[218:219], v228 offset:11520
  v_mfma_f32_16x16x32_bf16 v[116:119], a[196:199], v[208:211], v[116:119]
  s_waitcnt lgkmcnt(8)
  v_exp_f32 v174, v174
  v_mfma_f32_16x16x32_bf16 v[120:123], a[200:203], v[192:195], v[120:123]
  ds_read_b64_tr_b16 a[220:221], v239 offset:3328
  v_add_f32 v234, v174, v234
  v_mfma_f32_16x16x32_bf16 v[124:127], a[200:203], v[200:203], v[124:127]
  ds_read_b64_tr_b16 a[222:223], v239 offset:11520
  v_add_u32 v228, 81920, v229
  v_mfma_f32_16x16x32_bf16 v[128:131], a[200:203], v[208:211], v[128:131]
  s_waitcnt lgkmcnt(8)
  v_exp_f32 v175, v175
  v_mfma_f32_16x16x32_bf16 v[132:135], a[204:207], v[192:195], v[132:135]
  ds_read_b128 a[192:195], v228 offset:0
  v_add_f32 v234, v175, v234
  v_mfma_f32_16x16x32_bf16 v[136:139], a[204:207], v[200:203], v[136:139]
  v_exp_f32 v180, v180
  v_mfma_f32_16x16x32_bf16 v[140:143], a[204:207], v[208:211], v[140:143]
  s_waitcnt lgkmcnt(7)
  v_exp_f32 v181, v181
  v_mfma_f32_16x16x32_bf16 v[144:147], a[208:211], v[192:195], v[144:147]
  ds_read_b128 a[196:199], v228 offset:256
  v_cvt_pk_bf16_f32 v171, v174, v175
  v_mfma_f32_16x16x32_bf16 v[148:151], a[208:211], v[200:203], v[148:151]
  v_exp_f32 v182, v182
  v_mfma_f32_16x16x32_bf16 v[152:155], a[208:211], v[208:211], v[152:155]
  s_waitcnt lgkmcnt(6)
  v_exp_f32 v183, v183
  v_mfma_f32_16x16x32_bf16 v[156:159], a[212:215], v[192:195], v[156:159]
  ds_read_b128 a[200:203], v228 offset:1024
  v_add_f32 v235, v180, v235
  v_mfma_f32_16x16x32_bf16 v[160:163], a[212:215], v[200:203], v[160:163]
  v_exp_f32 v188, v188
  v_mfma_f32_16x16x32_bf16 v[164:167], a[212:215], v[208:211], v[164:167]
  s_waitcnt lgkmcnt(5)
  v_exp_f32 v189, v189
  v_mfma_f32_16x16x32_bf16 a[224:227], a[216:219], v[192:195], a[224:227]
  ds_read_b128 a[204:207], v228 offset:1280
  v_add_f32 v235, v181, v235
  v_mfma_f32_16x16x32_bf16 a[228:231], a[216:219], v[200:203], a[228:231]
  v_exp_f32 v190, v190
  v_mfma_f32_16x16x32_bf16 a[232:235], a[216:219], v[208:211], a[232:235]
  s_waitcnt lgkmcnt(4)
  v_exp_f32 v191, v191
  v_mfma_f32_16x16x32_bf16 a[236:239], a[220:223], v[192:195], a[236:239]
  ds_read_b128 a[208:211], v228 offset:2048
  v_cvt_pk_bf16_f32 v178, v180, v181
  v_mfma_f32_16x16x32_bf16 a[240:243], a[220:223], v[200:203], a[240:243]
  v_add_f32 v235, v182, v235
  v_add_f32 v236, v188, v236
  v_mfma_f32_16x16x32_bf16 a[244:247], a[220:223], v[208:211], a[244:247]
  s_waitcnt lgkmcnt(4)
  v_add_f32 v235, v183, v235
  v_add_f32 v236, v189, v236
  v_mfma_f32_16x16x32_bf16 v[192:195], a[192:195], a[0:3], v[216:219]
  s_add_u32 m0, s28, 147456
  ds_read_b128 a[212:215], v228 offset:2304
  v_cvt_pk_bf16_f32 v179, v182, v183
  v_mfma_f32_16x16x32_bf16 v[200:203], a[192:195], a[4:7], v[220:223]
  s_mov_b32 s29, 232448
  v_cvt_pk_bf16_f32 v186, v188, v189
  v_add_f32 v236, v190, v236
  v_mfma_f32_16x16x32_bf16 v[208:211], a[192:195], a[8:11], v[224:227]
  s_waitcnt lgkmcnt(4)
  v_add_f32 v236, v191, v236
  v_mfma_f32_16x16x32_bf16 v[192:195], a[196:199], a[12:15], v[192:195]
  ds_read_b128 a[216:219], v228 offset:3072
  v_cvt_pk_bf16_f32 v187, v190, v191
  v_mfma_f32_16x16x32_bf16 v[200:203], a[196:199], a[16:19], v[200:203]
  v_mfma_f32_16x16x32_bf16 v[208:211], a[196:199], a[20:23], v[208:211]
  s_waitcnt lgkmcnt(4)
  v_mfma_f32_16x16x32_bf16 v[192:195], a[200:203], a[24:27], v[192:195]
  ds_read_b128 a[220:223], v228 offset:3328
  v_mfma_f32_16x16x32_bf16 v[200:203], a[200:203], a[28:31], v[200:203]
  buffer_load_dwordx4 v231, s[8:11], s29 offen offset:0 nt lds
  v_mfma_f32_16x16x32_bf16 v[208:211], a[200:203], a[32:35], v[208:211]
  s_waitcnt lgkmcnt(4)
  v_mfma_f32_16x16x32_bf16 v[192:195], a[204:207], a[36:39], v[192:195]
  s_add_u32 s29, s29, s30
  ds_read_b128 a[192:195], v228 offset:8192
  v_mfma_f32_16x16x32_bf16 v[200:203], a[204:207], a[40:43], v[200:203]
  v_mfma_f32_16x16x32_bf16 v[208:211], a[204:207], a[44:47], v[208:211]
  s_waitcnt lgkmcnt(4)
  v_mfma_f32_16x16x32_bf16 v[192:195], a[208:211], a[48:51], v[192:195]
  ds_read_b128 a[196:199], v228 offset:8448
  v_mfma_f32_16x16x32_bf16 v[200:203], a[208:211], a[52:55], v[200:203]
  buffer_load_dwordx4 v231, s[8:11], s29 offen offset:1024 nt lds
  v_mfma_f32_16x16x32_bf16 v[208:211], a[208:211], a[56:59], v[208:211]
  s_waitcnt lgkmcnt(4)
  v_mfma_f32_16x16x32_bf16 v[192:195], a[212:215], a[60:63], v[192:195]
  s_add_u32 s29, s29, s30
  ds_read_b128 a[200:203], v228 offset:9216
  v_mfma_f32_16x16x32_bf16 v[200:203], a[212:215], a[64:67], v[200:203]
  v_mfma_f32_16x16x32_bf16 v[208:211], a[212:215], a[68:71], v[208:211]
  s_waitcnt lgkmcnt(4)
  v_mfma_f32_16x16x32_bf16 v[192:195], a[216:219], a[72:75], v[192:195]
  ds_read_b128 a[204:207], v228 offset:9472
  v_mfma_f32_16x16x32_bf16 v[200:203], a[216:219], a[76:79], v[200:203]
  buffer_load_dwordx4 v231, s[8:11], s29 offen offset:2048 nt lds
  v_mfma_f32_16x16x32_bf16 v[208:211], a[216:219], a[80:83], v[208:211]
  s_waitcnt lgkmcnt(4)
  v_mfma_f32_16x16x32_bf16 v[192:195], a[220:223], a[84:87], v[192:195]
  s_add_u32 s29, s29, s30
  ds_read_b128 a[208:211], v228 offset:10240
  v_mfma_f32_16x16x32_bf16 v[200:203], a[220:223], a[88:91], v[200:203]
  v_mfma_f32_16x16x32_bf16 v[208:211], a[220:223], a[92:95], v[208:211]
  s_waitcnt lgkmcnt(4)
  v_mfma_f32_16x16x32_bf16 v[196:199], a[192:195], a[0:3], v[216:219]
  ds_read_b128 a[212:215], v228 offset:10496
  v_mfma_f32_16x16x32_bf16 v[204:207], a[192:195], a[4:7], v[220:223]
  buffer_load_dwordx4 v231, s[8:11], s29 offen offset:3072 nt lds
  v_mfma_f32_16x16x32_bf16 v[212:215], a[192:195], a[8:11], v[224:227]
  s_waitcnt lgkmcnt(4)
  v_exp_f32 v192, v192
  v_mfma_f32_16x16x32_bf16 v[196:199], a[196:199], a[12:15], v[196:199]
  s_waitcnt vmcnt(4)
  ds_read_b128 a[216:219], v228 offset:11264
  v_add_f32 v234, v192, v234
  v_mfma_f32_16x16x32_bf16 v[204:207], a[196:199], a[16:19], v[204:207]
  s_barrier
  v_exp_f32 v193, v193
  v_mfma_f32_16x16x32_bf16 v[212:215], a[196:199], a[20:23], v[212:215]
  s_waitcnt lgkmcnt(4)
  v_exp_f32 v194, v194
  v_mfma_f32_16x16x32_bf16 v[196:199], a[200:203], a[24:27], v[196:199]
  ds_read_b128 a[220:223], v228 offset:11520
  v_add_u32 v228, 131072, v230
  v_mfma_f32_16x16x32_bf16 v[204:207], a[200:203], a[28:31], v[204:207]
  v_xor_b32 v239, 32, v228
  v_mfma_f32_16x16x32_bf16 v[212:215], a[200:203], a[32:35], v[212:215]
  s_waitcnt lgkmcnt(4)
  v_exp_f32 v195, v195
  v_mfma_f32_16x16x32_bf16 v[196:199], a[204:207], a[36:39], v[196:199]
  ds_read_b64_tr_b16 a[192:193], v228 offset:0
  v_add_f32 v234, v193, v234
  v_mfma_f32_16x16x32_bf16 v[204:207], a[204:207], a[40:43], v[204:207]
  ds_read_b64_tr_b16 a[194:195], v228 offset:8192
  v_cvt_pk_bf16_f32 v192, v192, v193
  v_mfma_f32_16x16x32_bf16 v[212:215], a[204:207], a[44:47], v[212:215]
  s_waitcnt lgkmcnt(5)
  v_exp_f32 v200, v200
  v_mfma_f32_16x16x32_bf16 v[196:199], a[208:211], a[48:51], v[196:199]
  ds_read_b64_tr_b16 a[196:197], v239 offset:0
  v_add_f32 v234, v194, v234
  v_mfma_f32_16x16x32_bf16 v[204:207], a[208:211], a[52:55], v[204:207]
  ds_read_b64_tr_b16 a[198:199], v239 offset:8192
  v_add_f32 v234, v195, v234
  v_mfma_f32_16x16x32_bf16 v[212:215], a[208:211], a[56:59], v[212:215]
  s_waitcnt lgkmcnt(6)
  v_exp_f32 v201, v201
  v_mfma_f32_16x16x32_bf16 v[196:199], a[212:215], a[60:63], v[196:199]
  ds_read_b64_tr_b16 a[200:201], v228 offset:256
  v_cvt_pk_bf16_f32 v193, v194, v195
  v_mfma_f32_16x16x32_bf16 v[204:207], a[212:215], a[64:67], v[204:207]
  ds_read_b64_tr_b16 a[202:203], v228 offset:8448
  v_add_f32 v235, v200, v235
  v_mfma_f32_16x16x32_bf16 v[212:215], a[212:215], a[68:71], v[212:215]
  s_waitcnt lgkmcnt(7)
  v_exp_f32 v202, v202
  v_mfma_f32_16x16x32_bf16 v[196:199], a[216:219], a[72:75], v[196:199]
  ds_read_b64_tr_b16 a[204:205], v239 offset:256
  v_add_f32 v235, v201, v235
  v_mfma_f32_16x16x32_bf16 v[204:207], a[216:219], a[76:79], v[204:207]
  ds_read_b64_tr_b16 a[206:207], v239 offset:8448
  v_cvt_pk_bf16_f32 v200, v200, v201
  v_mfma_f32_16x16x32_bf16 v[212:215], a[216:219], a[80:83], v[212:215]
  s_waitcnt lgkmcnt(8)
  v_exp_f32 v203, v203
  v_mfma_f32_16x16x32_bf16 v[196:199], a[220:223], a[84:87], v[196:199]
  ds_read_b64_tr_b16 a[208:209], v228 offset:1024
  v_add_f32 v235, v202, v235
  v_mfma_f32_16x16x32_bf16 v[204:207], a[220:223], a[88:91], v[204:207]
  ds_read_b64_tr_b16 a[210:211], v228 offset:9216
  v_add_f32 v235, v203, v235
  v_mfma_f32_16x16x32_bf16 v[212:215], a[220:223], a[92:95], v[212:215]
  s_waitcnt lgkmcnt(8)
  v_exp_f32 v208, v208
  v_mfma_f32_16x16x32_bf16 v[0:3], a[192:195], v[168:171], v[0:3]
  s_add_u32 m0, s28, 0
  ds_read_b64_tr_b16 a[212:213], v239 offset:1024
  v_cvt_pk_bf16_f32 v201, v202, v203
  v_mfma_f32_16x16x32_bf16 v[4:7], a[192:195], v[176:179], v[4:7]
  s_mov_b32 s29, 216064
  ds_read_b64_tr_b16 a[214:215], v239 offset:9216
  v_add_f32 v236, v208, v236
  v_mfma_f32_16x16x32_bf16 v[8:11], a[192:195], v[184:187], v[8:11]
  s_waitcnt lgkmcnt(8)
  v_exp_f32 v209, v209
  v_mfma_f32_16x16x32_bf16 v[12:15], a[196:199], v[168:171], v[12:15]
  ds_read_b64_tr_b16 a[216:217], v228 offset:1280
  v_add_f32 v236, v209, v236
  v_mfma_f32_16x16x32_bf16 v[16:19], a[196:199], v[176:179], v[16:19]
  ds_read_b64_tr_b16 a[218:219], v228 offset:9472
  v_cvt_pk_bf16_f32 v208, v208, v209
  v_mfma_f32_16x16x32_bf16 v[20:23], a[196:199], v[184:187], v[20:23]
  s_waitcnt lgkmcnt(8)
  v_exp_f32 v210, v210
  v_mfma_f32_16x16x32_bf16 v[24:27], a[200:203], v[168:171], v[24:27]
  ds_read_b64_tr_b16 a[220:221], v239 offset:1280
  v_add_f32 v236, v210, v236
  v_mfma_f32_16x16x32_bf16 v[28:31], a[200:203], v[176:179], v[28:31]
  buffer_load_dwordx4 v231, s[12:15], s29 offen offset:0 nt lds
  v_mfma_f32_16x16x32_bf16 v[32:35], a[200:203], v[184:187], v[32:35]
  s_waitcnt lgkmcnt(7)
  ds_read_b64_tr_b16 a[222:223], v239 offset:9472
  v_mfma_f32_16x16x32_bf16 v[36:39], a[204:207], v[168:171], v[36:39]
  s_add_u32 s29, s29, s30
  ds_read_b64_tr_b16 a[192:193], v228 offset:2048
  v_mfma_f32_16x16x32_bf16 v[40:43], a[204:207], v[176:179], v[40:43]
  ds_read_b64_tr_b16 a[194:195], v228 offset:10240
  v_mfma_f32_16x16x32_bf16 v[44:47], a[204:207], v[184:187], v[44:47]
  s_waitcnt lgkmcnt(8)
  v_exp_f32 v211, v211
  v_mfma_f32_16x16x32_bf16 v[48:51], a[208:211], v[168:171], v[48:51]
  ds_read_b64_tr_b16 a[196:197], v239 offset:2048
  v_add_f32 v236, v211, v236
  v_mfma_f32_16x16x32_bf16 v[52:55], a[208:211], v[176:179], v[52:55]
  buffer_load_dwordx4 v231, s[12:15], s29 offen offset:1024 nt lds
  v_mfma_f32_16x16x32_bf16 v[56:59], a[208:211], v[184:187], v[56:59]
  s_waitcnt lgkmcnt(7)
  ds_read_b64_tr_b16 a[198:199], v239 offset:10240
  v_cvt_pk_bf16_f32 v209, v210, v211
  v_mfma_f32_16x16x32_bf16 v[60:63], a[212:215], v[168:171], v[60:63]
  s_add_u32 s29, s29, s30
  ds_read_b64_tr_b16 a[200:201], v228 offset:2304
  v_mfma_f32_16x16x32_bf16 v[64:67], a[212:215], v[176:179], v[64:67]
  ds_read_b64_tr_b16 a[202:203], v228 offset:10496
  v_mfma_f32_16x16x32_bf16 v[68:71], a[212:215], v[184:187], v[68:71]
  s_waitcnt lgkmcnt(8)
  v_exp_f32 v196, v196
  v_mfma_f32_16x16x32_bf16 v[72:75], a[216:219], v[168:171], v[72:75]
  ds_read_b64_tr_b16 a[204:205], v239 offset:2304
  v_add_f32 v234, v196, v234
  v_mfma_f32_16x16x32_bf16 v[76:79], a[216:219], v[176:179], v[76:79]
  buffer_load_dwordx4 v231, s[12:15], s29 offen offset:2048 nt lds
  v_mfma_f32_16x16x32_bf16 v[80:83], a[216:219], v[184:187], v[80:83]
  s_waitcnt lgkmcnt(7)
  ds_read_b64_tr_b16 a[206:207], v239 offset:10496
  v_mfma_f32_16x16x32_bf16 v[84:87], a[220:223], v[168:171], v[84:87]
  s_add_u32 s29, s29, s30
  ds_read_b64_tr_b16 a[208:209], v228 offset:3072
  v_mfma_f32_16x16x32_bf16 v[88:91], a[220:223], v[176:179], v[88:91]
  ds_read_b64_tr_b16 a[210:211], v228 offset:11264
  v_mfma_f32_16x16x32_bf16 v[92:95], a[220:223], v[184:187], v[92:95]
  s_waitcnt lgkmcnt(8)
  v_exp_f32 v197, v197
  v_mfma_f32_16x16x32_bf16 v[96:99], a[192:195], v[168:171], v[96:99]
  ds_read_b64_tr_b16 a[212:213], v239 offset:3072
  v_add_f32 v234, v197, v234
  v_mfma_f32_16x16x32_bf16 v[100:103], a[192:195], v[176:179], v[100:103]
  buffer_load_dwordx4 v231, s[12:15], s29 offen offset:3072 nt lds
  v_mfma_f32_16x16x32_bf16 v[104:107], a[192:195], v[184:187], v[104:107]
  s_waitcnt lgkmcnt(7)
  ds_read_b64_tr_b16 a[214:215], v239 offset:11264
  v_cvt_pk_bf16_f32 v194, v196, v197
  v_mfma_f32_16x16x32_bf16 v[108:111], a[196:199], v[168:171], v[108:111]
  s_waitcnt vmcnt(4)
  ds_read_b64_tr_b16 a[216:217], v228 offset:3328
  v_mfma_f32_16x16x32_bf16 v[112:115], a[196:199], v[176:179], v[112:115]
  s_barrier
  ds_read_b64_tr_b16 a[218:219], v228 offset:11520
  v_mfma_f32_16x16x32_bf16 v[116:119], a[196:199], v[184:187], v[116:119]
  s_waitcnt lgkmcnt(8)
  v_exp_f32 v198, v198
  v_mfma_f32_16x16x32_bf16 v[120:123], a[200:203], v[168:171], v[120:123]
  ds_read_b64_tr_b16 a[220:221], v239 offset:3328
  v_add_f32 v234, v198, v234
  v_mfma_f32_16x16x32_bf16 v[124:127], a[200:203], v[176:179], v[124:127]
  ds_read_b64_tr_b16 a[222:223], v239 offset:11520
  v_add_u32 v228, 147456, v229
  v_mfma_f32_16x16x32_bf16 v[128:131], a[200:203], v[184:187], v[128:131]
  s_waitcnt lgkmcnt(8)
  v_exp_f32 v199, v199
  v_mfma_f32_16x16x32_bf16 v[132:135], a[204:207], v[168:171], v[132:135]
  ds_read_b128 a[192:195], v228 offset:0
  v_add_f32 v234, v199, v234
  v_mfma_f32_16x16x32_bf16 v[136:139], a[204:207], v[176:179], v[136:139]
  v_exp_f32 v204, v204
  v_mfma_f32_16x16x32_bf16 v[140:143], a[204:207], v[184:187], v[140:143]
  s_waitcnt lgkmcnt(7)
  v_exp_f32 v205, v205
  v_mfma_f32_16x16x32_bf16 v[144:147], a[208:211], v[168:171], v[144:147]
  ds_read_b128 a[196:199], v228 offset:256
  v_cvt_pk_bf16_f32 v195, v198, v199
  v_mfma_f32_16x16x32_bf16 v[148:151], a[208:211], v[176:179], v[148:151]
  v_exp_f32 v206, v206
  v_mfma_f32_16x16x32_bf16 v[152:155], a[208:211], v[184:187], v[152:155]
  s_waitcnt lgkmcnt(6)
  v_exp_f32 v207, v207
  v_mfma_f32_16x16x32_bf16 v[156:159], a[212:215], v[168:171], v[156:159]
  ds_read_b128 a[200:203], v228 offset:1024
  v_add_f32 v235, v204, v235
  v_mfma_f32_16x16x32_bf16 v[160:163], a[212:215], v[176:179], v[160:163]
  v_exp_f32 v212, v212
  v_mfma_f32_16x16x32_bf16 v[164:167], a[212:215], v[184:187], v[164:167]
  s_waitcnt lgkmcnt(5)
  v_exp_f32 v213, v213
  v_mfma_f32_16x16x32_bf16 a[224:227], a[216:219], v[168:171], a[224:227]
  ds_read_b128 a[204:207], v228 offset:1280
  v_add_f32 v235, v205, v235
  v_mfma_f32_16x16x32_bf16 a[228:231], a[216:219], v[176:179], a[228:231]
  v_exp_f32 v214, v214
  v_mfma_f32_16x16x32_bf16 a[232:235], a[216:219], v[184:187], a[232:235]
  s_waitcnt lgkmcnt(4)
  v_exp_f32 v215, v215
  v_mfma_f32_16x16x32_bf16 a[236:239], a[220:223], v[168:171], a[236:239]
  ds_read_b128 a[208:211], v228 offset:2048
  v_cvt_pk_bf16_f32 v202, v204, v205
  v_mfma_f32_16x16x32_bf16 a[240:243], a[220:223], v[176:179], a[240:243]
  v_add_f32 v235, v206, v235
  v_add_f32 v236, v212, v236
  v_mfma_f32_16x16x32_bf16 a[244:247], a[220:223], v[184:187], a[244:247]
  s_waitcnt lgkmcnt(4)
  v_add_f32 v235, v207, v235
  v_add_f32 v236, v213, v236
  v_mfma_f32_16x16x32_bf16 v[168:171], a[192:195], a[0:3], v[216:219]
  s_add_u32 m0, s28, 49152
  ds_read_b128 a[212:215], v228 offset:2304
  v_cvt_pk_bf16_f32 v203, v206, v207
  v_mfma_f32_16x16x32_bf16 v[176:179], a[192:195], a[4:7], v[220:223]
  s_mov_b32 s29, 248832
  v_cvt_pk_bf16_f32 v210, v212, v213
  v_add_f32 v236, v214, v236
  v_mfma_f32_16x16x32_bf16 v[184:187], a[192:195], a[8:11], v[224:227]
  s_waitcnt lgkmcnt(4)
  v_add_f32 v236, v215, v236
  v_mfma_f32_16x16x32_bf16 v[168:171], a[196:199], a[12:15], v[168:171]
  ds_read_b128 a[216:219], v228 offset:3072
  v_cvt_pk_bf16_f32 v211, v214, v215
  v_mfma_f32_16x16x32_bf16 v[176:179], a[196:199], a[16:19], v[176:179]
  v_mfma_f32_16x16x32_bf16 v[184:187], a[196:199], a[20:23], v[184:187]
  s_waitcnt lgkmcnt(4)
  v_mfma_f32_16x16x32_bf16 v[168:171], a[200:203], a[24:27], v[168:171]
  ds_read_b128 a[220:223], v228 offset:3328
  v_mfma_f32_16x16x32_bf16 v[176:179], a[200:203], a[28:31], v[176:179]
  buffer_load_dwordx4 v231, s[8:11], s29 offen offset:0 nt lds
  v_mfma_f32_16x16x32_bf16 v[184:187], a[200:203], a[32:35], v[184:187]
  s_waitcnt lgkmcnt(4)
  v_mfma_f32_16x16x32_bf16 v[168:171], a[204:207], a[36:39], v[168:171]
  s_add_u32 s29, s29, s30
  ds_read_b128 a[192:195], v228 offset:8192
  v_mfma_f32_16x16x32_bf16 v[176:179], a[204:207], a[40:43], v[176:179]
  v_mfma_f32_16x16x32_bf16 v[184:187], a[204:207], a[44:47], v[184:187]
  s_waitcnt lgkmcnt(4)
  v_mfma_f32_16x16x32_bf16 v[168:171], a[208:211], a[48:51], v[168:171]
  ds_read_b128 a[196:199], v228 offset:8448
  v_mfma_f32_16x16x32_bf16 v[176:179], a[208:211], a[52:55], v[176:179]
  buffer_load_dwordx4 v231, s[8:11], s29 offen offset:1024 nt lds
  v_mfma_f32_16x16x32_bf16 v[184:187], a[208:211], a[56:59], v[184:187]
  s_waitcnt lgkmcnt(4)
  v_mfma_f32_16x16x32_bf16 v[168:171], a[212:215], a[60:63], v[168:171]
  s_add_u32 s29, s29, s30
  ds_read_b128 a[200:203], v228 offset:9216
  v_mfma_f32_16x16x32_bf16 v[176:179], a[212:215], a[64:67], v[176:179]
  v_mfma_f32_16x16x32_bf16 v[184:187], a[212:215], a[68:71], v[184:187]
  s_waitcnt lgkmcnt(4)
  v_mfma_f32_16x16x32_bf16 v[168:171], a[216:219], a[72:75], v[168:171]
  ds_read_b128 a[204:207], v228 offset:9472
  v_mfma_f32_16x16x32_bf16 v[176:179], a[216:219], a[76:79], v[176:179]
  buffer_load_dwordx4 v231, s[8:11], s29 offen offset:2048 nt lds
  v_mfma_f32_16x16x32_bf16 v[184:187], a[216:219], a[80:83], v[184:187]
  s_waitcnt lgkmcnt(4)
  v_mfma_f32_16x16x32_bf16 v[168:171], a[220:223], a[84:87], v[168:171]
  s_add_u32 s29, s29, s30
  ds_read_b128 a[208:211], v228 offset:10240
  v_mfma_f32_16x16x32_bf16 v[176:179], a[220:223], a[88:91], v[176:179]
  v_mfma_f32_16x16x32_bf16 v[184:187], a[220:223], a[92:95], v[184:187]
  s_waitcnt lgkmcnt(4)
  v_mfma_f32_16x16x32_bf16 v[172:175], a[192:195], a[0:3], v[216:219]
  ds_read_b128 a[212:215], v228 offset:10496
  v_mfma_f32_16x16x32_bf16 v[180:183], a[192:195], a[4:7], v[220:223]
  buffer_load_dwordx4 v231, s[8:11], s29 offen offset:3072 nt lds
  v_mfma_f32_16x16x32_bf16 v[188:191], a[192:195], a[8:11], v[224:227]
  s_waitcnt lgkmcnt(4)
  v_exp_f32 v168, v168
  v_mfma_f32_16x16x32_bf16 v[172:175], a[196:199], a[12:15], v[172:175]
  s_waitcnt vmcnt(4)
  ds_read_b128 a[216:219], v228 offset:11264
  v_add_f32 v234, v168, v234
  v_mfma_f32_16x16x32_bf16 v[180:183], a[196:199], a[16:19], v[180:183]
  s_barrier
  v_exp_f32 v169, v169
  v_mfma_f32_16x16x32_bf16 v[188:191], a[196:199], a[20:23], v[188:191]
  s_waitcnt lgkmcnt(4)
  v_exp_f32 v170, v170
  v_mfma_f32_16x16x32_bf16 v[172:175], a[200:203], a[24:27], v[172:175]
  ds_read_b128 a[220:223], v228 offset:11520
  v_add_u32 v228, 0, v230
  v_mfma_f32_16x16x32_bf16 v[180:183], a[200:203], a[28:31], v[180:183]
  v_xor_b32 v239, 32, v228
  v_mfma_f32_16x16x32_bf16 v[188:191], a[200:203], a[32:35], v[188:191]
  s_waitcnt lgkmcnt(4)
  v_exp_f32 v171, v171
  v_mfma_f32_16x16x32_bf16 v[172:175], a[204:207], a[36:39], v[172:175]
  ds_read_b64_tr_b16 a[192:193], v228 offset:0
  v_add_f32 v234, v169, v234
  v_mfma_f32_16x16x32_bf16 v[180:183], a[204:207], a[40:43], v[180:183]
  ds_read_b64_tr_b16 a[194:195], v228 offset:8192
  v_cvt_pk_bf16_f32 v168, v168, v169
  v_mfma_f32_16x16x32_bf16 v[188:191], a[204:207], a[44:47], v[188:191]
  s_waitcnt lgkmcnt(5)
  v_exp_f32 v176, v176
  v_mfma_f32_16x16x32_bf16 v[172:175], a[208:211], a[48:51], v[172:175]
  ds_read_b64_tr_b16 a[196:197], v239 offset:0
  v_add_f32 v234, v170, v234
  v_mfma_f32_16x16x32_bf16 v[180:183], a[208:211], a[52:55], v[180:183]
  ds_read_b64_tr_b16 a[198:199], v239 offset:8192
  v_add_f32 v234, v171, v234
  v_mfma_f32_16x16x32_bf16 v[188:191], a[208:211], a[56:59], v[188:191]
  s_waitcnt lgkmcnt(6)
  v_exp_f32 v177, v177
  v_mfma_f32_16x16x32_bf16 v[172:175], a[212:215], a[60:63], v[172:175]
  ds_read_b64_tr_b16 a[200:201], v228 offset:256
  v_cvt_pk_bf16_f32 v169, v170, v171
  v_mfma_f32_16x16x32_bf16 v[180:183], a[212:215], a[64:67], v[180:183]
  ds_read_b64_tr_b16 a[202:203], v228 offset:8448
  v_add_f32 v235, v176, v235
  v_mfma_f32_16x16x32_bf16 v[188:191], a[212:215], a[68:71], v[188:191]
  s_waitcnt lgkmcnt(7)
  v_exp_f32 v178, v178
  v_mfma_f32_16x16x32_bf16 v[172:175], a[216:219], a[72:75], v[172:175]
  ds_read_b64_tr_b16 a[204:205], v239 offset:256
  v_add_f32 v235, v177, v235
  v_mfma_f32_16x16x32_bf16 v[180:183], a[216:219], a[76:79], v[180:183]
  ds_read_b64_tr_b16 a[206:207], v239 offset:8448
  v_cvt_pk_bf16_f32 v176, v176, v177
  v_mfma_f32_16x16x32_bf16 v[188:191], a[216:219], a[80:83], v[188:191]
  s_waitcnt lgkmcnt(8)
  v_exp_f32 v179, v179
  v_mfma_f32_16x16x32_bf16 v[172:175], a[220:223], a[84:87], v[172:175]
  ds_read_b64_tr_b16 a[208:209], v228 offset:1024
  v_add_f32 v235, v178, v235
  v_mfma_f32_16x16x32_bf16 v[180:183], a[220:223], a[88:91], v[180:183]
  ds_read_b64_tr_b16 a[210:211], v228 offset:9216
  v_add_f32 v235, v179, v235
  v_mfma_f32_16x16x32_bf16 v[188:191], a[220:223], a[92:95], v[188:191]
  s_waitcnt lgkmcnt(8)
  v_exp_f32 v184, v184
  v_mfma_f32_16x16x32_bf16 v[0:3], a[192:195], v[192:195], v[0:3]
  s_add_u32 m0, s28, 81920
  ds_read_b64_tr_b16 a[212:213], v239 offset:1024
  v_cvt_pk_bf16_f32 v177, v178, v179
  v_mfma_f32_16x16x32_bf16 v[4:7], a[192:195], v[200:203], v[4:7]
  s_mov_b32 s29, 232448
  ds_read_b64_tr_b16 a[214:215], v239 offset:9216
  v_add_f32 v236, v184, v236
  v_mfma_f32_16x16x32_bf16 v[8:11], a[192:195], v[208:211], v[8:11]
  s_waitcnt lgkmcnt(8)
  v_exp_f32 v185, v185
  v_mfma_f32_16x16x32_bf16 v[12:15], a[196:199], v[192:195], v[12:15]
  ds_read_b64_tr_b16 a[216:217], v228 offset:1280
  v_add_f32 v236, v185, v236
  v_mfma_f32_16x16x32_bf16 v[16:19], a[196:199], v[200:203], v[16:19]
  ds_read_b64_tr_b16 a[218:219], v228 offset:9472
  v_cvt_pk_bf16_f32 v184, v184, v185
  v_mfma_f32_16x16x32_bf16 v[20:23], a[196:199], v[208:211], v[20:23]
  s_waitcnt lgkmcnt(8)
  v_exp_f32 v186, v186
  v_mfma_f32_16x16x32_bf16 v[24:27], a[200:203], v[192:195], v[24:27]
  ds_read_b64_tr_b16 a[220:221], v239 offset:1280
  v_add_f32 v236, v186, v236
  v_mfma_f32_16x16x32_bf16 v[28:31], a[200:203], v[200:203], v[28:31]
  buffer_load_dwordx4 v231, s[12:15], s29 offen offset:0 nt lds
  v_mfma_f32_16x16x32_bf16 v[32:35], a[200:203], v[208:211], v[32:35]
  s_waitcnt lgkmcnt(7)
  ds_read_b64_tr_b16 a[222:223], v239 offset:9472
  v_mfma_f32_16x16x32_bf16 v[36:39], a[204:207], v[192:195], v[36:39]
  s_add_u32 s29, s29, s30
  ds_read_b64_tr_b16 a[192:193], v228 offset:2048
  v_mfma_f32_16x16x32_bf16 v[40:43], a[204:207], v[200:203], v[40:43]
  ds_read_b64_tr_b16 a[194:195], v228 offset:10240
  v_mfma_f32_16x16x32_bf16 v[44:47], a[204:207], v[208:211], v[44:47]
  s_waitcnt lgkmcnt(8)
  v_exp_f32 v187, v187
  v_mfma_f32_16x16x32_bf16 v[48:51], a[208:211], v[192:195], v[48:51]
  ds_read_b64_tr_b16 a[196:197], v239 offset:2048
  v_add_f32 v236, v187, v236
  v_mfma_f32_16x16x32_bf16 v[52:55], a[208:211], v[200:203], v[52:55]
  buffer_load_dwordx4 v231, s[12:15], s29 offen offset:1024 nt lds
  v_mfma_f32_16x16x32_bf16 v[56:59], a[208:211], v[208:211], v[56:59]
  s_waitcnt lgkmcnt(7)
  ds_read_b64_tr_b16 a[198:199], v239 offset:10240
  v_cvt_pk_bf16_f32 v185, v186, v187
  v_mfma_f32_16x16x32_bf16 v[60:63], a[212:215], v[192:195], v[60:63]
  s_add_u32 s29, s29, s30
  ds_read_b64_tr_b16 a[200:201], v228 offset:2304
  v_mfma_f32_16x16x32_bf16 v[64:67], a[212:215], v[200:203], v[64:67]
  ds_read_b64_tr_b16 a[202:203], v228 offset:10496
  v_mfma_f32_16x16x32_bf16 v[68:71], a[212:215], v[208:211], v[68:71]
  s_waitcnt lgkmcnt(8)
  v_exp_f32 v172, v172
  v_mfma_f32_16x16x32_bf16 v[72:75], a[216:219], v[192:195], v[72:75]
  ds_read_b64_tr_b16 a[204:205], v239 offset:2304
  v_add_f32 v234, v172, v234
  v_mfma_f32_16x16x32_bf16 v[76:79], a[216:219], v[200:203], v[76:79]
  buffer_load_dwordx4 v231, s[12:15], s29 offen offset:2048 nt lds
  v_mfma_f32_16x16x32_bf16 v[80:83], a[216:219], v[208:211], v[80:83]
  s_waitcnt lgkmcnt(7)
  ds_read_b64_tr_b16 a[206:207], v239 offset:10496
  v_mfma_f32_16x16x32_bf16 v[84:87], a[220:223], v[192:195], v[84:87]
  s_add_u32 s29, s29, s30
  ds_read_b64_tr_b16 a[208:209], v228 offset:3072
  v_mfma_f32_16x16x32_bf16 v[88:91], a[220:223], v[200:203], v[88:91]
  ds_read_b64_tr_b16 a[210:211], v228 offset:11264
  v_mfma_f32_16x16x32_bf16 v[92:95], a[220:223], v[208:211], v[92:95]
  s_waitcnt lgkmcnt(8)
  v_exp_f32 v173, v173
  v_mfma_f32_16x16x32_bf16 v[96:99], a[192:195], v[192:195], v[96:99]
  ds_read_b64_tr_b16 a[212:213], v239 offset:3072
  v_add_f32 v234, v173, v234
  v_mfma_f32_16x16x32_bf16 v[100:103], a[192:195], v[200:203], v[100:103]
  buffer_load_dwordx4 v231, s[12:15], s29 offen offset:3072 nt lds
  v_mfma_f32_16x16x32_bf16 v[104:107], a[192:195], v[208:211], v[104:107]
  s_waitcnt lgkmcnt(7)
  ds_read_b64_tr_b16 a[214:215], v239 offset:11264
  v_cvt_pk_bf16_f32 v170, v172, v173
  v_mfma_f32_16x16x32_bf16 v[108:111], a[196:199], v[192:195], v[108:111]
  s_waitcnt vmcnt(4)
  ds_read_b64_tr_b16 a[216:217], v228 offset:3328
  v_mfma_f32_16x16x32_bf16 v[112:115], a[196:199], v[200:203], v[112:115]
  s_barrier
  ds_read_b64_tr_b16 a[218:219], v228 offset:11520
  v_mfma_f32_16x16x32_bf16 v[116:119], a[196:199], v[208:211], v[116:119]
  s_waitcnt lgkmcnt(8)
  v_exp_f32 v174, v174
  v_mfma_f32_16x16x32_bf16 v[120:123], a[200:203], v[192:195], v[120:123]
  ds_read_b64_tr_b16 a[220:221], v239 offset:3328
  v_add_f32 v234, v174, v234
  v_mfma_f32_16x16x32_bf16 v[124:127], a[200:203], v[200:203], v[124:127]
  ds_read_b64_tr_b16 a[222:223], v239 offset:11520
  v_add_u32 v228, 49152, v229
  v_mfma_f32_16x16x32_bf16 v[128:131], a[200:203], v[208:211], v[128:131]
  s_waitcnt lgkmcnt(8)
  v_exp_f32 v175, v175
  v_mfma_f32_16x16x32_bf16 v[132:135], a[204:207], v[192:195], v[132:135]
  ds_read_b128 a[192:195], v228 offset:0
  v_add_f32 v234, v175, v234
  v_mfma_f32_16x16x32_bf16 v[136:139], a[204:207], v[200:203], v[136:139]
  v_exp_f32 v180, v180
  v_mfma_f32_16x16x32_bf16 v[140:143], a[204:207], v[208:211], v[140:143]
  s_waitcnt lgkmcnt(7)
  v_exp_f32 v181, v181
  v_mfma_f32_16x16x32_bf16 v[144:147], a[208:211], v[192:195], v[144:147]
  ds_read_b128 a[196:199], v228 offset:256
  v_cvt_pk_bf16_f32 v171, v174, v175
  v_mfma_f32_16x16x32_bf16 v[148:151], a[208:211], v[200:203], v[148:151]
  v_exp_f32 v182, v182
  v_mfma_f32_16x16x32_bf16 v[152:155], a[208:211], v[208:211], v[152:155]
  s_waitcnt lgkmcnt(6)
  v_exp_f32 v183, v183
  v_mfma_f32_16x16x32_bf16 v[156:159], a[212:215], v[192:195], v[156:159]
  ds_read_b128 a[200:203], v228 offset:1024
  v_add_f32 v235, v180, v235
  v_mfma_f32_16x16x32_bf16 v[160:163], a[212:215], v[200:203], v[160:163]
  v_exp_f32 v188, v188
  v_mfma_f32_16x16x32_bf16 v[164:167], a[212:215], v[208:211], v[164:167]
  s_waitcnt lgkmcnt(5)
  v_exp_f32 v189, v189
  v_mfma_f32_16x16x32_bf16 a[224:227], a[216:219], v[192:195], a[224:227]
  ds_read_b128 a[204:207], v228 offset:1280
  v_add_f32 v235, v181, v235
  v_mfma_f32_16x16x32_bf16 a[228:231], a[216:219], v[200:203], a[228:231]
  v_exp_f32 v190, v190
  v_mfma_f32_16x16x32_bf16 a[232:235], a[216:219], v[208:211], a[232:235]
  s_waitcnt lgkmcnt(4)
  v_exp_f32 v191, v191
  v_mfma_f32_16x16x32_bf16 a[236:239], a[220:223], v[192:195], a[236:239]
  ds_read_b128 a[208:211], v228 offset:2048
  v_cvt_pk_bf16_f32 v178, v180, v181
  v_mfma_f32_16x16x32_bf16 a[240:243], a[220:223], v[200:203], a[240:243]
  v_add_f32 v235, v182, v235
  v_add_f32 v236, v188, v236
  v_mfma_f32_16x16x32_bf16 a[244:247], a[220:223], v[208:211], a[244:247]
  s_waitcnt lgkmcnt(4)
  v_add_f32 v235, v183, v235
  v_add_f32 v236, v189, v236
  v_mfma_f32_16x16x32_bf16 v[192:195], a[192:195], a[0:3], v[216:219]
  s_add_u32 m0, s28, 131072
  ds_read_b128 a[212:215], v228 offset:2304
  v_cvt_pk_bf16_f32 v179, v182, v183
  v_mfma_f32_16x16x32_bf16 v[200:203], a[192:195], a[4:7], v[220:223]
  s_mov_b32 s29, 248832
  v_cvt_pk_bf16_f32 v186, v188, v189
  v_add_f32 v236, v190, v236
  v_mfma_f32_16x16x32_bf16 v[208:211], a[192:195], a[8:11], v[224:227]
  s_waitcnt lgkmcnt(4)
  v_add_f32 v236, v191, v236
  v_mfma_f32_16x16x32_bf16 v[192:195], a[196:199], a[12:15], v[192:195]
  ds_read_b128 a[216:219], v228 offset:3072
  v_cvt_pk_bf16_f32 v187, v190, v191
  v_mfma_f32_16x16x32_bf16 v[200:203], a[196:199], a[16:19], v[200:203]
  buffer_load_dwordx4 v231, s[12:15], s29 offen offset:0 nt lds
  v_mfma_f32_16x16x32_bf16 v[208:211], a[196:199], a[20:23], v[208:211]
  s_waitcnt lgkmcnt(4)
  v_mfma_f32_16x16x32_bf16 v[192:195], a[200:203], a[24:27], v[192:195]
  s_add_u32 s29, s29, s30
  ds_read_b128 a[220:223], v228 offset:3328
  v_mfma_f32_16x16x32_bf16 v[200:203], a[200:203], a[28:31], v[200:203]
  v_mfma_f32_16x16x32_bf16 v[208:211], a[200:203], a[32:35], v[208:211]
  s_waitcnt lgkmcnt(4)
  v_mfma_f32_16x16x32_bf16 v[192:195], a[204:207], a[36:39], v[192:195]
  ds_read_b128 a[192:195], v228 offset:8192
  v_mfma_f32_16x16x32_bf16 v[200:203], a[204:207], a[40:43], v[200:203]
  buffer_load_dwordx4 v231, s[12:15], s29 offen offset:1024 nt lds
  v_mfma_f32_16x16x32_bf16 v[208:211], a[204:207], a[44:47], v[208:211]
  s_waitcnt lgkmcnt(4)
  v_mfma_f32_16x16x32_bf16 v[192:195], a[208:211], a[48:51], v[192:195]
  s_add_u32 s29, s29, s30
  ds_read_b128 a[196:199], v228 offset:8448
  v_mfma_f32_16x16x32_bf16 v[200:203], a[208:211], a[52:55], v[200:203]
  v_mfma_f32_16x16x32_bf16 v[208:211], a[208:211], a[56:59], v[208:211]
  s_waitcnt lgkmcnt(4)
  v_mfma_f32_16x16x32_bf16 v[192:195], a[212:215], a[60:63], v[192:195]
  ds_read_b128 a[200:203], v228 offset:9216
  v_mfma_f32_16x16x32_bf16 v[200:203], a[212:215], a[64:67], v[200:203]
  buffer_load_dwordx4 v231, s[12:15], s29 offen offset:2048 nt lds
  v_mfma_f32_16x16x32_bf16 v[208:211], a[212:215], a[68:71], v[208:211]
  s_waitcnt lgkmcnt(4)
  v_mfma_f32_16x16x32_bf16 v[192:195], a[216:219], a[72:75], v[192:195]
  s_add_u32 s29, s29, s30
  ds_read_b128 a[204:207], v228 offset:9472
  v_mfma_f32_16x16x32_bf16 v[200:203], a[216:219], a[76:79], v[200:203]
  v_mfma_f32_16x16x32_bf16 v[208:211], a[216:219], a[80:83], v[208:211]
  s_waitcnt lgkmcnt(4)
  v_mfma_f32_16x16x32_bf16 v[192:195], a[220:223], a[84:87], v[192:195]
  ds_read_b128 a[208:211], v228 offset:10240
  v_mfma_f32_16x16x32_bf16 v[200:203], a[220:223], a[88:91], v[200:203]
  buffer_load_dwordx4 v231, s[12:15], s29 offen offset:3072 nt lds
  v_mfma_f32_16x16x32_bf16 v[208:211], a[220:223], a[92:95], v[208:211]
  s_waitcnt lgkmcnt(4)
  v_mfma_f32_16x16x32_bf16 v[196:199], a[192:195], a[0:3], v[216:219]
  s_add_u32 m0, s28, 147456
  ds_read_b128 a[212:215], v228 offset:10496
  v_mfma_f32_16x16x32_bf16 v[204:207], a[192:195], a[4:7], v[220:223]
  s_mov_b32 s29, 265216
  buffer_load_dwordx4 v231, s[8:11], s29 offen offset:0 nt lds
  v_mfma_f32_16x16x32_bf16 v[212:215], a[192:195], a[8:11], v[224:227]
  s_waitcnt lgkmcnt(4)
  v_exp_f32 v192, v192
  v_mfma_f32_16x16x32_bf16 v[196:199], a[196:199], a[12:15], v[196:199]
  s_waitcnt vmcnt(5)
  ds_read_b128 a[216:219], v228 offset:11264
  v_add_f32 v234, v192, v234
  v_mfma_f32_16x16x32_bf16 v[204:207], a[196:199], a[16:19], v[204:207]
  s_barrier
  v_exp_f32 v193, v193
  v_mfma_f32_16x16x32_bf16 v[212:215], a[196:199], a[20:23], v[212:215]
  s_waitcnt lgkmcnt(4)
  v_exp_f32 v194, v194
  v_mfma_f32_16x16x32_bf16 v[196:199], a[200:203], a[24:27], v[196:199]
  s_add_u32 s29, s29, s30
  ds_read_b128 a[220:223], v228 offset:11520
  v_add_u32 v228, 81920, v230
  v_mfma_f32_16x16x32_bf16 v[204:207], a[200:203], a[28:31], v[204:207]
  v_xor_b32 v239, 32, v228
  v_mfma_f32_16x16x32_bf16 v[212:215], a[200:203], a[32:35], v[212:215]
  s_waitcnt lgkmcnt(4)
  v_exp_f32 v195, v195
  v_mfma_f32_16x16x32_bf16 v[196:199], a[204:207], a[36:39], v[196:199]
  ds_read_b64_tr_b16 a[192:193], v228 offset:0
  v_add_f32 v234, v193, v234
  v_mfma_f32_16x16x32_bf16 v[204:207], a[204:207], a[40:43], v[204:207]
  buffer_load_dwordx4 v231, s[8:11], s29 offen offset:1024 nt lds
  v_mfma_f32_16x16x32_bf16 v[212:215], a[204:207], a[44:47], v[212:215]
  s_waitcnt lgkmcnt(4)
  ds_read_b64_tr_b16 a[194:195], v228 offset:8192
  v_cvt_pk_bf16_f32 v192, v192, v193
  v_mfma_f32_16x16x32_bf16 v[196:199], a[208:211], a[48:51], v[196:199]
  s_add_u32 s29, s29, s30
  ds_read_b64_tr_b16 a[196:197], v239 offset:0
  v_add_f32 v234, v194, v234
  v_mfma_f32_16x16x32_bf16 v[204:207], a[208:211], a[52:55], v[204:207]
  ds_read_b64_tr_b16 a[198:199], v239 offset:8192
  v_add_f32 v234, v195, v234
  v_mfma_f32_16x16x32_bf16 v[212:215], a[208:211], a[56:59], v[212:215]
  s_waitcnt lgkmcnt(6)
  v_exp_f32 v200, v200
  v_mfma_f32_16x16x32_bf16 v[196:199], a[212:215], a[60:63], v[196:199]
  ds_read_b64_tr_b16 a[200:201], v228 offset:256
  v_cvt_pk_bf16_f32 v193, v194, v195
  v_mfma_f32_16x16x32_bf16 v[204:207], a[212:215], a[64:67], v[204:207]
  buffer_load_dwordx4 v231, s[8:11], s29 offen offset:2048 nt lds
  v_mfma_f32_16x16x32_bf16 v[212:215], a[212:215], a[68:71], v[212:215]
  s_waitcnt lgkmcnt(6)
  ds_read_b64_tr_b16 a[202:203], v228 offset:8448
  v_add_f32 v235, v200, v235
  v_mfma_f32_16x16x32_bf16 v[196:199], a[216:219], a[72:75], v[196:199]
  s_add_u32 s29, s29, s30
  ds_read_b64_tr_b16 a[204:205], v239 offset:256
  v_mfma_f32_16x16x32_bf16 v[204:207], a[216:219], a[76:79], v[204:207]
  ds_read_b64_tr_b16 a[206:207], v239 offset:8448
  v_mfma_f32_16x16x32_bf16 v[212:215], a[216:219], a[80:83], v[212:215]
  s_waitcnt lgkmcnt(8)
  v_exp_f32 v201, v201
  v_mfma_f32_16x16x32_bf16 v[196:199], a[220:223], a[84:87], v[196:199]
  ds_read_b64_tr_b16 a[208:209], v228 offset:1024
  v_add_f32 v235, v201, v235
  v_mfma_f32_16x16x32_bf16 v[204:207], a[220:223], a[88:91], v[204:207]
  buffer_load_dwordx4 v231, s[8:11], s29 offen offset:3072 nt lds
  v_mfma_f32_16x16x32_bf16 v[212:215], a[220:223], a[92:95], v[212:215]
  s_waitcnt lgkmcnt(7)
  ds_read_b64_tr_b16 a[210:211], v228 offset:9216
  v_cvt_pk_bf16_f32 v200, v200, v201
  v_mfma_f32_16x16x32_bf16 v[0:3], a[192:195], v[168:171], v[0:3]
  s_add_u32 m0, s28, 0
  ds_read_b64_tr_b16 a[212:213], v239 offset:1024
  v_mfma_f32_16x16x32_bf16 v[4:7], a[192:195], v[176:179], v[4:7]
  s_mov_b32 s29, 527872
  ds_read_b64_tr_b16 a[214:215], v239 offset:9216
  v_mfma_f32_16x16x32_bf16 v[8:11], a[192:195], v[184:187], v[8:11]
  s_waitcnt lgkmcnt(8)
  v_exp_f32 v202, v202
  v_mfma_f32_16x16x32_bf16 v[12:15], a[196:199], v[168:171], v[12:15]
  ds_read_b64_tr_b16 a[216:217], v228 offset:1280
  v_add_f32 v235, v202, v235
  v_mfma_f32_16x16x32_bf16 v[16:19], a[196:199], v[176:179], v[16:19]
  ds_read_b64_tr_b16 a[218:219], v228 offset:9472
  v_mfma_f32_16x16x32_bf16 v[20:23], a[196:199], v[184:187], v[20:23]
  s_waitcnt lgkmcnt(8)
  v_exp_f32 v203, v203
  v_mfma_f32_16x16x32_bf16 v[24:27], a[200:203], v[168:171], v[24:27]
  ds_read_b64_tr_b16 a[220:221], v239 offset:1280
  v_add_f32 v235, v203, v235
  v_mfma_f32_16x16x32_bf16 v[28:31], a[200:203], v[176:179], v[28:31]
  buffer_load_dwordx4 v232, s[16:19], s29 offen offset:0 lds
  v_mfma_f32_16x16x32_bf16 v[32:35], a[200:203], v[184:187], v[32:35]
  s_waitcnt lgkmcnt(7)
  ds_read_b64_tr_b16 a[222:223], v239 offset:9472
  v_cvt_pk_bf16_f32 v201, v202, v203
  v_mfma_f32_16x16x32_bf16 v[36:39], a[204:207], v[168:171], v[36:39]
  s_add_u32 s29, s29, s30
  ds_read_b64_tr_b16 a[192:193], v228 offset:2048
  v_mfma_f32_16x16x32_bf16 v[40:43], a[204:207], v[176:179], v[40:43]
  ds_read_b64_tr_b16 a[194:195], v228 offset:10240
  v_mfma_f32_16x16x32_bf16 v[44:47], a[204:207], v[184:187], v[44:47]
  s_waitcnt lgkmcnt(8)
  v_exp_f32 v208, v208
  v_mfma_f32_16x16x32_bf16 v[48:51], a[208:211], v[168:171], v[48:51]
  ds_read_b64_tr_b16 a[196:197], v239 offset:2048
  v_add_f32 v236, v208, v236
  v_mfma_f32_16x16x32_bf16 v[52:55], a[208:211], v[176:179], v[52:55]
  buffer_load_dwordx4 v232, s[16:19], s29 offen offset:1024 lds
  v_mfma_f32_16x16x32_bf16 v[56:59], a[208:211], v[184:187], v[56:59]
  s_waitcnt lgkmcnt(7)
  ds_read_b64_tr_b16 a[198:199], v239 offset:10240
  v_mfma_f32_16x16x32_bf16 v[60:63], a[212:215], v[168:171], v[60:63]
  s_add_u32 s29, s29, s30
  ds_read_b64_tr_b16 a[200:201], v228 offset:2304
  v_mfma_f32_16x16x32_bf16 v[64:67], a[212:215], v[176:179], v[64:67]
  ds_read_b64_tr_b16 a[202:203], v228 offset:10496
  v_mfma_f32_16x16x32_bf16 v[68:71], a[212:215], v[184:187], v[68:71]
  s_waitcnt lgkmcnt(8)
  v_exp_f32 v209, v209
  v_mfma_f32_16x16x32_bf16 v[72:75], a[216:219], v[168:171], v[72:75]
  ds_read_b64_tr_b16 a[204:205], v239 offset:2304
  v_add_f32 v236, v209, v236
  v_mfma_f32_16x16x32_bf16 v[76:79], a[216:219], v[176:179], v[76:79]
  buffer_load_dwordx4 v232, s[16:19], s29 offen offset:2048 lds
  v_mfma_f32_16x16x32_bf16 v[80:83], a[216:219], v[184:187], v[80:83]
  s_waitcnt lgkmcnt(7)
  ds_read_b64_tr_b16 a[206:207], v239 offset:10496
  v_cvt_pk_bf16_f32 v208, v208, v209
  v_mfma_f32_16x16x32_bf16 v[84:87], a[220:223], v[168:171], v[84:87]
  s_add_u32 s29, s29, s30
  ds_read_b64_tr_b16 a[208:209], v228 offset:3072
  v_mfma_f32_16x16x32_bf16 v[88:91], a[220:223], v[176:179], v[88:91]
  ds_read_b64_tr_b16 a[210:211], v228 offset:11264
  v_mfma_f32_16x16x32_bf16 v[92:95], a[220:223], v[184:187], v[92:95]
  s_waitcnt lgkmcnt(8)
  v_exp_f32 v210, v210
  v_mfma_f32_16x16x32_bf16 v[96:99], a[192:195], v[168:171], v[96:99]
  ds_read_b64_tr_b16 a[212:213], v239 offset:3072
  v_add_f32 v236, v210, v236
  v_mfma_f32_16x16x32_bf16 v[100:103], a[192:195], v[176:179], v[100:103]
  buffer_load_dwordx4 v232, s[16:19], s29 offen offset:3072 lds
  v_mfma_f32_16x16x32_bf16 v[104:107], a[192:195], v[184:187], v[104:107]
  s_waitcnt lgkmcnt(7)
  ds_read_b64_tr_b16 a[214:215], v239 offset:11264
  v_mfma_f32_16x16x32_bf16 v[108:111], a[196:199], v[168:171], v[108:111]
  s_waitcnt vmcnt(8)
  ds_read_b64_tr_b16 a[216:217], v228 offset:3328
  v_mfma_f32_16x16x32_bf16 v[112:115], a[196:199], v[176:179], v[112:115]
  s_barrier
  ds_read_b64_tr_b16 a[218:219], v228 offset:11520
  v_mfma_f32_16x16x32_bf16 v[116:119], a[196:199], v[184:187], v[116:119]
  s_waitcnt lgkmcnt(8)
  v_exp_f32 v211, v211
  v_mfma_f32_16x16x32_bf16 v[120:123], a[200:203], v[168:171], v[120:123]
  ds_read_b64_tr_b16 a[220:221], v239 offset:3328
  v_add_f32 v236, v211, v236
  v_mfma_f32_16x16x32_bf16 v[124:127], a[200:203], v[176:179], v[124:127]
  ds_read_b64_tr_b16 a[222:223], v239 offset:11520
  v_add_u32 v228, 131072, v230
  v_mfma_f32_16x16x32_bf16 v[128:131], a[200:203], v[184:187], v[128:131]
  s_waitcnt lgkmcnt(8)
  v_xor_b32 v239, 32, v228
  v_mfma_f32_16x16x32_bf16 v[132:135], a[204:207], v[168:171], v[132:135]
  ds_read_b64_tr_b16 a[192:193], v228 offset:0
  v_cvt_pk_bf16_f32 v209, v210, v211
  v_mfma_f32_16x16x32_bf16 v[136:139], a[204:207], v[176:179], v[136:139]
  ds_read_b64_tr_b16 a[194:195], v228 offset:8192
  v_mfma_f32_16x16x32_bf16 v[140:143], a[204:207], v[184:187], v[140:143]
  s_waitcnt lgkmcnt(8)
  v_exp_f32 v196, v196
  v_mfma_f32_16x16x32_bf16 v[144:147], a[208:211], v[168:171], v[144:147]
  ds_read_b64_tr_b16 a[196:197], v239 offset:0
  v_add_f32 v234, v196, v234
  v_mfma_f32_16x16x32_bf16 v[148:151], a[208:211], v[176:179], v[148:151]
  ds_read_b64_tr_b16 a[198:199], v239 offset:8192
  v_mfma_f32_16x16x32_bf16 v[152:155], a[208:211], v[184:187], v[152:155]
  s_waitcnt lgkmcnt(8)
  v_exp_f32 v197, v197
  v_mfma_f32_16x16x32_bf16 v[156:159], a[212:215], v[168:171], v[156:159]
  ds_read_b64_tr_b16 a[200:201], v228 offset:256
  v_add_f32 v234, v197, v234
  v_mfma_f32_16x16x32_bf16 v[160:163], a[212:215], v[176:179], v[160:163]
  ds_read_b64_tr_b16 a[202:203], v228 offset:8448
  v_cvt_pk_bf16_f32 v194, v196, v197
  v_mfma_f32_16x16x32_bf16 v[164:167], a[212:215], v[184:187], v[164:167]
  s_waitcnt lgkmcnt(8)
  v_exp_f32 v198, v198
  v_mfma_f32_16x16x32_bf16 a[224:227], a[216:219], v[168:171], a[224:227]
  ds_read_b64_tr_b16 a[204:205], v239 offset:256
  v_add_f32 v234, v198, v234
  v_mfma_f32_16x16x32_bf16 a[228:231], a[216:219], v[176:179], a[228:231]
  ds_read_b64_tr_b16 a[206:207], v239 offset:8448
  v_mfma_f32_16x16x32_bf16 a[232:235], a[216:219], v[184:187], a[232:235]
  s_waitcnt lgkmcnt(8)
  v_exp_f32 v199, v199
  v_mfma_f32_16x16x32_bf16 a[236:239], a[220:223], v[168:171], a[236:239]
  ds_read_b64_tr_b16 a[208:209], v228 offset:1024
  v_add_f32 v234, v199, v234
  v_mfma_f32_16x16x32_bf16 a[240:243], a[220:223], v[176:179], a[240:243]
  ds_read_b64_tr_b16 a[210:211], v228 offset:9216
  v_cvt_pk_bf16_f32 v195, v198, v199
  v_exp_f32 v204, v204
  v_exp_f32 v205, v205
  v_exp_f32 v206, v206
  v_exp_f32 v207, v207
  v_exp_f32 v212, v212
  v_exp_f32 v213, v213
  v_exp_f32 v214, v214
  v_exp_f32 v215, v215
  v_add_f32 v235, v204, v235
  v_add_f32 v235, v205, v235
  v_cvt_pk_bf16_f32 v202, v204, v205
  v_add_f32 v235, v206, v235
  v_add_f32 v235, v207, v235
  v_cvt_pk_bf16_f32 v203, v206, v207
  v_add_f32 v236, v212, v236
  v_add_f32 v236, v213, v236
  v_cvt_pk_bf16_f32 v210, v212, v213
  v_add_f32 v236, v214, v236
  v_add_f32 v236, v215, v236
  v_cvt_pk_bf16_f32 v211, v214, v215
  v_mfma_f32_16x16x32_bf16 a[244:247], a[220:223], v[184:187], a[244:247]
  s_waitcnt lgkmcnt(8)
  v_mfma_f32_16x16x32_bf16 v[0:3], a[192:195], v[192:195], v[0:3]
  ds_read_b64_tr_b16 a[212:213], v239 offset:1024
  v_mfma_f32_16x16x32_bf16 v[4:7], a[192:195], v[200:203], v[4:7]
  ds_read_b64_tr_b16 a[214:215], v239 offset:9216
  v_mfma_f32_16x16x32_bf16 v[8:11], a[192:195], v[208:211], v[8:11]
  s_waitcnt lgkmcnt(8)
  v_mfma_f32_16x16x32_bf16 v[12:15], a[196:199], v[192:195], v[12:15]
  ds_read_b64_tr_b16 a[216:217], v228 offset:1280
  v_mfma_f32_16x16x32_bf16 v[16:19], a[196:199], v[200:203], v[16:19]
  ds_read_b64_tr_b16 a[218:219], v228 offset:9472
  v_mfma_f32_16x16x32_bf16 v[20:23], a[196:199], v[208:211], v[20:23]
  s_waitcnt lgkmcnt(8)
  v_mfma_f32_16x16x32_bf16 v[24:27], a[200:203], v[192:195], v[24:27]
  ds_read_b64_tr_b16 a[220:221], v239 offset:1280
  v_mfma_f32_16x16x32_bf16 v[28:31], a[200:203], v[200:203], v[28:31]
  ds_read_b64_tr_b16 a[222:223], v239 offset:9472
  v_mfma_f32_16x16x32_bf16 v[32:35], a[200:203], v[208:211], v[32:35]
  s_waitcnt lgkmcnt(8)
  v_mfma_f32_16x16x32_bf16 v[36:39], a[204:207], v[192:195], v[36:39]
  ds_read_b64_tr_b16 a[192:193], v228 offset:2048
  v_mfma_f32_16x16x32_bf16 v[40:43], a[204:207], v[200:203], v[40:43]
  ds_read_b64_tr_b16 a[194:195], v228 offset:10240
  v_mfma_f32_16x16x32_bf16 v[44:47], a[204:207], v[208:211], v[44:47]
  s_waitcnt lgkmcnt(8)
  v_mfma_f32_16x16x32_bf16 v[48:51], a[208:211], v[192:195], v[48:51]
  ds_read_b64_tr_b16 a[196:197], v239 offset:2048
  v_mfma_f32_16x16x32_bf16 v[52:55], a[208:211], v[200:203], v[52:55]
  ds_read_b64_tr_b16 a[198:199], v239 offset:10240
  v_mfma_f32_16x16x32_bf16 v[56:59], a[208:211], v[208:211], v[56:59]
  s_waitcnt lgkmcnt(8)
  v_mfma_f32_16x16x32_bf16 v[60:63], a[212:215], v[192:195], v[60:63]
  ds_read_b64_tr_b16 a[200:201], v228 offset:2304
  v_mfma_f32_16x16x32_bf16 v[64:67], a[212:215], v[200:203], v[64:67]
  ds_read_b64_tr_b16 a[202:203], v228 offset:10496
  v_mfma_f32_16x16x32_bf16 v[68:71], a[212:215], v[208:211], v[68:71]
  s_waitcnt lgkmcnt(8)
  v_mfma_f32_16x16x32_bf16 v[72:75], a[216:219], v[192:195], v[72:75]
  ds_read_b64_tr_b16 a[204:205], v239 offset:2304
  v_mfma_f32_16x16x32_bf16 v[76:79], a[216:219], v[200:203], v[76:79]
  ds_read_b64_tr_b16 a[206:207], v239 offset:10496
  v_mfma_f32_16x16x32_bf16 v[80:83], a[216:219], v[208:211], v[80:83]
  s_waitcnt lgkmcnt(8)
  v_mfma_f32_16x16x32_bf16 v[84:87], a[220:223], v[192:195], v[84:87]
  ds_read_b64_tr_b16 a[208:209], v228 offset:3072
  v_mfma_f32_16x16x32_bf16 v[88:91], a[220:223], v[200:203], v[88:91]
  ds_read_b64_tr_b16 a[210:211], v228 offset:11264
  v_mfma_f32_16x16x32_bf16 v[92:95], a[220:223], v[208:211], v[92:95]
  s_waitcnt lgkmcnt(8)
  v_mfma_f32_16x16x32_bf16 v[96:99], a[192:195], v[192:195], v[96:99]
  ds_read_b64_tr_b16 a[212:213], v239 offset:3072
  v_mfma_f32_16x16x32_bf16 v[100:103], a[192:195], v[200:203], v[100:103]
  ds_read_b64_tr_b16 a[214:215], v239 offset:11264
  v_mfma_f32_16x16x32_bf16 v[104:107], a[192:195], v[208:211], v[104:107]
  s_waitcnt lgkmcnt(8)
  v_mfma_f32_16x16x32_bf16 v[108:111], a[196:199], v[192:195], v[108:111]
  s_waitcnt vmcnt(63)
  ds_read_b64_tr_b16 a[216:217], v228 offset:3328
  v_mfma_f32_16x16x32_bf16 v[112:115], a[196:199], v[200:203], v[112:115]
  s_barrier
  ds_read_b64_tr_b16 a[218:219], v228 offset:11520
  v_mfma_f32_16x16x32_bf16 v[116:119], a[196:199], v[208:211], v[116:119]
  s_waitcnt lgkmcnt(8)
  v_mfma_f32_16x16x32_bf16 v[120:123], a[200:203], v[192:195], v[120:123]
  ds_read_b64_tr_b16 a[220:221], v239 offset:3328
  v_mfma_f32_16x16x32_bf16 v[124:127], a[200:203], v[200:203], v[124:127]
  ds_read_b64_tr_b16 a[222:223], v239 offset:11520
  v_mfma_f32_16x16x32_bf16 v[128:131], a[200:203], v[208:211], v[128:131]
  s_waitcnt lgkmcnt(8)
  v_mfma_f32_16x16x32_bf16 v[132:135], a[204:207], v[192:195], v[132:135]
  v_mfma_f32_16x16x32_bf16 v[136:139], a[204:207], v[200:203], v[136:139]
  v_mfma_f32_16x16x32_bf16 v[140:143], a[204:207], v[208:211], v[140:143]
  s_waitcnt lgkmcnt(6)
  v_mfma_f32_16x16x32_bf16 v[144:147], a[208:211], v[192:195], v[144:147]
  v_mfma_f32_16x16x32_bf16 v[148:151], a[208:211], v[200:203], v[148:151]
  v_mfma_f32_16x16x32_bf16 v[152:155], a[208:211], v[208:211], v[152:155]
  s_waitcnt lgkmcnt(4)
  v_mfma_f32_16x16x32_bf16 v[156:159], a[212:215], v[192:195], v[156:159]
  v_mfma_f32_16x16x32_bf16 v[160:163], a[212:215], v[200:203], v[160:163]
  v_mfma_f32_16x16x32_bf16 v[164:167], a[212:215], v[208:211], v[164:167]
  s_waitcnt lgkmcnt(2)
  v_mfma_f32_16x16x32_bf16 a[224:227], a[216:219], v[192:195], a[224:227]
  v_mfma_f32_16x16x32_bf16 a[228:231], a[216:219], v[200:203], a[228:231]
  v_mfma_f32_16x16x32_bf16 a[232:235], a[216:219], v[208:211], a[232:235]
  s_waitcnt lgkmcnt(0)
  v_mfma_f32_16x16x32_bf16 a[236:239], a[220:223], v[192:195], a[236:239]
  v_mfma_f32_16x16x32_bf16 a[240:243], a[220:223], v[200:203], a[240:243]
  v_mfma_f32_16x16x32_bf16 a[244:247], a[220:223], v[208:211], a[244:247]
  v_mov_b32 v240, v234
  v_mov_b32 v241, v235
  v_mov_b32 v242, v236
  v_permlane32_swap_b32 v234, v240
  v_permlane32_swap_b32 v235, v241
  v_permlane32_swap_b32 v236, v242
  v_add_f32 v234, v234, v240
  v_add_f32 v235, v235, v241
  v_add_f32 v236, v236, v242
  v_mov_b32 v240, v234
  v_mov_b32 v241, v235
  v_mov_b32 v242, v236
  v_permlane16_swap_b32 v234, v240
  v_permlane16_swap_b32 v235, v241
  v_permlane16_swap_b32 v236, v242
  v_add_f32 v234, v234, v240
  v_add_f32 v235, v235, v241
  v_add_f32 v236, v236, v242
  v_add_f32 v241, v234, v235
  v_add_f32 v241, v241, v236
  v_cmp_nge_f32 vcc, s40, v241
  s_nop 0
  s_cbranch_vccnz L_slow
L_back0:
  v_rcp_f32 v234, v234
  v_rcp_f32 v235, v235
  v_rcp_f32 v236, v236
  v_mov_b32 v216, v234
  v_mov_b32 v217, v234
  v_mov_b32 v218, v235
  v_mov_b32 v219, v235
  v_mov_b32 v220, v236
  v_mov_b32 v221, v236
  buffer_load_dwordx4 a[252:255], v247, s[88:91], 0 offen offset:0
  s_waitcnt vmcnt(63)
  v_add_u32 v238, 98304, v237
  ds_read_b128 v[168:171], v238 offset:0
  ds_read_b128 v[180:183], v238 offset:256
  ds_read_b128 v[172:175], v238 offset:2048
  ds_read_b128 v[184:187], v238 offset:2304
  s_waitcnt lgkmcnt(8)
  v_add_u32 v238, 16384, v237
  ds_read_b128 v[176:179], v238 offset:0
  ds_read_b128 v[188:191], v238 offset:256
  ds_read_b128 v[192:195], v238 offset:2048
  ds_read_b128 v[204:207], v238 offset:2304
  s_waitcnt lgkmcnt(8)
  v_add_u32 v238, 32768, v237
  ds_read_b128 v[196:199], v238 offset:0
  ds_read_b128 v[208:211], v238 offset:256
  ds_read_b128 v[200:203], v238 offset:2048
  ds_read_b128 v[212:215], v238 offset:2304
  s_waitcnt lgkmcnt(8)
  s_waitcnt vmcnt(63)
  v_accvgpr_read_b32 v242, a248
  v_accvgpr_read_b32 v243, a249
  v_mov_b32 v241, 49152
  v_readfirstlane_b32 s36, v242
  v_readfirstlane_b32 s37, v243
  s_nop 0
  s_cmp_eq_u64 s[36:37], 0
  s_cselect_b64 s[72:73], s[72:73], s[36:37]
  v_mov_b32 v242, s72
  v_mov_b32 v243, s73
  s_cmp_lg_u32 s34, 0
  s_cbranch_scc1 L_nw
  ds_write_b64 v241, v[242:243]
L_nw:
.p2align 3
  v_pk_mul_f32 v[0:1], v[0:1], v[216:217]
  v_pk_mul_f32 v[2:3], v[2:3], v[216:217]
  v_pk_mul_f32 v[12:13], v[12:13], v[216:217]
  v_pk_mul_f32 v[14:15], v[14:15], v[216:217]
  v_cvt_pk_bf16_f32 v0, v0, v1
  v_cvt_pk_bf16_f32 v1, v2, v3
  v_cvt_pk_bf16_f32 v12, v12, v13
  v_cvt_pk_bf16_f32 v13, v14, v15
  v_pk_mul_f32 v[4:5], v[4:5], v[218:219]
  v_pk_mul_f32 v[6:7], v[6:7], v[218:219]
  v_pk_mul_f32 v[16:17], v[16:17], v[218:219]
  v_pk_mul_f32 v[18:19], v[18:19], v[218:219]
  v_cvt_pk_bf16_f32 v4, v4, v5
  v_cvt_pk_bf16_f32 v5, v6, v7
  v_cvt_pk_bf16_f32 v16, v16, v17
  v_cvt_pk_bf16_f32 v17, v18, v19
  v_pk_mul_f32 v[8:9], v[8:9], v[220:221]
  v_pk_mul_f32 v[10:11], v[10:11], v[220:221]
  v_pk_mul_f32 v[20:21], v[20:21], v[220:221]
  v_pk_mul_f32 v[22:23], v[22:23], v[220:221]
  v_cvt_pk_bf16_f32 v8, v8, v9
  v_cvt_pk_bf16_f32 v9, v10, v11
  v_cvt_pk_bf16_f32 v20, v20, v21
  v_cvt_pk_bf16_f32 v21, v22, v23
  v_accvgpr_write_b32 a96, v0
  v_accvgpr_write_b32 a97, v1
  v_accvgpr_write_b32 a98, v12
  v_accvgpr_write_b32 a99, v13
  v_pk_mul_f32 v[24:25], v[24:25], v[216:217]
  v_pk_mul_f32 v[26:27], v[26:27], v[216:217]
  v_pk_mul_f32 v[36:37], v[36:37], v[216:217]
  v_pk_mul_f32 v[38:39], v[38:39], v[216:217]
  v_cvt_pk_bf16_f32 v24, v24, v25
  v_cvt_pk_bf16_f32 v25, v26, v27
  v_cvt_pk_bf16_f32 v36, v36, v37
  v_cvt_pk_bf16_f32 v37, v38, v39
  v_accvgpr_write_b32 a100, v4
  v_accvgpr_write_b32 a101, v5
  v_accvgpr_write_b32 a102, v16
  v_accvgpr_write_b32 a103, v17
  s_waitcnt lgkmcnt(0)
  s_barrier
  ds_read_b64 v[242:243], v241 offset:0
  v_pk_mul_f32 v[28:29], v[28:29], v[218:219]
  v_pk_mul_f32 v[30:31], v[30:31], v[218:219]
  v_pk_mul_f32 v[40:41], v[40:41], v[218:219]
  v_pk_mul_f32 v[42:43], v[42:43], v[218:219]
  v_cvt_pk_bf16_f32 v28, v28, v29
  v_cvt_pk_bf16_f32 v29, v30, v31
  v_cvt_pk_bf16_f32 v40, v40, v41
  v_cvt_pk_bf16_f32 v41, v42, v43
  v_accvgpr_write_b32 a104, v8
  v_accvgpr_write_b32 a105, v9
  v_accvgpr_write_b32 a106, v20
  v_accvgpr_write_b32 a107, v21
  v_pk_mul_f32 v[32:33], v[32:33], v[220:221]
  v_pk_mul_f32 v[34:35], v[34:35], v[220:221]
  v_pk_mul_f32 v[44:45], v[44:45], v[220:221]
  v_pk_mul_f32 v[46:47], v[46:47], v[220:221]
  v_cvt_pk_bf16_f32 v32, v32, v33
  v_cvt_pk_bf16_f32 v33, v34, v35
  v_cvt_pk_bf16_f32 v44, v44, v45
  v_cvt_pk_bf16_f32 v45, v46, v47
  s_waitcnt lgkmcnt(0)
  v_readfirstlane_b32 s72, v242
  v_readfirstlane_b32 s73, v243
.p2align 3
  v_accvgpr_write_b32 a108, v24
  v_accvgpr_write_b32 a109, v25
  v_accvgpr_write_b32 a110, v36
  v_accvgpr_write_b32 a111, v37
  v_pk_mul_f32 v[48:49], v[48:49], v[216:217]
  v_pk_mul_f32 v[50:51], v[50:51], v[216:217]
  v_pk_mul_f32 v[60:61], v[60:61], v[216:217]
  v_pk_mul_f32 v[62:63], v[62:63], v[216:217]
  v_cvt_pk_bf16_f32 v48, v48, v49
  v_cvt_pk_bf16_f32 v49, v50, v51
  v_cvt_pk_bf16_f32 v60, v60, v61
  v_cvt_pk_bf16_f32 v61, v62, v63
  v_accvgpr_write_b32 a112, v28
  v_accvgpr_write_b32 a113, v29
  v_accvgpr_write_b32 a114, v40
  v_accvgpr_write_b32 a115, v41
  v_pk_mul_f32 v[52:53], v[52:53], v[218:219]
  v_pk_mul_f32 v[54:55], v[54:55], v[218:219]
  v_pk_mul_f32 v[64:65], v[64:65], v[218:219]
  v_pk_mul_f32 v[66:67], v[66:67], v[218:219]
  v_cvt_pk_bf16_f32 v52, v52, v53
  v_cvt_pk_bf16_f32 v53, v54, v55
  v_cvt_pk_bf16_f32 v64, v64, v65
  v_cvt_pk_bf16_f32 v65, v66, v67
  v_accvgpr_write_b32 a116, v32
  v_accvgpr_write_b32 a117, v33
  v_accvgpr_write_b32 a118, v44
  v_accvgpr_write_b32 a119, v45
  v_pk_mul_f32 v[56:57], v[56:57], v[220:221]
  v_pk_mul_f32 v[58:59], v[58:59], v[220:221]
  v_pk_mul_f32 v[68:69], v[68:69], v[220:221]
  v_pk_mul_f32 v[70:71], v[70:71], v[220:221]
  v_cvt_pk_bf16_f32 v56, v56, v57
  v_cvt_pk_bf16_f32 v57, v58, v59
  v_cvt_pk_bf16_f32 v68, v68, v69
  v_cvt_pk_bf16_f32 v69, v70, v71
  v_accvgpr_write_b32 a120, v48
  v_accvgpr_write_b32 a121, v49
  v_accvgpr_write_b32 a122, v60
  v_accvgpr_write_b32 a123, v61
  v_pk_mul_f32 v[72:73], v[72:73], v[216:217]
  v_pk_mul_f32 v[74:75], v[74:75], v[216:217]
  v_pk_mul_f32 v[84:85], v[84:85], v[216:217]
  v_pk_mul_f32 v[86:87], v[86:87], v[216:217]
  v_cvt_pk_bf16_f32 v72, v72, v73
  v_cvt_pk_bf16_f32 v73, v74, v75
  v_cvt_pk_bf16_f32 v84, v84, v85
  v_cvt_pk_bf16_f32 v85, v86, v87
  v_accvgpr_write_b32 a124, v52
  v_accvgpr_write_b32 a125, v53
  v_accvgpr_write_b32 a126, v64
  v_accvgpr_write_b32 a127, v65
  v_pk_mul_f32 v[76:77], v[76:77], v[218:219]
  v_pk_mul_f32 v[78:79], v[78:79], v[218:219]
  v_pk_mul_f32 v[88:89], v[88:89], v[218:219]
  v_pk_mul_f32 v[90:91], v[90:91], v[218:219]
  v_cvt_pk_bf16_f32 v76, v76, v77
  v_cvt_pk_bf16_f32 v77, v78, v79
  v_cvt_pk_bf16_f32 v88, v88, v89
  v_cvt_pk_bf16_f32 v89, v90, v91
  v_accvgpr_write_b32 a128, v56
  v_accvgpr_write_b32 a129, v57
  v_accvgpr_write_b32 a130, v68
  v_accvgpr_write_b32 a131, v69
  v_pk_mul_f32 v[80:81], v[80:81], v[220:221]
  v_pk_mul_f32 v[82:83], v[82:83], v[220:221]
  v_pk_mul_f32 v[92:93], v[92:93], v[220:221]
  v_pk_mul_f32 v[94:95], v[94:95], v[220:221]
  v_cvt_pk_bf16_f32 v80, v80, v81
  v_cvt_pk_bf16_f32 v81, v82, v83
  v_cvt_pk_bf16_f32 v92, v92, v93
  v_cvt_pk_bf16_f32 v93, v94, v95
  v_accvgpr_write_b32 a132, v72
  v_accvgpr_write_b32 a133, v73
  v_accvgpr_write_b32 a134, v84
  v_accvgpr_write_b32 a135, v85
  v_pk_mul_f32 v[96:97], v[96:97], v[216:217]
  v_pk_mul_f32 v[98:99], v[98:99], v[216:217]
  v_pk_mul_f32 v[108:109], v[108:109], v[216:217]
  v_pk_mul_f32 v[110:111], v[110:111], v[216:217]
  v_cvt_pk_bf16_f32 v96, v96, v97
  v_cvt_pk_bf16_f32 v97, v98, v99
  v_cvt_pk_bf16_f32 v108, v108, v109
  v_cvt_pk_bf16_f32 v109, v110, v111
  v_accvgpr_write_b32 a136, v76
  v_accvgpr_write_b32 a137, v77
  v_accvgpr_write_b32 a138, v88
  v_accvgpr_write_b32 a139, v89
  v_pk_mul_f32 v[100:101], v[100:101], v[218:219]
  v_pk_mul_f32 v[102:103], v[102:103], v[218:219]
  v_pk_mul_f32 v[112:113], v[112:113], v[218:219]
  v_pk_mul_f32 v[114:115], v[114:115], v[218:219]
  v_cvt_pk_bf16_f32 v100, v100, v101
  v_cvt_pk_bf16_f32 v101, v102, v103
  v_cvt_pk_bf16_f32 v112, v112, v113
  v_cvt_pk_bf16_f32 v113, v114, v115
  v_accvgpr_write_b32 a140, v80
  v_accvgpr_write_b32 a141, v81
  v_accvgpr_write_b32 a142, v92
  v_accvgpr_write_b32 a143, v93
  v_pk_mul_f32 v[104:105], v[104:105], v[220:221]
  v_pk_mul_f32 v[106:107], v[106:107], v[220:221]
  v_pk_mul_f32 v[116:117], v[116:117], v[220:221]
  v_pk_mul_f32 v[118:119], v[118:119], v[220:221]
  v_cvt_pk_bf16_f32 v104, v104, v105
  v_cvt_pk_bf16_f32 v105, v106, v107
  v_cvt_pk_bf16_f32 v116, v116, v117
  v_cvt_pk_bf16_f32 v117, v118, v119
  v_accvgpr_write_b32 a144, v96
  v_accvgpr_write_b32 a145, v97
  v_accvgpr_write_b32 a146, v108
  v_accvgpr_write_b32 a147, v109
  v_pk_mul_f32 v[120:121], v[120:121], v[216:217]
  v_pk_mul_f32 v[122:123], v[122:123], v[216:217]
  v_pk_mul_f32 v[132:133], v[132:133], v[216:217]
  v_pk_mul_f32 v[134:135], v[134:135], v[216:217]
  v_cvt_pk_bf16_f32 v120, v120, v121
  v_cvt_pk_bf16_f32 v121, v122, v123
  v_cvt_pk_bf16_f32 v132, v132, v133
  v_cvt_pk_bf16_f32 v133, v134, v135
  v_accvgpr_write_b32 a148, v100
  v_accvgpr_write_b32 a149, v101
  v_accvgpr_write_b32 a150, v112
  v_accvgpr_write_b32 a151, v113
  v_pk_mul_f32 v[124:125], v[124:125], v[218:219]
  v_pk_mul_f32 v[126:127], v[126:127], v[218:219]
  v_pk_mul_f32 v[136:137], v[136:137], v[218:219]
  v_pk_mul_f32 v[138:139], v[138:139], v[218:219]
  v_cvt_pk_bf16_f32 v124, v124, v125
  v_cvt_pk_bf16_f32 v125, v126, v127
  v_cvt_pk_bf16_f32 v136, v136, v137
  v_cvt_pk_bf16_f32 v137, v138, v139
  v_accvgpr_write_b32 a152, v104
  v_accvgpr_write_b32 a153, v105
  v_accvgpr_write_b32 a154, v116
  v_accvgpr_write_b32 a155, v117
  v_pk_mul_f32 v[128:129], v[128:129], v[220:221]
  v_pk_mul_f32 v[130:131], v[130:131], v[220:221]
  v_pk_mul_f32 v[140:141], v[140:141], v[220:221]
  v_pk_mul_f32 v[142:143], v[142:143], v[220:221]
  v_cvt_pk_bf16_f32 v128, v128, v129
  v_cvt_pk_bf16_f32 v129, v130, v131
  v_cvt_pk_bf16_f32 v140, v140, v141
  v_cvt_pk_bf16_f32 v141, v142, v143
  v_accvgpr_write_b32 a156, v120
  v_accvgpr_write_b32 a157, v121
  v_accvgpr_write_b32 a158, v132
  v_accvgpr_write_b32 a159, v133
  v_pk_mul_f32 v[144:145], v[144:145], v[216:217]
  v_pk_mul_f32 v[146:147], v[146:147], v[216:217]
  v_pk_mul_f32 v[156:157], v[156:157], v[216:217]
  v_pk_mul_f32 v[158:159], v[158:159], v[216:217]
  v_cvt_pk_bf16_f32 v144, v144, v145
  v_cvt_pk_bf16_f32 v145, v146, v147
  v_cvt_pk_bf16_f32 v156, v156, v157
  v_cvt_pk_bf16_f32 v157, v158, v159
  v_accvgpr_write_b32 a160, v124
  v_accvgpr_write_b32 a161, v125
  v_accvgpr_write_b32 a162, v136
  v_accvgpr_write_b32 a163, v137
  v_pk_mul_f32 v[148:149], v[148:149], v[218:219]
  v_pk_mul_f32 v[150:151], v[150:151], v[218:219]
  v_pk_mul_f32 v[160:161], v[160:161], v[218:219]
  v_pk_mul_f32 v[162:163], v[162:163], v[218:219]
  v_cvt_pk_bf16_f32 v148, v148, v149
  v_cvt_pk_bf16_f32 v149, v150, v151
  v_cvt_pk_bf16_f32 v160, v160, v161
  v_cvt_pk_bf16_f32 v161, v162, v163
  v_accvgpr_write_b32 a164, v128
  v_accvgpr_write_b32 a165, v129
  v_accvgpr_write_b32 a166, v140
  v_accvgpr_write_b32 a167, v141
  v_pk_mul_f32 v[152:153], v[152:153], v[220:221]
  v_pk_mul_f32 v[154:155], v[154:155], v[220:221]
  v_pk_mul_f32 v[164:165], v[164:165], v[220:221]
  v_pk_mul_f32 v[166:167], v[166:167], v[220:221]
  v_cvt_pk_bf16_f32 v152, v152, v153
  v_cvt_pk_bf16_f32 v153, v154, v155
  v_cvt_pk_bf16_f32 v164, v164, v165
  v_cvt_pk_bf16_f32 v165, v166, v167
  v_accvgpr_write_b32 a168, v144
  v_accvgpr_write_b32 a169, v145
  v_accvgpr_write_b32 a170, v156
  v_accvgpr_write_b32 a171, v157
  v_accvgpr_read_b32 v0, a224
  v_accvgpr_read_b32 v1, a225
  v_accvgpr_read_b32 v2, a226
  v_accvgpr_read_b32 v3, a227
  v_accvgpr_read_b32 v12, a236
  v_accvgpr_read_b32 v13, a237
  v_accvgpr_read_b32 v14, a238
  v_accvgpr_read_b32 v15, a239
  v_pk_mul_f32 v[0:1], v[0:1], v[216:217]
  v_pk_mul_f32 v[2:3], v[2:3], v[216:217]
  v_pk_mul_f32 v[12:13], v[12:13], v[216:217]
  v_pk_mul_f32 v[14:15], v[14:15], v[216:217]
  v_cvt_pk_bf16_f32 v0, v0, v1
  v_cvt_pk_bf16_f32 v1, v2, v3
  v_cvt_pk_bf16_f32 v12, v12, v13
  v_cvt_pk_bf16_f32 v13, v14, v15
  v_accvgpr_write_b32 a172, v148
  v_accvgpr_write_b32 a173, v149
  v_accvgpr_write_b32 a174, v160
  v_accvgpr_write_b32 a175, v161
  v_accvgpr_read_b32 v24, a228
  v_accvgpr_read_b32 v25, a229
  v_accvgpr_read_b32 v26, a230
  v_accvgpr_read_b32 v27, a231
  v_accvgpr_read_b32 v36, a240
  v_accvgpr_read_b32 v37, a241
  v_accvgpr_read_b32 v38, a242
  v_accvgpr_read_b32 v39, a243
  v_pk_mul_f32 v[24:25], v[24:25], v[218:219]
  v_pk_mul_f32 v[26:27], v[26:27], v[218:219]
  v_pk_mul_f32 v[36:37], v[36:37], v[218:219]
  v_pk_mul_f32 v[38:39], v[38:39], v[218:219]
  v_cvt_pk_bf16_f32 v24, v24, v25
  v_cvt_pk_bf16_f32 v25, v26, v27
  v_cvt_pk_bf16_f32 v36, v36, v37
  v_cvt_pk_bf16_f32 v37, v38, v39
  v_accvgpr_write_b32 a176, v152
  v_accvgpr_write_b32 a177, v153
  v_accvgpr_write_b32 a178, v164
  v_accvgpr_write_b32 a179, v165
  v_accvgpr_read_b32 v48, a232
  v_accvgpr_read_b32 v49, a233
  v_accvgpr_read_b32 v50, a234
  v_accvgpr_read_b32 v51, a235
  v_accvgpr_read_b32 v60, a244
  v_accvgpr_read_b32 v61, a245
  v_accvgpr_read_b32 v62, a246
  v_accvgpr_read_b32 v63, a247
  v_pk_mul_f32 v[48:49], v[48:49], v[220:221]
  v_pk_mul_f32 v[50:51], v[50:51], v[220:221]
  v_pk_mul_f32 v[60:61], v[60:61], v[220:221]
  v_pk_mul_f32 v[62:63], v[62:63], v[220:221]
  v_cvt_pk_bf16_f32 v48, v48, v49
  v_cvt_pk_bf16_f32 v49, v50, v51
  v_cvt_pk_bf16_f32 v60, v60, v61
  v_cvt_pk_bf16_f32 v61, v62, v63
  v_accvgpr_write_b32 a180, v0
  v_accvgpr_write_b32 a181, v1
  v_accvgpr_write_b32 a182, v12
  v_accvgpr_write_b32 a183, v13
  v_accvgpr_write_b32 a184, v24
  v_accvgpr_write_b32 a185, v25
  v_accvgpr_write_b32 a186, v36
  v_accvgpr_write_b32 a187, v37
  v_accvgpr_write_b32 a188, v48
  v_accvgpr_write_b32 a189, v49
  v_accvgpr_write_b32 a190, v60
  v_accvgpr_write_b32 a191, v61
  s_mov_b32 s32, 1
  s_mov_b32 s33, 262144
  v_add_u32 v228, 65536, v230
  v_xor_b32 v239, 32, v228
  ds_read_b64_tr_b16 a[192:193], v228 offset:0
  ds_read_b64_tr_b16 a[194:195], v228 offset:8192
  ds_read_b64_tr_b16 a[196:197], v239 offset:0
  ds_read_b64_tr_b16 a[198:199], v239 offset:8192
  ds_read_b64_tr_b16 a[200:201], v228 offset:256
  ds_read_b64_tr_b16 a[202:203], v228 offset:8448
  ds_read_b64_tr_b16 a[204:205], v239 offset:256
  ds_read_b64_tr_b16 a[206:207], v239 offset:8448
  ds_read_b64_tr_b16 a[208:209], v228 offset:1024
  ds_read_b64_tr_b16 a[210:211], v228 offset:9216
  s_waitcnt lgkmcnt(8)
  v_mfma_f32_16x16x32_bf16 v[0:3], a[192:195], v[168:171], 0
  s_waitcnt vmcnt(63)
  ds_read_b64_tr_b16 a[212:213], v239 offset:1024
  v_mfma_f32_16x16x32_bf16 v[4:7], a[192:195], v[172:175], 0
  s_barrier
  ds_read_b64_tr_b16 a[214:215], v239 offset:9216
  v_mfma_f32_16x16x32_bf16 v[8:11], a[192:195], v[176:179], 0
  s_waitcnt lgkmcnt(8)
  v_mfma_f32_16x16x32_bf16 v[12:15], a[196:199], v[168:171], 0
  s_add_u32 m0, s28, 81920
  ds_read_b64_tr_b16 a[216:217], v228 offset:1280
  v_mfma_f32_16x16x32_bf16 v[16:19], a[196:199], v[172:175], 0
  s_mov_b32 s29, 790016
  buffer_load_dwordx4 v232, s[16:19], s29 offen offset:0 lds
  v_mfma_f32_16x16x32_bf16 v[20:23], a[196:199], v[176:179], 0
  s_waitcnt lgkmcnt(7)
  ds_read_b64_tr_b16 a[218:219], v228 offset:9472
  v_mfma_f32_16x16x32_bf16 v[24:27], a[200:203], v[168:171], 0
  s_add_u32 s29, s29, s30
  ds_read_b64_tr_b16 a[220:221], v239 offset:1280
  v_mfma_f32_16x16x32_bf16 v[28:31], a[200:203], v[172:175], 0
  buffer_load_dwordx4 v232, s[16:19], s29 offen offset:1024 lds
  v_mfma_f32_16x16x32_bf16 v[32:35], a[200:203], v[176:179], 0
  s_waitcnt lgkmcnt(7)
  ds_read_b64_tr_b16 a[222:223], v239 offset:9472
  v_mfma_f32_16x16x32_bf16 v[36:39], a[204:207], v[168:171], 0
  s_add_u32 s29, s29, s30
  ds_read_b64_tr_b16 a[192:193], v228 offset:2048
  v_mfma_f32_16x16x32_bf16 v[40:43], a[204:207], v[172:175], 0
  ds_read_b64_tr_b16 a[194:195], v228 offset:10240
  v_mfma_f32_16x16x32_bf16 v[44:47], a[204:207], v[176:179], 0
  s_waitcnt lgkmcnt(8)
  v_mfma_f32_16x16x32_bf16 v[48:51], a[208:211], v[168:171], 0
  ds_read_b64_tr_b16 a[196:197], v239 offset:2048
  v_mfma_f32_16x16x32_bf16 v[52:55], a[208:211], v[172:175], 0
  buffer_load_dwordx4 v232, s[16:19], s29 offen offset:2048 lds
  v_mfma_f32_16x16x32_bf16 v[56:59], a[208:211], v[176:179], 0
  s_waitcnt lgkmcnt(7)
  ds_read_b64_tr_b16 a[198:199], v239 offset:10240
  v_mfma_f32_16x16x32_bf16 v[60:63], a[212:215], v[168:171], 0
  s_add_u32 s29, s29, s30
  ds_read_b64_tr_b16 a[200:201], v228 offset:2304
  v_mfma_f32_16x16x32_bf16 v[64:67], a[212:215], v[172:175], 0
  buffer_load_dwordx4 v232, s[16:19], s29 offen offset:3072 lds
  v_mfma_f32_16x16x32_bf16 v[68:71], a[212:215], v[176:179], 0
  s_waitcnt lgkmcnt(7)
  ds_read_b64_tr_b16 a[202:203], v228 offset:10496
  v_mfma_f32_16x16x32_bf16 v[72:75], a[216:219], v[168:171], 0
  s_add_u32 m0, s28, 131072
  ds_read_b64_tr_b16 a[204:205], v239 offset:2304
  v_mfma_f32_16x16x32_bf16 v[76:79], a[216:219], v[172:175], 0
  s_mov_b32 s29, 3328
  buffer_load_dwordx4 v233, s[4:7], s29 offen offset:0 lds
  v_mfma_f32_16x16x32_bf16 v[80:83], a[216:219], v[176:179], 0
  s_waitcnt lgkmcnt(7)
  ds_read_b64_tr_b16 a[206:207], v239 offset:10496
  v_mfma_f32_16x16x32_bf16 v[84:87], a[220:223], v[168:171], 0
  s_mov_b32 s29, 9472
  ds_read_b64_tr_b16 a[208:209], v228 offset:3072
  v_mfma_f32_16x16x32_bf16 v[88:91], a[220:223], v[172:175], 0
  buffer_load_dwordx4 v233, s[4:7], s29 offen offset:1024 lds
  v_mfma_f32_16x16x32_bf16 v[92:95], a[220:223], v[176:179], 0
  s_waitcnt lgkmcnt(7)
  ds_read_b64_tr_b16 a[210:211], v228 offset:11264
  v_mfma_f32_16x16x32_bf16 v[96:99], a[192:195], v[168:171], 0
  s_mov_b32 s29, 15616
  ds_read_b64_tr_b16 a[212:213], v239 offset:3072
  v_mfma_f32_16x16x32_bf16 v[100:103], a[192:195], v[172:175], 0
  ds_read_b64_tr_b16 a[214:215], v239 offset:11264
  v_mfma_f32_16x16x32_bf16 v[104:107], a[192:195], v[176:179], 0
  s_waitcnt lgkmcnt(8)
  v_mfma_f32_16x16x32_bf16 v[108:111], a[196:199], v[168:171], 0
  ds_read_b64_tr_b16 a[216:217], v228 offset:3328
  v_mfma_f32_16x16x32_bf16 v[112:115], a[196:199], v[172:175], 0
  buffer_load_dwordx4 v233, s[4:7], s29 offen offset:2048 lds
  v_mfma_f32_16x16x32_bf16 v[116:119], a[196:199], v[176:179], 0
  s_waitcnt lgkmcnt(7)
  ds_read_b64_tr_b16 a[218:219], v228 offset:11520
  v_mfma_f32_16x16x32_bf16 v[120:123], a[200:203], v[168:171], 0
  s_mov_b32 s29, 21760
  ds_read_b64_tr_b16 a[220:221], v239 offset:3328
  v_mfma_f32_16x16x32_bf16 v[124:127], a[200:203], v[172:175], 0
  buffer_load_dwordx4 v233, s[4:7], s29 offen offset:3072 lds
  v_mfma_f32_16x16x32_bf16 v[128:131], a[200:203], v[176:179], 0
  s_waitcnt lgkmcnt(7)
  ds_read_b64_tr_b16 a[222:223], v239 offset:11520
  v_add_u32 v228, 114688, v230
  v_mfma_f32_16x16x32_bf16 v[132:135], a[204:207], v[168:171], 0
  s_add_u32 m0, s28, 98304
  ds_read_b64_tr_b16 a[192:193], v228 offset:0
  v_xor_b32 v239, 32, v228
  v_mfma_f32_16x16x32_bf16 v[136:139], a[204:207], v[172:175], 0
  s_mov_b32 s29, 32000
  buffer_load_dwordx4 v233, s[4:7], s29 offen offset:0 lds
  v_mfma_f32_16x16x32_bf16 v[140:143], a[204:207], v[176:179], 0
  s_waitcnt lgkmcnt(7)
  ds_read_b64_tr_b16 a[194:195], v228 offset:8192
  v_mfma_f32_16x16x32_bf16 v[144:147], a[208:211], v[168:171], 0
  s_mov_b32 s29, 38144
  ds_read_b64_tr_b16 a[196:197], v239 offset:0
  v_mfma_f32_16x16x32_bf16 v[148:151], a[208:211], v[172:175], 0
  buffer_load_dwordx4 v233, s[4:7], s29 offen offset:1024 lds
  v_mfma_f32_16x16x32_bf16 v[152:155], a[208:211], v[176:179], 0
  s_waitcnt lgkmcnt(7)
  ds_read_b64_tr_b16 a[198:199], v239 offset:8192
  v_mfma_f32_16x16x32_bf16 v[156:159], a[212:215], v[168:171], 0
  s_mov_b32 s29, 1408
  ds_read_b64_tr_b16 a[200:201], v228 offset:256
  v_mfma_f32_16x16x32_bf16 v[160:163], a[212:215], v[172:175], 0
  ds_read_b64_tr_b16 a[202:203], v228 offset:8448
  v_mfma_f32_16x16x32_bf16 v[164:167], a[212:215], v[176:179], 0
  s_waitcnt lgkmcnt(8)
  v_mfma_f32_16x16x32_bf16 a[224:227], a[216:219], v[168:171], 0
  ds_read_b64_tr_b16 a[204:205], v239 offset:256
  v_mfma_f32_16x16x32_bf16 a[228:231], a[216:219], v[172:175], 0
  buffer_load_dwordx4 v233, s[4:7], s29 offen offset:2048 lds
  v_mfma_f32_16x16x32_bf16 a[232:235], a[216:219], v[176:179], 0
  s_waitcnt lgkmcnt(7)
  ds_read_b64_tr_b16 a[206:207], v239 offset:8448
  v_mfma_f32_16x16x32_bf16 a[236:239], a[220:223], v[168:171], 0
  s_mov_b32 s29, 7552
  ds_read_b64_tr_b16 a[208:209], v228 offset:1024
  v_mfma_f32_16x16x32_bf16 a[240:243], a[220:223], v[172:175], 0
  buffer_load_dwordx4 v233, s[4:7], s29 offen offset:3072 lds
  v_mfma_f32_16x16x32_bf16 a[244:247], a[220:223], v[176:179], 0
  s_waitcnt lgkmcnt(7)
  ds_read_b64_tr_b16 a[210:211], v228 offset:9216
  v_mfma_f32_16x16x32_bf16 v[0:3], a[192:195], v[180:183], v[0:3]
  s_waitcnt vmcnt(13)
  ds_read_b64_tr_b16 a[212:213], v239 offset:1024
  v_mfma_f32_16x16x32_bf16 v[4:7], a[192:195], v[184:187], v[4:7]
  s_barrier
  ds_read_b64_tr_b16 a[214:215], v239 offset:9216
  v_mfma_f32_16x16x32_bf16 v[8:11], a[192:195], v[188:191], v[8:11]
  s_waitcnt lgkmcnt(8)
  v_mfma_f32_16x16x32_bf16 v[12:15], a[196:199], v[180:183], v[12:15]
  s_add_u32 m0, s28, 16384
  ds_read_b64_tr_b16 a[216:217], v228 offset:1280
  v_mfma_f32_16x16x32_bf16 v[16:19], a[196:199], v[184:187], v[16:19]
  s_mov_b32 s29, 1052160
  buffer_load_dwordx4 v232, s[16:19], s29 offen offset:0 lds
  v_mfma_f32_16x16x32_bf16 v[20:23], a[196:199], v[188:191], v[20:23]
  s_waitcnt lgkmcnt(7)
  ds_read_b64_tr_b16 a[218:219], v228 offset:9472
  v_mfma_f32_16x16x32_bf16 v[24:27], a[200:203], v[180:183], v[24:27]
  s_add_u32 s29, s29, s30
  ds_read_b64_tr_b16 a[220:221], v239 offset:1280
  v_mfma_f32_16x16x32_bf16 v[28:31], a[200:203], v[184:187], v[28:31]
  buffer_load_dwordx4 v232, s[16:19], s29 offen offset:1024 lds
  v_mfma_f32_16x16x32_bf16 v[32:35], a[200:203], v[188:191], v[32:35]
  s_waitcnt lgkmcnt(7)
  ds_read_b64_tr_b16 a[222:223], v239 offset:9472
  v_mfma_f32_16x16x32_bf16 v[36:39], a[204:207], v[180:183], v[36:39]
  s_add_u32 s29, s29, s30
  ds_read_b64_tr_b16 a[192:193], v228 offset:2048
  v_mfma_f32_16x16x32_bf16 v[40:43], a[204:207], v[184:187], v[40:43]
  ds_read_b64_tr_b16 a[194:195], v228 offset:10240
  v_mfma_f32_16x16x32_bf16 v[44:47], a[204:207], v[188:191], v[44:47]
  s_waitcnt lgkmcnt(8)
  v_mfma_f32_16x16x32_bf16 v[48:51], a[208:211], v[180:183], v[48:51]
  ds_read_b64_tr_b16 a[196:197], v239 offset:2048
  v_mfma_f32_16x16x32_bf16 v[52:55], a[208:211], v[184:187], v[52:55]
  buffer_load_dwordx4 v232, s[16:19], s29 offen offset:2048 lds
  v_mfma_f32_16x16x32_bf16 v[56:59], a[208:211], v[188:191], v[56:59]
  s_waitcnt lgkmcnt(7)
  ds_read_b64_tr_b16 a[198:199], v239 offset:10240
  v_mfma_f32_16x16x32_bf16 v[60:63], a[212:215], v[180:183], v[60:63]
  s_add_u32 s29, s29, s30
  ds_read_b64_tr_b16 a[200:201], v228 offset:2304
  v_mfma_f32_16x16x32_bf16 v[64:67], a[212:215], v[184:187], v[64:67]
  buffer_load_dwordx4 v232, s[16:19], s29 offen offset:3072 lds
  v_mfma_f32_16x16x32_bf16 v[68:71], a[212:215], v[188:191], v[68:71]
  s_waitcnt lgkmcnt(7)
  ds_read_b64_tr_b16 a[202:203], v228 offset:10496
  v_mfma_f32_16x16x32_bf16 v[72:75], a[216:219], v[180:183], v[72:75]
  s_add_u32 m0, s28, 32768
  ds_read_b64_tr_b16 a[204:205], v239 offset:2304
  v_mfma_f32_16x16x32_bf16 v[76:79], a[216:219], v[184:187], v[76:79]
  s_mov_b32 s29, 1314304
  buffer_load_dwordx4 v232, s[16:19], s29 offen offset:0 lds
  v_mfma_f32_16x16x32_bf16 v[80:83], a[216:219], v[188:191], v[80:83]
  s_waitcnt lgkmcnt(7)
  ds_read_b64_tr_b16 a[206:207], v239 offset:10496
  v_mfma_f32_16x16x32_bf16 v[84:87], a[220:223], v[180:183], v[84:87]
  s_add_u32 s29, s29, s30
  ds_read_b64_tr_b16 a[208:209], v228 offset:3072
  v_mfma_f32_16x16x32_bf16 v[88:91], a[220:223], v[184:187], v[88:91]
  buffer_load_dwordx4 v232, s[16:19], s29 offen offset:1024 lds
  v_mfma_f32_16x16x32_bf16 v[92:95], a[220:223], v[188:191], v[92:95]
  s_waitcnt lgkmcnt(7)
  ds_read_b64_tr_b16 a[210:211], v228 offset:11264
  v_mfma_f32_16x16x32_bf16 v[96:99], a[192:195], v[180:183], v[96:99]
  s_add_u32 s29, s29, s30
  ds_read_b64_tr_b16 a[212:213], v239 offset:3072
  v_mfma_f32_16x16x32_bf16 v[100:103], a[192:195], v[184:187], v[100:103]
  ds_read_b64_tr_b16 a[214:215], v239 offset:11264
  v_mfma_f32_16x16x32_bf16 v[104:107], a[192:195], v[188:191], v[104:107]
  s_waitcnt lgkmcnt(8)
  v_mfma_f32_16x16x32_bf16 v[108:111], a[196:199], v[180:183], v[108:111]
  ds_read_b64_tr_b16 a[216:217], v228 offset:3328
  v_mfma_f32_16x16x32_bf16 v[112:115], a[196:199], v[184:187], v[112:115]
  buffer_load_dwordx4 v232, s[16:19], s29 offen offset:2048 lds
  v_mfma_f32_16x16x32_bf16 v[116:119], a[196:199], v[188:191], v[116:119]
  s_waitcnt lgkmcnt(7)
  ds_read_b64_tr_b16 a[218:219], v228 offset:11520
  v_mfma_f32_16x16x32_bf16 v[120:123], a[200:203], v[180:183], v[120:123]
  s_add_u32 s29, s29, s30
  ds_read_b64_tr_b16 a[220:221], v239 offset:3328
  v_mfma_f32_16x16x32_bf16 v[124:127], a[200:203], v[184:187], v[124:127]
  buffer_load_dwordx4 v232, s[16:19], s29 offen offset:3072 lds
  v_mfma_f32_16x16x32_bf16 v[128:131], a[200:203], v[188:191], v[128:131]
  s_waitcnt lgkmcnt(7)
  ds_read_b64_tr_b16 a[222:223], v239 offset:11520
  v_add_u32 v228, 0, v230
  v_mfma_f32_16x16x32_bf16 v[132:135], a[204:207], v[180:183], v[132:135]
  s_add_u32 m0, s28, 49152
  ds_read_b64_tr_b16 a[192:193], v228 offset:0
  v_xor_b32 v239, 32, v228
  v_mfma_f32_16x16x32_bf16 v[136:139], a[204:207], v[184:187], v[136:139]
  s_mov_b32 s29, 281600
  buffer_load_dwordx4 v231, s[8:11], s29 offen offset:0 nt lds
  v_mfma_f32_16x16x32_bf16 v[140:143], a[204:207], v[188:191], v[140:143]
  s_waitcnt lgkmcnt(7)
  ds_read_b64_tr_b16 a[194:195], v228 offset:8192
  v_mfma_f32_16x16x32_bf16 v[144:147], a[208:211], v[180:183], v[144:147]
  s_add_u32 s29, s29, s30
  ds_read_b64_tr_b16 a[196:197], v239 offset:0
  v_mfma_f32_16x16x32_bf16 v[148:151], a[208:211], v[184:187], v[148:151]
  buffer_load_dwordx4 v231, s[8:11], s29 offen offset:1024 nt lds
  v_mfma_f32_16x16x32_bf16 v[152:155], a[208:211], v[188:191], v[152:155]
  s_waitcnt lgkmcnt(7)
  ds_read_b64_tr_b16 a[198:199], v239 offset:8192
  v_mfma_f32_16x16x32_bf16 v[156:159], a[212:215], v[180:183], v[156:159]
  s_add_u32 s29, s29, s30
  ds_read_b64_tr_b16 a[200:201], v228 offset:256
  v_mfma_f32_16x16x32_bf16 v[160:163], a[212:215], v[184:187], v[160:163]
  ds_read_b64_tr_b16 a[202:203], v228 offset:8448
  v_mfma_f32_16x16x32_bf16 v[164:167], a[212:215], v[188:191], v[164:167]
  s_waitcnt lgkmcnt(8)
  v_mfma_f32_16x16x32_bf16 a[224:227], a[216:219], v[180:183], a[224:227]
  ds_read_b64_tr_b16 a[204:205], v239 offset:256
  v_mfma_f32_16x16x32_bf16 a[228:231], a[216:219], v[184:187], a[228:231]
  buffer_load_dwordx4 v231, s[8:11], s29 offen offset:2048 nt lds
  v_mfma_f32_16x16x32_bf16 a[232:235], a[216:219], v[188:191], a[232:235]
  s_waitcnt lgkmcnt(7)
  ds_read_b64_tr_b16 a[206:207], v239 offset:8448
  v_mfma_f32_16x16x32_bf16 a[236:239], a[220:223], v[180:183], a[236:239]
  s_add_u32 s29, s29, s30
  ds_read_b64_tr_b16 a[208:209], v228 offset:1024
  v_mfma_f32_16x16x32_bf16 a[240:243], a[220:223], v[184:187], a[240:243]
  buffer_load_dwordx4 v231, s[8:11], s29 offen offset:3072 nt lds
  v_mfma_f32_16x16x32_bf16 a[244:247], a[220:223], v[188:191], a[244:247]
  s_waitcnt lgkmcnt(7)
  ds_read_b64_tr_b16 a[210:211], v228 offset:9216
  v_mfma_f32_16x16x32_bf16 v[0:3], a[192:195], v[192:195], v[0:3]
  s_waitcnt vmcnt(12)
  ds_read_b64_tr_b16 a[212:213], v239 offset:1024
  v_mfma_f32_16x16x32_bf16 v[4:7], a[192:195], v[196:199], v[4:7]
  s_barrier
  ds_read_b64_tr_b16 a[214:215], v239 offset:9216
  v_add_u32 v238, 131072, v237
  v_mfma_f32_16x16x32_bf16 v[8:11], a[192:195], v[200:203], v[8:11]
  s_waitcnt lgkmcnt(8)
  ds_read_b128 a[0:3], v238 offset:0
  v_mfma_f32_16x16x32_bf16 v[12:15], a[196:199], v[192:195], v[12:15]
  s_add_u32 m0, s28, 65536
  ds_read_b128 a[12:15], v238 offset:256
  v_mfma_f32_16x16x32_bf16 v[16:19], a[196:199], v[196:199], v[16:19]
  s_mov_b32 s29, 17792
  buffer_load_dwordx4 v233, s[4:7], s29 offen offset:0 lds
  v_mfma_f32_16x16x32_bf16 v[20:23], a[196:199], v[200:203], v[20:23]
  s_waitcnt lgkmcnt(8)
  ds_read_b128 a[4:7], v238 offset:2048
  v_mfma_f32_16x16x32_bf16 v[24:27], a[200:203], v[192:195], v[24:27]
  s_mov_b32 s29, 23936
  ds_read_b128 a[16:19], v238 offset:2304
  v_add_u32 v238, 98304, v237
  v_mfma_f32_16x16x32_bf16 v[28:31], a[200:203], v[196:199], v[28:31]
  ds_read_b64_tr_b16 a[216:217], v228 offset:1280
  v_mfma_f32_16x16x32_bf16 v[32:35], a[200:203], v[200:203], v[32:35]
  s_waitcnt lgkmcnt(9)
  ds_read_b64_tr_b16 a[218:219], v228 offset:9472
  v_mfma_f32_16x16x32_bf16 v[36:39], a[204:207], v[192:195], v[36:39]
  ds_read_b128 a[8:11], v238 offset:0
  v_mfma_f32_16x16x32_bf16 v[40:43], a[204:207], v[196:199], v[40:43]
  buffer_load_dwordx4 v233, s[4:7], s29 offen offset:1024 lds
  v_mfma_f32_16x16x32_bf16 v[44:47], a[204:207], v[200:203], v[44:47]
  s_waitcnt lgkmcnt(9)
  ds_read_b64_tr_b16 a[220:221], v239 offset:1280
  v_mfma_f32_16x16x32_bf16 v[48:51], a[208:211], v[192:195], v[48:51]
  s_mov_b32 s29, 30080
  ds_read_b64_tr_b16 a[222:223], v239 offset:9472
  v_mfma_f32_16x16x32_bf16 v[52:55], a[208:211], v[196:199], v[52:55]
  ds_read_b64_tr_b16 a[192:193], v228 offset:2048
  v_mfma_f32_16x16x32_bf16 v[56:59], a[208:211], v[200:203], v[56:59]
  s_waitcnt lgkmcnt(10)
  ds_read_b64_tr_b16 a[194:195], v228 offset:10240
  v_mfma_f32_16x16x32_bf16 v[60:63], a[212:215], v[192:195], v[60:63]
  ds_read_b128 a[20:23], v238 offset:256
  v_mfma_f32_16x16x32_bf16 v[64:67], a[212:215], v[196:199], v[64:67]
  buffer_load_dwordx4 v233, s[4:7], s29 offen offset:2048 lds
  v_mfma_f32_16x16x32_bf16 v[68:71], a[212:215], v[200:203], v[68:71]
  s_waitcnt lgkmcnt(6)
  ds_read_b64_tr_b16 a[196:197], v239 offset:2048
  v_mfma_f32_16x16x32_bf16 v[72:75], a[216:219], v[192:195], v[72:75]
  s_mov_b32 s29, 36224
  ds_read_b64_tr_b16 a[198:199], v239 offset:10240
  v_mfma_f32_16x16x32_bf16 v[76:79], a[216:219], v[196:199], v[76:79]
  ds_read_b64_tr_b16 a[200:201], v228 offset:2304
  v_mfma_f32_16x16x32_bf16 v[80:83], a[216:219], v[200:203], v[80:83]
  s_waitcnt lgkmcnt(6)
  ds_read_b64_tr_b16 a[202:203], v228 offset:10496
  v_mfma_f32_16x16x32_bf16 v[84:87], a[220:223], v[192:195], v[84:87]
  ds_read_b128 a[24:27], v238 offset:2048
  v_mfma_f32_16x16x32_bf16 v[88:91], a[220:223], v[196:199], v[88:91]
  buffer_load_dwordx4 v233, s[4:7], s29 offen offset:3072 lds
  v_mfma_f32_16x16x32_bf16 v[92:95], a[220:223], v[200:203], v[92:95]
  s_waitcnt lgkmcnt(6)
  ds_read_b64_tr_b16 a[204:205], v239 offset:2304
  v_mfma_f32_16x16x32_bf16 v[96:99], a[192:195], v[192:195], v[96:99]
  s_add_u32 m0, s28, 114688
  ds_read_b64_tr_b16 a[206:207], v239 offset:10496
  v_mfma_f32_16x16x32_bf16 v[100:103], a[192:195], v[196:199], v[100:103]
  s_mov_b32 s29, 1576448
  ds_read_b64_tr_b16 a[208:209], v228 offset:3072
  v_mfma_f32_16x16x32_bf16 v[104:107], a[192:195], v[200:203], v[104:107]
  s_waitcnt lgkmcnt(6)
  ds_read_b64_tr_b16 a[210:211], v228 offset:11264
  v_mfma_f32_16x16x32_bf16 v[108:111], a[196:199], v[192:195], v[108:111]
  ds_read_b128 a[36:39], v238 offset:2304
  v_mfma_f32_16x16x32_bf16 v[112:115], a[196:199], v[196:199], v[112:115]
  buffer_load_dwordx4 v232, s[16:19], s29 offen offset:0 lds
  v_mfma_f32_16x16x32_bf16 v[116:119], a[196:199], v[200:203], v[116:119]
  s_waitcnt lgkmcnt(6)
  ds_read_b64_tr_b16 a[212:213], v239 offset:3072
  v_mfma_f32_16x16x32_bf16 v[120:123], a[200:203], v[192:195], v[120:123]
  s_add_u32 s29, s29, s30
  ds_read_b64_tr_b16 a[214:215], v239 offset:11264
  v_mfma_f32_16x16x32_bf16 v[124:127], a[200:203], v[196:199], v[124:127]
  ds_read_b64_tr_b16 a[216:217], v228 offset:3328
  v_mfma_f32_16x16x32_bf16 v[128:131], a[200:203], v[200:203], v[128:131]
  s_waitcnt lgkmcnt(6)
  ds_read_b64_tr_b16 a[218:219], v228 offset:11520
  v_mfma_f32_16x16x32_bf16 v[132:135], a[204:207], v[192:195], v[132:135]
  ds_read_b64_tr_b16 a[220:221], v239 offset:3328
  v_mfma_f32_16x16x32_bf16 v[136:139], a[204:207], v[196:199], v[136:139]
  buffer_load_dwordx4 v232, s[16:19], s29 offen offset:1024 lds
  v_mfma_f32_16x16x32_bf16 v[140:143], a[204:207], v[200:203], v[140:143]
  s_waitcnt lgkmcnt(6)
  ds_read_b64_tr_b16 a[222:223], v239 offset:11520
  v_add_u32 v228, 81920, v230
  v_mfma_f32_16x16x32_bf16 v[144:147], a[208:211], v[192:195], v[144:147]
  s_add_u32 s29, s29, s30
  ds_read_b64_tr_b16 a[192:193], v228 offset:0
  v_xor_b32 v239, 32, v228
  v_mfma_f32_16x16x32_bf16 v[148:151], a[208:211], v[196:199], v[148:151]
  ds_read_b64_tr_b16 a[194:195], v228 offset:8192
  v_mfma_f32_16x16x32_bf16 v[152:155], a[208:211], v[200:203], v[152:155]
  s_waitcnt lgkmcnt(6)
  ds_read_b64_tr_b16 a[196:197], v239 offset:0
  v_mfma_f32_16x16x32_bf16 v[156:159], a[212:215], v[192:195], v[156:159]
  ds_read_b64_tr_b16 a[198:199], v239 offset:8192
  v_mfma_f32_16x16x32_bf16 v[160:163], a[212:215], v[196:199], v[160:163]
  buffer_load_dwordx4 v232, s[16:19], s29 offen offset:2048 lds
  v_mfma_f32_16x16x32_bf16 v[164:167], a[212:215], v[200:203], v[164:167]
  s_waitcnt lgkmcnt(6)
  ds_read_b64_tr_b16 a[200:201], v228 offset:256
  v_mfma_f32_16x16x32_bf16 a[224:227], a[216:219], v[192:195], a[224:227]
  s_add_u32 s29, s29, s30
  ds_read_b64_tr_b16 a[202:203], v228 offset:8448
  v_mfma_f32_16x16x32_bf16 a[228:231], a[216:219], v[196:199], a[228:231]
  ds_read_b64_tr_b16 a[204:205], v239 offset:256
  v_mfma_f32_16x16x32_bf16 a[232:235], a[216:219], v[200:203], a[232:235]
  s_waitcnt lgkmcnt(7)
  ds_read_b64_tr_b16 a[206:207], v239 offset:8448
  v_mfma_f32_16x16x32_bf16 a[236:239], a[220:223], v[192:195], a[236:239]
  ds_read_b64_tr_b16 a[208:209], v228 offset:1024
  v_mfma_f32_16x16x32_bf16 a[240:243], a[220:223], v[196:199], a[240:243]
  buffer_load_dwordx4 v232, s[16:19], s29 offen offset:3072 lds
  v_mfma_f32_16x16x32_bf16 a[244:247], a[220:223], v[200:203], a[244:247]
  s_waitcnt lgkmcnt(7)
  ds_read_b64_tr_b16 a[210:211], v228 offset:9216
  v_mfma_f32_16x16x32_bf16 v[0:3], a[192:195], v[204:207], v[0:3]
  s_waitcnt vmcnt(16)
  ds_read_b64_tr_b16 a[212:213], v239 offset:1024
  v_mfma_f32_16x16x32_bf16 v[4:7], a[192:195], v[208:211], v[4:7]
  s_barrier
  ds_read_b64_tr_b16 a[214:215], v239 offset:9216
  v_mfma_f32_16x16x32_bf16 v[8:11], a[192:195], v[212:215], v[8:11]
  s_waitcnt lgkmcnt(8)
  v_mfma_f32_16x16x32_bf16 v[12:15], a[196:199], v[204:207], v[12:15]
  s_add_u32 m0, s28, 0
  ds_read_b64_tr_b16 a[216:217], v228 offset:1280
  v_mfma_f32_16x16x32_bf16 v[16:19], a[196:199], v[208:211], v[16:19]
  s_mov_b32 s29, 1838592
  buffer_load_dwordx4 v232, s[16:19], s29 offen offset:0 lds
  v_mfma_f32_16x16x32_bf16 v[20:23], a[196:199], v[212:215], v[20:23]
  s_waitcnt lgkmcnt(7)
  ds_read_b64_tr_b16 a[218:219], v228 offset:9472
  v_mfma_f32_16x16x32_bf16 v[24:27], a[200:203], v[204:207], v[24:27]
  s_add_u32 s29, s29, s30
  ds_read_b64_tr_b16 a[220:221], v239 offset:1280
  v_mfma_f32_16x16x32_bf16 v[28:31], a[200:203], v[208:211], v[28:31]
  ds_read_b64_tr_b16 a[222:223], v239 offset:9472
  v_mfma_f32_16x16x32_bf16 v[32:35], a[200:203], v[212:215], v[32:35]
  s_waitcnt lgkmcnt(8)
  v_mfma_f32_16x16x32_bf16 v[36:39], a[204:207], v[204:207], v[36:39]
  ds_read_b64_tr_b16 a[192:193], v228 offset:2048
  v_mfma_f32_16x16x32_bf16 v[40:43], a[204:207], v[208:211], v[40:43]
  buffer_load_dwordx4 v232, s[16:19], s29 offen offset:1024 lds
  v_mfma_f32_16x16x32_bf16 v[44:47], a[204:207], v[212:215], v[44:47]
  s_waitcnt lgkmcnt(7)
  ds_read_b64_tr_b16 a[194:195], v228 offset:10240
  v_mfma_f32_16x16x32_bf16 v[48:51], a[208:211], v[204:207], v[48:51]
  s_add_u32 s29, s29, s30
  ds_read_b64_tr_b16 a[196:197], v239 offset:2048
  v_mfma_f32_16x16x32_bf16 v[52:55], a[208:211], v[208:211], v[52:55]
  ds_read_b64_tr_b16 a[198:199], v239 offset:10240
  v_mfma_f32_16x16x32_bf16 v[56:59], a[208:211], v[212:215], v[56:59]
  s_waitcnt lgkmcnt(8)
  v_mfma_f32_16x16x32_bf16 v[60:63], a[212:215], v[204:207], v[60:63]
  ds_read_b64_tr_b16 a[200:201], v228 offset:2304
  v_mfma_f32_16x16x32_bf16 v[64:67], a[212:215], v[208:211], v[64:67]
  buffer_load_dwordx4 v232, s[16:19], s29 offen offset:2048 lds
  v_mfma_f32_16x16x32_bf16 v[68:71], a[212:215], v[212:215], v[68:71]
  s_waitcnt lgkmcnt(7)
  ds_read_b64_tr_b16 a[202:203], v228 offset:10496
  v_mfma_f32_16x16x32_bf16 v[72:75], a[216:219], v[204:207], v[72:75]
  s_add_u32 s29, s29, s30
  ds_read_b64_tr_b16 a[204:205], v239 offset:2304
  v_mfma_f32_16x16x32_bf16 v[76:79], a[216:219], v[208:211], v[76:79]
  ds_read_b64_tr_b16 a[206:207], v239 offset:10496
  v_mfma_f32_16x16x32_bf16 v[80:83], a[216:219], v[212:215], v[80:83]
  s_waitcnt lgkmcnt(8)
  v_mfma_f32_16x16x32_bf16 v[84:87], a[220:223], v[204:207], v[84:87]
  ds_read_b64_tr_b16 a[208:209], v228 offset:3072
  v_mfma_f32_16x16x32_bf16 v[88:91], a[220:223], v[208:211], v[88:91]
  buffer_load_dwordx4 v232, s[16:19], s29 offen offset:3072 lds
  v_mfma_f32_16x16x32_bf16 v[92:95], a[220:223], v[212:215], v[92:95]
  s_waitcnt lgkmcnt(7)
  ds_read_b64_tr_b16 a[210:211], v228 offset:11264
  v_mfma_f32_16x16x32_bf16 v[96:99], a[192:195], v[204:207], v[96:99]
  s_add_u32 m0, s28, 131072
  ds_read_b64_tr_b16 a[212:213], v239 offset:3072
  v_mfma_f32_16x16x32_bf16 v[100:103], a[192:195], v[208:211], v[100:103]
  s_mov_b32 s29, 265216
  ds_read_b64_tr_b16 a[214:215], v239 offset:11264
  v_mfma_f32_16x16x32_bf16 v[104:107], a[192:195], v[212:215], v[104:107]
  s_waitcnt lgkmcnt(8)
  v_mfma_f32_16x16x32_bf16 v[108:111], a[196:199], v[204:207], v[108:111]
  ds_read_b64_tr_b16 a[216:217], v228 offset:3328
  v_mfma_f32_16x16x32_bf16 v[112:115], a[196:199], v[208:211], v[112:115]
  buffer_load_dwordx4 v231, s[12:15], s29 offen offset:0 nt lds
  v_mfma_f32_16x16x32_bf16 v[116:119], a[196:199], v[212:215], v[116:119]
  s_waitcnt lgkmcnt(7)
  ds_read_b64_tr_b16 a[218:219], v228 offset:11520
  v_mfma_f32_16x16x32_bf16 v[120:123], a[200:203], v[204:207], v[120:123]
  s_add_u32 s29, s29, s30
  ds_read_b64_tr_b16 a[220:221], v239 offset:3328
  v_mfma_f32_16x16x32_bf16 v[124:127], a[200:203], v[208:211], v[124:127]
  ds_read_b64_tr_b16 a[222:223], v239 offset:11520
  v_add_u32 v228, 16384, v230
  v_mfma_f32_16x16x32_bf16 v[128:131], a[200:203], v[212:215], v[128:131]
  s_waitcnt lgkmcnt(8)
  v_xor_b32 v239, 32, v228
  v_mfma_f32_16x16x32_bf16 v[132:135], a[204:207], v[204:207], v[132:135]
  ds_read_b64_tr_b16 a[192:193], v228 offset:0
  v_mfma_f32_16x16x32_bf16 v[136:139], a[204:207], v[208:211], v[136:139]
  buffer_load_dwordx4 v231, s[12:15], s29 offen offset:1024 nt lds
  v_mfma_f32_16x16x32_bf16 v[140:143], a[204:207], v[212:215], v[140:143]
  s_waitcnt lgkmcnt(7)
  ds_read_b64_tr_b16 a[194:195], v228 offset:8192
  v_mfma_f32_16x16x32_bf16 v[144:147], a[208:211], v[204:207], v[144:147]
  s_add_u32 s29, s29, s30
  ds_read_b64_tr_b16 a[196:197], v239 offset:0
  v_mfma_f32_16x16x32_bf16 v[148:151], a[208:211], v[208:211], v[148:151]
  ds_read_b64_tr_b16 a[198:199], v239 offset:8192
  v_mfma_f32_16x16x32_bf16 v[152:155], a[208:211], v[212:215], v[152:155]
  s_waitcnt lgkmcnt(8)
  v_mfma_f32_16x16x32_bf16 v[156:159], a[212:215], v[204:207], v[156:159]
  ds_read_b64_tr_b16 a[200:201], v228 offset:256
  v_mfma_f32_16x16x32_bf16 v[160:163], a[212:215], v[208:211], v[160:163]
  buffer_load_dwordx4 v231, s[12:15], s29 offen offset:2048 nt lds
  v_mfma_f32_16x16x32_bf16 v[164:167], a[212:215], v[212:215], v[164:167]
  s_waitcnt lgkmcnt(7)
  ds_read_b64_tr_b16 a[202:203], v228 offset:8448
  v_mfma_f32_16x16x32_bf16 a[224:227], a[216:219], v[204:207], a[224:227]
  s_add_u32 s29, s29, s30
  ds_read_b64_tr_b16 a[204:205], v239 offset:256
  v_mfma_f32_16x16x32_bf16 a[228:231], a[216:219], v[208:211], a[228:231]
  ds_read_b64_tr_b16 a[206:207], v239 offset:8448
  v_mfma_f32_16x16x32_bf16 a[232:235], a[216:219], v[212:215], a[232:235]
  s_waitcnt lgkmcnt(8)
  v_mfma_f32_16x16x32_bf16 a[236:239], a[220:223], v[204:207], a[236:239]
  ds_read_b64_tr_b16 a[208:209], v228 offset:1024
  v_mfma_f32_16x16x32_bf16 a[240:243], a[220:223], v[208:211], a[240:243]
  buffer_load_dwordx4 v231, s[12:15], s29 offen offset:3072 nt lds
  v_mfma_f32_16x16x32_bf16 a[244:247], a[220:223], v[212:215], a[244:247]
  s_waitcnt lgkmcnt(7)
  ds_read_b64_tr_b16 a[210:211], v228 offset:9216
  v_mfma_f32_16x16x32_bf16 v[0:3], a[192:195], a[0:3], v[0:3]
  s_waitcnt vmcnt(12)
  ds_read_b64_tr_b16 a[212:213], v239 offset:1024
  v_mfma_f32_16x16x32_bf16 v[4:7], a[192:195], a[4:7], v[4:7]
  s_barrier
  ds_read_b64_tr_b16 a[214:215], v239 offset:9216
  v_add_u32 v238, 65536, v237
  v_mfma_f32_16x16x32_bf16 v[8:11], a[192:195], a[8:11], v[8:11]
  s_waitcnt lgkmcnt(8)
  ds_read_b128 a[28:31], v238 offset:0
  v_mfma_f32_16x16x32_bf16 v[12:15], a[196:199], a[0:3], v[12:15]
  s_add_u32 m0, s28, 98304
  ds_read_b128 a[40:43], v238 offset:256
  v_mfma_f32_16x16x32_bf16 v[16:19], a[196:199], a[4:7], v[16:19]
  s_mov_b32 s29, 3584
  buffer_load_dwordx4 v233, s[4:7], s29 offen offset:0 lds
  v_mfma_f32_16x16x32_bf16 v[20:23], a[196:199], a[8:11], v[20:23]
  s_waitcnt lgkmcnt(8)
  ds_read_b128 a[32:35], v238 offset:2048
  v_mfma_f32_16x16x32_bf16 v[24:27], a[200:203], a[0:3], v[24:27]
  s_mov_b32 s29, 9728
  ds_read_b128 a[44:47], v238 offset:2304
  v_mfma_f32_16x16x32_bf16 v[28:31], a[200:203], a[4:7], v[28:31]
  ds_read_b64_tr_b16 a[216:217], v228 offset:1280
  v_mfma_f32_16x16x32_bf16 v[32:35], a[200:203], a[8:11], v[32:35]
  s_waitcnt lgkmcnt(9)
  ds_read_b64_tr_b16 a[218:219], v228 offset:9472
  v_mfma_f32_16x16x32_bf16 v[36:39], a[204:207], a[0:3], v[36:39]
  ds_read_b64_tr_b16 a[220:221], v239 offset:1280
  v_mfma_f32_16x16x32_bf16 v[40:43], a[204:207], a[4:7], v[40:43]
  buffer_load_dwordx4 v233, s[4:7], s29 offen offset:1024 lds
  v_mfma_f32_16x16x32_bf16 v[44:47], a[204:207], a[8:11], v[44:47]
  s_waitcnt lgkmcnt(9)
  ds_read_b64_tr_b16 a[222:223], v239 offset:9472
  v_mfma_f32_16x16x32_bf16 v[48:51], a[208:211], a[0:3], v[48:51]
  s_mov_b32 s29, 15872
  ds_read_b64_tr_b16 a[192:193], v228 offset:2048
  v_mfma_f32_16x16x32_bf16 v[52:55], a[208:211], a[4:7], v[52:55]
  ds_read_b64_tr_b16 a[194:195], v228 offset:10240
  v_mfma_f32_16x16x32_bf16 v[56:59], a[208:211], a[8:11], v[56:59]
  s_waitcnt lgkmcnt(10)
  ds_read_b64_tr_b16 a[196:197], v239 offset:2048
  v_mfma_f32_16x16x32_bf16 v[60:63], a[212:215], a[0:3], v[60:63]
  ds_read_b64_tr_b16 a[198:199], v239 offset:10240
  v_mfma_f32_16x16x32_bf16 v[64:67], a[212:215], a[4:7], v[64:67]
  buffer_load_dwordx4 v233, s[4:7], s29 offen offset:2048 lds
  v_mfma_f32_16x16x32_bf16 v[68:71], a[212:215], a[8:11], v[68:71]
  s_waitcnt lgkmcnt(6)
  ds_read_b64_tr_b16 a[200:201], v228 offset:2304
  v_mfma_f32_16x16x32_bf16 v[72:75], a[216:219], a[0:3], v[72:75]
  s_mov_b32 s29, 22016
  ds_read_b64_tr_b16 a[202:203], v228 offset:10496
  v_mfma_f32_16x16x32_bf16 v[76:79], a[216:219], a[4:7], v[76:79]
  ds_read_b64_tr_b16 a[204:205], v239 offset:2304
  v_mfma_f32_16x16x32_bf16 v[80:83], a[216:219], a[8:11], v[80:83]
  s_waitcnt lgkmcnt(7)
  ds_read_b64_tr_b16 a[206:207], v239 offset:10496
  v_mfma_f32_16x16x32_bf16 v[84:87], a[220:223], a[0:3], v[84:87]
  ds_read_b64_tr_b16 a[208:209], v228 offset:3072
  v_mfma_f32_16x16x32_bf16 v[88:91], a[220:223], a[4:7], v[88:91]
  buffer_load_dwordx4 v233, s[4:7], s29 offen offset:3072 lds
  v_mfma_f32_16x16x32_bf16 v[92:95], a[220:223], a[8:11], v[92:95]
  s_waitcnt lgkmcnt(7)
  ds_read_b64_tr_b16 a[210:211], v228 offset:11264
  v_mfma_f32_16x16x32_bf16 v[96:99], a[192:195], a[0:3], v[96:99]
  s_add_u32 m0, s28, 81920
  ds_read_b64_tr_b16 a[212:213], v239 offset:3072
  v_mfma_f32_16x16x32_bf16 v[100:103], a[192:195], a[4:7], v[100:103]
  s_mov_b32 s29, 32256
  ds_read_b64_tr_b16 a[214:215], v239 offset:11264
  v_mfma_f32_16x16x32_bf16 v[104:107], a[192:195], a[8:11], v[104:107]
  s_waitcnt lgkmcnt(8)
  v_mfma_f32_16x16x32_bf16 v[108:111], a[196:199], a[0:3], v[108:111]
  ds_read_b64_tr_b16 a[216:217], v228 offset:3328
  v_mfma_f32_16x16x32_bf16 v[112:115], a[196:199], a[4:7], v[112:115]
  buffer_load_dwordx4 v233, s[4:7], s29 offen offset:0 lds
  v_mfma_f32_16x16x32_bf16 v[116:119], a[196:199], a[8:11], v[116:119]
  s_waitcnt lgkmcnt(7)
  ds_read_b64_tr_b16 a[218:219], v228 offset:11520
  v_mfma_f32_16x16x32_bf16 v[120:123], a[200:203], a[0:3], v[120:123]
  s_mov_b32 s29, 38400
  ds_read_b64_tr_b16 a[220:221], v239 offset:3328
  v_mfma_f32_16x16x32_bf16 v[124:127], a[200:203], a[4:7], v[124:127]
  ds_read_b64_tr_b16 a[222:223], v239 offset:11520
  v_add_u32 v228, 32768, v230
  v_mfma_f32_16x16x32_bf16 v[128:131], a[200:203], a[8:11], v[128:131]
  s_waitcnt lgkmcnt(8)
  v_xor_b32 v239, 32, v228
  v_mfma_f32_16x16x32_bf16 v[132:135], a[204:207], a[0:3], v[132:135]
  ds_read_b64_tr_b16 a[192:193], v228 offset:0
  v_mfma_f32_16x16x32_bf16 v[136:139], a[204:207], a[4:7], v[136:139]
  buffer_load_dwordx4 v233, s[4:7], s29 offen offset:1024 lds
  v_mfma_f32_16x16x32_bf16 v[140:143], a[204:207], a[8:11], v[140:143]
  s_waitcnt lgkmcnt(7)
  ds_read_b64_tr_b16 a[194:195], v228 offset:8192
  v_mfma_f32_16x16x32_bf16 v[144:147], a[208:211], a[0:3], v[144:147]
  s_mov_b32 s29, 1664
  ds_read_b64_tr_b16 a[196:197], v239 offset:0
  v_mfma_f32_16x16x32_bf16 v[148:151], a[208:211], a[4:7], v[148:151]
  ds_read_b64_tr_b16 a[198:199], v239 offset:8192
  v_mfma_f32_16x16x32_bf16 v[152:155], a[208:211], a[8:11], v[152:155]
  s_waitcnt lgkmcnt(8)
  v_mfma_f32_16x16x32_bf16 v[156:159], a[212:215], a[0:3], v[156:159]
  ds_read_b64_tr_b16 a[200:201], v228 offset:256
  v_mfma_f32_16x16x32_bf16 v[160:163], a[212:215], a[4:7], v[160:163]
  buffer_load_dwordx4 v233, s[4:7], s29 offen offset:2048 lds
  v_mfma_f32_16x16x32_bf16 v[164:167], a[212:215], a[8:11], v[164:167]
  s_waitcnt lgkmcnt(7)
  ds_read_b64_tr_b16 a[202:203], v228 offset:8448
  v_mfma_f32_16x16x32_bf16 a[224:227], a[216:219], a[0:3], a[224:227]
  s_mov_b32 s29, 7808
  ds_read_b64_tr_b16 a[204:205], v239 offset:256
  v_mfma_f32_16x16x32_bf16 a[228:231], a[216:219], a[4:7], a[228:231]
  ds_read_b64_tr_b16 a[206:207], v239 offset:8448
  v_mfma_f32_16x16x32_bf16 a[232:235], a[216:219], a[8:11], a[232:235]
  s_waitcnt lgkmcnt(8)
  v_mfma_f32_16x16x32_bf16 a[236:239], a[220:223], a[0:3], a[236:239]
  ds_read_b64_tr_b16 a[208:209], v228 offset:1024
  v_mfma_f32_16x16x32_bf16 a[240:243], a[220:223], a[4:7], a[240:243]
  buffer_load_dwordx4 v233, s[4:7], s29 offen offset:3072 lds
  v_mfma_f32_16x16x32_bf16 a[244:247], a[220:223], a[8:11], a[244:247]
  s_waitcnt lgkmcnt(7)
  ds_read_b64_tr_b16 a[210:211], v228 offset:9216
  v_mfma_f32_16x16x32_bf16 v[0:3], a[192:195], a[12:15], v[0:3]
  s_waitcnt vmcnt(16)
  ds_read_b64_tr_b16 a[212:213], v239 offset:1024
  v_mfma_f32_16x16x32_bf16 v[4:7], a[192:195], a[16:19], v[4:7]
  s_barrier
  ds_read_b64_tr_b16 a[214:215], v239 offset:9216
  v_mfma_f32_16x16x32_bf16 v[8:11], a[192:195], a[20:23], v[8:11]
  s_waitcnt lgkmcnt(8)
  v_mfma_f32_16x16x32_bf16 v[12:15], a[196:199], a[12:15], v[12:15]
  s_add_u32 m0, s28, 16384
  ds_read_b64_tr_b16 a[216:217], v228 offset:1280
  v_mfma_f32_16x16x32_bf16 v[16:19], a[196:199], a[16:19], v[16:19]
  s_mov_b32 s29, 2100736
  buffer_load_dwordx4 v232, s[16:19], s29 offen offset:0 lds
  v_mfma_f32_16x16x32_bf16 v[20:23], a[196:199], a[20:23], v[20:23]
  s_waitcnt lgkmcnt(7)
  ds_read_b64_tr_b16 a[218:219], v228 offset:9472
  v_mfma_f32_16x16x32_bf16 v[24:27], a[200:203], a[12:15], v[24:27]
  s_add_u32 s29, s29, s30
  ds_read_b64_tr_b16 a[220:221], v239 offset:1280
  v_mfma_f32_16x16x32_bf16 v[28:31], a[200:203], a[16:19], v[28:31]
  ds_read_b64_tr_b16 a[222:223], v239 offset:9472
  v_mfma_f32_16x16x32_bf16 v[32:35], a[200:203], a[20:23], v[32:35]
  s_waitcnt lgkmcnt(8)
  v_mfma_f32_16x16x32_bf16 v[36:39], a[204:207], a[12:15], v[36:39]
  ds_read_b64_tr_b16 a[192:193], v228 offset:2048
  v_mfma_f32_16x16x32_bf16 v[40:43], a[204:207], a[16:19], v[40:43]
  buffer_load_dwordx4 v232, s[16:19], s29 offen offset:1024 lds
  v_mfma_f32_16x16x32_bf16 v[44:47], a[204:207], a[20:23], v[44:47]
  s_waitcnt lgkmcnt(7)
  ds_read_b64_tr_b16 a[194:195], v228 offset:10240
  v_mfma_f32_16x16x32_bf16 v[48:51], a[208:211], a[12:15], v[48:51]
  s_add_u32 s29, s29, s30
  ds_read_b64_tr_b16 a[196:197], v239 offset:2048
  v_mfma_f32_16x16x32_bf16 v[52:55], a[208:211], a[16:19], v[52:55]
  ds_read_b64_tr_b16 a[198:199], v239 offset:10240
  v_mfma_f32_16x16x32_bf16 v[56:59], a[208:211], a[20:23], v[56:59]
  s_waitcnt lgkmcnt(8)
  v_mfma_f32_16x16x32_bf16 v[60:63], a[212:215], a[12:15], v[60:63]
  ds_read_b64_tr_b16 a[200:201], v228 offset:2304
  v_mfma_f32_16x16x32_bf16 v[64:67], a[212:215], a[16:19], v[64:67]
  buffer_load_dwordx4 v232, s[16:19], s29 offen offset:2048 lds
  v_mfma_f32_16x16x32_bf16 v[68:71], a[212:215], a[20:23], v[68:71]
  s_waitcnt lgkmcnt(7)
  ds_read_b64_tr_b16 a[202:203], v228 offset:10496
  v_mfma_f32_16x16x32_bf16 v[72:75], a[216:219], a[12:15], v[72:75]
  s_add_u32 s29, s29, s30
  ds_read_b64_tr_b16 a[204:205], v239 offset:2304
  v_mfma_f32_16x16x32_bf16 v[76:79], a[216:219], a[16:19], v[76:79]
  ds_read_b64_tr_b16 a[206:207], v239 offset:10496
  v_mfma_f32_16x16x32_bf16 v[80:83], a[216:219], a[20:23], v[80:83]
  s_waitcnt lgkmcnt(8)
  v_mfma_f32_16x16x32_bf16 v[84:87], a[220:223], a[12:15], v[84:87]
  ds_read_b64_tr_b16 a[208:209], v228 offset:3072
  v_mfma_f32_16x16x32_bf16 v[88:91], a[220:223], a[16:19], v[88:91]
  buffer_load_dwordx4 v232, s[16:19], s29 offen offset:3072 lds
  v_mfma_f32_16x16x32_bf16 v[92:95], a[220:223], a[20:23], v[92:95]
  s_waitcnt lgkmcnt(7)
  ds_read_b64_tr_b16 a[210:211], v228 offset:11264
  v_mfma_f32_16x16x32_bf16 v[96:99], a[192:195], a[12:15], v[96:99]
  s_add_u32 m0, s28, 65536
  ds_read_b64_tr_b16 a[212:213], v239 offset:3072
  v_mfma_f32_16x16x32_bf16 v[100:103], a[192:195], a[16:19], v[100:103]
  s_mov_b32 s29, 2362880
  ds_read_b64_tr_b16 a[214:215], v239 offset:11264
  v_mfma_f32_16x16x32_bf16 v[104:107], a[192:195], a[20:23], v[104:107]
  s_waitcnt lgkmcnt(8)
  v_mfma_f32_16x16x32_bf16 v[108:111], a[196:199], a[12:15], v[108:111]
  ds_read_b64_tr_b16 a[216:217], v228 offset:3328
  v_mfma_f32_16x16x32_bf16 v[112:115], a[196:199], a[16:19], v[112:115]
  buffer_load_dwordx4 v232, s[16:19], s29 offen offset:0 lds
  v_mfma_f32_16x16x32_bf16 v[116:119], a[196:199], a[20:23], v[116:119]
  s_waitcnt lgkmcnt(7)
  ds_read_b64_tr_b16 a[218:219], v228 offset:11520
  v_mfma_f32_16x16x32_bf16 v[120:123], a[200:203], a[12:15], v[120:123]
  s_add_u32 s29, s29, s30
  ds_read_b64_tr_b16 a[220:221], v239 offset:3328
  v_mfma_f32_16x16x32_bf16 v[124:127], a[200:203], a[16:19], v[124:127]
  ds_read_b64_tr_b16 a[222:223], v239 offset:11520
  v_add_u32 v228, 114688, v230
  v_mfma_f32_16x16x32_bf16 v[128:131], a[200:203], a[20:23], v[128:131]
  s_waitcnt lgkmcnt(8)
  v_xor_b32 v239, 32, v228
  v_mfma_f32_16x16x32_bf16 v[132:135], a[204:207], a[12:15], v[132:135]
  ds_read_b64_tr_b16 a[192:193], v228 offset:0
  v_mfma_f32_16x16x32_bf16 v[136:139], a[204:207], a[16:19], v[136:139]
  buffer_load_dwordx4 v232, s[16:19], s29 offen offset:1024 lds
  v_mfma_f32_16x16x32_bf16 v[140:143], a[204:207], a[20:23], v[140:143]
  s_waitcnt lgkmcnt(7)
  ds_read_b64_tr_b16 a[194:195], v228 offset:8192
  v_mfma_f32_16x16x32_bf16 v[144:147], a[208:211], a[12:15], v[144:147]
  s_add_u32 s29, s29, s30
  ds_read_b64_tr_b16 a[196:197], v239 offset:0
  v_mfma_f32_16x16x32_bf16 v[148:151], a[208:211], a[16:19], v[148:151]
  ds_read_b64_tr_b16 a[198:199], v239 offset:8192
  v_mfma_f32_16x16x32_bf16 v[152:155], a[208:211], a[20:23], v[152:155]
  s_waitcnt lgkmcnt(8)
  v_mfma_f32_16x16x32_bf16 v[156:159], a[212:215], a[12:15], v[156:159]
  ds_read_b64_tr_b16 a[200:201], v228 offset:256
  v_mfma_f32_16x16x32_bf16 v[160:163], a[212:215], a[16:19], v[160:163]
  buffer_load_dwordx4 v232, s[16:19], s29 offen offset:2048 lds
  v_mfma_f32_16x16x32_bf16 v[164:167], a[212:215], a[20:23], v[164:167]
  s_waitcnt lgkmcnt(7)
  ds_read_b64_tr_b16 a[202:203], v228 offset:8448
  v_mfma_f32_16x16x32_bf16 a[224:227], a[216:219], a[12:15], a[224:227]
  s_add_u32 s29, s29, s30
  ds_read_b64_tr_b16 a[204:205], v239 offset:256
  v_mfma_f32_16x16x32_bf16 a[228:231], a[216:219], a[16:19], a[228:231]
  ds_read_b64_tr_b16 a[206:207], v239 offset:8448
  v_mfma_f32_16x16x32_bf16 a[232:235], a[216:219], a[20:23], a[232:235]
  s_waitcnt lgkmcnt(8)
  v_mfma_f32_16x16x32_bf16 a[236:239], a[220:223], a[12:15], a[236:239]
  ds_read_b64_tr_b16 a[208:209], v228 offset:1024
  v_mfma_f32_16x16x32_bf16 a[240:243], a[220:223], a[16:19], a[240:243]
  buffer_load_dwordx4 v232, s[16:19], s29 offen offset:3072 lds
  v_mfma_f32_16x16x32_bf16 a[244:247], a[220:223], a[20:23], a[244:247]
  s_waitcnt lgkmcnt(7)
  ds_read_b64_tr_b16 a[210:211], v228 offset:9216
  v_mfma_f32_16x16x32_bf16 v[0:3], a[192:195], a[24:27], v[0:3]
  s_waitcnt vmcnt(8)
  ds_read_b64_tr_b16 a[212:213], v239 offset:1024
  v_mfma_f32_16x16x32_bf16 v[4:7], a[192:195], a[28:31], v[4:7]
  s_barrier
  ds_read_b64_tr_b16 a[214:215], v239 offset:9216
  v_add_u32 v238, 98304, v237
  v_mfma_f32_16x16x32_bf16 v[8:11], a[192:195], a[32:35], v[8:11]
  s_waitcnt lgkmcnt(8)
  ds_read_b128 a[48:51], v238 offset:0
  v_mfma_f32_16x16x32_bf16 v[12:15], a[196:199], a[24:27], v[12:15]
  s_add_u32 m0, s28, 32768
  ds_read_b128 a[60:63], v238 offset:256
  v_mfma_f32_16x16x32_bf16 v[16:19], a[196:199], a[28:31], v[16:19]
  s_mov_b32 s29, 18048
  ds_read_b128 a[52:55], v238 offset:2048
  v_mfma_f32_16x16x32_bf16 v[20:23], a[196:199], a[32:35], v[20:23]
  s_waitcnt lgkmcnt(9)
  ds_read_b128 a[64:67], v238 offset:2304
  v_add_u32 v238, 81920, v237
  v_mfma_f32_16x16x32_bf16 v[24:27], a[200:203], a[24:27], v[24:27]
  ds_read_b128 a[56:59], v238 offset:0
  v_mfma_f32_16x16x32_bf16 v[28:31], a[200:203], a[28:31], v[28:31]
  buffer_load_dwordx4 v233, s[4:7], s29 offen offset:0 lds
  v_mfma_f32_16x16x32_bf16 v[32:35], a[200:203], a[32:35], v[32:35]
  s_waitcnt lgkmcnt(9)
  ds_read_b64_tr_b16 a[216:217], v228 offset:1280
  v_mfma_f32_16x16x32_bf16 v[36:39], a[204:207], a[24:27], v[36:39]
  s_mov_b32 s29, 24192
  ds_read_b64_tr_b16 a[218:219], v228 offset:9472
  v_mfma_f32_16x16x32_bf16 v[40:43], a[204:207], a[28:31], v[40:43]
  ds_read_b64_tr_b16 a[220:221], v239 offset:1280
  v_mfma_f32_16x16x32_bf16 v[44:47], a[204:207], a[32:35], v[44:47]
  s_waitcnt lgkmcnt(10)
  ds_read_b64_tr_b16 a[222:223], v239 offset:9472
  v_mfma_f32_16x16x32_bf16 v[48:51], a[208:211], a[24:27], v[48:51]
  ds_read_b128 a[68:71], v238 offset:256
  v_mfma_f32_16x16x32_bf16 v[52:55], a[208:211], a[28:31], v[52:55]
  ds_read_b64_tr_b16 a[192:193], v228 offset:2048
  v_mfma_f32_16x16x32_bf16 v[56:59], a[208:211], a[32:35], v[56:59]
  s_waitcnt lgkmcnt(11)
  ds_read_b64_tr_b16 a[194:195], v228 offset:10240
  v_mfma_f32_16x16x32_bf16 v[60:63], a[212:215], a[24:27], v[60:63]
  ds_read_b128 a[72:75], v238 offset:2048
  v_mfma_f32_16x16x32_bf16 v[64:67], a[212:215], a[28:31], v[64:67]
  ds_read_b64_tr_b16 a[196:197], v239 offset:2048
  v_mfma_f32_16x16x32_bf16 v[68:71], a[212:215], a[32:35], v[68:71]
  s_waitcnt lgkmcnt(7)
  ds_read_b64_tr_b16 a[198:199], v239 offset:10240
  v_mfma_f32_16x16x32_bf16 v[72:75], a[216:219], a[24:27], v[72:75]
  ds_read_b128 a[84:87], v238 offset:2304
  v_mfma_f32_16x16x32_bf16 v[76:79], a[216:219], a[28:31], v[76:79]
  buffer_load_dwordx4 v233, s[4:7], s29 offen offset:1024 lds
  v_mfma_f32_16x16x32_bf16 v[80:83], a[216:219], a[32:35], v[80:83]
  s_waitcnt lgkmcnt(7)
  ds_read_b64_tr_b16 a[200:201], v228 offset:2304
  v_mfma_f32_16x16x32_bf16 v[84:87], a[220:223], a[24:27], v[84:87]
  s_mov_b32 s29, 30336
  ds_read_b64_tr_b16 a[202:203], v228 offset:10496
  v_mfma_f32_16x16x32_bf16 v[88:91], a[220:223], a[28:31], v[88:91]
  ds_read_b64_tr_b16 a[204:205], v239 offset:2304
  v_mfma_f32_16x16x32_bf16 v[92:95], a[220:223], a[32:35], v[92:95]
  s_waitcnt lgkmcnt(7)
  ds_read_b64_tr_b16 a[206:207], v239 offset:10496
  v_mfma_f32_16x16x32_bf16 v[96:99], a[192:195], a[24:27], v[96:99]
  ds_read_b64_tr_b16 a[208:209], v228 offset:3072
  v_mfma_f32_16x16x32_bf16 v[100:103], a[192:195], a[28:31], v[100:103]
  ds_read_b64_tr_b16 a[210:211], v228 offset:11264
  v_mfma_f32_16x16x32_bf16 v[104:107], a[192:195], a[32:35], v[104:107]
  s_waitcnt lgkmcnt(7)
  ds_read_b64_tr_b16 a[212:213], v239 offset:3072
  v_mfma_f32_16x16x32_bf16 v[108:111], a[196:199], a[24:27], v[108:111]
  ds_read_b64_tr_b16 a[214:215], v239 offset:11264
  v_mfma_f32_16x16x32_bf16 v[112:115], a[196:199], a[28:31], v[112:115]
  ds_read_b64_tr_b16 a[216:217], v228 offset:3328
  v_mfma_f32_16x16x32_bf16 v[116:119], a[196:199], a[32:35], v[116:119]
  s_waitcnt lgkmcnt(7)
  ds_read_b64_tr_b16 a[218:219], v228 offset:11520
  v_mfma_f32_16x16x32_bf16 v[120:123], a[200:203], a[24:27], v[120:123]
  ds_read_b64_tr_b16 a[220:221], v239 offset:3328
  v_mfma_f32_16x16x32_bf16 v[124:127], a[200:203], a[28:31], v[124:127]
  buffer_load_dwordx4 v233, s[4:7], s29 offen offset:2048 lds
  v_mfma_f32_16x16x32_bf16 v[128:131], a[200:203], a[32:35], v[128:131]
  s_waitcnt lgkmcnt(7)
  ds_read_b64_tr_b16 a[222:223], v239 offset:11520
  v_add_u32 v228, 0, v230
  v_mfma_f32_16x16x32_bf16 v[132:135], a[204:207], a[24:27], v[132:135]
  s_mov_b32 s29, 36480
  ds_read_b64_tr_b16 a[192:193], v228 offset:0
  v_xor_b32 v239, 32, v228
  v_mfma_f32_16x16x32_bf16 v[136:139], a[204:207], a[28:31], v[136:139]
  ds_read_b64_tr_b16 a[194:195], v228 offset:8192
  v_mfma_f32_16x16x32_bf16 v[140:143], a[204:207], a[32:35], v[140:143]
  s_waitcnt lgkmcnt(8)
  v_mfma_f32_16x16x32_bf16 v[144:147], a[208:211], a[24:27], v[144:147]
  ds_read_b64_tr_b16 a[196:197], v239 offset:0
  v_mfma_f32_16x16x32_bf16 v[148:151], a[208:211], a[28:31], v[148:151]
  ds_read_b64_tr_b16 a[198:199], v239 offset:8192
  v_mfma_f32_16x16x32_bf16 v[152:155], a[208:211], a[32:35], v[152:155]
  s_waitcnt lgkmcnt(8)
  v_mfma_f32_16x16x32_bf16 v[156:159], a[212:215], a[24:27], v[156:159]
  ds_read_b64_tr_b16 a[200:201], v228 offset:256
  v_mfma_f32_16x16x32_bf16 v[160:163], a[212:215], a[28:31], v[160:163]
  ds_read_b64_tr_b16 a[202:203], v228 offset:8448
  v_mfma_f32_16x16x32_bf16 v[164:167], a[212:215], a[32:35], v[164:167]
  s_waitcnt lgkmcnt(8)
  v_mfma_f32_16x16x32_bf16 a[224:227], a[216:219], a[24:27], a[224:227]
  ds_read_b64_tr_b16 a[204:205], v239 offset:256
  v_mfma_f32_16x16x32_bf16 a[228:231], a[216:219], a[28:31], a[228:231]
  buffer_load_dwordx4 v233, s[4:7], s29 offen offset:3072 lds
  v_mfma_f32_16x16x32_bf16 a[232:235], a[216:219], a[32:35], a[232:235]
  s_waitcnt lgkmcnt(7)
  ds_read_b64_tr_b16 a[206:207], v239 offset:8448
  v_mfma_f32_16x16x32_bf16 a[236:239], a[220:223], a[24:27], a[236:239]
  ds_read_b64_tr_b16 a[208:209], v228 offset:1024
  v_mfma_f32_16x16x32_bf16 a[240:243], a[220:223], a[28:31], a[240:243]
  ds_read_b64_tr_b16 a[210:211], v228 offset:9216
  v_mfma_f32_16x16x32_bf16 a[244:247], a[220:223], a[32:35], a[244:247]
  s_waitcnt lgkmcnt(8)
  v_mfma_f32_16x16x32_bf16 v[0:3], a[192:195], a[36:39], v[0:3]
  s_waitcnt vmcnt(8)
  ds_read_b64_tr_b16 a[212:213], v239 offset:1024
  v_mfma_f32_16x16x32_bf16 v[4:7], a[192:195], a[40:43], v[4:7]
  s_barrier
  ds_read_b64_tr_b16 a[214:215], v239 offset:9216
  v_mfma_f32_16x16x32_bf16 v[8:11], a[192:195], a[44:47], v[8:11]
  s_waitcnt lgkmcnt(8)
  v_mfma_f32_16x16x32_bf16 v[12:15], a[196:199], a[36:39], v[12:15]
  s_add_u32 m0, s28, 114688
  ds_read_b64_tr_b16 a[216:217], v228 offset:1280
  v_mfma_f32_16x16x32_bf16 v[16:19], a[196:199], a[40:43], v[16:19]
  s_mov_b32 s29, 2625024
  buffer_load_dwordx4 v232, s[16:19], s29 offen offset:0 lds
  v_mfma_f32_16x16x32_bf16 v[20:23], a[196:199], a[44:47], v[20:23]
  s_waitcnt lgkmcnt(7)
  ds_read_b64_tr_b16 a[218:219], v228 offset:9472
  v_mfma_f32_16x16x32_bf16 v[24:27], a[200:203], a[36:39], v[24:27]
  s_add_u32 s29, s29, s30
  ds_read_b64_tr_b16 a[220:221], v239 offset:1280
  v_mfma_f32_16x16x32_bf16 v[28:31], a[200:203], a[40:43], v[28:31]
  ds_read_b64_tr_b16 a[222:223], v239 offset:9472
  v_mfma_f32_16x16x32_bf16 v[32:35], a[200:203], a[44:47], v[32:35]
  s_waitcnt lgkmcnt(8)
  v_mfma_f32_16x16x32_bf16 v[36:39], a[204:207], a[36:39], v[36:39]
  ds_read_b64_tr_b16 a[192:193], v228 offset:2048
  v_mfma_f32_16x16x32_bf16 v[40:43], a[204:207], a[40:43], v[40:43]
  buffer_load_dwordx4 v232, s[16:19], s29 offen offset:1024 lds
  v_mfma_f32_16x16x32_bf16 v[44:47], a[204:207], a[44:47], v[44:47]
  s_waitcnt lgkmcnt(7)
  ds_read_b64_tr_b16 a[194:195], v228 offset:10240
  v_mfma_f32_16x16x32_bf16 v[48:51], a[208:211], a[36:39], v[48:51]
  s_add_u32 s29, s29, s30
  ds_read_b64_tr_b16 a[196:197], v239 offset:2048
  v_mfma_f32_16x16x32_bf16 v[52:55], a[208:211], a[40:43], v[52:55]
  ds_read_b64_tr_b16 a[198:199], v239 offset:10240
  v_mfma_f32_16x16x32_bf16 v[56:59], a[208:211], a[44:47], v[56:59]
  s_waitcnt lgkmcnt(8)
  v_mfma_f32_16x16x32_bf16 v[60:63], a[212:215], a[36:39], v[60:63]
  ds_read_b64_tr_b16 a[200:201], v228 offset:2304
  v_mfma_f32_16x16x32_bf16 v[64:67], a[212:215], a[40:43], v[64:67]
  buffer_load_dwordx4 v232, s[16:19], s29 offen offset:2048 lds
  v_mfma_f32_16x16x32_bf16 v[68:71], a[212:215], a[44:47], v[68:71]
  s_waitcnt lgkmcnt(7)
  ds_read_b64_tr_b16 a[202:203], v228 offset:10496
  v_mfma_f32_16x16x32_bf16 v[72:75], a[216:219], a[36:39], v[72:75]
  s_add_u32 s29, s29, s30
  ds_read_b64_tr_b16 a[204:205], v239 offset:2304
  v_mfma_f32_16x16x32_bf16 v[76:79], a[216:219], a[40:43], v[76:79]
  ds_read_b64_tr_b16 a[206:207], v239 offset:10496
  v_mfma_f32_16x16x32_bf16 v[80:83], a[216:219], a[44:47], v[80:83]
  s_waitcnt lgkmcnt(8)
  v_mfma_f32_16x16x32_bf16 v[84:87], a[220:223], a[36:39], v[84:87]
  ds_read_b64_tr_b16 a[208:209], v228 offset:3072
  v_mfma_f32_16x16x32_bf16 v[88:91], a[220:223], a[40:43], v[88:91]
  buffer_load_dwordx4 v232, s[16:19], s29 offen offset:3072 lds
  v_mfma_f32_16x16x32_bf16 v[92:95], a[220:223], a[44:47], v[92:95]
  s_waitcnt lgkmcnt(7)
  ds_read_b64_tr_b16 a[210:211], v228 offset:11264
  v_mfma_f32_16x16x32_bf16 v[96:99], a[192:195], a[36:39], v[96:99]
  s_add_u32 m0, s28, 98304
  ds_read_b64_tr_b16 a[212:213], v239 offset:3072
  v_mfma_f32_16x16x32_bf16 v[100:103], a[192:195], a[40:43], v[100:103]
  s_mov_b32 s29, 2887168
  ds_read_b64_tr_b16 a[214:215], v239 offset:11264
  v_mfma_f32_16x16x32_bf16 v[104:107], a[192:195], a[44:47], v[104:107]
  s_waitcnt lgkmcnt(8)
  v_mfma_f32_16x16x32_bf16 v[108:111], a[196:199], a[36:39], v[108:111]
  ds_read_b64_tr_b16 a[216:217], v228 offset:3328
  v_mfma_f32_16x16x32_bf16 v[112:115], a[196:199], a[40:43], v[112:115]
  buffer_load_dwordx4 v232, s[16:19], s29 offen offset:0 lds
  v_mfma_f32_16x16x32_bf16 v[116:119], a[196:199], a[44:47], v[116:119]
  s_waitcnt lgkmcnt(7)
  ds_read_b64_tr_b16 a[218:219], v228 offset:11520
  v_mfma_f32_16x16x32_bf16 v[120:123], a[200:203], a[36:39], v[120:123]
  s_add_u32 s29, s29, s30
  ds_read_b64_tr_b16 a[220:221], v239 offset:3328
  v_mfma_f32_16x16x32_bf16 v[124:127], a[200:203], a[40:43], v[124:127]
  ds_read_b64_tr_b16 a[222:223], v239 offset:11520
  v_add_u32 v228, 16384, v230
  v_mfma_f32_16x16x32_bf16 v[128:131], a[200:203], a[44:47], v[128:131]
  s_waitcnt lgkmcnt(8)
  v_xor_b32 v239, 32, v228
  v_mfma_f32_16x16x32_bf16 v[132:135], a[204:207], a[36:39], v[132:135]
  ds_read_b64_tr_b16 a[192:193], v228 offset:0
  v_mfma_f32_16x16x32_bf16 v[136:139], a[204:207], a[40:43], v[136:139]
  buffer_load_dwordx4 v232, s[16:19], s29 offen offset:1024 lds
  v_mfma_f32_16x16x32_bf16 v[140:143], a[204:207], a[44:47], v[140:143]
  s_waitcnt lgkmcnt(7)
  ds_read_b64_tr_b16 a[194:195], v228 offset:8192
  v_mfma_f32_16x16x32_bf16 v[144:147], a[208:211], a[36:39], v[144:147]
  s_add_u32 s29, s29, s30
  ds_read_b64_tr_b16 a[196:197], v239 offset:0
  v_mfma_f32_16x16x32_bf16 v[148:151], a[208:211], a[40:43], v[148:151]
  ds_read_b64_tr_b16 a[198:199], v239 offset:8192
  v_mfma_f32_16x16x32_bf16 v[152:155], a[208:211], a[44:47], v[152:155]
  s_waitcnt lgkmcnt(8)
  v_mfma_f32_16x16x32_bf16 v[156:159], a[212:215], a[36:39], v[156:159]
  ds_read_b64_tr_b16 a[200:201], v228 offset:256
  v_mfma_f32_16x16x32_bf16 v[160:163], a[212:215], a[40:43], v[160:163]
  buffer_load_dwordx4 v232, s[16:19], s29 offen offset:2048 lds
  v_mfma_f32_16x16x32_bf16 v[164:167], a[212:215], a[44:47], v[164:167]
  s_waitcnt lgkmcnt(7)
  ds_read_b64_tr_b16 a[202:203], v228 offset:8448
  v_mfma_f32_16x16x32_bf16 a[224:227], a[216:219], a[36:39], a[224:227]
  s_add_u32 s29, s29, s30
  ds_read_b64_tr_b16 a[204:205], v239 offset:256
  v_mfma_f32_16x16x32_bf16 a[228:231], a[216:219], a[40:43], a[228:231]
  ds_read_b64_tr_b16 a[206:207], v239 offset:8448
  v_mfma_f32_16x16x32_bf16 a[232:235], a[216:219], a[44:47], a[232:235]
  s_waitcnt lgkmcnt(8)
  v_mfma_f32_16x16x32_bf16 a[236:239], a[220:223], a[36:39], a[236:239]
  ds_read_b64_tr_b16 a[208:209], v228 offset:1024
  v_mfma_f32_16x16x32_bf16 a[240:243], a[220:223], a[40:43], a[240:243]
  buffer_load_dwordx4 v232, s[16:19], s29 offen offset:3072 lds
  v_mfma_f32_16x16x32_bf16 a[244:247], a[220:223], a[44:47], a[244:247]
  s_waitcnt lgkmcnt(7)
  ds_read_b64_tr_b16 a[210:211], v228 offset:9216
  v_mfma_f32_16x16x32_bf16 v[0:3], a[192:195], a[48:51], v[0:3]
  s_waitcnt vmcnt(8)
  ds_read_b64_tr_b16 a[212:213], v239 offset:1024
  v_mfma_f32_16x16x32_bf16 v[4:7], a[192:195], a[52:55], v[4:7]
  s_barrier
  ds_read_b64_tr_b16 a[214:215], v239 offset:9216
  v_add_u32 v238, 32768, v237
  v_mfma_f32_16x16x32_bf16 v[8:11], a[192:195], a[56:59], v[8:11]
  s_waitcnt lgkmcnt(8)
  ds_read_b128 a[76:79], v238 offset:0
  v_mfma_f32_16x16x32_bf16 v[12:15], a[196:199], a[48:51], v[12:15]
  s_add_u32 m0, s28, 81920
  ds_read_b128 a[88:91], v238 offset:256
  v_mfma_f32_16x16x32_bf16 v[16:19], a[196:199], a[52:55], v[16:19]
  s_mov_b32 s29, 3840
  ds_read_b128 a[80:83], v238 offset:2048
  v_mfma_f32_16x16x32_bf16 v[20:23], a[196:199], a[56:59], v[20:23]
  s_waitcnt lgkmcnt(9)
  ds_read_b128 a[92:95], v238 offset:2304
  v_mfma_f32_16x16x32_bf16 v[24:27], a[200:203], a[48:51], v[24:27]
  ds_read_b64_tr_b16 a[216:217], v228 offset:1280
  v_mfma_f32_16x16x32_bf16 v[28:31], a[200:203], a[52:55], v[28:31]
  buffer_load_dwordx4 v233, s[4:7], s29 offen offset:0 lds
  v_mfma_f32_16x16x32_bf16 v[32:35], a[200:203], a[56:59], v[32:35]
  s_waitcnt lgkmcnt(9)
  ds_read_b64_tr_b16 a[218:219], v228 offset:9472
  v_mfma_f32_16x16x32_bf16 v[36:39], a[204:207], a[48:51], v[36:39]
  s_mov_b32 s29, 9984
  ds_read_b64_tr_b16 a[220:221], v239 offset:1280
  v_mfma_f32_16x16x32_bf16 v[40:43], a[204:207], a[52:55], v[40:43]
  ds_read_b64_tr_b16 a[222:223], v239 offset:9472
  v_mfma_f32_16x16x32_bf16 v[44:47], a[204:207], a[56:59], v[44:47]
  s_waitcnt lgkmcnt(10)
  ds_read_b64_tr_b16 a[192:193], v228 offset:2048
  v_mfma_f32_16x16x32_bf16 v[48:51], a[208:211], a[48:51], v[48:51]
  ds_read_b64_tr_b16 a[194:195], v228 offset:10240
  v_mfma_f32_16x16x32_bf16 v[52:55], a[208:211], a[52:55], v[52:55]
  buffer_load_dwordx4 v233, s[4:7], s29 offen offset:1024 lds
  v_mfma_f32_16x16x32_bf16 v[56:59], a[208:211], a[56:59], v[56:59]
  s_waitcnt lgkmcnt(10)
  ds_read_b64_tr_b16 a[196:197], v239 offset:2048
  v_mfma_f32_16x16x32_bf16 v[60:63], a[212:215], a[48:51], v[60:63]
  s_mov_b32 s29, 16128
  ds_read_b64_tr_b16 a[198:199], v239 offset:10240
  v_mfma_f32_16x16x32_bf16 v[64:67], a[212:215], a[52:55], v[64:67]
  ds_read_b64_tr_b16 a[200:201], v228 offset:2304
  v_mfma_f32_16x16x32_bf16 v[68:71], a[212:215], a[56:59], v[68:71]
  s_waitcnt lgkmcnt(7)
  ds_read_b64_tr_b16 a[202:203], v228 offset:10496
  v_mfma_f32_16x16x32_bf16 v[72:75], a[216:219], a[48:51], v[72:75]
  ds_read_b64_tr_b16 a[204:205], v239 offset:2304
  v_mfma_f32_16x16x32_bf16 v[76:79], a[216:219], a[52:55], v[76:79]
  ds_read_b64_tr_b16 a[206:207], v239 offset:10496
  v_mfma_f32_16x16x32_bf16 v[80:83], a[216:219], a[56:59], v[80:83]
  s_waitcnt lgkmcnt(8)
  v_mfma_f32_16x16x32_bf16 v[84:87], a[220:223], a[48:51], v[84:87]
  ds_read_b64_tr_b16 a[208:209], v228 offset:3072
  v_mfma_f32_16x16x32_bf16 v[88:91], a[220:223], a[52:55], v[88:91]
  buffer_load_dwordx4 v233, s[4:7], s29 offen offset:2048 lds
  v_mfma_f32_16x16x32_bf16 v[92:95], a[220:223], a[56:59], v[92:95]
  s_waitcnt lgkmcnt(7)
  ds_read_b64_tr_b16 a[210:211], v228 offset:11264
  v_mfma_f32_16x16x32_bf16 v[96:99], a[192:195], a[48:51], v[96:99]
  s_mov_b32 s29, 22272
  ds_read_b64_tr_b16 a[212:213], v239 offset:3072
  v_mfma_f32_16x16x32_bf16 v[100:103], a[192:195], a[52:55], v[100:103]
  ds_read_b64_tr_b16 a[214:215], v239 offset:11264
  v_mfma_f32_16x16x32_bf16 v[104:107], a[192:195], a[56:59], v[104:107]
  s_waitcnt lgkmcnt(8)
  v_mfma_f32_16x16x32_bf16 v[108:111], a[196:199], a[48:51], v[108:111]
  ds_read_b64_tr_b16 a[216:217], v228 offset:3328
  v_mfma_f32_16x16x32_bf16 v[112:115], a[196:199], a[52:55], v[112:115]
  buffer_load_dwordx4 v233, s[4:7], s29 offen offset:3072 lds
  v_mfma_f32_16x16x32_bf16 v[116:119], a[196:199], a[56:59], v[116:119]
  s_waitcnt lgkmcnt(7)
  ds_read_b64_tr_b16 a[218:219], v228 offset:11520
  v_mfma_f32_16x16x32_bf16 v[120:123], a[200:203], a[48:51], v[120:123]
  s_add_u32 m0, s28, 0
  ds_read_b64_tr_b16 a[220:221], v239 offset:3328
  v_mfma_f32_16x16x32_bf16 v[124:127], a[200:203], a[52:55], v[124:127]
  s_mov_b32 s29, 32512
  ds_read_b64_tr_b16 a[222:223], v239 offset:11520
  v_add_u32 v228, 65536, v230
  v_mfma_f32_16x16x32_bf16 v[128:131], a[200:203], a[56:59], v[128:131]
  s_waitcnt lgkmcnt(8)
  v_xor_b32 v239, 32, v228
  v_mfma_f32_16x16x32_bf16 v[132:135], a[204:207], a[48:51], v[132:135]
  ds_read_b64_tr_b16 a[192:193], v228 offset:0
  v_mfma_f32_16x16x32_bf16 v[136:139], a[204:207], a[52:55], v[136:139]
  ds_read_b64_tr_b16 a[194:195], v228 offset:8192
  v_mfma_f32_16x16x32_bf16 v[140:143], a[204:207], a[56:59], v[140:143]
  s_waitcnt lgkmcnt(8)
  v_mfma_f32_16x16x32_bf16 v[144:147], a[208:211], a[48:51], v[144:147]
  ds_read_b64_tr_b16 a[196:197], v239 offset:0
  v_mfma_f32_16x16x32_bf16 v[148:151], a[208:211], a[52:55], v[148:151]
  buffer_load_dwordx4 v233, s[4:7], s29 offen offset:0 lds
  v_mfma_f32_16x16x32_bf16 v[152:155], a[208:211], a[56:59], v[152:155]
  s_waitcnt lgkmcnt(7)
  ds_read_b64_tr_b16 a[198:199], v239 offset:8192
  v_mfma_f32_16x16x32_bf16 v[156:159], a[212:215], a[48:51], v[156:159]
  s_mov_b32 s29, 38656
  ds_read_b64_tr_b16 a[200:201], v228 offset:256
  v_mfma_f32_16x16x32_bf16 v[160:163], a[212:215], a[52:55], v[160:163]
  ds_read_b64_tr_b16 a[202:203], v228 offset:8448
  v_mfma_f32_16x16x32_bf16 v[164:167], a[212:215], a[56:59], v[164:167]
  s_waitcnt lgkmcnt(8)
  v_mfma_f32_16x16x32_bf16 a[224:227], a[216:219], a[48:51], a[224:227]
  ds_read_b64_tr_b16 a[204:205], v239 offset:256
  v_mfma_f32_16x16x32_bf16 a[228:231], a[216:219], a[52:55], a[228:231]
  buffer_load_dwordx4 v233, s[4:7], s29 offen offset:1024 lds
  v_mfma_f32_16x16x32_bf16 a[232:235], a[216:219], a[56:59], a[232:235]
  s_waitcnt lgkmcnt(7)
  ds_read_b64_tr_b16 a[206:207], v239 offset:8448
  v_mfma_f32_16x16x32_bf16 a[236:239], a[220:223], a[48:51], a[236:239]
  ds_read_b64_tr_b16 a[208:209], v228 offset:1024
  v_mfma_f32_16x16x32_bf16 a[240:243], a[220:223], a[52:55], a[240:243]
  ds_read_b64_tr_b16 a[210:211], v228 offset:9216
  v_mfma_f32_16x16x32_bf16 a[244:247], a[220:223], a[56:59], a[244:247]
  s_waitcnt lgkmcnt(8)
  v_mfma_f32_16x16x32_bf16 v[0:3], a[192:195], a[60:63], v[0:3]
  s_waitcnt vmcnt(10)
  ds_read_b64_tr_b16 a[212:213], v239 offset:1024
  v_mfma_f32_16x16x32_bf16 v[4:7], a[192:195], a[64:67], v[4:7]
  s_barrier
  ds_read_b64_tr_b16 a[214:215], v239 offset:9216
  v_mfma_f32_16x16x32_bf16 v[8:11], a[192:195], a[68:71], v[8:11]
  s_waitcnt lgkmcnt(8)
  v_mfma_f32_16x16x32_bf16 v[12:15], a[196:199], a[60:63], v[12:15]
  s_add_u32 m0, s28, 16384
  ds_read_b64_tr_b16 a[216:217], v228 offset:1280
  v_mfma_f32_16x16x32_bf16 v[16:19], a[196:199], a[64:67], v[16:19]
  s_mov_b32 s29, 3149312
  buffer_load_dwordx4 v232, s[16:19], s29 offen offset:0 lds
  v_mfma_f32_16x16x32_bf16 v[20:23], a[196:199], a[68:71], v[20:23]
  s_waitcnt lgkmcnt(7)
  ds_read_b64_tr_b16 a[218:219], v228 offset:9472
  v_mfma_f32_16x16x32_bf16 v[24:27], a[200:203], a[60:63], v[24:27]
  s_add_u32 s29, s29, s30
  ds_read_b64_tr_b16 a[220:221], v239 offset:1280
  v_mfma_f32_16x16x32_bf16 v[28:31], a[200:203], a[64:67], v[28:31]
  ds_read_b64_tr_b16 a[222:223], v239 offset:9472
  v_mfma_f32_16x16x32_bf16 v[32:35], a[200:203], a[68:71], v[32:35]
  s_waitcnt lgkmcnt(8)
  v_mfma_f32_16x16x32_bf16 v[36:39], a[204:207], a[60:63], v[36:39]
  ds_read_b64_tr_b16 a[192:193], v228 offset:2048
  v_mfma_f32_16x16x32_bf16 v[40:43], a[204:207], a[64:67], v[40:43]
  buffer_load_dwordx4 v232, s[16:19], s29 offen offset:1024 lds
  v_mfma_f32_16x16x32_bf16 v[44:47], a[204:207], a[68:71], v[44:47]
  s_waitcnt lgkmcnt(7)
  ds_read_b64_tr_b16 a[194:195], v228 offset:10240
  v_mfma_f32_16x16x32_bf16 v[48:51], a[208:211], a[60:63], v[48:51]
  s_add_u32 s29, s29, s30
  ds_read_b64_tr_b16 a[196:197], v239 offset:2048
  v_mfma_f32_16x16x32_bf16 v[52:55], a[208:211], a[64:67], v[52:55]
  ds_read_b64_tr_b16 a[198:199], v239 offset:10240
  v_mfma_f32_16x16x32_bf16 v[56:59], a[208:211], a[68:71], v[56:59]
  s_waitcnt lgkmcnt(8)
  v_mfma_f32_16x16x32_bf16 v[60:63], a[212:215], a[60:63], v[60:63]
  ds_read_b64_tr_b16 a[200:201], v228 offset:2304
  v_mfma_f32_16x16x32_bf16 v[64:67], a[212:215], a[64:67], v[64:67]
  buffer_load_dwordx4 v232, s[16:19], s29 offen offset:2048 lds
  v_mfma_f32_16x16x32_bf16 v[68:71], a[212:215], a[68:71], v[68:71]
  s_waitcnt lgkmcnt(7)
  ds_read_b64_tr_b16 a[202:203], v228 offset:10496
  v_mfma_f32_16x16x32_bf16 v[72:75], a[216:219], a[60:63], v[72:75]
  s_add_u32 s29, s29, s30
  ds_read_b64_tr_b16 a[204:205], v239 offset:2304
  v_mfma_f32_16x16x32_bf16 v[76:79], a[216:219], a[64:67], v[76:79]
  ds_read_b64_tr_b16 a[206:207], v239 offset:10496
  v_mfma_f32_16x16x32_bf16 v[80:83], a[216:219], a[68:71], v[80:83]
  s_waitcnt lgkmcnt(8)
  v_mfma_f32_16x16x32_bf16 v[84:87], a[220:223], a[60:63], v[84:87]
  ds_read_b64_tr_b16 a[208:209], v228 offset:3072
  v_mfma_f32_16x16x32_bf16 v[88:91], a[220:223], a[64:67], v[88:91]
  buffer_load_dwordx4 v232, s[16:19], s29 offen offset:3072 lds
  v_mfma_f32_16x16x32_bf16 v[92:95], a[220:223], a[68:71], v[92:95]
  s_waitcnt lgkmcnt(7)
  ds_read_b64_tr_b16 a[210:211], v228 offset:11264
  v_mfma_f32_16x16x32_bf16 v[96:99], a[192:195], a[60:63], v[96:99]
  s_add_u32 m0, s28, 32768
  ds_read_b64_tr_b16 a[212:213], v239 offset:3072
  v_mfma_f32_16x16x32_bf16 v[100:103], a[192:195], a[64:67], v[100:103]
  s_mov_b32 s29, 3411456
  ds_read_b64_tr_b16 a[214:215], v239 offset:11264
  v_mfma_f32_16x16x32_bf16 v[104:107], a[192:195], a[68:71], v[104:107]
  s_waitcnt lgkmcnt(8)
  v_mfma_f32_16x16x32_bf16 v[108:111], a[196:199], a[60:63], v[108:111]
  ds_read_b64_tr_b16 a[216:217], v228 offset:3328
  v_mfma_f32_16x16x32_bf16 v[112:115], a[196:199], a[64:67], v[112:115]
  buffer_load_dwordx4 v232, s[16:19], s29 offen offset:0 lds
  v_mfma_f32_16x16x32_bf16 v[116:119], a[196:199], a[68:71], v[116:119]
  s_waitcnt lgkmcnt(7)
  ds_read_b64_tr_b16 a[218:219], v228 offset:11520
  v_mfma_f32_16x16x32_bf16 v[120:123], a[200:203], a[60:63], v[120:123]
  s_add_u32 s29, s29, s30
  ds_read_b64_tr_b16 a[220:221], v239 offset:3328
  v_mfma_f32_16x16x32_bf16 v[124:127], a[200:203], a[64:67], v[124:127]
  ds_read_b64_tr_b16 a[222:223], v239 offset:11520
  v_add_u32 v228, 114688, v230
  v_mfma_f32_16x16x32_bf16 v[128:131], a[200:203], a[68:71], v[128:131]
  s_waitcnt lgkmcnt(8)
  v_xor_b32 v239, 32, v228
  v_mfma_f32_16x16x32_bf16 v[132:135], a[204:207], a[60:63], v[132:135]
  ds_read_b64_tr_b16 a[192:193], v228 offset:0
  v_mfma_f32_16x16x32_bf16 v[136:139], a[204:207], a[64:67], v[136:139]
  buffer_load_dwordx4 v232, s[16:19], s29 offen offset:1024 lds
  v_mfma_f32_16x16x32_bf16 v[140:143], a[204:207], a[68:71], v[140:143]
  s_waitcnt lgkmcnt(7)
  ds_read_b64_tr_b16 a[194:195], v228 offset:8192
  v_mfma_f32_16x16x32_bf16 v[144:147], a[208:211], a[60:63], v[144:147]
  s_add_u32 s29, s29, s30
  ds_read_b64_tr_b16 a[196:197], v239 offset:0
  v_mfma_f32_16x16x32_bf16 v[148:151], a[208:211], a[64:67], v[148:151]
  ds_read_b64_tr_b16 a[198:199], v239 offset:8192
  v_mfma_f32_16x16x32_bf16 v[152:155], a[208:211], a[68:71], v[152:155]
  s_waitcnt lgkmcnt(8)
  v_mfma_f32_16x16x32_bf16 v[156:159], a[212:215], a[60:63], v[156:159]
  ds_read_b64_tr_b16 a[200:201], v228 offset:256
  v_mfma_f32_16x16x32_bf16 v[160:163], a[212:215], a[64:67], v[160:163]
  buffer_load_dwordx4 v232, s[16:19], s29 offen offset:2048 lds
  v_mfma_f32_16x16x32_bf16 v[164:167], a[212:215], a[68:71], v[164:167]
  s_waitcnt lgkmcnt(7)
  ds_read_b64_tr_b16 a[202:203], v228 offset:8448
  v_mfma_f32_16x16x32_bf16 a[224:227], a[216:219], a[60:63], a[224:227]
  s_add_u32 s29, s29, s30
  ds_read_b64_tr_b16 a[204:205], v239 offset:256
  v_mfma_f32_16x16x32_bf16 a[228:231], a[216:219], a[64:67], a[228:231]
  ds_read_b64_tr_b16 a[206:207], v239 offset:8448
  v_mfma_f32_16x16x32_bf16 a[232:235], a[216:219], a[68:71], a[232:235]
  s_waitcnt lgkmcnt(8)
  v_mfma_f32_16x16x32_bf16 a[236:239], a[220:223], a[60:63], a[236:239]
  ds_read_b64_tr_b16 a[208:209], v228 offset:1024
  v_mfma_f32_16x16x32_bf16 a[240:243], a[220:223], a[64:67], a[240:243]
  buffer_load_dwordx4 v232, s[16:19], s29 offen offset:3072 lds
  v_mfma_f32_16x16x32_bf16 a[244:247], a[220:223], a[68:71], a[244:247]
  s_waitcnt lgkmcnt(7)
  ds_read_b64_tr_b16 a[210:211], v228 offset:9216
  v_mfma_f32_16x16x32_bf16 v[0:3], a[192:195], a[72:75], v[0:3]
  s_waitcnt vmcnt(8)
  ds_read_b64_tr_b16 a[212:213], v239 offset:1024
  v_mfma_f32_16x16x32_bf16 v[4:7], a[192:195], a[76:79], v[4:7]
  s_barrier
  ds_read_b64_tr_b16 a[214:215], v239 offset:9216
  v_add_u32 v238, 81920, v237
  v_mfma_f32_16x16x32_bf16 v[8:11], a[192:195], a[80:83], v[8:11]
  s_waitcnt lgkmcnt(8)
  ds_read_b128 v[168:171], v238 offset:0
  v_mfma_f32_16x16x32_bf16 v[12:15], a[196:199], a[72:75], v[12:15]
  s_add_u32 m0, s28, 65536
  ds_read_b128 v[180:183], v238 offset:256
  v_mfma_f32_16x16x32_bf16 v[16:19], a[196:199], a[76:79], v[16:19]
  s_mov_b32 s29, 297984
  ds_read_b128 v[172:175], v238 offset:2048
  v_mfma_f32_16x16x32_bf16 v[20:23], a[196:199], a[80:83], v[20:23]
  s_waitcnt lgkmcnt(9)
  ds_read_b128 v[184:187], v238 offset:2304
  v_add_u32 v238, 0, v237
  v_mfma_f32_16x16x32_bf16 v[24:27], a[200:203], a[72:75], v[24:27]
  ds_read_b128 v[176:179], v238 offset:0
  v_mfma_f32_16x16x32_bf16 v[28:31], a[200:203], a[76:79], v[28:31]
  buffer_load_dwordx4 v231, s[8:11], s29 offen offset:0 nt lds
  v_mfma_f32_16x16x32_bf16 v[32:35], a[200:203], a[80:83], v[32:35]
  s_waitcnt lgkmcnt(9)
  ds_read_b64_tr_b16 a[216:217], v228 offset:1280
  v_mfma_f32_16x16x32_bf16 v[36:39], a[204:207], a[72:75], v[36:39]
  s_add_u32 s29, s29, s30
  ds_read_b64_tr_b16 a[218:219], v228 offset:9472
  v_mfma_f32_16x16x32_bf16 v[40:43], a[204:207], a[76:79], v[40:43]
  ds_read_b64_tr_b16 a[220:221], v239 offset:1280
  v_mfma_f32_16x16x32_bf16 v[44:47], a[204:207], a[80:83], v[44:47]
  s_waitcnt lgkmcnt(10)
  ds_read_b64_tr_b16 a[222:223], v239 offset:9472
  v_mfma_f32_16x16x32_bf16 v[48:51], a[208:211], a[72:75], v[48:51]
  ds_read_b128 v[188:191], v238 offset:256
  v_mfma_f32_16x16x32_bf16 v[52:55], a[208:211], a[76:79], v[52:55]
  ds_read_b64_tr_b16 a[192:193], v228 offset:2048
  v_mfma_f32_16x16x32_bf16 v[56:59], a[208:211], a[80:83], v[56:59]
  s_waitcnt lgkmcnt(11)
  ds_read_b64_tr_b16 a[194:195], v228 offset:10240
  v_mfma_f32_16x16x32_bf16 v[60:63], a[212:215], a[72:75], v[60:63]
  ds_read_b64_tr_b16 a[196:197], v239 offset:2048
  v_mfma_f32_16x16x32_bf16 v[64:67], a[212:215], a[76:79], v[64:67]
  ds_read_b64_tr_b16 a[198:199], v239 offset:10240
  v_mfma_f32_16x16x32_bf16 v[68:71], a[212:215], a[80:83], v[68:71]
  s_waitcnt lgkmcnt(7)
  ds_read_b64_tr_b16 a[200:201], v228 offset:2304
  v_mfma_f32_16x16x32_bf16 v[72:75], a[216:219], a[72:75], v[72:75]
  ds_read_b64_tr_b16 a[202:203], v228 offset:10496
  v_mfma_f32_16x16x32_bf16 v[76:79], a[216:219], a[76:79], v[76:79]
  buffer_load_dwordx4 v231, s[8:11], s29 offen offset:1024 nt lds
  v_mfma_f32_16x16x32_bf16 v[80:83], a[216:219], a[80:83], v[80:83]
  s_waitcnt lgkmcnt(7)
  ds_read_b64_tr_b16 a[204:205], v239 offset:2304
  v_mfma_f32_16x16x32_bf16 v[84:87], a[220:223], a[72:75], v[84:87]
  s_add_u32 s29, s29, s30
  ds_read_b64_tr_b16 a[206:207], v239 offset:10496
  v_mfma_f32_16x16x32_bf16 v[88:91], a[220:223], a[76:79], v[88:91]
  ds_read_b64_tr_b16 a[208:209], v228 offset:3072
  v_mfma_f32_16x16x32_bf16 v[92:95], a[220:223], a[80:83], v[92:95]
  s_waitcnt lgkmcnt(7)
  ds_read_b64_tr_b16 a[210:211], v228 offset:11264
  v_mfma_f32_16x16x32_bf16 v[96:99], a[192:195], a[72:75], v[96:99]
  ds_read_b64_tr_b16 a[212:213], v239 offset:3072
  v_mfma_f32_16x16x32_bf16 v[100:103], a[192:195], a[76:79], v[100:103]
  ds_read_b64_tr_b16 a[214:215], v239 offset:11264
  v_mfma_f32_16x16x32_bf16 v[104:107], a[192:195], a[80:83], v[104:107]
  s_waitcnt lgkmcnt(8)
  v_mfma_f32_16x16x32_bf16 v[108:111], a[196:199], a[72:75], v[108:111]
  ds_read_b64_tr_b16 a[216:217], v228 offset:3328
  v_mfma_f32_16x16x32_bf16 v[112:115], a[196:199], a[76:79], v[112:115]
  ds_read_b64_tr_b16 a[218:219], v228 offset:11520
  v_mfma_f32_16x16x32_bf16 v[116:119], a[196:199], a[80:83], v[116:119]
  s_waitcnt lgkmcnt(8)
  v_mfma_f32_16x16x32_bf16 v[120:123], a[200:203], a[72:75], v[120:123]
  ds_read_b64_tr_b16 a[220:221], v239 offset:3328
  v_mfma_f32_16x16x32_bf16 v[124:127], a[200:203], a[76:79], v[124:127]
  buffer_load_dwordx4 v231, s[8:11], s29 offen offset:2048 nt lds
  v_mfma_f32_16x16x32_bf16 v[128:131], a[200:203], a[80:83], v[128:131]
  s_waitcnt lgkmcnt(7)
  ds_read_b64_tr_b16 a[222:223], v239 offset:11520
  v_add_u32 v228, 98304, v230
  v_mfma_f32_16x16x32_bf16 v[132:135], a[204:207], a[72:75], v[132:135]
  s_add_u32 s29, s29, s30
  ds_read_b64_tr_b16 a[192:193], v228 offset:0
  v_xor_b32 v239, 32, v228
  v_mfma_f32_16x16x32_bf16 v[136:139], a[204:207], a[76:79], v[136:139]
  ds_read_b64_tr_b16 a[194:195], v228 offset:8192
  v_mfma_f32_16x16x32_bf16 v[140:143], a[204:207], a[80:83], v[140:143]
  s_waitcnt lgkmcnt(8)
  v_mfma_f32_16x16x32_bf16 v[144:147], a[208:211], a[72:75], v[144:147]
  ds_read_b64_tr_b16 a[196:197], v239 offset:0
  v_mfma_f32_16x16x32_bf16 v[148:151], a[208:211], a[76:79], v[148:151]
  ds_read_b64_tr_b16 a[198:199], v239 offset:8192
  v_mfma_f32_16x16x32_bf16 v[152:155], a[208:211], a[80:83], v[152:155]
  s_waitcnt lgkmcnt(8)
  v_mfma_f32_16x16x32_bf16 v[156:159], a[212:215], a[72:75], v[156:159]
  ds_read_b64_tr_b16 a[200:201], v228 offset:256
  v_mfma_f32_16x16x32_bf16 v[160:163], a[212:215], a[76:79], v[160:163]
  ds_read_b64_tr_b16 a[202:203], v228 offset:8448
  v_mfma_f32_16x16x32_bf16 v[164:167], a[212:215], a[80:83], v[164:167]
  s_waitcnt lgkmcnt(8)
  v_mfma_f32_16x16x32_bf16 a[224:227], a[216:219], a[72:75], a[224:227]
  ds_read_b64_tr_b16 a[204:205], v239 offset:256
  v_mfma_f32_16x16x32_bf16 a[228:231], a[216:219], a[76:79], a[228:231]
  buffer_load_dwordx4 v231, s[8:11], s29 offen offset:3072 nt lds
  v_mfma_f32_16x16x32_bf16 a[232:235], a[216:219], a[80:83], a[232:235]
  s_waitcnt lgkmcnt(7)
  ds_read_b64_tr_b16 a[206:207], v239 offset:8448
  v_mfma_f32_16x16x32_bf16 a[236:239], a[220:223], a[72:75], a[236:239]
  ds_read_b64_tr_b16 a[208:209], v228 offset:1024
  v_mfma_f32_16x16x32_bf16 a[240:243], a[220:223], a[76:79], a[240:243]
  ds_read_b64_tr_b16 a[210:211], v228 offset:9216
  v_mfma_f32_16x16x32_bf16 a[244:247], a[220:223], a[80:83], a[244:247]
  s_waitcnt lgkmcnt(8)
  v_mfma_f32_16x16x32_bf16 v[0:3], a[192:195], a[84:87], v[0:3]
  s_waitcnt vmcnt(8)
  ds_read_b64_tr_b16 a[212:213], v239 offset:1024
  v_mfma_f32_16x16x32_bf16 v[4:7], a[192:195], a[88:91], v[4:7]
  s_barrier
  ds_read_b64_tr_b16 a[214:215], v239 offset:9216
  v_mfma_f32_16x16x32_bf16 v[8:11], a[192:195], a[92:95], v[8:11]
  s_waitcnt lgkmcnt(8)
  v_mfma_f32_16x16x32_bf16 v[12:15], a[196:199], a[84:87], v[12:15]
  s_add_u32 m0, s28, 114688
  ds_read_b64_tr_b16 a[216:217], v228 offset:1280
  v_mfma_f32_16x16x32_bf16 v[16:19], a[196:199], a[88:91], v[16:19]
  s_mov_b32 s29, 281600
  ds_read_b64_tr_b16 a[218:219], v228 offset:9472
  v_mfma_f32_16x16x32_bf16 v[20:23], a[196:199], a[92:95], v[20:23]
  s_waitcnt lgkmcnt(8)
  v_mfma_f32_16x16x32_bf16 v[24:27], a[200:203], a[84:87], v[24:27]
  ds_read_b64_tr_b16 a[220:221], v239 offset:1280
  v_mfma_f32_16x16x32_bf16 v[28:31], a[200:203], a[88:91], v[28:31]
  buffer_load_dwordx4 v231, s[12:15], s29 offen offset:0 nt lds
  v_mfma_f32_16x16x32_bf16 v[32:35], a[200:203], a[92:95], v[32:35]
  s_waitcnt lgkmcnt(7)
  ds_read_b64_tr_b16 a[222:223], v239 offset:9472
  v_mfma_f32_16x16x32_bf16 v[36:39], a[204:207], a[84:87], v[36:39]
  s_add_u32 s29, s29, s30
  ds_read_b64_tr_b16 a[192:193], v228 offset:2048
  v_mfma_f32_16x16x32_bf16 v[40:43], a[204:207], a[88:91], v[40:43]
  ds_read_b64_tr_b16 a[194:195], v228 offset:10240
  v_mfma_f32_16x16x32_bf16 v[44:47], a[204:207], a[92:95], v[44:47]
  s_waitcnt lgkmcnt(8)
  v_mfma_f32_16x16x32_bf16 v[48:51], a[208:211], a[84:87], v[48:51]
  ds_read_b64_tr_b16 a[196:197], v239 offset:2048
  v_mfma_f32_16x16x32_bf16 v[52:55], a[208:211], a[88:91], v[52:55]
  ds_read_b64_tr_b16 a[198:199], v239 offset:10240
  v_mfma_f32_16x16x32_bf16 v[56:59], a[208:211], a[92:95], v[56:59]
  s_waitcnt lgkmcnt(8)
  v_mfma_f32_16x16x32_bf16 v[60:63], a[212:215], a[84:87], v[60:63]
  ds_read_b64_tr_b16 a[200:201], v228 offset:2304
  v_mfma_f32_16x16x32_bf16 v[64:67], a[212:215], a[88:91], v[64:67]
  ds_read_b64_tr_b16 a[202:203], v228 offset:10496
  v_mfma_f32_16x16x32_bf16 v[68:71], a[212:215], a[92:95], v[68:71]
  s_waitcnt lgkmcnt(8)
  v_mfma_f32_16x16x32_bf16 v[72:75], a[216:219], a[84:87], v[72:75]
  ds_read_b64_tr_b16 a[204:205], v239 offset:2304
  v_mfma_f32_16x16x32_bf16 v[76:79], a[216:219], a[88:91], v[76:79]
  buffer_load_dwordx4 v231, s[12:15], s29 offen offset:1024 nt lds
  v_mfma_f32_16x16x32_bf16 v[80:83], a[216:219], a[92:95], v[80:83]
  s_waitcnt lgkmcnt(7)
  ds_read_b64_tr_b16 a[206:207], v239 offset:10496
  v_mfma_f32_16x16x32_bf16 v[84:87], a[220:223], a[84:87], v[84:87]
  s_add_u32 s29, s29, s30
  ds_read_b64_tr_b16 a[208:209], v228 offset:3072
  v_mfma_f32_16x16x32_bf16 v[88:91], a[220:223], a[88:91], v[88:91]
  ds_read_b64_tr_b16 a[210:211], v228 offset:11264
  v_mfma_f32_16x16x32_bf16 v[92:95], a[220:223], a[92:95], v[92:95]
  s_waitcnt lgkmcnt(8)
  v_mfma_f32_16x16x32_bf16 v[96:99], a[192:195], a[84:87], v[96:99]
  ds_read_b64_tr_b16 a[212:213], v239 offset:3072
  v_mfma_f32_16x16x32_bf16 v[100:103], a[192:195], a[88:91], v[100:103]
  ds_read_b64_tr_b16 a[214:215], v239 offset:11264
  v_mfma_f32_16x16x32_bf16 v[104:107], a[192:195], a[92:95], v[104:107]
  s_waitcnt lgkmcnt(8)
  v_mfma_f32_16x16x32_bf16 v[108:111], a[196:199], a[84:87], v[108:111]
  ds_read_b64_tr_b16 a[216:217], v228 offset:3328
  v_mfma_f32_16x16x32_bf16 v[112:115], a[196:199], a[88:91], v[112:115]
  ds_read_b64_tr_b16 a[218:219], v228 offset:11520
  v_mfma_f32_16x16x32_bf16 v[116:119], a[196:199], a[92:95], v[116:119]
  s_waitcnt lgkmcnt(8)
  v_mfma_f32_16x16x32_bf16 v[120:123], a[200:203], a[84:87], v[120:123]
  ds_read_b64_tr_b16 a[220:221], v239 offset:3328
  v_mfma_f32_16x16x32_bf16 v[124:127], a[200:203], a[88:91], v[124:127]
  buffer_load_dwordx4 v231, s[12:15], s29 offen offset:2048 nt lds
  v_mfma_f32_16x16x32_bf16 v[128:131], a[200:203], a[92:95], v[128:131]
  s_waitcnt lgkmcnt(7)
  ds_read_b64_tr_b16 a[222:223], v239 offset:11520
  v_add_u32 v228, 16384, v230
  v_mfma_f32_16x16x32_bf16 v[132:135], a[204:207], a[84:87], v[132:135]
  s_add_u32 s29, s29, s30
  ds_read_b64_tr_b16 a[192:193], v228 offset:0
  v_xor_b32 v239, 32, v228
  v_mfma_f32_16x16x32_bf16 v[136:139], a[204:207], a[88:91], v[136:139]
  ds_read_b64_tr_b16 a[194:195], v228 offset:8192
  v_mfma_f32_16x16x32_bf16 v[140:143], a[204:207], a[92:95], v[140:143]
  s_waitcnt lgkmcnt(8)
  v_mfma_f32_16x16x32_bf16 v[144:147], a[208:211], a[84:87], v[144:147]
  ds_read_b64_tr_b16 a[196:197], v239 offset:0
  v_mfma_f32_16x16x32_bf16 v[148:151], a[208:211], a[88:91], v[148:151]
  ds_read_b64_tr_b16 a[198:199], v239 offset:8192
  v_mfma_f32_16x16x32_bf16 v[152:155], a[208:211], a[92:95], v[152:155]
  s_waitcnt lgkmcnt(8)
  v_mfma_f32_16x16x32_bf16 v[156:159], a[212:215], a[84:87], v[156:159]
  ds_read_b64_tr_b16 a[200:201], v228 offset:256
  v_mfma_f32_16x16x32_bf16 v[160:163], a[212:215], a[88:91], v[160:163]
  ds_read_b64_tr_b16 a[202:203], v228 offset:8448
  v_mfma_f32_16x16x32_bf16 v[164:167], a[212:215], a[92:95], v[164:167]
  s_waitcnt lgkmcnt(8)
  v_mfma_f32_16x16x32_bf16 a[224:227], a[216:219], a[84:87], a[224:227]
  ds_read_b64_tr_b16 a[204:205], v239 offset:256
  v_mfma_f32_16x16x32_bf16 a[228:231], a[216:219], a[88:91], a[228:231]
  buffer_load_dwordx4 v231, s[12:15], s29 offen offset:3072 nt lds
  v_mfma_f32_16x16x32_bf16 a[232:235], a[216:219], a[92:95], a[232:235]
  s_waitcnt lgkmcnt(7)
  ds_read_b64_tr_b16 a[206:207], v239 offset:8448
  v_mfma_f32_16x16x32_bf16 a[236:239], a[220:223], a[84:87], a[236:239]
  ds_read_b64_tr_b16 a[208:209], v228 offset:1024
  v_mfma_f32_16x16x32_bf16 a[240:243], a[220:223], a[88:91], a[240:243]
  ds_read_b64_tr_b16 a[210:211], v228 offset:9216
  v_mfma_f32_16x16x32_bf16 a[244:247], a[220:223], a[92:95], a[244:247]
  s_waitcnt lgkmcnt(8)
  v_mfma_f32_16x16x32_bf16 v[0:3], a[192:195], v[168:171], v[0:3]
  s_waitcnt vmcnt(8)
  ds_read_b64_tr_b16 a[212:213], v239 offset:1024
  v_mfma_f32_16x16x32_bf16 v[4:7], a[192:195], v[172:175], v[4:7]
  s_barrier
  ds_read_b64_tr_b16 a[214:215], v239 offset:9216
  v_mfma_f32_16x16x32_bf16 v[8:11], a[192:195], v[176:179], v[8:11]
  s_waitcnt lgkmcnt(8)
  v_mfma_f32_16x16x32_bf16 v[12:15], a[196:199], v[168:171], v[12:15]
  s_add_u32 m0, s28, 81920
  ds_read_b64_tr_b16 a[216:217], v228 offset:1280
  v_mfma_f32_16x16x32_bf16 v[16:19], a[196:199], v[172:175], v[16:19]
  s_mov_b32 s29, 314368
  ds_read_b64_tr_b16 a[218:219], v228 offset:9472
  v_mfma_f32_16x16x32_bf16 v[20:23], a[196:199], v[176:179], v[20:23]
  s_waitcnt lgkmcnt(8)
  v_mfma_f32_16x16x32_bf16 v[24:27], a[200:203], v[168:171], v[24:27]
  ds_read_b64_tr_b16 a[220:221], v239 offset:1280
  v_mfma_f32_16x16x32_bf16 v[28:31], a[200:203], v[172:175], v[28:31]
  buffer_load_dwordx4 v231, s[8:11], s29 offen offset:0 nt lds
  v_mfma_f32_16x16x32_bf16 v[32:35], a[200:203], v[176:179], v[32:35]
  s_waitcnt lgkmcnt(7)
  ds_read_b64_tr_b16 a[222:223], v239 offset:9472
  v_mfma_f32_16x16x32_bf16 v[36:39], a[204:207], v[168:171], v[36:39]
  s_add_u32 s29, s29, s30
  ds_read_b64_tr_b16 a[192:193], v228 offset:2048
  v_mfma_f32_16x16x32_bf16 v[40:43], a[204:207], v[172:175], v[40:43]
  ds_read_b64_tr_b16 a[194:195], v228 offset:10240
  v_mfma_f32_16x16x32_bf16 v[44:47], a[204:207], v[176:179], v[44:47]
  s_waitcnt lgkmcnt(8)
  v_mfma_f32_16x16x32_bf16 v[48:51], a[208:211], v[168:171], v[48:51]
  ds_read_b64_tr_b16 a[196:197], v239 offset:2048
  v_mfma_f32_16x16x32_bf16 v[52:55], a[208:211], v[172:175], v[52:55]
  ds_read_b64_tr_b16 a[198:199], v239 offset:10240
  v_mfma_f32_16x16x32_bf16 v[56:59], a[208:211], v[176:179], v[56:59]
  s_waitcnt lgkmcnt(8)
  v_mfma_f32_16x16x32_bf16 v[60:63], a[212:215], v[168:171], v[60:63]
  ds_read_b64_tr_b16 a[200:201], v228 offset:2304
  v_mfma_f32_16x16x32_bf16 v[64:67], a[212:215], v[172:175], v[64:67]
  ds_read_b64_tr_b16 a[202:203], v228 offset:10496
  v_mfma_f32_16x16x32_bf16 v[68:71], a[212:215], v[176:179], v[68:71]
  s_waitcnt lgkmcnt(8)
  v_mfma_f32_16x16x32_bf16 v[72:75], a[216:219], v[168:171], v[72:75]
  ds_read_b64_tr_b16 a[204:205], v239 offset:2304
  v_mfma_f32_16x16x32_bf16 v[76:79], a[216:219], v[172:175], v[76:79]
  buffer_load_dwordx4 v231, s[8:11], s29 offen offset:1024 nt lds
  v_mfma_f32_16x16x32_bf16 v[80:83], a[216:219], v[176:179], v[80:83]
  s_waitcnt lgkmcnt(7)
  ds_read_b64_tr_b16 a[206:207], v239 offset:10496
  v_mfma_f32_16x16x32_bf16 v[84:87], a[220:223], v[168:171], v[84:87]
  s_add_u32 s29, s29, s30
  ds_read_b64_tr_b16 a[208:209], v228 offset:3072
  v_mfma_f32_16x16x32_bf16 v[88:91], a[220:223], v[172:175], v[88:91]
  ds_read_b64_tr_b16 a[210:211], v228 offset:11264
  v_mfma_f32_16x16x32_bf16 v[92:95], a[220:223], v[176:179], v[92:95]
  s_waitcnt lgkmcnt(8)
  v_mfma_f32_16x16x32_bf16 v[96:99], a[192:195], v[168:171], v[96:99]
  ds_read_b64_tr_b16 a[212:213], v239 offset:3072
  v_mfma_f32_16x16x32_bf16 v[100:103], a[192:195], v[172:175], v[100:103]
  ds_read_b64_tr_b16 a[214:215], v239 offset:11264
  v_mfma_f32_16x16x32_bf16 v[104:107], a[192:195], v[176:179], v[104:107]
  s_waitcnt lgkmcnt(8)
  v_mfma_f32_16x16x32_bf16 v[108:111], a[196:199], v[168:171], v[108:111]
  ds_read_b64_tr_b16 a[216:217], v228 offset:3328
  v_mfma_f32_16x16x32_bf16 v[112:115], a[196:199], v[172:175], v[112:115]
  ds_read_b64_tr_b16 a[218:219], v228 offset:11520
  v_mfma_f32_16x16x32_bf16 v[116:119], a[196:199], v[176:179], v[116:119]
  s_waitcnt lgkmcnt(8)
  v_mfma_f32_16x16x32_bf16 v[120:123], a[200:203], v[168:171], v[120:123]
  ds_read_b64_tr_b16 a[220:221], v239 offset:3328
  v_mfma_f32_16x16x32_bf16 v[124:127], a[200:203], v[172:175], v[124:127]
  buffer_load_dwordx4 v231, s[8:11], s29 offen offset:2048 nt lds
  v_mfma_f32_16x16x32_bf16 v[128:131], a[200:203], v[176:179], v[128:131]
  s_waitcnt lgkmcnt(7)
  ds_read_b64_tr_b16 a[222:223], v239 offset:11520
  v_add_u32 v228, 32768, v230
  v_mfma_f32_16x16x32_bf16 v[132:135], a[204:207], v[168:171], v[132:135]
  s_add_u32 s29, s29, s30
  ds_read_b64_tr_b16 a[192:193], v228 offset:0
  v_xor_b32 v239, 32, v228
  v_mfma_f32_16x16x32_bf16 v[136:139], a[204:207], v[172:175], v[136:139]
  ds_read_b64_tr_b16 a[194:195], v228 offset:8192
  v_mfma_f32_16x16x32_bf16 v[140:143], a[204:207], v[176:179], v[140:143]
  s_waitcnt lgkmcnt(8)
  v_mfma_f32_16x16x32_bf16 v[144:147], a[208:211], v[168:171], v[144:147]
  ds_read_b64_tr_b16 a[196:197], v239 offset:0
  v_mfma_f32_16x16x32_bf16 v[148:151], a[208:211], v[172:175], v[148:151]
  ds_read_b64_tr_b16 a[198:199], v239 offset:8192
  v_mfma_f32_16x16x32_bf16 v[152:155], a[208:211], v[176:179], v[152:155]
  s_waitcnt lgkmcnt(8)
  v_mfma_f32_16x16x32_bf16 v[156:159], a[212:215], v[168:171], v[156:159]
  ds_read_b64_tr_b16 a[200:201], v228 offset:256
  v_mfma_f32_16x16x32_bf16 v[160:163], a[212:215], v[172:175], v[160:163]
  ds_read_b64_tr_b16 a[202:203], v228 offset:8448
  v_mfma_f32_16x16x32_bf16 v[164:167], a[212:215], v[176:179], v[164:167]
  s_waitcnt lgkmcnt(8)
  v_mfma_f32_16x16x32_bf16 a[224:227], a[216:219], v[168:171], a[224:227]
  ds_read_b64_tr_b16 a[204:205], v239 offset:256
  v_mfma_f32_16x16x32_bf16 a[228:231], a[216:219], v[172:175], a[228:231]
  buffer_load_dwordx4 v231, s[8:11], s29 offen offset:3072 nt lds
  v_mfma_f32_16x16x32_bf16 a[232:235], a[216:219], v[176:179], a[232:235]
  s_waitcnt lgkmcnt(7)
  ds_read_b64_tr_b16 a[206:207], v239 offset:8448
  v_mfma_f32_16x16x32_bf16 a[236:239], a[220:223], v[168:171], a[236:239]
  ds_read_b64_tr_b16 a[208:209], v228 offset:1024
  v_mfma_f32_16x16x32_bf16 a[240:243], a[220:223], v[172:175], a[240:243]
  ds_read_b64_tr_b16 a[210:211], v228 offset:9216
  v_mfma_f32_16x16x32_bf16 a[244:247], a[220:223], v[176:179], a[244:247]
  s_waitcnt lgkmcnt(8)
  v_mfma_f32_16x16x32_bf16 v[0:3], a[192:195], v[180:183], v[0:3]
  s_waitcnt vmcnt(63)
  ds_read_b64_tr_b16 a[212:213], v239 offset:1024
  v_mfma_f32_16x16x32_bf16 v[4:7], a[192:195], v[184:187], v[4:7]
  s_barrier
  ds_read_b64_tr_b16 a[214:215], v239 offset:9216
  v_mfma_f32_16x16x32_bf16 v[8:11], a[192:195], v[188:191], v[8:11]
  s_waitcnt lgkmcnt(8)
  v_mfma_f32_16x16x32_bf16 v[12:15], a[196:199], v[180:183], v[12:15]
  s_add_u32 m0, s28, 0
  ds_read_b64_tr_b16 a[216:217], v228 offset:1280
  v_mfma_f32_16x16x32_bf16 v[16:19], a[196:199], v[184:187], v[16:19]
  s_mov_b32 s29, 297984
  ds_read_b64_tr_b16 a[218:219], v228 offset:9472
  v_mfma_f32_16x16x32_bf16 v[20:23], a[196:199], v[188:191], v[20:23]
  s_waitcnt lgkmcnt(8)
  v_mfma_f32_16x16x32_bf16 v[24:27], a[200:203], v[180:183], v[24:27]
  ds_read_b64_tr_b16 a[220:221], v239 offset:1280
  v_mfma_f32_16x16x32_bf16 v[28:31], a[200:203], v[184:187], v[28:31]
  buffer_load_dwordx4 v231, s[12:15], s29 offen offset:0 nt lds
  v_mfma_f32_16x16x32_bf16 v[32:35], a[200:203], v[188:191], v[32:35]
  s_waitcnt lgkmcnt(7)
  ds_read_b64_tr_b16 a[222:223], v239 offset:9472
  v_mfma_f32_16x16x32_bf16 v[36:39], a[204:207], v[180:183], v[36:39]
  s_add_u32 s29, s29, s30
  ds_read_b64_tr_b16 a[192:193], v228 offset:2048
  v_mfma_f32_16x16x32_bf16 v[40:43], a[204:207], v[184:187], v[40:43]
  ds_read_b64_tr_b16 a[194:195], v228 offset:10240
  v_mfma_f32_16x16x32_bf16 v[44:47], a[204:207], v[188:191], v[44:47]
  s_waitcnt lgkmcnt(8)
  v_mfma_f32_16x16x32_bf16 v[48:51], a[208:211], v[180:183], v[48:51]
  ds_read_b64_tr_b16 a[196:197], v239 offset:2048
  v_mfma_f32_16x16x32_bf16 v[52:55], a[208:211], v[184:187], v[52:55]
  ds_read_b64_tr_b16 a[198:199], v239 offset:10240
  v_mfma_f32_16x16x32_bf16 v[56:59], a[208:211], v[188:191], v[56:59]
  s_waitcnt lgkmcnt(8)
  v_mfma_f32_16x16x32_bf16 v[60:63], a[212:215], v[180:183], v[60:63]
  ds_read_b64_tr_b16 a[200:201], v228 offset:2304
  v_mfma_f32_16x16x32_bf16 v[64:67], a[212:215], v[184:187], v[64:67]
  ds_read_b64_tr_b16 a[202:203], v228 offset:10496
  v_mfma_f32_16x16x32_bf16 v[68:71], a[212:215], v[188:191], v[68:71]
  s_waitcnt lgkmcnt(8)
  v_mfma_f32_16x16x32_bf16 v[72:75], a[216:219], v[180:183], v[72:75]
  ds_read_b64_tr_b16 a[204:205], v239 offset:2304
  v_mfma_f32_16x16x32_bf16 v[76:79], a[216:219], v[184:187], v[76:79]
  buffer_load_dwordx4 v231, s[12:15], s29 offen offset:1024 nt lds
  v_mfma_f32_16x16x32_bf16 v[80:83], a[216:219], v[188:191], v[80:83]
  s_waitcnt lgkmcnt(7)
  ds_read_b64_tr_b16 a[206:207], v239 offset:10496
  v_mfma_f32_16x16x32_bf16 v[84:87], a[220:223], v[180:183], v[84:87]
  s_add_u32 s29, s29, s30
  ds_read_b64_tr_b16 a[208:209], v228 offset:3072
  v_mfma_f32_16x16x32_bf16 v[88:91], a[220:223], v[184:187], v[88:91]
  ds_read_b64_tr_b16 a[210:211], v228 offset:11264
  v_mfma_f32_16x16x32_bf16 v[92:95], a[220:223], v[188:191], v[92:95]
  s_waitcnt lgkmcnt(8)
  v_mfma_f32_16x16x32_bf16 v[96:99], a[192:195], v[180:183], v[96:99]
  ds_read_b64_tr_b16 a[212:213], v239 offset:3072
  v_mfma_f32_16x16x32_bf16 v[100:103], a[192:195], v[184:187], v[100:103]
  ds_read_b64_tr_b16 a[214:215], v239 offset:11264
  v_mfma_f32_16x16x32_bf16 v[104:107], a[192:195], v[188:191], v[104:107]
  s_waitcnt lgkmcnt(8)
  v_mfma_f32_16x16x32_bf16 v[108:111], a[196:199], v[180:183], v[108:111]
  ds_read_b64_tr_b16 a[216:217], v228 offset:3328
  v_mfma_f32_16x16x32_bf16 v[112:115], a[196:199], v[184:187], v[112:115]
  ds_read_b64_tr_b16 a[218:219], v228 offset:11520
  v_mfma_f32_16x16x32_bf16 v[116:119], a[196:199], v[188:191], v[116:119]
  s_waitcnt lgkmcnt(8)
  v_mfma_f32_16x16x32_bf16 v[120:123], a[200:203], v[180:183], v[120:123]
  ds_read_b64_tr_b16 a[220:221], v239 offset:3328
  v_mfma_f32_16x16x32_bf16 v[124:127], a[200:203], v[184:187], v[124:127]
  buffer_load_dwordx4 v231, s[12:15], s29 offen offset:2048 nt lds
  v_mfma_f32_16x16x32_bf16 v[128:131], a[200:203], v[188:191], v[128:131]
  s_waitcnt lgkmcnt(7)
  ds_read_b64_tr_b16 a[222:223], v239 offset:11520
  v_add_u32 v228, 147456, v229
  v_mfma_f32_16x16x32_bf16 v[132:135], a[204:207], v[180:183], v[132:135]
  s_add_u32 s29, s29, s30
  ds_read_b128 a[192:195], v228 offset:0
  v_mfma_f32_16x16x32_bf16 v[136:139], a[204:207], v[184:187], v[136:139]
  v_mfma_f32_16x16x32_bf16 v[140:143], a[204:207], v[188:191], v[140:143]
  s_waitcnt lgkmcnt(7)
  v_mfma_f32_16x16x32_bf16 v[144:147], a[208:211], v[180:183], v[144:147]
  ds_read_b128 a[196:199], v228 offset:256
  v_mfma_f32_16x16x32_bf16 v[148:151], a[208:211], v[184:187], v[148:151]
  v_mfma_f32_16x16x32_bf16 v[152:155], a[208:211], v[188:191], v[152:155]
  s_waitcnt lgkmcnt(6)
  v_mfma_f32_16x16x32_bf16 v[156:159], a[212:215], v[180:183], v[156:159]
  ds_read_b128 a[200:203], v228 offset:1024
  v_mfma_f32_16x16x32_bf16 v[160:163], a[212:215], v[184:187], v[160:163]
  v_mfma_f32_16x16x32_bf16 v[164:167], a[212:215], v[188:191], v[164:167]
  s_waitcnt lgkmcnt(5)
  v_mfma_f32_16x16x32_bf16 a[224:227], a[216:219], v[180:183], a[224:227]
  ds_read_b128 a[204:207], v228 offset:1280
  v_mfma_f32_16x16x32_bf16 a[228:231], a[216:219], v[184:187], a[228:231]
  buffer_load_dwordx4 v231, s[12:15], s29 offen offset:3072 nt lds
  v_mfma_f32_16x16x32_bf16 a[232:235], a[216:219], v[188:191], a[232:235]
  s_waitcnt lgkmcnt(4)
  v_mfma_f32_16x16x32_bf16 a[236:239], a[220:223], v[180:183], a[236:239]
  ds_read_b128 a[208:211], v228 offset:2048
  v_mfma_f32_16x16x32_bf16 a[240:243], a[220:223], v[184:187], a[240:243]
  v_mfma_f32_16x16x32_bf16 a[244:247], a[220:223], v[188:191], a[244:247]
  buffer_load_dwordx4 a[252:255], v247, s[88:91], 0 offen offset:0
  v_mbcnt_lo_u32_b32 v240, -1, 0
  v_mbcnt_hi_u32_b32 v240, -1, v240
  v_lshrrev_b32 v241, 5, v240
  v_bfe_u32 v244, v240, 2, 2
  v_lshl_add_u32 v244, v241, 2, v244
  v_lshlrev_b32 v241, 1, v241
  v_xor_b32 v241, v241, v240
  v_and_b32 v241, 3, v241
  v_lshlrev_b32 v245, 4, v241
  v_bfe_u32 v241, v240, 4, 1
  v_lshl_add_u32 v245, v241, 6, v245
  s_lshl_b32 s36, s34, 5
  v_add_u32 v241, s36, v244
  v_mul_u32_u24 v241, 896, v241
  v_add_u32 v232, v241, v245
  s_barrier
.p2align 3
  s_add_u32 m0, s28, 98304
  s_mov_b32 s29, 330752
  buffer_load_dwordx4 v231, s[8:11], s29 offen offset:0 nt lds
.p2align 3
  v_pk_mul_f32 v[0:1], v[0:1], s[44:45]
  v_pk_mul_f32 v[2:3], v[2:3], s[44:45]
  v_pk_mul_f32 v[12:13], v[12:13], s[44:45]
  v_pk_mul_f32 v[14:15], v[14:15], s[44:45]
  v_cvt_pk_bf16_f32 v0, v0, v1
  v_cvt_pk_bf16_f32 v1, v2, v3
  v_cvt_pk_bf16_f32 v12, v12, v13
  v_cvt_pk_bf16_f32 v13, v14, v15
  v_pk_mul_f32 v[4:5], v[4:5], s[44:45]
  v_pk_mul_f32 v[6:7], v[6:7], s[44:45]
  v_pk_mul_f32 v[16:17], v[16:17], s[44:45]
  v_pk_mul_f32 v[18:19], v[18:19], s[44:45]
  v_permlane32_swap_b32 v0, v12
  v_permlane32_swap_b32 v1, v13
  v_cvt_pk_bf16_f32 v4, v4, v5
  v_cvt_pk_bf16_f32 v5, v6, v7
  v_cvt_pk_bf16_f32 v16, v16, v17
  v_cvt_pk_bf16_f32 v17, v18, v19
  v_permlane16_swap_b32 v0, v12
  v_permlane16_swap_b32 v1, v13
  v_pk_mul_f32 v[8:9], v[8:9], s[44:45]
  v_pk_mul_f32 v[10:11], v[10:11], s[44:45]
  v_pk_mul_f32 v[20:21], v[20:21], s[44:45]
  v_pk_mul_f32 v[22:23], v[22:23], s[44:45]
  v_permlane32_swap_b32 v4, v16
  v_permlane32_swap_b32 v5, v17
  v_cvt_pk_bf16_f32 v8, v8, v9
  v_cvt_pk_bf16_f32 v9, v10, v11
  v_cvt_pk_bf16_f32 v20, v20, v21
  v_cvt_pk_bf16_f32 v21, v22, v23
  v_permlane16_swap_b32 v4, v16
  v_permlane16_swap_b32 v5, v17
  v_accvgpr_write_b32 a0, v0
  v_accvgpr_write_b32 a1, v1
  v_accvgpr_write_b32 a2, v12
  v_accvgpr_write_b32 a3, v13
  v_pk_mul_f32 v[24:25], v[24:25], s[44:45]
  v_pk_mul_f32 v[26:27], v[26:27], s[44:45]
  v_pk_mul_f32 v[36:37], v[36:37], s[44:45]
  v_pk_mul_f32 v[38:39], v[38:39], s[44:45]
  v_permlane32_swap_b32 v8, v20
  v_permlane32_swap_b32 v9, v21
  v_cvt_pk_bf16_f32 v24, v24, v25
  v_cvt_pk_bf16_f32 v25, v26, v27
  v_cvt_pk_bf16_f32 v36, v36, v37
  v_cvt_pk_bf16_f32 v37, v38, v39
  v_permlane16_swap_b32 v8, v20
  v_permlane16_swap_b32 v9, v21
  s_add_u32 s29, s29, s30
  buffer_load_dwordx4 v231, s[8:11], s29 offen offset:1024 nt lds
.p2align 3
  v_accvgpr_write_b32 a4, v4
  v_accvgpr_write_b32 a5, v5
  v_accvgpr_write_b32 a6, v16
  v_accvgpr_write_b32 a7, v17
  v_pk_mul_f32 v[28:29], v[28:29], s[44:45]
  v_pk_mul_f32 v[30:31], v[30:31], s[44:45]
  v_pk_mul_f32 v[40:41], v[40:41], s[44:45]
  v_pk_mul_f32 v[42:43], v[42:43], s[44:45]
  v_permlane32_swap_b32 v24, v36
  v_permlane32_swap_b32 v25, v37
  v_cvt_pk_bf16_f32 v28, v28, v29
  v_cvt_pk_bf16_f32 v29, v30, v31
  v_cvt_pk_bf16_f32 v40, v40, v41
  v_cvt_pk_bf16_f32 v41, v42, v43
  v_permlane16_swap_b32 v24, v36
  v_permlane16_swap_b32 v25, v37
  v_accvgpr_write_b32 a8, v8
  v_accvgpr_write_b32 a9, v9
  v_accvgpr_write_b32 a10, v20
  v_accvgpr_write_b32 a11, v21
  v_pk_mul_f32 v[32:33], v[32:33], s[44:45]
  v_pk_mul_f32 v[34:35], v[34:35], s[44:45]
  v_pk_mul_f32 v[44:45], v[44:45], s[44:45]
  v_pk_mul_f32 v[46:47], v[46:47], s[44:45]
  v_permlane32_swap_b32 v28, v40
  v_permlane32_swap_b32 v29, v41
  v_cvt_pk_bf16_f32 v32, v32, v33
  v_cvt_pk_bf16_f32 v33, v34, v35
  v_cvt_pk_bf16_f32 v44, v44, v45
  v_cvt_pk_bf16_f32 v45, v46, v47
  v_permlane16_swap_b32 v28, v40
  v_permlane16_swap_b32 v29, v41
  v_accvgpr_write_b32 a12, v24
  v_accvgpr_write_b32 a13, v25
  v_accvgpr_write_b32 a14, v36
  v_accvgpr_write_b32 a15, v37
  v_pk_mul_f32 v[48:49], v[48:49], s[44:45]
  v_pk_mul_f32 v[50:51], v[50:51], s[44:45]
  v_pk_mul_f32 v[60:61], v[60:61], s[44:45]
  v_pk_mul_f32 v[62:63], v[62:63], s[44:45]
  v_permlane32_swap_b32 v32, v44
  v_permlane32_swap_b32 v33, v45
  v_cvt_pk_bf16_f32 v48, v48, v49
  v_cvt_pk_bf16_f32 v49, v50, v51
  v_cvt_pk_bf16_f32 v60, v60, v61
  v_cvt_pk_bf16_f32 v61, v62, v63
  v_permlane16_swap_b32 v32, v44
  v_permlane16_swap_b32 v33, v45
  s_add_u32 s29, s29, s30
  buffer_load_dwordx4 v231, s[8:11], s29 offen offset:2048 nt lds
.p2align 3
  v_accvgpr_write_b32 a16, v28
  v_accvgpr_write_b32 a17, v29
  v_accvgpr_write_b32 a18, v40
  v_accvgpr_write_b32 a19, v41
  v_pk_mul_f32 v[52:53], v[52:53], s[44:45]
  v_pk_mul_f32 v[54:55], v[54:55], s[44:45]
  v_pk_mul_f32 v[64:65], v[64:65], s[44:45]
  v_pk_mul_f32 v[66:67], v[66:67], s[44:45]
  v_permlane32_swap_b32 v48, v60
  v_permlane32_swap_b32 v49, v61
  v_cvt_pk_bf16_f32 v52, v52, v53
  v_cvt_pk_bf16_f32 v53, v54, v55
  v_cvt_pk_bf16_f32 v64, v64, v65
  v_cvt_pk_bf16_f32 v65, v66, v67
  v_permlane16_swap_b32 v48, v60
  v_permlane16_swap_b32 v49, v61
  v_accvgpr_write_b32 a20, v32
  v_accvgpr_write_b32 a21, v33
  v_accvgpr_write_b32 a22, v44
  v_accvgpr_write_b32 a23, v45
  v_pk_mul_f32 v[56:57], v[56:57], s[44:45]
  v_pk_mul_f32 v[58:59], v[58:59], s[44:45]
  v_pk_mul_f32 v[68:69], v[68:69], s[44:45]
  v_pk_mul_f32 v[70:71], v[70:71], s[44:45]
  v_permlane32_swap_b32 v52, v64
  v_permlane32_swap_b32 v53, v65
  v_cvt_pk_bf16_f32 v56, v56, v57
  v_cvt_pk_bf16_f32 v57, v58, v59
  v_cvt_pk_bf16_f32 v68, v68, v69
  v_cvt_pk_bf16_f32 v69, v70, v71
  v_permlane16_swap_b32 v52, v64
  v_permlane16_swap_b32 v53, v65
  v_accvgpr_write_b32 a24, v48
  v_accvgpr_write_b32 a25, v49
  v_accvgpr_write_b32 a26, v60
  v_accvgpr_write_b32 a27, v61
  v_pk_mul_f32 v[72:73], v[72:73], s[44:45]
  v_pk_mul_f32 v[74:75], v[74:75], s[44:45]
  v_pk_mul_f32 v[84:85], v[84:85], s[44:45]
  v_pk_mul_f32 v[86:87], v[86:87], s[44:45]
  v_permlane32_swap_b32 v56, v68
  v_permlane32_swap_b32 v57, v69
  v_cvt_pk_bf16_f32 v72, v72, v73
  v_cvt_pk_bf16_f32 v73, v74, v75
  v_cvt_pk_bf16_f32 v84, v84, v85
  v_cvt_pk_bf16_f32 v85, v86, v87
  v_permlane16_swap_b32 v56, v68
  v_permlane16_swap_b32 v57, v69
  v_accvgpr_write_b32 a28, v52
  s_add_u32 s29, s29, s30
  buffer_load_dwordx4 v231, s[8:11], s29 offen offset:3072 nt lds
.p2align 3
  v_accvgpr_write_b32 a29, v53
  v_accvgpr_write_b32 a30, v64
  v_accvgpr_write_b32 a31, v65
  v_pk_mul_f32 v[76:77], v[76:77], s[44:45]
  v_pk_mul_f32 v[78:79], v[78:79], s[44:45]
  v_pk_mul_f32 v[88:89], v[88:89], s[44:45]
  v_pk_mul_f32 v[90:91], v[90:91], s[44:45]
  v_permlane32_swap_b32 v72, v84
  v_permlane32_swap_b32 v73, v85
  v_cvt_pk_bf16_f32 v76, v76, v77
  v_cvt_pk_bf16_f32 v77, v78, v79
  v_cvt_pk_bf16_f32 v88, v88, v89
  v_cvt_pk_bf16_f32 v89, v90, v91
  v_permlane16_swap_b32 v72, v84
  v_permlane16_swap_b32 v73, v85
  v_accvgpr_write_b32 a32, v56
  v_accvgpr_write_b32 a33, v57
  v_accvgpr_write_b32 a34, v68
  v_accvgpr_write_b32 a35, v69
  v_pk_mul_f32 v[80:81], v[80:81], s[44:45]
  v_pk_mul_f32 v[82:83], v[82:83], s[44:45]
  v_pk_mul_f32 v[92:93], v[92:93], s[44:45]
  v_pk_mul_f32 v[94:95], v[94:95], s[44:45]
  v_permlane32_swap_b32 v76, v88
  v_permlane32_swap_b32 v77, v89
  v_cvt_pk_bf16_f32 v80, v80, v81
  v_cvt_pk_bf16_f32 v81, v82, v83
  v_cvt_pk_bf16_f32 v92, v92, v93
  v_cvt_pk_bf16_f32 v93, v94, v95
  v_permlane16_swap_b32 v76, v88
  v_permlane16_swap_b32 v77, v89
  v_accvgpr_write_b32 a36, v72
  v_accvgpr_write_b32 a37, v73
  v_accvgpr_write_b32 a38, v84
  v_accvgpr_write_b32 a39, v85
  v_pk_mul_f32 v[96:97], v[96:97], s[44:45]
  v_pk_mul_f32 v[98:99], v[98:99], s[44:45]
  v_pk_mul_f32 v[108:109], v[108:109], s[44:45]
  v_pk_mul_f32 v[110:111], v[110:111], s[44:45]
  v_permlane32_swap_b32 v80, v92
  v_permlane32_swap_b32 v81, v93
  v_cvt_pk_bf16_f32 v96, v96, v97
  v_cvt_pk_bf16_f32 v97, v98, v99
  v_cvt_pk_bf16_f32 v108, v108, v109
  v_cvt_pk_bf16_f32 v109, v110, v111
  v_permlane16_swap_b32 v80, v92
  v_permlane16_swap_b32 v81, v93
  v_accvgpr_write_b32 a40, v76
  s_add_u32 m0, s28, 16384
  s_mov_b32 s29, 314368
  buffer_load_dwordx4 v231, s[12:15], s29 offen offset:0 nt lds
.p2align 3
  v_accvgpr_write_b32 a41, v77
  v_accvgpr_write_b32 a42, v88
  v_accvgpr_write_b32 a43, v89
  v_pk_mul_f32 v[100:101], v[100:101], s[44:45]
  v_pk_mul_f32 v[102:103], v[102:103], s[44:45]
  v_pk_mul_f32 v[112:113], v[112:113], s[44:45]
  v_pk_mul_f32 v[114:115], v[114:115], s[44:45]
  v_permlane32_swap_b32 v96, v108
  v_permlane32_swap_b32 v97, v109
  v_cvt_pk_bf16_f32 v100, v100, v101
  v_cvt_pk_bf16_f32 v101, v102, v103
  v_cvt_pk_bf16_f32 v112, v112, v113
  v_cvt_pk_bf16_f32 v113, v114, v115
  v_permlane16_swap_b32 v96, v108
  v_permlane16_swap_b32 v97, v109
  v_accvgpr_write_b32 a44, v80
  v_accvgpr_write_b32 a45, v81
  v_accvgpr_write_b32 a46, v92
  v_accvgpr_write_b32 a47, v93
  v_pk_mul_f32 v[104:105], v[104:105], s[44:45]
  v_pk_mul_f32 v[106:107], v[106:107], s[44:45]
  v_pk_mul_f32 v[116:117], v[116:117], s[44:45]
  v_pk_mul_f32 v[118:119], v[118:119], s[44:45]
  v_permlane32_swap_b32 v100, v112
  v_permlane32_swap_b32 v101, v113
  v_cvt_pk_bf16_f32 v104, v104, v105
  v_cvt_pk_bf16_f32 v105, v106, v107
  v_cvt_pk_bf16_f32 v116, v116, v117
  v_cvt_pk_bf16_f32 v117, v118, v119
  v_permlane16_swap_b32 v100, v112
  v_permlane16_swap_b32 v101, v113
  v_accvgpr_write_b32 a48, v96
  v_accvgpr_write_b32 a49, v97
  v_accvgpr_write_b32 a50, v108
  v_accvgpr_write_b32 a51, v109
  v_pk_mul_f32 v[120:121], v[120:121], s[44:45]
  v_pk_mul_f32 v[122:123], v[122:123], s[44:45]
  v_pk_mul_f32 v[132:133], v[132:133], s[44:45]
  v_pk_mul_f32 v[134:135], v[134:135], s[44:45]
  v_permlane32_swap_b32 v104, v116
  v_permlane32_swap_b32 v105, v117
  v_cvt_pk_bf16_f32 v120, v120, v121
  v_cvt_pk_bf16_f32 v121, v122, v123
  v_cvt_pk_bf16_f32 v132, v132, v133
  v_cvt_pk_bf16_f32 v133, v134, v135
  v_permlane16_swap_b32 v104, v116
  v_permlane16_swap_b32 v105, v117
  v_accvgpr_write_b32 a52, v100
  v_accvgpr_write_b32 a53, v101
  s_add_u32 s29, s29, s30
  buffer_load_dwordx4 v231, s[12:15], s29 offen offset:1024 nt lds
.p2align 3
  v_accvgpr_write_b32 a54, v112
  v_accvgpr_write_b32 a55, v113
  v_pk_mul_f32 v[124:125], v[124:125], s[44:45]
  v_pk_mul_f32 v[126:127], v[126:127], s[44:45]
  v_pk_mul_f32 v[136:137], v[136:137], s[44:45]
  v_pk_mul_f32 v[138:139], v[138:139], s[44:45]
  v_permlane32_swap_b32 v120, v132
  v_permlane32_swap_b32 v121, v133
  v_cvt_pk_bf16_f32 v124, v124, v125
  v_cvt_pk_bf16_f32 v125, v126, v127
  v_cvt_pk_bf16_f32 v136, v136, v137
  v_cvt_pk_bf16_f32 v137, v138, v139
  v_permlane16_swap_b32 v120, v132
  v_permlane16_swap_b32 v121, v133
  v_accvgpr_write_b32 a56, v104
  v_accvgpr_write_b32 a57, v105
  v_accvgpr_write_b32 a58, v116
  v_accvgpr_write_b32 a59, v117
  v_pk_mul_f32 v[128:129], v[128:129], s[44:45]
  v_pk_mul_f32 v[130:131], v[130:131], s[44:45]
  v_pk_mul_f32 v[140:141], v[140:141], s[44:45]
  v_pk_mul_f32 v[142:143], v[142:143], s[44:45]
  v_permlane32_swap_b32 v124, v136
  v_permlane32_swap_b32 v125, v137
  v_cvt_pk_bf16_f32 v128, v128, v129
  v_cvt_pk_bf16_f32 v129, v130, v131
  v_cvt_pk_bf16_f32 v140, v140, v141
  v_cvt_pk_bf16_f32 v141, v142, v143
  v_permlane16_swap_b32 v124, v136
  v_permlane16_swap_b32 v125, v137
  v_accvgpr_write_b32 a60, v120
  v_accvgpr_write_b32 a61, v121
  v_accvgpr_write_b32 a62, v132
  v_accvgpr_write_b32 a63, v133
  v_pk_mul_f32 v[144:145], v[144:145], s[44:45]
  v_pk_mul_f32 v[146:147], v[146:147], s[44:45]
  v_pk_mul_f32 v[156:157], v[156:157], s[44:45]
  v_pk_mul_f32 v[158:159], v[158:159], s[44:45]
  v_permlane32_swap_b32 v128, v140
  v_permlane32_swap_b32 v129, v141
  v_cvt_pk_bf16_f32 v144, v144, v145
  v_cvt_pk_bf16_f32 v145, v146, v147
  v_cvt_pk_bf16_f32 v156, v156, v157
  v_cvt_pk_bf16_f32 v157, v158, v159
  v_permlane16_swap_b32 v128, v140
  v_permlane16_swap_b32 v129, v141
  v_accvgpr_write_b32 a64, v124
  v_accvgpr_write_b32 a65, v125
  s_add_u32 s29, s29, s30
  buffer_load_dwordx4 v231, s[12:15], s29 offen offset:2048 nt lds
.p2align 3
  v_accvgpr_write_b32 a66, v136
  v_accvgpr_write_b32 a67, v137
  v_pk_mul_f32 v[148:149], v[148:149], s[44:45]
  v_pk_mul_f32 v[150:151], v[150:151], s[44:45]
  v_pk_mul_f32 v[160:161], v[160:161], s[44:45]
  v_pk_mul_f32 v[162:163], v[162:163], s[44:45]
  v_permlane32_swap_b32 v144, v156
  v_permlane32_swap_b32 v145, v157
  v_cvt_pk_bf16_f32 v148, v148, v149
  v_cvt_pk_bf16_f32 v149, v150, v151
  v_cvt_pk_bf16_f32 v160, v160, v161
  v_cvt_pk_bf16_f32 v161, v162, v163
  v_permlane16_swap_b32 v144, v156
  v_permlane16_swap_b32 v145, v157
  v_accvgpr_write_b32 a68, v128
  v_accvgpr_write_b32 a69, v129
  v_accvgpr_write_b32 a70, v140
  v_accvgpr_write_b32 a71, v141
  v_pk_mul_f32 v[152:153], v[152:153], s[44:45]
  v_pk_mul_f32 v[154:155], v[154:155], s[44:45]
  v_pk_mul_f32 v[164:165], v[164:165], s[44:45]
  v_pk_mul_f32 v[166:167], v[166:167], s[44:45]
  v_permlane32_swap_b32 v148, v160
  v_permlane32_swap_b32 v149, v161
  v_cvt_pk_bf16_f32 v152, v152, v153
  v_cvt_pk_bf16_f32 v153, v154, v155
  v_cvt_pk_bf16_f32 v164, v164, v165
  v_cvt_pk_bf16_f32 v165, v166, v167
  v_permlane16_swap_b32 v148, v160
  v_permlane16_swap_b32 v149, v161
  v_accvgpr_write_b32 a72, v144
  v_accvgpr_write_b32 a73, v145
  v_accvgpr_write_b32 a74, v156
  v_accvgpr_write_b32 a75, v157
  v_accvgpr_read_b32 v0, a224
  v_accvgpr_read_b32 v1, a225
  v_accvgpr_read_b32 v2, a226
  v_accvgpr_read_b32 v3, a227
  v_accvgpr_read_b32 v12, a236
  v_accvgpr_read_b32 v13, a237
  v_accvgpr_read_b32 v14, a238
  v_accvgpr_read_b32 v15, a239
  v_permlane32_swap_b32 v152, v164
  v_permlane32_swap_b32 v153, v165
  v_pk_mul_f32 v[0:1], v[0:1], s[44:45]
  v_pk_mul_f32 v[2:3], v[2:3], s[44:45]
  v_pk_mul_f32 v[12:13], v[12:13], s[44:45]
  v_pk_mul_f32 v[14:15], v[14:15], s[44:45]
  v_cvt_pk_bf16_f32 v0, v0, v1
  s_add_u32 s29, s29, s30
  buffer_load_dwordx4 v231, s[12:15], s29 offen offset:3072 nt lds
.p2align 3
  v_cvt_pk_bf16_f32 v1, v2, v3
  v_cvt_pk_bf16_f32 v12, v12, v13
  v_cvt_pk_bf16_f32 v13, v14, v15
  v_permlane16_swap_b32 v152, v164
  v_permlane16_swap_b32 v153, v165
  v_accvgpr_write_b32 a76, v148
  v_accvgpr_write_b32 a77, v149
  v_accvgpr_write_b32 a78, v160
  v_accvgpr_write_b32 a79, v161
  v_accvgpr_read_b32 v24, a228
  v_accvgpr_read_b32 v25, a229
  v_accvgpr_read_b32 v26, a230
  v_accvgpr_read_b32 v27, a231
  v_accvgpr_read_b32 v36, a240
  v_accvgpr_read_b32 v37, a241
  v_accvgpr_read_b32 v38, a242
  v_accvgpr_read_b32 v39, a243
  v_permlane32_swap_b32 v0, v12
  v_permlane32_swap_b32 v1, v13
  v_pk_mul_f32 v[24:25], v[24:25], s[44:45]
  v_pk_mul_f32 v[26:27], v[26:27], s[44:45]
  v_pk_mul_f32 v[36:37], v[36:37], s[44:45]
  v_pk_mul_f32 v[38:39], v[38:39], s[44:45]
  v_cvt_pk_bf16_f32 v24, v24, v25
  v_cvt_pk_bf16_f32 v25, v26, v27
  v_cvt_pk_bf16_f32 v36, v36, v37
  v_cvt_pk_bf16_f32 v37, v38, v39
  v_permlane16_swap_b32 v0, v12
  v_permlane16_swap_b32 v1, v13
  v_accvgpr_write_b32 a80, v152
  v_accvgpr_write_b32 a81, v153
  v_accvgpr_write_b32 a82, v164
  v_accvgpr_write_b32 a83, v165
  v_accvgpr_read_b32 v48, a232
  v_accvgpr_read_b32 v49, a233
  v_accvgpr_read_b32 v50, a234
  v_accvgpr_read_b32 v51, a235
  v_accvgpr_read_b32 v60, a244
  v_accvgpr_read_b32 v61, a245
  v_accvgpr_read_b32 v62, a246
  v_accvgpr_read_b32 v63, a247
  v_permlane32_swap_b32 v24, v36
  v_permlane32_swap_b32 v25, v37
  v_pk_mul_f32 v[48:49], v[48:49], s[44:45]
  v_pk_mul_f32 v[50:51], v[50:51], s[44:45]
  v_pk_mul_f32 v[60:61], v[60:61], s[44:45]
  v_pk_mul_f32 v[62:63], v[62:63], s[44:45]
  v_cvt_pk_bf16_f32 v48, v48, v49
  v_cvt_pk_bf16_f32 v49, v50, v51
  v_cvt_pk_bf16_f32 v60, v60, v61
  v_cvt_pk_bf16_f32 v61, v62, v63
  v_permlane16_swap_b32 v24, v36
  v_permlane16_swap_b32 v25, v37
  v_accvgpr_write_b32 a84, v0
  v_accvgpr_write_b32 a85, v1
  v_accvgpr_write_b32 a86, v12
  v_accvgpr_write_b32 a87, v13
  v_permlane32_swap_b32 v48, v60
  v_permlane32_swap_b32 v49, v61
  s_nop 0
  v_permlane16_swap_b32 v48, v60
  v_permlane16_swap_b32 v49, v61
  v_accvgpr_write_b32 a88, v24
  v_accvgpr_write_b32 a89, v25
  v_accvgpr_write_b32 a90, v36
  v_accvgpr_write_b32 a91, v37
  v_accvgpr_write_b32 a92, v48
  v_accvgpr_write_b32 a93, v49
  v_accvgpr_write_b32 a94, v60
  v_accvgpr_write_b32 a95, v61
  s_waitcnt lgkmcnt(4)
  v_mfma_f32_16x16x32_bf16 v[168:171], a[192:195], a[0:3], 0
  s_waitcnt vmcnt(63)
  ds_read_b128 a[212:215], v228 offset:2304
  v_mfma_f32_16x16x32_bf16 v[176:179], a[192:195], a[4:7], 0
  s_barrier
  v_mfma_f32_16x16x32_bf16 v[184:187], a[192:195], a[8:11], 0
  s_waitcnt lgkmcnt(4)
  v_mov_b32 v234, 0
  v_mov_b32 v235, 0
  v_mfma_f32_16x16x32_bf16 v[168:171], a[196:199], a[12:15], v[168:171]
  ds_read_b128 a[216:219], v228 offset:3072
  v_mov_b32 v236, 0
  v_mfma_f32_16x16x32_bf16 v[176:179], a[196:199], a[16:19], v[176:179]
  v_mfma_f32_16x16x32_bf16 v[184:187], a[196:199], a[20:23], v[184:187]
  s_waitcnt lgkmcnt(4)
  v_mfma_f32_16x16x32_bf16 v[168:171], a[200:203], a[24:27], v[168:171]
  ds_read_b128 a[220:223], v228 offset:3328
  v_mfma_f32_16x16x32_bf16 v[176:179], a[200:203], a[28:31], v[176:179]
  v_mfma_f32_16x16x32_bf16 v[184:187], a[200:203], a[32:35], v[184:187]
  s_waitcnt lgkmcnt(4)
  v_mfma_f32_16x16x32_bf16 v[168:171], a[204:207], a[36:39], v[168:171]
  ds_read_b128 a[192:195], v228 offset:8192
  v_mfma_f32_16x16x32_bf16 v[176:179], a[204:207], a[40:43], v[176:179]
  v_mfma_f32_16x16x32_bf16 v[184:187], a[204:207], a[44:47], v[184:187]
  s_waitcnt lgkmcnt(4)
  v_mfma_f32_16x16x32_bf16 v[168:171], a[208:211], a[48:51], v[168:171]
  ds_read_b128 a[196:199], v228 offset:8448
  v_mfma_f32_16x16x32_bf16 v[176:179], a[208:211], a[52:55], v[176:179]
  v_mfma_f32_16x16x32_bf16 v[184:187], a[208:211], a[56:59], v[184:187]
  s_waitcnt lgkmcnt(4)
  v_mfma_f32_16x16x32_bf16 v[168:171], a[212:215], a[60:63], v[168:171]
  ds_read_b128 a[200:203], v228 offset:9216
  v_mfma_f32_16x16x32_bf16 v[176:179], a[212:215], a[64:67], v[176:179]
  v_mfma_f32_16x16x32_bf16 v[184:187], a[212:215], a[68:71], v[184:187]
  s_waitcnt lgkmcnt(4)
  v_mfma_f32_16x16x32_bf16 v[168:171], a[216:219], a[72:75], v[168:171]
  ds_read_b128 a[204:207], v228 offset:9472
  v_mfma_f32_16x16x32_bf16 v[176:179], a[216:219], a[76:79], v[176:179]
  v_mfma_f32_16x16x32_bf16 v[184:187], a[216:219], a[80:83], v[184:187]
  s_waitcnt lgkmcnt(4)
  v_mfma_f32_16x16x32_bf16 v[168:171], a[220:223], a[84:87], v[168:171]
  ds_read_b128 a[208:211], v228 offset:10240
  v_mfma_f32_16x16x32_bf16 v[176:179], a[220:223], a[88:91], v[176:179]
  v_mfma_f32_16x16x32_bf16 v[184:187], a[220:223], a[92:95], v[184:187]
  s_waitcnt lgkmcnt(4)
  v_mfma_f32_16x16x32_bf16 v[172:175], a[192:195], a[0:3], 0
  ds_read_b128 a[212:215], v228 offset:10496
  v_mfma_f32_16x16x32_bf16 v[180:183], a[192:195], a[4:7], 0
  s_nop 0
  v_max3_f32 v240, v168, v169, v170
  v_mfma_f32_16x16x32_bf16 v[188:191], a[192:195], a[8:11], 0
  s_waitcnt lgkmcnt(4)
  v_max3_f32 v241, v176, v177, v178
  v_max_f32 v240, v240, v171
  v_mfma_f32_16x16x32_bf16 v[172:175], a[196:199], a[12:15], v[172:175]
  ds_read_b128 a[216:219], v228 offset:11264
  v_max3_f32 v242, v184, v185, v186
  v_mfma_f32_16x16x32_bf16 v[180:183], a[196:199], a[16:19], v[180:183]
  v_max_f32 v241, v241, v179
  v_max_f32 v242, v242, v187
  v_mfma_f32_16x16x32_bf16 v[188:191], a[196:199], a[20:23], v[188:191]
  s_waitcnt lgkmcnt(4)
  v_mov_b32 v243, v240
  v_mov_b32 v244, v241
  v_mfma_f32_16x16x32_bf16 v[172:175], a[200:203], a[24:27], v[172:175]
  ds_read_b128 a[220:223], v228 offset:11520
  v_add_u32 v228, 49152, v229
  v_mfma_f32_16x16x32_bf16 v[180:183], a[200:203], a[28:31], v[180:183]
  v_permlane32_swap_b32 v240, v243
  v_mfma_f32_16x16x32_bf16 v[188:191], a[200:203], a[32:35], v[188:191]
  s_waitcnt lgkmcnt(4)
  v_permlane32_swap_b32 v241, v244
  v_mfma_f32_16x16x32_bf16 v[172:175], a[204:207], a[36:39], v[172:175]
  ds_read_b128 a[192:195], v228 offset:0
  v_mov_b32 v245, v242
  v_mfma_f32_16x16x32_bf16 v[180:183], a[204:207], a[40:43], v[180:183]
  s_nop 0
  v_permlane32_swap_b32 v242, v245
  v_mfma_f32_16x16x32_bf16 v[188:191], a[204:207], a[44:47], v[188:191]
  s_waitcnt lgkmcnt(4)
  v_max_f32 v240, v240, v243
  v_max_f32 v241, v241, v244
  v_mfma_f32_16x16x32_bf16 v[172:175], a[208:211], a[48:51], v[172:175]
  ds_read_b128 a[196:199], v228 offset:256
  v_max_f32 v242, v242, v245
  v_mfma_f32_16x16x32_bf16 v[180:183], a[208:211], a[52:55], v[180:183]
  v_mov_b32 v243, v240
  v_mov_b32 v244, v241
  v_mfma_f32_16x16x32_bf16 v[188:191], a[208:211], a[56:59], v[188:191]
  s_waitcnt lgkmcnt(4)
  v_permlane16_swap_b32 v240, v243
  v_mfma_f32_16x16x32_bf16 v[172:175], a[212:215], a[60:63], v[172:175]
  ds_read_b128 a[200:203], v228 offset:1024
  v_mov_b32 v245, v242
  v_mfma_f32_16x16x32_bf16 v[180:183], a[212:215], a[64:67], v[180:183]
  v_permlane16_swap_b32 v241, v244
  v_mfma_f32_16x16x32_bf16 v[188:191], a[212:215], a[68:71], v[188:191]
  s_waitcnt lgkmcnt(4)
  v_permlane16_swap_b32 v242, v245
  v_mfma_f32_16x16x32_bf16 v[172:175], a[216:219], a[72:75], v[172:175]
  ds_read_b128 a[204:207], v228 offset:1280
  v_max_f32 v240, v240, v243
  v_mfma_f32_16x16x32_bf16 v[180:183], a[216:219], a[76:79], v[180:183]
  v_max_f32 v241, v241, v244
  v_max_f32 v242, v242, v245
  v_mfma_f32_16x16x32_bf16 v[188:191], a[216:219], a[80:83], v[188:191]
  s_waitcnt lgkmcnt(4)
  v_sub_f32 v216, 0, v240
  v_sub_f32 v220, 0, v241
  v_mfma_f32_16x16x32_bf16 v[172:175], a[220:223], a[84:87], v[172:175]
  ds_read_b128 a[208:211], v228 offset:2048
  v_sub_f32 v224, 0, v242
  v_mfma_f32_16x16x32_bf16 v[180:183], a[220:223], a[88:91], v[180:183]
  v_sub_f32 v217, 0, v240
  v_sub_f32 v221, 0, v241
  v_sub_f32 v225, 0, v242
  v_sub_f32 v218, 0, v240
  v_sub_f32 v222, 0, v241
  v_sub_f32 v226, 0, v242
  v_sub_f32 v219, 0, v240
  v_sub_f32 v223, 0, v241
  v_sub_f32 v227, 0, v242
  v_mfma_f32_16x16x32_bf16 v[188:191], a[220:223], a[92:95], v[188:191]
  s_waitcnt lgkmcnt(4)
  v_add_f32 v168, v216, v168
  v_add_f32 v169, v216, v169
  v_mfma_f32_16x16x32_bf16 v[192:195], a[192:195], a[0:3], v[216:219]
  s_waitcnt vmcnt(63)
  ds_read_b128 a[212:215], v228 offset:2304
  v_add_f32 v170, v216, v170
  v_mfma_f32_16x16x32_bf16 v[200:203], a[192:195], a[4:7], v[220:223]
  s_barrier
  v_add_f32 v171, v216, v171
  v_add_f32 v176, v220, v176
  v_mfma_f32_16x16x32_bf16 v[208:211], a[192:195], a[8:11], v[224:227]
  s_waitcnt lgkmcnt(4)
  v_add_f32 v177, v220, v177
  v_add_f32 v178, v220, v178
  v_mfma_f32_16x16x32_bf16 v[192:195], a[196:199], a[12:15], v[192:195]
  s_add_u32 m0, s28, 32768
  ds_read_b128 a[216:219], v228 offset:3072
  v_add_f32 v179, v220, v179
  v_mfma_f32_16x16x32_bf16 v[200:203], a[196:199], a[16:19], v[200:203]
  s_add_u32 s29, s52, 0
  v_add_f32 v184, v224, v184
  v_add_f32 v185, v224, v185
  v_mfma_f32_16x16x32_bf16 v[208:211], a[196:199], a[20:23], v[208:211]
  s_waitcnt lgkmcnt(4)
  v_add_f32 v186, v224, v186
  v_add_f32 v187, v224, v187
  v_mfma_f32_16x16x32_bf16 v[192:195], a[200:203], a[24:27], v[192:195]
  ds_read_b128 a[220:223], v228 offset:3328
  v_add_f32 v172, v216, v172
  v_mfma_f32_16x16x32_bf16 v[200:203], a[200:203], a[28:31], v[200:203]
  buffer_load_dwordx4 v232, s[24:27], s29 offen offset:0 lds
  v_mfma_f32_16x16x32_bf16 v[208:211], a[200:203], a[32:35], v[208:211]
  s_waitcnt lgkmcnt(4)
  v_add_f32 v173, v216, v173
  v_add_f32 v174, v216, v174
  v_mfma_f32_16x16x32_bf16 v[192:195], a[204:207], a[36:39], v[192:195]
  s_add_u32 s29, s29, s31
  ds_read_b128 a[192:195], v228 offset:8192
  v_add_f32 v175, v216, v175
  v_mfma_f32_16x16x32_bf16 v[200:203], a[204:207], a[40:43], v[200:203]
  v_add_f32 v180, v220, v180
  v_add_f32 v181, v220, v181
  v_mfma_f32_16x16x32_bf16 v[208:211], a[204:207], a[44:47], v[208:211]
  s_waitcnt lgkmcnt(4)
  v_add_f32 v182, v220, v182
  v_add_f32 v183, v220, v183
  v_mfma_f32_16x16x32_bf16 v[192:195], a[208:211], a[48:51], v[192:195]
  ds_read_b128 a[196:199], v228 offset:8448
  v_add_f32 v188, v224, v188
  v_mfma_f32_16x16x32_bf16 v[200:203], a[208:211], a[52:55], v[200:203]
  v_exp_f32 v168, v168
  v_mfma_f32_16x16x32_bf16 v[208:211], a[208:211], a[56:59], v[208:211]
  s_waitcnt lgkmcnt(4)
  v_add_f32 v234, v168, v234
  v_add_f32 v189, v224, v189
  v_mfma_f32_16x16x32_bf16 v[192:195], a[212:215], a[60:63], v[192:195]
  ds_read_b128 a[200:203], v228 offset:9216
  v_add_f32 v190, v224, v190
  v_mfma_f32_16x16x32_bf16 v[200:203], a[212:215], a[64:67], v[200:203]
  v_exp_f32 v169, v169
  v_mfma_f32_16x16x32_bf16 v[208:211], a[212:215], a[68:71], v[208:211]
  s_waitcnt lgkmcnt(4)
  v_exp_f32 v170, v170
  v_mfma_f32_16x16x32_bf16 v[192:195], a[216:219], a[72:75], v[192:195]
  ds_read_b128 a[204:207], v228 offset:9472
  v_add_f32 v234, v169, v234
  v_mfma_f32_16x16x32_bf16 v[200:203], a[216:219], a[76:79], v[200:203]
  buffer_load_dwordx4 v232, s[24:27], s29 offen offset:1024 lds
  v_mfma_f32_16x16x32_bf16 v[208:211], a[216:219], a[80:83], v[208:211]
  s_waitcnt lgkmcnt(4)
  v_exp_f32 v171, v171
  v_mfma_f32_16x16x32_bf16 v[192:195], a[220:223], a[84:87], v[192:195]
  s_add_u32 s29, s29, s31
  ds_read_b128 a[208:211], v228 offset:10240
  v_cvt_pk_bf16_f32 v168, v168, v169
  v_mfma_f32_16x16x32_bf16 v[200:203], a[220:223], a[88:91], v[200:203]
  v_exp_f32 v176, v176
  v_mfma_f32_16x16x32_bf16 v[208:211], a[220:223], a[92:95], v[208:211]
  s_waitcnt lgkmcnt(4)
  v_exp_f32 v177, v177
  v_mfma_f32_16x16x32_bf16 v[196:199], a[192:195], a[0:3], v[216:219]
  ds_read_b128 a[212:215], v228 offset:10496
  v_add_f32 v234, v170, v234
  v_mfma_f32_16x16x32_bf16 v[204:207], a[192:195], a[4:7], v[220:223]
  v_exp_f32 v178, v178
  v_mfma_f32_16x16x32_bf16 v[212:215], a[192:195], a[8:11], v[224:227]
  s_waitcnt lgkmcnt(4)
  v_exp_f32 v179, v179
  v_mfma_f32_16x16x32_bf16 v[196:199], a[196:199], a[12:15], v[196:199]
  ds_read_b128 a[216:219], v228 offset:11264
  v_add_f32 v234, v171, v234
  v_mfma_f32_16x16x32_bf16 v[204:207], a[196:199], a[16:19], v[204:207]
  v_exp_f32 v184, v184
  v_mfma_f32_16x16x32_bf16 v[212:215], a[196:199], a[20:23], v[212:215]
  s_waitcnt lgkmcnt(4)
  v_cvt_pk_bf16_f32 v169, v170, v171
  v_add_f32 v235, v176, v235
  v_mfma_f32_16x16x32_bf16 v[196:199], a[200:203], a[24:27], v[196:199]
  ds_read_b128 a[220:223], v228 offset:11520
  v_add_u32 v228, 131072, v230
  v_mfma_f32_16x16x32_bf16 v[204:207], a[200:203], a[28:31], v[204:207]
  buffer_load_dwordx4 v232, s[24:27], s29 offen offset:2048 lds
  v_mfma_f32_16x16x32_bf16 v[212:215], a[200:203], a[32:35], v[212:215]
  s_waitcnt lgkmcnt(4)
  v_xor_b32 v239, 32, v228
  v_mfma_f32_16x16x32_bf16 v[196:199], a[204:207], a[36:39], v[196:199]
  s_add_u32 s29, s29, s31
  ds_read_b64_tr_b16 a[192:193], v228 offset:0
  v_add_f32 v235, v177, v235
  v_mfma_f32_16x16x32_bf16 v[204:207], a[204:207], a[40:43], v[204:207]
  ds_read_b64_tr_b16 a[194:195], v228 offset:8192
  v_cvt_pk_bf16_f32 v176, v176, v177
  v_mfma_f32_16x16x32_bf16 v[212:215], a[204:207], a[44:47], v[212:215]
  s_waitcnt lgkmcnt(5)
  v_exp_f32 v185, v185
  v_mfma_f32_16x16x32_bf16 v[196:199], a[208:211], a[48:51], v[196:199]
  ds_read_b64_tr_b16 a[196:197], v239 offset:0
  v_add_f32 v235, v178, v235
  v_mfma_f32_16x16x32_bf16 v[204:207], a[208:211], a[52:55], v[204:207]
  ds_read_b64_tr_b16 a[198:199], v239 offset:8192
  v_add_f32 v235, v179, v235
  v_mfma_f32_16x16x32_bf16 v[212:215], a[208:211], a[56:59], v[212:215]
  s_waitcnt lgkmcnt(6)
  v_exp_f32 v186, v186
  v_mfma_f32_16x16x32_bf16 v[196:199], a[212:215], a[60:63], v[196:199]
  ds_read_b64_tr_b16 a[200:201], v228 offset:256
  v_cvt_pk_bf16_f32 v177, v178, v179
  v_mfma_f32_16x16x32_bf16 v[204:207], a[212:215], a[64:67], v[204:207]
  ds_read_b64_tr_b16 a[202:203], v228 offset:8448
  v_add_f32 v236, v184, v236
  v_mfma_f32_16x16x32_bf16 v[212:215], a[212:215], a[68:71], v[212:215]
  s_waitcnt lgkmcnt(7)
  v_exp_f32 v187, v187
  v_mfma_f32_16x16x32_bf16 v[196:199], a[216:219], a[72:75], v[196:199]
  ds_read_b64_tr_b16 a[204:205], v239 offset:256
  v_add_f32 v236, v185, v236
  v_mfma_f32_16x16x32_bf16 v[204:207], a[216:219], a[76:79], v[204:207]
  buffer_load_dwordx4 v232, s[24:27], s29 offen offset:3072 lds
  v_mfma_f32_16x16x32_bf16 v[212:215], a[216:219], a[80:83], v[212:215]
  s_waitcnt lgkmcnt(7)
  ds_read_b64_tr_b16 a[206:207], v239 offset:8448
  v_cvt_pk_bf16_f32 v184, v184, v185
  v_mfma_f32_16x16x32_bf16 v[196:199], a[220:223], a[84:87], v[196:199]
  ds_read_b64_tr_b16 a[208:209], v228 offset:1024
  v_add_f32 v236, v186, v236
  v_mfma_f32_16x16x32_bf16 v[204:207], a[220:223], a[88:91], v[204:207]
  ds_read_b64_tr_b16 a[210:211], v228 offset:9216
  v_add_f32 v236, v187, v236
  v_exp_f32 v172, v172
  v_exp_f32 v173, v173
  v_exp_f32 v174, v174
  v_exp_f32 v175, v175
  v_exp_f32 v180, v180
  v_exp_f32 v181, v181
  v_exp_f32 v182, v182
  v_exp_f32 v183, v183
  v_exp_f32 v188, v188
  v_exp_f32 v189, v189
  v_exp_f32 v190, v190
  v_cvt_pk_bf16_f32 v185, v186, v187
  v_add_f32 v234, v172, v234
  v_add_f32 v234, v173, v234
  v_cvt_pk_bf16_f32 v170, v172, v173
  v_add_f32 v234, v174, v234
  v_add_f32 v234, v175, v234
  v_cvt_pk_bf16_f32 v171, v174, v175
  v_add_f32 v235, v180, v235
  v_add_f32 v235, v181, v235
  v_cvt_pk_bf16_f32 v178, v180, v181
  v_add_f32 v235, v182, v235
  v_add_f32 v235, v183, v235
  v_cvt_pk_bf16_f32 v179, v182, v183
  v_add_f32 v236, v188, v236
  v_add_f32 v236, v189, v236
  v_cvt_pk_bf16_f32 v186, v188, v189
  v_add_f32 v236, v190, v236
  v_add_f32 v191, v224, v191
  v_exp_f32 v191, v191
  s_nop 0
  v_add_f32 v236, v191, v236
  v_cvt_pk_bf16_f32 v187, v190, v191
  v_mfma_f32_16x16x32_bf16 v[212:215], a[220:223], a[92:95], v[212:215]
  s_waitcnt lgkmcnt(8)
  v_exp_f32 v192, v192
  v_mfma_f32_16x16x32_bf16 v[0:3], a[192:195], v[168:171], 0
  s_waitcnt vmcnt(25)
  ds_read_b64_tr_b16 a[212:213], v239 offset:1024
  v_add_f32 v234, v192, v234
  v_mfma_f32_16x16x32_bf16 v[4:7], a[192:195], v[176:179], 0
  s_barrier
  ds_read_b64_tr_b16 a[214:215], v239 offset:9216
  v_mbcnt_lo_u32_b32 v240, -1, 0
  v_mfma_f32_16x16x32_bf16 v[8:11], a[192:195], v[184:187], 0
  s_waitcnt lgkmcnt(8)
  v_exp_f32 v193, v193
  v_mfma_f32_16x16x32_bf16 v[12:15], a[196:199], v[168:171], 0
  s_add_u32 m0, s28, 147456
  ds_read_b64_tr_b16 a[216:217], v228 offset:1280
  v_add_f32 v234, v193, v234
  v_mfma_f32_16x16x32_bf16 v[16:19], a[196:199], v[176:179], 0
  s_add_u32 s29, s52, 114688
  ds_read_b64_tr_b16 a[218:219], v228 offset:9472
  v_cvt_pk_bf16_f32 v192, v192, v193
  v_mfma_f32_16x16x32_bf16 v[20:23], a[196:199], v[184:187], 0
  s_waitcnt lgkmcnt(8)
  v_exp_f32 v194, v194
  v_mfma_f32_16x16x32_bf16 v[24:27], a[200:203], v[168:171], 0
  ds_read_b64_tr_b16 a[220:221], v239 offset:1280
  v_add_f32 v234, v194, v234
  v_mfma_f32_16x16x32_bf16 v[28:31], a[200:203], v[176:179], 0
  buffer_load_dwordx4 v232, s[24:27], s29 offen offset:0 lds
  v_mfma_f32_16x16x32_bf16 v[32:35], a[200:203], v[184:187], 0
  s_waitcnt lgkmcnt(7)
  ds_read_b64_tr_b16 a[222:223], v239 offset:9472
  v_mbcnt_hi_u32_b32 v240, -1, v240
  v_mfma_f32_16x16x32_bf16 v[36:39], a[204:207], v[168:171], 0
  s_add_u32 s29, s29, s31
  ds_read_b64_tr_b16 a[192:193], v228 offset:2048
  v_and_b32 v241, 3, v240
  v_mfma_f32_16x16x32_bf16 v[40:43], a[204:207], v[176:179], 0
  ds_read_b64_tr_b16 a[194:195], v228 offset:10240
  v_lshlrev_b32 v241, 3, v241
  v_mfma_f32_16x16x32_bf16 v[44:47], a[204:207], v[184:187], 0
  s_waitcnt lgkmcnt(8)
  v_exp_f32 v195, v195
  v_mfma_f32_16x16x32_bf16 v[48:51], a[208:211], v[168:171], 0
  ds_read_b64_tr_b16 a[196:197], v239 offset:2048
  v_add_f32 v234, v195, v234
  v_mfma_f32_16x16x32_bf16 v[52:55], a[208:211], v[176:179], 0
  ds_read_b64_tr_b16 a[198:199], v239 offset:10240
  v_cvt_pk_bf16_f32 v193, v194, v195
  v_mfma_f32_16x16x32_bf16 v[56:59], a[208:211], v[184:187], 0
  s_waitcnt lgkmcnt(8)
  v_exp_f32 v200, v200
  v_mfma_f32_16x16x32_bf16 v[60:63], a[212:215], v[168:171], 0
  ds_read_b64_tr_b16 a[200:201], v228 offset:2304
  v_add_f32 v235, v200, v235
  v_mfma_f32_16x16x32_bf16 v[64:67], a[212:215], v[176:179], 0
  ds_read_b64_tr_b16 a[202:203], v228 offset:10496
  v_bfe_u32 v242, v240, 2, 2
  v_mfma_f32_16x16x32_bf16 v[68:71], a[212:215], v[184:187], 0
  s_waitcnt lgkmcnt(8)
  v_exp_f32 v201, v201
  v_mfma_f32_16x16x32_bf16 v[72:75], a[216:219], v[168:171], 0
  ds_read_b64_tr_b16 a[204:205], v239 offset:2304
  v_add_f32 v235, v201, v235
  v_mfma_f32_16x16x32_bf16 v[76:79], a[216:219], v[176:179], 0
  buffer_load_dwordx4 v232, s[24:27], s29 offen offset:1024 lds
  v_mfma_f32_16x16x32_bf16 v[80:83], a[216:219], v[184:187], 0
  s_waitcnt lgkmcnt(7)
  ds_read_b64_tr_b16 a[206:207], v239 offset:10496
  v_cvt_pk_bf16_f32 v200, v200, v201
  v_mfma_f32_16x16x32_bf16 v[84:87], a[220:223], v[168:171], 0
  s_add_u32 s29, s29, s31
  ds_read_b64_tr_b16 a[208:209], v228 offset:3072
  v_lshl_add_u32 v241, v242, 6, v241
  v_mfma_f32_16x16x32_bf16 v[88:91], a[220:223], v[176:179], 0
  ds_read_b64_tr_b16 a[210:211], v228 offset:11264
  v_bfe_u32 v242, v240, 4, 1
  v_mfma_f32_16x16x32_bf16 v[92:95], a[220:223], v[184:187], 0
  s_waitcnt lgkmcnt(8)
  v_exp_f32 v202, v202
  v_mfma_f32_16x16x32_bf16 v[96:99], a[192:195], v[168:171], 0
  ds_read_b64_tr_b16 a[212:213], v239 offset:3072
  v_add_f32 v235, v202, v235
  v_mfma_f32_16x16x32_bf16 v[100:103], a[192:195], v[176:179], 0
  ds_read_b64_tr_b16 a[214:215], v239 offset:11264
  v_mul_u32_u24 v242, 544, v242
  v_mfma_f32_16x16x32_bf16 v[104:107], a[192:195], v[184:187], 0
  s_waitcnt lgkmcnt(8)
  v_exp_f32 v203, v203
  v_mfma_f32_16x16x32_bf16 v[108:111], a[196:199], v[168:171], 0
  ds_read_b64_tr_b16 a[216:217], v228 offset:3328
  v_add_f32 v235, v203, v235
  v_mfma_f32_16x16x32_bf16 v[112:115], a[196:199], v[176:179], 0
  ds_read_b64_tr_b16 a[218:219], v228 offset:11520
  v_cvt_pk_bf16_f32 v201, v202, v203
  v_mfma_f32_16x16x32_bf16 v[116:119], a[196:199], v[184:187], 0
  s_waitcnt lgkmcnt(8)
  v_exp_f32 v208, v208
  v_mfma_f32_16x16x32_bf16 v[120:123], a[200:203], v[168:171], 0
  ds_read_b64_tr_b16 a[220:221], v239 offset:3328
  v_add_f32 v236, v208, v236
  v_mfma_f32_16x16x32_bf16 v[124:127], a[200:203], v[176:179], 0
  buffer_load_dwordx4 v232, s[24:27], s29 offen offset:2048 lds
  v_mfma_f32_16x16x32_bf16 v[128:131], a[200:203], v[184:187], 0
  s_waitcnt lgkmcnt(7)
  ds_read_b64_tr_b16 a[222:223], v239 offset:11520
  v_add_u32 v228, 65536, v229
  v_mfma_f32_16x16x32_bf16 v[132:135], a[204:207], v[168:171], 0
  s_add_u32 s29, s29, s31
  ds_read_b128 a[192:195], v228 offset:0
  v_add_u32 v241, v241, v242
  v_mfma_f32_16x16x32_bf16 v[136:139], a[204:207], v[176:179], 0
  v_exp_f32 v209, v209
  v_mfma_f32_16x16x32_bf16 v[140:143], a[204:207], v[184:187], 0
  s_waitcnt lgkmcnt(7)
  v_exp_f32 v210, v210
  v_mfma_f32_16x16x32_bf16 v[144:147], a[208:211], v[168:171], 0
  ds_read_b128 a[196:199], v228 offset:256
  v_add_f32 v236, v209, v236
  v_mfma_f32_16x16x32_bf16 v[148:151], a[208:211], v[176:179], 0
  v_exp_f32 v211, v211
  v_mfma_f32_16x16x32_bf16 v[152:155], a[208:211], v[184:187], 0
  s_waitcnt lgkmcnt(6)
  v_exp_f32 v196, v196
  v_mfma_f32_16x16x32_bf16 v[156:159], a[212:215], v[168:171], 0
  ds_read_b128 a[200:203], v228 offset:1024
  v_cvt_pk_bf16_f32 v208, v208, v209
  v_mfma_f32_16x16x32_bf16 v[160:163], a[212:215], v[176:179], 0
  v_exp_f32 v197, v197
  v_mfma_f32_16x16x32_bf16 v[164:167], a[212:215], v[184:187], 0
  s_waitcnt lgkmcnt(5)
  v_exp_f32 v198, v198
  v_mfma_f32_16x16x32_bf16 a[224:227], a[216:219], v[168:171], 0
  ds_read_b128 a[204:207], v228 offset:1280
  v_add_f32 v236, v210, v236
  v_mfma_f32_16x16x32_bf16 a[228:231], a[216:219], v[176:179], 0
  buffer_load_dwordx4 v232, s[24:27], s29 offen offset:3072 lds
  v_mfma_f32_16x16x32_bf16 a[232:235], a[216:219], v[184:187], 0
  s_waitcnt lgkmcnt(4)
  v_exp_f32 v199, v199
  v_mfma_f32_16x16x32_bf16 a[236:239], a[220:223], v[168:171], 0
  ds_read_b128 a[208:211], v228 offset:2048
  v_add_f32 v236, v211, v236
  v_mfma_f32_16x16x32_bf16 a[240:243], a[220:223], v[176:179], 0
  v_exp_f32 v204, v204
  v_mfma_f32_16x16x32_bf16 a[244:247], a[220:223], v[184:187], 0
  s_waitcnt lgkmcnt(4)
  v_cvt_pk_bf16_f32 v209, v210, v211
  v_add_f32 v234, v196, v234
  v_mfma_f32_16x16x32_bf16 v[168:171], a[192:195], a[0:3], v[216:219]
  s_waitcnt vmcnt(25)
  ds_read_b128 a[212:215], v228 offset:2304
  v_add_f32 v234, v197, v234
  v_mfma_f32_16x16x32_bf16 v[176:179], a[192:195], a[4:7], v[220:223]
  s_barrier
  v_cvt_pk_bf16_f32 v194, v196, v197
  v_add_f32 v234, v198, v234
  v_mfma_f32_16x16x32_bf16 v[184:187], a[192:195], a[8:11], v[224:227]
  s_waitcnt lgkmcnt(4)
  v_exp_f32 v205, v205
  v_mfma_f32_16x16x32_bf16 v[168:171], a[196:199], a[12:15], v[168:171]
  s_add_u32 m0, s28, 49152
  ds_read_b128 a[216:219], v228 offset:3072
  v_add_f32 v234, v199, v234
  v_mfma_f32_16x16x32_bf16 v[176:179], a[196:199], a[16:19], v[176:179]
  s_add_u32 s29, s52, 229376
  v_exp_f32 v206, v206
  v_mfma_f32_16x16x32_bf16 v[184:187], a[196:199], a[20:23], v[184:187]
  s_waitcnt lgkmcnt(4)
  v_exp_f32 v207, v207
  v_mfma_f32_16x16x32_bf16 v[168:171], a[200:203], a[24:27], v[168:171]
  ds_read_b128 a[220:223], v228 offset:3328
  v_cvt_pk_bf16_f32 v195, v198, v199
  v_mfma_f32_16x16x32_bf16 v[176:179], a[200:203], a[28:31], v[176:179]
  buffer_load_dwordx4 v232, s[24:27], s29 offen offset:0 lds
  v_mfma_f32_16x16x32_bf16 v[184:187], a[200:203], a[32:35], v[184:187]
  s_waitcnt lgkmcnt(4)
  v_exp_f32 v212, v212
  v_mfma_f32_16x16x32_bf16 v[168:171], a[204:207], a[36:39], v[168:171]
  s_add_u32 s29, s29, s31
  ds_read_b128 a[192:195], v228 offset:8192
  v_add_f32 v235, v204, v235
  v_mfma_f32_16x16x32_bf16 v[176:179], a[204:207], a[40:43], v[176:179]
  v_exp_f32 v213, v213
  v_mfma_f32_16x16x32_bf16 v[184:187], a[204:207], a[44:47], v[184:187]
  s_waitcnt lgkmcnt(4)
  v_exp_f32 v214, v214
  v_mfma_f32_16x16x32_bf16 v[168:171], a[208:211], a[48:51], v[168:171]
  ds_read_b128 a[196:199], v228 offset:8448
  v_add_f32 v235, v205, v235
  v_mfma_f32_16x16x32_bf16 v[176:179], a[208:211], a[52:55], v[176:179]
  v_cvt_pk_bf16_f32 v202, v204, v205
  v_add_f32 v235, v206, v235
  v_mfma_f32_16x16x32_bf16 v[184:187], a[208:211], a[56:59], v[184:187]
  s_waitcnt lgkmcnt(4)
  v_exp_f32 v215, v215
  v_mfma_f32_16x16x32_bf16 v[168:171], a[212:215], a[60:63], v[168:171]
  ds_read_b128 a[200:203], v228 offset:9216
  v_add_f32 v235, v207, v235
  v_mfma_f32_16x16x32_bf16 v[176:179], a[212:215], a[64:67], v[176:179]
  v_cvt_pk_bf16_f32 v203, v206, v207
  v_add_f32 v236, v212, v236
  v_mfma_f32_16x16x32_bf16 v[184:187], a[212:215], a[68:71], v[184:187]
  s_waitcnt lgkmcnt(4)
  v_add_f32 v236, v213, v236
  v_lshrrev_b32 v242, 5, v240
  v_mfma_f32_16x16x32_bf16 v[168:171], a[216:219], a[72:75], v[168:171]
  ds_read_b128 a[204:207], v228 offset:9472
  v_cvt_pk_bf16_f32 v210, v212, v213
  v_mfma_f32_16x16x32_bf16 v[176:179], a[216:219], a[76:79], v[176:179]
  buffer_load_dwordx4 v232, s[24:27], s29 offen offset:1024 lds
  v_mfma_f32_16x16x32_bf16 v[184:187], a[216:219], a[80:83], v[184:187]
  s_waitcnt lgkmcnt(4)
  v_add_f32 v236, v214, v236
  v_lshl_add_u32 v243, v242, 10, v241
  v_mfma_f32_16x16x32_bf16 v[168:171], a[220:223], a[84:87], v[168:171]
  s_add_u32 s29, s29, s31
  ds_read_b128 a[208:211], v228 offset:10240
  v_add_f32 v236, v215, v236
  v_mfma_f32_16x16x32_bf16 v[176:179], a[220:223], a[88:91], v[176:179]
  v_cvt_pk_bf16_f32 v211, v214, v215
  v_accvgpr_write_b32 a248, v243
  v_mfma_f32_16x16x32_bf16 v[184:187], a[220:223], a[92:95], v[184:187]
  s_waitcnt lgkmcnt(4)
  v_lshlrev_b32 v241, 4, v240
  v_mfma_f32_16x16x32_bf16 v[172:175], a[192:195], a[0:3], v[216:219]
  ds_read_b128 a[212:215], v228 offset:10496
  v_mov_b32 v242, s34
  v_mfma_f32_16x16x32_bf16 v[180:183], a[192:195], a[4:7], v[220:223]
  v_exp_f32 v168, v168
  v_mfma_f32_16x16x32_bf16 v[188:191], a[192:195], a[8:11], v[224:227]
  s_waitcnt lgkmcnt(4)
  v_exp_f32 v169, v169
  v_mfma_f32_16x16x32_bf16 v[172:175], a[196:199], a[12:15], v[172:175]
  ds_read_b128 a[216:219], v228 offset:11264
  v_add_f32 v234, v168, v234
  v_mfma_f32_16x16x32_bf16 v[180:183], a[196:199], a[16:19], v[180:183]
  v_exp_f32 v170, v170
  v_mfma_f32_16x16x32_bf16 v[188:191], a[196:199], a[20:23], v[188:191]
  s_waitcnt lgkmcnt(4)
  v_exp_f32 v171, v171
  v_mfma_f32_16x16x32_bf16 v[172:175], a[200:203], a[24:27], v[172:175]
  ds_read_b128 a[220:223], v228 offset:11520
  v_add_u32 v228, 114688, v230
  v_mfma_f32_16x16x32_bf16 v[180:183], a[200:203], a[28:31], v[180:183]
  buffer_load_dwordx4 v232, s[24:27], s29 offen offset:2048 lds
  v_mfma_f32_16x16x32_bf16 v[188:191], a[200:203], a[32:35], v[188:191]
  s_waitcnt lgkmcnt(4)
  v_xor_b32 v239, 32, v228
  v_mfma_f32_16x16x32_bf16 v[172:175], a[204:207], a[36:39], v[172:175]
  s_add_u32 s29, s29, s31
  ds_read_b64_tr_b16 a[192:193], v228 offset:0
  v_add_f32 v234, v169, v234
  v_mfma_f32_16x16x32_bf16 v[180:183], a[204:207], a[40:43], v[180:183]
  ds_read_b64_tr_b16 a[194:195], v228 offset:8192
  v_cvt_pk_bf16_f32 v168, v168, v169
  v_mfma_f32_16x16x32_bf16 v[188:191], a[204:207], a[44:47], v[188:191]
  s_waitcnt lgkmcnt(5)
  v_exp_f32 v176, v176
  v_mfma_f32_16x16x32_bf16 v[172:175], a[208:211], a[48:51], v[172:175]
  ds_read_b64_tr_b16 a[196:197], v239 offset:0
  v_add_f32 v234, v170, v234
  v_mfma_f32_16x16x32_bf16 v[180:183], a[208:211], a[52:55], v[180:183]
  ds_read_b64_tr_b16 a[198:199], v239 offset:8192
  v_add_f32 v234, v171, v234
  v_mfma_f32_16x16x32_bf16 v[188:191], a[208:211], a[56:59], v[188:191]
  s_waitcnt lgkmcnt(6)
  v_exp_f32 v177, v177
  v_mfma_f32_16x16x32_bf16 v[172:175], a[212:215], a[60:63], v[172:175]
  ds_read_b64_tr_b16 a[200:201], v228 offset:256
  v_cvt_pk_bf16_f32 v169, v170, v171
  v_mfma_f32_16x16x32_bf16 v[180:183], a[212:215], a[64:67], v[180:183]
  ds_read_b64_tr_b16 a[202:203], v228 offset:8448
  v_add_f32 v235, v176, v235
  v_mfma_f32_16x16x32_bf16 v[188:191], a[212:215], a[68:71], v[188:191]
  s_waitcnt lgkmcnt(7)
  v_exp_f32 v178, v178
  v_mfma_f32_16x16x32_bf16 v[172:175], a[216:219], a[72:75], v[172:175]
  ds_read_b64_tr_b16 a[204:205], v239 offset:256
  v_add_f32 v235, v177, v235
  v_mfma_f32_16x16x32_bf16 v[180:183], a[216:219], a[76:79], v[180:183]
  buffer_load_dwordx4 v232, s[24:27], s29 offen offset:3072 lds
  v_mfma_f32_16x16x32_bf16 v[188:191], a[216:219], a[80:83], v[188:191]
  s_waitcnt lgkmcnt(7)
  ds_read_b64_tr_b16 a[206:207], v239 offset:8448
  v_cvt_pk_bf16_f32 v176, v176, v177
  v_mfma_f32_16x16x32_bf16 v[172:175], a[220:223], a[84:87], v[172:175]
  ds_read_b64_tr_b16 a[208:209], v228 offset:1024
  v_add_f32 v235, v178, v235
  v_mfma_f32_16x16x32_bf16 v[180:183], a[220:223], a[88:91], v[180:183]
  ds_read_b64_tr_b16 a[210:211], v228 offset:9216
  v_mul_u32_u24 v243, 6144, v242
  v_mfma_f32_16x16x32_bf16 v[188:191], a[220:223], a[92:95], v[188:191]
  s_waitcnt lgkmcnt(8)
  v_exp_f32 v179, v179
  v_mfma_f32_16x16x32_bf16 v[0:3], a[192:195], v[192:195], v[0:3]
  s_waitcnt vmcnt(25)
  ds_read_b64_tr_b16 a[212:213], v239 offset:1024
  v_add_f32 v235, v179, v235
  v_mfma_f32_16x16x32_bf16 v[4:7], a[192:195], v[200:203], v[4:7]
  s_barrier
  ds_read_b64_tr_b16 a[214:215], v239 offset:9216
  v_cvt_pk_bf16_f32 v177, v178, v179
  v_mfma_f32_16x16x32_bf16 v[8:11], a[192:195], v[208:211], v[8:11]
  s_waitcnt lgkmcnt(8)
  v_exp_f32 v184, v184
  v_mfma_f32_16x16x32_bf16 v[12:15], a[196:199], v[192:195], v[12:15]
  s_add_u32 m0, s28, 131072
  ds_read_b64_tr_b16 a[216:217], v228 offset:1280
  v_add_f32 v236, v184, v236
  v_mfma_f32_16x16x32_bf16 v[16:19], a[196:199], v[200:203], v[16:19]
  s_add_u32 s29, s52, 344064
  ds_read_b64_tr_b16 a[218:219], v228 offset:9472
  v_add_u32 v243, v243, v241
  v_mfma_f32_16x16x32_bf16 v[20:23], a[196:199], v[208:211], v[20:23]
  s_waitcnt lgkmcnt(8)
  v_exp_f32 v185, v185
  v_mfma_f32_16x16x32_bf16 v[24:27], a[200:203], v[192:195], v[24:27]
  ds_read_b64_tr_b16 a[220:221], v239 offset:1280
  v_add_f32 v236, v185, v236
  v_mfma_f32_16x16x32_bf16 v[28:31], a[200:203], v[200:203], v[28:31]
  buffer_load_dwordx4 v232, s[24:27], s29 offen offset:0 lds
  v_mfma_f32_16x16x32_bf16 v[32:35], a[200:203], v[208:211], v[32:35]
  s_waitcnt lgkmcnt(7)
  ds_read_b64_tr_b16 a[222:223], v239 offset:9472
  v_cvt_pk_bf16_f32 v184, v184, v185
  v_mfma_f32_16x16x32_bf16 v[36:39], a[204:207], v[192:195], v[36:39]
  s_add_u32 s29, s29, s31
  ds_read_b64_tr_b16 a[192:193], v228 offset:2048
  v_mfma_f32_16x16x32_bf16 v[40:43], a[204:207], v[200:203], v[40:43]
  ds_read_b64_tr_b16 a[194:195], v228 offset:10240
  v_mfma_f32_16x16x32_bf16 v[44:47], a[204:207], v[208:211], v[44:47]
  s_waitcnt lgkmcnt(8)
  v_exp_f32 v186, v186
  v_mfma_f32_16x16x32_bf16 v[48:51], a[208:211], v[192:195], v[48:51]
  ds_read_b64_tr_b16 a[196:197], v239 offset:2048
  v_add_f32 v236, v186, v236
  v_mfma_f32_16x16x32_bf16 v[52:55], a[208:211], v[200:203], v[52:55]
  ds_read_b64_tr_b16 a[198:199], v239 offset:10240
  v_mfma_f32_16x16x32_bf16 v[56:59], a[208:211], v[208:211], v[56:59]
  s_waitcnt lgkmcnt(8)
  v_exp_f32 v187, v187
  v_mfma_f32_16x16x32_bf16 v[60:63], a[212:215], v[192:195], v[60:63]
  ds_read_b64_tr_b16 a[200:201], v228 offset:2304
  v_add_f32 v236, v187, v236
  v_mfma_f32_16x16x32_bf16 v[64:67], a[212:215], v[200:203], v[64:67]
  ds_read_b64_tr_b16 a[202:203], v228 offset:10496
  v_cvt_pk_bf16_f32 v185, v186, v187
  v_mfma_f32_16x16x32_bf16 v[68:71], a[212:215], v[208:211], v[68:71]
  s_waitcnt lgkmcnt(8)
  v_exp_f32 v172, v172
  v_mfma_f32_16x16x32_bf16 v[72:75], a[216:219], v[192:195], v[72:75]
  ds_read_b64_tr_b16 a[204:205], v239 offset:2304
  v_add_f32 v234, v172, v234
  v_mfma_f32_16x16x32_bf16 v[76:79], a[216:219], v[200:203], v[76:79]
  buffer_load_dwordx4 v232, s[24:27], s29 offen offset:1024 lds
  v_mfma_f32_16x16x32_bf16 v[80:83], a[216:219], v[208:211], v[80:83]
  s_waitcnt lgkmcnt(7)
  ds_read_b64_tr_b16 a[206:207], v239 offset:10496
  v_mfma_f32_16x16x32_bf16 v[84:87], a[220:223], v[192:195], v[84:87]
  s_add_u32 s29, s29, s31
  ds_read_b64_tr_b16 a[208:209], v228 offset:3072
  v_mfma_f32_16x16x32_bf16 v[88:91], a[220:223], v[200:203], v[88:91]
  ds_read_b64_tr_b16 a[210:211], v228 offset:11264
  v_mfma_f32_16x16x32_bf16 v[92:95], a[220:223], v[208:211], v[92:95]
  s_waitcnt lgkmcnt(8)
  v_exp_f32 v173, v173
  v_mfma_f32_16x16x32_bf16 v[96:99], a[192:195], v[192:195], v[96:99]
  ds_read_b64_tr_b16 a[212:213], v239 offset:3072
  v_add_f32 v234, v173, v234
  v_mfma_f32_16x16x32_bf16 v[100:103], a[192:195], v[200:203], v[100:103]
  ds_read_b64_tr_b16 a[214:215], v239 offset:11264
  v_cvt_pk_bf16_f32 v170, v172, v173
  v_mfma_f32_16x16x32_bf16 v[104:107], a[192:195], v[208:211], v[104:107]
  s_waitcnt lgkmcnt(8)
  v_exp_f32 v174, v174
  v_mfma_f32_16x16x32_bf16 v[108:111], a[196:199], v[192:195], v[108:111]
  ds_read_b64_tr_b16 a[216:217], v228 offset:3328
  v_add_f32 v234, v174, v234
  v_mfma_f32_16x16x32_bf16 v[112:115], a[196:199], v[200:203], v[112:115]
  ds_read_b64_tr_b16 a[218:219], v228 offset:11520
  v_mfma_f32_16x16x32_bf16 v[116:119], a[196:199], v[208:211], v[116:119]
  s_waitcnt lgkmcnt(8)
  v_exp_f32 v175, v175
  v_mfma_f32_16x16x32_bf16 v[120:123], a[200:203], v[192:195], v[120:123]
  ds_read_b64_tr_b16 a[220:221], v239 offset:3328
  v_add_f32 v234, v175, v234
  v_mfma_f32_16x16x32_bf16 v[124:127], a[200:203], v[200:203], v[124:127]
  buffer_load_dwordx4 v232, s[24:27], s29 offen offset:2048 lds
  v_mfma_f32_16x16x32_bf16 v[128:131], a[200:203], v[208:211], v[128:131]
  s_waitcnt lgkmcnt(7)
  ds_read_b64_tr_b16 a[222:223], v239 offset:11520
  v_add_u32 v228, 81920, v229
  v_mfma_f32_16x16x32_bf16 v[132:135], a[204:207], v[192:195], v[132:135]
  s_add_u32 s29, s29, s31
  ds_read_b128 a[192:195], v228 offset:0
  v_cvt_pk_bf16_f32 v171, v174, v175
  v_mfma_f32_16x16x32_bf16 v[136:139], a[204:207], v[200:203], v[136:139]
  v_exp_f32 v180, v180
  v_mfma_f32_16x16x32_bf16 v[140:143], a[204:207], v[208:211], v[140:143]
  s_waitcnt lgkmcnt(7)
  v_exp_f32 v181, v181
  v_mfma_f32_16x16x32_bf16 v[144:147], a[208:211], v[192:195], v[144:147]
  ds_read_b128 a[196:199], v228 offset:256
  v_add_f32 v235, v180, v235
  v_mfma_f32_16x16x32_bf16 v[148:151], a[208:211], v[200:203], v[148:151]
  v_exp_f32 v182, v182
  v_mfma_f32_16x16x32_bf16 v[152:155], a[208:211], v[208:211], v[152:155]
  s_waitcnt lgkmcnt(6)
  v_exp_f32 v183, v183
  v_mfma_f32_16x16x32_bf16 v[156:159], a[212:215], v[192:195], v[156:159]
  ds_read_b128 a[200:203], v228 offset:1024
  v_add_f32 v235, v181, v235
  v_mfma_f32_16x16x32_bf16 v[160:163], a[212:215], v[200:203], v[160:163]
  v_exp_f32 v188, v188
  v_mfma_f32_16x16x32_bf16 v[164:167], a[212:215], v[208:211], v[164:167]
  s_waitcnt lgkmcnt(5)
  v_exp_f32 v189, v189
  v_mfma_f32_16x16x32_bf16 a[224:227], a[216:219], v[192:195], a[224:227]
  ds_read_b128 a[204:207], v228 offset:1280
  v_cvt_pk_bf16_f32 v178, v180, v181
  v_mfma_f32_16x16x32_bf16 a[228:231], a[216:219], v[200:203], a[228:231]
  buffer_load_dwordx4 v232, s[24:27], s29 offen offset:3072 lds
  v_mfma_f32_16x16x32_bf16 a[232:235], a[216:219], v[208:211], a[232:235]
  s_waitcnt lgkmcnt(4)
  v_exp_f32 v190, v190
  v_mfma_f32_16x16x32_bf16 a[236:239], a[220:223], v[192:195], a[236:239]
  ds_read_b128 a[208:211], v228 offset:2048
  v_add_f32 v235, v182, v235
  v_mfma_f32_16x16x32_bf16 a[240:243], a[220:223], v[200:203], a[240:243]
  v_exp_f32 v191, v191
  v_mfma_f32_16x16x32_bf16 a[244:247], a[220:223], v[208:211], a[244:247]
  s_waitcnt lgkmcnt(4)
  v_add_f32 v235, v183, v235
  v_add_f32 v236, v188, v236
  v_mfma_f32_16x16x32_bf16 v[192:195], a[192:195], a[0:3], v[216:219]
  s_waitcnt vmcnt(25)
  ds_read_b128 a[212:215], v228 offset:2304
  v_cvt_pk_bf16_f32 v179, v182, v183
  v_mfma_f32_16x16x32_bf16 v[200:203], a[192:195], a[4:7], v[220:223]
  s_barrier
  v_add_f32 v236, v189, v236
  v_accvgpr_write_b32 a249, v243
  v_mfma_f32_16x16x32_bf16 v[208:211], a[192:195], a[8:11], v[224:227]
  s_waitcnt lgkmcnt(4)
  v_cvt_pk_bf16_f32 v186, v188, v189
  v_add_f32 v236, v190, v236
  v_mfma_f32_16x16x32_bf16 v[192:195], a[196:199], a[12:15], v[192:195]
  s_add_u32 m0, s28, 65536
  ds_read_b128 a[216:219], v228 offset:3072
  v_add_f32 v236, v191, v236
  v_mfma_f32_16x16x32_bf16 v[200:203], a[196:199], a[16:19], v[200:203]
  s_add_u32 s29, s53, 0
  v_cvt_pk_bf16_f32 v187, v190, v191
  v_mul_u32_u24 v242, 48, v242
  v_mfma_f32_16x16x32_bf16 v[208:211], a[196:199], a[20:23], v[208:211]
  s_waitcnt lgkmcnt(4)
  v_and_b32 v241, 15, v240
  v_mfma_f32_16x16x32_bf16 v[192:195], a[200:203], a[24:27], v[192:195]
  ds_read_b128 a[220:223], v228 offset:3328
  v_add_u32 v241, v241, v242
  v_mfma_f32_16x16x32_bf16 v[200:203], a[200:203], a[28:31], v[200:203]
  buffer_load_dwordx4 v232, s[24:27], s29 offen offset:0 lds
  v_mfma_f32_16x16x32_bf16 v[208:211], a[200:203], a[32:35], v[208:211]
  s_waitcnt lgkmcnt(4)
  v_mfma_f32_16x16x32_bf16 v[192:195], a[204:207], a[36:39], v[192:195]
  s_add_u32 s29, s29, s31
  ds_read_b128 a[192:195], v228 offset:8192
  v_mfma_f32_16x16x32_bf16 v[200:203], a[204:207], a[40:43], v[200:203]
  v_mfma_f32_16x16x32_bf16 v[208:211], a[204:207], a[44:47], v[208:211]
  s_waitcnt lgkmcnt(4)
  v_mfma_f32_16x16x32_bf16 v[192:195], a[208:211], a[48:51], v[192:195]
  ds_read_b128 a[196:199], v228 offset:8448
  v_mfma_f32_16x16x32_bf16 v[200:203], a[208:211], a[52:55], v[200:203]
  v_mfma_f32_16x16x32_bf16 v[208:211], a[208:211], a[56:59], v[208:211]
  s_waitcnt lgkmcnt(4)
  v_mfma_f32_16x16x32_bf16 v[192:195], a[212:215], a[60:63], v[192:195]
  ds_read_b128 a[200:203], v228 offset:9216
  v_mfma_f32_16x16x32_bf16 v[200:203], a[212:215], a[64:67], v[200:203]
  v_mfma_f32_16x16x32_bf16 v[208:211], a[212:215], a[68:71], v[208:211]
  s_waitcnt lgkmcnt(4)
  v_mfma_f32_16x16x32_bf16 v[192:195], a[216:219], a[72:75], v[192:195]
  ds_read_b128 a[204:207], v228 offset:9472
  v_mfma_f32_16x16x32_bf16 v[200:203], a[216:219], a[76:79], v[200:203]
  buffer_load_dwordx4 v232, s[24:27], s29 offen offset:1024 lds
  v_mfma_f32_16x16x32_bf16 v[208:211], a[216:219], a[80:83], v[208:211]
  s_waitcnt lgkmcnt(4)
  v_mfma_f32_16x16x32_bf16 v[192:195], a[220:223], a[84:87], v[192:195]
  s_add_u32 s29, s29, s31
  ds_read_b128 a[208:211], v228 offset:10240
  v_mfma_f32_16x16x32_bf16 v[200:203], a[220:223], a[88:91], v[200:203]
  v_mfma_f32_16x16x32_bf16 v[208:211], a[220:223], a[92:95], v[208:211]
  s_waitcnt lgkmcnt(4)
  v_mfma_f32_16x16x32_bf16 v[196:199], a[192:195], a[0:3], v[216:219]
  ds_read_b128 a[212:215], v228 offset:10496
  v_mfma_f32_16x16x32_bf16 v[204:207], a[192:195], a[4:7], v[220:223]
  v_exp_f32 v192, v192
  v_mfma_f32_16x16x32_bf16 v[212:215], a[192:195], a[8:11], v[224:227]
  s_waitcnt lgkmcnt(4)
  v_exp_f32 v193, v193
  v_mfma_f32_16x16x32_bf16 v[196:199], a[196:199], a[12:15], v[196:199]
  ds_read_b128 a[216:219], v228 offset:11264
  v_add_f32 v234, v192, v234
  v_mfma_f32_16x16x32_bf16 v[204:207], a[196:199], a[16:19], v[204:207]
  v_exp_f32 v194, v194
  v_mfma_f32_16x16x32_bf16 v[212:215], a[196:199], a[20:23], v[212:215]
  s_waitcnt lgkmcnt(4)
  v_exp_f32 v195, v195
  v_mfma_f32_16x16x32_bf16 v[196:199], a[200:203], a[24:27], v[196:199]
  ds_read_b128 a[220:223], v228 offset:11520
  v_add_u32 v228, 0, v230
  v_mfma_f32_16x16x32_bf16 v[204:207], a[200:203], a[28:31], v[204:207]
  buffer_load_dwordx4 v232, s[24:27], s29 offen offset:2048 lds
  v_mfma_f32_16x16x32_bf16 v[212:215], a[200:203], a[32:35], v[212:215]
  s_waitcnt lgkmcnt(4)
  v_xor_b32 v239, 32, v228
  v_mfma_f32_16x16x32_bf16 v[196:199], a[204:207], a[36:39], v[196:199]
  s_add_u32 s29, s29, s31
  ds_read_b64_tr_b16 a[192:193], v228 offset:0
  v_add_f32 v234, v193, v234
  v_mfma_f32_16x16x32_bf16 v[204:207], a[204:207], a[40:43], v[204:207]
  ds_read_b64_tr_b16 a[194:195], v228 offset:8192
  v_cvt_pk_bf16_f32 v192, v192, v193
  v_mfma_f32_16x16x32_bf16 v[212:215], a[204:207], a[44:47], v[212:215]
  s_waitcnt lgkmcnt(5)
  v_exp_f32 v200, v200
  v_mfma_f32_16x16x32_bf16 v[196:199], a[208:211], a[48:51], v[196:199]
  ds_read_b64_tr_b16 a[196:197], v239 offset:0
  v_add_f32 v234, v194, v234
  v_mfma_f32_16x16x32_bf16 v[204:207], a[208:211], a[52:55], v[204:207]
  ds_read_b64_tr_b16 a[198:199], v239 offset:8192
  v_add_f32 v234, v195, v234
  v_mfma_f32_16x16x32_bf16 v[212:215], a[208:211], a[56:59], v[212:215]
  s_waitcnt lgkmcnt(6)
  v_exp_f32 v201, v201
  v_mfma_f32_16x16x32_bf16 v[196:199], a[212:215], a[60:63], v[196:199]
  ds_read_b64_tr_b16 a[200:201], v228 offset:256
  v_cvt_pk_bf16_f32 v193, v194, v195
  v_mfma_f32_16x16x32_bf16 v[204:207], a[212:215], a[64:67], v[204:207]
  ds_read_b64_tr_b16 a[202:203], v228 offset:8448
  v_add_f32 v235, v200, v235
  v_mfma_f32_16x16x32_bf16 v[212:215], a[212:215], a[68:71], v[212:215]
  s_waitcnt lgkmcnt(7)
  v_exp_f32 v202, v202
  v_mfma_f32_16x16x32_bf16 v[196:199], a[216:219], a[72:75], v[196:199]
  ds_read_b64_tr_b16 a[204:205], v239 offset:256
  v_add_f32 v235, v201, v235
  v_mfma_f32_16x16x32_bf16 v[204:207], a[216:219], a[76:79], v[204:207]
  buffer_load_dwordx4 v232, s[24:27], s29 offen offset:3072 lds
  v_mfma_f32_16x16x32_bf16 v[212:215], a[216:219], a[80:83], v[212:215]
  s_waitcnt lgkmcnt(7)
  ds_read_b64_tr_b16 a[206:207], v239 offset:8448
  v_cvt_pk_bf16_f32 v200, v200, v201
  v_mfma_f32_16x16x32_bf16 v[196:199], a[220:223], a[84:87], v[196:199]
  ds_read_b64_tr_b16 a[208:209], v228 offset:1024
  v_add_f32 v235, v202, v235
  v_mfma_f32_16x16x32_bf16 v[204:207], a[220:223], a[88:91], v[204:207]
  ds_read_b64_tr_b16 a[210:211], v228 offset:9216
  v_mfma_f32_16x16x32_bf16 v[212:215], a[220:223], a[92:95], v[212:215]
  s_waitcnt lgkmcnt(8)
  v_exp_f32 v203, v203
  v_mfma_f32_16x16x32_bf16 v[0:3], a[192:195], v[168:171], v[0:3]
  ds_read_b64_tr_b16 a[212:213], v239 offset:1024
  v_add_f32 v235, v203, v235
  v_mfma_f32_16x16x32_bf16 v[4:7], a[192:195], v[176:179], v[4:7]
  ds_read_b64_tr_b16 a[214:215], v239 offset:9216
  v_cvt_pk_bf16_f32 v201, v202, v203
  v_mfma_f32_16x16x32_bf16 v[8:11], a[192:195], v[184:187], v[8:11]
  s_waitcnt lgkmcnt(8)
  v_exp_f32 v208, v208
  v_mfma_f32_16x16x32_bf16 v[12:15], a[196:199], v[168:171], v[12:15]
  ds_read_b64_tr_b16 a[216:217], v228 offset:1280
  v_add_f32 v236, v208, v236
  v_mfma_f32_16x16x32_bf16 v[16:19], a[196:199], v[176:179], v[16:19]
  ds_read_b64_tr_b16 a[218:219], v228 offset:9472
  v_mfma_f32_16x16x32_bf16 v[20:23], a[196:199], v[184:187], v[20:23]
  s_waitcnt lgkmcnt(8)
  v_exp_f32 v209, v209
  v_mfma_f32_16x16x32_bf16 v[24:27], a[200:203], v[168:171], v[24:27]
  ds_read_b64_tr_b16 a[220:221], v239 offset:1280
  v_add_f32 v236, v209, v236
  v_mfma_f32_16x16x32_bf16 v[28:31], a[200:203], v[176:179], v[28:31]
  ds_read_b64_tr_b16 a[222:223], v239 offset:9472
  v_cvt_pk_bf16_f32 v208, v208, v209
  v_mfma_f32_16x16x32_bf16 v[32:35], a[200:203], v[184:187], v[32:35]
  s_waitcnt lgkmcnt(8)
  v_exp_f32 v210, v210
  v_mfma_f32_16x16x32_bf16 v[36:39], a[204:207], v[168:171], v[36:39]
  ds_read_b64_tr_b16 a[192:193], v228 offset:2048
  v_add_f32 v236, v210, v236
  v_mfma_f32_16x16x32_bf16 v[40:43], a[204:207], v[176:179], v[40:43]
  ds_read_b64_tr_b16 a[194:195], v228 offset:10240
  v_mfma_f32_16x16x32_bf16 v[44:47], a[204:207], v[184:187], v[44:47]
  s_waitcnt lgkmcnt(8)
  v_exp_f32 v211, v211
  v_mfma_f32_16x16x32_bf16 v[48:51], a[208:211], v[168:171], v[48:51]
  ds_read_b64_tr_b16 a[196:197], v239 offset:2048
  v_add_f32 v236, v211, v236
  v_mfma_f32_16x16x32_bf16 v[52:55], a[208:211], v[176:179], v[52:55]
  ds_read_b64_tr_b16 a[198:199], v239 offset:10240
  v_cvt_pk_bf16_f32 v209, v210, v211
  v_mfma_f32_16x16x32_bf16 v[56:59], a[208:211], v[184:187], v[56:59]
  s_waitcnt lgkmcnt(8)
  v_exp_f32 v196, v196
  v_mfma_f32_16x16x32_bf16 v[60:63], a[212:215], v[168:171], v[60:63]
  ds_read_b64_tr_b16 a[200:201], v228 offset:2304
  v_add_f32 v234, v196, v234
  v_mfma_f32_16x16x32_bf16 v[64:67], a[212:215], v[176:179], v[64:67]
  ds_read_b64_tr_b16 a[202:203], v228 offset:10496
  v_mfma_f32_16x16x32_bf16 v[68:71], a[212:215], v[184:187], v[68:71]
  s_waitcnt lgkmcnt(8)
  v_exp_f32 v197, v197
  v_mfma_f32_16x16x32_bf16 v[72:75], a[216:219], v[168:171], v[72:75]
  ds_read_b64_tr_b16 a[204:205], v239 offset:2304
  v_add_f32 v234, v197, v234
  v_mfma_f32_16x16x32_bf16 v[76:79], a[216:219], v[176:179], v[76:79]
  ds_read_b64_tr_b16 a[206:207], v239 offset:10496
  v_cvt_pk_bf16_f32 v194, v196, v197
  v_mfma_f32_16x16x32_bf16 v[80:83], a[216:219], v[184:187], v[80:83]
  s_waitcnt lgkmcnt(8)
  v_exp_f32 v198, v198
  v_mfma_f32_16x16x32_bf16 v[84:87], a[220:223], v[168:171], v[84:87]
  ds_read_b64_tr_b16 a[208:209], v228 offset:3072
  v_add_f32 v234, v198, v234
  v_mfma_f32_16x16x32_bf16 v[88:91], a[220:223], v[176:179], v[88:91]
  ds_read_b64_tr_b16 a[210:211], v228 offset:11264
  v_mfma_f32_16x16x32_bf16 v[92:95], a[220:223], v[184:187], v[92:95]
  s_waitcnt lgkmcnt(8)
  v_exp_f32 v199, v199
  v_mfma_f32_16x16x32_bf16 v[96:99], a[192:195], v[168:171], v[96:99]
  ds_read_b64_tr_b16 a[212:213], v239 offset:3072
  v_add_f32 v234, v199, v234
  v_mfma_f32_16x16x32_bf16 v[100:103], a[192:195], v[176:179], v[100:103]
  ds_read_b64_tr_b16 a[214:215], v239 offset:11264
  v_cvt_pk_bf16_f32 v195, v198, v199
  v_mfma_f32_16x16x32_bf16 v[104:107], a[192:195], v[184:187], v[104:107]
  s_waitcnt lgkmcnt(8)
  v_exp_f32 v204, v204
  v_mfma_f32_16x16x32_bf16 v[108:111], a[196:199], v[168:171], v[108:111]
  s_waitcnt vmcnt(24)
  ds_read_b64_tr_b16 a[216:217], v228 offset:3328
  v_add_f32 v235, v204, v235
  v_mfma_f32_16x16x32_bf16 v[112:115], a[196:199], v[176:179], v[112:115]
  s_barrier
  ds_read_b64_tr_b16 a[218:219], v228 offset:11520
  v_mfma_f32_16x16x32_bf16 v[116:119], a[196:199], v[184:187], v[116:119]
  s_waitcnt lgkmcnt(8)
  v_exp_f32 v205, v205
  v_mfma_f32_16x16x32_bf16 v[120:123], a[200:203], v[168:171], v[120:123]
  ds_read_b64_tr_b16 a[220:221], v239 offset:3328
  v_add_f32 v235, v205, v235
  v_mfma_f32_16x16x32_bf16 v[124:127], a[200:203], v[176:179], v[124:127]
  ds_read_b64_tr_b16 a[222:223], v239 offset:11520
  v_add_u32 v228, 98304, v229
  v_mfma_f32_16x16x32_bf16 v[128:131], a[200:203], v[184:187], v[128:131]
  s_waitcnt lgkmcnt(8)
  v_exp_f32 v206, v206
  v_mfma_f32_16x16x32_bf16 v[132:135], a[204:207], v[168:171], v[132:135]
  ds_read_b128 a[192:195], v228 offset:0
  v_cvt_pk_bf16_f32 v202, v204, v205
  v_mfma_f32_16x16x32_bf16 v[136:139], a[204:207], v[176:179], v[136:139]
  v_exp_f32 v207, v207
  v_mfma_f32_16x16x32_bf16 v[140:143], a[204:207], v[184:187], v[140:143]
  s_waitcnt lgkmcnt(7)
  v_exp_f32 v212, v212
  v_mfma_f32_16x16x32_bf16 v[144:147], a[208:211], v[168:171], v[144:147]
  ds_read_b128 a[196:199], v228 offset:256
  v_add_f32 v235, v206, v235
  v_mfma_f32_16x16x32_bf16 v[148:151], a[208:211], v[176:179], v[148:151]
  v_exp_f32 v213, v213
  v_mfma_f32_16x16x32_bf16 v[152:155], a[208:211], v[184:187], v[152:155]
  s_waitcnt lgkmcnt(6)
  v_exp_f32 v214, v214
  v_mfma_f32_16x16x32_bf16 v[156:159], a[212:215], v[168:171], v[156:159]
  ds_read_b128 a[200:203], v228 offset:1024
  v_add_f32 v235, v207, v235
  v_mfma_f32_16x16x32_bf16 v[160:163], a[212:215], v[176:179], v[160:163]
  v_exp_f32 v215, v215
  v_mfma_f32_16x16x32_bf16 v[164:167], a[212:215], v[184:187], v[164:167]
  s_waitcnt lgkmcnt(5)
  v_cvt_pk_bf16_f32 v203, v206, v207
  v_add_f32 v236, v212, v236
  v_mfma_f32_16x16x32_bf16 a[224:227], a[216:219], v[168:171], a[224:227]
  ds_read_b128 a[204:207], v228 offset:1280
  v_add_f32 v236, v213, v236
  v_mfma_f32_16x16x32_bf16 a[228:231], a[216:219], v[176:179], a[228:231]
  v_cvt_pk_bf16_f32 v210, v212, v213
  v_add_f32 v236, v214, v236
  v_mfma_f32_16x16x32_bf16 a[232:235], a[216:219], v[184:187], a[232:235]
  s_waitcnt lgkmcnt(4)
  v_add_f32 v236, v215, v236
  v_mul_u32_u24 v241, 896, v241
  v_mfma_f32_16x16x32_bf16 a[236:239], a[220:223], v[168:171], a[236:239]
  ds_read_b128 a[208:211], v228 offset:2048
  v_cvt_pk_bf16_f32 v211, v214, v215
  v_mfma_f32_16x16x32_bf16 a[240:243], a[220:223], v[176:179], a[240:243]
  v_lshrrev_b32 v242, 4, v240
  v_mfma_f32_16x16x32_bf16 a[244:247], a[220:223], v[184:187], a[244:247]
  s_waitcnt lgkmcnt(4)
  v_lshl_add_u32 v243, v242, 4, v241
  v_mfma_f32_16x16x32_bf16 v[168:171], a[192:195], a[0:3], v[216:219]
  s_add_u32 m0, s28, 114688
  ds_read_b128 a[212:215], v228 offset:2304
  v_accvgpr_write_b32 a250, v243
  v_mfma_f32_16x16x32_bf16 v[176:179], a[192:195], a[4:7], v[220:223]
  s_mov_b32 s29, 347136
  v_mfma_f32_16x16x32_bf16 v[184:187], a[192:195], a[8:11], v[224:227]
  s_waitcnt lgkmcnt(4)
  v_mfma_f32_16x16x32_bf16 v[168:171], a[196:199], a[12:15], v[168:171]
  ds_read_b128 a[216:219], v228 offset:3072
  v_mfma_f32_16x16x32_bf16 v[176:179], a[196:199], a[16:19], v[176:179]
  v_mfma_f32_16x16x32_bf16 v[184:187], a[196:199], a[20:23], v[184:187]
  s_waitcnt lgkmcnt(4)
  v_mfma_f32_16x16x32_bf16 v[168:171], a[200:203], a[24:27], v[168:171]
  ds_read_b128 a[220:223], v228 offset:3328
  v_mfma_f32_16x16x32_bf16 v[176:179], a[200:203], a[28:31], v[176:179]
  buffer_load_dwordx4 v231, s[8:11], s29 offen offset:0 nt lds
  v_mfma_f32_16x16x32_bf16 v[184:187], a[200:203], a[32:35], v[184:187]
  s_waitcnt lgkmcnt(4)
  v_mfma_f32_16x16x32_bf16 v[168:171], a[204:207], a[36:39], v[168:171]
  s_add_u32 s29, s29, s30
  ds_read_b128 a[192:195], v228 offset:8192
  v_mfma_f32_16x16x32_bf16 v[176:179], a[204:207], a[40:43], v[176:179]
  v_mfma_f32_16x16x32_bf16 v[184:187], a[204:207], a[44:47], v[184:187]
  s_waitcnt lgkmcnt(4)
  v_mfma_f32_16x16x32_bf16 v[168:171], a[208:211], a[48:51], v[168:171]
  ds_read_b128 a[196:199], v228 offset:8448
  v_mfma_f32_16x16x32_bf16 v[176:179], a[208:211], a[52:55], v[176:179]
  buffer_load_dwordx4 v231, s[8:11], s29 offen offset:1024 nt lds
  v_mfma_f32_16x16x32_bf16 v[184:187], a[208:211], a[56:59], v[184:187]
  s_waitcnt lgkmcnt(4)
  v_mfma_f32_16x16x32_bf16 v[168:171], a[212:215], a[60:63], v[168:171]
  s_add_u32 s29, s29, s30
  ds_read_b128 a[200:203], v228 offset:9216
  v_mfma_f32_16x16x32_bf16 v[176:179], a[212:215], a[64:67], v[176:179]
  v_mfma_f32_16x16x32_bf16 v[184:187], a[212:215], a[68:71], v[184:187]
  s_waitcnt lgkmcnt(4)
  v_mfma_f32_16x16x32_bf16 v[168:171], a[216:219], a[72:75], v[168:171]
  ds_read_b128 a[204:207], v228 offset:9472
  v_mfma_f32_16x16x32_bf16 v[176:179], a[216:219], a[76:79], v[176:179]
  buffer_load_dwordx4 v231, s[8:11], s29 offen offset:2048 nt lds
  v_mfma_f32_16x16x32_bf16 v[184:187], a[216:219], a[80:83], v[184:187]
  s_waitcnt lgkmcnt(4)
  v_mfma_f32_16x16x32_bf16 v[168:171], a[220:223], a[84:87], v[168:171]
  s_add_u32 s29, s29, s30
  ds_read_b128 a[208:211], v228 offset:10240
  v_mfma_f32_16x16x32_bf16 v[176:179], a[220:223], a[88:91], v[176:179]
  v_mfma_f32_16x16x32_bf16 v[184:187], a[220:223], a[92:95], v[184:187]
  s_waitcnt lgkmcnt(4)
  v_mfma_f32_16x16x32_bf16 v[172:175], a[192:195], a[0:3], v[216:219]
  ds_read_b128 a[212:215], v228 offset:10496
  v_mfma_f32_16x16x32_bf16 v[180:183], a[192:195], a[4:7], v[220:223]
  buffer_load_dwordx4 v231, s[8:11], s29 offen offset:3072 nt lds
  v_mfma_f32_16x16x32_bf16 v[188:191], a[192:195], a[8:11], v[224:227]
  s_waitcnt lgkmcnt(4)
  v_exp_f32 v168, v168
  v_mfma_f32_16x16x32_bf16 v[172:175], a[196:199], a[12:15], v[172:175]
  s_waitcnt vmcnt(24)
  ds_read_b128 a[216:219], v228 offset:11264
  v_add_f32 v234, v168, v234
  v_mfma_f32_16x16x32_bf16 v[180:183], a[196:199], a[16:19], v[180:183]
  s_barrier
  v_exp_f32 v169, v169
  v_mfma_f32_16x16x32_bf16 v[188:191], a[196:199], a[20:23], v[188:191]
  s_waitcnt lgkmcnt(4)
  v_exp_f32 v170, v170
  v_mfma_f32_16x16x32_bf16 v[172:175], a[200:203], a[24:27], v[172:175]
  ds_read_b128 a[220:223], v228 offset:11520
  v_add_u32 v228, 16384, v230
  v_mfma_f32_16x16x32_bf16 v[180:183], a[200:203], a[28:31], v[180:183]
  v_xor_b32 v239, 32, v228
  v_mfma_f32_16x16x32_bf16 v[188:191], a[200:203], a[32:35], v[188:191]
  s_waitcnt lgkmcnt(4)
  v_exp_f32 v171, v171
  v_mfma_f32_16x16x32_bf16 v[172:175], a[204:207], a[36:39], v[172:175]
  ds_read_b64_tr_b16 a[192:193], v228 offset:0
  v_add_f32 v234, v169, v234
  v_mfma_f32_16x16x32_bf16 v[180:183], a[204:207], a[40:43], v[180:183]
  ds_read_b64_tr_b16 a[194:195], v228 offset:8192
  v_cvt_pk_bf16_f32 v168, v168, v169
  v_mfma_f32_16x16x32_bf16 v[188:191], a[204:207], a[44:47], v[188:191]
  s_waitcnt lgkmcnt(5)
  v_exp_f32 v176, v176
  v_mfma_f32_16x16x32_bf16 v[172:175], a[208:211], a[48:51], v[172:175]
  ds_read_b64_tr_b16 a[196:197], v239 offset:0
  v_add_f32 v234, v170, v234
  v_mfma_f32_16x16x32_bf16 v[180:183], a[208:211], a[52:55], v[180:183]
  ds_read_b64_tr_b16 a[198:199], v239 offset:8192
  v_add_f32 v234, v171, v234
  v_mfma_f32_16x16x32_bf16 v[188:191], a[208:211], a[56:59], v[188:191]
  s_waitcnt lgkmcnt(6)
  v_exp_f32 v177, v177
  v_mfma_f32_16x16x32_bf16 v[172:175], a[212:215], a[60:63], v[172:175]
  ds_read_b64_tr_b16 a[200:201], v228 offset:256
  v_cvt_pk_bf16_f32 v169, v170, v171
  v_mfma_f32_16x16x32_bf16 v[180:183], a[212:215], a[64:67], v[180:183]
  ds_read_b64_tr_b16 a[202:203], v228 offset:8448
  v_add_f32 v235, v176, v235
  v_mfma_f32_16x16x32_bf16 v[188:191], a[212:215], a[68:71], v[188:191]
  s_waitcnt lgkmcnt(7)
  v_exp_f32 v178, v178
  v_mfma_f32_16x16x32_bf16 v[172:175], a[216:219], a[72:75], v[172:175]
  ds_read_b64_tr_b16 a[204:205], v239 offset:256
  v_add_f32 v235, v177, v235
  v_mfma_f32_16x16x32_bf16 v[180:183], a[216:219], a[76:79], v[180:183]
  ds_read_b64_tr_b16 a[206:207], v239 offset:8448
  v_cvt_pk_bf16_f32 v176, v176, v177
  v_mfma_f32_16x16x32_bf16 v[188:191], a[216:219], a[80:83], v[188:191]
  s_waitcnt lgkmcnt(8)
  v_exp_f32 v179, v179
  v_mfma_f32_16x16x32_bf16 v[172:175], a[220:223], a[84:87], v[172:175]
  ds_read_b64_tr_b16 a[208:209], v228 offset:1024
  v_add_f32 v235, v178, v235
  v_mfma_f32_16x16x32_bf16 v[180:183], a[220:223], a[88:91], v[180:183]
  ds_read_b64_tr_b16 a[210:211], v228 offset:9216
  v_add_f32 v235, v179, v235
  v_mfma_f32_16x16x32_bf16 v[188:191], a[220:223], a[92:95], v[188:191]
  s_waitcnt lgkmcnt(8)
  v_exp_f32 v184, v184
  v_mfma_f32_16x16x32_bf16 v[0:3], a[192:195], v[192:195], v[0:3]
  s_add_u32 m0, s28, 81920
  ds_read_b64_tr_b16 a[212:213], v239 offset:1024
  v_cvt_pk_bf16_f32 v177, v178, v179
  v_mfma_f32_16x16x32_bf16 v[4:7], a[192:195], v[200:203], v[4:7]
  s_mov_b32 s29, 330752
  ds_read_b64_tr_b16 a[214:215], v239 offset:9216
  v_add_f32 v236, v184, v236
  v_mfma_f32_16x16x32_bf16 v[8:11], a[192:195], v[208:211], v[8:11]
  s_waitcnt lgkmcnt(8)
  v_exp_f32 v185, v185
  v_mfma_f32_16x16x32_bf16 v[12:15], a[196:199], v[192:195], v[12:15]
  ds_read_b64_tr_b16 a[216:217], v228 offset:1280
  v_add_f32 v236, v185, v236
  v_mfma_f32_16x16x32_bf16 v[16:19], a[196:199], v[200:203], v[16:19]
  ds_read_b64_tr_b16 a[218:219], v228 offset:9472
  v_cvt_pk_bf16_f32 v184, v184, v185
  v_mfma_f32_16x16x32_bf16 v[20:23], a[196:199], v[208:211], v[20:23]
  s_waitcnt lgkmcnt(8)
  v_exp_f32 v186, v186
  v_mfma_f32_16x16x32_bf16 v[24:27], a[200:203], v[192:195], v[24:27]
  ds_read_b64_tr_b16 a[220:221], v239 offset:1280
  v_add_f32 v236, v186, v236
  v_mfma_f32_16x16x32_bf16 v[28:31], a[200:203], v[200:203], v[28:31]
  buffer_load_dwordx4 v231, s[12:15], s29 offen offset:0 nt lds
  v_mfma_f32_16x16x32_bf16 v[32:35], a[200:203], v[208:211], v[32:35]
  s_waitcnt lgkmcnt(7)
  ds_read_b64_tr_b16 a[222:223], v239 offset:9472
  v_mfma_f32_16x16x32_bf16 v[36:39], a[204:207], v[192:195], v[36:39]
  s_add_u32 s29, s29, s30
  ds_read_b64_tr_b16 a[192:193], v228 offset:2048
  v_mfma_f32_16x16x32_bf16 v[40:43], a[204:207], v[200:203], v[40:43]
  ds_read_b64_tr_b16 a[194:195], v228 offset:10240
  v_mfma_f32_16x16x32_bf16 v[44:47], a[204:207], v[208:211], v[44:47]
  s_waitcnt lgkmcnt(8)
  v_exp_f32 v187, v187
  v_mfma_f32_16x16x32_bf16 v[48:51], a[208:211], v[192:195], v[48:51]
  ds_read_b64_tr_b16 a[196:197], v239 offset:2048
  v_add_f32 v236, v187, v236
  v_mfma_f32_16x16x32_bf16 v[52:55], a[208:211], v[200:203], v[52:55]
  buffer_load_dwordx4 v231, s[12:15], s29 offen offset:1024 nt lds
  v_mfma_f32_16x16x32_bf16 v[56:59], a[208:211], v[208:211], v[56:59]
  s_waitcnt lgkmcnt(7)
  ds_read_b64_tr_b16 a[198:199], v239 offset:10240
  v_cvt_pk_bf16_f32 v185, v186, v187
  v_mfma_f32_16x16x32_bf16 v[60:63], a[212:215], v[192:195], v[60:63]
  s_add_u32 s29, s29, s30
  ds_read_b64_tr_b16 a[200:201], v228 offset:2304
  v_mfma_f32_16x16x32_bf16 v[64:67], a[212:215], v[200:203], v[64:67]
  ds_read_b64_tr_b16 a[202:203], v228 offset:10496
  v_mfma_f32_16x16x32_bf16 v[68:71], a[212:215], v[208:211], v[68:71]
  s_waitcnt lgkmcnt(8)
  v_exp_f32 v172, v172
  v_mfma_f32_16x16x32_bf16 v[72:75], a[216:219], v[192:195], v[72:75]
  ds_read_b64_tr_b16 a[204:205], v239 offset:2304
  v_add_f32 v234, v172, v234
  v_mfma_f32_16x16x32_bf16 v[76:79], a[216:219], v[200:203], v[76:79]
  buffer_load_dwordx4 v231, s[12:15], s29 offen offset:2048 nt lds
  v_mfma_f32_16x16x32_bf16 v[80:83], a[216:219], v[208:211], v[80:83]
  s_waitcnt lgkmcnt(7)
  ds_read_b64_tr_b16 a[206:207], v239 offset:10496
  v_mfma_f32_16x16x32_bf16 v[84:87], a[220:223], v[192:195], v[84:87]
  s_add_u32 s29, s29, s30
  ds_read_b64_tr_b16 a[208:209], v228 offset:3072
  v_mfma_f32_16x16x32_bf16 v[88:91], a[220:223], v[200:203], v[88:91]
  ds_read_b64_tr_b16 a[210:211], v228 offset:11264
  v_mfma_f32_16x16x32_bf16 v[92:95], a[220:223], v[208:211], v[92:95]
  s_waitcnt lgkmcnt(8)
  v_exp_f32 v173, v173
  v_mfma_f32_16x16x32_bf16 v[96:99], a[192:195], v[192:195], v[96:99]
  ds_read_b64_tr_b16 a[212:213], v239 offset:3072
  v_add_f32 v234, v173, v234
  v_mfma_f32_16x16x32_bf16 v[100:103], a[192:195], v[200:203], v[100:103]
  buffer_load_dwordx4 v231, s[12:15], s29 offen offset:3072 nt lds
  v_mfma_f32_16x16x32_bf16 v[104:107], a[192:195], v[208:211], v[104:107]
  s_waitcnt lgkmcnt(7)
  ds_read_b64_tr_b16 a[214:215], v239 offset:11264
  v_cvt_pk_bf16_f32 v170, v172, v173
  v_mfma_f32_16x16x32_bf16 v[108:111], a[196:199], v[192:195], v[108:111]
  s_waitcnt vmcnt(4)
  ds_read_b64_tr_b16 a[216:217], v228 offset:3328
  v_mfma_f32_16x16x32_bf16 v[112:115], a[196:199], v[200:203], v[112:115]
  s_barrier
  ds_read_b64_tr_b16 a[218:219], v228 offset:11520
  v_mfma_f32_16x16x32_bf16 v[116:119], a[196:199], v[208:211], v[116:119]
  s_waitcnt lgkmcnt(8)
  v_exp_f32 v174, v174
  v_mfma_f32_16x16x32_bf16 v[120:123], a[200:203], v[192:195], v[120:123]
  ds_read_b64_tr_b16 a[220:221], v239 offset:3328
  v_add_f32 v234, v174, v234
  v_mfma_f32_16x16x32_bf16 v[124:127], a[200:203], v[200:203], v[124:127]
  ds_read_b64_tr_b16 a[222:223], v239 offset:11520
  v_add_u32 v228, 114688, v229
  v_mfma_f32_16x16x32_bf16 v[128:131], a[200:203], v[208:211], v[128:131]
  s_waitcnt lgkmcnt(8)
  v_exp_f32 v175, v175
  v_mfma_f32_16x16x32_bf16 v[132:135], a[204:207], v[192:195], v[132:135]
  ds_read_b128 a[192:195], v228 offset:0
  v_add_f32 v234, v175, v234
  v_mfma_f32_16x16x32_bf16 v[136:139], a[204:207], v[200:203], v[136:139]
  v_exp_f32 v180, v180
  v_mfma_f32_16x16x32_bf16 v[140:143], a[204:207], v[208:211], v[140:143]
  s_waitcnt lgkmcnt(7)
  v_exp_f32 v181, v181
  v_mfma_f32_16x16x32_bf16 v[144:147], a[208:211], v[192:195], v[144:147]
  ds_read_b128 a[196:199], v228 offset:256
  v_cvt_pk_bf16_f32 v171, v174, v175
  v_mfma_f32_16x16x32_bf16 v[148:151], a[208:211], v[200:203], v[148:151]
  v_exp_f32 v182, v182
  v_mfma_f32_16x16x32_bf16 v[152:155], a[208:211], v[208:211], v[152:155]
  s_waitcnt lgkmcnt(6)
  v_exp_f32 v183, v183
  v_mfma_f32_16x16x32_bf16 v[156:159], a[212:215], v[192:195], v[156:159]
  ds_read_b128 a[200:203], v228 offset:1024
  v_add_f32 v235, v180, v235
  v_mfma_f32_16x16x32_bf16 v[160:163], a[212:215], v[200:203], v[160:163]
  v_exp_f32 v188, v188
  v_mfma_f32_16x16x32_bf16 v[164:167], a[212:215], v[208:211], v[164:167]
  s_waitcnt lgkmcnt(5)
  v_exp_f32 v189, v189
  v_mfma_f32_16x16x32_bf16 a[224:227], a[216:219], v[192:195], a[224:227]
  ds_read_b128 a[204:207], v228 offset:1280
  v_add_f32 v235, v181, v235
  v_mfma_f32_16x16x32_bf16 a[228:231], a[216:219], v[200:203], a[228:231]
  v_exp_f32 v190, v190
  v_mfma_f32_16x16x32_bf16 a[232:235], a[216:219], v[208:211], a[232:235]
  s_waitcnt lgkmcnt(4)
  v_exp_f32 v191, v191
  v_mfma_f32_16x16x32_bf16 a[236:239], a[220:223], v[192:195], a[236:239]
  ds_read_b128 a[208:211], v228 offset:2048
  v_cvt_pk_bf16_f32 v178, v180, v181
  v_mfma_f32_16x16x32_bf16 a[240:243], a[220:223], v[200:203], a[240:243]
  v_add_f32 v235, v182, v235
  v_add_f32 v236, v188, v236
  v_mfma_f32_16x16x32_bf16 a[244:247], a[220:223], v[208:211], a[244:247]
  s_waitcnt lgkmcnt(4)
  v_add_f32 v235, v183, v235
  v_add_f32 v236, v189, v236
  v_mfma_f32_16x16x32_bf16 v[192:195], a[192:195], a[0:3], v[216:219]
  s_add_u32 m0, s28, 0
  ds_read_b128 a[212:215], v228 offset:2304
  v_cvt_pk_bf16_f32 v179, v182, v183
  v_mfma_f32_16x16x32_bf16 v[200:203], a[192:195], a[4:7], v[220:223]
  s_mov_b32 s29, 363520
  v_cvt_pk_bf16_f32 v186, v188, v189
  v_add_f32 v236, v190, v236
  v_mfma_f32_16x16x32_bf16 v[208:211], a[192:195], a[8:11], v[224:227]
  s_waitcnt lgkmcnt(4)
  v_add_f32 v236, v191, v236
  v_sub_u32 v241, s35, v240
  v_mfma_f32_16x16x32_bf16 v[192:195], a[196:199], a[12:15], v[192:195]
  ds_read_b128 a[216:219], v228 offset:3072
  v_cvt_pk_bf16_f32 v187, v190, v191
  v_mfma_f32_16x16x32_bf16 v[200:203], a[196:199], a[16:19], v[200:203]
  v_add_u32 v241, 6, v241
  v_mfma_f32_16x16x32_bf16 v[208:211], a[196:199], a[20:23], v[208:211]
  s_waitcnt lgkmcnt(4)
  v_subrev_u32 v242, 7, v241
  v_mfma_f32_16x16x32_bf16 v[192:195], a[200:203], a[24:27], v[192:195]
  ds_read_b128 a[220:223], v228 offset:3328
  v_min_u32 v241, v241, v242
  v_mfma_f32_16x16x32_bf16 v[200:203], a[200:203], a[28:31], v[200:203]
  buffer_load_dwordx4 v231, s[8:11], s29 offen offset:0 nt lds
  v_mfma_f32_16x16x32_bf16 v[208:211], a[200:203], a[32:35], v[208:211]
  s_waitcnt lgkmcnt(4)
  v_mfma_f32_16x16x32_bf16 v[192:195], a[204:207], a[36:39], v[192:195]
  s_add_u32 s29, s29, s30
  ds_read_b128 a[192:195], v228 offset:8192
  v_mfma_f32_16x16x32_bf16 v[200:203], a[204:207], a[40:43], v[200:203]
  v_mfma_f32_16x16x32_bf16 v[208:211], a[204:207], a[44:47], v[208:211]
  s_waitcnt lgkmcnt(4)
  v_mfma_f32_16x16x32_bf16 v[192:195], a[208:211], a[48:51], v[192:195]
  ds_read_b128 a[196:199], v228 offset:8448
  v_mfma_f32_16x16x32_bf16 v[200:203], a[208:211], a[52:55], v[200:203]
  buffer_load_dwordx4 v231, s[8:11], s29 offen offset:1024 nt lds
  v_mfma_f32_16x16x32_bf16 v[208:211], a[208:211], a[56:59], v[208:211]
  s_waitcnt lgkmcnt(4)
  v_mfma_f32_16x16x32_bf16 v[192:195], a[212:215], a[60:63], v[192:195]
  s_add_u32 s29, s29, s30
  ds_read_b128 a[200:203], v228 offset:9216
  v_mfma_f32_16x16x32_bf16 v[200:203], a[212:215], a[64:67], v[200:203]
  v_mfma_f32_16x16x32_bf16 v[208:211], a[212:215], a[68:71], v[208:211]
  s_waitcnt lgkmcnt(4)
  v_mfma_f32_16x16x32_bf16 v[192:195], a[216:219], a[72:75], v[192:195]
  ds_read_b128 a[204:207], v228 offset:9472
  v_mfma_f32_16x16x32_bf16 v[200:203], a[216:219], a[76:79], v[200:203]
  buffer_load_dwordx4 v231, s[8:11], s29 offen offset:2048 nt lds
  v_mfma_f32_16x16x32_bf16 v[208:211], a[216:219], a[80:83], v[208:211]
  s_waitcnt lgkmcnt(4)
  v_mfma_f32_16x16x32_bf16 v[192:195], a[220:223], a[84:87], v[192:195]
  s_add_u32 s29, s29, s30
  ds_read_b128 a[208:211], v228 offset:10240
  v_mfma_f32_16x16x32_bf16 v[200:203], a[220:223], a[88:91], v[200:203]
  v_mfma_f32_16x16x32_bf16 v[208:211], a[220:223], a[92:95], v[208:211]
  s_waitcnt lgkmcnt(4)
  v_mfma_f32_16x16x32_bf16 v[196:199], a[192:195], a[0:3], v[216:219]
  ds_read_b128 a[212:215], v228 offset:10496
  v_mfma_f32_16x16x32_bf16 v[204:207], a[192:195], a[4:7], v[220:223]
  buffer_load_dwordx4 v231, s[8:11], s29 offen offset:3072 nt lds
  v_mfma_f32_16x16x32_bf16 v[212:215], a[192:195], a[8:11], v[224:227]
  s_waitcnt lgkmcnt(4)
  v_exp_f32 v192, v192
  v_mfma_f32_16x16x32_bf16 v[196:199], a[196:199], a[12:15], v[196:199]
  s_waitcnt vmcnt(4)
  ds_read_b128 a[216:219], v228 offset:11264
  v_add_f32 v234, v192, v234
  v_mfma_f32_16x16x32_bf16 v[204:207], a[196:199], a[16:19], v[204:207]
  s_barrier
  v_exp_f32 v193, v193
  v_mfma_f32_16x16x32_bf16 v[212:215], a[196:199], a[20:23], v[212:215]
  s_waitcnt lgkmcnt(4)
  v_exp_f32 v194, v194
  v_mfma_f32_16x16x32_bf16 v[196:199], a[200:203], a[24:27], v[196:199]
  ds_read_b128 a[220:223], v228 offset:11520
  v_add_u32 v228, 81920, v230
  v_mfma_f32_16x16x32_bf16 v[204:207], a[200:203], a[28:31], v[204:207]
  v_xor_b32 v239, 32, v228
  v_mfma_f32_16x16x32_bf16 v[212:215], a[200:203], a[32:35], v[212:215]
  s_waitcnt lgkmcnt(4)
  v_exp_f32 v195, v195
  v_mfma_f32_16x16x32_bf16 v[196:199], a[204:207], a[36:39], v[196:199]
  ds_read_b64_tr_b16 a[192:193], v228 offset:0
  v_add_f32 v234, v193, v234
  v_mfma_f32_16x16x32_bf16 v[204:207], a[204:207], a[40:43], v[204:207]
  ds_read_b64_tr_b16 a[194:195], v228 offset:8192
  v_cvt_pk_bf16_f32 v192, v192, v193
  v_mfma_f32_16x16x32_bf16 v[212:215], a[204:207], a[44:47], v[212:215]
  s_waitcnt lgkmcnt(5)
  v_exp_f32 v200, v200
  v_mfma_f32_16x16x32_bf16 v[196:199], a[208:211], a[48:51], v[196:199]
  ds_read_b64_tr_b16 a[196:197], v239 offset:0
  v_add_f32 v234, v194, v234
  v_mfma_f32_16x16x32_bf16 v[204:207], a[208:211], a[52:55], v[204:207]
  ds_read_b64_tr_b16 a[198:199], v239 offset:8192
  v_add_f32 v234, v195, v234
  v_mfma_f32_16x16x32_bf16 v[212:215], a[208:211], a[56:59], v[212:215]
  s_waitcnt lgkmcnt(6)
  v_exp_f32 v201, v201
  v_mfma_f32_16x16x32_bf16 v[196:199], a[212:215], a[60:63], v[196:199]
  ds_read_b64_tr_b16 a[200:201], v228 offset:256
  v_cvt_pk_bf16_f32 v193, v194, v195
  v_mfma_f32_16x16x32_bf16 v[204:207], a[212:215], a[64:67], v[204:207]
  ds_read_b64_tr_b16 a[202:203], v228 offset:8448
  v_add_f32 v235, v200, v235
  v_mfma_f32_16x16x32_bf16 v[212:215], a[212:215], a[68:71], v[212:215]
  s_waitcnt lgkmcnt(7)
  v_exp_f32 v202, v202
  v_mfma_f32_16x16x32_bf16 v[196:199], a[216:219], a[72:75], v[196:199]
  ds_read_b64_tr_b16 a[204:205], v239 offset:256
  v_add_f32 v235, v201, v235
  v_mfma_f32_16x16x32_bf16 v[204:207], a[216:219], a[76:79], v[204:207]
  ds_read_b64_tr_b16 a[206:207], v239 offset:8448
  v_cvt_pk_bf16_f32 v200, v200, v201
  v_mfma_f32_16x16x32_bf16 v[212:215], a[216:219], a[80:83], v[212:215]
  s_waitcnt lgkmcnt(8)
  v_exp_f32 v203, v203
  v_mfma_f32_16x16x32_bf16 v[196:199], a[220:223], a[84:87], v[196:199]
  ds_read_b64_tr_b16 a[208:209], v228 offset:1024
  v_add_f32 v235, v202, v235
  v_mfma_f32_16x16x32_bf16 v[204:207], a[220:223], a[88:91], v[204:207]
  ds_read_b64_tr_b16 a[210:211], v228 offset:9216
  v_add_f32 v235, v203, v235
  v_mfma_f32_16x16x32_bf16 v[212:215], a[220:223], a[92:95], v[212:215]
  s_waitcnt lgkmcnt(8)
  v_exp_f32 v208, v208
  v_mfma_f32_16x16x32_bf16 v[0:3], a[192:195], v[168:171], v[0:3]
  s_add_u32 m0, s28, 98304
  ds_read_b64_tr_b16 a[212:213], v239 offset:1024
  v_cvt_pk_bf16_f32 v201, v202, v203
  v_mfma_f32_16x16x32_bf16 v[4:7], a[192:195], v[176:179], v[4:7]
  s_mov_b32 s29, 347136
  ds_read_b64_tr_b16 a[214:215], v239 offset:9216
  v_add_f32 v236, v208, v236
  v_mfma_f32_16x16x32_bf16 v[8:11], a[192:195], v[184:187], v[8:11]
  s_waitcnt lgkmcnt(8)
  v_exp_f32 v209, v209
  v_mfma_f32_16x16x32_bf16 v[12:15], a[196:199], v[168:171], v[12:15]
  ds_read_b64_tr_b16 a[216:217], v228 offset:1280
  v_add_f32 v236, v209, v236
  v_mfma_f32_16x16x32_bf16 v[16:19], a[196:199], v[176:179], v[16:19]
  ds_read_b64_tr_b16 a[218:219], v228 offset:9472
  v_cvt_pk_bf16_f32 v208, v208, v209
  v_mfma_f32_16x16x32_bf16 v[20:23], a[196:199], v[184:187], v[20:23]
  s_waitcnt lgkmcnt(8)
  v_exp_f32 v210, v210
  v_mfma_f32_16x16x32_bf16 v[24:27], a[200:203], v[168:171], v[24:27]
  ds_read_b64_tr_b16 a[220:221], v239 offset:1280
  v_add_f32 v236, v210, v236
  v_mfma_f32_16x16x32_bf16 v[28:31], a[200:203], v[176:179], v[28:31]
  buffer_load_dwordx4 v231, s[12:15], s29 offen offset:0 nt lds
  v_mfma_f32_16x16x32_bf16 v[32:35], a[200:203], v[184:187], v[32:35]
  s_waitcnt lgkmcnt(7)
  ds_read_b64_tr_b16 a[222:223], v239 offset:9472
  v_mfma_f32_16x16x32_bf16 v[36:39], a[204:207], v[168:171], v[36:39]
  s_add_u32 s29, s29, s30
  ds_read_b64_tr_b16 a[192:193], v228 offset:2048
  v_mfma_f32_16x16x32_bf16 v[40:43], a[204:207], v[176:179], v[40:43]
  ds_read_b64_tr_b16 a[194:195], v228 offset:10240
  v_mfma_f32_16x16x32_bf16 v[44:47], a[204:207], v[184:187], v[44:47]
  s_waitcnt lgkmcnt(8)
  v_exp_f32 v211, v211
  v_mfma_f32_16x16x32_bf16 v[48:51], a[208:211], v[168:171], v[48:51]
  ds_read_b64_tr_b16 a[196:197], v239 offset:2048
  v_add_f32 v236, v211, v236
  v_mfma_f32_16x16x32_bf16 v[52:55], a[208:211], v[176:179], v[52:55]
  buffer_load_dwordx4 v231, s[12:15], s29 offen offset:1024 nt lds
  v_mfma_f32_16x16x32_bf16 v[56:59], a[208:211], v[184:187], v[56:59]
  s_waitcnt lgkmcnt(7)
  ds_read_b64_tr_b16 a[198:199], v239 offset:10240
  v_cvt_pk_bf16_f32 v209, v210, v211
  v_mfma_f32_16x16x32_bf16 v[60:63], a[212:215], v[168:171], v[60:63]
  s_add_u32 s29, s29, s30
  ds_read_b64_tr_b16 a[200:201], v228 offset:2304
  v_mfma_f32_16x16x32_bf16 v[64:67], a[212:215], v[176:179], v[64:67]
  ds_read_b64_tr_b16 a[202:203], v228 offset:10496
  v_mfma_f32_16x16x32_bf16 v[68:71], a[212:215], v[184:187], v[68:71]
  s_waitcnt lgkmcnt(8)
  v_exp_f32 v196, v196
  v_mfma_f32_16x16x32_bf16 v[72:75], a[216:219], v[168:171], v[72:75]
  ds_read_b64_tr_b16 a[204:205], v239 offset:2304
  v_add_f32 v234, v196, v234
  v_mfma_f32_16x16x32_bf16 v[76:79], a[216:219], v[176:179], v[76:79]
  buffer_load_dwordx4 v231, s[12:15], s29 offen offset:2048 nt lds
  v_mfma_f32_16x16x32_bf16 v[80:83], a[216:219], v[184:187], v[80:83]
  s_waitcnt lgkmcnt(7)
  ds_read_b64_tr_b16 a[206:207], v239 offset:10496
  v_mfma_f32_16x16x32_bf16 v[84:87], a[220:223], v[168:171], v[84:87]
  s_add_u32 s29, s29, s30
  ds_read_b64_tr_b16 a[208:209], v228 offset:3072
  v_mfma_f32_16x16x32_bf16 v[88:91], a[220:223], v[176:179], v[88:91]
  ds_read_b64_tr_b16 a[210:211], v228 offset:11264
  v_mfma_f32_16x16x32_bf16 v[92:95], a[220:223], v[184:187], v[92:95]
  s_waitcnt lgkmcnt(8)
  v_exp_f32 v197, v197
  v_mfma_f32_16x16x32_bf16 v[96:99], a[192:195], v[168:171], v[96:99]
  ds_read_b64_tr_b16 a[212:213], v239 offset:3072
  v_add_f32 v234, v197, v234
  v_mfma_f32_16x16x32_bf16 v[100:103], a[192:195], v[176:179], v[100:103]
  buffer_load_dwordx4 v231, s[12:15], s29 offen offset:3072 nt lds
  v_mfma_f32_16x16x32_bf16 v[104:107], a[192:195], v[184:187], v[104:107]
  s_waitcnt lgkmcnt(7)
  ds_read_b64_tr_b16 a[214:215], v239 offset:11264
  v_cvt_pk_bf16_f32 v194, v196, v197
  v_mfma_f32_16x16x32_bf16 v[108:111], a[196:199], v[168:171], v[108:111]
  s_waitcnt vmcnt(4)
  ds_read_b64_tr_b16 a[216:217], v228 offset:3328
  v_mfma_f32_16x16x32_bf16 v[112:115], a[196:199], v[176:179], v[112:115]
  s_barrier
  ds_read_b64_tr_b16 a[218:219], v228 offset:11520
  v_mfma_f32_16x16x32_bf16 v[116:119], a[196:199], v[184:187], v[116:119]
  s_waitcnt lgkmcnt(8)
  v_exp_f32 v198, v198
  v_mfma_f32_16x16x32_bf16 v[120:123], a[200:203], v[168:171], v[120:123]
  ds_read_b64_tr_b16 a[220:221], v239 offset:3328
  v_add_f32 v234, v198, v234
  v_mfma_f32_16x16x32_bf16 v[124:127], a[200:203], v[176:179], v[124:127]
  ds_read_b64_tr_b16 a[222:223], v239 offset:11520
  v_add_u32 v228, 0, v229
  v_mfma_f32_16x16x32_bf16 v[128:131], a[200:203], v[184:187], v[128:131]
  s_waitcnt lgkmcnt(8)
  v_exp_f32 v199, v199
  v_mfma_f32_16x16x32_bf16 v[132:135], a[204:207], v[168:171], v[132:135]
  ds_read_b128 a[192:195], v228 offset:0
  v_add_f32 v234, v199, v234
  v_mfma_f32_16x16x32_bf16 v[136:139], a[204:207], v[176:179], v[136:139]
  v_exp_f32 v204, v204
  v_mfma_f32_16x16x32_bf16 v[140:143], a[204:207], v[184:187], v[140:143]
  s_waitcnt lgkmcnt(7)
  v_exp_f32 v205, v205
  v_mfma_f32_16x16x32_bf16 v[144:147], a[208:211], v[168:171], v[144:147]
  ds_read_b128 a[196:199], v228 offset:256
  v_cvt_pk_bf16_f32 v195, v198, v199
  v_mfma_f32_16x16x32_bf16 v[148:151], a[208:211], v[176:179], v[148:151]
  v_exp_f32 v206, v206
  v_mfma_f32_16x16x32_bf16 v[152:155], a[208:211], v[184:187], v[152:155]
  s_waitcnt lgkmcnt(6)
  v_exp_f32 v207, v207
  v_mfma_f32_16x16x32_bf16 v[156:159], a[212:215], v[168:171], v[156:159]
  ds_read_b128 a[200:203], v228 offset:1024
  v_add_f32 v235, v204, v235
  v_mfma_f32_16x16x32_bf16 v[160:163], a[212:215], v[176:179], v[160:163]
  v_exp_f32 v212, v212
  v_mfma_f32_16x16x32_bf16 v[164:167], a[212:215], v[184:187], v[164:167]
  s_waitcnt lgkmcnt(5)
  v_exp_f32 v213, v213
  v_mfma_f32_16x16x32_bf16 a[224:227], a[216:219], v[168:171], a[224:227]
  ds_read_b128 a[204:207], v228 offset:1280
  v_add_f32 v235, v205, v235
  v_mfma_f32_16x16x32_bf16 a[228:231], a[216:219], v[176:179], a[228:231]
  v_exp_f32 v214, v214
  v_mfma_f32_16x16x32_bf16 a[232:235], a[216:219], v[184:187], a[232:235]
  s_waitcnt lgkmcnt(4)
  v_exp_f32 v215, v215
  v_mfma_f32_16x16x32_bf16 a[236:239], a[220:223], v[168:171], a[236:239]
  ds_read_b128 a[208:211], v228 offset:2048
  v_cvt_pk_bf16_f32 v202, v204, v205
  v_mfma_f32_16x16x32_bf16 a[240:243], a[220:223], v[176:179], a[240:243]
  v_add_f32 v235, v206, v235
  v_add_f32 v236, v212, v236
  v_mfma_f32_16x16x32_bf16 a[244:247], a[220:223], v[184:187], a[244:247]
  s_waitcnt lgkmcnt(4)
  v_add_f32 v235, v207, v235
  v_add_f32 v236, v213, v236
  v_mfma_f32_16x16x32_bf16 v[168:171], a[192:195], a[0:3], v[216:219]
  s_add_u32 m0, s28, 16384
  ds_read_b128 a[212:215], v228 offset:2304
  v_cvt_pk_bf16_f32 v203, v206, v207
  v_mfma_f32_16x16x32_bf16 v[176:179], a[192:195], a[4:7], v[220:223]
  s_mov_b32 s29, 379904
  v_cvt_pk_bf16_f32 v210, v212, v213
  v_add_f32 v236, v214, v236
  v_mfma_f32_16x16x32_bf16 v[184:187], a[192:195], a[8:11], v[224:227]
  s_waitcnt lgkmcnt(4)
  v_add_f32 v236, v215, v236
  v_cmp_eq_u32 vcc, 6, v240
  v_mfma_f32_16x16x32_bf16 v[168:171], a[196:199], a[12:15], v[168:171]
  ds_read_b128 a[216:219], v228 offset:3072
  v_cvt_pk_bf16_f32 v211, v214, v215
  v_mfma_f32_16x16x32_bf16 v[176:179], a[196:199], a[16:19], v[176:179]
  v_mov_b32 v242, 7
  v_mfma_f32_16x16x32_bf16 v[184:187], a[196:199], a[20:23], v[184:187]
  s_waitcnt lgkmcnt(4)
  v_mov_b32 v243, s58
  v_mfma_f32_16x16x32_bf16 v[168:171], a[200:203], a[24:27], v[168:171]
  ds_read_b128 a[220:223], v228 offset:3328
  v_cndmask_b32 v241, v241, v242, vcc
  v_mfma_f32_16x16x32_bf16 v[176:179], a[200:203], a[28:31], v[176:179]
  buffer_load_dwordx4 v231, s[8:11], s29 offen offset:0 nt lds
  v_mfma_f32_16x16x32_bf16 v[184:187], a[200:203], a[32:35], v[184:187]
  s_waitcnt lgkmcnt(4)
  v_mfma_f32_16x16x32_bf16 v[168:171], a[204:207], a[36:39], v[168:171]
  s_add_u32 s29, s29, s30
  ds_read_b128 a[192:195], v228 offset:8192
  v_mfma_f32_16x16x32_bf16 v[176:179], a[204:207], a[40:43], v[176:179]
  v_mfma_f32_16x16x32_bf16 v[184:187], a[204:207], a[44:47], v[184:187]
  s_waitcnt lgkmcnt(4)
  v_mfma_f32_16x16x32_bf16 v[168:171], a[208:211], a[48:51], v[168:171]
  ds_read_b128 a[196:199], v228 offset:8448
  v_mfma_f32_16x16x32_bf16 v[176:179], a[208:211], a[52:55], v[176:179]
  buffer_load_dwordx4 v231, s[8:11], s29 offen offset:1024 nt lds
  v_mfma_f32_16x16x32_bf16 v[184:187], a[208:211], a[56:59], v[184:187]
  s_waitcnt lgkmcnt(4)
  v_mfma_f32_16x16x32_bf16 v[168:171], a[212:215], a[60:63], v[168:171]
  s_add_u32 s29, s29, s30
  ds_read_b128 a[200:203], v228 offset:9216
  v_mfma_f32_16x16x32_bf16 v[176:179], a[212:215], a[64:67], v[176:179]
  v_mfma_f32_16x16x32_bf16 v[184:187], a[212:215], a[68:71], v[184:187]
  s_waitcnt lgkmcnt(4)
  v_mfma_f32_16x16x32_bf16 v[168:171], a[216:219], a[72:75], v[168:171]
  ds_read_b128 a[204:207], v228 offset:9472
  v_mfma_f32_16x16x32_bf16 v[176:179], a[216:219], a[76:79], v[176:179]
  buffer_load_dwordx4 v231, s[8:11], s29 offen offset:2048 nt lds
  v_mfma_f32_16x16x32_bf16 v[184:187], a[216:219], a[80:83], v[184:187]
  s_waitcnt lgkmcnt(4)
  v_mfma_f32_16x16x32_bf16 v[168:171], a[220:223], a[84:87], v[168:171]
  s_add_u32 s29, s29, s30
  ds_read_b128 a[208:211], v228 offset:10240
  v_mfma_f32_16x16x32_bf16 v[176:179], a[220:223], a[88:91], v[176:179]
  v_mfma_f32_16x16x32_bf16 v[184:187], a[220:223], a[92:95], v[184:187]
  s_waitcnt lgkmcnt(4)
  v_mfma_f32_16x16x32_bf16 v[172:175], a[192:195], a[0:3], v[216:219]
  ds_read_b128 a[212:215], v228 offset:10496
  v_mfma_f32_16x16x32_bf16 v[180:183], a[192:195], a[4:7], v[220:223]
  buffer_load_dwordx4 v231, s[8:11], s29 offen offset:3072 nt lds
  v_mfma_f32_16x16x32_bf16 v[188:191], a[192:195], a[8:11], v[224:227]
  s_waitcnt lgkmcnt(4)
  v_exp_f32 v168, v168
  v_mfma_f32_16x16x32_bf16 v[172:175], a[196:199], a[12:15], v[172:175]
  s_waitcnt vmcnt(4)
  ds_read_b128 a[216:219], v228 offset:11264
  v_add_f32 v234, v168, v234
  v_mfma_f32_16x16x32_bf16 v[180:183], a[196:199], a[16:19], v[180:183]
  s_barrier
  v_exp_f32 v169, v169
  v_mfma_f32_16x16x32_bf16 v[188:191], a[196:199], a[20:23], v[188:191]
  s_waitcnt lgkmcnt(4)
  v_exp_f32 v170, v170
  v_mfma_f32_16x16x32_bf16 v[172:175], a[200:203], a[24:27], v[172:175]
  ds_read_b128 a[220:223], v228 offset:11520
  v_add_u32 v228, 98304, v230
  v_mfma_f32_16x16x32_bf16 v[180:183], a[200:203], a[28:31], v[180:183]
  v_xor_b32 v239, 32, v228
  v_mfma_f32_16x16x32_bf16 v[188:191], a[200:203], a[32:35], v[188:191]
  s_waitcnt lgkmcnt(4)
  v_exp_f32 v171, v171
  v_mfma_f32_16x16x32_bf16 v[172:175], a[204:207], a[36:39], v[172:175]
  ds_read_b64_tr_b16 a[192:193], v228 offset:0
  v_add_f32 v234, v169, v234
  v_mfma_f32_16x16x32_bf16 v[180:183], a[204:207], a[40:43], v[180:183]
  ds_read_b64_tr_b16 a[194:195], v228 offset:8192
  v_cvt_pk_bf16_f32 v168, v168, v169
  v_mfma_f32_16x16x32_bf16 v[188:191], a[204:207], a[44:47], v[188:191]
  s_waitcnt lgkmcnt(5)
  v_exp_f32 v176, v176
  v_mfma_f32_16x16x32_bf16 v[172:175], a[208:211], a[48:51], v[172:175]
  ds_read_b64_tr_b16 a[196:197], v239 offset:0
  v_add_f32 v234, v170, v234
  v_mfma_f32_16x16x32_bf16 v[180:183], a[208:211], a[52:55], v[180:183]
  ds_read_b64_tr_b16 a[198:199], v239 offset:8192
  v_add_f32 v234, v171, v234
  v_mfma_f32_16x16x32_bf16 v[188:191], a[208:211], a[56:59], v[188:191]
  s_waitcnt lgkmcnt(6)
  v_exp_f32 v177, v177
  v_mfma_f32_16x16x32_bf16 v[172:175], a[212:215], a[60:63], v[172:175]
  ds_read_b64_tr_b16 a[200:201], v228 offset:256
  v_cvt_pk_bf16_f32 v169, v170, v171
  v_mfma_f32_16x16x32_bf16 v[180:183], a[212:215], a[64:67], v[180:183]
  ds_read_b64_tr_b16 a[202:203], v228 offset:8448
  v_add_f32 v235, v176, v235
  v_mfma_f32_16x16x32_bf16 v[188:191], a[212:215], a[68:71], v[188:191]
  s_waitcnt lgkmcnt(7)
  v_exp_f32 v178, v178
  v_mfma_f32_16x16x32_bf16 v[172:175], a[216:219], a[72:75], v[172:175]
  ds_read_b64_tr_b16 a[204:205], v239 offset:256
  v_add_f32 v235, v177, v235
  v_mfma_f32_16x16x32_bf16 v[180:183], a[216:219], a[76:79], v[180:183]
  ds_read_b64_tr_b16 a[206:207], v239 offset:8448
  v_cvt_pk_bf16_f32 v176, v176, v177
  v_mfma_f32_16x16x32_bf16 v[188:191], a[216:219], a[80:83], v[188:191]
  s_waitcnt lgkmcnt(8)
  v_exp_f32 v179, v179
  v_mfma_f32_16x16x32_bf16 v[172:175], a[220:223], a[84:87], v[172:175]
  ds_read_b64_tr_b16 a[208:209], v228 offset:1024
  v_add_f32 v235, v178, v235
  v_mfma_f32_16x16x32_bf16 v[180:183], a[220:223], a[88:91], v[180:183]
  ds_read_b64_tr_b16 a[210:211], v228 offset:9216
  v_add_f32 v235, v179, v235
  v_mfma_f32_16x16x32_bf16 v[188:191], a[220:223], a[92:95], v[188:191]
  s_waitcnt lgkmcnt(8)
  v_exp_f32 v184, v184
  v_mfma_f32_16x16x32_bf16 v[0:3], a[192:195], v[192:195], v[0:3]
  s_add_u32 m0, s28, 114688
  ds_read_b64_tr_b16 a[212:213], v239 offset:1024
  v_cvt_pk_bf16_f32 v177, v178, v179
  v_mfma_f32_16x16x32_bf16 v[4:7], a[192:195], v[200:203], v[4:7]
  s_mov_b32 s29, 363520
  ds_read_b64_tr_b16 a[214:215], v239 offset:9216
  v_add_f32 v236, v184, v236
  v_mfma_f32_16x16x32_bf16 v[8:11], a[192:195], v[208:211], v[8:11]
  s_waitcnt lgkmcnt(8)
  v_exp_f32 v185, v185
  v_mfma_f32_16x16x32_bf16 v[12:15], a[196:199], v[192:195], v[12:15]
  ds_read_b64_tr_b16 a[216:217], v228 offset:1280
  v_add_f32 v236, v185, v236
  v_mfma_f32_16x16x32_bf16 v[16:19], a[196:199], v[200:203], v[16:19]
  ds_read_b64_tr_b16 a[218:219], v228 offset:9472
  v_cvt_pk_bf16_f32 v184, v184, v185
  v_mfma_f32_16x16x32_bf16 v[20:23], a[196:199], v[208:211], v[20:23]
  s_waitcnt lgkmcnt(8)
  v_exp_f32 v186, v186
  v_mfma_f32_16x16x32_bf16 v[24:27], a[200:203], v[192:195], v[24:27]
  ds_read_b64_tr_b16 a[220:221], v239 offset:1280
  v_add_f32 v236, v186, v236
  v_mfma_f32_16x16x32_bf16 v[28:31], a[200:203], v[200:203], v[28:31]
  buffer_load_dwordx4 v231, s[12:15], s29 offen offset:0 nt lds
  v_mfma_f32_16x16x32_bf16 v[32:35], a[200:203], v[208:211], v[32:35]
  s_waitcnt lgkmcnt(7)
  ds_read_b64_tr_b16 a[222:223], v239 offset:9472
  v_mfma_f32_16x16x32_bf16 v[36:39], a[204:207], v[192:195], v[36:39]
  s_add_u32 s29, s29, s30
  ds_read_b64_tr_b16 a[192:193], v228 offset:2048
  v_mfma_f32_16x16x32_bf16 v[40:43], a[204:207], v[200:203], v[40:43]
  ds_read_b64_tr_b16 a[194:195], v228 offset:10240
  v_mfma_f32_16x16x32_bf16 v[44:47], a[204:207], v[208:211], v[44:47]
  s_waitcnt lgkmcnt(8)
  v_exp_f32 v187, v187
  v_mfma_f32_16x16x32_bf16 v[48:51], a[208:211], v[192:195], v[48:51]
  ds_read_b64_tr_b16 a[196:197], v239 offset:2048
  v_add_f32 v236, v187, v236
  v_mfma_f32_16x16x32_bf16 v[52:55], a[208:211], v[200:203], v[52:55]
  buffer_load_dwordx4 v231, s[12:15], s29 offen offset:1024 nt lds
  v_mfma_f32_16x16x32_bf16 v[56:59], a[208:211], v[208:211], v[56:59]
  s_waitcnt lgkmcnt(7)
  ds_read_b64_tr_b16 a[198:199], v239 offset:10240
  v_cvt_pk_bf16_f32 v185, v186, v187
  v_mfma_f32_16x16x32_bf16 v[60:63], a[212:215], v[192:195], v[60:63]
  s_add_u32 s29, s29, s30
  ds_read_b64_tr_b16 a[200:201], v228 offset:2304
  v_mfma_f32_16x16x32_bf16 v[64:67], a[212:215], v[200:203], v[64:67]
  ds_read_b64_tr_b16 a[202:203], v228 offset:10496
  v_mfma_f32_16x16x32_bf16 v[68:71], a[212:215], v[208:211], v[68:71]
  s_waitcnt lgkmcnt(8)
  v_exp_f32 v172, v172
  v_mfma_f32_16x16x32_bf16 v[72:75], a[216:219], v[192:195], v[72:75]
  ds_read_b64_tr_b16 a[204:205], v239 offset:2304
  v_add_f32 v234, v172, v234
  v_mfma_f32_16x16x32_bf16 v[76:79], a[216:219], v[200:203], v[76:79]
  buffer_load_dwordx4 v231, s[12:15], s29 offen offset:2048 nt lds
  v_mfma_f32_16x16x32_bf16 v[80:83], a[216:219], v[208:211], v[80:83]
  s_waitcnt lgkmcnt(7)
  ds_read_b64_tr_b16 a[206:207], v239 offset:10496
  v_mfma_f32_16x16x32_bf16 v[84:87], a[220:223], v[192:195], v[84:87]
  s_add_u32 s29, s29, s30
  ds_read_b64_tr_b16 a[208:209], v228 offset:3072
  v_mfma_f32_16x16x32_bf16 v[88:91], a[220:223], v[200:203], v[88:91]
  ds_read_b64_tr_b16 a[210:211], v228 offset:11264
  v_mfma_f32_16x16x32_bf16 v[92:95], a[220:223], v[208:211], v[92:95]
  s_waitcnt lgkmcnt(8)
  v_exp_f32 v173, v173
  v_mfma_f32_16x16x32_bf16 v[96:99], a[192:195], v[192:195], v[96:99]
  ds_read_b64_tr_b16 a[212:213], v239 offset:3072
  v_add_f32 v234, v173, v234
  v_mfma_f32_16x16x32_bf16 v[100:103], a[192:195], v[200:203], v[100:103]
  buffer_load_dwordx4 v231, s[12:15], s29 offen offset:3072 nt lds
  v_mfma_f32_16x16x32_bf16 v[104:107], a[192:195], v[208:211], v[104:107]
  s_waitcnt lgkmcnt(7)
  ds_read_b64_tr_b16 a[214:215], v239 offset:11264
  v_cvt_pk_bf16_f32 v170, v172, v173
  v_mfma_f32_16x16x32_bf16 v[108:111], a[196:199], v[192:195], v[108:111]
  s_waitcnt vmcnt(4)
  ds_read_b64_tr_b16 a[216:217], v228 offset:3328
  v_mfma_f32_16x16x32_bf16 v[112:115], a[196:199], v[200:203], v[112:115]
  s_barrier
  ds_read_b64_tr_b16 a[218:219], v228 offset:11520
  v_mfma_f32_16x16x32_bf16 v[116:119], a[196:199], v[208:211], v[116:119]
  s_waitcnt lgkmcnt(8)
  v_exp_f32 v174, v174
  v_mfma_f32_16x16x32_bf16 v[120:123], a[200:203], v[192:195], v[120:123]
  ds_read_b64_tr_b16 a[220:221], v239 offset:3328
  v_add_f32 v234, v174, v234
  v_mfma_f32_16x16x32_bf16 v[124:127], a[200:203], v[200:203], v[124:127]
  ds_read_b64_tr_b16 a[222:223], v239 offset:11520
  v_add_u32 v228, 16384, v229
  v_mfma_f32_16x16x32_bf16 v[128:131], a[200:203], v[208:211], v[128:131]
  s_waitcnt lgkmcnt(8)
  v_exp_f32 v175, v175
  v_mfma_f32_16x16x32_bf16 v[132:135], a[204:207], v[192:195], v[132:135]
  ds_read_b128 a[192:195], v228 offset:0
  v_add_f32 v234, v175, v234
  v_mfma_f32_16x16x32_bf16 v[136:139], a[204:207], v[200:203], v[136:139]
  v_exp_f32 v180, v180
  v_mfma_f32_16x16x32_bf16 v[140:143], a[204:207], v[208:211], v[140:143]
  s_waitcnt lgkmcnt(7)
  v_exp_f32 v181, v181
  v_mfma_f32_16x16x32_bf16 v[144:147], a[208:211], v[192:195], v[144:147]
  ds_read_b128 a[196:199], v228 offset:256
  v_cvt_pk_bf16_f32 v171, v174, v175
  v_mfma_f32_16x16x32_bf16 v[148:151], a[208:211], v[200:203], v[148:151]
  v_exp_f32 v182, v182
  v_mfma_f32_16x16x32_bf16 v[152:155], a[208:211], v[208:211], v[152:155]
  s_waitcnt lgkmcnt(6)
  v_exp_f32 v183, v183
  v_mfma_f32_16x16x32_bf16 v[156:159], a[212:215], v[192:195], v[156:159]
  ds_read_b128 a[200:203], v228 offset:1024
  v_add_f32 v235, v180, v235
  v_mfma_f32_16x16x32_bf16 v[160:163], a[212:215], v[200:203], v[160:163]
  v_exp_f32 v188, v188
  v_mfma_f32_16x16x32_bf16 v[164:167], a[212:215], v[208:211], v[164:167]
  s_waitcnt lgkmcnt(5)
  v_exp_f32 v189, v189
  v_mfma_f32_16x16x32_bf16 a[224:227], a[216:219], v[192:195], a[224:227]
  ds_read_b128 a[204:207], v228 offset:1280
  v_add_f32 v235, v181, v235
  v_mfma_f32_16x16x32_bf16 a[228:231], a[216:219], v[200:203], a[228:231]
  v_exp_f32 v190, v190
  v_mfma_f32_16x16x32_bf16 a[232:235], a[216:219], v[208:211], a[232:235]
  s_waitcnt lgkmcnt(4)
  v_exp_f32 v191, v191
  v_mfma_f32_16x16x32_bf16 a[236:239], a[220:223], v[192:195], a[236:239]
  ds_read_b128 a[208:211], v228 offset:2048
  v_cvt_pk_bf16_f32 v178, v180, v181
  v_mfma_f32_16x16x32_bf16 a[240:243], a[220:223], v[200:203], a[240:243]
  v_add_f32 v235, v182, v235
  v_add_f32 v236, v188, v236
  v_mfma_f32_16x16x32_bf16 a[244:247], a[220:223], v[208:211], a[244:247]
  s_waitcnt lgkmcnt(4)
  v_add_f32 v235, v183, v235
  v_add_f32 v236, v189, v236
  v_mfma_f32_16x16x32_bf16 v[192:195], a[192:195], a[0:3], v[216:219]
  s_add_u32 m0, s28, 81920
  ds_read_b128 a[212:215], v228 offset:2304
  v_cvt_pk_bf16_f32 v179, v182, v183
  v_mfma_f32_16x16x32_bf16 v[200:203], a[192:195], a[4:7], v[220:223]
  s_mov_b32 s29, 396288
  v_cvt_pk_bf16_f32 v186, v188, v189
  v_add_f32 v236, v190, v236
  v_mfma_f32_16x16x32_bf16 v[208:211], a[192:195], a[8:11], v[224:227]
  s_waitcnt lgkmcnt(4)
  v_add_f32 v236, v191, v236
  v_lshlrev_b32 v241, 3, v241
  v_mfma_f32_16x16x32_bf16 v[192:195], a[196:199], a[12:15], v[192:195]
  ds_read_b128 a[216:219], v228 offset:3072
  v_cvt_pk_bf16_f32 v187, v190, v191
  v_mfma_f32_16x16x32_bf16 v[200:203], a[196:199], a[16:19], v[200:203]
  v_cmp_eq_u32 vcc, 7, v240
  v_mfma_f32_16x16x32_bf16 v[208:211], a[196:199], a[20:23], v[208:211]
  s_waitcnt lgkmcnt(4)
  v_lshrrev_b32 v243, 4, v243
  v_mfma_f32_16x16x32_bf16 v[192:195], a[200:203], a[24:27], v[192:195]
  ds_read_b128 a[220:223], v228 offset:3328
  v_mov_b32 v242, 0x80000000
  v_mfma_f32_16x16x32_bf16 v[200:203], a[200:203], a[28:31], v[200:203]
  buffer_load_dwordx4 v231, s[8:11], s29 offen offset:0 nt lds
  v_mfma_f32_16x16x32_bf16 v[208:211], a[200:203], a[32:35], v[208:211]
  s_waitcnt lgkmcnt(4)
  v_mfma_f32_16x16x32_bf16 v[192:195], a[204:207], a[36:39], v[192:195]
  s_add_u32 s29, s29, s30
  ds_read_b128 a[192:195], v228 offset:8192
  v_mfma_f32_16x16x32_bf16 v[200:203], a[204:207], a[40:43], v[200:203]
  v_mfma_f32_16x16x32_bf16 v[208:211], a[204:207], a[44:47], v[208:211]
  s_waitcnt lgkmcnt(4)
  v_mfma_f32_16x16x32_bf16 v[192:195], a[208:211], a[48:51], v[192:195]
  ds_read_b128 a[196:199], v228 offset:8448
  v_mfma_f32_16x16x32_bf16 v[200:203], a[208:211], a[52:55], v[200:203]
  buffer_load_dwordx4 v231, s[8:11], s29 offen offset:1024 nt lds
  v_mfma_f32_16x16x32_bf16 v[208:211], a[208:211], a[56:59], v[208:211]
  s_waitcnt lgkmcnt(4)
  v_mfma_f32_16x16x32_bf16 v[192:195], a[212:215], a[60:63], v[192:195]
  s_add_u32 s29, s29, s30
  ds_read_b128 a[200:203], v228 offset:9216
  v_mfma_f32_16x16x32_bf16 v[200:203], a[212:215], a[64:67], v[200:203]
  v_mfma_f32_16x16x32_bf16 v[208:211], a[212:215], a[68:71], v[208:211]
  s_waitcnt lgkmcnt(4)
  v_mfma_f32_16x16x32_bf16 v[192:195], a[216:219], a[72:75], v[192:195]
  ds_read_b128 a[204:207], v228 offset:9472
  v_mfma_f32_16x16x32_bf16 v[200:203], a[216:219], a[76:79], v[200:203]
  buffer_load_dwordx4 v231, s[8:11], s29 offen offset:2048 nt lds
  v_mfma_f32_16x16x32_bf16 v[208:211], a[216:219], a[80:83], v[208:211]
  s_waitcnt lgkmcnt(4)
  v_mfma_f32_16x16x32_bf16 v[192:195], a[220:223], a[84:87], v[192:195]
  s_add_u32 s29, s29, s30
  ds_read_b128 a[208:211], v228 offset:10240
  v_mfma_f32_16x16x32_bf16 v[200:203], a[220:223], a[88:91], v[200:203]
  v_mfma_f32_16x16x32_bf16 v[208:211], a[220:223], a[92:95], v[208:211]
  s_waitcnt lgkmcnt(4)
  v_mfma_f32_16x16x32_bf16 v[196:199], a[192:195], a[0:3], v[216:219]
  ds_read_b128 a[212:215], v228 offset:10496
  v_mfma_f32_16x16x32_bf16 v[204:207], a[192:195], a[4:7], v[220:223]
  buffer_load_dwordx4 v231, s[8:11], s29 offen offset:3072 nt lds
  v_mfma_f32_16x16x32_bf16 v[212:215], a[192:195], a[8:11], v[224:227]
  s_waitcnt lgkmcnt(4)
  v_exp_f32 v192, v192
  v_mfma_f32_16x16x32_bf16 v[196:199], a[196:199], a[12:15], v[196:199]
  s_waitcnt vmcnt(4)
  ds_read_b128 a[216:219], v228 offset:11264
  v_add_f32 v234, v192, v234
  v_mfma_f32_16x16x32_bf16 v[204:207], a[196:199], a[16:19], v[204:207]
  s_barrier
  v_exp_f32 v193, v193
  v_mfma_f32_16x16x32_bf16 v[212:215], a[196:199], a[20:23], v[212:215]
  s_waitcnt lgkmcnt(4)
  v_exp_f32 v194, v194
  v_mfma_f32_16x16x32_bf16 v[196:199], a[200:203], a[24:27], v[196:199]
  ds_read_b128 a[220:223], v228 offset:11520
  v_add_u32 v228, 114688, v230
  v_mfma_f32_16x16x32_bf16 v[204:207], a[200:203], a[28:31], v[204:207]
  v_xor_b32 v239, 32, v228
  v_mfma_f32_16x16x32_bf16 v[212:215], a[200:203], a[32:35], v[212:215]
  s_waitcnt lgkmcnt(4)
  v_exp_f32 v195, v195
  v_mfma_f32_16x16x32_bf16 v[196:199], a[204:207], a[36:39], v[196:199]
  ds_read_b64_tr_b16 a[192:193], v228 offset:0
  v_add_f32 v234, v193, v234
  v_mfma_f32_16x16x32_bf16 v[204:207], a[204:207], a[40:43], v[204:207]
  ds_read_b64_tr_b16 a[194:195], v228 offset:8192
  v_cvt_pk_bf16_f32 v192, v192, v193
  v_mfma_f32_16x16x32_bf16 v[212:215], a[204:207], a[44:47], v[212:215]
  s_waitcnt lgkmcnt(5)
  v_exp_f32 v200, v200
  v_mfma_f32_16x16x32_bf16 v[196:199], a[208:211], a[48:51], v[196:199]
  ds_read_b64_tr_b16 a[196:197], v239 offset:0
  v_add_f32 v234, v194, v234
  v_mfma_f32_16x16x32_bf16 v[204:207], a[208:211], a[52:55], v[204:207]
  ds_read_b64_tr_b16 a[198:199], v239 offset:8192
  v_add_f32 v234, v195, v234
  v_mfma_f32_16x16x32_bf16 v[212:215], a[208:211], a[56:59], v[212:215]
  s_waitcnt lgkmcnt(6)
  v_exp_f32 v201, v201
  v_mfma_f32_16x16x32_bf16 v[196:199], a[212:215], a[60:63], v[196:199]
  ds_read_b64_tr_b16 a[200:201], v228 offset:256
  v_cvt_pk_bf16_f32 v193, v194, v195
  v_mfma_f32_16x16x32_bf16 v[204:207], a[212:215], a[64:67], v[204:207]
  ds_read_b64_tr_b16 a[202:203], v228 offset:8448
  v_add_f32 v235, v200, v235
  v_mfma_f32_16x16x32_bf16 v[212:215], a[212:215], a[68:71], v[212:215]
  s_waitcnt lgkmcnt(7)
  v_exp_f32 v202, v202
  v_mfma_f32_16x16x32_bf16 v[196:199], a[216:219], a[72:75], v[196:199]
  ds_read_b64_tr_b16 a[204:205], v239 offset:256
  v_add_f32 v235, v201, v235
  v_mfma_f32_16x16x32_bf16 v[204:207], a[216:219], a[76:79], v[204:207]
  ds_read_b64_tr_b16 a[206:207], v239 offset:8448
  v_cvt_pk_bf16_f32 v200, v200, v201
  v_mfma_f32_16x16x32_bf16 v[212:215], a[216:219], a[80:83], v[212:215]
  s_waitcnt lgkmcnt(8)
  v_exp_f32 v203, v203
  v_mfma_f32_16x16x32_bf16 v[196:199], a[220:223], a[84:87], v[196:199]
  ds_read_b64_tr_b16 a[208:209], v228 offset:1024
  v_add_f32 v235, v202, v235
  v_mfma_f32_16x16x32_bf16 v[204:207], a[220:223], a[88:91], v[204:207]
  ds_read_b64_tr_b16 a[210:211], v228 offset:9216
  v_add_f32 v235, v203, v235
  v_mfma_f32_16x16x32_bf16 v[212:215], a[220:223], a[92:95], v[212:215]
  s_waitcnt lgkmcnt(8)
  v_exp_f32 v208, v208
  v_mfma_f32_16x16x32_bf16 v[0:3], a[192:195], v[168:171], v[0:3]
  s_add_u32 m0, s28, 0
  ds_read_b64_tr_b16 a[212:213], v239 offset:1024
  v_cvt_pk_bf16_f32 v201, v202, v203
  v_mfma_f32_16x16x32_bf16 v[4:7], a[192:195], v[176:179], v[4:7]
  s_mov_b32 s29, 379904
  ds_read_b64_tr_b16 a[214:215], v239 offset:9216
  v_add_f32 v236, v208, v236
  v_mfma_f32_16x16x32_bf16 v[8:11], a[192:195], v[184:187], v[8:11]
  s_waitcnt lgkmcnt(8)
  v_exp_f32 v209, v209
  v_mfma_f32_16x16x32_bf16 v[12:15], a[196:199], v[168:171], v[12:15]
  ds_read_b64_tr_b16 a[216:217], v228 offset:1280
  v_add_f32 v236, v209, v236
  v_mfma_f32_16x16x32_bf16 v[16:19], a[196:199], v[176:179], v[16:19]
  ds_read_b64_tr_b16 a[218:219], v228 offset:9472
  v_cvt_pk_bf16_f32 v208, v208, v209
  v_mfma_f32_16x16x32_bf16 v[20:23], a[196:199], v[184:187], v[20:23]
  s_waitcnt lgkmcnt(8)
  v_exp_f32 v210, v210
  v_mfma_f32_16x16x32_bf16 v[24:27], a[200:203], v[168:171], v[24:27]
  ds_read_b64_tr_b16 a[220:221], v239 offset:1280
  v_add_f32 v236, v210, v236
  v_mfma_f32_16x16x32_bf16 v[28:31], a[200:203], v[176:179], v[28:31]
  buffer_load_dwordx4 v231, s[12:15], s29 offen offset:0 nt lds
  v_mfma_f32_16x16x32_bf16 v[32:35], a[200:203], v[184:187], v[32:35]
  s_waitcnt lgkmcnt(7)
  ds_read_b64_tr_b16 a[222:223], v239 offset:9472
  v_mfma_f32_16x16x32_bf16 v[36:39], a[204:207], v[168:171], v[36:39]
  s_add_u32 s29, s29, s30
  ds_read_b64_tr_b16 a[192:193], v228 offset:2048
  v_mfma_f32_16x16x32_bf16 v[40:43], a[204:207], v[176:179], v[40:43]
  ds_read_b64_tr_b16 a[194:195], v228 offset:10240
  v_mfma_f32_16x16x32_bf16 v[44:47], a[204:207], v[184:187], v[44:47]
  s_waitcnt lgkmcnt(8)
  v_exp_f32 v211, v211
  v_mfma_f32_16x16x32_bf16 v[48:51], a[208:211], v[168:171], v[48:51]
  ds_read_b64_tr_b16 a[196:197], v239 offset:2048
  v_add_f32 v236, v211, v236
  v_mfma_f32_16x16x32_bf16 v[52:55], a[208:211], v[176:179], v[52:55]
  buffer_load_dwordx4 v231, s[12:15], s29 offen offset:1024 nt lds
  v_mfma_f32_16x16x32_bf16 v[56:59], a[208:211], v[184:187], v[56:59]
  s_waitcnt lgkmcnt(7)
  ds_read_b64_tr_b16 a[198:199], v239 offset:10240
  v_cvt_pk_bf16_f32 v209, v210, v211
  v_mfma_f32_16x16x32_bf16 v[60:63], a[212:215], v[168:171], v[60:63]
  s_add_u32 s29, s29, s30
  ds_read_b64_tr_b16 a[200:201], v228 offset:2304
  v_mfma_f32_16x16x32_bf16 v[64:67], a[212:215], v[176:179], v[64:67]
  ds_read_b64_tr_b16 a[202:203], v228 offset:10496
  v_mfma_f32_16x16x32_bf16 v[68:71], a[212:215], v[184:187], v[68:71]
  s_waitcnt lgkmcnt(8)
  v_exp_f32 v196, v196
  v_mfma_f32_16x16x32_bf16 v[72:75], a[216:219], v[168:171], v[72:75]
  ds_read_b64_tr_b16 a[204:205], v239 offset:2304
  v_add_f32 v234, v196, v234
  v_mfma_f32_16x16x32_bf16 v[76:79], a[216:219], v[176:179], v[76:79]
  buffer_load_dwordx4 v231, s[12:15], s29 offen offset:2048 nt lds
  v_mfma_f32_16x16x32_bf16 v[80:83], a[216:219], v[184:187], v[80:83]
  s_waitcnt lgkmcnt(7)
  ds_read_b64_tr_b16 a[206:207], v239 offset:10496
  v_mfma_f32_16x16x32_bf16 v[84:87], a[220:223], v[168:171], v[84:87]
  s_add_u32 s29, s29, s30
  ds_read_b64_tr_b16 a[208:209], v228 offset:3072
  v_mfma_f32_16x16x32_bf16 v[88:91], a[220:223], v[176:179], v[88:91]
  ds_read_b64_tr_b16 a[210:211], v228 offset:11264
  v_mfma_f32_16x16x32_bf16 v[92:95], a[220:223], v[184:187], v[92:95]
  s_waitcnt lgkmcnt(8)
  v_exp_f32 v197, v197
  v_mfma_f32_16x16x32_bf16 v[96:99], a[192:195], v[168:171], v[96:99]
  ds_read_b64_tr_b16 a[212:213], v239 offset:3072
  v_add_f32 v234, v197, v234
  v_mfma_f32_16x16x32_bf16 v[100:103], a[192:195], v[176:179], v[100:103]
  buffer_load_dwordx4 v231, s[12:15], s29 offen offset:3072 nt lds
  v_mfma_f32_16x16x32_bf16 v[104:107], a[192:195], v[184:187], v[104:107]
  s_waitcnt lgkmcnt(7)
  ds_read_b64_tr_b16 a[214:215], v239 offset:11264
  v_cvt_pk_bf16_f32 v194, v196, v197
  v_mfma_f32_16x16x32_bf16 v[108:111], a[196:199], v[168:171], v[108:111]
  s_waitcnt vmcnt(4)
  ds_read_b64_tr_b16 a[216:217], v228 offset:3328
  v_mfma_f32_16x16x32_bf16 v[112:115], a[196:199], v[176:179], v[112:115]
  s_barrier
  ds_read_b64_tr_b16 a[218:219], v228 offset:11520
  v_mfma_f32_16x16x32_bf16 v[116:119], a[196:199], v[184:187], v[116:119]
  s_waitcnt lgkmcnt(8)
  v_exp_f32 v198, v198
  v_mfma_f32_16x16x32_bf16 v[120:123], a[200:203], v[168:171], v[120:123]
  ds_read_b64_tr_b16 a[220:221], v239 offset:3328
  v_add_f32 v234, v198, v234
  v_mfma_f32_16x16x32_bf16 v[124:127], a[200:203], v[176:179], v[124:127]
  ds_read_b64_tr_b16 a[222:223], v239 offset:11520
  v_add_u32 v228, 81920, v229
  v_mfma_f32_16x16x32_bf16 v[128:131], a[200:203], v[184:187], v[128:131]
  s_waitcnt lgkmcnt(8)
  v_exp_f32 v199, v199
  v_mfma_f32_16x16x32_bf16 v[132:135], a[204:207], v[168:171], v[132:135]
  ds_read_b128 a[192:195], v228 offset:0
  v_add_f32 v234, v199, v234
  v_mfma_f32_16x16x32_bf16 v[136:139], a[204:207], v[176:179], v[136:139]
  v_exp_f32 v204, v204
  v_mfma_f32_16x16x32_bf16 v[140:143], a[204:207], v[184:187], v[140:143]
  s_waitcnt lgkmcnt(7)
  v_exp_f32 v205, v205
  v_mfma_f32_16x16x32_bf16 v[144:147], a[208:211], v[168:171], v[144:147]
  ds_read_b128 a[196:199], v228 offset:256
  v_cvt_pk_bf16_f32 v195, v198, v199
  v_mfma_f32_16x16x32_bf16 v[148:151], a[208:211], v[176:179], v[148:151]
  v_exp_f32 v206, v206
  v_mfma_f32_16x16x32_bf16 v[152:155], a[208:211], v[184:187], v[152:155]
  s_waitcnt lgkmcnt(6)
  v_exp_f32 v207, v207
  v_mfma_f32_16x16x32_bf16 v[156:159], a[212:215], v[168:171], v[156:159]
  ds_read_b128 a[200:203], v228 offset:1024
  v_add_f32 v235, v204, v235
  v_mfma_f32_16x16x32_bf16 v[160:163], a[212:215], v[176:179], v[160:163]
  v_exp_f32 v212, v212
  v_mfma_f32_16x16x32_bf16 v[164:167], a[212:215], v[184:187], v[164:167]
  s_waitcnt lgkmcnt(5)
  v_exp_f32 v213, v213
  v_mfma_f32_16x16x32_bf16 a[224:227], a[216:219], v[168:171], a[224:227]
  ds_read_b128 a[204:207], v228 offset:1280
  v_add_f32 v235, v205, v235
  v_mfma_f32_16x16x32_bf16 a[228:231], a[216:219], v[176:179], a[228:231]
  v_exp_f32 v214, v214
  v_mfma_f32_16x16x32_bf16 a[232:235], a[216:219], v[184:187], a[232:235]
  s_waitcnt lgkmcnt(4)
  v_exp_f32 v215, v215
  v_mfma_f32_16x16x32_bf16 a[236:239], a[220:223], v[168:171], a[236:239]
  ds_read_b128 a[208:211], v228 offset:2048
  v_cvt_pk_bf16_f32 v202, v204, v205
  v_mfma_f32_16x16x32_bf16 a[240:243], a[220:223], v[176:179], a[240:243]
  v_add_f32 v235, v206, v235
  v_add_f32 v236, v212, v236
  v_mfma_f32_16x16x32_bf16 a[244:247], a[220:223], v[184:187], a[244:247]
  s_waitcnt lgkmcnt(4)
  v_add_f32 v235, v207, v235
  v_add_f32 v236, v213, v236
  v_mfma_f32_16x16x32_bf16 v[168:171], a[192:195], a[0:3], v[216:219]
  s_add_u32 m0, s28, 98304
  ds_read_b128 a[212:215], v228 offset:2304
  v_cvt_pk_bf16_f32 v203, v206, v207
  v_mfma_f32_16x16x32_bf16 v[176:179], a[192:195], a[4:7], v[220:223]
  s_mov_b32 s29, 412672
  v_cvt_pk_bf16_f32 v210, v212, v213
  v_add_f32 v236, v214, v236
  v_mfma_f32_16x16x32_bf16 v[184:187], a[192:195], a[8:11], v[224:227]
  s_waitcnt lgkmcnt(4)
  v_add_f32 v236, v215, v236
  v_cndmask_b32 v241, v241, v243, vcc
  v_mfma_f32_16x16x32_bf16 v[168:171], a[196:199], a[12:15], v[168:171]
  ds_read_b128 a[216:219], v228 offset:3072
  v_cvt_pk_bf16_f32 v211, v214, v215
  v_mfma_f32_16x16x32_bf16 v[176:179], a[196:199], a[16:19], v[176:179]
  v_cmp_lt_u32 vcc, 7, v240
  v_mfma_f32_16x16x32_bf16 v[184:187], a[196:199], a[20:23], v[184:187]
  s_waitcnt lgkmcnt(4)
  v_mov_b32 v243, 0
  v_mfma_f32_16x16x32_bf16 v[168:171], a[200:203], a[24:27], v[168:171]
  ds_read_b128 a[220:223], v228 offset:3328
  v_mov_b32 v243, 0
  v_mfma_f32_16x16x32_bf16 v[176:179], a[200:203], a[28:31], v[176:179]
  buffer_load_dwordx4 v231, s[8:11], s29 offen offset:0 nt lds
  v_mfma_f32_16x16x32_bf16 v[184:187], a[200:203], a[32:35], v[184:187]
  s_waitcnt lgkmcnt(4)
  v_mfma_f32_16x16x32_bf16 v[168:171], a[204:207], a[36:39], v[168:171]
  s_add_u32 s29, s29, s30
  ds_read_b128 a[192:195], v228 offset:8192
  v_mfma_f32_16x16x32_bf16 v[176:179], a[204:207], a[40:43], v[176:179]
  v_mfma_f32_16x16x32_bf16 v[184:187], a[204:207], a[44:47], v[184:187]
  s_waitcnt lgkmcnt(4)
  v_mfma_f32_16x16x32_bf16 v[168:171], a[208:211], a[48:51], v[168:171]
  ds_read_b128 a[196:199], v228 offset:8448
  v_mfma_f32_16x16x32_bf16 v[176:179], a[208:211], a[52:55], v[176:179]
  buffer_load_dwordx4 v231, s[8:11], s29 offen offset:1024 nt lds
  v_mfma_f32_16x16x32_bf16 v[184:187], a[208:211], a[56:59], v[184:187]
  s_waitcnt lgkmcnt(4)
  v_mfma_f32_16x16x32_bf16 v[168:171], a[212:215], a[60:63], v[168:171]
  s_add_u32 s29, s29, s30
  ds_read_b128 a[200:203], v228 offset:9216
  v_mfma_f32_16x16x32_bf16 v[176:179], a[212:215], a[64:67], v[176:179]
  v_mfma_f32_16x16x32_bf16 v[184:187], a[212:215], a[68:71], v[184:187]
  s_waitcnt lgkmcnt(4)
  v_mfma_f32_16x16x32_bf16 v[168:171], a[216:219], a[72:75], v[168:171]
  ds_read_b128 a[204:207], v228 offset:9472
  v_mfma_f32_16x16x32_bf16 v[176:179], a[216:219], a[76:79], v[176:179]
  buffer_load_dwordx4 v231, s[8:11], s29 offen offset:2048 nt lds
  v_mfma_f32_16x16x32_bf16 v[184:187], a[216:219], a[80:83], v[184:187]
  s_waitcnt lgkmcnt(4)
  v_mfma_f32_16x16x32_bf16 v[168:171], a[220:223], a[84:87], v[168:171]
  s_add_u32 s29, s29, s30
  ds_read_b128 a[208:211], v228 offset:10240
  v_mfma_f32_16x16x32_bf16 v[176:179], a[220:223], a[88:91], v[176:179]
  v_mfma_f32_16x16x32_bf16 v[184:187], a[220:223], a[92:95], v[184:187]
  s_waitcnt lgkmcnt(4)
  v_mfma_f32_16x16x32_bf16 v[172:175], a[192:195], a[0:3], v[216:219]
  ds_read_b128 a[212:215], v228 offset:10496
  v_mfma_f32_16x16x32_bf16 v[180:183], a[192:195], a[4:7], v[220:223]
  buffer_load_dwordx4 v231, s[8:11], s29 offen offset:3072 nt lds
  v_mfma_f32_16x16x32_bf16 v[188:191], a[192:195], a[8:11], v[224:227]
  s_waitcnt lgkmcnt(4)
  v_exp_f32 v168, v168
  v_mfma_f32_16x16x32_bf16 v[172:175], a[196:199], a[12:15], v[172:175]
  s_waitcnt vmcnt(4)
  ds_read_b128 a[216:219], v228 offset:11264
  v_add_f32 v234, v168, v234
  v_mfma_f32_16x16x32_bf16 v[180:183], a[196:199], a[16:19], v[180:183]
  s_barrier
  v_exp_f32 v169, v169
  v_mfma_f32_16x16x32_bf16 v[188:191], a[196:199], a[20:23], v[188:191]
  s_waitcnt lgkmcnt(4)
  v_exp_f32 v170, v170
  v_mfma_f32_16x16x32_bf16 v[172:175], a[200:203], a[24:27], v[172:175]
  ds_read_b128 a[220:223], v228 offset:11520
  v_add_u32 v228, 0, v230
  v_mfma_f32_16x16x32_bf16 v[180:183], a[200:203], a[28:31], v[180:183]
  v_xor_b32 v239, 32, v228
  v_mfma_f32_16x16x32_bf16 v[188:191], a[200:203], a[32:35], v[188:191]
  s_waitcnt lgkmcnt(4)
  v_exp_f32 v171, v171
  v_mfma_f32_16x16x32_bf16 v[172:175], a[204:207], a[36:39], v[172:175]
  ds_read_b64_tr_b16 a[192:193], v228 offset:0
  v_add_f32 v234, v169, v234
  v_mfma_f32_16x16x32_bf16 v[180:183], a[204:207], a[40:43], v[180:183]
  ds_read_b64_tr_b16 a[194:195], v228 offset:8192
  v_cvt_pk_bf16_f32 v168, v168, v169
  v_mfma_f32_16x16x32_bf16 v[188:191], a[204:207], a[44:47], v[188:191]
  s_waitcnt lgkmcnt(5)
  v_exp_f32 v176, v176
  v_mfma_f32_16x16x32_bf16 v[172:175], a[208:211], a[48:51], v[172:175]
  ds_read_b64_tr_b16 a[196:197], v239 offset:0
  v_add_f32 v234, v170, v234
  v_mfma_f32_16x16x32_bf16 v[180:183], a[208:211], a[52:55], v[180:183]
  ds_read_b64_tr_b16 a[198:199], v239 offset:8192
  v_add_f32 v234, v171, v234
  v_mfma_f32_16x16x32_bf16 v[188:191], a[208:211], a[56:59], v[188:191]
  s_waitcnt lgkmcnt(6)
  v_exp_f32 v177, v177
  v_mfma_f32_16x16x32_bf16 v[172:175], a[212:215], a[60:63], v[172:175]
  ds_read_b64_tr_b16 a[200:201], v228 offset:256
  v_cvt_pk_bf16_f32 v169, v170, v171
  v_mfma_f32_16x16x32_bf16 v[180:183], a[212:215], a[64:67], v[180:183]
  ds_read_b64_tr_b16 a[202:203], v228 offset:8448
  v_add_f32 v235, v176, v235
  v_mfma_f32_16x16x32_bf16 v[188:191], a[212:215], a[68:71], v[188:191]
  s_waitcnt lgkmcnt(7)
  v_exp_f32 v178, v178
  v_mfma_f32_16x16x32_bf16 v[172:175], a[216:219], a[72:75], v[172:175]
  ds_read_b64_tr_b16 a[204:205], v239 offset:256
  v_add_f32 v235, v177, v235
  v_mfma_f32_16x16x32_bf16 v[180:183], a[216:219], a[76:79], v[180:183]
  ds_read_b64_tr_b16 a[206:207], v239 offset:8448
  v_cvt_pk_bf16_f32 v176, v176, v177
  v_mfma_f32_16x16x32_bf16 v[188:191], a[216:219], a[80:83], v[188:191]
  s_waitcnt lgkmcnt(8)
  v_exp_f32 v179, v179
  v_mfma_f32_16x16x32_bf16 v[172:175], a[220:223], a[84:87], v[172:175]
  ds_read_b64_tr_b16 a[208:209], v228 offset:1024
  v_add_f32 v235, v178, v235
  v_mfma_f32_16x16x32_bf16 v[180:183], a[220:223], a[88:91], v[180:183]
  ds_read_b64_tr_b16 a[210:211], v228 offset:9216
  v_add_f32 v235, v179, v235
  v_mfma_f32_16x16x32_bf16 v[188:191], a[220:223], a[92:95], v[188:191]
  s_waitcnt lgkmcnt(8)
  v_exp_f32 v184, v184
  v_mfma_f32_16x16x32_bf16 v[0:3], a[192:195], v[192:195], v[0:3]
  s_add_u32 m0, s28, 16384
  ds_read_b64_tr_b16 a[212:213], v239 offset:1024
  v_cvt_pk_bf16_f32 v177, v178, v179
  v_mfma_f32_16x16x32_bf16 v[4:7], a[192:195], v[200:203], v[4:7]
  s_mov_b32 s29, 396288
  ds_read_b64_tr_b16 a[214:215], v239 offset:9216
  v_add_f32 v236, v184, v236
  v_mfma_f32_16x16x32_bf16 v[8:11], a[192:195], v[208:211], v[8:11]
  s_waitcnt lgkmcnt(8)
  v_exp_f32 v185, v185
  v_mfma_f32_16x16x32_bf16 v[12:15], a[196:199], v[192:195], v[12:15]
  ds_read_b64_tr_b16 a[216:217], v228 offset:1280
  v_add_f32 v236, v185, v236
  v_mfma_f32_16x16x32_bf16 v[16:19], a[196:199], v[200:203], v[16:19]
  buffer_load_dwordx4 a[252:255], v247, s[88:91], 0 offen offset:0
  v_mfma_f32_16x16x32_bf16 v[20:23], a[196:199], v[208:211], v[20:23]
  s_waitcnt lgkmcnt(7)
  ds_read_b64_tr_b16 a[218:219], v228 offset:9472
  v_cvt_pk_bf16_f32 v184, v184, v185
  v_mfma_f32_16x16x32_bf16 v[24:27], a[200:203], v[192:195], v[24:27]
  ds_read_b64_tr_b16 a[220:221], v239 offset:1280
  v_mfma_f32_16x16x32_bf16 v[28:31], a[200:203], v[200:203], v[28:31]
  buffer_load_dwordx4 v231, s[12:15], s29 offen offset:0 nt lds
  v_mfma_f32_16x16x32_bf16 v[32:35], a[200:203], v[208:211], v[32:35]
  s_waitcnt lgkmcnt(7)
  ds_read_b64_tr_b16 a[222:223], v239 offset:9472
  v_mfma_f32_16x16x32_bf16 v[36:39], a[204:207], v[192:195], v[36:39]
  s_add_u32 s29, s29, s30
  ds_read_b64_tr_b16 a[192:193], v228 offset:2048
  v_mfma_f32_16x16x32_bf16 v[40:43], a[204:207], v[200:203], v[40:43]
  ds_read_b64_tr_b16 a[194:195], v228 offset:10240
  v_mfma_f32_16x16x32_bf16 v[44:47], a[204:207], v[208:211], v[44:47]
  s_waitcnt lgkmcnt(8)
  v_exp_f32 v186, v186
  v_mfma_f32_16x16x32_bf16 v[48:51], a[208:211], v[192:195], v[48:51]
  ds_read_b64_tr_b16 a[196:197], v239 offset:2048
  v_add_f32 v236, v186, v236
  v_mfma_f32_16x16x32_bf16 v[52:55], a[208:211], v[200:203], v[52:55]
  buffer_load_dwordx4 v231, s[12:15], s29 offen offset:1024 nt lds
  v_mfma_f32_16x16x32_bf16 v[56:59], a[208:211], v[208:211], v[56:59]
  s_waitcnt lgkmcnt(7)
  ds_read_b64_tr_b16 a[198:199], v239 offset:10240
  v_mfma_f32_16x16x32_bf16 v[60:63], a[212:215], v[192:195], v[60:63]
  s_add_u32 s29, s29, s30
  ds_read_b64_tr_b16 a[200:201], v228 offset:2304
  v_mfma_f32_16x16x32_bf16 v[64:67], a[212:215], v[200:203], v[64:67]
  ds_read_b64_tr_b16 a[202:203], v228 offset:10496
  v_mfma_f32_16x16x32_bf16 v[68:71], a[212:215], v[208:211], v[68:71]
  s_waitcnt lgkmcnt(8)
  v_exp_f32 v187, v187
  v_mfma_f32_16x16x32_bf16 v[72:75], a[216:219], v[192:195], v[72:75]
  ds_read_b64_tr_b16 a[204:205], v239 offset:2304
  v_add_f32 v236, v187, v236
  v_mfma_f32_16x16x32_bf16 v[76:79], a[216:219], v[200:203], v[76:79]
  buffer_load_dwordx4 v231, s[12:15], s29 offen offset:2048 nt lds
  v_mfma_f32_16x16x32_bf16 v[80:83], a[216:219], v[208:211], v[80:83]
  s_waitcnt lgkmcnt(7)
  ds_read_b64_tr_b16 a[206:207], v239 offset:10496
  v_cvt_pk_bf16_f32 v185, v186, v187
  v_mfma_f32_16x16x32_bf16 v[84:87], a[220:223], v[192:195], v[84:87]
  s_add_u32 s29, s29, s30
  ds_read_b64_tr_b16 a[208:209], v228 offset:3072
  v_mfma_f32_16x16x32_bf16 v[88:91], a[220:223], v[200:203], v[88:91]
  ds_read_b64_tr_b16 a[210:211], v228 offset:11264
  v_mfma_f32_16x16x32_bf16 v[92:95], a[220:223], v[208:211], v[92:95]
  s_waitcnt lgkmcnt(8)
  v_exp_f32 v172, v172
  v_mfma_f32_16x16x32_bf16 v[96:99], a[192:195], v[192:195], v[96:99]
  ds_read_b64_tr_b16 a[212:213], v239 offset:3072
  v_add_f32 v234, v172, v234
  v_mfma_f32_16x16x32_bf16 v[100:103], a[192:195], v[200:203], v[100:103]
  buffer_load_dwordx4 v231, s[12:15], s29 offen offset:3072 nt lds
  v_mfma_f32_16x16x32_bf16 v[104:107], a[192:195], v[208:211], v[104:107]
  s_waitcnt lgkmcnt(7)
  ds_read_b64_tr_b16 a[214:215], v239 offset:11264
  v_mfma_f32_16x16x32_bf16 v[108:111], a[196:199], v[192:195], v[108:111]
  s_waitcnt vmcnt(5)
  ds_read_b64_tr_b16 a[216:217], v228 offset:3328
  v_mfma_f32_16x16x32_bf16 v[112:115], a[196:199], v[200:203], v[112:115]
  s_barrier
  ds_read_b64_tr_b16 a[218:219], v228 offset:11520
  v_mfma_f32_16x16x32_bf16 v[116:119], a[196:199], v[208:211], v[116:119]
  s_waitcnt lgkmcnt(8)
  v_exp_f32 v173, v173
  v_mfma_f32_16x16x32_bf16 v[120:123], a[200:203], v[192:195], v[120:123]
  ds_read_b64_tr_b16 a[220:221], v239 offset:3328
  v_add_f32 v234, v173, v234
  v_mfma_f32_16x16x32_bf16 v[124:127], a[200:203], v[200:203], v[124:127]
  ds_read_b64_tr_b16 a[222:223], v239 offset:11520
  v_add_u32 v228, 98304, v229
  v_mfma_f32_16x16x32_bf16 v[128:131], a[200:203], v[208:211], v[128:131]
  s_waitcnt lgkmcnt(8)
  v_exp_f32 v174, v174
  v_mfma_f32_16x16x32_bf16 v[132:135], a[204:207], v[192:195], v[132:135]
  ds_read_b128 a[192:195], v228 offset:0
  v_cvt_pk_bf16_f32 v170, v172, v173
  v_mfma_f32_16x16x32_bf16 v[136:139], a[204:207], v[200:203], v[136:139]
  v_exp_f32 v175, v175
  v_mfma_f32_16x16x32_bf16 v[140:143], a[204:207], v[208:211], v[140:143]
  s_waitcnt lgkmcnt(7)
  v_exp_f32 v180, v180
  v_mfma_f32_16x16x32_bf16 v[144:147], a[208:211], v[192:195], v[144:147]
  ds_read_b128 a[196:199], v228 offset:256
  v_add_f32 v234, v174, v234
  v_mfma_f32_16x16x32_bf16 v[148:151], a[208:211], v[200:203], v[148:151]
  v_exp_f32 v181, v181
  v_mfma_f32_16x16x32_bf16 v[152:155], a[208:211], v[208:211], v[152:155]
  s_waitcnt lgkmcnt(6)
  v_exp_f32 v182, v182
  v_mfma_f32_16x16x32_bf16 v[156:159], a[212:215], v[192:195], v[156:159]
  ds_read_b128 a[200:203], v228 offset:1024
  v_add_f32 v234, v175, v234
  v_mfma_f32_16x16x32_bf16 v[160:163], a[212:215], v[200:203], v[160:163]
  v_exp_f32 v183, v183
  v_mfma_f32_16x16x32_bf16 v[164:167], a[212:215], v[208:211], v[164:167]
  s_waitcnt lgkmcnt(5)
  v_exp_f32 v188, v188
  v_mfma_f32_16x16x32_bf16 a[224:227], a[216:219], v[192:195], a[224:227]
  ds_read_b128 a[204:207], v228 offset:1280
  v_cvt_pk_bf16_f32 v171, v174, v175
  v_mfma_f32_16x16x32_bf16 a[228:231], a[216:219], v[200:203], a[228:231]
  v_exp_f32 v189, v189
  v_mfma_f32_16x16x32_bf16 a[232:235], a[216:219], v[208:211], a[232:235]
  s_waitcnt lgkmcnt(4)
  v_exp_f32 v190, v190
  v_mfma_f32_16x16x32_bf16 a[236:239], a[220:223], v[192:195], a[236:239]
  ds_read_b128 a[208:211], v228 offset:2048
  v_add_f32 v235, v180, v235
  v_mfma_f32_16x16x32_bf16 a[240:243], a[220:223], v[200:203], a[240:243]
  v_exp_f32 v191, v191
  v_mfma_f32_16x16x32_bf16 a[244:247], a[220:223], v[208:211], a[244:247]
  s_waitcnt lgkmcnt(4)
  v_add_f32 v235, v181, v235
  v_add_f32 v236, v188, v236
  v_mfma_f32_16x16x32_bf16 v[192:195], a[192:195], a[0:3], v[216:219]
  s_add_u32 m0, s28, 114688
  ds_read_b128 a[212:215], v228 offset:2304
  v_cvt_pk_bf16_f32 v178, v180, v181
  v_mfma_f32_16x16x32_bf16 v[200:203], a[192:195], a[4:7], v[220:223]
  s_mov_b32 s29, 429056
  v_add_f32 v235, v182, v235
  v_add_f32 v236, v189, v236
  v_mfma_f32_16x16x32_bf16 v[208:211], a[192:195], a[8:11], v[224:227]
  s_waitcnt lgkmcnt(4)
  v_add_f32 v235, v183, v235
  v_cvt_pk_bf16_f32 v186, v188, v189
  v_mfma_f32_16x16x32_bf16 v[192:195], a[196:199], a[12:15], v[192:195]
  ds_read_b128 a[216:219], v228 offset:3072
  v_cvt_pk_bf16_f32 v179, v182, v183
  v_mfma_f32_16x16x32_bf16 v[200:203], a[196:199], a[16:19], v[200:203]
  v_add_f32 v236, v190, v236
  v_cndmask_b32 v241, v241, v242, vcc
  v_mfma_f32_16x16x32_bf16 v[208:211], a[196:199], a[20:23], v[208:211]
  s_waitcnt lgkmcnt(4)
  v_add_f32 v236, v191, v236
  v_accvgpr_write_b32 a251, v241
  v_mfma_f32_16x16x32_bf16 v[192:195], a[200:203], a[24:27], v[192:195]
  ds_read_b128 a[220:223], v228 offset:3328
  v_cvt_pk_bf16_f32 v187, v190, v191
  v_mfma_f32_16x16x32_bf16 v[200:203], a[200:203], a[28:31], v[200:203]
  buffer_load_dwordx4 v231, s[8:11], s29 offen offset:0 nt lds
  v_mfma_f32_16x16x32_bf16 v[208:211], a[200:203], a[32:35], v[208:211]
  s_waitcnt lgkmcnt(4)
  v_mfma_f32_16x16x32_bf16 v[192:195], a[204:207], a[36:39], v[192:195]
  s_add_u32 s29, s29, s30
  ds_read_b128 a[192:195], v228 offset:8192
  v_mfma_f32_16x16x32_bf16 v[200:203], a[204:207], a[40:43], v[200:203]
  v_mfma_f32_16x16x32_bf16 v[208:211], a[204:207], a[44:47], v[208:211]
  s_waitcnt lgkmcnt(4)
  v_mfma_f32_16x16x32_bf16 v[192:195], a[208:211], a[48:51], v[192:195]
  ds_read_b128 a[196:199], v228 offset:8448
  v_mfma_f32_16x16x32_bf16 v[200:203], a[208:211], a[52:55], v[200:203]
  buffer_load_dwordx4 v231, s[8:11], s29 offen offset:1024 nt lds
  v_mfma_f32_16x16x32_bf16 v[208:211], a[208:211], a[56:59], v[208:211]
  s_waitcnt lgkmcnt(4)
  v_mfma_f32_16x16x32_bf16 v[192:195], a[212:215], a[60:63], v[192:195]
  s_add_u32 s29, s29, s30
  ds_read_b128 a[200:203], v228 offset:9216
  v_mfma_f32_16x16x32_bf16 v[200:203], a[212:215], a[64:67], v[200:203]
  v_mfma_f32_16x16x32_bf16 v[208:211], a[212:215], a[68:71], v[208:211]
  s_waitcnt lgkmcnt(4)
  v_mfma_f32_16x16x32_bf16 v[192:195], a[216:219], a[72:75], v[192:195]
  ds_read_b128 a[204:207], v228 offset:9472
  v_mfma_f32_16x16x32_bf16 v[200:203], a[216:219], a[76:79], v[200:203]
  buffer_load_dwordx4 v231, s[8:11], s29 offen offset:2048 nt lds
  v_mfma_f32_16x16x32_bf16 v[208:211], a[216:219], a[80:83], v[208:211]
  s_waitcnt lgkmcnt(4)
  v_mfma_f32_16x16x32_bf16 v[192:195], a[220:223], a[84:87], v[192:195]
  s_add_u32 s29, s29, s30
  ds_read_b128 a[208:211], v228 offset:10240
  v_mfma_f32_16x16x32_bf16 v[200:203], a[220:223], a[88:91], v[200:203]
  v_mfma_f32_16x16x32_bf16 v[208:211], a[220:223], a[92:95], v[208:211]
  s_waitcnt lgkmcnt(4)
  v_mfma_f32_16x16x32_bf16 v[196:199], a[192:195], a[0:3], v[216:219]
  ds_read_b128 a[212:215], v228 offset:10496
  v_mfma_f32_16x16x32_bf16 v[204:207], a[192:195], a[4:7], v[220:223]
  buffer_load_dwordx4 v231, s[8:11], s29 offen offset:3072 nt lds
  v_mfma_f32_16x16x32_bf16 v[212:215], a[192:195], a[8:11], v[224:227]
  s_waitcnt lgkmcnt(4)
  v_exp_f32 v192, v192
  v_mfma_f32_16x16x32_bf16 v[196:199], a[196:199], a[12:15], v[196:199]
  s_waitcnt vmcnt(4)
  ds_read_b128 a[216:219], v228 offset:11264
  v_add_f32 v234, v192, v234
  v_mfma_f32_16x16x32_bf16 v[204:207], a[196:199], a[16:19], v[204:207]
  s_barrier
  v_exp_f32 v193, v193
  v_mfma_f32_16x16x32_bf16 v[212:215], a[196:199], a[20:23], v[212:215]
  s_waitcnt lgkmcnt(4)
  v_exp_f32 v194, v194
  v_mfma_f32_16x16x32_bf16 v[196:199], a[200:203], a[24:27], v[196:199]
  ds_read_b128 a[220:223], v228 offset:11520
  v_add_u32 v228, 16384, v230
  v_mfma_f32_16x16x32_bf16 v[204:207], a[200:203], a[28:31], v[204:207]
  v_xor_b32 v239, 32, v228
  v_mfma_f32_16x16x32_bf16 v[212:215], a[200:203], a[32:35], v[212:215]
  s_waitcnt lgkmcnt(4)
  v_exp_f32 v195, v195
  v_mfma_f32_16x16x32_bf16 v[196:199], a[204:207], a[36:39], v[196:199]
  ds_read_b64_tr_b16 a[192:193], v228 offset:0
  v_add_f32 v234, v193, v234
  v_mfma_f32_16x16x32_bf16 v[204:207], a[204:207], a[40:43], v[204:207]
  ds_read_b64_tr_b16 a[194:195], v228 offset:8192
  v_cvt_pk_bf16_f32 v192, v192, v193
  v_mfma_f32_16x16x32_bf16 v[212:215], a[204:207], a[44:47], v[212:215]
  s_waitcnt lgkmcnt(5)
  v_exp_f32 v200, v200
  v_mfma_f32_16x16x32_bf16 v[196:199], a[208:211], a[48:51], v[196:199]
  ds_read_b64_tr_b16 a[196:197], v239 offset:0
  v_add_f32 v234, v194, v234
  v_mfma_f32_16x16x32_bf16 v[204:207], a[208:211], a[52:55], v[204:207]
  ds_read_b64_tr_b16 a[198:199], v239 offset:8192
  v_add_f32 v234, v195, v234
  v_mfma_f32_16x16x32_bf16 v[212:215], a[208:211], a[56:59], v[212:215]
  s_waitcnt lgkmcnt(6)
  v_exp_f32 v201, v201
  v_mfma_f32_16x16x32_bf16 v[196:199], a[212:215], a[60:63], v[196:199]
  ds_read_b64_tr_b16 a[200:201], v228 offset:256
  v_cvt_pk_bf16_f32 v193, v194, v195
  v_mfma_f32_16x16x32_bf16 v[204:207], a[212:215], a[64:67], v[204:207]
  ds_read_b64_tr_b16 a[202:203], v228 offset:8448
  v_add_f32 v235, v200, v235
  v_mfma_f32_16x16x32_bf16 v[212:215], a[212:215], a[68:71], v[212:215]
  s_waitcnt lgkmcnt(7)
  v_exp_f32 v202, v202
  v_mfma_f32_16x16x32_bf16 v[196:199], a[216:219], a[72:75], v[196:199]
  ds_read_b64_tr_b16 a[204:205], v239 offset:256
  v_add_f32 v235, v201, v235
  v_mfma_f32_16x16x32_bf16 v[204:207], a[216:219], a[76:79], v[204:207]
  ds_read_b64_tr_b16 a[206:207], v239 offset:8448
  v_cvt_pk_bf16_f32 v200, v200, v201
  v_mfma_f32_16x16x32_bf16 v[212:215], a[216:219], a[80:83], v[212:215]
  s_waitcnt lgkmcnt(8)
  v_exp_f32 v203, v203
  v_mfma_f32_16x16x32_bf16 v[196:199], a[220:223], a[84:87], v[196:199]
  ds_read_b64_tr_b16 a[208:209], v228 offset:1024
  v_add_f32 v235, v202, v235
  v_mfma_f32_16x16x32_bf16 v[204:207], a[220:223], a[88:91], v[204:207]
  ds_read_b64_tr_b16 a[210:211], v228 offset:9216
  v_add_f32 v235, v203, v235
  v_mfma_f32_16x16x32_bf16 v[212:215], a[220:223], a[92:95], v[212:215]
  s_waitcnt lgkmcnt(8)
  v_exp_f32 v208, v208
  v_mfma_f32_16x16x32_bf16 v[0:3], a[192:195], v[168:171], v[0:3]
  s_add_u32 m0, s28, 81920
  ds_read_b64_tr_b16 a[212:213], v239 offset:1024
  v_cvt_pk_bf16_f32 v201, v202, v203
  v_mfma_f32_16x16x32_bf16 v[4:7], a[192:195], v[176:179], v[4:7]
  s_mov_b32 s29, 412672
  ds_read_b64_tr_b16 a[214:215], v239 offset:9216
  v_add_f32 v236, v208, v236
  v_mfma_f32_16x16x32_bf16 v[8:11], a[192:195], v[184:187], v[8:11]
  s_waitcnt lgkmcnt(8)
  v_exp_f32 v209, v209
  v_mfma_f32_16x16x32_bf16 v[12:15], a[196:199], v[168:171], v[12:15]
  ds_read_b64_tr_b16 a[216:217], v228 offset:1280
  v_add_f32 v236, v209, v236
  v_mfma_f32_16x16x32_bf16 v[16:19], a[196:199], v[176:179], v[16:19]
  ds_read_b64_tr_b16 a[218:219], v228 offset:9472
  v_cvt_pk_bf16_f32 v208, v208, v209
  v_mfma_f32_16x16x32_bf16 v[20:23], a[196:199], v[184:187], v[20:23]
  s_waitcnt lgkmcnt(8)
  v_exp_f32 v210, v210
  v_mfma_f32_16x16x32_bf16 v[24:27], a[200:203], v[168:171], v[24:27]
  ds_read_b64_tr_b16 a[220:221], v239 offset:1280
  v_add_f32 v236, v210, v236
  v_mfma_f32_16x16x32_bf16 v[28:31], a[200:203], v[176:179], v[28:31]
  buffer_load_dwordx4 v231, s[12:15], s29 offen offset:0 nt lds
  v_mfma_f32_16x16x32_bf16 v[32:35], a[200:203], v[184:187], v[32:35]
  s_waitcnt lgkmcnt(7)
  ds_read_b64_tr_b16 a[222:223], v239 offset:9472
  v_mfma_f32_16x16x32_bf16 v[36:39], a[204:207], v[168:171], v[36:39]
  s_add_u32 s29, s29, s30
  ds_read_b64_tr_b16 a[192:193], v228 offset:2048
  v_mfma_f32_16x16x32_bf16 v[40:43], a[204:207], v[176:179], v[40:43]
  ds_read_b64_tr_b16 a[194:195], v228 offset:10240
  v_mfma_f32_16x16x32_bf16 v[44:47], a[204:207], v[184:187], v[44:47]
  s_waitcnt lgkmcnt(8)
  v_exp_f32 v211, v211
  v_mfma_f32_16x16x32_bf16 v[48:51], a[208:211], v[168:171], v[48:51]
  ds_read_b64_tr_b16 a[196:197], v239 offset:2048
  v_add_f32 v236, v211, v236
  v_mfma_f32_16x16x32_bf16 v[52:55], a[208:211], v[176:179], v[52:55]
  buffer_load_dwordx4 v231, s[12:15], s29 offen offset:1024 nt lds
  v_mfma_f32_16x16x32_bf16 v[56:59], a[208:211], v[184:187], v[56:59]
  s_waitcnt lgkmcnt(7)
  ds_read_b64_tr_b16 a[198:199], v239 offset:10240
  v_cvt_pk_bf16_f32 v209, v210, v211
  v_mfma_f32_16x16x32_bf16 v[60:63], a[212:215], v[168:171], v[60:63]
  s_add_u32 s29, s29, s30
  ds_read_b64_tr_b16 a[200:201], v228 offset:2304
  v_mfma_f32_16x16x32_bf16 v[64:67], a[212:215], v[176:179], v[64:67]
  ds_read_b64_tr_b16 a[202:203], v228 offset:10496
  v_mfma_f32_16x16x32_bf16 v[68:71], a[212:215], v[184:187], v[68:71]
  s_waitcnt lgkmcnt(8)
  v_exp_f32 v196, v196
  v_mfma_f32_16x16x32_bf16 v[72:75], a[216:219], v[168:171], v[72:75]
  ds_read_b64_tr_b16 a[204:205], v239 offset:2304
  v_add_f32 v234, v196, v234
  v_mfma_f32_16x16x32_bf16 v[76:79], a[216:219], v[176:179], v[76:79]
  buffer_load_dwordx4 v231, s[12:15], s29 offen offset:2048 nt lds
  v_mfma_f32_16x16x32_bf16 v[80:83], a[216:219], v[184:187], v[80:83]
  s_waitcnt lgkmcnt(7)
  ds_read_b64_tr_b16 a[206:207], v239 offset:10496
  v_mfma_f32_16x16x32_bf16 v[84:87], a[220:223], v[168:171], v[84:87]
  s_add_u32 s29, s29, s30
  ds_read_b64_tr_b16 a[208:209], v228 offset:3072
  v_mfma_f32_16x16x32_bf16 v[88:91], a[220:223], v[176:179], v[88:91]
  ds_read_b64_tr_b16 a[210:211], v228 offset:11264
  v_mfma_f32_16x16x32_bf16 v[92:95], a[220:223], v[184:187], v[92:95]
  s_waitcnt lgkmcnt(8)
  v_exp_f32 v197, v197
  v_mfma_f32_16x16x32_bf16 v[96:99], a[192:195], v[168:171], v[96:99]
  ds_read_b64_tr_b16 a[212:213], v239 offset:3072
  v_add_f32 v234, v197, v234
  v_mfma_f32_16x16x32_bf16 v[100:103], a[192:195], v[176:179], v[100:103]
  buffer_load_dwordx4 v231, s[12:15], s29 offen offset:3072 nt lds
  v_mfma_f32_16x16x32_bf16 v[104:107], a[192:195], v[184:187], v[104:107]
  s_waitcnt lgkmcnt(7)
  ds_read_b64_tr_b16 a[214:215], v239 offset:11264
  v_cvt_pk_bf16_f32 v194, v196, v197
  v_mfma_f32_16x16x32_bf16 v[108:111], a[196:199], v[168:171], v[108:111]
  s_waitcnt vmcnt(4)
  ds_read_b64_tr_b16 a[216:217], v228 offset:3328
  v_mfma_f32_16x16x32_bf16 v[112:115], a[196:199], v[176:179], v[112:115]
  s_barrier
  ds_read_b64_tr_b16 a[218:219], v228 offset:11520
  v_mfma_f32_16x16x32_bf16 v[116:119], a[196:199], v[184:187], v[116:119]
  s_waitcnt lgkmcnt(8)
  v_exp_f32 v198, v198
  v_mfma_f32_16x16x32_bf16 v[120:123], a[200:203], v[168:171], v[120:123]
  ds_read_b64_tr_b16 a[220:221], v239 offset:3328
  v_add_f32 v234, v198, v234
  v_mfma_f32_16x16x32_bf16 v[124:127], a[200:203], v[176:179], v[124:127]
  ds_read_b64_tr_b16 a[222:223], v239 offset:11520
  v_add_u32 v228, 114688, v229
  v_mfma_f32_16x16x32_bf16 v[128:131], a[200:203], v[184:187], v[128:131]
  s_waitcnt lgkmcnt(8)
  v_exp_f32 v199, v199
  v_mfma_f32_16x16x32_bf16 v[132:135], a[204:207], v[168:171], v[132:135]
  ds_read_b128 a[192:195], v228 offset:0
  v_add_f32 v234, v199, v234
  v_mfma_f32_16x16x32_bf16 v[136:139], a[204:207], v[176:179], v[136:139]
  v_exp_f32 v204, v204
  v_mfma_f32_16x16x32_bf16 v[140:143], a[204:207], v[184:187], v[140:143]
  s_waitcnt lgkmcnt(7)
  v_exp_f32 v205, v205
  v_mfma_f32_16x16x32_bf16 v[144:147], a[208:211], v[168:171], v[144:147]
  ds_read_b128 a[196:199], v228 offset:256
  v_cvt_pk_bf16_f32 v195, v198, v199
  v_mfma_f32_16x16x32_bf16 v[148:151], a[208:211], v[176:179], v[148:151]
  v_exp_f32 v206, v206
  v_mfma_f32_16x16x32_bf16 v[152:155], a[208:211], v[184:187], v[152:155]
  s_waitcnt lgkmcnt(6)
  v_exp_f32 v207, v207
  v_mfma_f32_16x16x32_bf16 v[156:159], a[212:215], v[168:171], v[156:159]
  ds_read_b128 a[200:203], v228 offset:1024
  v_add_f32 v235, v204, v235
  v_mfma_f32_16x16x32_bf16 v[160:163], a[212:215], v[176:179], v[160:163]
  v_exp_f32 v212, v212
  v_mfma_f32_16x16x32_bf16 v[164:167], a[212:215], v[184:187], v[164:167]
  s_waitcnt lgkmcnt(5)
  v_exp_f32 v213, v213
  v_mfma_f32_16x16x32_bf16 a[224:227], a[216:219], v[168:171], a[224:227]
  ds_read_b128 a[204:207], v228 offset:1280
  v_add_f32 v235, v205, v235
  v_mfma_f32_16x16x32_bf16 a[228:231], a[216:219], v[176:179], a[228:231]
  v_exp_f32 v214, v214
  v_mfma_f32_16x16x32_bf16 a[232:235], a[216:219], v[184:187], a[232:235]
  s_waitcnt lgkmcnt(4)
  v_exp_f32 v215, v215
  v_mfma_f32_16x16x32_bf16 a[236:239], a[220:223], v[168:171], a[236:239]
  ds_read_b128 a[208:211], v228 offset:2048
  v_cvt_pk_bf16_f32 v202, v204, v205
  v_mfma_f32_16x16x32_bf16 a[240:243], a[220:223], v[176:179], a[240:243]
  v_add_f32 v235, v206, v235
  v_add_f32 v236, v212, v236
  v_mfma_f32_16x16x32_bf16 a[244:247], a[220:223], v[184:187], a[244:247]
  s_waitcnt lgkmcnt(4)
  v_add_f32 v235, v207, v235
  v_add_f32 v236, v213, v236
  v_mfma_f32_16x16x32_bf16 v[168:171], a[192:195], a[0:3], v[216:219]
  s_add_u32 m0, s28, 0
  ds_read_b128 a[212:215], v228 offset:2304
  v_cvt_pk_bf16_f32 v203, v206, v207
  v_mfma_f32_16x16x32_bf16 v[176:179], a[192:195], a[4:7], v[220:223]
  s_mov_b32 s29, 445440
  v_cvt_pk_bf16_f32 v210, v212, v213
  v_add_f32 v236, v214, v236
  v_mfma_f32_16x16x32_bf16 v[184:187], a[192:195], a[8:11], v[224:227]
  s_waitcnt lgkmcnt(4)
  v_add_f32 v236, v215, v236
  v_mfma_f32_16x16x32_bf16 v[168:171], a[196:199], a[12:15], v[168:171]
  ds_read_b128 a[216:219], v228 offset:3072
  v_cvt_pk_bf16_f32 v211, v214, v215
  v_mfma_f32_16x16x32_bf16 v[176:179], a[196:199], a[16:19], v[176:179]
  v_mfma_f32_16x16x32_bf16 v[184:187], a[196:199], a[20:23], v[184:187]
  s_waitcnt lgkmcnt(4)
  v_mfma_f32_16x16x32_bf16 v[168:171], a[200:203], a[24:27], v[168:171]
  ds_read_b128 a[220:223], v228 offset:3328
  v_mfma_f32_16x16x32_bf16 v[176:179], a[200:203], a[28:31], v[176:179]
  buffer_load_dwordx4 v231, s[8:11], s29 offen offset:0 nt lds
  v_mfma_f32_16x16x32_bf16 v[184:187], a[200:203], a[32:35], v[184:187]
  s_waitcnt lgkmcnt(4)
  v_mfma_f32_16x16x32_bf16 v[168:171], a[204:207], a[36:39], v[168:171]
  s_add_u32 s29, s29, s30
  ds_read_b128 a[192:195], v228 offset:8192
  v_mfma_f32_16x16x32_bf16 v[176:179], a[204:207], a[40:43], v[176:179]
  v_mfma_f32_16x16x32_bf16 v[184:187], a[204:207], a[44:47], v[184:187]
  s_waitcnt lgkmcnt(4)
  v_mfma_f32_16x16x32_bf16 v[168:171], a[208:211], a[48:51], v[168:171]
  ds_read_b128 a[196:199], v228 offset:8448
  v_mfma_f32_16x16x32_bf16 v[176:179], a[208:211], a[52:55], v[176:179]
  buffer_load_dwordx4 v231, s[8:11], s29 offen offset:1024 nt lds
  v_mfma_f32_16x16x32_bf16 v[184:187], a[208:211], a[56:59], v[184:187]
  s_waitcnt lgkmcnt(4)
  v_mfma_f32_16x16x32_bf16 v[168:171], a[212:215], a[60:63], v[168:171]
  s_add_u32 s29, s29, s30
  ds_read_b128 a[200:203], v228 offset:9216
  v_mfma_f32_16x16x32_bf16 v[176:179], a[212:215], a[64:67], v[176:179]
  v_mfma_f32_16x16x32_bf16 v[184:187], a[212:215], a[68:71], v[184:187]
  s_waitcnt lgkmcnt(4)
  v_mfma_f32_16x16x32_bf16 v[168:171], a[216:219], a[72:75], v[168:171]
  ds_read_b128 a[204:207], v228 offset:9472
  v_mfma_f32_16x16x32_bf16 v[176:179], a[216:219], a[76:79], v[176:179]
  buffer_load_dwordx4 v231, s[8:11], s29 offen offset:2048 nt lds
  v_mfma_f32_16x16x32_bf16 v[184:187], a[216:219], a[80:83], v[184:187]
  s_waitcnt lgkmcnt(4)
  v_mfma_f32_16x16x32_bf16 v[168:171], a[220:223], a[84:87], v[168:171]
  s_add_u32 s29, s29, s30
  ds_read_b128 a[208:211], v228 offset:10240
  v_mfma_f32_16x16x32_bf16 v[176:179], a[220:223], a[88:91], v[176:179]
  v_mfma_f32_16x16x32_bf16 v[184:187], a[220:223], a[92:95], v[184:187]
  s_waitcnt lgkmcnt(4)
  v_mfma_f32_16x16x32_bf16 v[172:175], a[192:195], a[0:3], v[216:219]
  ds_read_b128 a[212:215], v228 offset:10496
  v_mfma_f32_16x16x32_bf16 v[180:183], a[192:195], a[4:7], v[220:223]
  buffer_load_dwordx4 v231, s[8:11], s29 offen offset:3072 nt lds
  v_mfma_f32_16x16x32_bf16 v[188:191], a[192:195], a[8:11], v[224:227]
  s_waitcnt lgkmcnt(4)
  v_exp_f32 v168, v168
  v_mfma_f32_16x16x32_bf16 v[172:175], a[196:199], a[12:15], v[172:175]
  s_waitcnt vmcnt(4)
  ds_read_b128 a[216:219], v228 offset:11264
  v_add_f32 v234, v168, v234
  v_mfma_f32_16x16x32_bf16 v[180:183], a[196:199], a[16:19], v[180:183]
  s_barrier
  v_exp_f32 v169, v169
  v_mfma_f32_16x16x32_bf16 v[188:191], a[196:199], a[20:23], v[188:191]
  s_waitcnt lgkmcnt(4)
  v_exp_f32 v170, v170
  v_mfma_f32_16x16x32_bf16 v[172:175], a[200:203], a[24:27], v[172:175]
  ds_read_b128 a[220:223], v228 offset:11520
  v_add_u32 v228, 81920, v230
  v_mfma_f32_16x16x32_bf16 v[180:183], a[200:203], a[28:31], v[180:183]
  v_xor_b32 v239, 32, v228
  v_mfma_f32_16x16x32_bf16 v[188:191], a[200:203], a[32:35], v[188:191]
  s_waitcnt lgkmcnt(4)
  v_exp_f32 v171, v171
  v_mfma_f32_16x16x32_bf16 v[172:175], a[204:207], a[36:39], v[172:175]
  ds_read_b64_tr_b16 a[192:193], v228 offset:0
  v_add_f32 v234, v169, v234
  v_mfma_f32_16x16x32_bf16 v[180:183], a[204:207], a[40:43], v[180:183]
  ds_read_b64_tr_b16 a[194:195], v228 offset:8192
  v_cvt_pk_bf16_f32 v168, v168, v169
  v_mfma_f32_16x16x32_bf16 v[188:191], a[204:207], a[44:47], v[188:191]
  s_waitcnt lgkmcnt(5)
  v_exp_f32 v176, v176
  v_mfma_f32_16x16x32_bf16 v[172:175], a[208:211], a[48:51], v[172:175]
  ds_read_b64_tr_b16 a[196:197], v239 offset:0
  v_add_f32 v234, v170, v234
  v_mfma_f32_16x16x32_bf16 v[180:183], a[208:211], a[52:55], v[180:183]
  ds_read_b64_tr_b16 a[198:199], v239 offset:8192
  v_add_f32 v234, v171, v234
  v_mfma_f32_16x16x32_bf16 v[188:191], a[208:211], a[56:59], v[188:191]
  s_waitcnt lgkmcnt(6)
  v_exp_f32 v177, v177
  v_mfma_f32_16x16x32_bf16 v[172:175], a[212:215], a[60:63], v[172:175]
  ds_read_b64_tr_b16 a[200:201], v228 offset:256
  v_cvt_pk_bf16_f32 v169, v170, v171
  v_mfma_f32_16x16x32_bf16 v[180:183], a[212:215], a[64:67], v[180:183]
  ds_read_b64_tr_b16 a[202:203], v228 offset:8448
  v_add_f32 v235, v176, v235
  v_mfma_f32_16x16x32_bf16 v[188:191], a[212:215], a[68:71], v[188:191]
  s_waitcnt lgkmcnt(7)
  v_exp_f32 v178, v178
  v_mfma_f32_16x16x32_bf16 v[172:175], a[216:219], a[72:75], v[172:175]
  ds_read_b64_tr_b16 a[204:205], v239 offset:256
  v_add_f32 v235, v177, v235
  v_mfma_f32_16x16x32_bf16 v[180:183], a[216:219], a[76:79], v[180:183]
  ds_read_b64_tr_b16 a[206:207], v239 offset:8448
  v_cvt_pk_bf16_f32 v176, v176, v177
  v_mfma_f32_16x16x32_bf16 v[188:191], a[216:219], a[80:83], v[188:191]
  s_waitcnt lgkmcnt(8)
  v_exp_f32 v179, v179
  v_mfma_f32_16x16x32_bf16 v[172:175], a[220:223], a[84:87], v[172:175]
  ds_read_b64_tr_b16 a[208:209], v228 offset:1024
  v_add_f32 v235, v178, v235
  v_mfma_f32_16x16x32_bf16 v[180:183], a[220:223], a[88:91], v[180:183]
  ds_read_b64_tr_b16 a[210:211], v228 offset:9216
  v_add_f32 v235, v179, v235
  v_mfma_f32_16x16x32_bf16 v[188:191], a[220:223], a[92:95], v[188:191]
  s_waitcnt lgkmcnt(8)
  v_exp_f32 v184, v184
  v_mfma_f32_16x16x32_bf16 v[0:3], a[192:195], v[192:195], v[0:3]
  s_add_u32 m0, s28, 98304
  ds_read_b64_tr_b16 a[212:213], v239 offset:1024
  v_cvt_pk_bf16_f32 v177, v178, v179
  v_mfma_f32_16x16x32_bf16 v[4:7], a[192:195], v[200:203], v[4:7]
  s_mov_b32 s29, 429056
  ds_read_b64_tr_b16 a[214:215], v239 offset:9216
  v_add_f32 v236, v184, v236
  v_mfma_f32_16x16x32_bf16 v[8:11], a[192:195], v[208:211], v[8:11]
  s_waitcnt lgkmcnt(8)
  v_exp_f32 v185, v185
  v_mfma_f32_16x16x32_bf16 v[12:15], a[196:199], v[192:195], v[12:15]
  ds_read_b64_tr_b16 a[216:217], v228 offset:1280
  v_add_f32 v236, v185, v236
  v_mfma_f32_16x16x32_bf16 v[16:19], a[196:199], v[200:203], v[16:19]
  ds_read_b64_tr_b16 a[218:219], v228 offset:9472
  v_cvt_pk_bf16_f32 v184, v184, v185
  v_mfma_f32_16x16x32_bf16 v[20:23], a[196:199], v[208:211], v[20:23]
  s_waitcnt lgkmcnt(8)
  v_exp_f32 v186, v186
  v_mfma_f32_16x16x32_bf16 v[24:27], a[200:203], v[192:195], v[24:27]
  ds_read_b64_tr_b16 a[220:221], v239 offset:1280
  v_add_f32 v236, v186, v236
  v_mfma_f32_16x16x32_bf16 v[28:31], a[200:203], v[200:203], v[28:31]
  buffer_load_dwordx4 v231, s[12:15], s29 offen offset:0 nt lds
  v_mfma_f32_16x16x32_bf16 v[32:35], a[200:203], v[208:211], v[32:35]
  s_waitcnt lgkmcnt(7)
  ds_read_b64_tr_b16 a[222:223], v239 offset:9472
  v_mfma_f32_16x16x32_bf16 v[36:39], a[204:207], v[192:195], v[36:39]
  s_add_u32 s29, s29, s30
  ds_read_b64_tr_b16 a[192:193], v228 offset:2048
  v_mfma_f32_16x16x32_bf16 v[40:43], a[204:207], v[200:203], v[40:43]
  ds_read_b64_tr_b16 a[194:195], v228 offset:10240
  v_mfma_f32_16x16x32_bf16 v[44:47], a[204:207], v[208:211], v[44:47]
  s_waitcnt lgkmcnt(8)
  v_exp_f32 v187, v187
  v_mfma_f32_16x16x32_bf16 v[48:51], a[208:211], v[192:195], v[48:51]
  ds_read_b64_tr_b16 a[196:197], v239 offset:2048
  v_add_f32 v236, v187, v236
  v_mfma_f32_16x16x32_bf16 v[52:55], a[208:211], v[200:203], v[52:55]
  buffer_load_dwordx4 v231, s[12:15], s29 offen offset:1024 nt lds
  v_mfma_f32_16x16x32_bf16 v[56:59], a[208:211], v[208:211], v[56:59]
  s_waitcnt lgkmcnt(7)
  ds_read_b64_tr_b16 a[198:199], v239 offset:10240
  v_cvt_pk_bf16_f32 v185, v186, v187
  v_mfma_f32_16x16x32_bf16 v[60:63], a[212:215], v[192:195], v[60:63]
  s_add_u32 s29, s29, s30
  ds_read_b64_tr_b16 a[200:201], v228 offset:2304
  v_mfma_f32_16x16x32_bf16 v[64:67], a[212:215], v[200:203], v[64:67]
  ds_read_b64_tr_b16 a[202:203], v228 offset:10496
  v_mfma_f32_16x16x32_bf16 v[68:71], a[212:215], v[208:211], v[68:71]
  s_waitcnt lgkmcnt(8)
  v_exp_f32 v172, v172
  v_mfma_f32_16x16x32_bf16 v[72:75], a[216:219], v[192:195], v[72:75]
  ds_read_b64_tr_b16 a[204:205], v239 offset:2304
  v_add_f32 v234, v172, v234
  v_mfma_f32_16x16x32_bf16 v[76:79], a[216:219], v[200:203], v[76:79]
  buffer_load_dwordx4 v231, s[12:15], s29 offen offset:2048 nt lds
  v_mfma_f32_16x16x32_bf16 v[80:83], a[216:219], v[208:211], v[80:83]
  s_waitcnt lgkmcnt(7)
  ds_read_b64_tr_b16 a[206:207], v239 offset:10496
  v_mfma_f32_16x16x32_bf16 v[84:87], a[220:223], v[192:195], v[84:87]
  s_add_u32 s29, s29, s30
  ds_read_b64_tr_b16 a[208:209], v228 offset:3072
  v_mfma_f32_16x16x32_bf16 v[88:91], a[220:223], v[200:203], v[88:91]
  ds_read_b64_tr_b16 a[210:211], v228 offset:11264
  v_mfma_f32_16x16x32_bf16 v[92:95], a[220:223], v[208:211], v[92:95]
  s_waitcnt lgkmcnt(8)
  v_exp_f32 v173, v173
  v_mfma_f32_16x16x32_bf16 v[96:99], a[192:195], v[192:195], v[96:99]
  ds_read_b64_tr_b16 a[212:213], v239 offset:3072
  v_add_f32 v234, v173, v234
  v_mfma_f32_16x16x32_bf16 v[100:103], a[192:195], v[200:203], v[100:103]
  buffer_load_dwordx4 v231, s[12:15], s29 offen offset:3072 nt lds
  v_mfma_f32_16x16x32_bf16 v[104:107], a[192:195], v[208:211], v[104:107]
  s_waitcnt lgkmcnt(7)
  ds_read_b64_tr_b16 a[214:215], v239 offset:11264
  v_cvt_pk_bf16_f32 v170, v172, v173
  v_mfma_f32_16x16x32_bf16 v[108:111], a[196:199], v[192:195], v[108:111]
  s_waitcnt vmcnt(4)
  ds_read_b64_tr_b16 a[216:217], v228 offset:3328
  v_mfma_f32_16x16x32_bf16 v[112:115], a[196:199], v[200:203], v[112:115]
  s_barrier
  ds_read_b64_tr_b16 a[218:219], v228 offset:11520
  v_mfma_f32_16x16x32_bf16 v[116:119], a[196:199], v[208:211], v[116:119]
  s_waitcnt lgkmcnt(8)
  v_exp_f32 v174, v174
  v_mfma_f32_16x16x32_bf16 v[120:123], a[200:203], v[192:195], v[120:123]
  ds_read_b64_tr_b16 a[220:221], v239 offset:3328
  v_add_f32 v234, v174, v234
  v_mfma_f32_16x16x32_bf16 v[124:127], a[200:203], v[200:203], v[124:127]
  ds_read_b64_tr_b16 a[222:223], v239 offset:11520
  v_add_u32 v228, 0, v229
  v_mfma_f32_16x16x32_bf16 v[128:131], a[200:203], v[208:211], v[128:131]
  s_waitcnt lgkmcnt(8)
  v_exp_f32 v175, v175
  v_mfma_f32_16x16x32_bf16 v[132:135], a[204:207], v[192:195], v[132:135]
  ds_read_b128 a[192:195], v228 offset:0
  v_add_f32 v234, v175, v234
  v_mfma_f32_16x16x32_bf16 v[136:139], a[204:207], v[200:203], v[136:139]
  v_exp_f32 v180, v180
  v_mfma_f32_16x16x32_bf16 v[140:143], a[204:207], v[208:211], v[140:143]
  s_waitcnt lgkmcnt(7)
  v_exp_f32 v181, v181
  v_mfma_f32_16x16x32_bf16 v[144:147], a[208:211], v[192:195], v[144:147]
  ds_read_b128 a[196:199], v228 offset:256
  v_cvt_pk_bf16_f32 v171, v174, v175
  v_mfma_f32_16x16x32_bf16 v[148:151], a[208:211], v[200:203], v[148:151]
  v_exp_f32 v182, v182
  v_mfma_f32_16x16x32_bf16 v[152:155], a[208:211], v[208:211], v[152:155]
  s_waitcnt lgkmcnt(6)
  v_exp_f32 v183, v183
  v_mfma_f32_16x16x32_bf16 v[156:159], a[212:215], v[192:195], v[156:159]
  ds_read_b128 a[200:203], v228 offset:1024
  v_add_f32 v235, v180, v235
  v_mfma_f32_16x16x32_bf16 v[160:163], a[212:215], v[200:203], v[160:163]
  v_exp_f32 v188, v188
  v_mfma_f32_16x16x32_bf16 v[164:167], a[212:215], v[208:211], v[164:167]
  s_waitcnt lgkmcnt(5)
  v_exp_f32 v189, v189
  v_mfma_f32_16x16x32_bf16 a[224:227], a[216:219], v[192:195], a[224:227]
  ds_read_b128 a[204:207], v228 offset:1280
  v_add_f32 v235, v181, v235
  v_mfma_f32_16x16x32_bf16 a[228:231], a[216:219], v[200:203], a[228:231]
  v_exp_f32 v190, v190
  v_mfma_f32_16x16x32_bf16 a[232:235], a[216:219], v[208:211], a[232:235]
  s_waitcnt lgkmcnt(4)
  v_exp_f32 v191, v191
  v_mfma_f32_16x16x32_bf16 a[236:239], a[220:223], v[192:195], a[236:239]
  ds_read_b128 a[208:211], v228 offset:2048
  v_cvt_pk_bf16_f32 v178, v180, v181
  v_mfma_f32_16x16x32_bf16 a[240:243], a[220:223], v[200:203], a[240:243]
  v_add_f32 v235, v182, v235
  v_add_f32 v236, v188, v236
  v_mfma_f32_16x16x32_bf16 a[244:247], a[220:223], v[208:211], a[244:247]
  s_waitcnt lgkmcnt(4)
  v_add_f32 v235, v183, v235
  v_add_f32 v236, v189, v236
  v_mfma_f32_16x16x32_bf16 v[192:195], a[192:195], a[0:3], v[216:219]
  s_add_u32 m0, s28, 16384
  ds_read_b128 a[212:215], v228 offset:2304
  v_cvt_pk_bf16_f32 v179, v182, v183
  v_mfma_f32_16x16x32_bf16 v[200:203], a[192:195], a[4:7], v[220:223]
  s_mov_b32 s29, 461824
  v_cvt_pk_bf16_f32 v186, v188, v189
  v_add_f32 v236, v190, v236
  v_mfma_f32_16x16x32_bf16 v[208:211], a[192:195], a[8:11], v[224:227]
  s_waitcnt lgkmcnt(4)
  v_add_f32 v236, v191, v236
  v_mfma_f32_16x16x32_bf16 v[192:195], a[196:199], a[12:15], v[192:195]
  ds_read_b128 a[216:219], v228 offset:3072
  v_cvt_pk_bf16_f32 v187, v190, v191
  v_mfma_f32_16x16x32_bf16 v[200:203], a[196:199], a[16:19], v[200:203]
  v_mfma_f32_16x16x32_bf16 v[208:211], a[196:199], a[20:23], v[208:211]
  s_waitcnt lgkmcnt(4)
  v_mfma_f32_16x16x32_bf16 v[192:195], a[200:203], a[24:27], v[192:195]
  ds_read_b128 a[220:223], v228 offset:3328
  v_mfma_f32_16x16x32_bf16 v[200:203], a[200:203], a[28:31], v[200:203]
  buffer_load_dwordx4 v231, s[8:11], s29 offen offset:0 nt lds
  v_mfma_f32_16x16x32_bf16 v[208:211], a[200:203], a[32:35], v[208:211]
  s_waitcnt lgkmcnt(4)
  v_mfma_f32_16x16x32_bf16 v[192:195], a[204:207], a[36:39], v[192:195]
  s_add_u32 s29, s29, s30
  ds_read_b128 a[192:195], v228 offset:8192
  v_mfma_f32_16x16x32_bf16 v[200:203], a[204:207], a[40:43], v[200:203]
  v_mfma_f32_16x16x32_bf16 v[208:211], a[204:207], a[44:47], v[208:211]
  s_waitcnt lgkmcnt(4)
  v_mfma_f32_16x16x32_bf16 v[192:195], a[208:211], a[48:51], v[192:195]
  ds_read_b128 a[196:199], v228 offset:8448
  v_mfma_f32_16x16x32_bf16 v[200:203], a[208:211], a[52:55], v[200:203]
  buffer_load_dwordx4 v231, s[8:11], s29 offen offset:1024 nt lds
  v_mfma_f32_16x16x32_bf16 v[208:211], a[208:211], a[56:59], v[208:211]
  s_waitcnt lgkmcnt(4)
  v_mfma_f32_16x16x32_bf16 v[192:195], a[212:215], a[60:63], v[192:195]
  s_add_u32 s29, s29, s30
  ds_read_b128 a[200:203], v228 offset:9216
  v_mfma_f32_16x16x32_bf16 v[200:203], a[212:215], a[64:67], v[200:203]
  v_mfma_f32_16x16x32_bf16 v[208:211], a[212:215], a[68:71], v[208:211]
  s_waitcnt lgkmcnt(4)
  v_mfma_f32_16x16x32_bf16 v[192:195], a[216:219], a[72:75], v[192:195]
  ds_read_b128 a[204:207], v228 offset:9472
  v_mfma_f32_16x16x32_bf16 v[200:203], a[216:219], a[76:79], v[200:203]
  buffer_load_dwordx4 v231, s[8:11], s29 offen offset:2048 nt lds
  v_mfma_f32_16x16x32_bf16 v[208:211], a[216:219], a[80:83], v[208:211]
  s_waitcnt lgkmcnt(4)
  v_mfma_f32_16x16x32_bf16 v[192:195], a[220:223], a[84:87], v[192:195]
  s_add_u32 s29, s29, s30
  ds_read_b128 a[208:211], v228 offset:10240
  v_mfma_f32_16x16x32_bf16 v[200:203], a[220:223], a[88:91], v[200:203]
  v_mfma_f32_16x16x32_bf16 v[208:211], a[220:223], a[92:95], v[208:211]
  s_waitcnt lgkmcnt(4)
  v_mfma_f32_16x16x32_bf16 v[196:199], a[192:195], a[0:3], v[216:219]
  ds_read_b128 a[212:215], v228 offset:10496
  v_mfma_f32_16x16x32_bf16 v[204:207], a[192:195], a[4:7], v[220:223]
  buffer_load_dwordx4 v231, s[8:11], s29 offen offset:3072 nt lds
  v_mfma_f32_16x16x32_bf16 v[212:215], a[192:195], a[8:11], v[224:227]
  s_waitcnt lgkmcnt(4)
  v_exp_f32 v192, v192
  v_mfma_f32_16x16x32_bf16 v[196:199], a[196:199], a[12:15], v[196:199]
  s_waitcnt vmcnt(4)
  ds_read_b128 a[216:219], v228 offset:11264
  v_add_f32 v234, v192, v234
  v_mfma_f32_16x16x32_bf16 v[204:207], a[196:199], a[16:19], v[204:207]
  s_barrier
  v_exp_f32 v193, v193
  v_mfma_f32_16x16x32_bf16 v[212:215], a[196:199], a[20:23], v[212:215]
  s_waitcnt lgkmcnt(4)
  v_exp_f32 v194, v194
  v_mfma_f32_16x16x32_bf16 v[196:199], a[200:203], a[24:27], v[196:199]
  ds_read_b128 a[220:223], v228 offset:11520
  v_add_u32 v228, 98304, v230
  v_mfma_f32_16x16x32_bf16 v[204:207], a[200:203], a[28:31], v[204:207]
  v_xor_b32 v239, 32, v228
  v_mfma_f32_16x16x32_bf16 v[212:215], a[200:203], a[32:35], v[212:215]
  s_waitcnt lgkmcnt(4)
  v_exp_f32 v195, v195
  v_mfma_f32_16x16x32_bf16 v[196:199], a[204:207], a[36:39], v[196:199]
  ds_read_b64_tr_b16 a[192:193], v228 offset:0
  v_add_f32 v234, v193, v234
  v_mfma_f32_16x16x32_bf16 v[204:207], a[204:207], a[40:43], v[204:207]
  ds_read_b64_tr_b16 a[194:195], v228 offset:8192
  v_cvt_pk_bf16_f32 v192, v192, v193
  v_mfma_f32_16x16x32_bf16 v[212:215], a[204:207], a[44:47], v[212:215]
  s_waitcnt lgkmcnt(5)
  v_exp_f32 v200, v200
  v_mfma_f32_16x16x32_bf16 v[196:199], a[208:211], a[48:51], v[196:199]
  ds_read_b64_tr_b16 a[196:197], v239 offset:0
  v_add_f32 v234, v194, v234
  v_mfma_f32_16x16x32_bf16 v[204:207], a[208:211], a[52:55], v[204:207]
  ds_read_b64_tr_b16 a[198:199], v239 offset:8192
  v_add_f32 v234, v195, v234
  v_mfma_f32_16x16x32_bf16 v[212:215], a[208:211], a[56:59], v[212:215]
  s_waitcnt lgkmcnt(6)
  v_exp_f32 v201, v201
  v_mfma_f32_16x16x32_bf16 v[196:199], a[212:215], a[60:63], v[196:199]
  ds_read_b64_tr_b16 a[200:201], v228 offset:256
  v_cvt_pk_bf16_f32 v193, v194, v195
  v_mfma_f32_16x16x32_bf16 v[204:207], a[212:215], a[64:67], v[204:207]
  ds_read_b64_tr_b16 a[202:203], v228 offset:8448
  v_add_f32 v235, v200, v235
  v_mfma_f32_16x16x32_bf16 v[212:215], a[212:215], a[68:71], v[212:215]
  s_waitcnt lgkmcnt(7)
  v_exp_f32 v202, v202
  v_mfma_f32_16x16x32_bf16 v[196:199], a[216:219], a[72:75], v[196:199]
  ds_read_b64_tr_b16 a[204:205], v239 offset:256
  v_add_f32 v235, v201, v235
  v_mfma_f32_16x16x32_bf16 v[204:207], a[216:219], a[76:79], v[204:207]
  ds_read_b64_tr_b16 a[206:207], v239 offset:8448
  v_cvt_pk_bf16_f32 v200, v200, v201
  v_mfma_f32_16x16x32_bf16 v[212:215], a[216:219], a[80:83], v[212:215]
  s_waitcnt lgkmcnt(8)
  v_exp_f32 v203, v203
  v_mfma_f32_16x16x32_bf16 v[196:199], a[220:223], a[84:87], v[196:199]
  ds_read_b64_tr_b16 a[208:209], v228 offset:1024
  v_add_f32 v235, v202, v235
  v_mfma_f32_16x16x32_bf16 v[204:207], a[220:223], a[88:91], v[204:207]
  ds_read_b64_tr_b16 a[210:211], v228 offset:9216
  v_add_f32 v235, v203, v235
  v_mfma_f32_16x16x32_bf16 v[212:215], a[220:223], a[92:95], v[212:215]
  s_waitcnt lgkmcnt(8)
  v_exp_f32 v208, v208
  v_mfma_f32_16x16x32_bf16 v[0:3], a[192:195], v[168:171], v[0:3]
  s_add_u32 m0, s28, 114688
  ds_read_b64_tr_b16 a[212:213], v239 offset:1024
  v_cvt_pk_bf16_f32 v201, v202, v203
  v_mfma_f32_16x16x32_bf16 v[4:7], a[192:195], v[176:179], v[4:7]
  s_mov_b32 s29, 445440
  ds_read_b64_tr_b16 a[214:215], v239 offset:9216
  v_add_f32 v236, v208, v236
  v_mfma_f32_16x16x32_bf16 v[8:11], a[192:195], v[184:187], v[8:11]
  s_waitcnt lgkmcnt(8)
  v_exp_f32 v209, v209
  v_mfma_f32_16x16x32_bf16 v[12:15], a[196:199], v[168:171], v[12:15]
  ds_read_b64_tr_b16 a[216:217], v228 offset:1280
  v_add_f32 v236, v209, v236
  v_mfma_f32_16x16x32_bf16 v[16:19], a[196:199], v[176:179], v[16:19]
  ds_read_b64_tr_b16 a[218:219], v228 offset:9472
  v_cvt_pk_bf16_f32 v208, v208, v209
  v_mfma_f32_16x16x32_bf16 v[20:23], a[196:199], v[184:187], v[20:23]
  s_waitcnt lgkmcnt(8)
  v_exp_f32 v210, v210
  v_mfma_f32_16x16x32_bf16 v[24:27], a[200:203], v[168:171], v[24:27]
  ds_read_b64_tr_b16 a[220:221], v239 offset:1280
  v_add_f32 v236, v210, v236
  v_mfma_f32_16x16x32_bf16 v[28:31], a[200:203], v[176:179], v[28:31]
  buffer_load_dwordx4 v231, s[12:15], s29 offen offset:0 nt lds
  v_mfma_f32_16x16x32_bf16 v[32:35], a[200:203], v[184:187], v[32:35]
  s_waitcnt lgkmcnt(7)
  ds_read_b64_tr_b16 a[222:223], v239 offset:9472
  v_mfma_f32_16x16x32_bf16 v[36:39], a[204:207], v[168:171], v[36:39]
  s_add_u32 s29, s29, s30
  ds_read_b64_tr_b16 a[192:193], v228 offset:2048
  v_mfma_f32_16x16x32_bf16 v[40:43], a[204:207], v[176:179], v[40:43]
  ds_read_b64_tr_b16 a[194:195], v228 offset:10240
  v_mfma_f32_16x16x32_bf16 v[44:47], a[204:207], v[184:187], v[44:47]
  s_waitcnt lgkmcnt(8)
  v_exp_f32 v211, v211
  v_mfma_f32_16x16x32_bf16 v[48:51], a[208:211], v[168:171], v[48:51]
  ds_read_b64_tr_b16 a[196:197], v239 offset:2048
  v_add_f32 v236, v211, v236
  v_mfma_f32_16x16x32_bf16 v[52:55], a[208:211], v[176:179], v[52:55]
  buffer_load_dwordx4 v231, s[12:15], s29 offen offset:1024 nt lds
  v_mfma_f32_16x16x32_bf16 v[56:59], a[208:211], v[184:187], v[56:59]
  s_waitcnt lgkmcnt(7)
  ds_read_b64_tr_b16 a[198:199], v239 offset:10240
  v_cvt_pk_bf16_f32 v209, v210, v211
  v_mfma_f32_16x16x32_bf16 v[60:63], a[212:215], v[168:171], v[60:63]
  s_add_u32 s29, s29, s30
  ds_read_b64_tr_b16 a[200:201], v228 offset:2304
  v_mfma_f32_16x16x32_bf16 v[64:67], a[212:215], v[176:179], v[64:67]
  ds_read_b64_tr_b16 a[202:203], v228 offset:10496
  v_mfma_f32_16x16x32_bf16 v[68:71], a[212:215], v[184:187], v[68:71]
  s_waitcnt lgkmcnt(8)
  v_exp_f32 v196, v196
  v_mfma_f32_16x16x32_bf16 v[72:75], a[216:219], v[168:171], v[72:75]
  ds_read_b64_tr_b16 a[204:205], v239 offset:2304
  v_add_f32 v234, v196, v234
  v_mfma_f32_16x16x32_bf16 v[76:79], a[216:219], v[176:179], v[76:79]
  buffer_load_dwordx4 v231, s[12:15], s29 offen offset:2048 nt lds
  v_mfma_f32_16x16x32_bf16 v[80:83], a[216:219], v[184:187], v[80:83]
  s_waitcnt lgkmcnt(7)
  ds_read_b64_tr_b16 a[206:207], v239 offset:10496
  v_mfma_f32_16x16x32_bf16 v[84:87], a[220:223], v[168:171], v[84:87]
  s_add_u32 s29, s29, s30
  ds_read_b64_tr_b16 a[208:209], v228 offset:3072
  v_mfma_f32_16x16x32_bf16 v[88:91], a[220:223], v[176:179], v[88:91]
  ds_read_b64_tr_b16 a[210:211], v228 offset:11264
  v_mfma_f32_16x16x32_bf16 v[92:95], a[220:223], v[184:187], v[92:95]
  s_waitcnt lgkmcnt(8)
  v_exp_f32 v197, v197
  v_mfma_f32_16x16x32_bf16 v[96:99], a[192:195], v[168:171], v[96:99]
  ds_read_b64_tr_b16 a[212:213], v239 offset:3072
  v_add_f32 v234, v197, v234
  v_mfma_f32_16x16x32_bf16 v[100:103], a[192:195], v[176:179], v[100:103]
  buffer_load_dwordx4 v231, s[12:15], s29 offen offset:3072 nt lds
  v_mfma_f32_16x16x32_bf16 v[104:107], a[192:195], v[184:187], v[104:107]
  s_waitcnt lgkmcnt(7)
  ds_read_b64_tr_b16 a[214:215], v239 offset:11264
  v_cvt_pk_bf16_f32 v194, v196, v197
  v_mfma_f32_16x16x32_bf16 v[108:111], a[196:199], v[168:171], v[108:111]
  s_waitcnt vmcnt(4)
  ds_read_b64_tr_b16 a[216:217], v228 offset:3328
  v_mfma_f32_16x16x32_bf16 v[112:115], a[196:199], v[176:179], v[112:115]
  s_barrier
  ds_read_b64_tr_b16 a[218:219], v228 offset:11520
  v_mfma_f32_16x16x32_bf16 v[116:119], a[196:199], v[184:187], v[116:119]
  s_waitcnt lgkmcnt(8)
  v_exp_f32 v198, v198
  v_mfma_f32_16x16x32_bf16 v[120:123], a[200:203], v[168:171], v[120:123]
  ds_read_b64_tr_b16 a[220:221], v239 offset:3328
  v_add_f32 v234, v198, v234
  v_mfma_f32_16x16x32_bf16 v[124:127], a[200:203], v[176:179], v[124:127]
  ds_read_b64_tr_b16 a[222:223], v239 offset:11520
  v_add_u32 v228, 16384, v229
  v_mfma_f32_16x16x32_bf16 v[128:131], a[200:203], v[184:187], v[128:131]
  s_waitcnt lgkmcnt(8)
  v_exp_f32 v199, v199
  v_mfma_f32_16x16x32_bf16 v[132:135], a[204:207], v[168:171], v[132:135]
  ds_read_b128 a[192:195], v228 offset:0
  v_add_f32 v234, v199, v234
  v_mfma_f32_16x16x32_bf16 v[136:139], a[204:207], v[176:179], v[136:139]
  v_exp_f32 v204, v204
  v_mfma_f32_16x16x32_bf16 v[140:143], a[204:207], v[184:187], v[140:143]
  s_waitcnt lgkmcnt(7)
  v_exp_f32 v205, v205
  v_mfma_f32_16x16x32_bf16 v[144:147], a[208:211], v[168:171], v[144:147]
  ds_read_b128 a[196:199], v228 offset:256
  v_cvt_pk_bf16_f32 v195, v198, v199
  v_mfma_f32_16x16x32_bf16 v[148:151], a[208:211], v[176:179], v[148:151]
  v_exp_f32 v206, v206
  v_mfma_f32_16x16x32_bf16 v[152:155], a[208:211], v[184:187], v[152:155]
  s_waitcnt lgkmcnt(6)
  v_exp_f32 v207, v207
  v_mfma_f32_16x16x32_bf16 v[156:159], a[212:215], v[168:171], v[156:159]
  ds_read_b128 a[200:203], v228 offset:1024
  v_add_f32 v235, v204, v235
  v_mfma_f32_16x16x32_bf16 v[160:163], a[212:215], v[176:179], v[160:163]
  v_exp_f32 v212, v212
  v_mfma_f32_16x16x32_bf16 v[164:167], a[212:215], v[184:187], v[164:167]
  s_waitcnt lgkmcnt(5)
  v_exp_f32 v213, v213
  v_mfma_f32_16x16x32_bf16 a[224:227], a[216:219], v[168:171], a[224:227]
  ds_read_b128 a[204:207], v228 offset:1280
  v_add_f32 v235, v205, v235
  v_mfma_f32_16x16x32_bf16 a[228:231], a[216:219], v[176:179], a[228:231]
  v_exp_f32 v214, v214
  v_mfma_f32_16x16x32_bf16 a[232:235], a[216:219], v[184:187], a[232:235]
  s_waitcnt lgkmcnt(4)
  v_exp_f32 v215, v215
  v_mfma_f32_16x16x32_bf16 a[236:239], a[220:223], v[168:171], a[236:239]
  ds_read_b128 a[208:211], v228 offset:2048
  v_cvt_pk_bf16_f32 v202, v204, v205
  v_mfma_f32_16x16x32_bf16 a[240:243], a[220:223], v[176:179], a[240:243]
  v_add_f32 v235, v206, v235
  v_add_f32 v236, v212, v236
  v_mfma_f32_16x16x32_bf16 a[244:247], a[220:223], v[184:187], a[244:247]
  s_waitcnt lgkmcnt(4)
  v_add_f32 v235, v207, v235
  v_add_f32 v236, v213, v236
  v_mfma_f32_16x16x32_bf16 v[168:171], a[192:195], a[0:3], v[216:219]
  s_add_u32 m0, s28, 81920
  ds_read_b128 a[212:215], v228 offset:2304
  v_cvt_pk_bf16_f32 v203, v206, v207
  v_mfma_f32_16x16x32_bf16 v[176:179], a[192:195], a[4:7], v[220:223]
  s_mov_b32 s29, 478208
  v_cvt_pk_bf16_f32 v210, v212, v213
  v_add_f32 v236, v214, v236
  v_mfma_f32_16x16x32_bf16 v[184:187], a[192:195], a[8:11], v[224:227]
  s_waitcnt lgkmcnt(4)
  v_add_f32 v236, v215, v236
  v_mfma_f32_16x16x32_bf16 v[168:171], a[196:199], a[12:15], v[168:171]
  ds_read_b128 a[216:219], v228 offset:3072
  v_cvt_pk_bf16_f32 v211, v214, v215
  v_mfma_f32_16x16x32_bf16 v[176:179], a[196:199], a[16:19], v[176:179]
  v_mfma_f32_16x16x32_bf16 v[184:187], a[196:199], a[20:23], v[184:187]
  s_waitcnt lgkmcnt(4)
  v_mfma_f32_16x16x32_bf16 v[168:171], a[200:203], a[24:27], v[168:171]
  ds_read_b128 a[220:223], v228 offset:3328
  v_mfma_f32_16x16x32_bf16 v[176:179], a[200:203], a[28:31], v[176:179]
  buffer_load_dwordx4 v231, s[8:11], s29 offen offset:0 nt lds
  v_mfma_f32_16x16x32_bf16 v[184:187], a[200:203], a[32:35], v[184:187]
  s_waitcnt lgkmcnt(4)
  v_mfma_f32_16x16x32_bf16 v[168:171], a[204:207], a[36:39], v[168:171]
  s_add_u32 s29, s29, s30
  ds_read_b128 a[192:195], v228 offset:8192
  v_mfma_f32_16x16x32_bf16 v[176:179], a[204:207], a[40:43], v[176:179]
  v_mfma_f32_16x16x32_bf16 v[184:187], a[204:207], a[44:47], v[184:187]
  s_waitcnt lgkmcnt(4)
  v_mfma_f32_16x16x32_bf16 v[168:171], a[208:211], a[48:51], v[168:171]
  ds_read_b128 a[196:199], v228 offset:8448
  v_mfma_f32_16x16x32_bf16 v[176:179], a[208:211], a[52:55], v[176:179]
  buffer_load_dwordx4 v231, s[8:11], s29 offen offset:1024 nt lds
  v_mfma_f32_16x16x32_bf16 v[184:187], a[208:211], a[56:59], v[184:187]
  s_waitcnt lgkmcnt(4)
  v_mfma_f32_16x16x32_bf16 v[168:171], a[212:215], a[60:63], v[168:171]
  s_add_u32 s29, s29, s30
  ds_read_b128 a[200:203], v228 offset:9216
  v_mfma_f32_16x16x32_bf16 v[176:179], a[212:215], a[64:67], v[176:179]
  v_mfma_f32_16x16x32_bf16 v[184:187], a[212:215], a[68:71], v[184:187]
  s_waitcnt lgkmcnt(4)
  v_mfma_f32_16x16x32_bf16 v[168:171], a[216:219], a[72:75], v[168:171]
  ds_read_b128 a[204:207], v228 offset:9472
  v_mfma_f32_16x16x32_bf16 v[176:179], a[216:219], a[76:79], v[176:179]
  buffer_load_dwordx4 v231, s[8:11], s29 offen offset:2048 nt lds
  v_mfma_f32_16x16x32_bf16 v[184:187], a[216:219], a[80:83], v[184:187]
  s_waitcnt lgkmcnt(4)
  v_mfma_f32_16x16x32_bf16 v[168:171], a[220:223], a[84:87], v[168:171]
  s_add_u32 s29, s29, s30
  ds_read_b128 a[208:211], v228 offset:10240
  v_mfma_f32_16x16x32_bf16 v[176:179], a[220:223], a[88:91], v[176:179]
  v_mfma_f32_16x16x32_bf16 v[184:187], a[220:223], a[92:95], v[184:187]
  s_waitcnt lgkmcnt(4)
  v_mfma_f32_16x16x32_bf16 v[172:175], a[192:195], a[0:3], v[216:219]
  ds_read_b128 a[212:215], v228 offset:10496
  v_mfma_f32_16x16x32_bf16 v[180:183], a[192:195], a[4:7], v[220:223]
  buffer_load_dwordx4 v231, s[8:11], s29 offen offset:3072 nt lds
  v_mfma_f32_16x16x32_bf16 v[188:191], a[192:195], a[8:11], v[224:227]
  s_waitcnt lgkmcnt(4)
  v_exp_f32 v168, v168
  v_mfma_f32_16x16x32_bf16 v[172:175], a[196:199], a[12:15], v[172:175]
  s_waitcnt vmcnt(4)
  ds_read_b128 a[216:219], v228 offset:11264
  v_add_f32 v234, v168, v234
  v_mfma_f32_16x16x32_bf16 v[180:183], a[196:199], a[16:19], v[180:183]
  s_barrier
  v_exp_f32 v169, v169
  v_mfma_f32_16x16x32_bf16 v[188:191], a[196:199], a[20:23], v[188:191]
  s_waitcnt lgkmcnt(4)
  v_exp_f32 v170, v170
  v_mfma_f32_16x16x32_bf16 v[172:175], a[200:203], a[24:27], v[172:175]
  ds_read_b128 a[220:223], v228 offset:11520
  v_add_u32 v228, 114688, v230
  v_mfma_f32_16x16x32_bf16 v[180:183], a[200:203], a[28:31], v[180:183]
  v_xor_b32 v239, 32, v228
  v_mfma_f32_16x16x32_bf16 v[188:191], a[200:203], a[32:35], v[188:191]
  s_waitcnt lgkmcnt(4)
  v_exp_f32 v171, v171
  v_mfma_f32_16x16x32_bf16 v[172:175], a[204:207], a[36:39], v[172:175]
  ds_read_b64_tr_b16 a[192:193], v228 offset:0
  v_add_f32 v234, v169, v234
  v_mfma_f32_16x16x32_bf16 v[180:183], a[204:207], a[40:43], v[180:183]
  ds_read_b64_tr_b16 a[194:195], v228 offset:8192
  v_cvt_pk_bf16_f32 v168, v168, v169
  v_mfma_f32_16x16x32_bf16 v[188:191], a[204:207], a[44:47], v[188:191]
  s_waitcnt lgkmcnt(5)
  v_exp_f32 v176, v176
  v_mfma_f32_16x16x32_bf16 v[172:175], a[208:211], a[48:51], v[172:175]
  ds_read_b64_tr_b16 a[196:197], v239 offset:0
  v_add_f32 v234, v170, v234
  v_mfma_f32_16x16x32_bf16 v[180:183], a[208:211], a[52:55], v[180:183]
  ds_read_b64_tr_b16 a[198:199], v239 offset:8192
  v_add_f32 v234, v171, v234
  v_mfma_f32_16x16x32_bf16 v[188:191], a[208:211], a[56:59], v[188:191]
  s_waitcnt lgkmcnt(6)
  v_exp_f32 v177, v177
  v_mfma_f32_16x16x32_bf16 v[172:175], a[212:215], a[60:63], v[172:175]
  ds_read_b64_tr_b16 a[200:201], v228 offset:256
  v_cvt_pk_bf16_f32 v169, v170, v171
  v_mfma_f32_16x16x32_bf16 v[180:183], a[212:215], a[64:67], v[180:183]
  ds_read_b64_tr_b16 a[202:203], v228 offset:8448
  v_add_f32 v235, v176, v235
  v_mfma_f32_16x16x32_bf16 v[188:191], a[212:215], a[68:71], v[188:191]
  s_waitcnt lgkmcnt(7)
  v_exp_f32 v178, v178
  v_mfma_f32_16x16x32_bf16 v[172:175], a[216:219], a[72:75], v[172:175]
  ds_read_b64_tr_b16 a[204:205], v239 offset:256
  v_add_f32 v235, v177, v235
  v_mfma_f32_16x16x32_bf16 v[180:183], a[216:219], a[76:79], v[180:183]
  ds_read_b64_tr_b16 a[206:207], v239 offset:8448
  v_cvt_pk_bf16_f32 v176, v176, v177
  v_mfma_f32_16x16x32_bf16 v[188:191], a[216:219], a[80:83], v[188:191]
  s_waitcnt lgkmcnt(8)
  v_exp_f32 v179, v179
  v_mfma_f32_16x16x32_bf16 v[172:175], a[220:223], a[84:87], v[172:175]
  ds_read_b64_tr_b16 a[208:209], v228 offset:1024
  v_add_f32 v235, v178, v235
  v_mfma_f32_16x16x32_bf16 v[180:183], a[220:223], a[88:91], v[180:183]
  ds_read_b64_tr_b16 a[210:211], v228 offset:9216
  v_add_f32 v235, v179, v235
  v_mfma_f32_16x16x32_bf16 v[188:191], a[220:223], a[92:95], v[188:191]
  s_waitcnt lgkmcnt(8)
  v_exp_f32 v184, v184
  v_mfma_f32_16x16x32_bf16 v[0:3], a[192:195], v[192:195], v[0:3]
  s_add_u32 m0, s28, 0
  ds_read_b64_tr_b16 a[212:213], v239 offset:1024
  v_cvt_pk_bf16_f32 v177, v178, v179
  v_mfma_f32_16x16x32_bf16 v[4:7], a[192:195], v[200:203], v[4:7]
  s_mov_b32 s29, 461824
  ds_read_b64_tr_b16 a[214:215], v239 offset:9216
  v_add_f32 v236, v184, v236
  v_mfma_f32_16x16x32_bf16 v[8:11], a[192:195], v[208:211], v[8:11]
  s_waitcnt lgkmcnt(8)
  v_exp_f32 v185, v185
  v_mfma_f32_16x16x32_bf16 v[12:15], a[196:199], v[192:195], v[12:15]
  ds_read_b64_tr_b16 a[216:217], v228 offset:1280
  v_add_f32 v236, v185, v236
  v_mfma_f32_16x16x32_bf16 v[16:19], a[196:199], v[200:203], v[16:19]
  ds_read_b64_tr_b16 a[218:219], v228 offset:9472
  v_cvt_pk_bf16_f32 v184, v184, v185
  v_mfma_f32_16x16x32_bf16 v[20:23], a[196:199], v[208:211], v[20:23]
  s_waitcnt lgkmcnt(8)
  v_exp_f32 v186, v186
  v_mfma_f32_16x16x32_bf16 v[24:27], a[200:203], v[192:195], v[24:27]
  ds_read_b64_tr_b16 a[220:221], v239 offset:1280
  v_add_f32 v236, v186, v236
  v_mfma_f32_16x16x32_bf16 v[28:31], a[200:203], v[200:203], v[28:31]
  buffer_load_dwordx4 v231, s[12:15], s29 offen offset:0 nt lds
  v_mfma_f32_16x16x32_bf16 v[32:35], a[200:203], v[208:211], v[32:35]
  s_waitcnt lgkmcnt(7)
  ds_read_b64_tr_b16 a[222:223], v239 offset:9472
  v_mfma_f32_16x16x32_bf16 v[36:39], a[204:207], v[192:195], v[36:39]
  s_add_u32 s29, s29, s30
  ds_read_b64_tr_b16 a[192:193], v228 offset:2048
  v_mfma_f32_16x16x32_bf16 v[40:43], a[204:207], v[200:203], v[40:43]
  ds_read_b64_tr_b16 a[194:195], v228 offset:10240
  v_mfma_f32_16x16x32_bf16 v[44:47], a[204:207], v[208:211], v[44:47]
  s_waitcnt lgkmcnt(8)
  v_exp_f32 v187, v187
  v_mfma_f32_16x16x32_bf16 v[48:51], a[208:211], v[192:195], v[48:51]
  ds_read_b64_tr_b16 a[196:197], v239 offset:2048
  v_add_f32 v236, v187, v236
  v_mfma_f32_16x16x32_bf16 v[52:55], a[208:211], v[200:203], v[52:55]
  buffer_load_dwordx4 v231, s[12:15], s29 offen offset:1024 nt lds
  v_mfma_f32_16x16x32_bf16 v[56:59], a[208:211], v[208:211], v[56:59]
  s_waitcnt lgkmcnt(7)
  ds_read_b64_tr_b16 a[198:199], v239 offset:10240
  v_cvt_pk_bf16_f32 v185, v186, v187
  v_mfma_f32_16x16x32_bf16 v[60:63], a[212:215], v[192:195], v[60:63]
  s_add_u32 s29, s29, s30
  ds_read_b64_tr_b16 a[200:201], v228 offset:2304
  v_mfma_f32_16x16x32_bf16 v[64:67], a[212:215], v[200:203], v[64:67]
  ds_read_b64_tr_b16 a[202:203], v228 offset:10496
  v_mfma_f32_16x16x32_bf16 v[68:71], a[212:215], v[208:211], v[68:71]
  s_waitcnt lgkmcnt(8)
  v_exp_f32 v172, v172
  v_mfma_f32_16x16x32_bf16 v[72:75], a[216:219], v[192:195], v[72:75]
  ds_read_b64_tr_b16 a[204:205], v239 offset:2304
  v_add_f32 v234, v172, v234
  v_mfma_f32_16x16x32_bf16 v[76:79], a[216:219], v[200:203], v[76:79]
  buffer_load_dwordx4 v231, s[12:15], s29 offen offset:2048 nt lds
  v_mfma_f32_16x16x32_bf16 v[80:83], a[216:219], v[208:211], v[80:83]
  s_waitcnt lgkmcnt(7)
  ds_read_b64_tr_b16 a[206:207], v239 offset:10496
  v_mfma_f32_16x16x32_bf16 v[84:87], a[220:223], v[192:195], v[84:87]
  s_add_u32 s29, s29, s30
  ds_read_b64_tr_b16 a[208:209], v228 offset:3072
  v_mfma_f32_16x16x32_bf16 v[88:91], a[220:223], v[200:203], v[88:91]
  ds_read_b64_tr_b16 a[210:211], v228 offset:11264
  v_mfma_f32_16x16x32_bf16 v[92:95], a[220:223], v[208:211], v[92:95]
  s_waitcnt lgkmcnt(8)
  v_exp_f32 v173, v173
  v_mfma_f32_16x16x32_bf16 v[96:99], a[192:195], v[192:195], v[96:99]
  ds_read_b64_tr_b16 a[212:213], v239 offset:3072
  v_add_f32 v234, v173, v234
  v_mfma_f32_16x16x32_bf16 v[100:103], a[192:195], v[200:203], v[100:103]
  buffer_load_dwordx4 v231, s[12:15], s29 offen offset:3072 nt lds
  v_mfma_f32_16x16x32_bf16 v[104:107], a[192:195], v[208:211], v[104:107]
  s_waitcnt lgkmcnt(7)
  ds_read_b64_tr_b16 a[214:215], v239 offset:11264
  v_cvt_pk_bf16_f32 v170, v172, v173
  v_mfma_f32_16x16x32_bf16 v[108:111], a[196:199], v[192:195], v[108:111]
  s_waitcnt vmcnt(4)
  ds_read_b64_tr_b16 a[216:217], v228 offset:3328
  v_mfma_f32_16x16x32_bf16 v[112:115], a[196:199], v[200:203], v[112:115]
  s_barrier
  ds_read_b64_tr_b16 a[218:219], v228 offset:11520
  v_mfma_f32_16x16x32_bf16 v[116:119], a[196:199], v[208:211], v[116:119]
  s_waitcnt lgkmcnt(8)
  v_exp_f32 v174, v174
  v_mfma_f32_16x16x32_bf16 v[120:123], a[200:203], v[192:195], v[120:123]
  ds_read_b64_tr_b16 a[220:221], v239 offset:3328
  v_add_f32 v234, v174, v234
  v_mfma_f32_16x16x32_bf16 v[124:127], a[200:203], v[200:203], v[124:127]
  ds_read_b64_tr_b16 a[222:223], v239 offset:11520
  v_add_u32 v228, 81920, v229
  v_mfma_f32_16x16x32_bf16 v[128:131], a[200:203], v[208:211], v[128:131]
  s_waitcnt lgkmcnt(8)
  v_exp_f32 v175, v175
  v_mfma_f32_16x16x32_bf16 v[132:135], a[204:207], v[192:195], v[132:135]
  ds_read_b128 a[192:195], v228 offset:0
  v_add_f32 v234, v175, v234
  v_mfma_f32_16x16x32_bf16 v[136:139], a[204:207], v[200:203], v[136:139]
  v_exp_f32 v180, v180
  v_mfma_f32_16x16x32_bf16 v[140:143], a[204:207], v[208:211], v[140:143]
  s_waitcnt lgkmcnt(7)
  v_exp_f32 v181, v181
  v_mfma_f32_16x16x32_bf16 v[144:147], a[208:211], v[192:195], v[144:147]
  ds_read_b128 a[196:199], v228 offset:256
  v_cvt_pk_bf16_f32 v171, v174, v175
  v_mfma_f32_16x16x32_bf16 v[148:151], a[208:211], v[200:203], v[148:151]
  v_exp_f32 v182, v182
  v_mfma_f32_16x16x32_bf16 v[152:155], a[208:211], v[208:211], v[152:155]
  s_waitcnt lgkmcnt(6)
  v_exp_f32 v183, v183
  v_mfma_f32_16x16x32_bf16 v[156:159], a[212:215], v[192:195], v[156:159]
  ds_read_b128 a[200:203], v228 offset:1024
  v_add_f32 v235, v180, v235
  v_mfma_f32_16x16x32_bf16 v[160:163], a[212:215], v[200:203], v[160:163]
  v_exp_f32 v188, v188
  v_mfma_f32_16x16x32_bf16 v[164:167], a[212:215], v[208:211], v[164:167]
  s_waitcnt lgkmcnt(5)
  v_exp_f32 v189, v189
  v_mfma_f32_16x16x32_bf16 a[224:227], a[216:219], v[192:195], a[224:227]
  ds_read_b128 a[204:207], v228 offset:1280
  v_add_f32 v235, v181, v235
  v_mfma_f32_16x16x32_bf16 a[228:231], a[216:219], v[200:203], a[228:231]
  v_exp_f32 v190, v190
  v_mfma_f32_16x16x32_bf16 a[232:235], a[216:219], v[208:211], a[232:235]
  s_waitcnt lgkmcnt(4)
  v_exp_f32 v191, v191
  v_mfma_f32_16x16x32_bf16 a[236:239], a[220:223], v[192:195], a[236:239]
  ds_read_b128 a[208:211], v228 offset:2048
  v_cvt_pk_bf16_f32 v178, v180, v181
  v_mfma_f32_16x16x32_bf16 a[240:243], a[220:223], v[200:203], a[240:243]
  v_add_f32 v235, v182, v235
  v_add_f32 v236, v188, v236
  v_mfma_f32_16x16x32_bf16 a[244:247], a[220:223], v[208:211], a[244:247]
  s_waitcnt lgkmcnt(4)
  v_add_f32 v235, v183, v235
  v_add_f32 v236, v189, v236
  v_mfma_f32_16x16x32_bf16 v[192:195], a[192:195], a[0:3], v[216:219]
  s_add_u32 m0, s28, 98304
  ds_read_b128 a[212:215], v228 offset:2304
  v_cvt_pk_bf16_f32 v179, v182, v183
  v_mfma_f32_16x16x32_bf16 v[200:203], a[192:195], a[4:7], v[220:223]
  s_mov_b32 s29, 494592
  v_cvt_pk_bf16_f32 v186, v188, v189
  v_add_f32 v236, v190, v236
  v_mfma_f32_16x16x32_bf16 v[208:211], a[192:195], a[8:11], v[224:227]
  s_waitcnt lgkmcnt(4)
  v_add_f32 v236, v191, v236
  v_mfma_f32_16x16x32_bf16 v[192:195], a[196:199], a[12:15], v[192:195]
  ds_read_b128 a[216:219], v228 offset:3072
  v_cvt_pk_bf16_f32 v187, v190, v191
  v_mfma_f32_16x16x32_bf16 v[200:203], a[196:199], a[16:19], v[200:203]
  v_mfma_f32_16x16x32_bf16 v[208:211], a[196:199], a[20:23], v[208:211]
  s_waitcnt lgkmcnt(4)
  v_mfma_f32_16x16x32_bf16 v[192:195], a[200:203], a[24:27], v[192:195]
  ds_read_b128 a[220:223], v228 offset:3328
  v_mfma_f32_16x16x32_bf16 v[200:203], a[200:203], a[28:31], v[200:203]
  buffer_load_dwordx4 v231, s[8:11], s29 offen offset:0 nt lds
  v_mfma_f32_16x16x32_bf16 v[208:211], a[200:203], a[32:35], v[208:211]
  s_waitcnt lgkmcnt(4)
  v_mfma_f32_16x16x32_bf16 v[192:195], a[204:207], a[36:39], v[192:195]
  s_add_u32 s29, s29, s30
  ds_read_b128 a[192:195], v228 offset:8192
  v_mfma_f32_16x16x32_bf16 v[200:203], a[204:207], a[40:43], v[200:203]
  v_mfma_f32_16x16x32_bf16 v[208:211], a[204:207], a[44:47], v[208:211]
  s_waitcnt lgkmcnt(4)
  v_mfma_f32_16x16x32_bf16 v[192:195], a[208:211], a[48:51], v[192:195]
  ds_read_b128 a[196:199], v228 offset:8448
  v_mfma_f32_16x16x32_bf16 v[200:203], a[208:211], a[52:55], v[200:203]
  buffer_load_dwordx4 v231, s[8:11], s29 offen offset:1024 nt lds
  v_mfma_f32_16x16x32_bf16 v[208:211], a[208:211], a[56:59], v[208:211]
  s_waitcnt lgkmcnt(4)
  v_mfma_f32_16x16x32_bf16 v[192:195], a[212:215], a[60:63], v[192:195]
  s_add_u32 s29, s29, s30
  ds_read_b128 a[200:203], v228 offset:9216
  v_mfma_f32_16x16x32_bf16 v[200:203], a[212:215], a[64:67], v[200:203]
  v_mfma_f32_16x16x32_bf16 v[208:211], a[212:215], a[68:71], v[208:211]
  s_waitcnt lgkmcnt(4)
  v_mfma_f32_16x16x32_bf16 v[192:195], a[216:219], a[72:75], v[192:195]
  ds_read_b128 a[204:207], v228 offset:9472
  v_mfma_f32_16x16x32_bf16 v[200:203], a[216:219], a[76:79], v[200:203]
  buffer_load_dwordx4 v231, s[8:11], s29 offen offset:2048 nt lds
  v_mfma_f32_16x16x32_bf16 v[208:211], a[216:219], a[80:83], v[208:211]
  s_waitcnt lgkmcnt(4)
  v_mfma_f32_16x16x32_bf16 v[192:195], a[220:223], a[84:87], v[192:195]
  s_add_u32 s29, s29, s30
  ds_read_b128 a[208:211], v228 offset:10240
  v_mfma_f32_16x16x32_bf16 v[200:203], a[220:223], a[88:91], v[200:203]
  v_mfma_f32_16x16x32_bf16 v[208:211], a[220:223], a[92:95], v[208:211]
  s_waitcnt lgkmcnt(4)
  v_mfma_f32_16x16x32_bf16 v[196:199], a[192:195], a[0:3], v[216:219]
  ds_read_b128 a[212:215], v228 offset:10496
  v_mfma_f32_16x16x32_bf16 v[204:207], a[192:195], a[4:7], v[220:223]
  buffer_load_dwordx4 v231, s[8:11], s29 offen offset:3072 nt lds
  v_mfma_f32_16x16x32_bf16 v[212:215], a[192:195], a[8:11], v[224:227]
  s_waitcnt lgkmcnt(4)
  v_exp_f32 v192, v192
  v_mfma_f32_16x16x32_bf16 v[196:199], a[196:199], a[12:15], v[196:199]
  s_waitcnt vmcnt(4)
  ds_read_b128 a[216:219], v228 offset:11264
  v_add_f32 v234, v192, v234
  v_mfma_f32_16x16x32_bf16 v[204:207], a[196:199], a[16:19], v[204:207]
  s_barrier
  v_exp_f32 v193, v193
  v_mfma_f32_16x16x32_bf16 v[212:215], a[196:199], a[20:23], v[212:215]
  s_waitcnt lgkmcnt(4)
  v_exp_f32 v194, v194
  v_mfma_f32_16x16x32_bf16 v[196:199], a[200:203], a[24:27], v[196:199]
  ds_read_b128 a[220:223], v228 offset:11520
  v_add_u32 v228, 0, v230
  v_mfma_f32_16x16x32_bf16 v[204:207], a[200:203], a[28:31], v[204:207]
  v_xor_b32 v239, 32, v228
  v_mfma_f32_16x16x32_bf16 v[212:215], a[200:203], a[32:35], v[212:215]
  s_waitcnt lgkmcnt(4)
  v_exp_f32 v195, v195
  v_mfma_f32_16x16x32_bf16 v[196:199], a[204:207], a[36:39], v[196:199]
  ds_read_b64_tr_b16 a[192:193], v228 offset:0
  v_add_f32 v234, v193, v234
  v_mfma_f32_16x16x32_bf16 v[204:207], a[204:207], a[40:43], v[204:207]
  ds_read_b64_tr_b16 a[194:195], v228 offset:8192
  v_cvt_pk_bf16_f32 v192, v192, v193
  v_mfma_f32_16x16x32_bf16 v[212:215], a[204:207], a[44:47], v[212:215]
  s_waitcnt lgkmcnt(5)
  v_exp_f32 v200, v200
  v_mfma_f32_16x16x32_bf16 v[196:199], a[208:211], a[48:51], v[196:199]
  ds_read_b64_tr_b16 a[196:197], v239 offset:0
  v_add_f32 v234, v194, v234
  v_mfma_f32_16x16x32_bf16 v[204:207], a[208:211], a[52:55], v[204:207]
  ds_read_b64_tr_b16 a[198:199], v239 offset:8192
  v_add_f32 v234, v195, v234
  v_mfma_f32_16x16x32_bf16 v[212:215], a[208:211], a[56:59], v[212:215]
  s_waitcnt lgkmcnt(6)
  v_exp_f32 v201, v201
  v_mfma_f32_16x16x32_bf16 v[196:199], a[212:215], a[60:63], v[196:199]
  ds_read_b64_tr_b16 a[200:201], v228 offset:256
  v_cvt_pk_bf16_f32 v193, v194, v195
  v_mfma_f32_16x16x32_bf16 v[204:207], a[212:215], a[64:67], v[204:207]
  ds_read_b64_tr_b16 a[202:203], v228 offset:8448
  v_add_f32 v235, v200, v235
  v_mfma_f32_16x16x32_bf16 v[212:215], a[212:215], a[68:71], v[212:215]
  s_waitcnt lgkmcnt(7)
  v_exp_f32 v202, v202
  v_mfma_f32_16x16x32_bf16 v[196:199], a[216:219], a[72:75], v[196:199]
  ds_read_b64_tr_b16 a[204:205], v239 offset:256
  v_add_f32 v235, v201, v235
  v_mfma_f32_16x16x32_bf16 v[204:207], a[216:219], a[76:79], v[204:207]
  ds_read_b64_tr_b16 a[206:207], v239 offset:8448
  v_cvt_pk_bf16_f32 v200, v200, v201
  v_mfma_f32_16x16x32_bf16 v[212:215], a[216:219], a[80:83], v[212:215]
  s_waitcnt lgkmcnt(8)
  v_exp_f32 v203, v203
  v_mfma_f32_16x16x32_bf16 v[196:199], a[220:223], a[84:87], v[196:199]
  ds_read_b64_tr_b16 a[208:209], v228 offset:1024
  v_add_f32 v235, v202, v235
  v_mfma_f32_16x16x32_bf16 v[204:207], a[220:223], a[88:91], v[204:207]
  ds_read_b64_tr_b16 a[210:211], v228 offset:9216
  v_add_f32 v235, v203, v235
  v_mfma_f32_16x16x32_bf16 v[212:215], a[220:223], a[92:95], v[212:215]
  s_waitcnt lgkmcnt(8)
  v_exp_f32 v208, v208
  v_mfma_f32_16x16x32_bf16 v[0:3], a[192:195], v[168:171], v[0:3]
  s_add_u32 m0, s28, 16384
  ds_read_b64_tr_b16 a[212:213], v239 offset:1024
  v_cvt_pk_bf16_f32 v201, v202, v203
  v_mfma_f32_16x16x32_bf16 v[4:7], a[192:195], v[176:179], v[4:7]
  s_mov_b32 s29, 478208
  ds_read_b64_tr_b16 a[214:215], v239 offset:9216
  v_add_f32 v236, v208, v236
  v_mfma_f32_16x16x32_bf16 v[8:11], a[192:195], v[184:187], v[8:11]
  s_waitcnt lgkmcnt(8)
  v_exp_f32 v209, v209
  v_mfma_f32_16x16x32_bf16 v[12:15], a[196:199], v[168:171], v[12:15]
  ds_read_b64_tr_b16 a[216:217], v228 offset:1280
  v_add_f32 v236, v209, v236
  v_mfma_f32_16x16x32_bf16 v[16:19], a[196:199], v[176:179], v[16:19]
  ds_read_b64_tr_b16 a[218:219], v228 offset:9472
  v_cvt_pk_bf16_f32 v208, v208, v209
  v_mfma_f32_16x16x32_bf16 v[20:23], a[196:199], v[184:187], v[20:23]
  s_waitcnt lgkmcnt(8)
  v_exp_f32 v210, v210
  v_mfma_f32_16x16x32_bf16 v[24:27], a[200:203], v[168:171], v[24:27]
  ds_read_b64_tr_b16 a[220:221], v239 offset:1280
  v_add_f32 v236, v210, v236
  v_mfma_f32_16x16x32_bf16 v[28:31], a[200:203], v[176:179], v[28:31]
  buffer_load_dwordx4 v231, s[12:15], s29 offen offset:0 nt lds
  v_mfma_f32_16x16x32_bf16 v[32:35], a[200:203], v[184:187], v[32:35]
  s_waitcnt lgkmcnt(7)
  ds_read_b64_tr_b16 a[222:223], v239 offset:9472
  v_mfma_f32_16x16x32_bf16 v[36:39], a[204:207], v[168:171], v[36:39]
  s_add_u32 s29, s29, s30
  ds_read_b64_tr_b16 a[192:193], v228 offset:2048
  v_mfma_f32_16x16x32_bf16 v[40:43], a[204:207], v[176:179], v[40:43]
  ds_read_b64_tr_b16 a[194:195], v228 offset:10240
  v_mfma_f32_16x16x32_bf16 v[44:47], a[204:207], v[184:187], v[44:47]
  s_waitcnt lgkmcnt(8)
  v_exp_f32 v211, v211
  v_mfma_f32_16x16x32_bf16 v[48:51], a[208:211], v[168:171], v[48:51]
  ds_read_b64_tr_b16 a[196:197], v239 offset:2048
  v_add_f32 v236, v211, v236
  v_mfma_f32_16x16x32_bf16 v[52:55], a[208:211], v[176:179], v[52:55]
  buffer_load_dwordx4 v231, s[12:15], s29 offen offset:1024 nt lds
  v_mfma_f32_16x16x32_bf16 v[56:59], a[208:211], v[184:187], v[56:59]
  s_waitcnt lgkmcnt(7)
  ds_read_b64_tr_b16 a[198:199], v239 offset:10240
  v_cvt_pk_bf16_f32 v209, v210, v211
  v_mfma_f32_16x16x32_bf16 v[60:63], a[212:215], v[168:171], v[60:63]
  s_add_u32 s29, s29, s30
  ds_read_b64_tr_b16 a[200:201], v228 offset:2304
  v_mfma_f32_16x16x32_bf16 v[64:67], a[212:215], v[176:179], v[64:67]
  ds_read_b64_tr_b16 a[202:203], v228 offset:10496
  v_mfma_f32_16x16x32_bf16 v[68:71], a[212:215], v[184:187], v[68:71]
  s_waitcnt lgkmcnt(8)
  v_exp_f32 v196, v196
  v_mfma_f32_16x16x32_bf16 v[72:75], a[216:219], v[168:171], v[72:75]
  ds_read_b64_tr_b16 a[204:205], v239 offset:2304
  v_add_f32 v234, v196, v234
  v_mfma_f32_16x16x32_bf16 v[76:79], a[216:219], v[176:179], v[76:79]
  buffer_load_dwordx4 v231, s[12:15], s29 offen offset:2048 nt lds
  v_mfma_f32_16x16x32_bf16 v[80:83], a[216:219], v[184:187], v[80:83]
  s_waitcnt lgkmcnt(7)
  ds_read_b64_tr_b16 a[206:207], v239 offset:10496
  v_mfma_f32_16x16x32_bf16 v[84:87], a[220:223], v[168:171], v[84:87]
  s_add_u32 s29, s29, s30
  ds_read_b64_tr_b16 a[208:209], v228 offset:3072
  v_mfma_f32_16x16x32_bf16 v[88:91], a[220:223], v[176:179], v[88:91]
  ds_read_b64_tr_b16 a[210:211], v228 offset:11264
  v_mfma_f32_16x16x32_bf16 v[92:95], a[220:223], v[184:187], v[92:95]
  s_waitcnt lgkmcnt(8)
  v_exp_f32 v197, v197
  v_mfma_f32_16x16x32_bf16 v[96:99], a[192:195], v[168:171], v[96:99]
  ds_read_b64_tr_b16 a[212:213], v239 offset:3072
  v_add_f32 v234, v197, v234
  v_mfma_f32_16x16x32_bf16 v[100:103], a[192:195], v[176:179], v[100:103]
  buffer_load_dwordx4 v231, s[12:15], s29 offen offset:3072 nt lds
  v_mfma_f32_16x16x32_bf16 v[104:107], a[192:195], v[184:187], v[104:107]
  s_waitcnt lgkmcnt(7)
  ds_read_b64_tr_b16 a[214:215], v239 offset:11264
  v_cvt_pk_bf16_f32 v194, v196, v197
  v_mfma_f32_16x16x32_bf16 v[108:111], a[196:199], v[168:171], v[108:111]
  s_waitcnt vmcnt(4)
  ds_read_b64_tr_b16 a[216:217], v228 offset:3328
  v_mfma_f32_16x16x32_bf16 v[112:115], a[196:199], v[176:179], v[112:115]
  s_barrier
  ds_read_b64_tr_b16 a[218:219], v228 offset:11520
  v_mfma_f32_16x16x32_bf16 v[116:119], a[196:199], v[184:187], v[116:119]
  s_waitcnt lgkmcnt(8)
  v_exp_f32 v198, v198
  v_mfma_f32_16x16x32_bf16 v[120:123], a[200:203], v[168:171], v[120:123]
  ds_read_b64_tr_b16 a[220:221], v239 offset:3328
  v_add_f32 v234, v198, v234
  v_mfma_f32_16x16x32_bf16 v[124:127], a[200:203], v[176:179], v[124:127]
  ds_read_b64_tr_b16 a[222:223], v239 offset:11520
  v_add_u32 v228, 98304, v229
  v_mfma_f32_16x16x32_bf16 v[128:131], a[200:203], v[184:187], v[128:131]
  s_waitcnt lgkmcnt(8)
  v_exp_f32 v199, v199
  v_mfma_f32_16x16x32_bf16 v[132:135], a[204:207], v[168:171], v[132:135]
  ds_read_b128 a[192:195], v228 offset:0
  v_add_f32 v234, v199, v234
  v_mfma_f32_16x16x32_bf16 v[136:139], a[204:207], v[176:179], v[136:139]
  v_exp_f32 v204, v204
  v_mfma_f32_16x16x32_bf16 v[140:143], a[204:207], v[184:187], v[140:143]
  s_waitcnt lgkmcnt(7)
  v_exp_f32 v205, v205
  v_mfma_f32_16x16x32_bf16 v[144:147], a[208:211], v[168:171], v[144:147]
  ds_read_b128 a[196:199], v228 offset:256
  v_cvt_pk_bf16_f32 v195, v198, v199
  v_mfma_f32_16x16x32_bf16 v[148:151], a[208:211], v[176:179], v[148:151]
  v_exp_f32 v206, v206
  v_mfma_f32_16x16x32_bf16 v[152:155], a[208:211], v[184:187], v[152:155]
  s_waitcnt lgkmcnt(6)
  v_exp_f32 v207, v207
  v_mfma_f32_16x16x32_bf16 v[156:159], a[212:215], v[168:171], v[156:159]
  ds_read_b128 a[200:203], v228 offset:1024
  v_add_f32 v235, v204, v235
  v_mfma_f32_16x16x32_bf16 v[160:163], a[212:215], v[176:179], v[160:163]
  v_exp_f32 v212, v212
  v_mfma_f32_16x16x32_bf16 v[164:167], a[212:215], v[184:187], v[164:167]
  s_waitcnt lgkmcnt(5)
  v_exp_f32 v213, v213
  v_mfma_f32_16x16x32_bf16 a[224:227], a[216:219], v[168:171], a[224:227]
  ds_read_b128 a[204:207], v228 offset:1280
  v_add_f32 v235, v205, v235
  v_mfma_f32_16x16x32_bf16 a[228:231], a[216:219], v[176:179], a[228:231]
  v_exp_f32 v214, v214
  v_mfma_f32_16x16x32_bf16 a[232:235], a[216:219], v[184:187], a[232:235]
  s_waitcnt lgkmcnt(4)
  v_exp_f32 v215, v215
  v_mfma_f32_16x16x32_bf16 a[236:239], a[220:223], v[168:171], a[236:239]
  ds_read_b128 a[208:211], v228 offset:2048
  v_cvt_pk_bf16_f32 v202, v204, v205
  v_mfma_f32_16x16x32_bf16 a[240:243], a[220:223], v[176:179], a[240:243]
  v_add_f32 v235, v206, v235
  v_add_f32 v236, v212, v236
  v_mfma_f32_16x16x32_bf16 a[244:247], a[220:223], v[184:187], a[244:247]
  s_waitcnt lgkmcnt(4)
  v_add_f32 v235, v207, v235
  v_add_f32 v236, v213, v236
  v_mfma_f32_16x16x32_bf16 v[168:171], a[192:195], a[0:3], v[216:219]
  s_add_u32 m0, s28, 114688
  ds_read_b128 a[212:215], v228 offset:2304
  v_cvt_pk_bf16_f32 v203, v206, v207
  v_mfma_f32_16x16x32_bf16 v[176:179], a[192:195], a[4:7], v[220:223]
  s_mov_b32 s29, 510976
  v_cvt_pk_bf16_f32 v210, v212, v213
  v_add_f32 v236, v214, v236
  v_mfma_f32_16x16x32_bf16 v[184:187], a[192:195], a[8:11], v[224:227]
  s_waitcnt lgkmcnt(4)
  v_add_f32 v236, v215, v236
  v_mfma_f32_16x16x32_bf16 v[168:171], a[196:199], a[12:15], v[168:171]
  ds_read_b128 a[216:219], v228 offset:3072
  v_cvt_pk_bf16_f32 v211, v214, v215
  v_mfma_f32_16x16x32_bf16 v[176:179], a[196:199], a[16:19], v[176:179]
  v_mfma_f32_16x16x32_bf16 v[184:187], a[196:199], a[20:23], v[184:187]
  s_waitcnt lgkmcnt(4)
  v_mfma_f32_16x16x32_bf16 v[168:171], a[200:203], a[24:27], v[168:171]
  ds_read_b128 a[220:223], v228 offset:3328
  v_mfma_f32_16x16x32_bf16 v[176:179], a[200:203], a[28:31], v[176:179]
  buffer_load_dwordx4 v231, s[8:11], s29 offen offset:0 nt lds
  v_mfma_f32_16x16x32_bf16 v[184:187], a[200:203], a[32:35], v[184:187]
  s_waitcnt lgkmcnt(4)
  v_mfma_f32_16x16x32_bf16 v[168:171], a[204:207], a[36:39], v[168:171]
  s_add_u32 s29, s29, s30
  ds_read_b128 a[192:195], v228 offset:8192
  v_mfma_f32_16x16x32_bf16 v[176:179], a[204:207], a[40:43], v[176:179]
  v_mfma_f32_16x16x32_bf16 v[184:187], a[204:207], a[44:47], v[184:187]
  s_waitcnt lgkmcnt(4)
  v_mfma_f32_16x16x32_bf16 v[168:171], a[208:211], a[48:51], v[168:171]
  ds_read_b128 a[196:199], v228 offset:8448
  v_mfma_f32_16x16x32_bf16 v[176:179], a[208:211], a[52:55], v[176:179]
  buffer_load_dwordx4 v231, s[8:11], s29 offen offset:1024 nt lds
  v_mfma_f32_16x16x32_bf16 v[184:187], a[208:211], a[56:59], v[184:187]
  s_waitcnt lgkmcnt(4)
  v_mfma_f32_16x16x32_bf16 v[168:171], a[212:215], a[60:63], v[168:171]
  s_add_u32 s29, s29, s30
  ds_read_b128 a[200:203], v228 offset:9216
  v_mfma_f32_16x16x32_bf16 v[176:179], a[212:215], a[64:67], v[176:179]
  v_mfma_f32_16x16x32_bf16 v[184:187], a[212:215], a[68:71], v[184:187]
  s_waitcnt lgkmcnt(4)
  v_mfma_f32_16x16x32_bf16 v[168:171], a[216:219], a[72:75], v[168:171]
  ds_read_b128 a[204:207], v228 offset:9472
  v_mfma_f32_16x16x32_bf16 v[176:179], a[216:219], a[76:79], v[176:179]
  buffer_load_dwordx4 v231, s[8:11], s29 offen offset:2048 nt lds
  v_mfma_f32_16x16x32_bf16 v[184:187], a[216:219], a[80:83], v[184:187]
  s_waitcnt lgkmcnt(4)
  v_mfma_f32_16x16x32_bf16 v[168:171], a[220:223], a[84:87], v[168:171]
  s_add_u32 s29, s29, s30
  ds_read_b128 a[208:211], v228 offset:10240
  v_mfma_f32_16x16x32_bf16 v[176:179], a[220:223], a[88:91], v[176:179]
  v_mfma_f32_16x16x32_bf16 v[184:187], a[220:223], a[92:95], v[184:187]
  s_waitcnt lgkmcnt(4)
  v_mfma_f32_16x16x32_bf16 v[172:175], a[192:195], a[0:3], v[216:219]
  ds_read_b128 a[212:215], v228 offset:10496
  v_mfma_f32_16x16x32_bf16 v[180:183], a[192:195], a[4:7], v[220:223]
  buffer_load_dwordx4 v231, s[8:11], s29 offen offset:3072 nt lds
  v_mfma_f32_16x16x32_bf16 v[188:191], a[192:195], a[8:11], v[224:227]
  s_waitcnt lgkmcnt(4)
  v_exp_f32 v168, v168
  v_mfma_f32_16x16x32_bf16 v[172:175], a[196:199], a[12:15], v[172:175]
  s_waitcnt vmcnt(4)
  ds_read_b128 a[216:219], v228 offset:11264
  v_add_f32 v234, v168, v234
  v_mfma_f32_16x16x32_bf16 v[180:183], a[196:199], a[16:19], v[180:183]
  s_barrier
  v_exp_f32 v169, v169
  v_mfma_f32_16x16x32_bf16 v[188:191], a[196:199], a[20:23], v[188:191]
  s_waitcnt lgkmcnt(4)
  v_exp_f32 v170, v170
  v_mfma_f32_16x16x32_bf16 v[172:175], a[200:203], a[24:27], v[172:175]
  ds_read_b128 a[220:223], v228 offset:11520
  v_add_u32 v228, 16384, v230
  v_mfma_f32_16x16x32_bf16 v[180:183], a[200:203], a[28:31], v[180:183]
  v_xor_b32 v239, 32, v228
  v_mfma_f32_16x16x32_bf16 v[188:191], a[200:203], a[32:35], v[188:191]
  s_waitcnt lgkmcnt(4)
  v_exp_f32 v171, v171
  v_mfma_f32_16x16x32_bf16 v[172:175], a[204:207], a[36:39], v[172:175]
  ds_read_b64_tr_b16 a[192:193], v228 offset:0
  v_add_f32 v234, v169, v234
  v_mfma_f32_16x16x32_bf16 v[180:183], a[204:207], a[40:43], v[180:183]
  ds_read_b64_tr_b16 a[194:195], v228 offset:8192
  v_cvt_pk_bf16_f32 v168, v168, v169
  v_mfma_f32_16x16x32_bf16 v[188:191], a[204:207], a[44:47], v[188:191]
  s_waitcnt lgkmcnt(5)
  v_exp_f32 v176, v176
  v_mfma_f32_16x16x32_bf16 v[172:175], a[208:211], a[48:51], v[172:175]
  ds_read_b64_tr_b16 a[196:197], v239 offset:0
  v_add_f32 v234, v170, v234
  v_mfma_f32_16x16x32_bf16 v[180:183], a[208:211], a[52:55], v[180:183]
  ds_read_b64_tr_b16 a[198:199], v239 offset:8192
  v_add_f32 v234, v171, v234
  v_mfma_f32_16x16x32_bf16 v[188:191], a[208:211], a[56:59], v[188:191]
  s_waitcnt lgkmcnt(6)
  v_exp_f32 v177, v177
  v_mfma_f32_16x16x32_bf16 v[172:175], a[212:215], a[60:63], v[172:175]
  ds_read_b64_tr_b16 a[200:201], v228 offset:256
  v_cvt_pk_bf16_f32 v169, v170, v171
  v_mfma_f32_16x16x32_bf16 v[180:183], a[212:215], a[64:67], v[180:183]
  ds_read_b64_tr_b16 a[202:203], v228 offset:8448
  v_add_f32 v235, v176, v235
  v_mfma_f32_16x16x32_bf16 v[188:191], a[212:215], a[68:71], v[188:191]
  s_waitcnt lgkmcnt(7)
  v_exp_f32 v178, v178
  v_mfma_f32_16x16x32_bf16 v[172:175], a[216:219], a[72:75], v[172:175]
  ds_read_b64_tr_b16 a[204:205], v239 offset:256
  v_add_f32 v235, v177, v235
  v_mfma_f32_16x16x32_bf16 v[180:183], a[216:219], a[76:79], v[180:183]
  ds_read_b64_tr_b16 a[206:207], v239 offset:8448
  v_cvt_pk_bf16_f32 v176, v176, v177
  v_mfma_f32_16x16x32_bf16 v[188:191], a[216:219], a[80:83], v[188:191]
  s_waitcnt lgkmcnt(8)
  v_exp_f32 v179, v179
  v_mfma_f32_16x16x32_bf16 v[172:175], a[220:223], a[84:87], v[172:175]
  ds_read_b64_tr_b16 a[208:209], v228 offset:1024
  v_add_f32 v235, v178, v235
  v_mfma_f32_16x16x32_bf16 v[180:183], a[220:223], a[88:91], v[180:183]
  ds_read_b64_tr_b16 a[210:211], v228 offset:9216
  v_add_f32 v235, v179, v235
  v_mfma_f32_16x16x32_bf16 v[188:191], a[220:223], a[92:95], v[188:191]
  s_waitcnt lgkmcnt(8)
  v_exp_f32 v184, v184
  v_mfma_f32_16x16x32_bf16 v[0:3], a[192:195], v[192:195], v[0:3]
  s_add_u32 m0, s28, 81920
  ds_read_b64_tr_b16 a[212:213], v239 offset:1024
  v_cvt_pk_bf16_f32 v177, v178, v179
  v_mfma_f32_16x16x32_bf16 v[4:7], a[192:195], v[200:203], v[4:7]
  s_mov_b32 s29, 494592
  ds_read_b64_tr_b16 a[214:215], v239 offset:9216
  v_add_f32 v236, v184, v236
  v_mfma_f32_16x16x32_bf16 v[8:11], a[192:195], v[208:211], v[8:11]
  s_waitcnt lgkmcnt(8)
  v_exp_f32 v185, v185
  v_mfma_f32_16x16x32_bf16 v[12:15], a[196:199], v[192:195], v[12:15]
  ds_read_b64_tr_b16 a[216:217], v228 offset:1280
  v_add_f32 v236, v185, v236
  v_mfma_f32_16x16x32_bf16 v[16:19], a[196:199], v[200:203], v[16:19]
  buffer_load_dwordx4 a[252:255], v247, s[88:91], 0 offen offset:0
  v_mfma_f32_16x16x32_bf16 v[20:23], a[196:199], v[208:211], v[20:23]
  s_waitcnt lgkmcnt(7)
  ds_read_b64_tr_b16 a[218:219], v228 offset:9472
  v_cvt_pk_bf16_f32 v184, v184, v185
  v_mfma_f32_16x16x32_bf16 v[24:27], a[200:203], v[192:195], v[24:27]
  ds_read_b64_tr_b16 a[220:221], v239 offset:1280
  v_mfma_f32_16x16x32_bf16 v[28:31], a[200:203], v[200:203], v[28:31]
  buffer_load_dwordx4 v231, s[12:15], s29 offen offset:0 nt lds
  v_mfma_f32_16x16x32_bf16 v[32:35], a[200:203], v[208:211], v[32:35]
  s_waitcnt lgkmcnt(7)
  ds_read_b64_tr_b16 a[222:223], v239 offset:9472
  v_mfma_f32_16x16x32_bf16 v[36:39], a[204:207], v[192:195], v[36:39]
  s_add_u32 s29, s29, s30
  ds_read_b64_tr_b16 a[192:193], v228 offset:2048
  v_mfma_f32_16x16x32_bf16 v[40:43], a[204:207], v[200:203], v[40:43]
  ds_read_b64_tr_b16 a[194:195], v228 offset:10240
  v_mfma_f32_16x16x32_bf16 v[44:47], a[204:207], v[208:211], v[44:47]
  s_waitcnt lgkmcnt(8)
  v_exp_f32 v186, v186
  v_mfma_f32_16x16x32_bf16 v[48:51], a[208:211], v[192:195], v[48:51]
  ds_read_b64_tr_b16 a[196:197], v239 offset:2048
  v_add_f32 v236, v186, v236
  v_mfma_f32_16x16x32_bf16 v[52:55], a[208:211], v[200:203], v[52:55]
  buffer_load_dwordx4 v231, s[12:15], s29 offen offset:1024 nt lds
  v_mfma_f32_16x16x32_bf16 v[56:59], a[208:211], v[208:211], v[56:59]
  s_waitcnt lgkmcnt(7)
  ds_read_b64_tr_b16 a[198:199], v239 offset:10240
  v_mfma_f32_16x16x32_bf16 v[60:63], a[212:215], v[192:195], v[60:63]
  s_add_u32 s29, s29, s30
  ds_read_b64_tr_b16 a[200:201], v228 offset:2304
  v_mfma_f32_16x16x32_bf16 v[64:67], a[212:215], v[200:203], v[64:67]
  ds_read_b64_tr_b16 a[202:203], v228 offset:10496
  v_mfma_f32_16x16x32_bf16 v[68:71], a[212:215], v[208:211], v[68:71]
  s_waitcnt lgkmcnt(8)
  v_exp_f32 v187, v187
  v_mfma_f32_16x16x32_bf16 v[72:75], a[216:219], v[192:195], v[72:75]
  ds_read_b64_tr_b16 a[204:205], v239 offset:2304
  v_add_f32 v236, v187, v236
  v_mfma_f32_16x16x32_bf16 v[76:79], a[216:219], v[200:203], v[76:79]
  buffer_load_dwordx4 v231, s[12:15], s29 offen offset:2048 nt lds
  v_mfma_f32_16x16x32_bf16 v[80:83], a[216:219], v[208:211], v[80:83]
  s_waitcnt lgkmcnt(7)
  ds_read_b64_tr_b16 a[206:207], v239 offset:10496
  v_cvt_pk_bf16_f32 v185, v186, v187
  v_mfma_f32_16x16x32_bf16 v[84:87], a[220:223], v[192:195], v[84:87]
  s_add_u32 s29, s29, s30
  ds_read_b64_tr_b16 a[208:209], v228 offset:3072
  v_mfma_f32_16x16x32_bf16 v[88:91], a[220:223], v[200:203], v[88:91]
  ds_read_b64_tr_b16 a[210:211], v228 offset:11264
  v_mfma_f32_16x16x32_bf16 v[92:95], a[220:223], v[208:211], v[92:95]
  s_waitcnt lgkmcnt(8)
  v_exp_f32 v172, v172
  v_mfma_f32_16x16x32_bf16 v[96:99], a[192:195], v[192:195], v[96:99]
  ds_read_b64_tr_b16 a[212:213], v239 offset:3072
  v_add_f32 v234, v172, v234
  v_mfma_f32_16x16x32_bf16 v[100:103], a[192:195], v[200:203], v[100:103]
  buffer_load_dwordx4 v231, s[12:15], s29 offen offset:3072 nt lds
  v_mfma_f32_16x16x32_bf16 v[104:107], a[192:195], v[208:211], v[104:107]
  s_waitcnt lgkmcnt(7)
  ds_read_b64_tr_b16 a[214:215], v239 offset:11264
  v_mfma_f32_16x16x32_bf16 v[108:111], a[196:199], v[192:195], v[108:111]
  s_waitcnt vmcnt(5)
  ds_read_b64_tr_b16 a[216:217], v228 offset:3328
  v_mfma_f32_16x16x32_bf16 v[112:115], a[196:199], v[200:203], v[112:115]
  s_barrier
  ds_read_b64_tr_b16 a[218:219], v228 offset:11520
  v_mfma_f32_16x16x32_bf16 v[116:119], a[196:199], v[208:211], v[116:119]
  s_waitcnt lgkmcnt(8)
  v_exp_f32 v173, v173
  v_mfma_f32_16x16x32_bf16 v[120:123], a[200:203], v[192:195], v[120:123]
  ds_read_b64_tr_b16 a[220:221], v239 offset:3328
  v_add_f32 v234, v173, v234
  v_mfma_f32_16x16x32_bf16 v[124:127], a[200:203], v[200:203], v[124:127]
  ds_read_b64_tr_b16 a[222:223], v239 offset:11520
  v_add_u32 v228, 114688, v229
  v_mfma_f32_16x16x32_bf16 v[128:131], a[200:203], v[208:211], v[128:131]
  s_waitcnt lgkmcnt(8)
  v_exp_f32 v174, v174
  v_mfma_f32_16x16x32_bf16 v[132:135], a[204:207], v[192:195], v[132:135]
  ds_read_b128 a[192:195], v228 offset:0
  v_cvt_pk_bf16_f32 v170, v172, v173
  v_mfma_f32_16x16x32_bf16 v[136:139], a[204:207], v[200:203], v[136:139]
  v_exp_f32 v175, v175
  v_mfma_f32_16x16x32_bf16 v[140:143], a[204:207], v[208:211], v[140:143]
  s_waitcnt lgkmcnt(7)
  v_exp_f32 v180, v180
  v_mfma_f32_16x16x32_bf16 v[144:147], a[208:211], v[192:195], v[144:147]
  ds_read_b128 a[196:199], v228 offset:256
  v_add_f32 v234, v174, v234
  v_mfma_f32_16x16x32_bf16 v[148:151], a[208:211], v[200:203], v[148:151]
  v_exp_f32 v181, v181
  v_mfma_f32_16x16x32_bf16 v[152:155], a[208:211], v[208:211], v[152:155]
  s_waitcnt lgkmcnt(6)
  v_exp_f32 v182, v182
  v_mfma_f32_16x16x32_bf16 v[156:159], a[212:215], v[192:195], v[156:159]
  ds_read_b128 a[200:203], v228 offset:1024
  v_add_f32 v234, v175, v234
  v_mfma_f32_16x16x32_bf16 v[160:163], a[212:215], v[200:203], v[160:163]
  v_exp_f32 v183, v183
  v_mfma_f32_16x16x32_bf16 v[164:167], a[212:215], v[208:211], v[164:167]
  s_waitcnt lgkmcnt(5)
  v_exp_f32 v188, v188
  v_mfma_f32_16x16x32_bf16 a[224:227], a[216:219], v[192:195], a[224:227]
  ds_read_b128 a[204:207], v228 offset:1280
  v_cvt_pk_bf16_f32 v171, v174, v175
  v_mfma_f32_16x16x32_bf16 a[228:231], a[216:219], v[200:203], a[228:231]
  v_exp_f32 v189, v189
  v_mfma_f32_16x16x32_bf16 a[232:235], a[216:219], v[208:211], a[232:235]
  s_waitcnt lgkmcnt(4)
  v_exp_f32 v190, v190
  v_mfma_f32_16x16x32_bf16 a[236:239], a[220:223], v[192:195], a[236:239]
  ds_read_b128 a[208:211], v228 offset:2048
  v_add_f32 v235, v180, v235
  v_mfma_f32_16x16x32_bf16 a[240:243], a[220:223], v[200:203], a[240:243]
  v_exp_f32 v191, v191
  v_mfma_f32_16x16x32_bf16 a[244:247], a[220:223], v[208:211], a[244:247]
  s_waitcnt lgkmcnt(4)
  v_add_f32 v235, v181, v235
  v_add_f32 v236, v188, v236
  v_mfma_f32_16x16x32_bf16 v[192:195], a[192:195], a[0:3], v[216:219]
  s_add_u32 m0, s28, 0
  ds_read_b128 a[212:215], v228 offset:2304
  v_cvt_pk_bf16_f32 v178, v180, v181
  v_mfma_f32_16x16x32_bf16 v[200:203], a[192:195], a[4:7], v[220:223]
  s_mov_b32 s29, 510976
  v_add_f32 v235, v182, v235
  v_add_f32 v236, v189, v236
  v_mfma_f32_16x16x32_bf16 v[208:211], a[192:195], a[8:11], v[224:227]
  s_waitcnt lgkmcnt(4)
  v_add_f32 v235, v183, v235
  v_cvt_pk_bf16_f32 v186, v188, v189
  v_mfma_f32_16x16x32_bf16 v[192:195], a[196:199], a[12:15], v[192:195]
  ds_read_b128 a[216:219], v228 offset:3072
  v_cvt_pk_bf16_f32 v179, v182, v183
  v_mfma_f32_16x16x32_bf16 v[200:203], a[196:199], a[16:19], v[200:203]
  buffer_load_dwordx4 v231, s[12:15], s29 offen offset:0 nt lds
  v_mfma_f32_16x16x32_bf16 v[208:211], a[196:199], a[20:23], v[208:211]
  s_waitcnt lgkmcnt(4)
  v_add_f32 v236, v190, v236
  v_mfma_f32_16x16x32_bf16 v[192:195], a[200:203], a[24:27], v[192:195]
  s_add_u32 s29, s29, s30
  ds_read_b128 a[220:223], v228 offset:3328
  v_add_f32 v236, v191, v236
  v_mfma_f32_16x16x32_bf16 v[200:203], a[200:203], a[28:31], v[200:203]
  v_cvt_pk_bf16_f32 v187, v190, v191
  v_mfma_f32_16x16x32_bf16 v[208:211], a[200:203], a[32:35], v[208:211]
  s_waitcnt lgkmcnt(4)
  v_mfma_f32_16x16x32_bf16 v[192:195], a[204:207], a[36:39], v[192:195]
  ds_read_b128 a[192:195], v228 offset:8192
  v_mfma_f32_16x16x32_bf16 v[200:203], a[204:207], a[40:43], v[200:203]
  buffer_load_dwordx4 v231, s[12:15], s29 offen offset:1024 nt lds
  v_mfma_f32_16x16x32_bf16 v[208:211], a[204:207], a[44:47], v[208:211]
  s_waitcnt lgkmcnt(4)
  v_mfma_f32_16x16x32_bf16 v[192:195], a[208:211], a[48:51], v[192:195]
  s_add_u32 s29, s29, s30
  ds_read_b128 a[196:199], v228 offset:8448
  v_mfma_f32_16x16x32_bf16 v[200:203], a[208:211], a[52:55], v[200:203]
  v_mfma_f32_16x16x32_bf16 v[208:211], a[208:211], a[56:59], v[208:211]
  s_waitcnt lgkmcnt(4)
  v_mfma_f32_16x16x32_bf16 v[192:195], a[212:215], a[60:63], v[192:195]
  ds_read_b128 a[200:203], v228 offset:9216
  v_mfma_f32_16x16x32_bf16 v[200:203], a[212:215], a[64:67], v[200:203]
  buffer_load_dwordx4 v231, s[12:15], s29 offen offset:2048 nt lds
  v_mfma_f32_16x16x32_bf16 v[208:211], a[212:215], a[68:71], v[208:211]
  s_waitcnt lgkmcnt(4)
  v_mfma_f32_16x16x32_bf16 v[192:195], a[216:219], a[72:75], v[192:195]
  s_add_u32 s29, s29, s30
  ds_read_b128 a[204:207], v228 offset:9472
  v_mfma_f32_16x16x32_bf16 v[200:203], a[216:219], a[76:79], v[200:203]
  v_mfma_f32_16x16x32_bf16 v[208:211], a[216:219], a[80:83], v[208:211]
  s_waitcnt lgkmcnt(4)
  v_mfma_f32_16x16x32_bf16 v[192:195], a[220:223], a[84:87], v[192:195]
  ds_read_b128 a[208:211], v228 offset:10240
  v_mfma_f32_16x16x32_bf16 v[200:203], a[220:223], a[88:91], v[200:203]
  buffer_load_dwordx4 v231, s[12:15], s29 offen offset:3072 nt lds
  v_mfma_f32_16x16x32_bf16 v[208:211], a[220:223], a[92:95], v[208:211]
  s_waitcnt lgkmcnt(4)
  v_mfma_f32_16x16x32_bf16 v[196:199], a[192:195], a[0:3], v[216:219]
  s_add_u32 m0, s28, 98304
  ds_read_b128 a[212:215], v228 offset:10496
  v_mfma_f32_16x16x32_bf16 v[204:207], a[192:195], a[4:7], v[220:223]
  s_add_u32 s29, s53, 114688
  buffer_load_dwordx4 v232, s[24:27], s29 offen offset:0 lds
  v_mfma_f32_16x16x32_bf16 v[212:215], a[192:195], a[8:11], v[224:227]
  s_waitcnt lgkmcnt(4)
  v_exp_f32 v192, v192
  v_mfma_f32_16x16x32_bf16 v[196:199], a[196:199], a[12:15], v[196:199]
  s_waitcnt vmcnt(5)
  ds_read_b128 a[216:219], v228 offset:11264
  v_add_f32 v234, v192, v234
  v_mfma_f32_16x16x32_bf16 v[204:207], a[196:199], a[16:19], v[204:207]
  s_barrier
  v_exp_f32 v193, v193
  v_mfma_f32_16x16x32_bf16 v[212:215], a[196:199], a[20:23], v[212:215]
  s_waitcnt lgkmcnt(4)
  v_exp_f32 v194, v194
  v_mfma_f32_16x16x32_bf16 v[196:199], a[200:203], a[24:27], v[196:199]
  s_add_u32 s29, s29, s31
  ds_read_b128 a[220:223], v228 offset:11520
  v_add_u32 v228, 81920, v230
  v_mfma_f32_16x16x32_bf16 v[204:207], a[200:203], a[28:31], v[204:207]
  v_xor_b32 v239, 32, v228
  v_mfma_f32_16x16x32_bf16 v[212:215], a[200:203], a[32:35], v[212:215]
  s_waitcnt lgkmcnt(4)
  v_exp_f32 v195, v195
  v_mfma_f32_16x16x32_bf16 v[196:199], a[204:207], a[36:39], v[196:199]
  ds_read_b64_tr_b16 a[192:193], v228 offset:0
  v_add_f32 v234, v193, v234
  v_mfma_f32_16x16x32_bf16 v[204:207], a[204:207], a[40:43], v[204:207]
  buffer_load_dwordx4 v232, s[24:27], s29 offen offset:1024 lds
  v_mfma_f32_16x16x32_bf16 v[212:215], a[204:207], a[44:47], v[212:215]
  s_waitcnt lgkmcnt(4)
  ds_read_b64_tr_b16 a[194:195], v228 offset:8192
  v_cvt_pk_bf16_f32 v192, v192, v193
  v_mfma_f32_16x16x32_bf16 v[196:199], a[208:211], a[48:51], v[196:199]
  s_add_u32 s29, s29, s31
  ds_read_b64_tr_b16 a[196:197], v239 offset:0
  v_add_f32 v234, v194, v234
  v_mfma_f32_16x16x32_bf16 v[204:207], a[208:211], a[52:55], v[204:207]
  ds_read_b64_tr_b16 a[198:199], v239 offset:8192
  v_add_f32 v234, v195, v234
  v_mfma_f32_16x16x32_bf16 v[212:215], a[208:211], a[56:59], v[212:215]
  s_waitcnt lgkmcnt(6)
  v_exp_f32 v200, v200
  v_mfma_f32_16x16x32_bf16 v[196:199], a[212:215], a[60:63], v[196:199]
  ds_read_b64_tr_b16 a[200:201], v228 offset:256
  v_cvt_pk_bf16_f32 v193, v194, v195
  v_mfma_f32_16x16x32_bf16 v[204:207], a[212:215], a[64:67], v[204:207]
  buffer_load_dwordx4 v232, s[24:27], s29 offen offset:2048 lds
  v_mfma_f32_16x16x32_bf16 v[212:215], a[212:215], a[68:71], v[212:215]
  s_waitcnt lgkmcnt(6)
  ds_read_b64_tr_b16 a[202:203], v228 offset:8448
  v_add_f32 v235, v200, v235
  v_mfma_f32_16x16x32_bf16 v[196:199], a[216:219], a[72:75], v[196:199]
  s_add_u32 s29, s29, s31
  ds_read_b64_tr_b16 a[204:205], v239 offset:256
  v_mfma_f32_16x16x32_bf16 v[204:207], a[216:219], a[76:79], v[204:207]
  ds_read_b64_tr_b16 a[206:207], v239 offset:8448
  v_mfma_f32_16x16x32_bf16 v[212:215], a[216:219], a[80:83], v[212:215]
  s_waitcnt lgkmcnt(8)
  v_exp_f32 v201, v201
  v_mfma_f32_16x16x32_bf16 v[196:199], a[220:223], a[84:87], v[196:199]
  ds_read_b64_tr_b16 a[208:209], v228 offset:1024
  v_add_f32 v235, v201, v235
  v_mfma_f32_16x16x32_bf16 v[204:207], a[220:223], a[88:91], v[204:207]
  buffer_load_dwordx4 v232, s[24:27], s29 offen offset:3072 lds
  v_mfma_f32_16x16x32_bf16 v[212:215], a[220:223], a[92:95], v[212:215]
  s_waitcnt lgkmcnt(7)
  ds_read_b64_tr_b16 a[210:211], v228 offset:9216
  v_cvt_pk_bf16_f32 v200, v200, v201
  v_mfma_f32_16x16x32_bf16 v[0:3], a[192:195], v[168:171], v[0:3]
  s_add_u32 m0, s28, 16384
  ds_read_b64_tr_b16 a[212:213], v239 offset:1024
  v_mfma_f32_16x16x32_bf16 v[4:7], a[192:195], v[176:179], v[4:7]
  s_add_u32 s29, s53, 229376
  ds_read_b64_tr_b16 a[214:215], v239 offset:9216
  v_mfma_f32_16x16x32_bf16 v[8:11], a[192:195], v[184:187], v[8:11]
  s_waitcnt lgkmcnt(8)
  v_exp_f32 v202, v202
  v_mfma_f32_16x16x32_bf16 v[12:15], a[196:199], v[168:171], v[12:15]
  ds_read_b64_tr_b16 a[216:217], v228 offset:1280
  v_add_f32 v235, v202, v235
  v_mfma_f32_16x16x32_bf16 v[16:19], a[196:199], v[176:179], v[16:19]
  ds_read_b64_tr_b16 a[218:219], v228 offset:9472
  v_mfma_f32_16x16x32_bf16 v[20:23], a[196:199], v[184:187], v[20:23]
  s_waitcnt lgkmcnt(8)
  v_exp_f32 v203, v203
  v_mfma_f32_16x16x32_bf16 v[24:27], a[200:203], v[168:171], v[24:27]
  ds_read_b64_tr_b16 a[220:221], v239 offset:1280
  v_add_f32 v235, v203, v235
  v_mfma_f32_16x16x32_bf16 v[28:31], a[200:203], v[176:179], v[28:31]
  buffer_load_dwordx4 v232, s[24:27], s29 offen offset:0 lds
  v_mfma_f32_16x16x32_bf16 v[32:35], a[200:203], v[184:187], v[32:35]
  s_waitcnt lgkmcnt(7)
  ds_read_b64_tr_b16 a[222:223], v239 offset:9472
  v_cvt_pk_bf16_f32 v201, v202, v203
  v_mfma_f32_16x16x32_bf16 v[36:39], a[204:207], v[168:171], v[36:39]
  s_add_u32 s29, s29, s31
  ds_read_b64_tr_b16 a[192:193], v228 offset:2048
  v_mfma_f32_16x16x32_bf16 v[40:43], a[204:207], v[176:179], v[40:43]
  ds_read_b64_tr_b16 a[194:195], v228 offset:10240
  v_mfma_f32_16x16x32_bf16 v[44:47], a[204:207], v[184:187], v[44:47]
  s_waitcnt lgkmcnt(8)
  v_exp_f32 v208, v208
  v_mfma_f32_16x16x32_bf16 v[48:51], a[208:211], v[168:171], v[48:51]
  ds_read_b64_tr_b16 a[196:197], v239 offset:2048
  v_add_f32 v236, v208, v236
  v_mfma_f32_16x16x32_bf16 v[52:55], a[208:211], v[176:179], v[52:55]
  buffer_load_dwordx4 v232, s[24:27], s29 offen offset:1024 lds
  v_mfma_f32_16x16x32_bf16 v[56:59], a[208:211], v[184:187], v[56:59]
  s_waitcnt lgkmcnt(7)
  ds_read_b64_tr_b16 a[198:199], v239 offset:10240
  v_mfma_f32_16x16x32_bf16 v[60:63], a[212:215], v[168:171], v[60:63]
  s_add_u32 s29, s29, s31
  ds_read_b64_tr_b16 a[200:201], v228 offset:2304
  v_mfma_f32_16x16x32_bf16 v[64:67], a[212:215], v[176:179], v[64:67]
  ds_read_b64_tr_b16 a[202:203], v228 offset:10496
  v_mfma_f32_16x16x32_bf16 v[68:71], a[212:215], v[184:187], v[68:71]
  s_waitcnt lgkmcnt(8)
  v_exp_f32 v209, v209
  v_mfma_f32_16x16x32_bf16 v[72:75], a[216:219], v[168:171], v[72:75]
  ds_read_b64_tr_b16 a[204:205], v239 offset:2304
  v_add_f32 v236, v209, v236
  v_mfma_f32_16x16x32_bf16 v[76:79], a[216:219], v[176:179], v[76:79]
  buffer_load_dwordx4 v232, s[24:27], s29 offen offset:2048 lds
  v_mfma_f32_16x16x32_bf16 v[80:83], a[216:219], v[184:187], v[80:83]
  s_waitcnt lgkmcnt(7)
  ds_read_b64_tr_b16 a[206:207], v239 offset:10496
  v_cvt_pk_bf16_f32 v208, v208, v209
  v_mfma_f32_16x16x32_bf16 v[84:87], a[220:223], v[168:171], v[84:87]
  s_add_u32 s29, s29, s31
  ds_read_b64_tr_b16 a[208:209], v228 offset:3072
  v_mfma_f32_16x16x32_bf16 v[88:91], a[220:223], v[176:179], v[88:91]
  ds_read_b64_tr_b16 a[210:211], v228 offset:11264
  v_mfma_f32_16x16x32_bf16 v[92:95], a[220:223], v[184:187], v[92:95]
  s_waitcnt lgkmcnt(8)
  v_exp_f32 v210, v210
  v_mfma_f32_16x16x32_bf16 v[96:99], a[192:195], v[168:171], v[96:99]
  ds_read_b64_tr_b16 a[212:213], v239 offset:3072
  v_add_f32 v236, v210, v236
  v_mfma_f32_16x16x32_bf16 v[100:103], a[192:195], v[176:179], v[100:103]
  buffer_load_dwordx4 v232, s[24:27], s29 offen offset:3072 lds
  v_mfma_f32_16x16x32_bf16 v[104:107], a[192:195], v[184:187], v[104:107]
  s_waitcnt lgkmcnt(7)
  ds_read_b64_tr_b16 a[214:215], v239 offset:11264
  v_mfma_f32_16x16x32_bf16 v[108:111], a[196:199], v[168:171], v[108:111]
  s_waitcnt vmcnt(8)
  ds_read_b64_tr_b16 a[216:217], v228 offset:3328
  v_mfma_f32_16x16x32_bf16 v[112:115], a[196:199], v[176:179], v[112:115]
  s_barrier
  ds_read_b64_tr_b16 a[218:219], v228 offset:11520
  v_mfma_f32_16x16x32_bf16 v[116:119], a[196:199], v[184:187], v[116:119]
  s_waitcnt lgkmcnt(8)
  v_exp_f32 v211, v211
  v_mfma_f32_16x16x32_bf16 v[120:123], a[200:203], v[168:171], v[120:123]
  ds_read_b64_tr_b16 a[220:221], v239 offset:3328
  v_add_f32 v236, v211, v236
  v_mfma_f32_16x16x32_bf16 v[124:127], a[200:203], v[176:179], v[124:127]
  ds_read_b64_tr_b16 a[222:223], v239 offset:11520
  v_add_u32 v228, 0, v230
  v_mfma_f32_16x16x32_bf16 v[128:131], a[200:203], v[184:187], v[128:131]
  s_waitcnt lgkmcnt(8)
  v_xor_b32 v239, 32, v228
  v_mfma_f32_16x16x32_bf16 v[132:135], a[204:207], v[168:171], v[132:135]
  ds_read_b64_tr_b16 a[192:193], v228 offset:0
  v_cvt_pk_bf16_f32 v209, v210, v211
  v_mfma_f32_16x16x32_bf16 v[136:139], a[204:207], v[176:179], v[136:139]
  ds_read_b64_tr_b16 a[194:195], v228 offset:8192
  v_mfma_f32_16x16x32_bf16 v[140:143], a[204:207], v[184:187], v[140:143]
  s_waitcnt lgkmcnt(8)
  v_exp_f32 v196, v196
  v_mfma_f32_16x16x32_bf16 v[144:147], a[208:211], v[168:171], v[144:147]
  ds_read_b64_tr_b16 a[196:197], v239 offset:0
  v_add_f32 v234, v196, v234
  v_mfma_f32_16x16x32_bf16 v[148:151], a[208:211], v[176:179], v[148:151]
  ds_read_b64_tr_b16 a[198:199], v239 offset:8192
  v_mfma_f32_16x16x32_bf16 v[152:155], a[208:211], v[184:187], v[152:155]
  s_waitcnt lgkmcnt(8)
  v_exp_f32 v197, v197
  v_mfma_f32_16x16x32_bf16 v[156:159], a[212:215], v[168:171], v[156:159]
  ds_read_b64_tr_b16 a[200:201], v228 offset:256
  v_add_f32 v234, v197, v234
  v_mfma_f32_16x16x32_bf16 v[160:163], a[212:215], v[176:179], v[160:163]
  ds_read_b64_tr_b16 a[202:203], v228 offset:8448
  v_cvt_pk_bf16_f32 v194, v196, v197
  v_mfma_f32_16x16x32_bf16 v[164:167], a[212:215], v[184:187], v[164:167]
  s_waitcnt lgkmcnt(8)
  v_exp_f32 v198, v198
  v_mfma_f32_16x16x32_bf16 a[224:227], a[216:219], v[168:171], a[224:227]
  ds_read_b64_tr_b16 a[204:205], v239 offset:256
  v_add_f32 v234, v198, v234
  v_mfma_f32_16x16x32_bf16 a[228:231], a[216:219], v[176:179], a[228:231]
  ds_read_b64_tr_b16 a[206:207], v239 offset:8448
  v_mfma_f32_16x16x32_bf16 a[232:235], a[216:219], v[184:187], a[232:235]
  s_waitcnt lgkmcnt(8)
  v_exp_f32 v199, v199
  v_mfma_f32_16x16x32_bf16 a[236:239], a[220:223], v[168:171], a[236:239]
  ds_read_b64_tr_b16 a[208:209], v228 offset:1024
  v_add_f32 v234, v199, v234
  v_mfma_f32_16x16x32_bf16 a[240:243], a[220:223], v[176:179], a[240:243]
  ds_read_b64_tr_b16 a[210:211], v228 offset:9216
  v_cvt_pk_bf16_f32 v195, v198, v199
  v_exp_f32 v204, v204
  v_exp_f32 v205, v205
  v_exp_f32 v206, v206
  v_exp_f32 v207, v207
  v_exp_f32 v212, v212
  v_exp_f32 v213, v213
  v_exp_f32 v214, v214
  v_exp_f32 v215, v215
  v_add_f32 v235, v204, v235
  v_add_f32 v235, v205, v235
  v_cvt_pk_bf16_f32 v202, v204, v205
  v_add_f32 v235, v206, v235
  v_add_f32 v235, v207, v235
  v_cvt_pk_bf16_f32 v203, v206, v207
  v_add_f32 v236, v212, v236
  v_add_f32 v236, v213, v236
  v_cvt_pk_bf16_f32 v210, v212, v213
  v_add_f32 v236, v214, v236
  v_add_f32 v236, v215, v236
  v_cvt_pk_bf16_f32 v211, v214, v215
  v_mfma_f32_16x16x32_bf16 a[244:247], a[220:223], v[184:187], a[244:247]
  s_waitcnt lgkmcnt(8)
  v_mfma_f32_16x16x32_bf16 v[0:3], a[192:195], v[192:195], v[0:3]
  s_add_u32 m0, s28, 114688
  ds_read_b64_tr_b16 a[212:213], v239 offset:1024
  v_mfma_f32_16x16x32_bf16 v[4:7], a[192:195], v[200:203], v[4:7]
  s_add_u32 s29, s53, 344064
  ds_read_b64_tr_b16 a[214:215], v239 offset:9216
  v_mfma_f32_16x16x32_bf16 v[8:11], a[192:195], v[208:211], v[8:11]
  s_waitcnt lgkmcnt(8)
  v_mfma_f32_16x16x32_bf16 v[12:15], a[196:199], v[192:195], v[12:15]
  ds_read_b64_tr_b16 a[216:217], v228 offset:1280
  v_mfma_f32_16x16x32_bf16 v[16:19], a[196:199], v[200:203], v[16:19]
  ds_read_b64_tr_b16 a[218:219], v228 offset:9472
  v_mfma_f32_16x16x32_bf16 v[20:23], a[196:199], v[208:211], v[20:23]
  s_waitcnt lgkmcnt(8)
  v_mfma_f32_16x16x32_bf16 v[24:27], a[200:203], v[192:195], v[24:27]
  ds_read_b64_tr_b16 a[220:221], v239 offset:1280
  v_mfma_f32_16x16x32_bf16 v[28:31], a[200:203], v[200:203], v[28:31]
  buffer_load_dwordx4 v232, s[24:27], s29 offen offset:0 lds
  v_mfma_f32_16x16x32_bf16 v[32:35], a[200:203], v[208:211], v[32:35]
  s_waitcnt lgkmcnt(7)
  ds_read_b64_tr_b16 a[222:223], v239 offset:9472
  v_mfma_f32_16x16x32_bf16 v[36:39], a[204:207], v[192:195], v[36:39]
  s_add_u32 s29, s29, s31
  ds_read_b64_tr_b16 a[192:193], v228 offset:2048
  v_mfma_f32_16x16x32_bf16 v[40:43], a[204:207], v[200:203], v[40:43]
  ds_read_b64_tr_b16 a[194:195], v228 offset:10240
  v_mfma_f32_16x16x32_bf16 v[44:47], a[204:207], v[208:211], v[44:47]
  s_waitcnt lgkmcnt(8)
  v_mfma_f32_16x16x32_bf16 v[48:51], a[208:211], v[192:195], v[48:51]
  ds_read_b64_tr_b16 a[196:197], v239 offset:2048
  v_mfma_f32_16x16x32_bf16 v[52:55], a[208:211], v[200:203], v[52:55]
  buffer_load_dwordx4 v232, s[24:27], s29 offen offset:1024 lds
  v_mfma_f32_16x16x32_bf16 v[56:59], a[208:211], v[208:211], v[56:59]
  s_waitcnt lgkmcnt(7)
  ds_read_b64_tr_b16 a[198:199], v239 offset:10240
  v_mfma_f32_16x16x32_bf16 v[60:63], a[212:215], v[192:195], v[60:63]
  s_add_u32 s29, s29, s31
  ds_read_b64_tr_b16 a[200:201], v228 offset:2304
  v_mfma_f32_16x16x32_bf16 v[64:67], a[212:215], v[200:203], v[64:67]
  ds_read_b64_tr_b16 a[202:203], v228 offset:10496
  v_mfma_f32_16x16x32_bf16 v[68:71], a[212:215], v[208:211], v[68:71]
  s_waitcnt lgkmcnt(8)
  v_mfma_f32_16x16x32_bf16 v[72:75], a[216:219], v[192:195], v[72:75]
  ds_read_b64_tr_b16 a[204:205], v239 offset:2304
  v_mfma_f32_16x16x32_bf16 v[76:79], a[216:219], v[200:203], v[76:79]
  buffer_load_dwordx4 v232, s[24:27], s29 offen offset:2048 lds
  v_mfma_f32_16x16x32_bf16 v[80:83], a[216:219], v[208:211], v[80:83]
  s_waitcnt lgkmcnt(7)
  ds_read_b64_tr_b16 a[206:207], v239 offset:10496
  v_mfma_f32_16x16x32_bf16 v[84:87], a[220:223], v[192:195], v[84:87]
  s_add_u32 s29, s29, s31
  ds_read_b64_tr_b16 a[208:209], v228 offset:3072
  v_mfma_f32_16x16x32_bf16 v[88:91], a[220:223], v[200:203], v[88:91]
  ds_read_b64_tr_b16 a[210:211], v228 offset:11264
  v_mfma_f32_16x16x32_bf16 v[92:95], a[220:223], v[208:211], v[92:95]
  s_waitcnt lgkmcnt(8)
  v_mfma_f32_16x16x32_bf16 v[96:99], a[192:195], v[192:195], v[96:99]
  ds_read_b64_tr_b16 a[212:213], v239 offset:3072
  v_mfma_f32_16x16x32_bf16 v[100:103], a[192:195], v[200:203], v[100:103]
  buffer_load_dwordx4 v232, s[24:27], s29 offen offset:3072 lds
  v_mfma_f32_16x16x32_bf16 v[104:107], a[192:195], v[208:211], v[104:107]
  s_waitcnt lgkmcnt(7)
  ds_read_b64_tr_b16 a[214:215], v239 offset:11264
  v_mfma_f32_16x16x32_bf16 v[108:111], a[196:199], v[192:195], v[108:111]
  s_waitcnt vmcnt(63)
  ds_read_b64_tr_b16 a[216:217], v228 offset:3328
  v_mfma_f32_16x16x32_bf16 v[112:115], a[196:199], v[200:203], v[112:115]
  s_barrier
  ds_read_b64_tr_b16 a[218:219], v228 offset:11520
  v_mfma_f32_16x16x32_bf16 v[116:119], a[196:199], v[208:211], v[116:119]
  s_waitcnt lgkmcnt(8)
  v_mfma_f32_16x16x32_bf16 v[120:123], a[200:203], v[192:195], v[120:123]
  ds_read_b64_tr_b16 a[220:221], v239 offset:3328
  v_mfma_f32_16x16x32_bf16 v[124:127], a[200:203], v[200:203], v[124:127]
  ds_read_b64_tr_b16 a[222:223], v239 offset:11520
  v_mfma_f32_16x16x32_bf16 v[128:131], a[200:203], v[208:211], v[128:131]
  s_waitcnt lgkmcnt(8)
  v_mfma_f32_16x16x32_bf16 v[132:135], a[204:207], v[192:195], v[132:135]
  v_mfma_f32_16x16x32_bf16 v[136:139], a[204:207], v[200:203], v[136:139]
  v_mfma_f32_16x16x32_bf16 v[140:143], a[204:207], v[208:211], v[140:143]
  s_waitcnt lgkmcnt(6)
  v_mfma_f32_16x16x32_bf16 v[144:147], a[208:211], v[192:195], v[144:147]
  v_mfma_f32_16x16x32_bf16 v[148:151], a[208:211], v[200:203], v[148:151]
  v_mfma_f32_16x16x32_bf16 v[152:155], a[208:211], v[208:211], v[152:155]
  s_waitcnt lgkmcnt(4)
  v_mfma_f32_16x16x32_bf16 v[156:159], a[212:215], v[192:195], v[156:159]
  v_mfma_f32_16x16x32_bf16 v[160:163], a[212:215], v[200:203], v[160:163]
  v_mfma_f32_16x16x32_bf16 v[164:167], a[212:215], v[208:211], v[164:167]
  s_waitcnt lgkmcnt(2)
  v_mfma_f32_16x16x32_bf16 a[224:227], a[216:219], v[192:195], a[224:227]
  v_mfma_f32_16x16x32_bf16 a[228:231], a[216:219], v[200:203], a[228:231]
  v_mfma_f32_16x16x32_bf16 a[232:235], a[216:219], v[208:211], a[232:235]
  s_waitcnt lgkmcnt(0)
  v_mfma_f32_16x16x32_bf16 a[236:239], a[220:223], v[192:195], a[236:239]
  v_mfma_f32_16x16x32_bf16 a[240:243], a[220:223], v[200:203], a[240:243]
  v_mfma_f32_16x16x32_bf16 a[244:247], a[220:223], v[208:211], a[244:247]
  v_mov_b32 v240, v234
  v_mov_b32 v241, v235
  v_mov_b32 v242, v236
  v_permlane32_swap_b32 v234, v240
  v_permlane32_swap_b32 v235, v241
  v_permlane32_swap_b32 v236, v242
  v_add_f32 v234, v234, v240
  v_add_f32 v235, v235, v241
  v_add_f32 v236, v236, v242
  v_mov_b32 v240, v234
  v_mov_b32 v241, v235
  v_mov_b32 v242, v236
  v_permlane16_swap_b32 v234, v240
  v_permlane16_swap_b32 v235, v241
  v_permlane16_swap_b32 v236, v242
  v_add_f32 v234, v234, v240
  v_add_f32 v235, v235, v241
  v_add_f32 v236, v236, v242
  v_add_f32 v241, v234, v235
  v_add_f32 v241, v241, v236
  v_cmp_nge_f32 vcc, s40, v241
  s_nop 0
  s_cbranch_vccnz L_slow
L_back1:
  v_rcp_f32 v234, v234
  v_rcp_f32 v235, v235
  v_rcp_f32 v236, v236
  v_mov_b32 v216, v234
  v_mov_b32 v217, v234
  v_mov_b32 v218, v235
  v_mov_b32 v219, v235
  v_mov_b32 v220, v236
  v_mov_b32 v221, v236
  v_accvgpr_read_b32 v229, a248
  v_accvgpr_read_b32 v233, a249
  v_accvgpr_read_b32 v231, a250
  v_accvgpr_read_b32 v222, a251
  v_mov_b32 v226, s72
  v_mov_b32 v227, s73
  v_add_u32 v238, 4096, v233
  v_add_u32 v228, 32768, v229
  v_xor_b32 v239, 32, v228
  ds_read_b64_tr_b16 a[192:193], v228 offset:0
  ds_read_b64_tr_b16 a[194:195], v228 offset:2048
  ds_read_b64_tr_b16 a[196:197], v239 offset:0
  ds_read_b64_tr_b16 a[198:199], v239 offset:2048
  ds_read_b64_tr_b16 a[200:201], v228 offset:256
  ds_read_b64_tr_b16 a[202:203], v228 offset:2304
  ds_read_b64_tr_b16 a[204:205], v239 offset:256
  ds_read_b64_tr_b16 a[206:207], v239 offset:2304
  ds_read_b64_tr_b16 a[208:209], v228 offset:4096
  ds_read_b64_tr_b16 a[210:211], v228 offset:6144
.p2align 3
  v_pk_mul_f32 v[0:1], v[0:1], v[216:217]
  v_pk_mul_f32 v[2:3], v[2:3], v[216:217]
  v_pk_mul_f32 v[12:13], v[12:13], v[216:217]
  v_pk_mul_f32 v[14:15], v[14:15], v[216:217]
  v_cvt_pk_bf16_f32 v0, v0, v1
  v_cvt_pk_bf16_f32 v1, v2, v3
  v_cvt_pk_bf16_f32 v12, v12, v13
  v_cvt_pk_bf16_f32 v13, v14, v15
  v_pk_mul_f32 v[4:5], v[4:5], v[218:219]
  v_pk_mul_f32 v[6:7], v[6:7], v[218:219]
  v_pk_mul_f32 v[16:17], v[16:17], v[218:219]
  v_pk_mul_f32 v[18:19], v[18:19], v[218:219]
  v_cvt_pk_bf16_f32 v4, v4, v5
  v_cvt_pk_bf16_f32 v5, v6, v7
  v_cvt_pk_bf16_f32 v16, v16, v17
  v_cvt_pk_bf16_f32 v17, v18, v19
  v_pk_mul_f32 v[8:9], v[8:9], v[220:221]
  v_pk_mul_f32 v[10:11], v[10:11], v[220:221]
  v_pk_mul_f32 v[20:21], v[20:21], v[220:221]
  v_pk_mul_f32 v[22:23], v[22:23], v[220:221]
  v_cvt_pk_bf16_f32 v8, v8, v9
  v_cvt_pk_bf16_f32 v9, v10, v11
  v_cvt_pk_bf16_f32 v20, v20, v21
  v_cvt_pk_bf16_f32 v21, v22, v23
  v_accvgpr_write_b32 a0, v0
  v_accvgpr_write_b32 a1, v1
  v_accvgpr_write_b32 a2, v12
  v_accvgpr_write_b32 a3, v13
  v_pk_mul_f32 v[24:25], v[24:25], v[216:217]
  v_pk_mul_f32 v[26:27], v[26:27], v[216:217]
  v_pk_mul_f32 v[36:37], v[36:37], v[216:217]
  v_pk_mul_f32 v[38:39], v[38:39], v[216:217]
  v_cvt_pk_bf16_f32 v24, v24, v25
  v_cvt_pk_bf16_f32 v25, v26, v27
  v_cvt_pk_bf16_f32 v36, v36, v37
  v_cvt_pk_bf16_f32 v37, v38, v39
  v_accvgpr_write_b32 a4, v4
  v_accvgpr_write_b32 a5, v5
  v_accvgpr_write_b32 a6, v16
  v_accvgpr_write_b32 a7, v17
  v_pk_mul_f32 v[28:29], v[28:29], v[218:219]
  v_pk_mul_f32 v[30:31], v[30:31], v[218:219]
  v_pk_mul_f32 v[40:41], v[40:41], v[218:219]
  v_pk_mul_f32 v[42:43], v[42:43], v[218:219]
  v_cvt_pk_bf16_f32 v28, v28, v29
  v_cvt_pk_bf16_f32 v29, v30, v31
  v_cvt_pk_bf16_f32 v40, v40, v41
  v_cvt_pk_bf16_f32 v41, v42, v43
  v_accvgpr_write_b32 a8, v8
  v_accvgpr_write_b32 a9, v9
  v_accvgpr_write_b32 a10, v20
  v_accvgpr_write_b32 a11, v21
  v_pk_mul_f32 v[32:33], v[32:33], v[220:221]
  v_pk_mul_f32 v[34:35], v[34:35], v[220:221]
  v_pk_mul_f32 v[44:45], v[44:45], v[220:221]
  v_pk_mul_f32 v[46:47], v[46:47], v[220:221]
  v_cvt_pk_bf16_f32 v32, v32, v33
  v_cvt_pk_bf16_f32 v33, v34, v35
  v_cvt_pk_bf16_f32 v44, v44, v45
  v_cvt_pk_bf16_f32 v45, v46, v47
  v_accvgpr_write_b32 a12, v24
  v_accvgpr_write_b32 a13, v25
  v_accvgpr_write_b32 a14, v36
  v_accvgpr_write_b32 a15, v37
  v_pk_mul_f32 v[48:49], v[48:49], v[216:217]
  v_pk_mul_f32 v[50:51], v[50:51], v[216:217]
  v_pk_mul_f32 v[60:61], v[60:61], v[216:217]
  v_pk_mul_f32 v[62:63], v[62:63], v[216:217]
  v_cvt_pk_bf16_f32 v48, v48, v49
  v_cvt_pk_bf16_f32 v49, v50, v51
  v_cvt_pk_bf16_f32 v60, v60, v61
  v_cvt_pk_bf16_f32 v61, v62, v63
  v_accvgpr_write_b32 a16, v28
  v_accvgpr_write_b32 a17, v29
  v_accvgpr_write_b32 a18, v40
  v_accvgpr_write_b32 a19, v41
  v_pk_mul_f32 v[52:53], v[52:53], v[218:219]
  v_pk_mul_f32 v[54:55], v[54:55], v[218:219]
  v_pk_mul_f32 v[64:65], v[64:65], v[218:219]
  v_pk_mul_f32 v[66:67], v[66:67], v[218:219]
  v_cvt_pk_bf16_f32 v52, v52, v53
  v_cvt_pk_bf16_f32 v53, v54, v55
  v_cvt_pk_bf16_f32 v64, v64, v65
  v_cvt_pk_bf16_f32 v65, v66, v67
  v_accvgpr_write_b32 a20, v32
  v_accvgpr_write_b32 a21, v33
  v_accvgpr_write_b32 a22, v44
  v_accvgpr_write_b32 a23, v45
  v_pk_mul_f32 v[56:57], v[56:57], v[220:221]
  v_pk_mul_f32 v[58:59], v[58:59], v[220:221]
  v_pk_mul_f32 v[68:69], v[68:69], v[220:221]
  v_pk_mul_f32 v[70:71], v[70:71], v[220:221]
  v_cvt_pk_bf16_f32 v56, v56, v57
  v_cvt_pk_bf16_f32 v57, v58, v59
  v_cvt_pk_bf16_f32 v68, v68, v69
  v_cvt_pk_bf16_f32 v69, v70, v71
  v_accvgpr_write_b32 a24, v48
  v_accvgpr_write_b32 a25, v49
  v_accvgpr_write_b32 a26, v60
  v_accvgpr_write_b32 a27, v61
  v_pk_mul_f32 v[72:73], v[72:73], v[216:217]
  v_pk_mul_f32 v[74:75], v[74:75], v[216:217]
  v_pk_mul_f32 v[84:85], v[84:85], v[216:217]
  v_pk_mul_f32 v[86:87], v[86:87], v[216:217]
  v_cvt_pk_bf16_f32 v72, v72, v73
  v_cvt_pk_bf16_f32 v73, v74, v75
  v_cvt_pk_bf16_f32 v84, v84, v85
  v_cvt_pk_bf16_f32 v85, v86, v87
  v_accvgpr_write_b32 a28, v52
  v_accvgpr_write_b32 a29, v53
  v_accvgpr_write_b32 a30, v64
  v_accvgpr_write_b32 a31, v65
  v_pk_mul_f32 v[76:77], v[76:77], v[218:219]
  v_pk_mul_f32 v[78:79], v[78:79], v[218:219]
  v_pk_mul_f32 v[88:89], v[88:89], v[218:219]
  v_pk_mul_f32 v[90:91], v[90:91], v[218:219]
  v_cvt_pk_bf16_f32 v76, v76, v77
  v_cvt_pk_bf16_f32 v77, v78, v79
  v_cvt_pk_bf16_f32 v88, v88, v89
  v_cvt_pk_bf16_f32 v89, v90, v91
  v_accvgpr_write_b32 a32, v56
  v_accvgpr_write_b32 a33, v57
  v_accvgpr_write_b32 a34, v68
  v_accvgpr_write_b32 a35, v69
  v_pk_mul_f32 v[80:81], v[80:81], v[220:221]
  v_pk_mul_f32 v[82:83], v[82:83], v[220:221]
  v_pk_mul_f32 v[92:93], v[92:93], v[220:221]
  v_pk_mul_f32 v[94:95], v[94:95], v[220:221]
  v_cvt_pk_bf16_f32 v80, v80, v81
  v_cvt_pk_bf16_f32 v81, v82, v83
  v_cvt_pk_bf16_f32 v92, v92, v93
  v_cvt_pk_bf16_f32 v93, v94, v95
  v_accvgpr_write_b32 a36, v72
  v_accvgpr_write_b32 a37, v73
  v_accvgpr_write_b32 a38, v84
  v_accvgpr_write_b32 a39, v85
  v_pk_mul_f32 v[96:97], v[96:97], v[216:217]
  v_pk_mul_f32 v[98:99], v[98:99], v[216:217]
  v_pk_mul_f32 v[108:109], v[108:109], v[216:217]
  v_pk_mul_f32 v[110:111], v[110:111], v[216:217]
  v_cvt_pk_bf16_f32 v96, v96, v97
  v_cvt_pk_bf16_f32 v97, v98, v99
  v_cvt_pk_bf16_f32 v108, v108, v109
  v_cvt_pk_bf16_f32 v109, v110, v111
  v_accvgpr_write_b32 a40, v76
  v_accvgpr_write_b32 a41, v77
  v_accvgpr_write_b32 a42, v88
  v_accvgpr_write_b32 a43, v89
  v_pk_mul_f32 v[100:101], v[100:101], v[218:219]
  v_pk_mul_f32 v[102:103], v[102:103], v[218:219]
  v_pk_mul_f32 v[112:113], v[112:113], v[218:219]
  v_pk_mul_f32 v[114:115], v[114:115], v[218:219]
  v_cvt_pk_bf16_f32 v100, v100, v101
  v_cvt_pk_bf16_f32 v101, v102, v103
  v_cvt_pk_bf16_f32 v112, v112, v113
  v_cvt_pk_bf16_f32 v113, v114, v115
  v_accvgpr_write_b32 a44, v80
  v_accvgpr_write_b32 a45, v81
  v_accvgpr_write_b32 a46, v92
  v_accvgpr_write_b32 a47, v93
  v_pk_mul_f32 v[104:105], v[104:105], v[220:221]
  v_pk_mul_f32 v[106:107], v[106:107], v[220:221]
  v_pk_mul_f32 v[116:117], v[116:117], v[220:221]
  v_pk_mul_f32 v[118:119], v[118:119], v[220:221]
  v_cvt_pk_bf16_f32 v104, v104, v105
  v_cvt_pk_bf16_f32 v105, v106, v107
  v_cvt_pk_bf16_f32 v116, v116, v117
  v_cvt_pk_bf16_f32 v117, v118, v119
  v_accvgpr_write_b32 a48, v96
  v_accvgpr_write_b32 a49, v97
  v_accvgpr_write_b32 a50, v108
  v_accvgpr_write_b32 a51, v109
  v_pk_mul_f32 v[120:121], v[120:121], v[216:217]
  v_pk_mul_f32 v[122:123], v[122:123], v[216:217]
  v_pk_mul_f32 v[132:133], v[132:133], v[216:217]
  v_pk_mul_f32 v[134:135], v[134:135], v[216:217]
  v_cvt_pk_bf16_f32 v120, v120, v121
  v_cvt_pk_bf16_f32 v121, v122, v123
  v_cvt_pk_bf16_f32 v132, v132, v133
  v_cvt_pk_bf16_f32 v133, v134, v135
  v_accvgpr_write_b32 a52, v100
  v_accvgpr_write_b32 a53, v101
  v_accvgpr_write_b32 a54, v112
  v_accvgpr_write_b32 a55, v113
  v_pk_mul_f32 v[124:125], v[124:125], v[218:219]
  v_pk_mul_f32 v[126:127], v[126:127], v[218:219]
  v_pk_mul_f32 v[136:137], v[136:137], v[218:219]
  v_pk_mul_f32 v[138:139], v[138:139], v[218:219]
  v_cvt_pk_bf16_f32 v124, v124, v125
  v_cvt_pk_bf16_f32 v125, v126, v127
  v_cvt_pk_bf16_f32 v136, v136, v137
  v_cvt_pk_bf16_f32 v137, v138, v139
  v_accvgpr_write_b32 a56, v104
  v_accvgpr_write_b32 a57, v105
  v_accvgpr_write_b32 a58, v116
  v_accvgpr_write_b32 a59, v117
  v_pk_mul_f32 v[128:129], v[128:129], v[220:221]
  v_pk_mul_f32 v[130:131], v[130:131], v[220:221]
  v_pk_mul_f32 v[140:141], v[140:141], v[220:221]
  v_pk_mul_f32 v[142:143], v[142:143], v[220:221]
  v_cvt_pk_bf16_f32 v128, v128, v129
  v_cvt_pk_bf16_f32 v129, v130, v131
  v_cvt_pk_bf16_f32 v140, v140, v141
  v_cvt_pk_bf16_f32 v141, v142, v143
  v_accvgpr_write_b32 a60, v120
  v_accvgpr_write_b32 a61, v121
  v_accvgpr_write_b32 a62, v132
  v_accvgpr_write_b32 a63, v133
  v_pk_mul_f32 v[144:145], v[144:145], v[216:217]
  v_pk_mul_f32 v[146:147], v[146:147], v[216:217]
  v_pk_mul_f32 v[156:157], v[156:157], v[216:217]
  v_pk_mul_f32 v[158:159], v[158:159], v[216:217]
  v_cvt_pk_bf16_f32 v144, v144, v145
  v_cvt_pk_bf16_f32 v145, v146, v147
  v_cvt_pk_bf16_f32 v156, v156, v157
  v_cvt_pk_bf16_f32 v157, v158, v159
  v_accvgpr_write_b32 a64, v124
  v_accvgpr_write_b32 a65, v125
  v_accvgpr_write_b32 a66, v136
  v_accvgpr_write_b32 a67, v137
  v_pk_mul_f32 v[148:149], v[148:149], v[218:219]
  v_pk_mul_f32 v[150:151], v[150:151], v[218:219]
  v_pk_mul_f32 v[160:161], v[160:161], v[218:219]
  v_pk_mul_f32 v[162:163], v[162:163], v[218:219]
  v_cvt_pk_bf16_f32 v148, v148, v149
  v_cvt_pk_bf16_f32 v149, v150, v151
  v_cvt_pk_bf16_f32 v160, v160, v161
  v_cvt_pk_bf16_f32 v161, v162, v163
  v_accvgpr_write_b32 a68, v128
  v_accvgpr_write_b32 a69, v129
  v_accvgpr_write_b32 a70, v140
  v_accvgpr_write_b32 a71, v141
  v_pk_mul_f32 v[152:153], v[152:153], v[220:221]
  v_pk_mul_f32 v[154:155], v[154:155], v[220:221]
  v_pk_mul_f32 v[164:165], v[164:165], v[220:221]
  v_pk_mul_f32 v[166:167], v[166:167], v[220:221]
  v_cvt_pk_bf16_f32 v152, v152, v153
  v_cvt_pk_bf16_f32 v153, v154, v155
  v_cvt_pk_bf16_f32 v164, v164, v165
  v_cvt_pk_bf16_f32 v165, v166, v167
  v_accvgpr_write_b32 a72, v144
  v_accvgpr_write_b32 a73, v145
  v_accvgpr_write_b32 a74, v156
  v_accvgpr_write_b32 a75, v157
  v_accvgpr_read_b32 v0, a224
  v_accvgpr_read_b32 v1, a225
  v_accvgpr_read_b32 v2, a226
  v_accvgpr_read_b32 v3, a227
  v_accvgpr_read_b32 v12, a236
  v_accvgpr_read_b32 v13, a237
  v_accvgpr_read_b32 v14, a238
  v_accvgpr_read_b32 v15, a239
  v_pk_mul_f32 v[0:1], v[0:1], v[216:217]
  v_pk_mul_f32 v[2:3], v[2:3], v[216:217]
  v_pk_mul_f32 v[12:13], v[12:13], v[216:217]
  v_pk_mul_f32 v[14:15], v[14:15], v[216:217]
  v_cvt_pk_bf16_f32 v0, v0, v1
  v_cvt_pk_bf16_f32 v1, v2, v3
  v_cvt_pk_bf16_f32 v12, v12, v13
  v_cvt_pk_bf16_f32 v13, v14, v15
  v_accvgpr_write_b32 a76, v148
  v_accvgpr_write_b32 a77, v149
  v_accvgpr_write_b32 a78, v160
  v_accvgpr_write_b32 a79, v161
  v_accvgpr_read_b32 v24, a228
  v_accvgpr_read_b32 v25, a229
  v_accvgpr_read_b32 v26, a230
  v_accvgpr_read_b32 v27, a231
  v_accvgpr_read_b32 v36, a240
  v_accvgpr_read_b32 v37, a241
  v_accvgpr_read_b32 v38, a242
  v_accvgpr_read_b32 v39, a243
  v_pk_mul_f32 v[24:25], v[24:25], v[218:219]
  v_pk_mul_f32 v[26:27], v[26:27], v[218:219]
  v_pk_mul_f32 v[36:37], v[36:37], v[218:219]
  v_pk_mul_f32 v[38:39], v[38:39], v[218:219]
  v_cvt_pk_bf16_f32 v24, v24, v25
  v_cvt_pk_bf16_f32 v25, v26, v27
  v_cvt_pk_bf16_f32 v36, v36, v37
  v_cvt_pk_bf16_f32 v37, v38, v39
  v_accvgpr_write_b32 a80, v152
  v_accvgpr_write_b32 a81, v153
  v_accvgpr_write_b32 a82, v164
  v_accvgpr_write_b32 a83, v165
  v_accvgpr_read_b32 v48, a232
  v_accvgpr_read_b32 v49, a233
  v_accvgpr_read_b32 v50, a234
  v_accvgpr_read_b32 v51, a235
  v_accvgpr_read_b32 v60, a244
  v_accvgpr_read_b32 v61, a245
  v_accvgpr_read_b32 v62, a246
  v_accvgpr_read_b32 v63, a247
  v_pk_mul_f32 v[48:49], v[48:49], v[220:221]
  v_pk_mul_f32 v[50:51], v[50:51], v[220:221]
  v_pk_mul_f32 v[60:61], v[60:61], v[220:221]
  v_pk_mul_f32 v[62:63], v[62:63], v[220:221]
  v_cvt_pk_bf16_f32 v48, v48, v49
  v_cvt_pk_bf16_f32 v49, v50, v51
  v_cvt_pk_bf16_f32 v60, v60, v61
  v_cvt_pk_bf16_f32 v61, v62, v63
  v_accvgpr_write_b32 a84, v0
  v_accvgpr_write_b32 a85, v1
  v_accvgpr_write_b32 a86, v12
  v_accvgpr_write_b32 a87, v13
  v_accvgpr_write_b32 a88, v24
  v_accvgpr_write_b32 a89, v25
  v_accvgpr_write_b32 a90, v36
  v_accvgpr_write_b32 a91, v37
  v_accvgpr_write_b32 a92, v48
  v_accvgpr_write_b32 a93, v49
  v_accvgpr_write_b32 a94, v60
  v_accvgpr_write_b32 a95, v61
  s_waitcnt lgkmcnt(8)
  v_mfma_f32_16x16x32_bf16 v[0:3], a[192:195], a[96:99], 0
  s_waitcnt vmcnt(63)
  ds_read_b64_tr_b16 a[212:213], v239 offset:4096
  v_mfma_f32_16x16x32_bf16 v[4:7], a[192:195], a[100:103], 0
  s_barrier
  ds_read_b64_tr_b16 a[214:215], v239 offset:6144
  v_mfma_f32_16x16x32_bf16 v[8:11], a[192:195], a[104:107], 0
  s_waitcnt lgkmcnt(8)
  v_mfma_f32_16x16x32_bf16 v[12:15], a[196:199], a[96:99], 0
  s_add_u32 m0, s28, 81920
  ds_read_b64_tr_b16 a[216:217], v228 offset:4352
  v_mfma_f32_16x16x32_bf16 v[16:19], a[196:199], a[100:103], 0
  s_add_u32 s29, s54, 0
  buffer_load_dwordx4 v232, s[24:27], s29 offen offset:0 lds
  v_mfma_f32_16x16x32_bf16 v[20:23], a[196:199], a[104:107], 0
  s_waitcnt lgkmcnt(7)
  ds_read_b64_tr_b16 a[218:219], v228 offset:6400
  v_mfma_f32_16x16x32_bf16 v[24:27], a[200:203], a[96:99], 0
  s_add_u32 s29, s29, s31
  ds_read_b64_tr_b16 a[220:221], v239 offset:4352
  v_mfma_f32_16x16x32_bf16 v[28:31], a[200:203], a[100:103], 0
  ds_read_b64_tr_b16 a[222:223], v239 offset:6400
  v_mfma_f32_16x16x32_bf16 v[32:35], a[200:203], a[104:107], 0
  s_waitcnt lgkmcnt(8)
  v_mfma_f32_16x16x32_bf16 v[36:39], a[204:207], a[96:99], 0
  ds_read_b64_tr_b16 a[192:193], v228 offset:8192
  v_mfma_f32_16x16x32_bf16 v[40:43], a[204:207], a[100:103], 0
  buffer_load_dwordx4 v232, s[24:27], s29 offen offset:1024 lds
  v_mfma_f32_16x16x32_bf16 v[44:47], a[204:207], a[104:107], 0
  s_waitcnt lgkmcnt(7)
  ds_read_b64_tr_b16 a[194:195], v228 offset:10240
  v_mfma_f32_16x16x32_bf16 v[0:3], a[208:211], a[108:111], v[0:3]
  s_add_u32 s29, s29, s31
  ds_read_b64_tr_b16 a[196:197], v239 offset:8192
  v_mfma_f32_16x16x32_bf16 v[4:7], a[208:211], a[112:115], v[4:7]
  ds_read_b64_tr_b16 a[198:199], v239 offset:10240
  v_mfma_f32_16x16x32_bf16 v[8:11], a[208:211], a[116:119], v[8:11]
  s_waitcnt lgkmcnt(8)
  v_mfma_f32_16x16x32_bf16 v[12:15], a[212:215], a[108:111], v[12:15]
  ds_read_b64_tr_b16 a[200:201], v228 offset:8448
  v_mfma_f32_16x16x32_bf16 v[16:19], a[212:215], a[112:115], v[16:19]
  buffer_load_dwordx4 v232, s[24:27], s29 offen offset:2048 lds
  v_mfma_f32_16x16x32_bf16 v[20:23], a[212:215], a[116:119], v[20:23]
  s_waitcnt lgkmcnt(7)
  ds_read_b64_tr_b16 a[202:203], v228 offset:10496
  v_mfma_f32_16x16x32_bf16 v[24:27], a[216:219], a[108:111], v[24:27]
  s_add_u32 s29, s29, s31
  ds_read_b64_tr_b16 a[204:205], v239 offset:8448
  v_mfma_f32_16x16x32_bf16 v[28:31], a[216:219], a[112:115], v[28:31]
  ds_read_b64_tr_b16 a[206:207], v239 offset:10496
  v_mfma_f32_16x16x32_bf16 v[32:35], a[216:219], a[116:119], v[32:35]
  s_waitcnt lgkmcnt(8)
  v_mfma_f32_16x16x32_bf16 v[36:39], a[220:223], a[108:111], v[36:39]
  ds_read_b64_tr_b16 a[208:209], v228 offset:12288
  v_mfma_f32_16x16x32_bf16 v[40:43], a[220:223], a[112:115], v[40:43]
  buffer_load_dwordx4 v232, s[24:27], s29 offen offset:3072 lds
  v_mfma_f32_16x16x32_bf16 v[44:47], a[220:223], a[116:119], v[44:47]
  s_waitcnt lgkmcnt(7)
  ds_read_b64_tr_b16 a[210:211], v228 offset:14336
  v_mfma_f32_16x16x32_bf16 v[0:3], a[192:195], a[120:123], v[0:3]
  s_add_u32 m0, s28, 0
  ds_read_b64_tr_b16 a[212:213], v239 offset:12288
  v_mfma_f32_16x16x32_bf16 v[4:7], a[192:195], a[124:127], v[4:7]
  s_add_u32 s29, s54, 114688
  ds_read_b64_tr_b16 a[214:215], v239 offset:14336
  v_mfma_f32_16x16x32_bf16 v[8:11], a[192:195], a[128:131], v[8:11]
  s_waitcnt lgkmcnt(8)
  v_mfma_f32_16x16x32_bf16 v[12:15], a[196:199], a[120:123], v[12:15]
  ds_read_b64_tr_b16 a[216:217], v228 offset:12544
  v_mfma_f32_16x16x32_bf16 v[16:19], a[196:199], a[124:127], v[16:19]
  buffer_load_dwordx4 v232, s[24:27], s29 offen offset:0 lds
  v_mfma_f32_16x16x32_bf16 v[20:23], a[196:199], a[128:131], v[20:23]
  s_waitcnt lgkmcnt(7)
  ds_read_b64_tr_b16 a[218:219], v228 offset:14592
  v_mfma_f32_16x16x32_bf16 v[24:27], a[200:203], a[120:123], v[24:27]
  s_add_u32 s29, s29, s31
  ds_read_b64_tr_b16 a[220:221], v239 offset:12544
  v_mfma_f32_16x16x32_bf16 v[28:31], a[200:203], a[124:127], v[28:31]
  ds_read_b64_tr_b16 a[222:223], v239 offset:14592
  v_add_u32 v228, 147456, v229
  v_mfma_f32_16x16x32_bf16 v[32:35], a[200:203], a[128:131], v[32:35]
  s_waitcnt lgkmcnt(8)
  v_xor_b32 v239, 32, v228
  v_mfma_f32_16x16x32_bf16 v[36:39], a[204:207], a[120:123], v[36:39]
  ds_read_b64_tr_b16 a[192:193], v228 offset:0
  v_mfma_f32_16x16x32_bf16 v[40:43], a[204:207], a[124:127], v[40:43]
  buffer_load_dwordx4 v232, s[24:27], s29 offen offset:1024 lds
  v_mfma_f32_16x16x32_bf16 v[44:47], a[204:207], a[128:131], v[44:47]
  s_waitcnt lgkmcnt(7)
  ds_read_b64_tr_b16 a[194:195], v228 offset:2048
  v_mfma_f32_16x16x32_bf16 v[0:3], a[208:211], a[132:135], v[0:3]
  s_add_u32 s29, s29, s31
  ds_read_b64_tr_b16 a[196:197], v239 offset:0
  v_mfma_f32_16x16x32_bf16 v[4:7], a[208:211], a[136:139], v[4:7]
  ds_read_b64_tr_b16 a[198:199], v239 offset:2048
  v_mfma_f32_16x16x32_bf16 v[8:11], a[208:211], a[140:143], v[8:11]
  s_waitcnt lgkmcnt(8)
  v_mfma_f32_16x16x32_bf16 v[12:15], a[212:215], a[132:135], v[12:15]
  ds_read_b64_tr_b16 a[200:201], v228 offset:256
  v_mfma_f32_16x16x32_bf16 v[16:19], a[212:215], a[136:139], v[16:19]
  buffer_load_dwordx4 v232, s[24:27], s29 offen offset:2048 lds
  v_mfma_f32_16x16x32_bf16 v[20:23], a[212:215], a[140:143], v[20:23]
  s_waitcnt lgkmcnt(7)
  ds_read_b64_tr_b16 a[202:203], v228 offset:2304
  v_mfma_f32_16x16x32_bf16 v[24:27], a[216:219], a[132:135], v[24:27]
  s_add_u32 s29, s29, s31
  ds_read_b64_tr_b16 a[204:205], v239 offset:256
  v_mfma_f32_16x16x32_bf16 v[28:31], a[216:219], a[136:139], v[28:31]
  ds_read_b64_tr_b16 a[206:207], v239 offset:2304
  v_mfma_f32_16x16x32_bf16 v[32:35], a[216:219], a[140:143], v[32:35]
  s_waitcnt lgkmcnt(8)
  v_mfma_f32_16x16x32_bf16 v[36:39], a[220:223], a[132:135], v[36:39]
  ds_read_b64_tr_b16 a[208:209], v228 offset:4096
  v_mfma_f32_16x16x32_bf16 v[40:43], a[220:223], a[136:139], v[40:43]
  buffer_load_dwordx4 v232, s[24:27], s29 offen offset:3072 lds
  v_mfma_f32_16x16x32_bf16 v[44:47], a[220:223], a[140:143], v[44:47]
  s_waitcnt lgkmcnt(7)
  ds_read_b64_tr_b16 a[210:211], v228 offset:6144
  v_mfma_f32_16x16x32_bf16 v[0:3], a[192:195], a[144:147], v[0:3]
  s_waitcnt vmcnt(63)
  ds_read_b64_tr_b16 a[212:213], v239 offset:4096
  v_mfma_f32_16x16x32_bf16 v[4:7], a[192:195], a[148:151], v[4:7]
  s_barrier
  ds_read_b64_tr_b16 a[214:215], v239 offset:6144
  v_mfma_f32_16x16x32_bf16 v[8:11], a[192:195], a[152:155], v[8:11]
  s_waitcnt lgkmcnt(8)
  v_mfma_f32_16x16x32_bf16 v[12:15], a[196:199], a[144:147], v[12:15]
  s_add_u32 m0, s28, 32768
  ds_read_b64_tr_b16 a[216:217], v228 offset:4352
  v_mfma_f32_16x16x32_bf16 v[16:19], a[196:199], a[148:151], v[16:19]
  s_add_u32 s29, s54, 229376
  ds_read_b64_tr_b16 a[218:219], v228 offset:6400
  v_mfma_f32_16x16x32_bf16 v[20:23], a[196:199], a[152:155], v[20:23]
  s_waitcnt lgkmcnt(8)
  v_mfma_f32_16x16x32_bf16 v[24:27], a[200:203], a[144:147], v[24:27]
  ds_read_b64_tr_b16 a[220:221], v239 offset:4352
  v_mfma_f32_16x16x32_bf16 v[28:31], a[200:203], a[148:151], v[28:31]
  buffer_load_dwordx4 v232, s[24:27], s29 offen offset:0 lds
  v_mfma_f32_16x16x32_bf16 v[32:35], a[200:203], a[152:155], v[32:35]
  s_waitcnt lgkmcnt(7)
  ds_read_b64_tr_b16 a[222:223], v239 offset:6400
  v_mfma_f32_16x16x32_bf16 v[36:39], a[204:207], a[144:147], v[36:39]
  s_add_u32 s29, s29, s31
  ds_read_b64_tr_b16 a[192:193], v228 offset:8192
  v_mfma_f32_16x16x32_bf16 v[40:43], a[204:207], a[148:151], v[40:43]
  ds_read_b64_tr_b16 a[194:195], v228 offset:10240
  v_mfma_f32_16x16x32_bf16 v[44:47], a[204:207], a[152:155], v[44:47]
  s_waitcnt lgkmcnt(8)
  v_mfma_f32_16x16x32_bf16 v[0:3], a[208:211], a[156:159], v[0:3]
  ds_read_b64_tr_b16 a[196:197], v239 offset:8192
  v_mfma_f32_16x16x32_bf16 v[4:7], a[208:211], a[160:163], v[4:7]
  ds_read_b64_tr_b16 a[198:199], v239 offset:10240
  v_mfma_f32_16x16x32_bf16 v[8:11], a[208:211], a[164:167], v[8:11]
  s_waitcnt lgkmcnt(8)
  v_mfma_f32_16x16x32_bf16 v[12:15], a[212:215], a[156:159], v[12:15]
  ds_read_b64_tr_b16 a[200:201], v228 offset:8448
  v_mfma_f32_16x16x32_bf16 v[16:19], a[212:215], a[160:163], v[16:19]
  ds_read_b64_tr_b16 a[202:203], v228 offset:10496
  v_mfma_f32_16x16x32_bf16 v[20:23], a[212:215], a[164:167], v[20:23]
  s_waitcnt lgkmcnt(8)
  v_mfma_f32_16x16x32_bf16 v[24:27], a[216:219], a[156:159], v[24:27]
  ds_read_b64_tr_b16 a[204:205], v239 offset:8448
  v_mfma_f32_16x16x32_bf16 v[28:31], a[216:219], a[160:163], v[28:31]
  buffer_load_dwordx4 v232, s[24:27], s29 offen offset:1024 lds
  v_mfma_f32_16x16x32_bf16 v[32:35], a[216:219], a[164:167], v[32:35]
  s_waitcnt lgkmcnt(7)
  ds_read_b64_tr_b16 a[206:207], v239 offset:10496
  v_mfma_f32_16x16x32_bf16 v[36:39], a[220:223], a[156:159], v[36:39]
  s_add_u32 s29, s29, s31
  ds_read_b64_tr_b16 a[208:209], v228 offset:12288
  v_mfma_f32_16x16x32_bf16 v[40:43], a[220:223], a[160:163], v[40:43]
  ds_read_b64_tr_b16 a[210:211], v228 offset:14336
  v_mfma_f32_16x16x32_bf16 v[44:47], a[220:223], a[164:167], v[44:47]
  s_waitcnt lgkmcnt(8)
  v_mfma_f32_16x16x32_bf16 v[0:3], a[192:195], a[168:171], v[0:3]
  ds_read_b64_tr_b16 a[212:213], v239 offset:12288
  v_mfma_f32_16x16x32_bf16 v[4:7], a[192:195], a[172:175], v[4:7]
  ds_read_b64_tr_b16 a[214:215], v239 offset:14336
  v_mfma_f32_16x16x32_bf16 v[8:11], a[192:195], a[176:179], v[8:11]
  s_waitcnt lgkmcnt(8)
  v_mfma_f32_16x16x32_bf16 v[12:15], a[196:199], a[168:171], v[12:15]
  ds_read_b64_tr_b16 a[216:217], v228 offset:12544
  v_mfma_f32_16x16x32_bf16 v[16:19], a[196:199], a[172:175], v[16:19]
  ds_read_b64_tr_b16 a[218:219], v228 offset:14592
  v_mfma_f32_16x16x32_bf16 v[20:23], a[196:199], a[176:179], v[20:23]
  s_waitcnt lgkmcnt(8)
  v_mfma_f32_16x16x32_bf16 v[24:27], a[200:203], a[168:171], v[24:27]
  ds_read_b64_tr_b16 a[220:221], v239 offset:12544
  v_mfma_f32_16x16x32_bf16 v[28:31], a[200:203], a[172:175], v[28:31]
  buffer_load_dwordx4 v232, s[24:27], s29 offen offset:2048 lds
  v_mfma_f32_16x16x32_bf16 v[32:35], a[200:203], a[176:179], v[32:35]
  s_waitcnt lgkmcnt(7)
  ds_read_b64_tr_b16 a[222:223], v239 offset:14592
  v_add_u32 v228, 49152, v229
  v_mfma_f32_16x16x32_bf16 v[36:39], a[204:207], a[168:171], v[36:39]
  s_add_u32 s29, s29, s31
  ds_read_b64_tr_b16 a[192:193], v228 offset:0
  v_xor_b32 v239, 32, v228
  v_mfma_f32_16x16x32_bf16 v[40:43], a[204:207], a[172:175], v[40:43]
  ds_read_b64_tr_b16 a[194:195], v228 offset:2048
  v_mfma_f32_16x16x32_bf16 v[44:47], a[204:207], a[176:179], v[44:47]
  s_waitcnt lgkmcnt(8)
  v_mfma_f32_16x16x32_bf16 v[0:3], a[208:211], a[180:183], v[0:3]
  ds_read_b64_tr_b16 a[196:197], v239 offset:0
  v_mfma_f32_16x16x32_bf16 v[4:7], a[208:211], a[184:187], v[4:7]
  ds_read_b64_tr_b16 a[198:199], v239 offset:2048
  v_mfma_f32_16x16x32_bf16 v[8:11], a[208:211], a[188:191], v[8:11]
  s_waitcnt lgkmcnt(8)
  v_mfma_f32_16x16x32_bf16 v[12:15], a[212:215], a[180:183], v[12:15]
  ds_read_b64_tr_b16 a[200:201], v228 offset:256
  v_mfma_f32_16x16x32_bf16 v[16:19], a[212:215], a[184:187], v[16:19]
  ds_read_b64_tr_b16 a[202:203], v228 offset:2304
  v_mfma_f32_16x16x32_bf16 v[20:23], a[212:215], a[188:191], v[20:23]
  s_waitcnt lgkmcnt(8)
  v_mfma_f32_16x16x32_bf16 v[24:27], a[216:219], a[180:183], v[24:27]
  ds_read_b64_tr_b16 a[204:205], v239 offset:256
  v_mfma_f32_16x16x32_bf16 v[28:31], a[216:219], a[184:187], v[28:31]
  buffer_load_dwordx4 v232, s[24:27], s29 offen offset:3072 lds
  v_mfma_f32_16x16x32_bf16 v[32:35], a[216:219], a[188:191], v[32:35]
  s_waitcnt lgkmcnt(7)
  ds_read_b64_tr_b16 a[206:207], v239 offset:2304
  v_mfma_f32_16x16x32_bf16 v[36:39], a[220:223], a[180:183], v[36:39]
  ds_read_b64_tr_b16 a[208:209], v228 offset:4096
  v_mfma_f32_16x16x32_bf16 v[40:43], a[220:223], a[184:187], v[40:43]
  ds_read_b64_tr_b16 a[210:211], v228 offset:6144
  v_mfma_f32_16x16x32_bf16 v[44:47], a[220:223], a[188:191], v[44:47]
  s_waitcnt lgkmcnt(8)
  v_mfma_f32_16x16x32_bf16 v[0:3], a[192:195], a[0:3], v[0:3]
  s_waitcnt vmcnt(63)
  ds_read_b64_tr_b16 a[212:213], v239 offset:4096
  v_mfma_f32_16x16x32_bf16 v[4:7], a[192:195], a[4:7], v[4:7]
  s_barrier
  ds_read_b64_tr_b16 a[214:215], v239 offset:6144
  v_mfma_f32_16x16x32_bf16 v[8:11], a[192:195], a[8:11], v[8:11]
  s_waitcnt lgkmcnt(8)
  v_mfma_f32_16x16x32_bf16 v[12:15], a[196:199], a[0:3], v[12:15]
  s_add_u32 m0, s28, 147456
  ds_read_b64_tr_b16 a[216:217], v228 offset:4352
  v_mfma_f32_16x16x32_bf16 v[16:19], a[196:199], a[4:7], v[16:19]
  s_add_u32 s29, s54, 344064
  ds_read_b64_tr_b16 a[218:219], v228 offset:6400
  v_mfma_f32_16x16x32_bf16 v[20:23], a[196:199], a[8:11], v[20:23]
  s_waitcnt lgkmcnt(8)
  v_mfma_f32_16x16x32_bf16 v[24:27], a[200:203], a[0:3], v[24:27]
  ds_read_b64_tr_b16 a[220:221], v239 offset:4352
  v_mfma_f32_16x16x32_bf16 v[28:31], a[200:203], a[4:7], v[28:31]
  buffer_load_dwordx4 v232, s[24:27], s29 offen offset:0 lds
  v_mfma_f32_16x16x32_bf16 v[32:35], a[200:203], a[8:11], v[32:35]
  s_waitcnt lgkmcnt(7)
  ds_read_b64_tr_b16 a[222:223], v239 offset:6400
  v_mfma_f32_16x16x32_bf16 v[36:39], a[204:207], a[0:3], v[36:39]
  s_add_u32 s29, s29, s31
  ds_read_b64_tr_b16 a[192:193], v228 offset:8192
  v_mfma_f32_16x16x32_bf16 v[40:43], a[204:207], a[4:7], v[40:43]
  ds_read_b64_tr_b16 a[194:195], v228 offset:10240
  v_mfma_f32_16x16x32_bf16 v[44:47], a[204:207], a[8:11], v[44:47]
  s_waitcnt lgkmcnt(8)
  v_mfma_f32_16x16x32_bf16 v[0:3], a[208:211], a[12:15], v[0:3]
  ds_read_b64_tr_b16 a[196:197], v239 offset:8192
  v_mfma_f32_16x16x32_bf16 v[4:7], a[208:211], a[16:19], v[4:7]
  ds_read_b64_tr_b16 a[198:199], v239 offset:10240
  v_mfma_f32_16x16x32_bf16 v[8:11], a[208:211], a[20:23], v[8:11]
  s_waitcnt lgkmcnt(8)
  v_mfma_f32_16x16x32_bf16 v[12:15], a[212:215], a[12:15], v[12:15]
  ds_read_b64_tr_b16 a[200:201], v228 offset:8448
  v_mfma_f32_16x16x32_bf16 v[16:19], a[212:215], a[16:19], v[16:19]
  ds_read_b64_tr_b16 a[202:203], v228 offset:10496
  v_mfma_f32_16x16x32_bf16 v[20:23], a[212:215], a[20:23], v[20:23]
  s_waitcnt lgkmcnt(8)
  v_mfma_f32_16x16x32_bf16 v[24:27], a[216:219], a[12:15], v[24:27]
  ds_read_b64_tr_b16 a[204:205], v239 offset:8448
  v_mfma_f32_16x16x32_bf16 v[28:31], a[216:219], a[16:19], v[28:31]
  buffer_load_dwordx4 v232, s[24:27], s29 offen offset:1024 lds
  v_mfma_f32_16x16x32_bf16 v[32:35], a[216:219], a[20:23], v[32:35]
  s_waitcnt lgkmcnt(7)
  ds_read_b64_tr_b16 a[206:207], v239 offset:10496
  v_mfma_f32_16x16x32_bf16 v[36:39], a[220:223], a[12:15], v[36:39]
  s_add_u32 s29, s29, s31
  ds_read_b64_tr_b16 a[208:209], v228 offset:12288
  v_mfma_f32_16x16x32_bf16 v[40:43], a[220:223], a[16:19], v[40:43]
  ds_read_b64_tr_b16 a[210:211], v228 offset:14336
  v_mfma_f32_16x16x32_bf16 v[44:47], a[220:223], a[20:23], v[44:47]
  s_waitcnt lgkmcnt(8)
  v_mfma_f32_16x16x32_bf16 v[0:3], a[192:195], a[24:27], v[0:3]
  ds_read_b64_tr_b16 a[212:213], v239 offset:12288
  v_mfma_f32_16x16x32_bf16 v[4:7], a[192:195], a[28:31], v[4:7]
  ds_read_b64_tr_b16 a[214:215], v239 offset:14336
  v_mfma_f32_16x16x32_bf16 v[8:11], a[192:195], a[32:35], v[8:11]
  s_waitcnt lgkmcnt(8)
  v_mfma_f32_16x16x32_bf16 v[12:15], a[196:199], a[24:27], v[12:15]
  ds_read_b64_tr_b16 a[216:217], v228 offset:12544
  v_mfma_f32_16x16x32_bf16 v[16:19], a[196:199], a[28:31], v[16:19]
  ds_read_b64_tr_b16 a[218:219], v228 offset:14592
  v_mfma_f32_16x16x32_bf16 v[20:23], a[196:199], a[32:35], v[20:23]
  s_waitcnt lgkmcnt(8)
  v_mfma_f32_16x16x32_bf16 v[24:27], a[200:203], a[24:27], v[24:27]
  ds_read_b64_tr_b16 a[220:221], v239 offset:12544
  v_mfma_f32_16x16x32_bf16 v[28:31], a[200:203], a[28:31], v[28:31]
  buffer_load_dwordx4 v232, s[24:27], s29 offen offset:2048 lds
  v_mfma_f32_16x16x32_bf16 v[32:35], a[200:203], a[32:35], v[32:35]
  s_waitcnt lgkmcnt(7)
  ds_read_b64_tr_b16 a[222:223], v239 offset:14592
  v_add_u32 v228, 131072, v229
  v_mfma_f32_16x16x32_bf16 v[36:39], a[204:207], a[24:27], v[36:39]
  s_add_u32 s29, s29, s31
  ds_read_b64_tr_b16 a[192:193], v228 offset:0
  v_xor_b32 v239, 32, v228
  v_mfma_f32_16x16x32_bf16 v[40:43], a[204:207], a[28:31], v[40:43]
  ds_read_b64_tr_b16 a[194:195], v228 offset:2048
  v_mfma_f32_16x16x32_bf16 v[44:47], a[204:207], a[32:35], v[44:47]
  s_waitcnt lgkmcnt(8)
  v_mfma_f32_16x16x32_bf16 v[0:3], a[208:211], a[36:39], v[0:3]
  ds_read_b64_tr_b16 a[196:197], v239 offset:0
  v_mfma_f32_16x16x32_bf16 v[4:7], a[208:211], a[40:43], v[4:7]
  ds_read_b64_tr_b16 a[198:199], v239 offset:2048
  v_mfma_f32_16x16x32_bf16 v[8:11], a[208:211], a[44:47], v[8:11]
  s_waitcnt lgkmcnt(8)
  v_mfma_f32_16x16x32_bf16 v[12:15], a[212:215], a[36:39], v[12:15]
  ds_read_b64_tr_b16 a[200:201], v228 offset:256
  v_mfma_f32_16x16x32_bf16 v[16:19], a[212:215], a[40:43], v[16:19]
  ds_read_b64_tr_b16 a[202:203], v228 offset:2304
  v_mfma_f32_16x16x32_bf16 v[20:23], a[212:215], a[44:47], v[20:23]
  s_waitcnt lgkmcnt(8)
  v_mfma_f32_16x16x32_bf16 v[24:27], a[216:219], a[36:39], v[24:27]
  ds_read_b64_tr_b16 a[204:205], v239 offset:256
  v_mfma_f32_16x16x32_bf16 v[28:31], a[216:219], a[40:43], v[28:31]
  buffer_load_dwordx4 v232, s[24:27], s29 offen offset:3072 lds
  v_mfma_f32_16x16x32_bf16 v[32:35], a[216:219], a[44:47], v[32:35]
  s_waitcnt lgkmcnt(7)
  ds_read_b64_tr_b16 a[206:207], v239 offset:2304
  v_mfma_f32_16x16x32_bf16 v[36:39], a[220:223], a[36:39], v[36:39]
  ds_read_b64_tr_b16 a[208:209], v228 offset:4096
  v_mfma_f32_16x16x32_bf16 v[40:43], a[220:223], a[40:43], v[40:43]
  ds_read_b64_tr_b16 a[210:211], v228 offset:6144
  v_mfma_f32_16x16x32_bf16 v[44:47], a[220:223], a[44:47], v[44:47]
  s_waitcnt lgkmcnt(8)
  v_mfma_f32_16x16x32_bf16 v[0:3], a[192:195], a[48:51], v[0:3]
  s_waitcnt vmcnt(63)
  ds_read_b64_tr_b16 a[212:213], v239 offset:4096
  v_mfma_f32_16x16x32_bf16 v[4:7], a[192:195], a[52:55], v[4:7]
  s_barrier
  ds_read_b64_tr_b16 a[214:215], v239 offset:6144
  v_mfma_f32_16x16x32_bf16 v[8:11], a[192:195], a[56:59], v[8:11]
  s_waitcnt lgkmcnt(8)
  v_mfma_f32_16x16x32_bf16 v[12:15], a[196:199], a[48:51], v[12:15]
  s_add_u32 m0, s28, 49152
  ds_read_b64_tr_b16 a[216:217], v228 offset:4352
  v_mfma_f32_16x16x32_bf16 v[16:19], a[196:199], a[52:55], v[16:19]
  s_add_u32 s29, s55, 0
  ds_read_b64_tr_b16 a[218:219], v228 offset:6400
  v_mfma_f32_16x16x32_bf16 v[20:23], a[196:199], a[56:59], v[20:23]
  s_waitcnt lgkmcnt(8)
  v_mfma_f32_16x16x32_bf16 v[24:27], a[200:203], a[48:51], v[24:27]
  ds_read_b64_tr_b16 a[220:221], v239 offset:4352
  v_mfma_f32_16x16x32_bf16 v[28:31], a[200:203], a[52:55], v[28:31]
  buffer_load_dwordx4 v232, s[24:27], s29 offen offset:0 lds
  v_mfma_f32_16x16x32_bf16 v[32:35], a[200:203], a[56:59], v[32:35]
  s_waitcnt lgkmcnt(7)
  ds_read_b64_tr_b16 a[222:223], v239 offset:6400
  v_mfma_f32_16x16x32_bf16 v[36:39], a[204:207], a[48:51], v[36:39]
  s_add_u32 s29, s29, s31
  ds_read_b64_tr_b16 a[192:193], v228 offset:8192
  v_mfma_f32_16x16x32_bf16 v[40:43], a[204:207], a[52:55], v[40:43]
  ds_read_b64_tr_b16 a[194:195], v228 offset:10240
  v_mfma_f32_16x16x32_bf16 v[44:47], a[204:207], a[56:59], v[44:47]
  s_waitcnt lgkmcnt(8)
  v_mfma_f32_16x16x32_bf16 v[0:3], a[208:211], a[60:63], v[0:3]
  ds_read_b64_tr_b16 a[196:197], v239 offset:8192
  v_mfma_f32_16x16x32_bf16 v[4:7], a[208:211], a[64:67], v[4:7]
  ds_read_b64_tr_b16 a[198:199], v239 offset:10240
  v_mfma_f32_16x16x32_bf16 v[8:11], a[208:211], a[68:71], v[8:11]
  s_waitcnt lgkmcnt(8)
  v_mfma_f32_16x16x32_bf16 v[12:15], a[212:215], a[60:63], v[12:15]
  ds_read_b64_tr_b16 a[200:201], v228 offset:8448
  v_mfma_f32_16x16x32_bf16 v[16:19], a[212:215], a[64:67], v[16:19]
  ds_read_b64_tr_b16 a[202:203], v228 offset:10496
  v_mfma_f32_16x16x32_bf16 v[20:23], a[212:215], a[68:71], v[20:23]
  s_waitcnt lgkmcnt(8)
  v_mfma_f32_16x16x32_bf16 v[24:27], a[216:219], a[60:63], v[24:27]
  ds_read_b64_tr_b16 a[204:205], v239 offset:8448
  v_mfma_f32_16x16x32_bf16 v[28:31], a[216:219], a[64:67], v[28:31]
  buffer_load_dwordx4 v232, s[24:27], s29 offen offset:1024 lds
  v_mfma_f32_16x16x32_bf16 v[32:35], a[216:219], a[68:71], v[32:35]
  s_waitcnt lgkmcnt(7)
  ds_read_b64_tr_b16 a[206:207], v239 offset:10496
  v_mfma_f32_16x16x32_bf16 v[36:39], a[220:223], a[60:63], v[36:39]
  s_add_u32 s29, s29, s31
  ds_read_b64_tr_b16 a[208:209], v228 offset:12288
  v_mfma_f32_16x16x32_bf16 v[40:43], a[220:223], a[64:67], v[40:43]
  ds_read_b64_tr_b16 a[210:211], v228 offset:14336
  v_mfma_f32_16x16x32_bf16 v[44:47], a[220:223], a[68:71], v[44:47]
  s_waitcnt lgkmcnt(8)
  v_mfma_f32_16x16x32_bf16 v[0:3], a[192:195], a[72:75], v[0:3]
  ds_read_b64_tr_b16 a[212:213], v239 offset:12288
  v_mfma_f32_16x16x32_bf16 v[4:7], a[192:195], a[76:79], v[4:7]
  ds_read_b64_tr_b16 a[214:215], v239 offset:14336
  v_mfma_f32_16x16x32_bf16 v[8:11], a[192:195], a[80:83], v[8:11]
  s_waitcnt lgkmcnt(8)
  v_mfma_f32_16x16x32_bf16 v[12:15], a[196:199], a[72:75], v[12:15]
  ds_read_b64_tr_b16 a[216:217], v228 offset:12544
  v_mfma_f32_16x16x32_bf16 v[16:19], a[196:199], a[76:79], v[16:19]
  ds_read_b64_tr_b16 a[218:219], v228 offset:14592
  v_mfma_f32_16x16x32_bf16 v[20:23], a[196:199], a[80:83], v[20:23]
  s_waitcnt lgkmcnt(8)
  v_mfma_f32_16x16x32_bf16 v[24:27], a[200:203], a[72:75], v[24:27]
  ds_read_b64_tr_b16 a[220:221], v239 offset:12544
  v_mfma_f32_16x16x32_bf16 v[28:31], a[200:203], a[76:79], v[28:31]
  buffer_load_dwordx4 v232, s[24:27], s29 offen offset:2048 lds
  v_mfma_f32_16x16x32_bf16 v[32:35], a[200:203], a[80:83], v[32:35]
  s_waitcnt lgkmcnt(7)
  ds_read_b64_tr_b16 a[222:223], v239 offset:14592
  v_add_u32 v228, 65536, v229
  v_mfma_f32_16x16x32_bf16 v[36:39], a[204:207], a[72:75], v[36:39]
  s_add_u32 s29, s29, s31
  ds_read_b64_tr_b16 a[192:193], v228 offset:0
  v_xor_b32 v239, 32, v228
  v_mfma_f32_16x16x32_bf16 v[40:43], a[204:207], a[76:79], v[40:43]
  ds_read_b64_tr_b16 a[194:195], v228 offset:2048
  v_mfma_f32_16x16x32_bf16 v[44:47], a[204:207], a[80:83], v[44:47]
  s_waitcnt lgkmcnt(8)
  v_mfma_f32_16x16x32_bf16 v[48:51], a[208:211], a[84:87], v[0:3]
  ds_read_b64_tr_b16 a[196:197], v239 offset:0
  v_mfma_f32_16x16x32_bf16 v[52:55], a[208:211], a[88:91], v[4:7]
  ds_read_b64_tr_b16 a[198:199], v239 offset:2048
  v_mfma_f32_16x16x32_bf16 v[56:59], a[208:211], a[92:95], v[8:11]
  s_waitcnt lgkmcnt(8)
  v_mfma_f32_16x16x32_bf16 v[60:63], a[212:215], a[84:87], v[12:15]
  ds_read_b64_tr_b16 a[200:201], v228 offset:256
  v_mfma_f32_16x16x32_bf16 v[64:67], a[212:215], a[88:91], v[16:19]
  ds_read_b64_tr_b16 a[202:203], v228 offset:2304
  v_mfma_f32_16x16x32_bf16 v[68:71], a[212:215], a[92:95], v[20:23]
  s_waitcnt lgkmcnt(8)
  v_mfma_f32_16x16x32_bf16 v[72:75], a[216:219], a[84:87], v[24:27]
  ds_read_b64_tr_b16 a[204:205], v239 offset:256
  v_mfma_f32_16x16x32_bf16 v[76:79], a[216:219], a[88:91], v[28:31]
  buffer_load_dwordx4 v232, s[24:27], s29 offen offset:3072 lds
  v_mfma_f32_16x16x32_bf16 v[80:83], a[216:219], a[92:95], v[32:35]
  s_waitcnt lgkmcnt(7)
  ds_read_b64_tr_b16 a[206:207], v239 offset:2304
  v_mfma_f32_16x16x32_bf16 v[84:87], a[220:223], a[84:87], v[36:39]
  ds_read_b64_tr_b16 a[208:209], v228 offset:4096
  v_mfma_f32_16x16x32_bf16 v[88:91], a[220:223], a[88:91], v[40:43]
  ds_read_b64_tr_b16 a[210:211], v228 offset:6144
  v_mfma_f32_16x16x32_bf16 v[92:95], a[220:223], a[92:95], v[44:47]
  s_waitcnt lgkmcnt(8)
  v_mfma_f32_16x16x32_bf16 v[0:3], a[192:195], a[96:99], 0
  s_waitcnt vmcnt(28)
  ds_read_b64_tr_b16 a[212:213], v239 offset:4096
  v_mfma_f32_16x16x32_bf16 v[4:7], a[192:195], a[100:103], 0
  s_barrier
  ds_read_b64_tr_b16 a[214:215], v239 offset:6144
  v_mfma_f32_16x16x32_bf16 v[8:11], a[192:195], a[104:107], 0
  s_waitcnt lgkmcnt(8)
  v_mfma_f32_16x16x32_bf16 v[12:15], a[196:199], a[96:99], 0
  s_add_u32 m0, s28, 131072
  ds_read_b64_tr_b16 a[216:217], v228 offset:4352
  v_cvt_pk_bf16_f32 v96, v48, v49
  v_mfma_f32_16x16x32_bf16 v[16:19], a[196:199], a[100:103], 0
  s_add_u32 s29, s55, 114688
  ds_read_b64_tr_b16 a[218:219], v228 offset:6400
  v_cvt_pk_bf16_f32 v97, v50, v51
  v_mfma_f32_16x16x32_bf16 v[20:23], a[196:199], a[104:107], 0
  s_waitcnt lgkmcnt(8)
  v_cvt_pk_bf16_f32 v98, v60, v61
  v_cvt_pk_bf16_f32 v99, v62, v63
  v_mfma_f32_16x16x32_bf16 v[24:27], a[200:203], a[96:99], 0
  s_mul_i32 s50, s52, 192
  ds_read_b64_tr_b16 a[220:221], v239 offset:4352
  v_cvt_pk_bf16_f32 v100, v72, v73
  v_mfma_f32_16x16x32_bf16 v[28:31], a[200:203], a[100:103], 0
  s_add_u32 s51, s50, 4096
  buffer_load_dwordx4 v232, s[24:27], s29 offen offset:0 lds
  v_mfma_f32_16x16x32_bf16 v[32:35], a[200:203], a[104:107], 0
  s_waitcnt lgkmcnt(7)
  ds_read_b64_tr_b16 a[222:223], v239 offset:6400
  v_cvt_pk_bf16_f32 v101, v74, v75
  v_mfma_f32_16x16x32_bf16 v[36:39], a[204:207], a[96:99], 0
  s_add_u32 s29, s29, s31
  ds_read_b64_tr_b16 a[192:193], v228 offset:8192
  v_cvt_pk_bf16_f32 v102, v84, v85
  v_mfma_f32_16x16x32_bf16 v[40:43], a[204:207], a[100:103], 0
  buffer_store_dwordx4 v[96:99], v233, s[20:23], s50 offen offset:0 sc1
  v_mfma_f32_16x16x32_bf16 v[44:47], a[204:207], a[104:107], 0
  s_waitcnt lgkmcnt(7)
  ds_read_b64_tr_b16 a[194:195], v228 offset:10240
  v_cvt_pk_bf16_f32 v103, v86, v87
  v_mfma_f32_16x16x32_bf16 v[0:3], a[208:211], a[108:111], v[0:3]
  ds_read_b64_tr_b16 a[196:197], v239 offset:8192
  v_cvt_pk_bf16_f32 v104, v52, v53
  v_mfma_f32_16x16x32_bf16 v[4:7], a[208:211], a[112:115], v[4:7]
  ds_read_b64_tr_b16 a[198:199], v239 offset:10240
  v_cvt_pk_bf16_f32 v105, v54, v55
  v_mfma_f32_16x16x32_bf16 v[8:11], a[208:211], a[116:119], v[8:11]
  s_waitcnt lgkmcnt(8)
  v_cvt_pk_bf16_f32 v106, v64, v65
  v_cvt_pk_bf16_f32 v107, v66, v67
  v_mfma_f32_16x16x32_bf16 v[12:15], a[212:215], a[108:111], v[12:15]
  ds_read_b64_tr_b16 a[200:201], v228 offset:8448
  v_cvt_pk_bf16_f32 v108, v76, v77
  v_mfma_f32_16x16x32_bf16 v[16:19], a[212:215], a[112:115], v[16:19]
  buffer_store_dwordx4 v[100:103], v233, s[20:23], s50 offen offset:1024 sc1
  v_mfma_f32_16x16x32_bf16 v[20:23], a[212:215], a[116:119], v[20:23]
  s_waitcnt lgkmcnt(7)
  ds_read_b64_tr_b16 a[202:203], v228 offset:10496
  v_cvt_pk_bf16_f32 v109, v78, v79
  v_mfma_f32_16x16x32_bf16 v[24:27], a[216:219], a[108:111], v[24:27]
  ds_read_b64_tr_b16 a[204:205], v239 offset:8448
  v_cvt_pk_bf16_f32 v110, v88, v89
  v_mfma_f32_16x16x32_bf16 v[28:31], a[216:219], a[112:115], v[28:31]
  buffer_load_dwordx4 v232, s[24:27], s29 offen offset:1024 lds
  v_mfma_f32_16x16x32_bf16 v[32:35], a[216:219], a[116:119], v[32:35]
  s_waitcnt lgkmcnt(7)
  ds_read_b64_tr_b16 a[206:207], v239 offset:10496
  v_cvt_pk_bf16_f32 v111, v90, v91
  v_mfma_f32_16x16x32_bf16 v[36:39], a[220:223], a[108:111], v[36:39]
  s_add_u32 s29, s29, s31
  ds_read_b64_tr_b16 a[208:209], v228 offset:12288
  v_cvt_pk_bf16_f32 v112, v56, v57
  v_mfma_f32_16x16x32_bf16 v[40:43], a[220:223], a[112:115], v[40:43]
  buffer_store_dwordx4 v[104:107], v233, s[20:23], s50 offen offset:2048 sc1
  v_mfma_f32_16x16x32_bf16 v[44:47], a[220:223], a[116:119], v[44:47]
  s_waitcnt lgkmcnt(7)
  ds_read_b64_tr_b16 a[210:211], v228 offset:14336
  v_cvt_pk_bf16_f32 v113, v58, v59
  v_mfma_f32_16x16x32_bf16 v[0:3], a[192:195], a[120:123], v[0:3]
  ds_read_b64_tr_b16 a[212:213], v239 offset:12288
  v_cvt_pk_bf16_f32 v114, v68, v69
  v_mfma_f32_16x16x32_bf16 v[4:7], a[192:195], a[124:127], v[4:7]
  ds_read_b64_tr_b16 a[214:215], v239 offset:14336
  v_cvt_pk_bf16_f32 v115, v70, v71
  v_mfma_f32_16x16x32_bf16 v[8:11], a[192:195], a[128:131], v[8:11]
  s_waitcnt lgkmcnt(8)
  v_cvt_pk_bf16_f32 v116, v80, v81
  v_cvt_pk_bf16_f32 v117, v82, v83
  v_mfma_f32_16x16x32_bf16 v[12:15], a[196:199], a[120:123], v[12:15]
  ds_read_b64_tr_b16 a[216:217], v228 offset:12544
  v_cvt_pk_bf16_f32 v118, v92, v93
  v_mfma_f32_16x16x32_bf16 v[16:19], a[196:199], a[124:127], v[16:19]
  buffer_store_dwordx4 v[108:111], v233, s[20:23], s50 offen offset:3072 sc1
  v_mfma_f32_16x16x32_bf16 v[20:23], a[196:199], a[128:131], v[20:23]
  s_waitcnt lgkmcnt(7)
  ds_read_b64_tr_b16 a[218:219], v228 offset:14592
  v_cvt_pk_bf16_f32 v119, v94, v95
  v_mfma_f32_16x16x32_bf16 v[24:27], a[200:203], a[120:123], v[24:27]
  ds_read_b64_tr_b16 a[220:221], v239 offset:12544
  v_mfma_f32_16x16x32_bf16 v[28:31], a[200:203], a[124:127], v[28:31]
  buffer_load_dwordx4 v232, s[24:27], s29 offen offset:2048 lds
  v_mfma_f32_16x16x32_bf16 v[32:35], a[200:203], a[128:131], v[32:35]
  s_waitcnt lgkmcnt(7)
  ds_read_b64_tr_b16 a[222:223], v239 offset:14592
  v_add_u32 v228, 98304, v229
  v_mfma_f32_16x16x32_bf16 v[36:39], a[204:207], a[120:123], v[36:39]
  s_add_u32 s29, s29, s31
  ds_read_b64_tr_b16 a[192:193], v228 offset:0
  v_xor_b32 v239, 32, v228
  v_mfma_f32_16x16x32_bf16 v[40:43], a[204:207], a[124:127], v[40:43]
  buffer_store_dwordx4 v[112:115], v233, s[20:23], s51 offen offset:0 sc1
  v_mfma_f32_16x16x32_bf16 v[44:47], a[204:207], a[128:131], v[44:47]
  s_waitcnt lgkmcnt(7)
  ds_read_b64_tr_b16 a[194:195], v228 offset:2048
  v_mfma_f32_16x16x32_bf16 v[0:3], a[208:211], a[132:135], v[0:3]
  ds_read_b64_tr_b16 a[196:197], v239 offset:0
  v_mfma_f32_16x16x32_bf16 v[4:7], a[208:211], a[136:139], v[4:7]
  ds_read_b64_tr_b16 a[198:199], v239 offset:2048
  v_mfma_f32_16x16x32_bf16 v[8:11], a[208:211], a[140:143], v[8:11]
  s_waitcnt lgkmcnt(8)
  v_mfma_f32_16x16x32_bf16 v[12:15], a[212:215], a[132:135], v[12:15]
  ds_read_b64_tr_b16 a[200:201], v228 offset:256
  v_mfma_f32_16x16x32_bf16 v[16:19], a[212:215], a[136:139], v[16:19]
  buffer_store_dwordx4 v[116:119], v233, s[20:23], s51 offen offset:1024 sc1
  v_mfma_f32_16x16x32_bf16 v[20:23], a[212:215], a[140:143], v[20:23]
  s_waitcnt lgkmcnt(7)
  ds_read_b64_tr_b16 a[202:203], v228 offset:2304
  v_mfma_f32_16x16x32_bf16 v[24:27], a[216:219], a[132:135], v[24:27]
  ds_read_b64_tr_b16 a[204:205], v239 offset:256
  v_mfma_f32_16x16x32_bf16 v[28:31], a[216:219], a[136:139], v[28:31]
  buffer_load_dwordx4 v232, s[24:27], s29 offen offset:3072 lds
  v_mfma_f32_16x16x32_bf16 v[32:35], a[216:219], a[140:143], v[32:35]
  s_waitcnt lgkmcnt(7)
  ds_read_b64_tr_b16 a[206:207], v239 offset:2304
  v_mfma_f32_16x16x32_bf16 v[36:39], a[220:223], a[132:135], v[36:39]
  ds_read_b64_tr_b16 a[208:209], v228 offset:4096
  v_mfma_f32_16x16x32_bf16 v[40:43], a[220:223], a[136:139], v[40:43]
  ds_read_b64_tr_b16 a[210:211], v228 offset:6144
  v_mfma_f32_16x16x32_bf16 v[44:47], a[220:223], a[140:143], v[44:47]
  s_waitcnt lgkmcnt(8)
  v_mfma_f32_16x16x32_bf16 v[0:3], a[192:195], a[144:147], v[0:3]
  s_waitcnt vmcnt(34)
  ds_read_b64_tr_b16 a[212:213], v239 offset:4096
  v_mfma_f32_16x16x32_bf16 v[4:7], a[192:195], a[148:151], v[4:7]
  s_barrier
  ds_read_b64_tr_b16 a[214:215], v239 offset:6144
  v_mfma_f32_16x16x32_bf16 v[8:11], a[192:195], a[152:155], v[8:11]
  s_waitcnt lgkmcnt(8)
  v_mfma_f32_16x16x32_bf16 v[12:15], a[196:199], a[144:147], v[12:15]
  s_add_u32 m0, s28, 65536
  ds_read_b64_tr_b16 a[216:217], v228 offset:4352
  v_mfma_f32_16x16x32_bf16 v[16:19], a[196:199], a[148:151], v[16:19]
  s_add_u32 s29, s55, 229376
  ds_read_b64_tr_b16 a[218:219], v228 offset:6400
  v_mfma_f32_16x16x32_bf16 v[20:23], a[196:199], a[152:155], v[20:23]
  s_waitcnt lgkmcnt(8)
  v_mfma_f32_16x16x32_bf16 v[24:27], a[200:203], a[144:147], v[24:27]
  ds_read_b64_tr_b16 a[220:221], v239 offset:4352
  v_mfma_f32_16x16x32_bf16 v[28:31], a[200:203], a[148:151], v[28:31]
  buffer_load_dwordx4 v232, s[24:27], s29 offen offset:0 lds
  v_mfma_f32_16x16x32_bf16 v[32:35], a[200:203], a[152:155], v[32:35]
  s_waitcnt lgkmcnt(7)
  ds_read_b64_tr_b16 a[222:223], v239 offset:6400
  v_mfma_f32_16x16x32_bf16 v[36:39], a[204:207], a[144:147], v[36:39]
  s_add_u32 s29, s29, s31
  ds_read_b64_tr_b16 a[192:193], v228 offset:8192
  v_mfma_f32_16x16x32_bf16 v[40:43], a[204:207], a[148:151], v[40:43]
  ds_read_b64_tr_b16 a[194:195], v228 offset:10240
  v_mfma_f32_16x16x32_bf16 v[44:47], a[204:207], a[152:155], v[44:47]
  s_waitcnt lgkmcnt(8)
  v_mfma_f32_16x16x32_bf16 v[0:3], a[208:211], a[156:159], v[0:3]
  ds_read_b64_tr_b16 a[196:197], v239 offset:8192
  v_mfma_f32_16x16x32_bf16 v[4:7], a[208:211], a[160:163], v[4:7]
  ds_read_b64_tr_b16 a[198:199], v239 offset:10240
  v_mfma_f32_16x16x32_bf16 v[8:11], a[208:211], a[164:167], v[8:11]
  s_waitcnt lgkmcnt(8)
  v_mfma_f32_16x16x32_bf16 v[12:15], a[212:215], a[156:159], v[12:15]
  ds_read_b64_tr_b16 a[200:201], v228 offset:8448
  v_mfma_f32_16x16x32_bf16 v[16:19], a[212:215], a[160:163], v[16:19]
  ds_read_b64_tr_b16 a[202:203], v228 offset:10496
  v_mfma_f32_16x16x32_bf16 v[20:23], a[212:215], a[164:167], v[20:23]
  s_waitcnt lgkmcnt(8)
  v_mfma_f32_16x16x32_bf16 v[24:27], a[216:219], a[156:159], v[24:27]
  ds_read_b64_tr_b16 a[204:205], v239 offset:8448
  v_mfma_f32_16x16x32_bf16 v[28:31], a[216:219], a[160:163], v[28:31]
  buffer_load_dwordx4 v232, s[24:27], s29 offen offset:1024 lds
  v_mfma_f32_16x16x32_bf16 v[32:35], a[216:219], a[164:167], v[32:35]
  s_waitcnt lgkmcnt(7)
  ds_read_b64_tr_b16 a[206:207], v239 offset:10496
  v_mfma_f32_16x16x32_bf16 v[36:39], a[220:223], a[156:159], v[36:39]
  s_add_u32 s29, s29, s31
  ds_read_b64_tr_b16 a[208:209], v228 offset:12288
  v_mfma_f32_16x16x32_bf16 v[40:43], a[220:223], a[160:163], v[40:43]
  ds_read_b64_tr_b16 a[210:211], v228 offset:14336
  v_mfma_f32_16x16x32_bf16 v[44:47], a[220:223], a[164:167], v[44:47]
  s_waitcnt lgkmcnt(8)
  v_mfma_f32_16x16x32_bf16 v[0:3], a[192:195], a[168:171], v[0:3]
  ds_read_b64_tr_b16 a[212:213], v239 offset:12288
  v_mfma_f32_16x16x32_bf16 v[4:7], a[192:195], a[172:175], v[4:7]
  ds_read_b64_tr_b16 a[214:215], v239 offset:14336
  v_mfma_f32_16x16x32_bf16 v[8:11], a[192:195], a[176:179], v[8:11]
  s_waitcnt lgkmcnt(8)
  v_mfma_f32_16x16x32_bf16 v[12:15], a[196:199], a[168:171], v[12:15]
  ds_read_b64_tr_b16 a[216:217], v228 offset:12544
  v_mfma_f32_16x16x32_bf16 v[16:19], a[196:199], a[172:175], v[16:19]
  ds_read_b64_tr_b16 a[218:219], v228 offset:14592
  v_mfma_f32_16x16x32_bf16 v[20:23], a[196:199], a[176:179], v[20:23]
  s_waitcnt lgkmcnt(8)
  v_mfma_f32_16x16x32_bf16 v[24:27], a[200:203], a[168:171], v[24:27]
  ds_read_b64_tr_b16 a[220:221], v239 offset:12544
  v_mfma_f32_16x16x32_bf16 v[28:31], a[200:203], a[172:175], v[28:31]
  buffer_load_dwordx4 v232, s[24:27], s29 offen offset:2048 lds
  v_mfma_f32_16x16x32_bf16 v[32:35], a[200:203], a[176:179], v[32:35]
  s_waitcnt lgkmcnt(7)
  ds_read_b64_tr_b16 a[222:223], v239 offset:14592
  v_add_u32 v228, 16384, v229
  v_mfma_f32_16x16x32_bf16 v[36:39], a[204:207], a[168:171], v[36:39]
  s_add_u32 s29, s29, s31
  ds_read_b64_tr_b16 a[192:193], v228 offset:0
  v_xor_b32 v239, 32, v228
  v_mfma_f32_16x16x32_bf16 v[40:43], a[204:207], a[172:175], v[40:43]
  ds_read_b64_tr_b16 a[194:195], v228 offset:2048
  v_mfma_f32_16x16x32_bf16 v[44:47], a[204:207], a[176:179], v[44:47]
  s_waitcnt lgkmcnt(8)
  v_mfma_f32_16x16x32_bf16 v[0:3], a[208:211], a[180:183], v[0:3]
  ds_read_b64_tr_b16 a[196:197], v239 offset:0
  v_mfma_f32_16x16x32_bf16 v[4:7], a[208:211], a[184:187], v[4:7]
  ds_read_b64_tr_b16 a[198:199], v239 offset:2048
  v_mfma_f32_16x16x32_bf16 v[8:11], a[208:211], a[188:191], v[8:11]
  s_waitcnt lgkmcnt(8)
  v_mfma_f32_16x16x32_bf16 v[12:15], a[212:215], a[180:183], v[12:15]
  ds_read_b64_tr_b16 a[200:201], v228 offset:256
  v_mfma_f32_16x16x32_bf16 v[16:19], a[212:215], a[184:187], v[16:19]
  ds_read_b64_tr_b16 a[202:203], v228 offset:2304
  v_mfma_f32_16x16x32_bf16 v[20:23], a[212:215], a[188:191], v[20:23]
  s_waitcnt lgkmcnt(8)
  v_mfma_f32_16x16x32_bf16 v[24:27], a[216:219], a[180:183], v[24:27]
  ds_read_b64_tr_b16 a[204:205], v239 offset:256
  v_mfma_f32_16x16x32_bf16 v[28:31], a[216:219], a[184:187], v[28:31]
  buffer_load_dwordx4 v232, s[24:27], s29 offen offset:3072 lds
  v_mfma_f32_16x16x32_bf16 v[32:35], a[216:219], a[188:191], v[32:35]
  s_waitcnt lgkmcnt(7)
  ds_read_b64_tr_b16 a[206:207], v239 offset:2304
  v_mfma_f32_16x16x32_bf16 v[36:39], a[220:223], a[180:183], v[36:39]
  ds_read_b64_tr_b16 a[208:209], v228 offset:4096
  v_mfma_f32_16x16x32_bf16 v[40:43], a[220:223], a[184:187], v[40:43]
  ds_read_b64_tr_b16 a[210:211], v228 offset:6144
  v_mfma_f32_16x16x32_bf16 v[44:47], a[220:223], a[188:191], v[44:47]
  s_waitcnt lgkmcnt(8)
  v_mfma_f32_16x16x32_bf16 v[0:3], a[192:195], a[0:3], v[0:3]
  s_waitcnt vmcnt(5)
  ds_read_b64_tr_b16 a[212:213], v239 offset:4096
  v_mfma_f32_16x16x32_bf16 v[4:7], a[192:195], a[4:7], v[4:7]
  s_barrier
  ds_read_b64_tr_b16 a[214:215], v239 offset:6144
  v_mfma_f32_16x16x32_bf16 v[8:11], a[192:195], a[8:11], v[8:11]
  s_waitcnt lgkmcnt(8)
  v_mfma_f32_16x16x32_bf16 v[12:15], a[196:199], a[0:3], v[12:15]
  s_add_u32 m0, s28, 98304
  ds_read_b64_tr_b16 a[216:217], v228 offset:4352
  v_mfma_f32_16x16x32_bf16 v[16:19], a[196:199], a[4:7], v[16:19]
  buffer_store_dwordx2 v[226:227], v246, s[76:79], s52 offen offset:0 sc1
  v_mfma_f32_16x16x32_bf16 v[20:23], a[196:199], a[8:11], v[20:23]
  s_waitcnt lgkmcnt(7)
  ds_read_b64_tr_b16 a[218:219], v228 offset:6400
  v_mfma_f32_16x16x32_bf16 v[24:27], a[200:203], a[0:3], v[24:27]
  s_add_u32 s29, s55, 344064
  ds_read_b64_tr_b16 a[220:221], v239 offset:4352
  v_mfma_f32_16x16x32_bf16 v[28:31], a[200:203], a[4:7], v[28:31]
  ds_read_b64_tr_b16 a[222:223], v239 offset:6400
  v_mfma_f32_16x16x32_bf16 v[32:35], a[200:203], a[8:11], v[32:35]
  s_waitcnt lgkmcnt(8)
  v_mfma_f32_16x16x32_bf16 v[36:39], a[204:207], a[0:3], v[36:39]
  ds_read_b64_tr_b16 a[192:193], v228 offset:8192
  v_mfma_f32_16x16x32_bf16 v[40:43], a[204:207], a[4:7], v[40:43]
  buffer_load_dwordx4 v232, s[24:27], s29 offen offset:0 lds
  v_mfma_f32_16x16x32_bf16 v[44:47], a[204:207], a[8:11], v[44:47]
  s_waitcnt lgkmcnt(7)
  ds_read_b64_tr_b16 a[194:195], v228 offset:10240
  v_mfma_f32_16x16x32_bf16 v[0:3], a[208:211], a[12:15], v[0:3]
  s_add_u32 s29, s29, s31
  ds_read_b64_tr_b16 a[196:197], v239 offset:8192
  v_mfma_f32_16x16x32_bf16 v[4:7], a[208:211], a[16:19], v[4:7]
  ds_read_b64_tr_b16 a[198:199], v239 offset:10240
  v_mfma_f32_16x16x32_bf16 v[8:11], a[208:211], a[20:23], v[8:11]
  s_waitcnt lgkmcnt(8)
  v_mfma_f32_16x16x32_bf16 v[12:15], a[212:215], a[12:15], v[12:15]
  ds_read_b64_tr_b16 a[200:201], v228 offset:8448
  v_mfma_f32_16x16x32_bf16 v[16:19], a[212:215], a[16:19], v[16:19]
  ds_read_b64_tr_b16 a[202:203], v228 offset:10496
  v_mfma_f32_16x16x32_bf16 v[20:23], a[212:215], a[20:23], v[20:23]
  s_waitcnt lgkmcnt(8)
  v_mfma_f32_16x16x32_bf16 v[24:27], a[216:219], a[12:15], v[24:27]
  ds_read_b64_tr_b16 a[204:205], v239 offset:8448
  v_mfma_f32_16x16x32_bf16 v[28:31], a[216:219], a[16:19], v[28:31]
  ds_read_b64_tr_b16 a[206:207], v239 offset:10496
  v_mfma_f32_16x16x32_bf16 v[32:35], a[216:219], a[20:23], v[32:35]
  s_waitcnt lgkmcnt(8)
  v_mfma_f32_16x16x32_bf16 v[36:39], a[220:223], a[12:15], v[36:39]
  ds_read_b64_tr_b16 a[208:209], v228 offset:12288
  v_mfma_f32_16x16x32_bf16 v[40:43], a[220:223], a[16:19], v[40:43]
  buffer_load_dwordx4 v232, s[24:27], s29 offen offset:1024 lds
  v_mfma_f32_16x16x32_bf16 v[44:47], a[220:223], a[20:23], v[44:47]
  s_waitcnt lgkmcnt(7)
  ds_read_b64_tr_b16 a[210:211], v228 offset:14336
  v_mfma_f32_16x16x32_bf16 v[0:3], a[192:195], a[24:27], v[0:3]
  s_add_u32 s29, s29, s31
  ds_read_b64_tr_b16 a[212:213], v239 offset:12288
  v_mfma_f32_16x16x32_bf16 v[4:7], a[192:195], a[28:31], v[4:7]
  ds_read_b64_tr_b16 a[214:215], v239 offset:14336
  v_mfma_f32_16x16x32_bf16 v[8:11], a[192:195], a[32:35], v[8:11]
  s_waitcnt lgkmcnt(8)
  v_mfma_f32_16x16x32_bf16 v[12:15], a[196:199], a[24:27], v[12:15]
  ds_read_b64_tr_b16 a[216:217], v228 offset:12544
  v_mfma_f32_16x16x32_bf16 v[16:19], a[196:199], a[28:31], v[16:19]
  ds_read_b64_tr_b16 a[218:219], v228 offset:14592
  v_mfma_f32_16x16x32_bf16 v[20:23], a[196:199], a[32:35], v[20:23]
  s_waitcnt lgkmcnt(8)
  v_mfma_f32_16x16x32_bf16 v[24:27], a[200:203], a[24:27], v[24:27]
  ds_read_b64_tr_b16 a[220:221], v239 offset:12544
  v_mfma_f32_16x16x32_bf16 v[28:31], a[200:203], a[28:31], v[28:31]
  buffer_load_dwordx4 v232, s[24:27], s29 offen offset:2048 lds
  v_mfma_f32_16x16x32_bf16 v[32:35], a[200:203], a[32:35], v[32:35]
  s_waitcnt lgkmcnt(7)
  ds_read_b64_tr_b16 a[222:223], v239 offset:14592
  v_add_u32 v228, 114688, v229
  v_mfma_f32_16x16x32_bf16 v[36:39], a[204:207], a[24:27], v[36:39]
  s_add_u32 s29, s29, s31
  ds_read_b64_tr_b16 a[192:193], v228 offset:0
  v_xor_b32 v239, 32, v228
  v_mfma_f32_16x16x32_bf16 v[40:43], a[204:207], a[28:31], v[40:43]
  ds_read_b64_tr_b16 a[194:195], v228 offset:2048
  v_mfma_f32_16x16x32_bf16 v[44:47], a[204:207], a[32:35], v[44:47]
  s_waitcnt lgkmcnt(8)
  v_mfma_f32_16x16x32_bf16 v[0:3], a[208:211], a[36:39], v[0:3]
  ds_read_b64_tr_b16 a[196:197], v239 offset:0
  v_mfma_f32_16x16x32_bf16 v[4:7], a[208:211], a[40:43], v[4:7]
  ds_read_b64_tr_b16 a[198:199], v239 offset:2048
  v_mfma_f32_16x16x32_bf16 v[8:11], a[208:211], a[44:47], v[8:11]
  s_waitcnt lgkmcnt(8)
  v_mfma_f32_16x16x32_bf16 v[12:15], a[212:215], a[36:39], v[12:15]
  ds_read_b64_tr_b16 a[200:201], v228 offset:256
  v_mfma_f32_16x16x32_bf16 v[16:19], a[212:215], a[40:43], v[16:19]
  ds_read_b64_tr_b16 a[202:203], v228 offset:2304
  v_mfma_f32_16x16x32_bf16 v[20:23], a[212:215], a[44:47], v[20:23]
  s_waitcnt lgkmcnt(8)
  v_mfma_f32_16x16x32_bf16 v[24:27], a[216:219], a[36:39], v[24:27]
  ds_read_b64_tr_b16 a[204:205], v239 offset:256
  v_mfma_f32_16x16x32_bf16 v[28:31], a[216:219], a[40:43], v[28:31]
  buffer_load_dwordx4 v232, s[24:27], s29 offen offset:3072 lds
  v_mfma_f32_16x16x32_bf16 v[32:35], a[216:219], a[44:47], v[32:35]
  s_waitcnt lgkmcnt(7)
  ds_read_b64_tr_b16 a[206:207], v239 offset:2304
  v_mfma_f32_16x16x32_bf16 v[36:39], a[220:223], a[36:39], v[36:39]
  ds_read_b64_tr_b16 a[208:209], v228 offset:4096
  v_mfma_f32_16x16x32_bf16 v[40:43], a[220:223], a[40:43], v[40:43]
  ds_read_b64_tr_b16 a[210:211], v228 offset:6144
  v_mfma_f32_16x16x32_bf16 v[44:47], a[220:223], a[44:47], v[44:47]
  s_waitcnt lgkmcnt(8)
  v_mfma_f32_16x16x32_bf16 v[0:3], a[192:195], a[48:51], v[0:3]
  s_waitcnt vmcnt(63)
  ds_read_b64_tr_b16 a[212:213], v239 offset:4096
  v_mfma_f32_16x16x32_bf16 v[4:7], a[192:195], a[52:55], v[4:7]
  s_barrier
  ds_read_b64_tr_b16 a[214:215], v239 offset:6144
  v_mfma_f32_16x16x32_bf16 v[8:11], a[192:195], a[56:59], v[8:11]
  s_waitcnt lgkmcnt(8)
  v_mfma_f32_16x16x32_bf16 v[12:15], a[196:199], a[48:51], v[12:15]
  s_add_u32 m0, s28, 16384
  ds_read_b64_tr_b16 a[216:217], v228 offset:4352
  v_mfma_f32_16x16x32_bf16 v[16:19], a[196:199], a[52:55], v[16:19]
  s_add_u32 s29, s56, 0
  ds_read_b64_tr_b16 a[218:219], v228 offset:6400
  v_mfma_f32_16x16x32_bf16 v[20:23], a[196:199], a[56:59], v[20:23]
  s_waitcnt lgkmcnt(8)
  v_mfma_f32_16x16x32_bf16 v[24:27], a[200:203], a[48:51], v[24:27]
  ds_read_b64_tr_b16 a[220:221], v239 offset:4352
  v_mfma_f32_16x16x32_bf16 v[28:31], a[200:203], a[52:55], v[28:31]
  buffer_load_dwordx4 v232, s[24:27], s29 offen offset:0 lds
  v_mfma_f32_16x16x32_bf16 v[32:35], a[200:203], a[56:59], v[32:35]
  s_waitcnt lgkmcnt(7)
  ds_read_b64_tr_b16 a[222:223], v239 offset:6400
  v_mfma_f32_16x16x32_bf16 v[36:39], a[204:207], a[48:51], v[36:39]
  s_add_u32 s29, s29, s31
  ds_read_b64_tr_b16 a[192:193], v228 offset:8192
  v_mfma_f32_16x16x32_bf16 v[40:43], a[204:207], a[52:55], v[40:43]
  ds_read_b64_tr_b16 a[194:195], v228 offset:10240
  v_mfma_f32_16x16x32_bf16 v[44:47], a[204:207], a[56:59], v[44:47]
  s_waitcnt lgkmcnt(8)
  v_mfma_f32_16x16x32_bf16 v[0:3], a[208:211], a[60:63], v[0:3]
  ds_read_b64_tr_b16 a[196:197], v239 offset:8192
  v_mfma_f32_16x16x32_bf16 v[4:7], a[208:211], a[64:67], v[4:7]
  ds_read_b64_tr_b16 a[198:199], v239 offset:10240
  v_mfma_f32_16x16x32_bf16 v[8:11], a[208:211], a[68:71], v[8:11]
  s_waitcnt lgkmcnt(8)
  v_mfma_f32_16x16x32_bf16 v[12:15], a[212:215], a[60:63], v[12:15]
  ds_read_b64_tr_b16 a[200:201], v228 offset:8448
  v_mfma_f32_16x16x32_bf16 v[16:19], a[212:215], a[64:67], v[16:19]
  ds_read_b64_tr_b16 a[202:203], v228 offset:10496
  v_mfma_f32_16x16x32_bf16 v[20:23], a[212:215], a[68:71], v[20:23]
  s_waitcnt lgkmcnt(8)
  v_mfma_f32_16x16x32_bf16 v[24:27], a[216:219], a[60:63], v[24:27]
  ds_read_b64_tr_b16 a[204:205], v239 offset:8448
  v_mfma_f32_16x16x32_bf16 v[28:31], a[216:219], a[64:67], v[28:31]
  buffer_load_dwordx4 v232, s[24:27], s29 offen offset:1024 lds
  v_mfma_f32_16x16x32_bf16 v[32:35], a[216:219], a[68:71], v[32:35]
  s_waitcnt lgkmcnt(7)
  ds_read_b64_tr_b16 a[206:207], v239 offset:10496
  v_mfma_f32_16x16x32_bf16 v[36:39], a[220:223], a[60:63], v[36:39]
  s_add_u32 s29, s29, s31
  ds_read_b64_tr_b16 a[208:209], v228 offset:12288
  v_mfma_f32_16x16x32_bf16 v[40:43], a[220:223], a[64:67], v[40:43]
  ds_read_b64_tr_b16 a[210:211], v228 offset:14336
  v_mfma_f32_16x16x32_bf16 v[44:47], a[220:223], a[68:71], v[44:47]
  s_waitcnt lgkmcnt(8)
  v_mfma_f32_16x16x32_bf16 v[0:3], a[192:195], a[72:75], v[0:3]
  ds_read_b64_tr_b16 a[212:213], v239 offset:12288
  v_mfma_f32_16x16x32_bf16 v[4:7], a[192:195], a[76:79], v[4:7]
  ds_read_b64_tr_b16 a[214:215], v239 offset:14336
  v_mfma_f32_16x16x32_bf16 v[8:11], a[192:195], a[80:83], v[8:11]
  s_waitcnt lgkmcnt(8)
  v_mfma_f32_16x16x32_bf16 v[12:15], a[196:199], a[72:75], v[12:15]
  ds_read_b64_tr_b16 a[216:217], v228 offset:12544
  v_mfma_f32_16x16x32_bf16 v[16:19], a[196:199], a[76:79], v[16:19]
  ds_read_b64_tr_b16 a[218:219], v228 offset:14592
  v_mfma_f32_16x16x32_bf16 v[20:23], a[196:199], a[80:83], v[20:23]
  s_waitcnt lgkmcnt(8)
  v_mfma_f32_16x16x32_bf16 v[24:27], a[200:203], a[72:75], v[24:27]
  ds_read_b64_tr_b16 a[220:221], v239 offset:12544
  v_mfma_f32_16x16x32_bf16 v[28:31], a[200:203], a[76:79], v[28:31]
  buffer_load_dwordx4 v232, s[24:27], s29 offen offset:2048 lds
  v_mfma_f32_16x16x32_bf16 v[32:35], a[200:203], a[80:83], v[32:35]
  s_waitcnt lgkmcnt(7)
  ds_read_b64_tr_b16 a[222:223], v239 offset:14592
  v_add_u32 v228, 81920, v229
  v_mfma_f32_16x16x32_bf16 v[36:39], a[204:207], a[72:75], v[36:39]
  s_add_u32 s29, s29, s31
  ds_read_b64_tr_b16 a[192:193], v228 offset:0
  v_xor_b32 v239, 32, v228
  v_mfma_f32_16x16x32_bf16 v[40:43], a[204:207], a[76:79], v[40:43]
  ds_read_b64_tr_b16 a[194:195], v228 offset:2048
  v_mfma_f32_16x16x32_bf16 v[44:47], a[204:207], a[80:83], v[44:47]
  s_waitcnt lgkmcnt(8)
  v_mfma_f32_16x16x32_bf16 v[48:51], a[208:211], a[84:87], v[0:3]
  ds_read_b64_tr_b16 a[196:197], v239 offset:0
  v_mfma_f32_16x16x32_bf16 v[52:55], a[208:211], a[88:91], v[4:7]
  ds_read_b64_tr_b16 a[198:199], v239 offset:2048
  v_mfma_f32_16x16x32_bf16 v[56:59], a[208:211], a[92:95], v[8:11]
  s_waitcnt lgkmcnt(8)
  v_mfma_f32_16x16x32_bf16 v[60:63], a[212:215], a[84:87], v[12:15]
  ds_read_b64_tr_b16 a[200:201], v228 offset:256
  v_mfma_f32_16x16x32_bf16 v[64:67], a[212:215], a[88:91], v[16:19]
  ds_read_b64_tr_b16 a[202:203], v228 offset:2304
  v_mfma_f32_16x16x32_bf16 v[68:71], a[212:215], a[92:95], v[20:23]
  s_waitcnt lgkmcnt(8)
  v_mfma_f32_16x16x32_bf16 v[72:75], a[216:219], a[84:87], v[24:27]
  ds_read_b64_tr_b16 a[204:205], v239 offset:256
  v_mfma_f32_16x16x32_bf16 v[76:79], a[216:219], a[88:91], v[28:31]
  buffer_load_dwordx4 v232, s[24:27], s29 offen offset:3072 lds
  v_mfma_f32_16x16x32_bf16 v[80:83], a[216:219], a[92:95], v[32:35]
  s_waitcnt lgkmcnt(7)
  ds_read_b64_tr_b16 a[206:207], v239 offset:2304
  v_mfma_f32_16x16x32_bf16 v[84:87], a[220:223], a[84:87], v[36:39]
  ds_read_b64_tr_b16 a[208:209], v228 offset:4096
  v_mfma_f32_16x16x32_bf16 v[88:91], a[220:223], a[88:91], v[40:43]
  ds_read_b64_tr_b16 a[210:211], v228 offset:6144
  v_mfma_f32_16x16x32_bf16 v[92:95], a[220:223], a[92:95], v[44:47]
  s_waitcnt lgkmcnt(8)
  v_mfma_f32_16x16x32_bf16 v[0:3], a[192:195], a[96:99], 0
  s_waitcnt vmcnt(63)
  ds_read_b64_tr_b16 a[212:213], v239 offset:4096
  v_mfma_f32_16x16x32_bf16 v[4:7], a[192:195], a[100:103], 0
  s_barrier
  ds_read_b64_tr_b16 a[214:215], v239 offset:6144
  v_mfma_f32_16x16x32_bf16 v[8:11], a[192:195], a[104:107], 0
  s_waitcnt lgkmcnt(8)
  v_mfma_f32_16x16x32_bf16 v[12:15], a[196:199], a[96:99], 0
  s_add_u32 m0, s28, 114688
  ds_read_b64_tr_b16 a[216:217], v228 offset:4352
  v_cvt_pk_bf16_f32 v96, v48, v49
  v_mfma_f32_16x16x32_bf16 v[16:19], a[196:199], a[100:103], 0
  s_add_u32 s29, s56, 114688
  ds_read_b64_tr_b16 a[218:219], v228 offset:6400
  v_cvt_pk_bf16_f32 v97, v50, v51
  v_mfma_f32_16x16x32_bf16 v[20:23], a[196:199], a[104:107], 0
  s_waitcnt lgkmcnt(8)
  v_cvt_pk_bf16_f32 v98, v60, v61
  v_cvt_pk_bf16_f32 v99, v62, v63
  v_mfma_f32_16x16x32_bf16 v[24:27], a[200:203], a[96:99], 0
  s_mul_i32 s50, s53, 192
  ds_read_b64_tr_b16 a[220:221], v239 offset:4352
  v_cvt_pk_bf16_f32 v100, v72, v73
  v_mfma_f32_16x16x32_bf16 v[28:31], a[200:203], a[100:103], 0
  s_add_u32 s51, s50, 4096
  buffer_load_dwordx4 v232, s[24:27], s29 offen offset:0 lds
  v_mfma_f32_16x16x32_bf16 v[32:35], a[200:203], a[104:107], 0
  s_waitcnt lgkmcnt(7)
  ds_read_b64_tr_b16 a[222:223], v239 offset:6400
  v_cvt_pk_bf16_f32 v101, v74, v75
  v_mfma_f32_16x16x32_bf16 v[36:39], a[204:207], a[96:99], 0
  s_add_u32 s29, s29, s31
  ds_read_b64_tr_b16 a[192:193], v228 offset:8192
  v_cvt_pk_bf16_f32 v102, v84, v85
  v_mfma_f32_16x16x32_bf16 v[40:43], a[204:207], a[100:103], 0
  buffer_store_dwordx4 v[96:99], v233, s[20:23], s50 offen offset:0 sc1
  v_mfma_f32_16x16x32_bf16 v[44:47], a[204:207], a[104:107], 0
  s_waitcnt lgkmcnt(7)
  ds_read_b64_tr_b16 a[194:195], v228 offset:10240
  v_cvt_pk_bf16_f32 v103, v86, v87
  v_mfma_f32_16x16x32_bf16 v[0:3], a[208:211], a[108:111], v[0:3]
  ds_read_b64_tr_b16 a[196:197], v239 offset:8192
  v_cvt_pk_bf16_f32 v104, v52, v53
  v_mfma_f32_16x16x32_bf16 v[4:7], a[208:211], a[112:115], v[4:7]
  ds_read_b64_tr_b16 a[198:199], v239 offset:10240
  v_cvt_pk_bf16_f32 v105, v54, v55
  v_mfma_f32_16x16x32_bf16 v[8:11], a[208:211], a[116:119], v[8:11]
  s_waitcnt lgkmcnt(8)
  v_cvt_pk_bf16_f32 v106, v64, v65
  v_cvt_pk_bf16_f32 v107, v66, v67
  v_mfma_f32_16x16x32_bf16 v[12:15], a[212:215], a[108:111], v[12:15]
  ds_read_b64_tr_b16 a[200:201], v228 offset:8448
  v_cvt_pk_bf16_f32 v108, v76, v77
  v_mfma_f32_16x16x32_bf16 v[16:19], a[212:215], a[112:115], v[16:19]
  buffer_store_dwordx4 v[100:103], v233, s[20:23], s50 offen offset:1024 sc1
  v_mfma_f32_16x16x32_bf16 v[20:23], a[212:215], a[116:119], v[20:23]
  s_waitcnt lgkmcnt(7)
  ds_read_b64_tr_b16 a[202:203], v228 offset:10496
  v_cvt_pk_bf16_f32 v109, v78, v79
  v_mfma_f32_16x16x32_bf16 v[24:27], a[216:219], a[108:111], v[24:27]
  ds_read_b64_tr_b16 a[204:205], v239 offset:8448
  v_cvt_pk_bf16_f32 v110, v88, v89
  v_mfma_f32_16x16x32_bf16 v[28:31], a[216:219], a[112:115], v[28:31]
  buffer_load_dwordx4 v232, s[24:27], s29 offen offset:1024 lds
  v_mfma_f32_16x16x32_bf16 v[32:35], a[216:219], a[116:119], v[32:35]
  s_waitcnt lgkmcnt(7)
  ds_read_b64_tr_b16 a[206:207], v239 offset:10496
  v_cvt_pk_bf16_f32 v111, v90, v91
  v_mfma_f32_16x16x32_bf16 v[36:39], a[220:223], a[108:111], v[36:39]
  s_add_u32 s29, s29, s31
  ds_read_b64_tr_b16 a[208:209], v228 offset:12288
  v_cvt_pk_bf16_f32 v112, v56, v57
  v_mfma_f32_16x16x32_bf16 v[40:43], a[220:223], a[112:115], v[40:43]
  buffer_store_dwordx4 v[104:107], v233, s[20:23], s50 offen offset:2048 sc1
  v_mfma_f32_16x16x32_bf16 v[44:47], a[220:223], a[116:119], v[44:47]
  s_waitcnt lgkmcnt(7)
  ds_read_b64_tr_b16 a[210:211], v228 offset:14336
  v_cvt_pk_bf16_f32 v113, v58, v59
  v_mfma_f32_16x16x32_bf16 v[0:3], a[192:195], a[120:123], v[0:3]
  ds_read_b64_tr_b16 a[212:213], v239 offset:12288
  v_cvt_pk_bf16_f32 v114, v68, v69
  v_mfma_f32_16x16x32_bf16 v[4:7], a[192:195], a[124:127], v[4:7]
  ds_read_b64_tr_b16 a[214:215], v239 offset:14336
  v_cvt_pk_bf16_f32 v115, v70, v71
  v_mfma_f32_16x16x32_bf16 v[8:11], a[192:195], a[128:131], v[8:11]
  s_waitcnt lgkmcnt(8)
  v_cvt_pk_bf16_f32 v116, v80, v81
  v_cvt_pk_bf16_f32 v117, v82, v83
  v_mfma_f32_16x16x32_bf16 v[12:15], a[196:199], a[120:123], v[12:15]
  ds_read_b64_tr_b16 a[216:217], v228 offset:12544
  v_cvt_pk_bf16_f32 v118, v92, v93
  v_mfma_f32_16x16x32_bf16 v[16:19], a[196:199], a[124:127], v[16:19]
  buffer_store_dwordx4 v[108:111], v233, s[20:23], s50 offen offset:3072 sc1
  v_mfma_f32_16x16x32_bf16 v[20:23], a[196:199], a[128:131], v[20:23]
  s_waitcnt lgkmcnt(7)
  ds_read_b64_tr_b16 a[218:219], v228 offset:14592
  v_cvt_pk_bf16_f32 v119, v94, v95
  v_mfma_f32_16x16x32_bf16 v[24:27], a[200:203], a[120:123], v[24:27]
  ds_read_b64_tr_b16 a[220:221], v239 offset:12544
  v_mfma_f32_16x16x32_bf16 v[28:31], a[200:203], a[124:127], v[28:31]
  buffer_load_dwordx4 v232, s[24:27], s29 offen offset:2048 lds
  v_mfma_f32_16x16x32_bf16 v[32:35], a[200:203], a[128:131], v[32:35]
  s_waitcnt lgkmcnt(7)
  ds_read_b64_tr_b16 a[222:223], v239 offset:14592
  v_add_u32 v228, 0, v229
  v_mfma_f32_16x16x32_bf16 v[36:39], a[204:207], a[120:123], v[36:39]
  s_add_u32 s29, s29, s31
  ds_read_b64_tr_b16 a[192:193], v228 offset:0
  v_xor_b32 v239, 32, v228
  v_mfma_f32_16x16x32_bf16 v[40:43], a[204:207], a[124:127], v[40:43]
  buffer_store_dwordx4 v[112:115], v233, s[20:23], s51 offen offset:0 sc1
  v_mfma_f32_16x16x32_bf16 v[44:47], a[204:207], a[128:131], v[44:47]
  s_waitcnt lgkmcnt(7)
  ds_read_b64_tr_b16 a[194:195], v228 offset:2048
  v_mfma_f32_16x16x32_bf16 v[0:3], a[208:211], a[132:135], v[0:3]
  ds_read_b64_tr_b16 a[196:197], v239 offset:0
  v_mfma_f32_16x16x32_bf16 v[4:7], a[208:211], a[136:139], v[4:7]
  ds_read_b64_tr_b16 a[198:199], v239 offset:2048
  v_mfma_f32_16x16x32_bf16 v[8:11], a[208:211], a[140:143], v[8:11]
  s_waitcnt lgkmcnt(8)
  v_mfma_f32_16x16x32_bf16 v[12:15], a[212:215], a[132:135], v[12:15]
  ds_read_b64_tr_b16 a[200:201], v228 offset:256
  v_mfma_f32_16x16x32_bf16 v[16:19], a[212:215], a[136:139], v[16:19]
  buffer_store_dwordx4 v[116:119], v233, s[20:23], s51 offen offset:1024 sc1
  v_mfma_f32_16x16x32_bf16 v[20:23], a[212:215], a[140:143], v[20:23]
  s_waitcnt lgkmcnt(7)
  ds_read_b64_tr_b16 a[202:203], v228 offset:2304
  v_mfma_f32_16x16x32_bf16 v[24:27], a[216:219], a[132:135], v[24:27]
  ds_read_b64_tr_b16 a[204:205], v239 offset:256
  v_mfma_f32_16x16x32_bf16 v[28:31], a[216:219], a[136:139], v[28:31]
  buffer_load_dwordx4 v232, s[24:27], s29 offen offset:3072 lds
  v_mfma_f32_16x16x32_bf16 v[32:35], a[216:219], a[140:143], v[32:35]
  s_waitcnt lgkmcnt(7)
  ds_read_b64_tr_b16 a[206:207], v239 offset:2304
  v_mfma_f32_16x16x32_bf16 v[36:39], a[220:223], a[132:135], v[36:39]
  ds_read_b64_tr_b16 a[208:209], v228 offset:4096
  v_mfma_f32_16x16x32_bf16 v[40:43], a[220:223], a[136:139], v[40:43]
  ds_read_b64_tr_b16 a[210:211], v228 offset:6144
  v_mfma_f32_16x16x32_bf16 v[44:47], a[220:223], a[140:143], v[44:47]
  s_waitcnt lgkmcnt(8)
  v_mfma_f32_16x16x32_bf16 v[0:3], a[192:195], a[144:147], v[0:3]
  s_waitcnt vmcnt(63)
  ds_read_b64_tr_b16 a[212:213], v239 offset:4096
  v_mfma_f32_16x16x32_bf16 v[4:7], a[192:195], a[148:151], v[4:7]
  s_barrier
  ds_read_b64_tr_b16 a[214:215], v239 offset:6144
  v_mfma_f32_16x16x32_bf16 v[8:11], a[192:195], a[152:155], v[8:11]
  s_waitcnt lgkmcnt(8)
  v_mfma_f32_16x16x32_bf16 v[12:15], a[196:199], a[144:147], v[12:15]
  s_add_u32 m0, s28, 81920
  ds_read_b64_tr_b16 a[216:217], v228 offset:4352
  v_mfma_f32_16x16x32_bf16 v[16:19], a[196:199], a[148:151], v[16:19]
  buffer_load_dwordx2 v[224:225], v222, s[76:79], s58 offen offset:0 sc1
  v_mfma_f32_16x16x32_bf16 v[20:23], a[196:199], a[152:155], v[20:23]
  s_waitcnt lgkmcnt(7)
  ds_read_b64_tr_b16 a[218:219], v228 offset:6400
  v_mfma_f32_16x16x32_bf16 v[24:27], a[200:203], a[144:147], v[24:27]
  s_add_u32 s29, s56, 229376
  ds_read_b64_tr_b16 a[220:221], v239 offset:4352
  v_mfma_f32_16x16x32_bf16 v[28:31], a[200:203], a[148:151], v[28:31]
  ds_read_b64_tr_b16 a[222:223], v239 offset:6400
  v_mfma_f32_16x16x32_bf16 v[32:35], a[200:203], a[152:155], v[32:35]
  s_waitcnt lgkmcnt(8)
  v_mfma_f32_16x16x32_bf16 v[36:39], a[204:207], a[144:147], v[36:39]
  ds_read_b64_tr_b16 a[192:193], v228 offset:8192
  v_mfma_f32_16x16x32_bf16 v[40:43], a[204:207], a[148:151], v[40:43]
  buffer_load_dwordx4 v232, s[24:27], s29 offen offset:0 lds
  v_mfma_f32_16x16x32_bf16 v[44:47], a[204:207], a[152:155], v[44:47]
  s_waitcnt lgkmcnt(7)
  ds_read_b64_tr_b16 a[194:195], v228 offset:10240
  v_mfma_f32_16x16x32_bf16 v[0:3], a[208:211], a[156:159], v[0:3]
  s_add_u32 s29, s29, s31
  ds_read_b64_tr_b16 a[196:197], v239 offset:8192
  v_mfma_f32_16x16x32_bf16 v[4:7], a[208:211], a[160:163], v[4:7]
  ds_read_b64_tr_b16 a[198:199], v239 offset:10240
  v_mfma_f32_16x16x32_bf16 v[8:11], a[208:211], a[164:167], v[8:11]
  s_waitcnt lgkmcnt(8)
  v_mfma_f32_16x16x32_bf16 v[12:15], a[212:215], a[156:159], v[12:15]
  ds_read_b64_tr_b16 a[200:201], v228 offset:8448
  v_mfma_f32_16x16x32_bf16 v[16:19], a[212:215], a[160:163], v[16:19]
  ds_read_b64_tr_b16 a[202:203], v228 offset:10496
  v_mfma_f32_16x16x32_bf16 v[20:23], a[212:215], a[164:167], v[20:23]
  s_waitcnt lgkmcnt(8)
  v_mfma_f32_16x16x32_bf16 v[24:27], a[216:219], a[156:159], v[24:27]
  ds_read_b64_tr_b16 a[204:205], v239 offset:8448
  v_mfma_f32_16x16x32_bf16 v[28:31], a[216:219], a[160:163], v[28:31]
  ds_read_b64_tr_b16 a[206:207], v239 offset:10496
  v_mfma_f32_16x16x32_bf16 v[32:35], a[216:219], a[164:167], v[32:35]
  s_waitcnt lgkmcnt(8)
  v_mfma_f32_16x16x32_bf16 v[36:39], a[220:223], a[156:159], v[36:39]
  ds_read_b64_tr_b16 a[208:209], v228 offset:12288
  v_mfma_f32_16x16x32_bf16 v[40:43], a[220:223], a[160:163], v[40:43]
  buffer_load_dwordx4 v232, s[24:27], s29 offen offset:1024 lds
  v_mfma_f32_16x16x32_bf16 v[44:47], a[220:223], a[164:167], v[44:47]
  s_waitcnt lgkmcnt(7)
  ds_read_b64_tr_b16 a[210:211], v228 offset:14336
  v_mfma_f32_16x16x32_bf16 v[0:3], a[192:195], a[168:171], v[0:3]
  s_add_u32 s29, s29, s31
  ds_read_b64_tr_b16 a[212:213], v239 offset:12288
  v_mfma_f32_16x16x32_bf16 v[4:7], a[192:195], a[172:175], v[4:7]
  ds_read_b64_tr_b16 a[214:215], v239 offset:14336
  v_mfma_f32_16x16x32_bf16 v[8:11], a[192:195], a[176:179], v[8:11]
  s_waitcnt lgkmcnt(8)
  v_mfma_f32_16x16x32_bf16 v[12:15], a[196:199], a[168:171], v[12:15]
  ds_read_b64_tr_b16 a[216:217], v228 offset:12544
  v_mfma_f32_16x16x32_bf16 v[16:19], a[196:199], a[172:175], v[16:19]
  ds_read_b64_tr_b16 a[218:219], v228 offset:14592
  v_mfma_f32_16x16x32_bf16 v[20:23], a[196:199], a[176:179], v[20:23]
  s_waitcnt lgkmcnt(8)
  v_mfma_f32_16x16x32_bf16 v[24:27], a[200:203], a[168:171], v[24:27]
  ds_read_b64_tr_b16 a[220:221], v239 offset:12544
  v_mfma_f32_16x16x32_bf16 v[28:31], a[200:203], a[172:175], v[28:31]
  buffer_load_dwordx4 v232, s[24:27], s29 offen offset:2048 lds
  v_mfma_f32_16x16x32_bf16 v[32:35], a[200:203], a[176:179], v[32:35]
  s_waitcnt lgkmcnt(7)
  ds_read_b64_tr_b16 a[222:223], v239 offset:14592
  v_add_u32 v228, 32768, v229
  v_mfma_f32_16x16x32_bf16 v[36:39], a[204:207], a[168:171], v[36:39]
  s_add_u32 s29, s29, s31
  ds_read_b64_tr_b16 a[192:193], v228 offset:0
  v_xor_b32 v239, 32, v228
  v_mfma_f32_16x16x32_bf16 v[40:43], a[204:207], a[172:175], v[40:43]
  ds_read_b64_tr_b16 a[194:195], v228 offset:2048
  v_mfma_f32_16x16x32_bf16 v[44:47], a[204:207], a[176:179], v[44:47]
  s_waitcnt lgkmcnt(8)
  v_mfma_f32_16x16x32_bf16 v[0:3], a[208:211], a[180:183], v[0:3]
  ds_read_b64_tr_b16 a[196:197], v239 offset:0
  v_mfma_f32_16x16x32_bf16 v[4:7], a[208:211], a[184:187], v[4:7]
  ds_read_b64_tr_b16 a[198:199], v239 offset:2048
  v_mfma_f32_16x16x32_bf16 v[8:11], a[208:211], a[188:191], v[8:11]
  s_waitcnt lgkmcnt(8)
  v_mfma_f32_16x16x32_bf16 v[12:15], a[212:215], a[180:183], v[12:15]
  ds_read_b64_tr_b16 a[200:201], v228 offset:256
  v_mfma_f32_16x16x32_bf16 v[16:19], a[212:215], a[184:187], v[16:19]
  ds_read_b64_tr_b16 a[202:203], v228 offset:2304
  v_mfma_f32_16x16x32_bf16 v[20:23], a[212:215], a[188:191], v[20:23]
  s_waitcnt lgkmcnt(8)
  v_mfma_f32_16x16x32_bf16 v[24:27], a[216:219], a[180:183], v[24:27]
  ds_read_b64_tr_b16 a[204:205], v239 offset:256
  v_mfma_f32_16x16x32_bf16 v[28:31], a[216:219], a[184:187], v[28:31]
  buffer_load_dwordx4 v232, s[24:27], s29 offen offset:3072 lds
  v_mfma_f32_16x16x32_bf16 v[32:35], a[216:219], a[188:191], v[32:35]
  s_waitcnt lgkmcnt(7)
  ds_read_b64_tr_b16 a[206:207], v239 offset:2304
  v_mfma_f32_16x16x32_bf16 v[36:39], a[220:223], a[180:183], v[36:39]
  ds_read_b64_tr_b16 a[208:209], v228 offset:4096
  v_mfma_f32_16x16x32_bf16 v[40:43], a[220:223], a[184:187], v[40:43]
  ds_read_b64_tr_b16 a[210:211], v228 offset:6144
  v_mfma_f32_16x16x32_bf16 v[44:47], a[220:223], a[188:191], v[44:47]
  s_waitcnt lgkmcnt(8)
  v_mfma_f32_16x16x32_bf16 v[0:3], a[192:195], a[0:3], v[0:3]
  s_waitcnt vmcnt(4)
  ds_read_b64_tr_b16 a[212:213], v239 offset:4096
  v_mfma_f32_16x16x32_bf16 v[4:7], a[192:195], a[4:7], v[4:7]
  s_barrier
  ds_read_b64_tr_b16 a[214:215], v239 offset:6144
  v_mfma_f32_16x16x32_bf16 v[8:11], a[192:195], a[8:11], v[8:11]
  s_waitcnt lgkmcnt(8)
  v_mfma_f32_16x16x32_bf16 v[12:15], a[196:199], a[0:3], v[12:15]
  s_add_u32 m0, s28, 0
  ds_read_b64_tr_b16 a[216:217], v228 offset:4352
  v_mfma_f32_16x16x32_bf16 v[16:19], a[196:199], a[4:7], v[16:19]
  buffer_store_dwordx2 v[226:227], v246, s[76:79], s53 offen offset:0 sc1
  v_mfma_f32_16x16x32_bf16 v[20:23], a[196:199], a[8:11], v[20:23]
  s_waitcnt lgkmcnt(7)
  ds_read_b64_tr_b16 a[218:219], v228 offset:6400
  v_mfma_f32_16x16x32_bf16 v[24:27], a[200:203], a[0:3], v[24:27]
  s_add_u32 s29, s56, 344064
  ds_read_b64_tr_b16 a[220:221], v239 offset:4352
  v_mfma_f32_16x16x32_bf16 v[28:31], a[200:203], a[4:7], v[28:31]
  v_cmp_eq_u64 vcc, s[72:73], v[224:225]
  ds_read_b64_tr_b16 a[222:223], v239 offset:6400
  v_mfma_f32_16x16x32_bf16 v[32:35], a[200:203], a[8:11], v[32:35]
  s_waitcnt lgkmcnt(8)
  v_mfma_f32_16x16x32_bf16 v[36:39], a[204:207], a[0:3], v[36:39]
  s_and_b32 s74, vcc_lo, 0xff
  ds_read_b64_tr_b16 a[192:193], v228 offset:8192
  v_mfma_f32_16x16x32_bf16 v[40:43], a[204:207], a[4:7], v[40:43]
  buffer_load_dwordx4 v232, s[24:27], s29 offen offset:0 lds
  v_mfma_f32_16x16x32_bf16 v[44:47], a[204:207], a[8:11], v[44:47]
  s_waitcnt lgkmcnt(7)
  ds_read_b64_tr_b16 a[194:195], v228 offset:10240
  v_mfma_f32_16x16x32_bf16 v[0:3], a[208:211], a[12:15], v[0:3]
  s_cmp_lt_u32 s35, 7
  ds_read_b64_tr_b16 a[196:197], v239 offset:8192
  v_mfma_f32_16x16x32_bf16 v[4:7], a[208:211], a[16:19], v[4:7]
  s_cselect_b32 s74, s74, 0
  ds_read_b64_tr_b16 a[198:199], v239 offset:10240
  v_mfma_f32_16x16x32_bf16 v[8:11], a[208:211], a[20:23], v[8:11]
  s_waitcnt lgkmcnt(8)
  v_mfma_f32_16x16x32_bf16 v[12:15], a[212:215], a[12:15], v[12:15]
  s_and_b32 s74, s74, s87
  ds_read_b64_tr_b16 a[200:201], v228 offset:8448
  v_mfma_f32_16x16x32_bf16 v[16:19], a[212:215], a[16:19], v[16:19]
  s_bitcmp1_b32 s74, 0
  ds_read_b64_tr_b16 a[202:203], v228 offset:10496
  v_mfma_f32_16x16x32_bf16 v[20:23], a[212:215], a[20:23], v[20:23]
  s_waitcnt lgkmcnt(8)
  v_mfma_f32_16x16x32_bf16 v[24:27], a[216:219], a[12:15], v[24:27]
  s_cselect_b32 s66, 1376256, 0
  ds_read_b64_tr_b16 a[204:205], v239 offset:8448
  v_mfma_f32_16x16x32_bf16 v[28:31], a[216:219], a[16:19], v[28:31]
  s_cselect_b32 s36, 1, 0
  s_andn2_b32 s87, s87, s36
  buffer_load_dwordx4 v[168:171], v233, s[64:67], s80 offen offset:0 sc1
  v_mfma_f32_16x16x32_bf16 v[32:35], a[216:219], a[20:23], v[32:35]
  s_waitcnt lgkmcnt(7)
  ds_read_b64_tr_b16 a[206:207], v239 offset:10496
  v_mfma_f32_16x16x32_bf16 v[36:39], a[220:223], a[12:15], v[36:39]
  s_add_u32 s29, s29, s31
  ds_read_b64_tr_b16 a[208:209], v228 offset:12288
  v_mfma_f32_16x16x32_bf16 v[40:43], a[220:223], a[16:19], v[40:43]
  buffer_load_dwordx4 v232, s[24:27], s29 offen offset:1024 lds
  v_mfma_f32_16x16x32_bf16 v[44:47], a[220:223], a[20:23], v[44:47]
  s_waitcnt lgkmcnt(7)
  ds_read_b64_tr_b16 a[210:211], v228 offset:14336
  v_mfma_f32_16x16x32_bf16 v[0:3], a[192:195], a[24:27], v[0:3]
  s_add_u32 s29, s29, s31
  ds_read_b64_tr_b16 a[212:213], v239 offset:12288
  v_mfma_f32_16x16x32_bf16 v[4:7], a[192:195], a[28:31], v[4:7]
  ds_read_b64_tr_b16 a[214:215], v239 offset:14336
  v_mfma_f32_16x16x32_bf16 v[8:11], a[192:195], a[32:35], v[8:11]
  s_waitcnt lgkmcnt(8)
  v_mfma_f32_16x16x32_bf16 v[12:15], a[196:199], a[24:27], v[12:15]
  ds_read_b64_tr_b16 a[216:217], v228 offset:12544
  v_mfma_f32_16x16x32_bf16 v[16:19], a[196:199], a[28:31], v[16:19]
  buffer_load_dwordx4 v232, s[24:27], s29 offen offset:2048 lds
  v_mfma_f32_16x16x32_bf16 v[20:23], a[196:199], a[32:35], v[20:23]
  s_waitcnt lgkmcnt(7)
  ds_read_b64_tr_b16 a[218:219], v228 offset:14592
  v_mfma_f32_16x16x32_bf16 v[24:27], a[200:203], a[24:27], v[24:27]
  s_add_u32 s29, s29, s31
  ds_read_b64_tr_b16 a[220:221], v239 offset:12544
  v_mfma_f32_16x16x32_bf16 v[28:31], a[200:203], a[28:31], v[28:31]
  buffer_load_dwordx4 v[172:175], v233, s[64:67], s80 offen offset:1024 sc1
  v_mfma_f32_16x16x32_bf16 v[32:35], a[200:203], a[32:35], v[32:35]
  s_waitcnt lgkmcnt(7)
  ds_read_b64_tr_b16 a[222:223], v239 offset:14592
  v_add_u32 v228, 147456, v229
  v_mfma_f32_16x16x32_bf16 v[36:39], a[204:207], a[24:27], v[36:39]
  ds_read_b64_tr_b16 a[192:193], v228 offset:0
  v_xor_b32 v239, 32, v228
  v_mfma_f32_16x16x32_bf16 v[40:43], a[204:207], a[28:31], v[40:43]
  ds_read_b64_tr_b16 a[194:195], v228 offset:2048
  v_mfma_f32_16x16x32_bf16 v[44:47], a[204:207], a[32:35], v[44:47]
  s_waitcnt lgkmcnt(8)
  v_mfma_f32_16x16x32_bf16 v[0:3], a[208:211], a[36:39], v[0:3]
  ds_read_b64_tr_b16 a[196:197], v239 offset:0
  v_mfma_f32_16x16x32_bf16 v[4:7], a[208:211], a[40:43], v[4:7]
  ds_read_b64_tr_b16 a[198:199], v239 offset:2048
  v_mfma_f32_16x16x32_bf16 v[8:11], a[208:211], a[44:47], v[8:11]
  s_waitcnt lgkmcnt(8)
  v_mfma_f32_16x16x32_bf16 v[12:15], a[212:215], a[36:39], v[12:15]
  ds_read_b64_tr_b16 a[200:201], v228 offset:256
  v_mfma_f32_16x16x32_bf16 v[16:19], a[212:215], a[40:43], v[16:19]
  buffer_load_dwordx4 v232, s[24:27], s29 offen offset:3072 lds
  v_mfma_f32_16x16x32_bf16 v[20:23], a[212:215], a[44:47], v[20:23]
  s_waitcnt lgkmcnt(7)
  ds_read_b64_tr_b16 a[202:203], v228 offset:2304
  v_mfma_f32_16x16x32_bf16 v[24:27], a[216:219], a[36:39], v[24:27]
  ds_read_b64_tr_b16 a[204:205], v239 offset:256
  v_mfma_f32_16x16x32_bf16 v[28:31], a[216:219], a[40:43], v[28:31]
  buffer_load_dwordx4 v[176:179], v233, s[64:67], s80 offen offset:2048 sc1
  v_mfma_f32_16x16x32_bf16 v[32:35], a[216:219], a[44:47], v[32:35]
  s_waitcnt lgkmcnt(7)
  ds_read_b64_tr_b16 a[206:207], v239 offset:2304
  v_mfma_f32_16x16x32_bf16 v[36:39], a[220:223], a[36:39], v[36:39]
  ds_read_b64_tr_b16 a[208:209], v228 offset:4096
  v_mfma_f32_16x16x32_bf16 v[40:43], a[220:223], a[40:43], v[40:43]
  ds_read_b64_tr_b16 a[210:211], v228 offset:6144
  v_mfma_f32_16x16x32_bf16 v[44:47], a[220:223], a[44:47], v[44:47]
  s_waitcnt lgkmcnt(8)
  v_mfma_f32_16x16x32_bf16 v[0:3], a[192:195], a[48:51], v[0:3]
  s_waitcnt vmcnt(63)
  ds_read_b64_tr_b16 a[212:213], v239 offset:4096
  v_mfma_f32_16x16x32_bf16 v[4:7], a[192:195], a[52:55], v[4:7]
  s_barrier
  ds_read_b64_tr_b16 a[214:215], v239 offset:6144
  v_mfma_f32_16x16x32_bf16 v[8:11], a[192:195], a[56:59], v[8:11]
  s_waitcnt lgkmcnt(8)
  v_mfma_f32_16x16x32_bf16 v[12:15], a[196:199], a[48:51], v[12:15]
  s_add_u32 m0, s28, 32768
  ds_read_b64_tr_b16 a[216:217], v228 offset:4352
  v_mfma_f32_16x16x32_bf16 v[16:19], a[196:199], a[52:55], v[16:19]
  s_add_u32 s29, s57, 0
  ds_read_b64_tr_b16 a[218:219], v228 offset:6400
  v_mfma_f32_16x16x32_bf16 v[20:23], a[196:199], a[56:59], v[20:23]
  s_waitcnt lgkmcnt(8)
  v_mfma_f32_16x16x32_bf16 v[24:27], a[200:203], a[48:51], v[24:27]
  ds_read_b64_tr_b16 a[220:221], v239 offset:4352
  v_mfma_f32_16x16x32_bf16 v[28:31], a[200:203], a[52:55], v[28:31]
  buffer_load_dwordx4 v[180:183], v233, s[64:67], s80 offen offset:3072 sc1
  v_mfma_f32_16x16x32_bf16 v[32:35], a[200:203], a[56:59], v[32:35]
  s_waitcnt lgkmcnt(7)
  ds_read_b64_tr_b16 a[222:223], v239 offset:6400
  v_mfma_f32_16x16x32_bf16 v[36:39], a[204:207], a[48:51], v[36:39]
  ds_read_b64_tr_b16 a[192:193], v228 offset:8192
  v_mfma_f32_16x16x32_bf16 v[40:43], a[204:207], a[52:55], v[40:43]
  buffer_load_dwordx4 v232, s[24:27], s29 offen offset:0 lds
  v_mfma_f32_16x16x32_bf16 v[44:47], a[204:207], a[56:59], v[44:47]
  s_waitcnt lgkmcnt(7)
  ds_read_b64_tr_b16 a[194:195], v228 offset:10240
  v_mfma_f32_16x16x32_bf16 v[0:3], a[208:211], a[60:63], v[0:3]
  s_add_u32 s29, s29, s31
  ds_read_b64_tr_b16 a[196:197], v239 offset:8192
  v_mfma_f32_16x16x32_bf16 v[4:7], a[208:211], a[64:67], v[4:7]
  ds_read_b64_tr_b16 a[198:199], v239 offset:10240
  v_mfma_f32_16x16x32_bf16 v[8:11], a[208:211], a[68:71], v[8:11]
  s_waitcnt lgkmcnt(8)
  v_mfma_f32_16x16x32_bf16 v[12:15], a[212:215], a[60:63], v[12:15]
  ds_read_b64_tr_b16 a[200:201], v228 offset:8448
  v_mfma_f32_16x16x32_bf16 v[16:19], a[212:215], a[64:67], v[16:19]
  ds_read_b64_tr_b16 a[202:203], v228 offset:10496
  v_mfma_f32_16x16x32_bf16 v[20:23], a[212:215], a[68:71], v[20:23]
  s_waitcnt lgkmcnt(8)
  v_mfma_f32_16x16x32_bf16 v[24:27], a[216:219], a[60:63], v[24:27]
  ds_read_b64_tr_b16 a[204:205], v239 offset:8448
  v_mfma_f32_16x16x32_bf16 v[28:31], a[216:219], a[64:67], v[28:31]
  buffer_load_dwordx4 v[184:187], v238, s[64:67], s80 offen offset:0 sc1
  v_mfma_f32_16x16x32_bf16 v[32:35], a[216:219], a[68:71], v[32:35]
  s_waitcnt lgkmcnt(7)
  ds_read_b64_tr_b16 a[206:207], v239 offset:10496
  v_mfma_f32_16x16x32_bf16 v[36:39], a[220:223], a[60:63], v[36:39]
  ds_read_b64_tr_b16 a[208:209], v228 offset:12288
  v_mfma_f32_16x16x32_bf16 v[40:43], a[220:223], a[64:67], v[40:43]
  buffer_load_dwordx4 v232, s[24:27], s29 offen offset:1024 lds
  v_mfma_f32_16x16x32_bf16 v[44:47], a[220:223], a[68:71], v[44:47]
  s_waitcnt lgkmcnt(7)
  ds_read_b64_tr_b16 a[210:211], v228 offset:14336
  v_mfma_f32_16x16x32_bf16 v[0:3], a[192:195], a[72:75], v[0:3]
  s_add_u32 s29, s29, s31
  ds_read_b64_tr_b16 a[212:213], v239 offset:12288
  v_mfma_f32_16x16x32_bf16 v[4:7], a[192:195], a[76:79], v[4:7]
  ds_read_b64_tr_b16 a[214:215], v239 offset:14336
  v_mfma_f32_16x16x32_bf16 v[8:11], a[192:195], a[80:83], v[8:11]
  s_waitcnt lgkmcnt(8)
  v_mfma_f32_16x16x32_bf16 v[12:15], a[196:199], a[72:75], v[12:15]
  ds_read_b64_tr_b16 a[216:217], v228 offset:12544
  v_mfma_f32_16x16x32_bf16 v[16:19], a[196:199], a[76:79], v[16:19]
  ds_read_b64_tr_b16 a[218:219], v228 offset:14592
  v_mfma_f32_16x16x32_bf16 v[20:23], a[196:199], a[80:83], v[20:23]
  s_waitcnt lgkmcnt(8)
  v_mfma_f32_16x16x32_bf16 v[24:27], a[200:203], a[72:75], v[24:27]
  ds_read_b64_tr_b16 a[220:221], v239 offset:12544
  v_mfma_f32_16x16x32_bf16 v[28:31], a[200:203], a[76:79], v[28:31]
  buffer_load_dwordx4 v[188:191], v238, s[64:67], s80 offen offset:1024 sc1
  v_mfma_f32_16x16x32_bf16 v[32:35], a[200:203], a[80:83], v[32:35]
  s_waitcnt lgkmcnt(7)
  ds_read_b64_tr_b16 a[222:223], v239 offset:14592
  v_add_u32 v228, 49152, v229
  v_mfma_f32_16x16x32_bf16 v[36:39], a[204:207], a[72:75], v[36:39]
  ds_read_b64_tr_b16 a[192:193], v228 offset:0
  v_xor_b32 v239, 32, v228
  v_mfma_f32_16x16x32_bf16 v[40:43], a[204:207], a[76:79], v[40:43]
  buffer_load_dwordx4 v232, s[24:27], s29 offen offset:2048 lds
  v_mfma_f32_16x16x32_bf16 v[44:47], a[204:207], a[80:83], v[44:47]
  s_waitcnt lgkmcnt(7)
  ds_read_b64_tr_b16 a[194:195], v228 offset:2048
  v_mfma_f32_16x16x32_bf16 v[48:51], a[208:211], a[84:87], v[0:3]
  s_add_u32 s29, s29, s31
  ds_read_b64_tr_b16 a[196:197], v239 offset:0
  v_mfma_f32_16x16x32_bf16 v[52:55], a[208:211], a[88:91], v[4:7]
  ds_read_b64_tr_b16 a[198:199], v239 offset:2048
  v_mfma_f32_16x16x32_bf16 v[56:59], a[208:211], a[92:95], v[8:11]
  s_waitcnt lgkmcnt(8)
  v_mfma_f32_16x16x32_bf16 v[60:63], a[212:215], a[84:87], v[12:15]
  ds_read_b64_tr_b16 a[200:201], v228 offset:256
  v_mfma_f32_16x16x32_bf16 v[64:67], a[212:215], a[88:91], v[16:19]
  ds_read_b64_tr_b16 a[202:203], v228 offset:2304
  v_mfma_f32_16x16x32_bf16 v[68:71], a[212:215], a[92:95], v[20:23]
  s_waitcnt lgkmcnt(8)
  v_mfma_f32_16x16x32_bf16 v[72:75], a[216:219], a[84:87], v[24:27]
  ds_read_b64_tr_b16 a[204:205], v239 offset:256
  v_mfma_f32_16x16x32_bf16 v[76:79], a[216:219], a[88:91], v[28:31]
  buffer_load_dwordx4 v232, s[24:27], s29 offen offset:3072 lds
  v_mfma_f32_16x16x32_bf16 v[80:83], a[216:219], a[92:95], v[32:35]
  s_waitcnt lgkmcnt(7)
  ds_read_b64_tr_b16 a[206:207], v239 offset:2304
  v_mfma_f32_16x16x32_bf16 v[84:87], a[220:223], a[84:87], v[36:39]
  ds_read_b64_tr_b16 a[208:209], v228 offset:4096
  v_mfma_f32_16x16x32_bf16 v[88:91], a[220:223], a[88:91], v[40:43]
  ds_read_b64_tr_b16 a[210:211], v228 offset:6144
  v_mfma_f32_16x16x32_bf16 v[92:95], a[220:223], a[92:95], v[44:47]
  s_waitcnt lgkmcnt(8)
  v_mfma_f32_16x16x32_bf16 v[0:3], a[192:195], a[96:99], 0
  s_waitcnt vmcnt(63)
  ds_read_b64_tr_b16 a[212:213], v239 offset:4096
  v_mfma_f32_16x16x32_bf16 v[4:7], a[192:195], a[100:103], 0
  s_barrier
  ds_read_b64_tr_b16 a[214:215], v239 offset:6144
  v_mfma_f32_16x16x32_bf16 v[8:11], a[192:195], a[104:107], 0
  s_waitcnt lgkmcnt(8)
  v_mfma_f32_16x16x32_bf16 v[12:15], a[196:199], a[96:99], 0
  s_add_u32 m0, s28, 147456
  ds_read_b64_tr_b16 a[216:217], v228 offset:4352
  v_cvt_pk_bf16_f32 v96, v48, v49
  v_mfma_f32_16x16x32_bf16 v[16:19], a[196:199], a[100:103], 0
  s_add_u32 s29, s57, 114688
  ds_read_b64_tr_b16 a[218:219], v228 offset:6400
  v_cvt_pk_bf16_f32 v97, v50, v51
  v_mfma_f32_16x16x32_bf16 v[20:23], a[196:199], a[104:107], 0
  s_waitcnt lgkmcnt(8)
  v_cvt_pk_bf16_f32 v98, v60, v61
  v_cvt_pk_bf16_f32 v99, v62, v63
  v_mfma_f32_16x16x32_bf16 v[24:27], a[200:203], a[96:99], 0
  s_mul_i32 s50, s54, 192
  ds_read_b64_tr_b16 a[220:221], v239 offset:4352
  v_cvt_pk_bf16_f32 v100, v72, v73
  v_mfma_f32_16x16x32_bf16 v[28:31], a[200:203], a[100:103], 0
  s_add_u32 s51, s50, 4096
  buffer_load_dwordx4 v232, s[24:27], s29 offen offset:0 lds
  v_mfma_f32_16x16x32_bf16 v[32:35], a[200:203], a[104:107], 0
  s_waitcnt lgkmcnt(7)
  ds_read_b64_tr_b16 a[222:223], v239 offset:6400
  v_cvt_pk_bf16_f32 v101, v74, v75
  v_mfma_f32_16x16x32_bf16 v[36:39], a[204:207], a[96:99], 0
  s_add_u32 s29, s29, s31
  ds_read_b64_tr_b16 a[192:193], v228 offset:8192
  v_cvt_pk_bf16_f32 v102, v84, v85
  v_mfma_f32_16x16x32_bf16 v[40:43], a[204:207], a[100:103], 0
  buffer_store_dwordx4 v[96:99], v233, s[20:23], s50 offen offset:0 sc1
  v_mfma_f32_16x16x32_bf16 v[44:47], a[204:207], a[104:107], 0
  s_waitcnt lgkmcnt(7)
  ds_read_b64_tr_b16 a[194:195], v228 offset:10240
  v_cvt_pk_bf16_f32 v103, v86, v87
  v_mfma_f32_16x16x32_bf16 v[0:3], a[208:211], a[108:111], v[0:3]
  ds_read_b64_tr_b16 a[196:197], v239 offset:8192
  v_cvt_pk_bf16_f32 v104, v52, v53
  v_mfma_f32_16x16x32_bf16 v[4:7], a[208:211], a[112:115], v[4:7]
  ds_read_b64_tr_b16 a[198:199], v239 offset:10240
  v_cvt_pk_bf16_f32 v105, v54, v55
  v_mfma_f32_16x16x32_bf16 v[8:11], a[208:211], a[116:119], v[8:11]
  s_waitcnt lgkmcnt(8)
  v_cvt_pk_bf16_f32 v106, v64, v65
  v_cvt_pk_bf16_f32 v107, v66, v67
  v_mfma_f32_16x16x32_bf16 v[12:15], a[212:215], a[108:111], v[12:15]
  ds_read_b64_tr_b16 a[200:201], v228 offset:8448
  v_cvt_pk_bf16_f32 v108, v76, v77
  v_mfma_f32_16x16x32_bf16 v[16:19], a[212:215], a[112:115], v[16:19]
  buffer_store_dwordx4 v[100:103], v233, s[20:23], s50 offen offset:1024 sc1
  v_mfma_f32_16x16x32_bf16 v[20:23], a[212:215], a[116:119], v[20:23]
  s_waitcnt lgkmcnt(7)
  ds_read_b64_tr_b16 a[202:203], v228 offset:10496
  v_cvt_pk_bf16_f32 v109, v78, v79
  v_mfma_f32_16x16x32_bf16 v[24:27], a[216:219], a[108:111], v[24:27]
  ds_read_b64_tr_b16 a[204:205], v239 offset:8448
  v_cvt_pk_bf16_f32 v110, v88, v89
  v_mfma_f32_16x16x32_bf16 v[28:31], a[216:219], a[112:115], v[28:31]
  buffer_load_dwordx4 v232, s[24:27], s29 offen offset:1024 lds
  v_mfma_f32_16x16x32_bf16 v[32:35], a[216:219], a[116:119], v[32:35]
  s_waitcnt lgkmcnt(7)
  ds_read_b64_tr_b16 a[206:207], v239 offset:10496
  v_cvt_pk_bf16_f32 v111, v90, v91
  v_mfma_f32_16x16x32_bf16 v[36:39], a[220:223], a[108:111], v[36:39]
  s_add_u32 s29, s29, s31
  ds_read_b64_tr_b16 a[208:209], v228 offset:12288
  v_cvt_pk_bf16_f32 v112, v56, v57
  v_mfma_f32_16x16x32_bf16 v[40:43], a[220:223], a[112:115], v[40:43]
  buffer_store_dwordx4 v[104:107], v233, s[20:23], s50 offen offset:2048 sc1
  v_mfma_f32_16x16x32_bf16 v[44:47], a[220:223], a[116:119], v[44:47]
  s_waitcnt lgkmcnt(7)
  ds_read_b64_tr_b16 a[210:211], v228 offset:14336
  v_cvt_pk_bf16_f32 v113, v58, v59
  v_mfma_f32_16x16x32_bf16 v[0:3], a[192:195], a[120:123], v[0:3]
  ds_read_b64_tr_b16 a[212:213], v239 offset:12288
  v_cvt_pk_bf16_f32 v114, v68, v69
  v_mfma_f32_16x16x32_bf16 v[4:7], a[192:195], a[124:127], v[4:7]
  ds_read_b64_tr_b16 a[214:215], v239 offset:14336
  v_cvt_pk_bf16_f32 v115, v70, v71
  v_mfma_f32_16x16x32_bf16 v[8:11], a[192:195], a[128:131], v[8:11]
  s_waitcnt lgkmcnt(8)
  v_cvt_pk_bf16_f32 v116, v80, v81
  v_cvt_pk_bf16_f32 v117, v82, v83
  v_mfma_f32_16x16x32_bf16 v[12:15], a[196:199], a[120:123], v[12:15]
  ds_read_b64_tr_b16 a[216:217], v228 offset:12544
  v_cvt_pk_bf16_f32 v118, v92, v93
  v_mfma_f32_16x16x32_bf16 v[16:19], a[196:199], a[124:127], v[16:19]
  buffer_store_dwordx4 v[108:111], v233, s[20:23], s50 offen offset:3072 sc1
  v_mfma_f32_16x16x32_bf16 v[20:23], a[196:199], a[128:131], v[20:23]
  s_waitcnt lgkmcnt(7)
  ds_read_b64_tr_b16 a[218:219], v228 offset:14592
  v_cvt_pk_bf16_f32 v119, v94, v95
  v_mfma_f32_16x16x32_bf16 v[24:27], a[200:203], a[120:123], v[24:27]
  ds_read_b64_tr_b16 a[220:221], v239 offset:12544
  v_mfma_f32_16x16x32_bf16 v[28:31], a[200:203], a[124:127], v[28:31]
  buffer_load_dwordx4 v232, s[24:27], s29 offen offset:2048 lds
  v_mfma_f32_16x16x32_bf16 v[32:35], a[200:203], a[128:131], v[32:35]
  s_waitcnt lgkmcnt(7)
  ds_read_b64_tr_b16 a[222:223], v239 offset:14592
  v_add_u32 v228, 131072, v229
  v_mfma_f32_16x16x32_bf16 v[36:39], a[204:207], a[120:123], v[36:39]
  s_add_u32 s29, s29, s31
  ds_read_b64_tr_b16 a[192:193], v228 offset:0
  v_xor_b32 v239, 32, v228
  v_mfma_f32_16x16x32_bf16 v[40:43], a[204:207], a[124:127], v[40:43]
  buffer_store_dwordx4 v[112:115], v233, s[20:23], s51 offen offset:0 sc1
  v_mfma_f32_16x16x32_bf16 v[44:47], a[204:207], a[128:131], v[44:47]
  s_waitcnt lgkmcnt(7)
  ds_read_b64_tr_b16 a[194:195], v228 offset:2048
  v_mfma_f32_16x16x32_bf16 v[0:3], a[208:211], a[132:135], v[0:3]
  ds_read_b64_tr_b16 a[196:197], v239 offset:0
  v_mfma_f32_16x16x32_bf16 v[4:7], a[208:211], a[136:139], v[4:7]
  ds_read_b64_tr_b16 a[198:199], v239 offset:2048
  v_mfma_f32_16x16x32_bf16 v[8:11], a[208:211], a[140:143], v[8:11]
  s_waitcnt lgkmcnt(8)
  v_mfma_f32_16x16x32_bf16 v[12:15], a[212:215], a[132:135], v[12:15]
  ds_read_b64_tr_b16 a[200:201], v228 offset:256
  v_mfma_f32_16x16x32_bf16 v[16:19], a[212:215], a[136:139], v[16:19]
  buffer_store_dwordx4 v[116:119], v233, s[20:23], s51 offen offset:1024 sc1
  v_mfma_f32_16x16x32_bf16 v[20:23], a[212:215], a[140:143], v[20:23]
  s_waitcnt lgkmcnt(7)
  ds_read_b64_tr_b16 a[202:203], v228 offset:2304
  v_mfma_f32_16x16x32_bf16 v[24:27], a[216:219], a[132:135], v[24:27]
  ds_read_b64_tr_b16 a[204:205], v239 offset:256
  v_mfma_f32_16x16x32_bf16 v[28:31], a[216:219], a[136:139], v[28:31]
  buffer_load_dwordx4 v232, s[24:27], s29 offen offset:3072 lds
  v_mfma_f32_16x16x32_bf16 v[32:35], a[216:219], a[140:143], v[32:35]
  s_waitcnt lgkmcnt(7)
  ds_read_b64_tr_b16 a[206:207], v239 offset:2304
  v_mfma_f32_16x16x32_bf16 v[36:39], a[220:223], a[132:135], v[36:39]
  ds_read_b64_tr_b16 a[208:209], v228 offset:4096
  v_mfma_f32_16x16x32_bf16 v[40:43], a[220:223], a[136:139], v[40:43]
  ds_read_b64_tr_b16 a[210:211], v228 offset:6144
  v_mfma_f32_16x16x32_bf16 v[44:47], a[220:223], a[140:143], v[44:47]
  s_waitcnt lgkmcnt(8)
  v_mfma_f32_16x16x32_bf16 v[0:3], a[192:195], a[144:147], v[0:3]
  s_waitcnt vmcnt(63)
  ds_read_b64_tr_b16 a[212:213], v239 offset:4096
  v_mfma_f32_16x16x32_bf16 v[4:7], a[192:195], a[148:151], v[4:7]
  s_barrier
  ds_read_b64_tr_b16 a[214:215], v239 offset:6144
  v_mfma_f32_16x16x32_bf16 v[8:11], a[192:195], a[152:155], v[8:11]
  s_waitcnt lgkmcnt(8)
  v_mfma_f32_16x16x32_bf16 v[12:15], a[196:199], a[144:147], v[12:15]
  s_add_u32 m0, s28, 49152
  ds_read_b64_tr_b16 a[216:217], v228 offset:4352
  v_mfma_f32_16x16x32_bf16 v[16:19], a[196:199], a[148:151], v[16:19]
  buffer_load_dwordx2 v[224:225], v222, s[76:79], s58 offen offset:0 sc1
  v_mfma_f32_16x16x32_bf16 v[20:23], a[196:199], a[152:155], v[20:23]
  s_waitcnt lgkmcnt(7)
  ds_read_b64_tr_b16 a[218:219], v228 offset:6400
  v_mfma_f32_16x16x32_bf16 v[24:27], a[200:203], a[144:147], v[24:27]
  s_add_u32 s29, s57, 229376
  ds_read_b64_tr_b16 a[220:221], v239 offset:4352
  v_mfma_f32_16x16x32_bf16 v[28:31], a[200:203], a[148:151], v[28:31]
  ds_read_b64_tr_b16 a[222:223], v239 offset:6400
  v_mfma_f32_16x16x32_bf16 v[32:35], a[200:203], a[152:155], v[32:35]
  s_waitcnt lgkmcnt(8)
  v_mfma_f32_16x16x32_bf16 v[36:39], a[204:207], a[144:147], v[36:39]
  ds_read_b64_tr_b16 a[192:193], v228 offset:8192
  v_mfma_f32_16x16x32_bf16 v[40:43], a[204:207], a[148:151], v[40:43]
  buffer_load_dwordx4 v232, s[24:27], s29 offen offset:0 lds
  v_mfma_f32_16x16x32_bf16 v[44:47], a[204:207], a[152:155], v[44:47]
  s_waitcnt lgkmcnt(7)
  ds_read_b64_tr_b16 a[194:195], v228 offset:10240
  v_mfma_f32_16x16x32_bf16 v[0:3], a[208:211], a[156:159], v[0:3]
  s_add_u32 s29, s29, s31
  ds_read_b64_tr_b16 a[196:197], v239 offset:8192
  v_mfma_f32_16x16x32_bf16 v[4:7], a[208:211], a[160:163], v[4:7]
  ds_read_b64_tr_b16 a[198:199], v239 offset:10240
  v_mfma_f32_16x16x32_bf16 v[8:11], a[208:211], a[164:167], v[8:11]
  s_waitcnt lgkmcnt(8)
  v_mfma_f32_16x16x32_bf16 v[12:15], a[212:215], a[156:159], v[12:15]
  ds_read_b64_tr_b16 a[200:201], v228 offset:8448
  v_mfma_f32_16x16x32_bf16 v[16:19], a[212:215], a[160:163], v[16:19]
  ds_read_b64_tr_b16 a[202:203], v228 offset:10496
  v_mfma_f32_16x16x32_bf16 v[20:23], a[212:215], a[164:167], v[20:23]
  s_waitcnt lgkmcnt(8)
  v_mfma_f32_16x16x32_bf16 v[24:27], a[216:219], a[156:159], v[24:27]
  ds_read_b64_tr_b16 a[204:205], v239 offset:8448
  v_mfma_f32_16x16x32_bf16 v[28:31], a[216:219], a[160:163], v[28:31]
  ds_read_b64_tr_b16 a[206:207], v239 offset:10496
  v_mfma_f32_16x16x32_bf16 v[32:35], a[216:219], a[164:167], v[32:35]
  s_waitcnt lgkmcnt(8)
  v_mfma_f32_16x16x32_bf16 v[36:39], a[220:223], a[156:159], v[36:39]
  ds_read_b64_tr_b16 a[208:209], v228 offset:12288
  v_mfma_f32_16x16x32_bf16 v[40:43], a[220:223], a[160:163], v[40:43]
  buffer_load_dwordx4 v232, s[24:27], s29 offen offset:1024 lds
  v_mfma_f32_16x16x32_bf16 v[44:47], a[220:223], a[164:167], v[44:47]
  s_waitcnt lgkmcnt(7)
  ds_read_b64_tr_b16 a[210:211], v228 offset:14336
  v_mfma_f32_16x16x32_bf16 v[0:3], a[192:195], a[168:171], v[0:3]
  s_add_u32 s29, s29, s31
  ds_read_b64_tr_b16 a[212:213], v239 offset:12288
  v_mfma_f32_16x16x32_bf16 v[4:7], a[192:195], a[172:175], v[4:7]
  ds_read_b64_tr_b16 a[214:215], v239 offset:14336
  v_mfma_f32_16x16x32_bf16 v[8:11], a[192:195], a[176:179], v[8:11]
  s_waitcnt lgkmcnt(8)
  v_mfma_f32_16x16x32_bf16 v[12:15], a[196:199], a[168:171], v[12:15]
  ds_read_b64_tr_b16 a[216:217], v228 offset:12544
  v_mfma_f32_16x16x32_bf16 v[16:19], a[196:199], a[172:175], v[16:19]
  ds_read_b64_tr_b16 a[218:219], v228 offset:14592
  v_mfma_f32_16x16x32_bf16 v[20:23], a[196:199], a[176:179], v[20:23]
  s_waitcnt lgkmcnt(8)
  v_mfma_f32_16x16x32_bf16 v[24:27], a[200:203], a[168:171], v[24:27]
  ds_read_b64_tr_b16 a[220:221], v239 offset:12544
  v_mfma_f32_16x16x32_bf16 v[28:31], a[200:203], a[172:175], v[28:31]
  buffer_load_dwordx4 v232, s[24:27], s29 offen offset:2048 lds
  v_mfma_f32_16x16x32_bf16 v[32:35], a[200:203], a[176:179], v[32:35]
  s_waitcnt lgkmcnt(7)
  ds_read_b64_tr_b16 a[222:223], v239 offset:14592
  v_add_u32 v228, 65536, v229
  v_mfma_f32_16x16x32_bf16 v[36:39], a[204:207], a[168:171], v[36:39]
  s_add_u32 s29, s29, s31
  ds_read_b64_tr_b16 a[192:193], v228 offset:0
  v_xor_b32 v239, 32, v228
  v_mfma_f32_16x16x32_bf16 v[40:43], a[204:207], a[172:175], v[40:43]
  ds_read_b64_tr_b16 a[194:195], v228 offset:2048
  v_mfma_f32_16x16x32_bf16 v[44:47], a[204:207], a[176:179], v[44:47]
  s_waitcnt lgkmcnt(8)
  v_mfma_f32_16x16x32_bf16 v[0:3], a[208:211], a[180:183], v[0:3]
  ds_read_b64_tr_b16 a[196:197], v239 offset:0
  v_mfma_f32_16x16x32_bf16 v[4:7], a[208:211], a[184:187], v[4:7]
  ds_read_b64_tr_b16 a[198:199], v239 offset:2048
  v_mfma_f32_16x16x32_bf16 v[8:11], a[208:211], a[188:191], v[8:11]
  s_waitcnt lgkmcnt(8)
  v_mfma_f32_16x16x32_bf16 v[12:15], a[212:215], a[180:183], v[12:15]
  ds_read_b64_tr_b16 a[200:201], v228 offset:256
  v_mfma_f32_16x16x32_bf16 v[16:19], a[212:215], a[184:187], v[16:19]
  ds_read_b64_tr_b16 a[202:203], v228 offset:2304
  v_mfma_f32_16x16x32_bf16 v[20:23], a[212:215], a[188:191], v[20:23]
  s_waitcnt lgkmcnt(8)
  v_mfma_f32_16x16x32_bf16 v[24:27], a[216:219], a[180:183], v[24:27]
  ds_read_b64_tr_b16 a[204:205], v239 offset:256
  v_mfma_f32_16x16x32_bf16 v[28:31], a[216:219], a[184:187], v[28:31]
  buffer_load_dwordx4 v232, s[24:27], s29 offen offset:3072 lds
  v_mfma_f32_16x16x32_bf16 v[32:35], a[216:219], a[188:191], v[32:35]
  s_waitcnt lgkmcnt(7)
  ds_read_b64_tr_b16 a[206:207], v239 offset:2304
  v_mfma_f32_16x16x32_bf16 v[36:39], a[220:223], a[180:183], v[36:39]
  ds_read_b64_tr_b16 a[208:209], v228 offset:4096
  v_mfma_f32_16x16x32_bf16 v[40:43], a[220:223], a[184:187], v[40:43]
  ds_read_b64_tr_b16 a[210:211], v228 offset:6144
  v_mfma_f32_16x16x32_bf16 v[44:47], a[220:223], a[188:191], v[44:47]
  s_cmp_eq_u32 s35, 7
  s_cbranch_scc1 L_sk1
  s_waitcnt vmcnt(17)
  v_mfma_f32_16x16x32_bf16 v[120:123], v[250:253], v[168:171], 0
  v_mfma_f32_16x16x32_bf16 v[132:135], v[248:251], v[168:171], 0
  v_mfma_f32_16x16x32_bf16 v[144:147], v[250:253], v[172:175], 0
  v_mfma_f32_16x16x32_bf16 v[156:159], v[248:251], v[172:175], 0
  v_mfma_f32_16x16x32_bf16 v[124:127], v[250:253], v[176:179], 0
  v_mfma_f32_16x16x32_bf16 v[136:139], v[248:251], v[176:179], 0
  v_mfma_f32_16x16x32_bf16 v[148:151], v[250:253], v[180:183], 0
  v_mfma_f32_16x16x32_bf16 v[160:163], v[248:251], v[180:183], 0
  v_mfma_f32_16x16x32_bf16 v[128:131], v[250:253], v[184:187], 0
  v_mfma_f32_16x16x32_bf16 v[140:143], v[248:251], v[184:187], 0
  v_mfma_f32_16x16x32_bf16 v[152:155], v[250:253], v[188:191], 0
  v_mfma_f32_16x16x32_bf16 v[164:167], v[248:251], v[188:191], 0
L_sk1:
  s_waitcnt lgkmcnt(8)
  v_mfma_f32_16x16x32_bf16 v[0:3], a[192:195], a[0:3], v[0:3]
  s_waitcnt vmcnt(4)
  ds_read_b64_tr_b16 a[212:213], v239 offset:4096
  v_mfma_f32_16x16x32_bf16 v[4:7], a[192:195], a[4:7], v[4:7]
  s_barrier
  ds_read_b64_tr_b16 a[214:215], v239 offset:6144
  v_mfma_f32_16x16x32_bf16 v[8:11], a[192:195], a[8:11], v[8:11]
  s_waitcnt lgkmcnt(8)
  v_mfma_f32_16x16x32_bf16 v[12:15], a[196:199], a[0:3], v[12:15]
  s_add_u32 m0, s28, 131072
  ds_read_b64_tr_b16 a[216:217], v228 offset:4352
  v_mfma_f32_16x16x32_bf16 v[16:19], a[196:199], a[4:7], v[16:19]
  buffer_store_dwordx2 v[226:227], v246, s[76:79], s54 offen offset:0 sc1
  v_mfma_f32_16x16x32_bf16 v[20:23], a[196:199], a[8:11], v[20:23]
  s_waitcnt lgkmcnt(7)
  ds_read_b64_tr_b16 a[218:219], v228 offset:6400
  v_mfma_f32_16x16x32_bf16 v[24:27], a[200:203], a[0:3], v[24:27]
  s_add_u32 s29, s57, 344064
  ds_read_b64_tr_b16 a[220:221], v239 offset:4352
  v_mfma_f32_16x16x32_bf16 v[28:31], a[200:203], a[4:7], v[28:31]
  v_cmp_eq_u64 vcc, s[72:73], v[224:225]
  ds_read_b64_tr_b16 a[222:223], v239 offset:6400
  v_mfma_f32_16x16x32_bf16 v[32:35], a[200:203], a[8:11], v[32:35]
  s_waitcnt lgkmcnt(8)
  v_mfma_f32_16x16x32_bf16 v[36:39], a[204:207], a[0:3], v[36:39]
  s_and_b32 s74, vcc_lo, 0xff
  ds_read_b64_tr_b16 a[192:193], v228 offset:8192
  v_mfma_f32_16x16x32_bf16 v[40:43], a[204:207], a[4:7], v[40:43]
  buffer_load_dwordx4 v232, s[24:27], s29 offen offset:0 lds
  v_mfma_f32_16x16x32_bf16 v[44:47], a[204:207], a[8:11], v[44:47]
  s_waitcnt lgkmcnt(7)
  ds_read_b64_tr_b16 a[194:195], v228 offset:10240
  v_mfma_f32_16x16x32_bf16 v[0:3], a[208:211], a[12:15], v[0:3]
  s_cmp_lt_u32 s35, 7
  ds_read_b64_tr_b16 a[196:197], v239 offset:8192
  v_mfma_f32_16x16x32_bf16 v[4:7], a[208:211], a[16:19], v[4:7]
  s_cselect_b32 s74, s74, 0
  ds_read_b64_tr_b16 a[198:199], v239 offset:10240
  v_mfma_f32_16x16x32_bf16 v[8:11], a[208:211], a[20:23], v[8:11]
  s_waitcnt lgkmcnt(8)
  v_mfma_f32_16x16x32_bf16 v[12:15], a[212:215], a[12:15], v[12:15]
  s_and_b32 s74, s74, s87
  ds_read_b64_tr_b16 a[200:201], v228 offset:8448
  v_mfma_f32_16x16x32_bf16 v[16:19], a[212:215], a[16:19], v[16:19]
  s_bitcmp1_b32 s74, 1
  ds_read_b64_tr_b16 a[202:203], v228 offset:10496
  v_mfma_f32_16x16x32_bf16 v[20:23], a[212:215], a[20:23], v[20:23]
  s_waitcnt lgkmcnt(8)
  v_mfma_f32_16x16x32_bf16 v[24:27], a[216:219], a[12:15], v[24:27]
  s_cselect_b32 s66, 1376256, 0
  ds_read_b64_tr_b16 a[204:205], v239 offset:8448
  v_mfma_f32_16x16x32_bf16 v[28:31], a[216:219], a[16:19], v[28:31]
  s_cselect_b32 s36, 2, 0
  s_andn2_b32 s87, s87, s36
  buffer_load_dwordx4 a[224:227], v233, s[64:67], s81 offen offset:0 sc1
  v_mfma_f32_16x16x32_bf16 v[32:35], a[216:219], a[20:23], v[32:35]
  s_waitcnt lgkmcnt(7)
  ds_read_b64_tr_b16 a[206:207], v239 offset:10496
  v_mfma_f32_16x16x32_bf16 v[36:39], a[220:223], a[12:15], v[36:39]
  s_add_u32 s29, s29, s31
  ds_read_b64_tr_b16 a[208:209], v228 offset:12288
  v_mfma_f32_16x16x32_bf16 v[40:43], a[220:223], a[16:19], v[40:43]
  buffer_load_dwordx4 v232, s[24:27], s29 offen offset:1024 lds
  v_mfma_f32_16x16x32_bf16 v[44:47], a[220:223], a[20:23], v[44:47]
  s_waitcnt lgkmcnt(7)
  ds_read_b64_tr_b16 a[210:211], v228 offset:14336
  v_mfma_f32_16x16x32_bf16 v[0:3], a[192:195], a[24:27], v[0:3]
  s_add_u32 s29, s29, s31
  ds_read_b64_tr_b16 a[212:213], v239 offset:12288
  v_mfma_f32_16x16x32_bf16 v[4:7], a[192:195], a[28:31], v[4:7]
  ds_read_b64_tr_b16 a[214:215], v239 offset:14336
  v_mfma_f32_16x16x32_bf16 v[8:11], a[192:195], a[32:35], v[8:11]
  s_waitcnt lgkmcnt(8)
  v_mfma_f32_16x16x32_bf16 v[12:15], a[196:199], a[24:27], v[12:15]
  ds_read_b64_tr_b16 a[216:217], v228 offset:12544
  v_mfma_f32_16x16x32_bf16 v[16:19], a[196:199], a[28:31], v[16:19]
  buffer_load_dwordx4 v232, s[24:27], s29 offen offset:2048 lds
  v_mfma_f32_16x16x32_bf16 v[20:23], a[196:199], a[32:35], v[20:23]
  s_waitcnt lgkmcnt(7)
  ds_read_b64_tr_b16 a[218:219], v228 offset:14592
  v_mfma_f32_16x16x32_bf16 v[24:27], a[200:203], a[24:27], v[24:27]
  s_add_u32 s29, s29, s31
  ds_read_b64_tr_b16 a[220:221], v239 offset:12544
  v_mfma_f32_16x16x32_bf16 v[28:31], a[200:203], a[28:31], v[28:31]
  buffer_load_dwordx4 a[228:231], v233, s[64:67], s81 offen offset:1024 sc1
  v_mfma_f32_16x16x32_bf16 v[32:35], a[200:203], a[32:35], v[32:35]
  s_waitcnt lgkmcnt(7)
  ds_read_b64_tr_b16 a[222:223], v239 offset:14592
  v_add_u32 v228, 98304, v229
  v_mfma_f32_16x16x32_bf16 v[36:39], a[204:207], a[24:27], v[36:39]
  ds_read_b64_tr_b16 a[192:193], v228 offset:0
  v_xor_b32 v239, 32, v228
  v_mfma_f32_16x16x32_bf16 v[40:43], a[204:207], a[28:31], v[40:43]
  ds_read_b64_tr_b16 a[194:195], v228 offset:2048
  v_mfma_f32_16x16x32_bf16 v[44:47], a[204:207], a[32:35], v[44:47]
  s_waitcnt lgkmcnt(8)
  v_mfma_f32_16x16x32_bf16 v[0:3], a[208:211], a[36:39], v[0:3]
  ds_read_b64_tr_b16 a[196:197], v239 offset:0
  v_mfma_f32_16x16x32_bf16 v[4:7], a[208:211], a[40:43], v[4:7]
  ds_read_b64_tr_b16 a[198:199], v239 offset:2048
  v_mfma_f32_16x16x32_bf16 v[8:11], a[208:211], a[44:47], v[8:11]
  s_waitcnt lgkmcnt(8)
  v_mfma_f32_16x16x32_bf16 v[12:15], a[212:215], a[36:39], v[12:15]
  ds_read_b64_tr_b16 a[200:201], v228 offset:256
  v_mfma_f32_16x16x32_bf16 v[16:19], a[212:215], a[40:43], v[16:19]
  buffer_load_dwordx4 v232, s[24:27], s29 offen offset:3072 lds
  v_mfma_f32_16x16x32_bf16 v[20:23], a[212:215], a[44:47], v[20:23]
  s_waitcnt lgkmcnt(7)
  ds_read_b64_tr_b16 a[202:203], v228 offset:2304
  v_mfma_f32_16x16x32_bf16 v[24:27], a[216:219], a[36:39], v[24:27]
  ds_read_b64_tr_b16 a[204:205], v239 offset:256
  v_mfma_f32_16x16x32_bf16 v[28:31], a[216:219], a[40:43], v[28:31]
  buffer_load_dwordx4 a[232:235], v233, s[64:67], s81 offen offset:2048 sc1
  v_mfma_f32_16x16x32_bf16 v[32:35], a[216:219], a[44:47], v[32:35]
  s_waitcnt lgkmcnt(7)
  ds_read_b64_tr_b16 a[206:207], v239 offset:2304
  v_mfma_f32_16x16x32_bf16 v[36:39], a[220:223], a[36:39], v[36:39]
  ds_read_b64_tr_b16 a[208:209], v228 offset:4096
  v_mfma_f32_16x16x32_bf16 v[40:43], a[220:223], a[40:43], v[40:43]
  ds_read_b64_tr_b16 a[210:211], v228 offset:6144
  v_mfma_f32_16x16x32_bf16 v[44:47], a[220:223], a[44:47], v[44:47]
  s_waitcnt lgkmcnt(8)
  v_mfma_f32_16x16x32_bf16 v[0:3], a[192:195], a[48:51], v[0:3]
  s_waitcnt vmcnt(63)
  ds_read_b64_tr_b16 a[212:213], v239 offset:4096
  v_mfma_f32_16x16x32_bf16 v[4:7], a[192:195], a[52:55], v[4:7]
  s_barrier
  ds_read_b64_tr_b16 a[214:215], v239 offset:6144
  v_mfma_f32_16x16x32_bf16 v[8:11], a[192:195], a[56:59], v[8:11]
  s_waitcnt lgkmcnt(8)
  v_mfma_f32_16x16x32_bf16 v[12:15], a[196:199], a[48:51], v[12:15]
  s_add_u32 m0, s28, 65536
  ds_read_b64_tr_b16 a[216:217], v228 offset:4352
  v_mfma_f32_16x16x32_bf16 v[16:19], a[196:199], a[52:55], v[16:19]
  s_add_u32 s29, s58, 0
  ds_read_b64_tr_b16 a[218:219], v228 offset:6400
  v_mfma_f32_16x16x32_bf16 v[20:23], a[196:199], a[56:59], v[20:23]
  s_waitcnt lgkmcnt(8)
  v_mfma_f32_16x16x32_bf16 v[24:27], a[200:203], a[48:51], v[24:27]
  ds_read_b64_tr_b16 a[220:221], v239 offset:4352
  v_mfma_f32_16x16x32_bf16 v[28:31], a[200:203], a[52:55], v[28:31]
  buffer_load_dwordx4 a[236:239], v233, s[64:67], s81 offen offset:3072 sc1
  v_mfma_f32_16x16x32_bf16 v[32:35], a[200:203], a[56:59], v[32:35]
  s_waitcnt lgkmcnt(7)
  ds_read_b64_tr_b16 a[222:223], v239 offset:6400
  v_mfma_f32_16x16x32_bf16 v[36:39], a[204:207], a[48:51], v[36:39]
  ds_read_b64_tr_b16 a[192:193], v228 offset:8192
  v_mfma_f32_16x16x32_bf16 v[40:43], a[204:207], a[52:55], v[40:43]
  buffer_load_dwordx4 v232, s[24:27], s29 offen offset:0 lds
  v_mfma_f32_16x16x32_bf16 v[44:47], a[204:207], a[56:59], v[44:47]
  s_waitcnt lgkmcnt(7)
  ds_read_b64_tr_b16 a[194:195], v228 offset:10240
  v_mfma_f32_16x16x32_bf16 v[0:3], a[208:211], a[60:63], v[0:3]
  s_add_u32 s29, s29, s31
  ds_read_b64_tr_b16 a[196:197], v239 offset:8192
  v_mfma_f32_16x16x32_bf16 v[4:7], a[208:211], a[64:67], v[4:7]
  ds_read_b64_tr_b16 a[198:199], v239 offset:10240
  v_mfma_f32_16x16x32_bf16 v[8:11], a[208:211], a[68:71], v[8:11]
  s_waitcnt lgkmcnt(8)
  v_mfma_f32_16x16x32_bf16 v[12:15], a[212:215], a[60:63], v[12:15]
  ds_read_b64_tr_b16 a[200:201], v228 offset:8448
  v_mfma_f32_16x16x32_bf16 v[16:19], a[212:215], a[64:67], v[16:19]
  ds_read_b64_tr_b16 a[202:203], v228 offset:10496
  v_mfma_f32_16x16x32_bf16 v[20:23], a[212:215], a[68:71], v[20:23]
  s_waitcnt lgkmcnt(8)
  v_mfma_f32_16x16x32_bf16 v[24:27], a[216:219], a[60:63], v[24:27]
  ds_read_b64_tr_b16 a[204:205], v239 offset:8448
  v_mfma_f32_16x16x32_bf16 v[28:31], a[216:219], a[64:67], v[28:31]
  buffer_load_dwordx4 a[240:243], v238, s[64:67], s81 offen offset:0 sc1
  v_mfma_f32_16x16x32_bf16 v[32:35], a[216:219], a[68:71], v[32:35]
  s_waitcnt lgkmcnt(7)
  ds_read_b64_tr_b16 a[206:207], v239 offset:10496
  v_mfma_f32_16x16x32_bf16 v[36:39], a[220:223], a[60:63], v[36:39]
  ds_read_b64_tr_b16 a[208:209], v228 offset:12288
  v_mfma_f32_16x16x32_bf16 v[40:43], a[220:223], a[64:67], v[40:43]
  buffer_load_dwordx4 v232, s[24:27], s29 offen offset:1024 lds
  v_mfma_f32_16x16x32_bf16 v[44:47], a[220:223], a[68:71], v[44:47]
  s_waitcnt lgkmcnt(7)
  ds_read_b64_tr_b16 a[210:211], v228 offset:14336
  v_mfma_f32_16x16x32_bf16 v[0:3], a[192:195], a[72:75], v[0:3]
  s_add_u32 s29, s29, s31
  ds_read_b64_tr_b16 a[212:213], v239 offset:12288
  v_mfma_f32_16x16x32_bf16 v[4:7], a[192:195], a[76:79], v[4:7]
  ds_read_b64_tr_b16 a[214:215], v239 offset:14336
  v_mfma_f32_16x16x32_bf16 v[8:11], a[192:195], a[80:83], v[8:11]
  s_waitcnt lgkmcnt(8)
  v_mfma_f32_16x16x32_bf16 v[12:15], a[196:199], a[72:75], v[12:15]
  ds_read_b64_tr_b16 a[216:217], v228 offset:12544
  v_mfma_f32_16x16x32_bf16 v[16:19], a[196:199], a[76:79], v[16:19]
  ds_read_b64_tr_b16 a[218:219], v228 offset:14592
  v_mfma_f32_16x16x32_bf16 v[20:23], a[196:199], a[80:83], v[20:23]
  s_waitcnt lgkmcnt(8)
  v_mfma_f32_16x16x32_bf16 v[24:27], a[200:203], a[72:75], v[24:27]
  ds_read_b64_tr_b16 a[220:221], v239 offset:12544
  v_mfma_f32_16x16x32_bf16 v[28:31], a[200:203], a[76:79], v[28:31]
  buffer_load_dwordx4 a[244:247], v238, s[64:67], s81 offen offset:1024 sc1
  v_mfma_f32_16x16x32_bf16 v[32:35], a[200:203], a[80:83], v[32:35]
  s_waitcnt lgkmcnt(7)
  ds_read_b64_tr_b16 a[222:223], v239 offset:14592
  v_add_u32 v228, 16384, v229
  v_mfma_f32_16x16x32_bf16 v[36:39], a[204:207], a[72:75], v[36:39]
  ds_read_b64_tr_b16 a[192:193], v228 offset:0
  v_xor_b32 v239, 32, v228
  v_mfma_f32_16x16x32_bf16 v[40:43], a[204:207], a[76:79], v[40:43]
  buffer_load_dwordx4 v232, s[24:27], s29 offen offset:2048 lds
  v_mfma_f32_16x16x32_bf16 v[44:47], a[204:207], a[80:83], v[44:47]
  s_waitcnt lgkmcnt(7)
  ds_read_b64_tr_b16 a[194:195], v228 offset:2048
  v_mfma_f32_16x16x32_bf16 v[48:51], a[208:211], a[84:87], v[0:3]
  s_add_u32 s29, s29, s31
  ds_read_b64_tr_b16 a[196:197], v239 offset:0
  v_mfma_f32_16x16x32_bf16 v[52:55], a[208:211], a[88:91], v[4:7]
  ds_read_b64_tr_b16 a[198:199], v239 offset:2048
  v_mfma_f32_16x16x32_bf16 v[56:59], a[208:211], a[92:95], v[8:11]
  s_waitcnt lgkmcnt(8)
  v_mfma_f32_16x16x32_bf16 v[60:63], a[212:215], a[84:87], v[12:15]
  ds_read_b64_tr_b16 a[200:201], v228 offset:256
  v_mfma_f32_16x16x32_bf16 v[64:67], a[212:215], a[88:91], v[16:19]
  ds_read_b64_tr_b16 a[202:203], v228 offset:2304
  v_mfma_f32_16x16x32_bf16 v[68:71], a[212:215], a[92:95], v[20:23]
  s_waitcnt lgkmcnt(8)
  v_mfma_f32_16x16x32_bf16 v[72:75], a[216:219], a[84:87], v[24:27]
  ds_read_b64_tr_b16 a[204:205], v239 offset:256
  v_mfma_f32_16x16x32_bf16 v[76:79], a[216:219], a[88:91], v[28:31]
  buffer_load_dwordx4 v232, s[24:27], s29 offen offset:3072 lds
  v_mfma_f32_16x16x32_bf16 v[80:83], a[216:219], a[92:95], v[32:35]
  s_waitcnt lgkmcnt(7)
  ds_read_b64_tr_b16 a[206:207], v239 offset:2304
  v_mfma_f32_16x16x32_bf16 v[84:87], a[220:223], a[84:87], v[36:39]
  ds_read_b64_tr_b16 a[208:209], v228 offset:4096
  v_mfma_f32_16x16x32_bf16 v[88:91], a[220:223], a[88:91], v[40:43]
  ds_read_b64_tr_b16 a[210:211], v228 offset:6144
  v_mfma_f32_16x16x32_bf16 v[92:95], a[220:223], a[92:95], v[44:47]
  s_waitcnt lgkmcnt(8)
  v_mfma_f32_16x16x32_bf16 v[0:3], a[192:195], a[96:99], 0
  s_waitcnt vmcnt(63)
  ds_read_b64_tr_b16 a[212:213], v239 offset:4096
  v_mfma_f32_16x16x32_bf16 v[4:7], a[192:195], a[100:103], 0
  s_barrier
  ds_read_b64_tr_b16 a[214:215], v239 offset:6144
  v_mfma_f32_16x16x32_bf16 v[8:11], a[192:195], a[104:107], 0
  s_waitcnt lgkmcnt(8)
  v_mfma_f32_16x16x32_bf16 v[12:15], a[196:199], a[96:99], 0
  s_add_u32 m0, s28, 98304
  ds_read_b64_tr_b16 a[216:217], v228 offset:4352
  v_cvt_pk_bf16_f32 v96, v48, v49
  v_mfma_f32_16x16x32_bf16 v[16:19], a[196:199], a[100:103], 0
  s_add_u32 s29, s58, 114688
  ds_read_b64_tr_b16 a[218:219], v228 offset:6400
  v_cvt_pk_bf16_f32 v97, v50, v51
  v_mfma_f32_16x16x32_bf16 v[20:23], a[196:199], a[104:107], 0
  s_waitcnt lgkmcnt(8)
  v_cvt_pk_bf16_f32 v98, v60, v61
  v_cvt_pk_bf16_f32 v99, v62, v63
  v_mfma_f32_16x16x32_bf16 v[24:27], a[200:203], a[96:99], 0
  s_mul_i32 s50, s55, 192
  ds_read_b64_tr_b16 a[220:221], v239 offset:4352
  v_cvt_pk_bf16_f32 v100, v72, v73
  v_mfma_f32_16x16x32_bf16 v[28:31], a[200:203], a[100:103], 0
  s_add_u32 s51, s50, 4096
  buffer_load_dwordx4 v232, s[24:27], s29 offen offset:0 lds
  v_mfma_f32_16x16x32_bf16 v[32:35], a[200:203], a[104:107], 0
  s_waitcnt lgkmcnt(7)
  ds_read_b64_tr_b16 a[222:223], v239 offset:6400
  v_cvt_pk_bf16_f32 v101, v74, v75
  v_mfma_f32_16x16x32_bf16 v[36:39], a[204:207], a[96:99], 0
  s_add_u32 s29, s29, s31
  ds_read_b64_tr_b16 a[192:193], v228 offset:8192
  v_cvt_pk_bf16_f32 v102, v84, v85
  v_mfma_f32_16x16x32_bf16 v[40:43], a[204:207], a[100:103], 0
  buffer_store_dwordx4 v[96:99], v233, s[20:23], s50 offen offset:0 sc1
  v_mfma_f32_16x16x32_bf16 v[44:47], a[204:207], a[104:107], 0
  s_waitcnt lgkmcnt(7)
  ds_read_b64_tr_b16 a[194:195], v228 offset:10240
  v_cvt_pk_bf16_f32 v103, v86, v87
  v_mfma_f32_16x16x32_bf16 v[0:3], a[208:211], a[108:111], v[0:3]
  ds_read_b64_tr_b16 a[196:197], v239 offset:8192
  v_cvt_pk_bf16_f32 v104, v52, v53
  v_mfma_f32_16x16x32_bf16 v[4:7], a[208:211], a[112:115], v[4:7]
  ds_read_b64_tr_b16 a[198:199], v239 offset:10240
  v_cvt_pk_bf16_f32 v105, v54, v55
  v_mfma_f32_16x16x32_bf16 v[8:11], a[208:211], a[116:119], v[8:11]
  s_waitcnt lgkmcnt(8)
  v_cvt_pk_bf16_f32 v106, v64, v65
  v_cvt_pk_bf16_f32 v107, v66, v67
  v_mfma_f32_16x16x32_bf16 v[12:15], a[212:215], a[108:111], v[12:15]
  ds_read_b64_tr_b16 a[200:201], v228 offset:8448
  v_cvt_pk_bf16_f32 v108, v76, v77
  v_mfma_f32_16x16x32_bf16 v[16:19], a[212:215], a[112:115], v[16:19]
  buffer_store_dwordx4 v[100:103], v233, s[20:23], s50 offen offset:1024 sc1
  v_mfma_f32_16x16x32_bf16 v[20:23], a[212:215], a[116:119], v[20:23]
  s_waitcnt lgkmcnt(7)
  ds_read_b64_tr_b16 a[202:203], v228 offset:10496
  v_cvt_pk_bf16_f32 v109, v78, v79
  v_mfma_f32_16x16x32_bf16 v[24:27], a[216:219], a[108:111], v[24:27]
  ds_read_b64_tr_b16 a[204:205], v239 offset:8448
  v_cvt_pk_bf16_f32 v110, v88, v89
  v_mfma_f32_16x16x32_bf16 v[28:31], a[216:219], a[112:115], v[28:31]
  buffer_load_dwordx4 v232, s[24:27], s29 offen offset:1024 lds
  v_mfma_f32_16x16x32_bf16 v[32:35], a[216:219], a[116:119], v[32:35]
  s_waitcnt lgkmcnt(7)
  ds_read_b64_tr_b16 a[206:207], v239 offset:10496
  v_cvt_pk_bf16_f32 v111, v90, v91
  v_mfma_f32_16x16x32_bf16 v[36:39], a[220:223], a[108:111], v[36:39]
  s_add_u32 s29, s29, s31
  ds_read_b64_tr_b16 a[208:209], v228 offset:12288
  v_cvt_pk_bf16_f32 v112, v56, v57
  v_mfma_f32_16x16x32_bf16 v[40:43], a[220:223], a[112:115], v[40:43]
  buffer_store_dwordx4 v[104:107], v233, s[20:23], s50 offen offset:2048 sc1
  v_mfma_f32_16x16x32_bf16 v[44:47], a[220:223], a[116:119], v[44:47]
  s_waitcnt lgkmcnt(7)
  ds_read_b64_tr_b16 a[210:211], v228 offset:14336
  v_cvt_pk_bf16_f32 v113, v58, v59
  v_mfma_f32_16x16x32_bf16 v[0:3], a[192:195], a[120:123], v[0:3]
  ds_read_b64_tr_b16 a[212:213], v239 offset:12288
  v_cvt_pk_bf16_f32 v114, v68, v69
  v_mfma_f32_16x16x32_bf16 v[4:7], a[192:195], a[124:127], v[4:7]
  ds_read_b64_tr_b16 a[214:215], v239 offset:14336
  v_cvt_pk_bf16_f32 v115, v70, v71
  v_mfma_f32_16x16x32_bf16 v[8:11], a[192:195], a[128:131], v[8:11]
  s_waitcnt lgkmcnt(8)
  v_cvt_pk_bf16_f32 v116, v80, v81
  v_cvt_pk_bf16_f32 v117, v82, v83
  v_mfma_f32_16x16x32_bf16 v[12:15], a[196:199], a[120:123], v[12:15]
  ds_read_b64_tr_b16 a[216:217], v228 offset:12544
  v_cvt_pk_bf16_f32 v118, v92, v93
  v_mfma_f32_16x16x32_bf16 v[16:19], a[196:199], a[124:127], v[16:19]
  buffer_store_dwordx4 v[108:111], v233, s[20:23], s50 offen offset:3072 sc1
  v_mfma_f32_16x16x32_bf16 v[20:23], a[196:199], a[128:131], v[20:23]
  s_waitcnt lgkmcnt(7)
  ds_read_b64_tr_b16 a[218:219], v228 offset:14592
  v_cvt_pk_bf16_f32 v119, v94, v95
  v_mfma_f32_16x16x32_bf16 v[24:27], a[200:203], a[120:123], v[24:27]
  ds_read_b64_tr_b16 a[220:221], v239 offset:12544
  v_mfma_f32_16x16x32_bf16 v[28:31], a[200:203], a[124:127], v[28:31]
  buffer_load_dwordx4 v232, s[24:27], s29 offen offset:2048 lds
  v_mfma_f32_16x16x32_bf16 v[32:35], a[200:203], a[128:131], v[32:35]
  s_waitcnt lgkmcnt(7)
  ds_read_b64_tr_b16 a[222:223], v239 offset:14592
  v_add_u32 v228, 114688, v229
  v_mfma_f32_16x16x32_bf16 v[36:39], a[204:207], a[120:123], v[36:39]
  s_add_u32 s29, s29, s31
  ds_read_b64_tr_b16 a[192:193], v228 offset:0
  v_xor_b32 v239, 32, v228
  v_mfma_f32_16x16x32_bf16 v[40:43], a[204:207], a[124:127], v[40:43]
  buffer_store_dwordx4 v[112:115], v233, s[20:23], s51 offen offset:0 sc1
  v_mfma_f32_16x16x32_bf16 v[44:47], a[204:207], a[128:131], v[44:47]
  s_waitcnt lgkmcnt(7)
  ds_read_b64_tr_b16 a[194:195], v228 offset:2048
  v_mfma_f32_16x16x32_bf16 v[0:3], a[208:211], a[132:135], v[0:3]
  ds_read_b64_tr_b16 a[196:197], v239 offset:0
  v_mfma_f32_16x16x32_bf16 v[4:7], a[208:211], a[136:139], v[4:7]
  ds_read_b64_tr_b16 a[198:199], v239 offset:2048
  v_mfma_f32_16x16x32_bf16 v[8:11], a[208:211], a[140:143], v[8:11]
  s_waitcnt lgkmcnt(8)
  v_mfma_f32_16x16x32_bf16 v[12:15], a[212:215], a[132:135], v[12:15]
  ds_read_b64_tr_b16 a[200:201], v228 offset:256
  v_mfma_f32_16x16x32_bf16 v[16:19], a[212:215], a[136:139], v[16:19]
  buffer_store_dwordx4 v[116:119], v233, s[20:23], s51 offen offset:1024 sc1
  v_mfma_f32_16x16x32_bf16 v[20:23], a[212:215], a[140:143], v[20:23]
  s_waitcnt lgkmcnt(7)
  ds_read_b64_tr_b16 a[202:203], v228 offset:2304
  v_mfma_f32_16x16x32_bf16 v[24:27], a[216:219], a[132:135], v[24:27]
  ds_read_b64_tr_b16 a[204:205], v239 offset:256
  v_mfma_f32_16x16x32_bf16 v[28:31], a[216:219], a[136:139], v[28:31]
  buffer_load_dwordx4 v232, s[24:27], s29 offen offset:3072 lds
  v_mfma_f32_16x16x32_bf16 v[32:35], a[216:219], a[140:143], v[32:35]
  s_waitcnt lgkmcnt(7)
  ds_read_b64_tr_b16 a[206:207], v239 offset:2304
  v_mfma_f32_16x16x32_bf16 v[36:39], a[220:223], a[132:135], v[36:39]
  ds_read_b64_tr_b16 a[208:209], v228 offset:4096
  v_mfma_f32_16x16x32_bf16 v[40:43], a[220:223], a[136:139], v[40:43]
  ds_read_b64_tr_b16 a[210:211], v228 offset:6144
  v_mfma_f32_16x16x32_bf16 v[44:47], a[220:223], a[140:143], v[44:47]
  s_waitcnt lgkmcnt(8)
  v_mfma_f32_16x16x32_bf16 v[0:3], a[192:195], a[144:147], v[0:3]
  s_waitcnt vmcnt(63)
  ds_read_b64_tr_b16 a[212:213], v239 offset:4096
  v_mfma_f32_16x16x32_bf16 v[4:7], a[192:195], a[148:151], v[4:7]
  s_barrier
  ds_read_b64_tr_b16 a[214:215], v239 offset:6144
  v_mfma_f32_16x16x32_bf16 v[8:11], a[192:195], a[152:155], v[8:11]
  s_waitcnt lgkmcnt(8)
  v_mfma_f32_16x16x32_bf16 v[12:15], a[196:199], a[144:147], v[12:15]
  s_add_u32 m0, s28, 16384
  ds_read_b64_tr_b16 a[216:217], v228 offset:4352
  v_mfma_f32_16x16x32_bf16 v[16:19], a[196:199], a[148:151], v[16:19]
  buffer_load_dwordx2 v[224:225], v222, s[76:79], s58 offen offset:0 sc1
  v_mfma_f32_16x16x32_bf16 v[20:23], a[196:199], a[152:155], v[20:23]
  s_waitcnt lgkmcnt(7)
  ds_read_b64_tr_b16 a[218:219], v228 offset:6400
  v_mfma_f32_16x16x32_bf16 v[24:27], a[200:203], a[144:147], v[24:27]
  s_add_u32 s29, s58, 229376
  ds_read_b64_tr_b16 a[220:221], v239 offset:4352
  v_mfma_f32_16x16x32_bf16 v[28:31], a[200:203], a[148:151], v[28:31]
  ds_read_b64_tr_b16 a[222:223], v239 offset:6400
  v_mfma_f32_16x16x32_bf16 v[32:35], a[200:203], a[152:155], v[32:35]
  s_waitcnt lgkmcnt(8)
  v_mfma_f32_16x16x32_bf16 v[36:39], a[204:207], a[144:147], v[36:39]
  ds_read_b64_tr_b16 a[192:193], v228 offset:8192
  v_mfma_f32_16x16x32_bf16 v[40:43], a[204:207], a[148:151], v[40:43]
  buffer_load_dwordx4 v232, s[24:27], s29 offen offset:0 lds
  v_mfma_f32_16x16x32_bf16 v[44:47], a[204:207], a[152:155], v[44:47]
  s_waitcnt lgkmcnt(7)
  ds_read_b64_tr_b16 a[194:195], v228 offset:10240
  v_mfma_f32_16x16x32_bf16 v[0:3], a[208:211], a[156:159], v[0:3]
  s_add_u32 s29, s29, s31
  ds_read_b64_tr_b16 a[196:197], v239 offset:8192
  v_mfma_f32_16x16x32_bf16 v[4:7], a[208:211], a[160:163], v[4:7]
  ds_read_b64_tr_b16 a[198:199], v239 offset:10240
  v_mfma_f32_16x16x32_bf16 v[8:11], a[208:211], a[164:167], v[8:11]
  s_waitcnt lgkmcnt(8)
  v_mfma_f32_16x16x32_bf16 v[12:15], a[212:215], a[156:159], v[12:15]
  ds_read_b64_tr_b16 a[200:201], v228 offset:8448
  v_mfma_f32_16x16x32_bf16 v[16:19], a[212:215], a[160:163], v[16:19]
  ds_read_b64_tr_b16 a[202:203], v228 offset:10496
  v_mfma_f32_16x16x32_bf16 v[20:23], a[212:215], a[164:167], v[20:23]
  s_waitcnt lgkmcnt(8)
  v_mfma_f32_16x16x32_bf16 v[24:27], a[216:219], a[156:159], v[24:27]
  ds_read_b64_tr_b16 a[204:205], v239 offset:8448
  v_mfma_f32_16x16x32_bf16 v[28:31], a[216:219], a[160:163], v[28:31]
  ds_read_b64_tr_b16 a[206:207], v239 offset:10496
  v_mfma_f32_16x16x32_bf16 v[32:35], a[216:219], a[164:167], v[32:35]
  s_waitcnt lgkmcnt(8)
  v_mfma_f32_16x16x32_bf16 v[36:39], a[220:223], a[156:159], v[36:39]
  ds_read_b64_tr_b16 a[208:209], v228 offset:12288
  v_mfma_f32_16x16x32_bf16 v[40:43], a[220:223], a[160:163], v[40:43]
  buffer_load_dwordx4 v232, s[24:27], s29 offen offset:1024 lds
  v_mfma_f32_16x16x32_bf16 v[44:47], a[220:223], a[164:167], v[44:47]
  s_waitcnt lgkmcnt(7)
  ds_read_b64_tr_b16 a[210:211], v228 offset:14336
  v_mfma_f32_16x16x32_bf16 v[0:3], a[192:195], a[168:171], v[0:3]
  s_add_u32 s29, s29, s31
  ds_read_b64_tr_b16 a[212:213], v239 offset:12288
  v_mfma_f32_16x16x32_bf16 v[4:7], a[192:195], a[172:175], v[4:7]
  ds_read_b64_tr_b16 a[214:215], v239 offset:14336
  v_mfma_f32_16x16x32_bf16 v[8:11], a[192:195], a[176:179], v[8:11]
  s_waitcnt lgkmcnt(8)
  v_mfma_f32_16x16x32_bf16 v[12:15], a[196:199], a[168:171], v[12:15]
  ds_read_b64_tr_b16 a[216:217], v228 offset:12544
  v_mfma_f32_16x16x32_bf16 v[16:19], a[196:199], a[172:175], v[16:19]
  ds_read_b64_tr_b16 a[218:219], v228 offset:14592
  v_mfma_f32_16x16x32_bf16 v[20:23], a[196:199], a[176:179], v[20:23]
  s_waitcnt lgkmcnt(8)
  v_mfma_f32_16x16x32_bf16 v[24:27], a[200:203], a[168:171], v[24:27]
  ds_read_b64_tr_b16 a[220:221], v239 offset:12544
  v_mfma_f32_16x16x32_bf16 v[28:31], a[200:203], a[172:175], v[28:31]
  buffer_load_dwordx4 v232, s[24:27], s29 offen offset:2048 lds
  v_mfma_f32_16x16x32_bf16 v[32:35], a[200:203], a[176:179], v[32:35]
  s_waitcnt lgkmcnt(7)
  ds_read_b64_tr_b16 a[222:223], v239 offset:14592
  v_add_u32 v228, 81920, v229
  v_mfma_f32_16x16x32_bf16 v[36:39], a[204:207], a[168:171], v[36:39]
  s_add_u32 s29, s29, s31
  ds_read_b64_tr_b16 a[192:193], v228 offset:0
  v_xor_b32 v239, 32, v228
  v_mfma_f32_16x16x32_bf16 v[40:43], a[204:207], a[172:175], v[40:43]
  ds_read_b64_tr_b16 a[194:195], v228 offset:2048
  v_mfma_f32_16x16x32_bf16 v[44:47], a[204:207], a[176:179], v[44:47]
  s_waitcnt lgkmcnt(8)
  v_mfma_f32_16x16x32_bf16 v[0:3], a[208:211], a[180:183], v[0:3]
  ds_read_b64_tr_b16 a[196:197], v239 offset:0
  v_mfma_f32_16x16x32_bf16 v[4:7], a[208:211], a[184:187], v[4:7]
  ds_read_b64_tr_b16 a[198:199], v239 offset:2048
  v_mfma_f32_16x16x32_bf16 v[8:11], a[208:211], a[188:191], v[8:11]
  s_waitcnt lgkmcnt(8)
  v_mfma_f32_16x16x32_bf16 v[12:15], a[212:215], a[180:183], v[12:15]
  ds_read_b64_tr_b16 a[200:201], v228 offset:256
  v_mfma_f32_16x16x32_bf16 v[16:19], a[212:215], a[184:187], v[16:19]
  ds_read_b64_tr_b16 a[202:203], v228 offset:2304
  v_mfma_f32_16x16x32_bf16 v[20:23], a[212:215], a[188:191], v[20:23]
  s_waitcnt lgkmcnt(8)
  v_mfma_f32_16x16x32_bf16 v[24:27], a[216:219], a[180:183], v[24:27]
  ds_read_b64_tr_b16 a[204:205], v239 offset:256
  v_mfma_f32_16x16x32_bf16 v[28:31], a[216:219], a[184:187], v[28:31]
  buffer_load_dwordx4 v232, s[24:27], s29 offen offset:3072 lds
  v_mfma_f32_16x16x32_bf16 v[32:35], a[216:219], a[188:191], v[32:35]
  s_waitcnt lgkmcnt(7)
  ds_read_b64_tr_b16 a[206:207], v239 offset:2304
  v_mfma_f32_16x16x32_bf16 v[36:39], a[220:223], a[180:183], v[36:39]
  ds_read_b64_tr_b16 a[208:209], v228 offset:4096
  v_mfma_f32_16x16x32_bf16 v[40:43], a[220:223], a[184:187], v[40:43]
  ds_read_b64_tr_b16 a[210:211], v228 offset:6144
  v_mfma_f32_16x16x32_bf16 v[44:47], a[220:223], a[188:191], v[44:47]
  s_cmp_eq_u32 s35, 7
  s_cbranch_scc1 L_sk2
  s_waitcnt vmcnt(17)
  v_mfma_f32_16x16x32_bf16 v[120:123], v[250:253], a[224:227], v[120:123]
  v_mfma_f32_16x16x32_bf16 v[132:135], v[248:251], a[224:227], v[132:135]
  v_mfma_f32_16x16x32_bf16 v[144:147], v[250:253], a[228:231], v[144:147]
  v_mfma_f32_16x16x32_bf16 v[156:159], v[248:251], a[228:231], v[156:159]
  v_mfma_f32_16x16x32_bf16 v[124:127], v[250:253], a[232:235], v[124:127]
  v_mfma_f32_16x16x32_bf16 v[136:139], v[248:251], a[232:235], v[136:139]
  v_mfma_f32_16x16x32_bf16 v[148:151], v[250:253], a[236:239], v[148:151]
  v_mfma_f32_16x16x32_bf16 v[160:163], v[248:251], a[236:239], v[160:163]
  v_mfma_f32_16x16x32_bf16 v[128:131], v[250:253], a[240:243], v[128:131]
  v_mfma_f32_16x16x32_bf16 v[140:143], v[248:251], a[240:243], v[140:143]
  v_mfma_f32_16x16x32_bf16 v[152:155], v[250:253], a[244:247], v[152:155]
  v_mfma_f32_16x16x32_bf16 v[164:167], v[248:251], a[244:247], v[164:167]
L_sk2:
  s_waitcnt lgkmcnt(8)
  v_mfma_f32_16x16x32_bf16 v[0:3], a[192:195], a[0:3], v[0:3]
  s_waitcnt vmcnt(4)
  ds_read_b64_tr_b16 a[212:213], v239 offset:4096
  v_mfma_f32_16x16x32_bf16 v[4:7], a[192:195], a[4:7], v[4:7]
  s_barrier
  ds_read_b64_tr_b16 a[214:215], v239 offset:6144
  v_mfma_f32_16x16x32_bf16 v[8:11], a[192:195], a[8:11], v[8:11]
  s_waitcnt lgkmcnt(8)
  v_mfma_f32_16x16x32_bf16 v[12:15], a[196:199], a[0:3], v[12:15]
  s_add_u32 m0, s28, 114688
  ds_read_b64_tr_b16 a[216:217], v228 offset:4352
  v_mfma_f32_16x16x32_bf16 v[16:19], a[196:199], a[4:7], v[16:19]
  buffer_store_dwordx2 v[226:227], v246, s[76:79], s55 offen offset:0 sc1
  v_mfma_f32_16x16x32_bf16 v[20:23], a[196:199], a[8:11], v[20:23]
  s_waitcnt lgkmcnt(7)
  ds_read_b64_tr_b16 a[218:219], v228 offset:6400
  v_mfma_f32_16x16x32_bf16 v[24:27], a[200:203], a[0:3], v[24:27]
  s_add_u32 s29, s58, 344064
  ds_read_b64_tr_b16 a[220:221], v239 offset:4352
  v_mfma_f32_16x16x32_bf16 v[28:31], a[200:203], a[4:7], v[28:31]
  v_cmp_eq_u64 vcc, s[72:73], v[224:225]
  ds_read_b64_tr_b16 a[222:223], v239 offset:6400
  v_mfma_f32_16x16x32_bf16 v[32:35], a[200:203], a[8:11], v[32:35]
  s_waitcnt lgkmcnt(8)
  v_mfma_f32_16x16x32_bf16 v[36:39], a[204:207], a[0:3], v[36:39]
  s_and_b32 s74, vcc_lo, 0xff
  ds_read_b64_tr_b16 a[192:193], v228 offset:8192
  v_mfma_f32_16x16x32_bf16 v[40:43], a[204:207], a[4:7], v[40:43]
  buffer_load_dwordx4 v232, s[24:27], s29 offen offset:0 lds
  v_mfma_f32_16x16x32_bf16 v[44:47], a[204:207], a[8:11], v[44:47]
  s_waitcnt lgkmcnt(7)
  ds_read_b64_tr_b16 a[194:195], v228 offset:10240
  v_mfma_f32_16x16x32_bf16 v[0:3], a[208:211], a[12:15], v[0:3]
  s_cmp_lt_u32 s35, 7
  ds_read_b64_tr_b16 a[196:197], v239 offset:8192
  v_mfma_f32_16x16x32_bf16 v[4:7], a[208:211], a[16:19], v[4:7]
  s_cselect_b32 s74, s74, 0
  ds_read_b64_tr_b16 a[198:199], v239 offset:10240
  v_mfma_f32_16x16x32_bf16 v[8:11], a[208:211], a[20:23], v[8:11]
  s_waitcnt lgkmcnt(8)
  v_mfma_f32_16x16x32_bf16 v[12:15], a[212:215], a[12:15], v[12:15]
  s_and_b32 s74, s74, s87
  ds_read_b64_tr_b16 a[200:201], v228 offset:8448
  v_mfma_f32_16x16x32_bf16 v[16:19], a[212:215], a[16:19], v[16:19]
  s_bitcmp1_b32 s74, 2
  ds_read_b64_tr_b16 a[202:203], v228 offset:10496
  v_mfma_f32_16x16x32_bf16 v[20:23], a[212:215], a[20:23], v[20:23]
  s_waitcnt lgkmcnt(8)
  v_mfma_f32_16x16x32_bf16 v[24:27], a[216:219], a[12:15], v[24:27]
  s_cselect_b32 s66, 1376256, 0
  ds_read_b64_tr_b16 a[204:205], v239 offset:8448
  v_mfma_f32_16x16x32_bf16 v[28:31], a[216:219], a[16:19], v[28:31]
  s_cselect_b32 s36, 4, 0
  s_andn2_b32 s87, s87, s36
  buffer_load_dwordx4 v[168:171], v233, s[64:67], s82 offen offset:0 sc1
  v_mfma_f32_16x16x32_bf16 v[32:35], a[216:219], a[20:23], v[32:35]
  s_waitcnt lgkmcnt(7)
  ds_read_b64_tr_b16 a[206:207], v239 offset:10496
  v_mfma_f32_16x16x32_bf16 v[36:39], a[220:223], a[12:15], v[36:39]
  s_add_u32 s29, s29, s31
  ds_read_b64_tr_b16 a[208:209], v228 offset:12288
  v_mfma_f32_16x16x32_bf16 v[40:43], a[220:223], a[16:19], v[40:43]
  buffer_load_dwordx4 v232, s[24:27], s29 offen offset:1024 lds
  v_mfma_f32_16x16x32_bf16 v[44:47], a[220:223], a[20:23], v[44:47]
  s_waitcnt lgkmcnt(7)
  ds_read_b64_tr_b16 a[210:211], v228 offset:14336
  v_mfma_f32_16x16x32_bf16 v[0:3], a[192:195], a[24:27], v[0:3]
  s_add_u32 s29, s29, s31
  ds_read_b64_tr_b16 a[212:213], v239 offset:12288
  v_mfma_f32_16x16x32_bf16 v[4:7], a[192:195], a[28:31], v[4:7]
  ds_read_b64_tr_b16 a[214:215], v239 offset:14336
  v_mfma_f32_16x16x32_bf16 v[8:11], a[192:195], a[32:35], v[8:11]
  s_waitcnt lgkmcnt(8)
  v_mfma_f32_16x16x32_bf16 v[12:15], a[196:199], a[24:27], v[12:15]
  ds_read_b64_tr_b16 a[216:217], v228 offset:12544
  v_mfma_f32_16x16x32_bf16 v[16:19], a[196:199], a[28:31], v[16:19]
  buffer_load_dwordx4 v232, s[24:27], s29 offen offset:2048 lds
  v_mfma_f32_16x16x32_bf16 v[20:23], a[196:199], a[32:35], v[20:23]
  s_waitcnt lgkmcnt(7)
  ds_read_b64_tr_b16 a[218:219], v228 offset:14592
  v_mfma_f32_16x16x32_bf16 v[24:27], a[200:203], a[24:27], v[24:27]
  s_add_u32 s29, s29, s31
  ds_read_b64_tr_b16 a[220:221], v239 offset:12544
  v_mfma_f32_16x16x32_bf16 v[28:31], a[200:203], a[28:31], v[28:31]
  buffer_load_dwordx4 v[172:175], v233, s[64:67], s82 offen offset:1024 sc1
  v_mfma_f32_16x16x32_bf16 v[32:35], a[200:203], a[32:35], v[32:35]
  s_waitcnt lgkmcnt(7)
  ds_read_b64_tr_b16 a[222:223], v239 offset:14592
  v_add_u32 v228, 0, v229
  v_mfma_f32_16x16x32_bf16 v[36:39], a[204:207], a[24:27], v[36:39]
  ds_read_b64_tr_b16 a[192:193], v228 offset:0
  v_xor_b32 v239, 32, v228
  v_mfma_f32_16x16x32_bf16 v[40:43], a[204:207], a[28:31], v[40:43]
  ds_read_b64_tr_b16 a[194:195], v228 offset:2048
  v_mfma_f32_16x16x32_bf16 v[44:47], a[204:207], a[32:35], v[44:47]
  s_waitcnt lgkmcnt(8)
  v_mfma_f32_16x16x32_bf16 v[0:3], a[208:211], a[36:39], v[0:3]
  ds_read_b64_tr_b16 a[196:197], v239 offset:0
  v_mfma_f32_16x16x32_bf16 v[4:7], a[208:211], a[40:43], v[4:7]
  ds_read_b64_tr_b16 a[198:199], v239 offset:2048
  v_mfma_f32_16x16x32_bf16 v[8:11], a[208:211], a[44:47], v[8:11]
  s_waitcnt lgkmcnt(8)
  v_mfma_f32_16x16x32_bf16 v[12:15], a[212:215], a[36:39], v[12:15]
  ds_read_b64_tr_b16 a[200:201], v228 offset:256
  v_mfma_f32_16x16x32_bf16 v[16:19], a[212:215], a[40:43], v[16:19]
  buffer_load_dwordx4 v232, s[24:27], s29 offen offset:3072 lds
  v_mfma_f32_16x16x32_bf16 v[20:23], a[212:215], a[44:47], v[20:23]
  s_waitcnt lgkmcnt(7)
  ds_read_b64_tr_b16 a[202:203], v228 offset:2304
  v_mfma_f32_16x16x32_bf16 v[24:27], a[216:219], a[36:39], v[24:27]
  ds_read_b64_tr_b16 a[204:205], v239 offset:256
  v_mfma_f32_16x16x32_bf16 v[28:31], a[216:219], a[40:43], v[28:31]
  buffer_load_dwordx4 v[176:179], v233, s[64:67], s82 offen offset:2048 sc1
  v_mfma_f32_16x16x32_bf16 v[32:35], a[216:219], a[44:47], v[32:35]
  s_waitcnt lgkmcnt(7)
  ds_read_b64_tr_b16 a[206:207], v239 offset:2304
  v_mfma_f32_16x16x32_bf16 v[36:39], a[220:223], a[36:39], v[36:39]
  ds_read_b64_tr_b16 a[208:209], v228 offset:4096
  v_mfma_f32_16x16x32_bf16 v[40:43], a[220:223], a[40:43], v[40:43]
  ds_read_b64_tr_b16 a[210:211], v228 offset:6144
  v_mfma_f32_16x16x32_bf16 v[44:47], a[220:223], a[44:47], v[44:47]
  s_waitcnt lgkmcnt(8)
  v_mfma_f32_16x16x32_bf16 v[0:3], a[192:195], a[48:51], v[0:3]
  s_waitcnt vmcnt(63)
  ds_read_b64_tr_b16 a[212:213], v239 offset:4096
  v_mfma_f32_16x16x32_bf16 v[4:7], a[192:195], a[52:55], v[4:7]
  s_barrier
  ds_read_b64_tr_b16 a[214:215], v239 offset:6144
  v_mfma_f32_16x16x32_bf16 v[8:11], a[192:195], a[56:59], v[8:11]
  s_waitcnt lgkmcnt(8)
  v_mfma_f32_16x16x32_bf16 v[12:15], a[196:199], a[48:51], v[12:15]
  ds_read_b64_tr_b16 a[216:217], v228 offset:4352
  v_mfma_f32_16x16x32_bf16 v[16:19], a[196:199], a[52:55], v[16:19]
  ds_read_b64_tr_b16 a[218:219], v228 offset:6400
  v_mfma_f32_16x16x32_bf16 v[20:23], a[196:199], a[56:59], v[20:23]
  s_waitcnt lgkmcnt(8)
  v_mfma_f32_16x16x32_bf16 v[24:27], a[200:203], a[48:51], v[24:27]
  ds_read_b64_tr_b16 a[220:221], v239 offset:4352
  v_mfma_f32_16x16x32_bf16 v[28:31], a[200:203], a[52:55], v[28:31]
  buffer_load_dwordx4 v[180:183], v233, s[64:67], s82 offen offset:3072 sc1
  v_mfma_f32_16x16x32_bf16 v[32:35], a[200:203], a[56:59], v[32:35]
  s_waitcnt lgkmcnt(7)
  ds_read_b64_tr_b16 a[222:223], v239 offset:6400
  v_mfma_f32_16x16x32_bf16 v[36:39], a[204:207], a[48:51], v[36:39]
  ds_read_b64_tr_b16 a[192:193], v228 offset:8192
  v_mfma_f32_16x16x32_bf16 v[40:43], a[204:207], a[52:55], v[40:43]
  ds_read_b64_tr_b16 a[194:195], v228 offset:10240
  v_mfma_f32_16x16x32_bf16 v[44:47], a[204:207], a[56:59], v[44:47]
  s_waitcnt lgkmcnt(8)
  v_mfma_f32_16x16x32_bf16 v[0:3], a[208:211], a[60:63], v[0:3]
  ds_read_b64_tr_b16 a[196:197], v239 offset:8192
  v_mfma_f32_16x16x32_bf16 v[4:7], a[208:211], a[64:67], v[4:7]
  ds_read_b64_tr_b16 a[198:199], v239 offset:10240
  v_mfma_f32_16x16x32_bf16 v[8:11], a[208:211], a[68:71], v[8:11]
  s_waitcnt lgkmcnt(8)
  v_mfma_f32_16x16x32_bf16 v[12:15], a[212:215], a[60:63], v[12:15]
  ds_read_b64_tr_b16 a[200:201], v228 offset:8448
  v_mfma_f32_16x16x32_bf16 v[16:19], a[212:215], a[64:67], v[16:19]
  ds_read_b64_tr_b16 a[202:203], v228 offset:10496
  v_mfma_f32_16x16x32_bf16 v[20:23], a[212:215], a[68:71], v[20:23]
  s_waitcnt lgkmcnt(8)
  v_mfma_f32_16x16x32_bf16 v[24:27], a[216:219], a[60:63], v[24:27]
  ds_read_b64_tr_b16 a[204:205], v239 offset:8448
  v_mfma_f32_16x16x32_bf16 v[28:31], a[216:219], a[64:67], v[28:31]
  buffer_load_dwordx4 v[184:187], v238, s[64:67], s82 offen offset:0 sc1
  v_mfma_f32_16x16x32_bf16 v[32:35], a[216:219], a[68:71], v[32:35]
  s_waitcnt lgkmcnt(7)
  ds_read_b64_tr_b16 a[206:207], v239 offset:10496
  v_mfma_f32_16x16x32_bf16 v[36:39], a[220:223], a[60:63], v[36:39]
  ds_read_b64_tr_b16 a[208:209], v228 offset:12288
  v_mfma_f32_16x16x32_bf16 v[40:43], a[220:223], a[64:67], v[40:43]
  ds_read_b64_tr_b16 a[210:211], v228 offset:14336
  v_mfma_f32_16x16x32_bf16 v[44:47], a[220:223], a[68:71], v[44:47]
  s_waitcnt lgkmcnt(8)
  v_mfma_f32_16x16x32_bf16 v[0:3], a[192:195], a[72:75], v[0:3]
  ds_read_b64_tr_b16 a[212:213], v239 offset:12288
  v_mfma_f32_16x16x32_bf16 v[4:7], a[192:195], a[76:79], v[4:7]
  ds_read_b64_tr_b16 a[214:215], v239 offset:14336
  v_mfma_f32_16x16x32_bf16 v[8:11], a[192:195], a[80:83], v[8:11]
  s_waitcnt lgkmcnt(8)
  v_mfma_f32_16x16x32_bf16 v[12:15], a[196:199], a[72:75], v[12:15]
  ds_read_b64_tr_b16 a[216:217], v228 offset:12544
  v_mfma_f32_16x16x32_bf16 v[16:19], a[196:199], a[76:79], v[16:19]
  ds_read_b64_tr_b16 a[218:219], v228 offset:14592
  v_mfma_f32_16x16x32_bf16 v[20:23], a[196:199], a[80:83], v[20:23]
  s_waitcnt lgkmcnt(8)
  v_mfma_f32_16x16x32_bf16 v[24:27], a[200:203], a[72:75], v[24:27]
  ds_read_b64_tr_b16 a[220:221], v239 offset:12544
  v_mfma_f32_16x16x32_bf16 v[28:31], a[200:203], a[76:79], v[28:31]
  buffer_load_dwordx4 v[188:191], v238, s[64:67], s82 offen offset:1024 sc1
  v_mfma_f32_16x16x32_bf16 v[32:35], a[200:203], a[80:83], v[32:35]
  s_waitcnt lgkmcnt(7)
  ds_read_b64_tr_b16 a[222:223], v239 offset:14592
  v_add_u32 v228, 32768, v229
  v_mfma_f32_16x16x32_bf16 v[36:39], a[204:207], a[72:75], v[36:39]
  ds_read_b64_tr_b16 a[192:193], v228 offset:0
  v_xor_b32 v239, 32, v228
  v_mfma_f32_16x16x32_bf16 v[40:43], a[204:207], a[76:79], v[40:43]
  ds_read_b64_tr_b16 a[194:195], v228 offset:2048
  v_mfma_f32_16x16x32_bf16 v[44:47], a[204:207], a[80:83], v[44:47]
  s_waitcnt lgkmcnt(8)
  v_mfma_f32_16x16x32_bf16 v[48:51], a[208:211], a[84:87], v[0:3]
  ds_read_b64_tr_b16 a[196:197], v239 offset:0
  v_mfma_f32_16x16x32_bf16 v[52:55], a[208:211], a[88:91], v[4:7]
  ds_read_b64_tr_b16 a[198:199], v239 offset:2048
  v_mfma_f32_16x16x32_bf16 v[56:59], a[208:211], a[92:95], v[8:11]
  s_waitcnt lgkmcnt(8)
  v_mfma_f32_16x16x32_bf16 v[60:63], a[212:215], a[84:87], v[12:15]
  ds_read_b64_tr_b16 a[200:201], v228 offset:256
  v_mfma_f32_16x16x32_bf16 v[64:67], a[212:215], a[88:91], v[16:19]
  ds_read_b64_tr_b16 a[202:203], v228 offset:2304
  v_mfma_f32_16x16x32_bf16 v[68:71], a[212:215], a[92:95], v[20:23]
  s_waitcnt lgkmcnt(8)
  v_mfma_f32_16x16x32_bf16 v[72:75], a[216:219], a[84:87], v[24:27]
  ds_read_b64_tr_b16 a[204:205], v239 offset:256
  v_mfma_f32_16x16x32_bf16 v[76:79], a[216:219], a[88:91], v[28:31]
  ds_read_b64_tr_b16 a[206:207], v239 offset:2304
  v_mfma_f32_16x16x32_bf16 v[80:83], a[216:219], a[92:95], v[32:35]
  s_waitcnt lgkmcnt(8)
  v_mfma_f32_16x16x32_bf16 v[84:87], a[220:223], a[84:87], v[36:39]
  ds_read_b64_tr_b16 a[208:209], v228 offset:4096
  v_mfma_f32_16x16x32_bf16 v[88:91], a[220:223], a[88:91], v[40:43]
  ds_read_b64_tr_b16 a[210:211], v228 offset:6144
  v_mfma_f32_16x16x32_bf16 v[92:95], a[220:223], a[92:95], v[44:47]
  s_waitcnt lgkmcnt(8)
  v_mfma_f32_16x16x32_bf16 v[0:3], a[192:195], a[96:99], 0
  s_waitcnt vmcnt(63)
  ds_read_b64_tr_b16 a[212:213], v239 offset:4096
  v_mfma_f32_16x16x32_bf16 v[4:7], a[192:195], a[100:103], 0
  s_barrier
  ds_read_b64_tr_b16 a[214:215], v239 offset:6144
  v_mfma_f32_16x16x32_bf16 v[8:11], a[192:195], a[104:107], 0
  s_waitcnt lgkmcnt(8)
  v_mfma_f32_16x16x32_bf16 v[12:15], a[196:199], a[96:99], 0
  s_mul_i32 s50, s56, 192
  ds_read_b64_tr_b16 a[216:217], v228 offset:4352
  v_cvt_pk_bf16_f32 v96, v48, v49
  v_mfma_f32_16x16x32_bf16 v[16:19], a[196:199], a[100:103], 0
  s_add_u32 s51, s50, 4096
  ds_read_b64_tr_b16 a[218:219], v228 offset:6400
  v_cvt_pk_bf16_f32 v97, v50, v51
  v_mfma_f32_16x16x32_bf16 v[20:23], a[196:199], a[104:107], 0
  s_waitcnt lgkmcnt(8)
  v_cvt_pk_bf16_f32 v98, v60, v61
  v_cvt_pk_bf16_f32 v99, v62, v63
  v_mfma_f32_16x16x32_bf16 v[24:27], a[200:203], a[96:99], 0
  ds_read_b64_tr_b16 a[220:221], v239 offset:4352
  v_cvt_pk_bf16_f32 v100, v72, v73
  v_mfma_f32_16x16x32_bf16 v[28:31], a[200:203], a[100:103], 0
  ds_read_b64_tr_b16 a[222:223], v239 offset:6400
  v_cvt_pk_bf16_f32 v101, v74, v75
  v_mfma_f32_16x16x32_bf16 v[32:35], a[200:203], a[104:107], 0
  s_waitcnt lgkmcnt(8)
  v_cvt_pk_bf16_f32 v102, v84, v85
  v_cvt_pk_bf16_f32 v103, v86, v87
  v_mfma_f32_16x16x32_bf16 v[36:39], a[204:207], a[96:99], 0
  ds_read_b64_tr_b16 a[192:193], v228 offset:8192
  v_cvt_pk_bf16_f32 v104, v52, v53
  v_mfma_f32_16x16x32_bf16 v[40:43], a[204:207], a[100:103], 0
  buffer_store_dwordx4 v[96:99], v233, s[20:23], s50 offen offset:0 sc1
  v_mfma_f32_16x16x32_bf16 v[44:47], a[204:207], a[104:107], 0
  s_waitcnt lgkmcnt(7)
  ds_read_b64_tr_b16 a[194:195], v228 offset:10240
  v_cvt_pk_bf16_f32 v105, v54, v55
  v_mfma_f32_16x16x32_bf16 v[0:3], a[208:211], a[108:111], v[0:3]
  ds_read_b64_tr_b16 a[196:197], v239 offset:8192
  v_cvt_pk_bf16_f32 v106, v64, v65
  v_mfma_f32_16x16x32_bf16 v[4:7], a[208:211], a[112:115], v[4:7]
  ds_read_b64_tr_b16 a[198:199], v239 offset:10240
  v_cvt_pk_bf16_f32 v107, v66, v67
  v_mfma_f32_16x16x32_bf16 v[8:11], a[208:211], a[116:119], v[8:11]
  s_waitcnt lgkmcnt(8)
  v_cvt_pk_bf16_f32 v108, v76, v77
  v_cvt_pk_bf16_f32 v109, v78, v79
  v_mfma_f32_16x16x32_bf16 v[12:15], a[212:215], a[108:111], v[12:15]
  ds_read_b64_tr_b16 a[200:201], v228 offset:8448
  v_cvt_pk_bf16_f32 v110, v88, v89
  v_mfma_f32_16x16x32_bf16 v[16:19], a[212:215], a[112:115], v[16:19]
  buffer_store_dwordx4 v[100:103], v233, s[20:23], s50 offen offset:1024 sc1
  v_mfma_f32_16x16x32_bf16 v[20:23], a[212:215], a[116:119], v[20:23]
  s_waitcnt lgkmcnt(7)
  ds_read_b64_tr_b16 a[202:203], v228 offset:10496
  v_cvt_pk_bf16_f32 v111, v90, v91
  v_mfma_f32_16x16x32_bf16 v[24:27], a[216:219], a[108:111], v[24:27]
  ds_read_b64_tr_b16 a[204:205], v239 offset:8448
  v_cvt_pk_bf16_f32 v112, v56, v57
  v_mfma_f32_16x16x32_bf16 v[28:31], a[216:219], a[112:115], v[28:31]
  ds_read_b64_tr_b16 a[206:207], v239 offset:10496
  v_cvt_pk_bf16_f32 v113, v58, v59
  v_mfma_f32_16x16x32_bf16 v[32:35], a[216:219], a[116:119], v[32:35]
  s_waitcnt lgkmcnt(8)
  v_cvt_pk_bf16_f32 v114, v68, v69
  v_cvt_pk_bf16_f32 v115, v70, v71
  v_mfma_f32_16x16x32_bf16 v[36:39], a[220:223], a[108:111], v[36:39]
  ds_read_b64_tr_b16 a[208:209], v228 offset:12288
  v_cvt_pk_bf16_f32 v116, v80, v81
  v_mfma_f32_16x16x32_bf16 v[40:43], a[220:223], a[112:115], v[40:43]
  buffer_store_dwordx4 v[104:107], v233, s[20:23], s50 offen offset:2048 sc1
  v_mfma_f32_16x16x32_bf16 v[44:47], a[220:223], a[116:119], v[44:47]
  s_waitcnt lgkmcnt(7)
  ds_read_b64_tr_b16 a[210:211], v228 offset:14336
  v_cvt_pk_bf16_f32 v117, v82, v83
  v_mfma_f32_16x16x32_bf16 v[0:3], a[192:195], a[120:123], v[0:3]
  ds_read_b64_tr_b16 a[212:213], v239 offset:12288
  v_cvt_pk_bf16_f32 v118, v92, v93
  v_mfma_f32_16x16x32_bf16 v[4:7], a[192:195], a[124:127], v[4:7]
  ds_read_b64_tr_b16 a[214:215], v239 offset:14336
  v_cvt_pk_bf16_f32 v119, v94, v95
  v_mfma_f32_16x16x32_bf16 v[8:11], a[192:195], a[128:131], v[8:11]
  s_waitcnt lgkmcnt(8)
  v_mfma_f32_16x16x32_bf16 v[12:15], a[196:199], a[120:123], v[12:15]
  ds_read_b64_tr_b16 a[216:217], v228 offset:12544
  v_mfma_f32_16x16x32_bf16 v[16:19], a[196:199], a[124:127], v[16:19]
  buffer_store_dwordx4 v[108:111], v233, s[20:23], s50 offen offset:3072 sc1
  v_mfma_f32_16x16x32_bf16 v[20:23], a[196:199], a[128:131], v[20:23]
  s_waitcnt lgkmcnt(7)
  ds_read_b64_tr_b16 a[218:219], v228 offset:14592
  v_mfma_f32_16x16x32_bf16 v[24:27], a[200:203], a[120:123], v[24:27]
  ds_read_b64_tr_b16 a[220:221], v239 offset:12544
  v_mfma_f32_16x16x32_bf16 v[28:31], a[200:203], a[124:127], v[28:31]
  ds_read_b64_tr_b16 a[222:223], v239 offset:14592
  v_add_u32 v228, 147456, v229
  v_mfma_f32_16x16x32_bf16 v[32:35], a[200:203], a[128:131], v[32:35]
  s_waitcnt lgkmcnt(8)
  v_xor_b32 v239, 32, v228
  v_mfma_f32_16x16x32_bf16 v[36:39], a[204:207], a[120:123], v[36:39]
  ds_read_b64_tr_b16 a[192:193], v228 offset:0
  v_mfma_f32_16x16x32_bf16 v[40:43], a[204:207], a[124:127], v[40:43]
  buffer_store_dwordx4 v[112:115], v233, s[20:23], s51 offen offset:0 sc1
  v_mfma_f32_16x16x32_bf16 v[44:47], a[204:207], a[128:131], v[44:47]
  s_waitcnt lgkmcnt(7)
  ds_read_b64_tr_b16 a[194:195], v228 offset:2048
  v_mfma_f32_16x16x32_bf16 v[0:3], a[208:211], a[132:135], v[0:3]
  ds_read_b64_tr_b16 a[196:197], v239 offset:0
  v_mfma_f32_16x16x32_bf16 v[4:7], a[208:211], a[136:139], v[4:7]
  ds_read_b64_tr_b16 a[198:199], v239 offset:2048
  v_mfma_f32_16x16x32_bf16 v[8:11], a[208:211], a[140:143], v[8:11]
  s_waitcnt lgkmcnt(8)
  v_mfma_f32_16x16x32_bf16 v[12:15], a[212:215], a[132:135], v[12:15]
  ds_read_b64_tr_b16 a[200:201], v228 offset:256
  v_mfma_f32_16x16x32_bf16 v[16:19], a[212:215], a[136:139], v[16:19]
  buffer_store_dwordx4 v[116:119], v233, s[20:23], s51 offen offset:1024 sc1
  v_mfma_f32_16x16x32_bf16 v[20:23], a[212:215], a[140:143], v[20:23]
  s_waitcnt lgkmcnt(7)
  ds_read_b64_tr_b16 a[202:203], v228 offset:2304
  v_mfma_f32_16x16x32_bf16 v[24:27], a[216:219], a[132:135], v[24:27]
  ds_read_b64_tr_b16 a[204:205], v239 offset:256
  v_mfma_f32_16x16x32_bf16 v[28:31], a[216:219], a[136:139], v[28:31]
  ds_read_b64_tr_b16 a[206:207], v239 offset:2304
  v_mfma_f32_16x16x32_bf16 v[32:35], a[216:219], a[140:143], v[32:35]
  s_waitcnt lgkmcnt(8)
  v_mfma_f32_16x16x32_bf16 v[36:39], a[220:223], a[132:135], v[36:39]
  ds_read_b64_tr_b16 a[208:209], v228 offset:4096
  v_mfma_f32_16x16x32_bf16 v[40:43], a[220:223], a[136:139], v[40:43]
  ds_read_b64_tr_b16 a[210:211], v228 offset:6144
  v_mfma_f32_16x16x32_bf16 v[44:47], a[220:223], a[140:143], v[44:47]
  s_waitcnt lgkmcnt(8)
  v_mfma_f32_16x16x32_bf16 v[0:3], a[192:195], a[144:147], v[0:3]
  s_waitcnt vmcnt(63)
  ds_read_b64_tr_b16 a[212:213], v239 offset:4096
  v_mfma_f32_16x16x32_bf16 v[4:7], a[192:195], a[148:151], v[4:7]
  s_barrier
  ds_read_b64_tr_b16 a[214:215], v239 offset:6144
  v_mfma_f32_16x16x32_bf16 v[8:11], a[192:195], a[152:155], v[8:11]
  s_waitcnt lgkmcnt(8)
  v_mfma_f32_16x16x32_bf16 v[12:15], a[196:199], a[144:147], v[12:15]
  ds_read_b64_tr_b16 a[216:217], v228 offset:4352
  v_mfma_f32_16x16x32_bf16 v[16:19], a[196:199], a[148:151], v[16:19]
  buffer_load_dwordx2 v[224:225], v222, s[76:79], s58 offen offset:0 sc1
  v_mfma_f32_16x16x32_bf16 v[20:23], a[196:199], a[152:155], v[20:23]
  s_waitcnt lgkmcnt(7)
  ds_read_b64_tr_b16 a[218:219], v228 offset:6400
  v_mfma_f32_16x16x32_bf16 v[24:27], a[200:203], a[144:147], v[24:27]
  ds_read_b64_tr_b16 a[220:221], v239 offset:4352
  v_mfma_f32_16x16x32_bf16 v[28:31], a[200:203], a[148:151], v[28:31]
  ds_read_b64_tr_b16 a[222:223], v239 offset:6400
  v_mfma_f32_16x16x32_bf16 v[32:35], a[200:203], a[152:155], v[32:35]
  s_waitcnt lgkmcnt(8)
  v_mfma_f32_16x16x32_bf16 v[36:39], a[204:207], a[144:147], v[36:39]
  ds_read_b64_tr_b16 a[192:193], v228 offset:8192
  v_mfma_f32_16x16x32_bf16 v[40:43], a[204:207], a[148:151], v[40:43]
  ds_read_b64_tr_b16 a[194:195], v228 offset:10240
  v_mfma_f32_16x16x32_bf16 v[44:47], a[204:207], a[152:155], v[44:47]
  s_waitcnt lgkmcnt(8)
  v_mfma_f32_16x16x32_bf16 v[0:3], a[208:211], a[156:159], v[0:3]
  ds_read_b64_tr_b16 a[196:197], v239 offset:8192
  v_mfma_f32_16x16x32_bf16 v[4:7], a[208:211], a[160:163], v[4:7]
  ds_read_b64_tr_b16 a[198:199], v239 offset:10240
  v_mfma_f32_16x16x32_bf16 v[8:11], a[208:211], a[164:167], v[8:11]
  s_waitcnt lgkmcnt(8)
  v_mfma_f32_16x16x32_bf16 v[12:15], a[212:215], a[156:159], v[12:15]
  ds_read_b64_tr_b16 a[200:201], v228 offset:8448
  v_mfma_f32_16x16x32_bf16 v[16:19], a[212:215], a[160:163], v[16:19]
  ds_read_b64_tr_b16 a[202:203], v228 offset:10496
  v_mfma_f32_16x16x32_bf16 v[20:23], a[212:215], a[164:167], v[20:23]
  s_waitcnt lgkmcnt(8)
  v_mfma_f32_16x16x32_bf16 v[24:27], a[216:219], a[156:159], v[24:27]
  ds_read_b64_tr_b16 a[204:205], v239 offset:8448
  v_mfma_f32_16x16x32_bf16 v[28:31], a[216:219], a[160:163], v[28:31]
  ds_read_b64_tr_b16 a[206:207], v239 offset:10496
  v_mfma_f32_16x16x32_bf16 v[32:35], a[216:219], a[164:167], v[32:35]
  s_waitcnt lgkmcnt(8)
  v_mfma_f32_16x16x32_bf16 v[36:39], a[220:223], a[156:159], v[36:39]
  ds_read_b64_tr_b16 a[208:209], v228 offset:12288
  v_mfma_f32_16x16x32_bf16 v[40:43], a[220:223], a[160:163], v[40:43]
  ds_read_b64_tr_b16 a[210:211], v228 offset:14336
  v_mfma_f32_16x16x32_bf16 v[44:47], a[220:223], a[164:167], v[44:47]
  s_waitcnt lgkmcnt(8)
  v_mfma_f32_16x16x32_bf16 v[0:3], a[192:195], a[168:171], v[0:3]
  ds_read_b64_tr_b16 a[212:213], v239 offset:12288
  v_mfma_f32_16x16x32_bf16 v[4:7], a[192:195], a[172:175], v[4:7]
  ds_read_b64_tr_b16 a[214:215], v239 offset:14336
  v_mfma_f32_16x16x32_bf16 v[8:11], a[192:195], a[176:179], v[8:11]
  s_waitcnt lgkmcnt(8)
  v_mfma_f32_16x16x32_bf16 v[12:15], a[196:199], a[168:171], v[12:15]
  ds_read_b64_tr_b16 a[216:217], v228 offset:12544
  v_mfma_f32_16x16x32_bf16 v[16:19], a[196:199], a[172:175], v[16:19]
  ds_read_b64_tr_b16 a[218:219], v228 offset:14592
  v_mfma_f32_16x16x32_bf16 v[20:23], a[196:199], a[176:179], v[20:23]
  s_waitcnt lgkmcnt(8)
  v_mfma_f32_16x16x32_bf16 v[24:27], a[200:203], a[168:171], v[24:27]
  ds_read_b64_tr_b16 a[220:221], v239 offset:12544
  v_mfma_f32_16x16x32_bf16 v[28:31], a[200:203], a[172:175], v[28:31]
  ds_read_b64_tr_b16 a[222:223], v239 offset:14592
  v_add_u32 v228, 49152, v229
  v_mfma_f32_16x16x32_bf16 v[32:35], a[200:203], a[176:179], v[32:35]
  s_waitcnt lgkmcnt(8)
  v_xor_b32 v239, 32, v228
  v_mfma_f32_16x16x32_bf16 v[36:39], a[204:207], a[168:171], v[36:39]
  ds_read_b64_tr_b16 a[192:193], v228 offset:0
  v_mfma_f32_16x16x32_bf16 v[40:43], a[204:207], a[172:175], v[40:43]
  ds_read_b64_tr_b16 a[194:195], v228 offset:2048
  v_mfma_f32_16x16x32_bf16 v[44:47], a[204:207], a[176:179], v[44:47]
  s_waitcnt lgkmcnt(8)
  v_mfma_f32_16x16x32_bf16 v[0:3], a[208:211], a[180:183], v[0:3]
  ds_read_b64_tr_b16 a[196:197], v239 offset:0
  v_mfma_f32_16x16x32_bf16 v[4:7], a[208:211], a[184:187], v[4:7]
  ds_read_b64_tr_b16 a[198:199], v239 offset:2048
  v_mfma_f32_16x16x32_bf16 v[8:11], a[208:211], a[188:191], v[8:11]
  s_waitcnt lgkmcnt(8)
  v_mfma_f32_16x16x32_bf16 v[12:15], a[212:215], a[180:183], v[12:15]
  ds_read_b64_tr_b16 a[200:201], v228 offset:256
  v_mfma_f32_16x16x32_bf16 v[16:19], a[212:215], a[184:187], v[16:19]
  ds_read_b64_tr_b16 a[202:203], v228 offset:2304
  v_mfma_f32_16x16x32_bf16 v[20:23], a[212:215], a[188:191], v[20:23]
  s_waitcnt lgkmcnt(8)
  v_mfma_f32_16x16x32_bf16 v[24:27], a[216:219], a[180:183], v[24:27]
  ds_read_b64_tr_b16 a[204:205], v239 offset:256
  v_mfma_f32_16x16x32_bf16 v[28:31], a[216:219], a[184:187], v[28:31]
  ds_read_b64_tr_b16 a[206:207], v239 offset:2304
  v_mfma_f32_16x16x32_bf16 v[32:35], a[216:219], a[188:191], v[32:35]
  s_waitcnt lgkmcnt(8)
  v_mfma_f32_16x16x32_bf16 v[36:39], a[220:223], a[180:183], v[36:39]
  ds_read_b64_tr_b16 a[208:209], v228 offset:4096
  v_mfma_f32_16x16x32_bf16 v[40:43], a[220:223], a[184:187], v[40:43]
  ds_read_b64_tr_b16 a[210:211], v228 offset:6144
  v_mfma_f32_16x16x32_bf16 v[44:47], a[220:223], a[188:191], v[44:47]
  s_cmp_eq_u32 s35, 7
  s_cbranch_scc1 L_sk3
  s_waitcnt vmcnt(7)
  v_mfma_f32_16x16x32_bf16 v[120:123], v[250:253], v[168:171], v[120:123]
  v_mfma_f32_16x16x32_bf16 v[132:135], v[248:251], v[168:171], v[132:135]
  v_mfma_f32_16x16x32_bf16 v[144:147], v[250:253], v[172:175], v[144:147]
  v_mfma_f32_16x16x32_bf16 v[156:159], v[248:251], v[172:175], v[156:159]
  v_mfma_f32_16x16x32_bf16 v[124:127], v[250:253], v[176:179], v[124:127]
  v_mfma_f32_16x16x32_bf16 v[136:139], v[248:251], v[176:179], v[136:139]
  v_mfma_f32_16x16x32_bf16 v[148:151], v[250:253], v[180:183], v[148:151]
  v_mfma_f32_16x16x32_bf16 v[160:163], v[248:251], v[180:183], v[160:163]
  v_mfma_f32_16x16x32_bf16 v[128:131], v[250:253], v[184:187], v[128:131]
  v_mfma_f32_16x16x32_bf16 v[140:143], v[248:251], v[184:187], v[140:143]
  v_mfma_f32_16x16x32_bf16 v[152:155], v[250:253], v[188:191], v[152:155]
  v_mfma_f32_16x16x32_bf16 v[164:167], v[248:251], v[188:191], v[164:167]
L_sk3:
  s_waitcnt lgkmcnt(8)
  v_mfma_f32_16x16x32_bf16 v[0:3], a[192:195], a[0:3], v[0:3]
  s_waitcnt vmcnt(0)
  ds_read_b64_tr_b16 a[212:213], v239 offset:4096
  v_mfma_f32_16x16x32_bf16 v[4:7], a[192:195], a[4:7], v[4:7]
  s_barrier
  ds_read_b64_tr_b16 a[214:215], v239 offset:6144
  v_mfma_f32_16x16x32_bf16 v[8:11], a[192:195], a[8:11], v[8:11]
  s_waitcnt lgkmcnt(8)
  v_mfma_f32_16x16x32_bf16 v[12:15], a[196:199], a[0:3], v[12:15]
  v_cmp_eq_u64 vcc, s[72:73], v[224:225]
  ds_read_b64_tr_b16 a[216:217], v228 offset:4352
  v_mfma_f32_16x16x32_bf16 v[16:19], a[196:199], a[4:7], v[16:19]
  buffer_store_dwordx2 v[226:227], v246, s[76:79], s56 offen offset:0 sc1
  v_mfma_f32_16x16x32_bf16 v[20:23], a[196:199], a[8:11], v[20:23]
  s_waitcnt lgkmcnt(7)
  ds_read_b64_tr_b16 a[218:219], v228 offset:6400
  v_mfma_f32_16x16x32_bf16 v[24:27], a[200:203], a[0:3], v[24:27]
  s_and_b32 s74, vcc_lo, 0xff
  ds_read_b64_tr_b16 a[220:221], v239 offset:4352
  v_mfma_f32_16x16x32_bf16 v[28:31], a[200:203], a[4:7], v[28:31]
  s_cmp_lt_u32 s35, 7
  ds_read_b64_tr_b16 a[222:223], v239 offset:6400
  v_mfma_f32_16x16x32_bf16 v[32:35], a[200:203], a[8:11], v[32:35]
  s_waitcnt lgkmcnt(8)
  v_mfma_f32_16x16x32_bf16 v[36:39], a[204:207], a[0:3], v[36:39]
  s_cselect_b32 s74, s74, 0
  ds_read_b64_tr_b16 a[192:193], v228 offset:8192
  v_mfma_f32_16x16x32_bf16 v[40:43], a[204:207], a[4:7], v[40:43]
  s_and_b32 s74, s74, s87
  ds_read_b64_tr_b16 a[194:195], v228 offset:10240
  v_mfma_f32_16x16x32_bf16 v[44:47], a[204:207], a[8:11], v[44:47]
  s_waitcnt lgkmcnt(8)
  v_mfma_f32_16x16x32_bf16 v[0:3], a[208:211], a[12:15], v[0:3]
  s_bitcmp1_b32 s74, 3
  ds_read_b64_tr_b16 a[196:197], v239 offset:8192
  v_mfma_f32_16x16x32_bf16 v[4:7], a[208:211], a[16:19], v[4:7]
  s_cselect_b32 s66, 1376256, 0
  ds_read_b64_tr_b16 a[198:199], v239 offset:10240
  v_mfma_f32_16x16x32_bf16 v[8:11], a[208:211], a[20:23], v[8:11]
  s_waitcnt lgkmcnt(8)
  v_mfma_f32_16x16x32_bf16 v[12:15], a[212:215], a[12:15], v[12:15]
  s_cselect_b32 s36, 8, 0
  ds_read_b64_tr_b16 a[200:201], v228 offset:8448
  v_mfma_f32_16x16x32_bf16 v[16:19], a[212:215], a[16:19], v[16:19]
  s_andn2_b32 s87, s87, s36
  ds_read_b64_tr_b16 a[202:203], v228 offset:10496
  v_mfma_f32_16x16x32_bf16 v[20:23], a[212:215], a[20:23], v[20:23]
  s_waitcnt lgkmcnt(8)
  v_mfma_f32_16x16x32_bf16 v[24:27], a[216:219], a[12:15], v[24:27]
  ds_read_b64_tr_b16 a[204:205], v239 offset:8448
  v_mfma_f32_16x16x32_bf16 v[28:31], a[216:219], a[16:19], v[28:31]
  buffer_load_dwordx4 a[224:227], v233, s[64:67], s83 offen offset:0 sc1
  v_mfma_f32_16x16x32_bf16 v[32:35], a[216:219], a[20:23], v[32:35]
  s_waitcnt lgkmcnt(7)
  ds_read_b64_tr_b16 a[206:207], v239 offset:10496
  v_mfma_f32_16x16x32_bf16 v[36:39], a[220:223], a[12:15], v[36:39]
  ds_read_b64_tr_b16 a[208:209], v228 offset:12288
  v_mfma_f32_16x16x32_bf16 v[40:43], a[220:223], a[16:19], v[40:43]
  ds_read_b64_tr_b16 a[210:211], v228 offset:14336
  v_mfma_f32_16x16x32_bf16 v[44:47], a[220:223], a[20:23], v[44:47]
  s_waitcnt lgkmcnt(8)
  v_mfma_f32_16x16x32_bf16 v[0:3], a[192:195], a[24:27], v[0:3]
  ds_read_b64_tr_b16 a[212:213], v239 offset:12288
  v_mfma_f32_16x16x32_bf16 v[4:7], a[192:195], a[28:31], v[4:7]
  ds_read_b64_tr_b16 a[214:215], v239 offset:14336
  v_mfma_f32_16x16x32_bf16 v[8:11], a[192:195], a[32:35], v[8:11]
  s_waitcnt lgkmcnt(8)
  v_mfma_f32_16x16x32_bf16 v[12:15], a[196:199], a[24:27], v[12:15]
  ds_read_b64_tr_b16 a[216:217], v228 offset:12544
  v_mfma_f32_16x16x32_bf16 v[16:19], a[196:199], a[28:31], v[16:19]
  ds_read_b64_tr_b16 a[218:219], v228 offset:14592
  v_mfma_f32_16x16x32_bf16 v[20:23], a[196:199], a[32:35], v[20:23]
  s_waitcnt lgkmcnt(8)
  v_mfma_f32_16x16x32_bf16 v[24:27], a[200:203], a[24:27], v[24:27]
  ds_read_b64_tr_b16 a[220:221], v239 offset:12544
  v_mfma_f32_16x16x32_bf16 v[28:31], a[200:203], a[28:31], v[28:31]
  buffer_load_dwordx4 a[228:231], v233, s[64:67], s83 offen offset:1024 sc1
  v_mfma_f32_16x16x32_bf16 v[32:35], a[200:203], a[32:35], v[32:35]
  s_waitcnt lgkmcnt(7)
  ds_read_b64_tr_b16 a[222:223], v239 offset:14592
  v_add_u32 v228, 131072, v229
  v_mfma_f32_16x16x32_bf16 v[36:39], a[204:207], a[24:27], v[36:39]
  ds_read_b64_tr_b16 a[192:193], v228 offset:0
  v_xor_b32 v239, 32, v228
  v_mfma_f32_16x16x32_bf16 v[40:43], a[204:207], a[28:31], v[40:43]
  ds_read_b64_tr_b16 a[194:195], v228 offset:2048
  v_mfma_f32_16x16x32_bf16 v[44:47], a[204:207], a[32:35], v[44:47]
  s_waitcnt lgkmcnt(8)
  v_mfma_f32_16x16x32_bf16 v[0:3], a[208:211], a[36:39], v[0:3]
  ds_read_b64_tr_b16 a[196:197], v239 offset:0
  v_mfma_f32_16x16x32_bf16 v[4:7], a[208:211], a[40:43], v[4:7]
  ds_read_b64_tr_b16 a[198:199], v239 offset:2048
  v_mfma_f32_16x16x32_bf16 v[8:11], a[208:211], a[44:47], v[8:11]
  s_waitcnt lgkmcnt(8)
  v_mfma_f32_16x16x32_bf16 v[12:15], a[212:215], a[36:39], v[12:15]
  ds_read_b64_tr_b16 a[200:201], v228 offset:256
  v_mfma_f32_16x16x32_bf16 v[16:19], a[212:215], a[40:43], v[16:19]
  ds_read_b64_tr_b16 a[202:203], v228 offset:2304
  v_mfma_f32_16x16x32_bf16 v[20:23], a[212:215], a[44:47], v[20:23]
  s_waitcnt lgkmcnt(8)
  v_mfma_f32_16x16x32_bf16 v[24:27], a[216:219], a[36:39], v[24:27]
  ds_read_b64_tr_b16 a[204:205], v239 offset:256
  v_mfma_f32_16x16x32_bf16 v[28:31], a[216:219], a[40:43], v[28:31]
  buffer_load_dwordx4 a[232:235], v233, s[64:67], s83 offen offset:2048 sc1
  v_mfma_f32_16x16x32_bf16 v[32:35], a[216:219], a[44:47], v[32:35]
  s_waitcnt lgkmcnt(7)
  ds_read_b64_tr_b16 a[206:207], v239 offset:2304
  v_mfma_f32_16x16x32_bf16 v[36:39], a[220:223], a[36:39], v[36:39]
  ds_read_b64_tr_b16 a[208:209], v228 offset:4096
  v_mfma_f32_16x16x32_bf16 v[40:43], a[220:223], a[40:43], v[40:43]
  ds_read_b64_tr_b16 a[210:211], v228 offset:6144
  v_mfma_f32_16x16x32_bf16 v[44:47], a[220:223], a[44:47], v[44:47]
  s_waitcnt lgkmcnt(8)
  v_mfma_f32_16x16x32_bf16 v[0:3], a[192:195], a[48:51], v[0:3]
  s_waitcnt vmcnt(63)
  ds_read_b64_tr_b16 a[212:213], v239 offset:4096
  v_mfma_f32_16x16x32_bf16 v[4:7], a[192:195], a[52:55], v[4:7]
  s_barrier
  ds_read_b64_tr_b16 a[214:215], v239 offset:6144
  v_mfma_f32_16x16x32_bf16 v[8:11], a[192:195], a[56:59], v[8:11]
  s_waitcnt lgkmcnt(8)
  v_mfma_f32_16x16x32_bf16 v[12:15], a[196:199], a[48:51], v[12:15]
  ds_read_b64_tr_b16 a[216:217], v228 offset:4352
  v_mfma_f32_16x16x32_bf16 v[16:19], a[196:199], a[52:55], v[16:19]
  ds_read_b64_tr_b16 a[218:219], v228 offset:6400
  v_mfma_f32_16x16x32_bf16 v[20:23], a[196:199], a[56:59], v[20:23]
  s_waitcnt lgkmcnt(8)
  v_mfma_f32_16x16x32_bf16 v[24:27], a[200:203], a[48:51], v[24:27]
  ds_read_b64_tr_b16 a[220:221], v239 offset:4352
  v_mfma_f32_16x16x32_bf16 v[28:31], a[200:203], a[52:55], v[28:31]
  buffer_load_dwordx4 a[236:239], v233, s[64:67], s83 offen offset:3072 sc1
  v_mfma_f32_16x16x32_bf16 v[32:35], a[200:203], a[56:59], v[32:35]
  s_waitcnt lgkmcnt(7)
  ds_read_b64_tr_b16 a[222:223], v239 offset:6400
  v_mfma_f32_16x16x32_bf16 v[36:39], a[204:207], a[48:51], v[36:39]
  ds_read_b64_tr_b16 a[192:193], v228 offset:8192
  v_mfma_f32_16x16x32_bf16 v[40:43], a[204:207], a[52:55], v[40:43]
  ds_read_b64_tr_b16 a[194:195], v228 offset:10240
  v_mfma_f32_16x16x32_bf16 v[44:47], a[204:207], a[56:59], v[44:47]
  s_waitcnt lgkmcnt(8)
  v_mfma_f32_16x16x32_bf16 v[0:3], a[208:211], a[60:63], v[0:3]
  ds_read_b64_tr_b16 a[196:197], v239 offset:8192
  v_mfma_f32_16x16x32_bf16 v[4:7], a[208:211], a[64:67], v[4:7]
  ds_read_b64_tr_b16 a[198:199], v239 offset:10240
  v_mfma_f32_16x16x32_bf16 v[8:11], a[208:211], a[68:71], v[8:11]
  s_waitcnt lgkmcnt(8)
  v_mfma_f32_16x16x32_bf16 v[12:15], a[212:215], a[60:63], v[12:15]
  ds_read_b64_tr_b16 a[200:201], v228 offset:8448
  v_mfma_f32_16x16x32_bf16 v[16:19], a[212:215], a[64:67], v[16:19]
  ds_read_b64_tr_b16 a[202:203], v228 offset:10496
  v_mfma_f32_16x16x32_bf16 v[20:23], a[212:215], a[68:71], v[20:23]
  s_waitcnt lgkmcnt(8)
  v_mfma_f32_16x16x32_bf16 v[24:27], a[216:219], a[60:63], v[24:27]
  ds_read_b64_tr_b16 a[204:205], v239 offset:8448
  v_mfma_f32_16x16x32_bf16 v[28:31], a[216:219], a[64:67], v[28:31]
  buffer_load_dwordx4 a[240:243], v238, s[64:67], s83 offen offset:0 sc1
  v_mfma_f32_16x16x32_bf16 v[32:35], a[216:219], a[68:71], v[32:35]
  s_waitcnt lgkmcnt(7)
  ds_read_b64_tr_b16 a[206:207], v239 offset:10496
  v_mfma_f32_16x16x32_bf16 v[36:39], a[220:223], a[60:63], v[36:39]
  ds_read_b64_tr_b16 a[208:209], v228 offset:12288
  v_mfma_f32_16x16x32_bf16 v[40:43], a[220:223], a[64:67], v[40:43]
  ds_read_b64_tr_b16 a[210:211], v228 offset:14336
  v_mfma_f32_16x16x32_bf16 v[44:47], a[220:223], a[68:71], v[44:47]
  s_waitcnt lgkmcnt(8)
  v_mfma_f32_16x16x32_bf16 v[0:3], a[192:195], a[72:75], v[0:3]
  ds_read_b64_tr_b16 a[212:213], v239 offset:12288
  v_mfma_f32_16x16x32_bf16 v[4:7], a[192:195], a[76:79], v[4:7]
  ds_read_b64_tr_b16 a[214:215], v239 offset:14336
  v_mfma_f32_16x16x32_bf16 v[8:11], a[192:195], a[80:83], v[8:11]
  s_waitcnt lgkmcnt(8)
  v_mfma_f32_16x16x32_bf16 v[12:15], a[196:199], a[72:75], v[12:15]
  ds_read_b64_tr_b16 a[216:217], v228 offset:12544
  v_mfma_f32_16x16x32_bf16 v[16:19], a[196:199], a[76:79], v[16:19]
  ds_read_b64_tr_b16 a[218:219], v228 offset:14592
  v_mfma_f32_16x16x32_bf16 v[20:23], a[196:199], a[80:83], v[20:23]
  s_waitcnt lgkmcnt(8)
  v_mfma_f32_16x16x32_bf16 v[24:27], a[200:203], a[72:75], v[24:27]
  ds_read_b64_tr_b16 a[220:221], v239 offset:12544
  v_mfma_f32_16x16x32_bf16 v[28:31], a[200:203], a[76:79], v[28:31]
  buffer_load_dwordx4 a[244:247], v238, s[64:67], s83 offen offset:1024 sc1
  v_mfma_f32_16x16x32_bf16 v[32:35], a[200:203], a[80:83], v[32:35]
  s_waitcnt lgkmcnt(7)
  ds_read_b64_tr_b16 a[222:223], v239 offset:14592
  v_add_u32 v228, 65536, v229
  v_mfma_f32_16x16x32_bf16 v[36:39], a[204:207], a[72:75], v[36:39]
  ds_read_b64_tr_b16 a[192:193], v228 offset:0
  v_xor_b32 v239, 32, v228
  v_mfma_f32_16x16x32_bf16 v[40:43], a[204:207], a[76:79], v[40:43]
  ds_read_b64_tr_b16 a[194:195], v228 offset:2048
  v_mfma_f32_16x16x32_bf16 v[44:47], a[204:207], a[80:83], v[44:47]
  s_waitcnt lgkmcnt(8)
  v_mfma_f32_16x16x32_bf16 v[48:51], a[208:211], a[84:87], v[0:3]
  ds_read_b64_tr_b16 a[196:197], v239 offset:0
  v_mfma_f32_16x16x32_bf16 v[52:55], a[208:211], a[88:91], v[4:7]
  ds_read_b64_tr_b16 a[198:199], v239 offset:2048
  v_mfma_f32_16x16x32_bf16 v[56:59], a[208:211], a[92:95], v[8:11]
  s_waitcnt lgkmcnt(8)
  v_mfma_f32_16x16x32_bf16 v[60:63], a[212:215], a[84:87], v[12:15]
  ds_read_b64_tr_b16 a[200:201], v228 offset:256
  v_mfma_f32_16x16x32_bf16 v[64:67], a[212:215], a[88:91], v[16:19]
  ds_read_b64_tr_b16 a[202:203], v228 offset:2304
  v_mfma_f32_16x16x32_bf16 v[68:71], a[212:215], a[92:95], v[20:23]
  s_waitcnt lgkmcnt(8)
  v_mfma_f32_16x16x32_bf16 v[72:75], a[216:219], a[84:87], v[24:27]
  ds_read_b64_tr_b16 a[204:205], v239 offset:256
  v_mfma_f32_16x16x32_bf16 v[76:79], a[216:219], a[88:91], v[28:31]
  ds_read_b64_tr_b16 a[206:207], v239 offset:2304
  v_mfma_f32_16x16x32_bf16 v[80:83], a[216:219], a[92:95], v[32:35]
  s_waitcnt lgkmcnt(8)
  v_mfma_f32_16x16x32_bf16 v[84:87], a[220:223], a[84:87], v[36:39]
  ds_read_b64_tr_b16 a[208:209], v228 offset:4096
  v_mfma_f32_16x16x32_bf16 v[88:91], a[220:223], a[88:91], v[40:43]
  ds_read_b64_tr_b16 a[210:211], v228 offset:6144
  v_mfma_f32_16x16x32_bf16 v[92:95], a[220:223], a[92:95], v[44:47]
  s_waitcnt lgkmcnt(8)
  v_mfma_f32_16x16x32_bf16 v[0:3], a[192:195], a[96:99], 0
  s_waitcnt vmcnt(63)
  ds_read_b64_tr_b16 a[212:213], v239 offset:4096
  v_mfma_f32_16x16x32_bf16 v[4:7], a[192:195], a[100:103], 0
  s_barrier
  ds_read_b64_tr_b16 a[214:215], v239 offset:6144
  v_mfma_f32_16x16x32_bf16 v[8:11], a[192:195], a[104:107], 0
  s_waitcnt lgkmcnt(8)
  v_mfma_f32_16x16x32_bf16 v[12:15], a[196:199], a[96:99], 0
  s_mul_i32 s50, s57, 192
  ds_read_b64_tr_b16 a[216:217], v228 offset:4352
  v_cvt_pk_bf16_f32 v96, v48, v49
  v_mfma_f32_16x16x32_bf16 v[16:19], a[196:199], a[100:103], 0
  s_add_u32 s51, s50, 4096
  ds_read_b64_tr_b16 a[218:219], v228 offset:6400
  v_cvt_pk_bf16_f32 v97, v50, v51
  v_mfma_f32_16x16x32_bf16 v[20:23], a[196:199], a[104:107], 0
  s_waitcnt lgkmcnt(8)
  v_cvt_pk_bf16_f32 v98, v60, v61
  v_cvt_pk_bf16_f32 v99, v62, v63
  v_mfma_f32_16x16x32_bf16 v[24:27], a[200:203], a[96:99], 0
  ds_read_b64_tr_b16 a[220:221], v239 offset:4352
  v_cvt_pk_bf16_f32 v100, v72, v73
  v_mfma_f32_16x16x32_bf16 v[28:31], a[200:203], a[100:103], 0
  buffer_store_dwordx4 v[96:99], v233, s[20:23], s50 offen offset:0 sc1
  v_mfma_f32_16x16x32_bf16 v[32:35], a[200:203], a[104:107], 0
  s_waitcnt lgkmcnt(7)
  ds_read_b64_tr_b16 a[222:223], v239 offset:6400
  v_cvt_pk_bf16_f32 v101, v74, v75
  v_cvt_pk_bf16_f32 v102, v84, v85
  v_cvt_pk_bf16_f32 v103, v86, v87
  v_mfma_f32_16x16x32_bf16 v[36:39], a[204:207], a[96:99], 0
  ds_read_b64_tr_b16 a[192:193], v228 offset:8192
  v_cvt_pk_bf16_f32 v104, v52, v53
  v_mfma_f32_16x16x32_bf16 v[40:43], a[204:207], a[100:103], 0
  buffer_store_dwordx4 v[100:103], v233, s[20:23], s50 offen offset:1024 sc1
  v_mfma_f32_16x16x32_bf16 v[44:47], a[204:207], a[104:107], 0
  s_waitcnt lgkmcnt(7)
  ds_read_b64_tr_b16 a[194:195], v228 offset:10240
  v_cvt_pk_bf16_f32 v105, v54, v55
  v_cvt_pk_bf16_f32 v106, v64, v65
  v_cvt_pk_bf16_f32 v107, v66, v67
  v_mfma_f32_16x16x32_bf16 v[0:3], a[208:211], a[108:111], v[0:3]
  ds_read_b64_tr_b16 a[196:197], v239 offset:8192
  v_cvt_pk_bf16_f32 v108, v76, v77
  v_mfma_f32_16x16x32_bf16 v[4:7], a[208:211], a[112:115], v[4:7]
  buffer_store_dwordx4 v[104:107], v233, s[20:23], s50 offen offset:2048 sc1
  v_mfma_f32_16x16x32_bf16 v[8:11], a[208:211], a[116:119], v[8:11]
  s_waitcnt lgkmcnt(7)
  ds_read_b64_tr_b16 a[198:199], v239 offset:10240
  v_cvt_pk_bf16_f32 v109, v78, v79
  v_cvt_pk_bf16_f32 v110, v88, v89
  v_cvt_pk_bf16_f32 v111, v90, v91
  v_mfma_f32_16x16x32_bf16 v[12:15], a[212:215], a[108:111], v[12:15]
  ds_read_b64_tr_b16 a[200:201], v228 offset:8448
  v_cvt_pk_bf16_f32 v112, v56, v57
  v_mfma_f32_16x16x32_bf16 v[16:19], a[212:215], a[112:115], v[16:19]
  buffer_store_dwordx4 v[108:111], v233, s[20:23], s50 offen offset:3072 sc1
  v_mfma_f32_16x16x32_bf16 v[20:23], a[212:215], a[116:119], v[20:23]
  s_waitcnt lgkmcnt(7)
  ds_read_b64_tr_b16 a[202:203], v228 offset:10496
  v_cvt_pk_bf16_f32 v113, v58, v59
  v_cvt_pk_bf16_f32 v114, v68, v69
  v_cvt_pk_bf16_f32 v115, v70, v71
  v_mfma_f32_16x16x32_bf16 v[24:27], a[216:219], a[108:111], v[24:27]
  ds_read_b64_tr_b16 a[204:205], v239 offset:8448
  v_cvt_pk_bf16_f32 v116, v80, v81
  v_mfma_f32_16x16x32_bf16 v[28:31], a[216:219], a[112:115], v[28:31]
  buffer_store_dwordx4 v[112:115], v233, s[20:23], s51 offen offset:0 sc1
  v_mfma_f32_16x16x32_bf16 v[32:35], a[216:219], a[116:119], v[32:35]
  s_waitcnt lgkmcnt(7)
  ds_read_b64_tr_b16 a[206:207], v239 offset:10496
  v_cvt_pk_bf16_f32 v117, v82, v83
  v_cvt_pk_bf16_f32 v118, v92, v93
  v_cvt_pk_bf16_f32 v119, v94, v95
  v_mfma_f32_16x16x32_bf16 v[36:39], a[220:223], a[108:111], v[36:39]
  ds_read_b64_tr_b16 a[208:209], v228 offset:12288
  v_mfma_f32_16x16x32_bf16 v[40:43], a[220:223], a[112:115], v[40:43]
  buffer_store_dwordx4 v[116:119], v233, s[20:23], s51 offen offset:1024 sc1
  v_mfma_f32_16x16x32_bf16 v[44:47], a[220:223], a[116:119], v[44:47]
  s_waitcnt lgkmcnt(7)
  ds_read_b64_tr_b16 a[210:211], v228 offset:14336
  v_mfma_f32_16x16x32_bf16 v[0:3], a[192:195], a[120:123], v[0:3]
  ds_read_b64_tr_b16 a[212:213], v239 offset:12288
  v_mfma_f32_16x16x32_bf16 v[4:7], a[192:195], a[124:127], v[4:7]
  ds_read_b64_tr_b16 a[214:215], v239 offset:14336
  v_mfma_f32_16x16x32_bf16 v[8:11], a[192:195], a[128:131], v[8:11]
  s_waitcnt lgkmcnt(8)
  v_mfma_f32_16x16x32_bf16 v[12:15], a[196:199], a[120:123], v[12:15]
  ds_read_b64_tr_b16 a[216:217], v228 offset:12544
  v_mfma_f32_16x16x32_bf16 v[16:19], a[196:199], a[124:127], v[16:19]
  ds_read_b64_tr_b16 a[218:219], v228 offset:14592
  v_mfma_f32_16x16x32_bf16 v[20:23], a[196:199], a[128:131], v[20:23]
  s_waitcnt lgkmcnt(8)
  v_mfma_f32_16x16x32_bf16 v[24:27], a[200:203], a[120:123], v[24:27]
  ds_read_b64_tr_b16 a[220:221], v239 offset:12544
  v_mfma_f32_16x16x32_bf16 v[28:31], a[200:203], a[124:127], v[28:31]
  ds_read_b64_tr_b16 a[222:223], v239 offset:14592
  v_add_u32 v228, 98304, v229
  v_mfma_f32_16x16x32_bf16 v[32:35], a[200:203], a[128:131], v[32:35]
  s_waitcnt lgkmcnt(8)
  v_xor_b32 v239, 32, v228
  v_mfma_f32_16x16x32_bf16 v[36:39], a[204:207], a[120:123], v[36:39]
  ds_read_b64_tr_b16 a[192:193], v228 offset:0
  v_mfma_f32_16x16x32_bf16 v[40:43], a[204:207], a[124:127], v[40:43]
  ds_read_b64_tr_b16 a[194:195], v228 offset:2048
  v_mfma_f32_16x16x32_bf16 v[44:47], a[204:207], a[128:131], v[44:47]
  s_waitcnt lgkmcnt(8)
  v_mfma_f32_16x16x32_bf16 v[0:3], a[208:211], a[132:135], v[0:3]
  ds_read_b64_tr_b16 a[196:197], v239 offset:0
  v_mfma_f32_16x16x32_bf16 v[4:7], a[208:211], a[136:139], v[4:7]
  ds_read_b64_tr_b16 a[198:199], v239 offset:2048
  v_mfma_f32_16x16x32_bf16 v[8:11], a[208:211], a[140:143], v[8:11]
  s_waitcnt lgkmcnt(8)
  v_mfma_f32_16x16x32_bf16 v[12:15], a[212:215], a[132:135], v[12:15]
  ds_read_b64_tr_b16 a[200:201], v228 offset:256
  v_mfma_f32_16x16x32_bf16 v[16:19], a[212:215], a[136:139], v[16:19]
  ds_read_b64_tr_b16 a[202:203], v228 offset:2304
  v_mfma_f32_16x16x32_bf16 v[20:23], a[212:215], a[140:143], v[20:23]
  s_waitcnt lgkmcnt(8)
  v_mfma_f32_16x16x32_bf16 v[24:27], a[216:219], a[132:135], v[24:27]
  ds_read_b64_tr_b16 a[204:205], v239 offset:256
  v_mfma_f32_16x16x32_bf16 v[28:31], a[216:219], a[136:139], v[28:31]
  ds_read_b64_tr_b16 a[206:207], v239 offset:2304
  v_mfma_f32_16x16x32_bf16 v[32:35], a[216:219], a[140:143], v[32:35]
  s_waitcnt lgkmcnt(8)
  v_mfma_f32_16x16x32_bf16 v[36:39], a[220:223], a[132:135], v[36:39]
  ds_read_b64_tr_b16 a[208:209], v228 offset:4096
  v_mfma_f32_16x16x32_bf16 v[40:43], a[220:223], a[136:139], v[40:43]
  ds_read_b64_tr_b16 a[210:211], v228 offset:6144
  v_mfma_f32_16x16x32_bf16 v[44:47], a[220:223], a[140:143], v[44:47]
  s_waitcnt lgkmcnt(8)
  v_mfma_f32_16x16x32_bf16 v[0:3], a[192:195], a[144:147], v[0:3]
  ds_read_b64_tr_b16 a[212:213], v239 offset:4096
  v_mfma_f32_16x16x32_bf16 v[4:7], a[192:195], a[148:151], v[4:7]
  ds_read_b64_tr_b16 a[214:215], v239 offset:6144
  v_mfma_f32_16x16x32_bf16 v[8:11], a[192:195], a[152:155], v[8:11]
  s_waitcnt lgkmcnt(8)
  v_mfma_f32_16x16x32_bf16 v[12:15], a[196:199], a[144:147], v[12:15]
  ds_read_b64_tr_b16 a[216:217], v228 offset:4352
  v_mfma_f32_16x16x32_bf16 v[16:19], a[196:199], a[148:151], v[16:19]
  buffer_load_dwordx2 v[224:225], v222, s[76:79], s58 offen offset:0 sc1
  v_mfma_f32_16x16x32_bf16 v[20:23], a[196:199], a[152:155], v[20:23]
  s_waitcnt lgkmcnt(7)
  ds_read_b64_tr_b16 a[218:219], v228 offset:6400
  v_mfma_f32_16x16x32_bf16 v[24:27], a[200:203], a[144:147], v[24:27]
  ds_read_b64_tr_b16 a[220:221], v239 offset:4352
  v_mfma_f32_16x16x32_bf16 v[28:31], a[200:203], a[148:151], v[28:31]
  ds_read_b64_tr_b16 a[222:223], v239 offset:6400
  v_mfma_f32_16x16x32_bf16 v[32:35], a[200:203], a[152:155], v[32:35]
  s_waitcnt lgkmcnt(8)
  v_mfma_f32_16x16x32_bf16 v[36:39], a[204:207], a[144:147], v[36:39]
  ds_read_b64_tr_b16 a[192:193], v228 offset:8192
  v_mfma_f32_16x16x32_bf16 v[40:43], a[204:207], a[148:151], v[40:43]
  ds_read_b64_tr_b16 a[194:195], v228 offset:10240
  v_mfma_f32_16x16x32_bf16 v[44:47], a[204:207], a[152:155], v[44:47]
  s_waitcnt lgkmcnt(8)
  v_mfma_f32_16x16x32_bf16 v[0:3], a[208:211], a[156:159], v[0:3]
  s_waitcnt vmcnt(1)
  ds_read_b64_tr_b16 a[196:197], v239 offset:8192
  v_mfma_f32_16x16x32_bf16 v[4:7], a[208:211], a[160:163], v[4:7]
  s_barrier
  ds_read_b64_tr_b16 a[198:199], v239 offset:10240
  v_mfma_f32_16x16x32_bf16 v[8:11], a[208:211], a[164:167], v[8:11]
  s_waitcnt lgkmcnt(8)
  v_mfma_f32_16x16x32_bf16 v[12:15], a[212:215], a[156:159], v[12:15]
  ds_read_b64_tr_b16 a[200:201], v228 offset:8448
  v_mfma_f32_16x16x32_bf16 v[16:19], a[212:215], a[160:163], v[16:19]
  buffer_store_dwordx2 v[226:227], v246, s[76:79], s57 offen offset:0 sc1
  v_mfma_f32_16x16x32_bf16 v[20:23], a[212:215], a[164:167], v[20:23]
  s_waitcnt lgkmcnt(7)
  ds_read_b64_tr_b16 a[202:203], v228 offset:10496
  v_mfma_f32_16x16x32_bf16 v[24:27], a[216:219], a[156:159], v[24:27]
  ds_read_b64_tr_b16 a[204:205], v239 offset:8448
  v_mfma_f32_16x16x32_bf16 v[28:31], a[216:219], a[160:163], v[28:31]
  ds_read_b64_tr_b16 a[206:207], v239 offset:10496
  v_mfma_f32_16x16x32_bf16 v[32:35], a[216:219], a[164:167], v[32:35]
  s_waitcnt lgkmcnt(8)
  v_mfma_f32_16x16x32_bf16 v[36:39], a[220:223], a[156:159], v[36:39]
  ds_read_b64_tr_b16 a[208:209], v228 offset:12288
  v_mfma_f32_16x16x32_bf16 v[40:43], a[220:223], a[160:163], v[40:43]
  ds_read_b64_tr_b16 a[210:211], v228 offset:14336
  v_mfma_f32_16x16x32_bf16 v[44:47], a[220:223], a[164:167], v[44:47]
  s_waitcnt lgkmcnt(8)
  v_mfma_f32_16x16x32_bf16 v[0:3], a[192:195], a[168:171], v[0:3]
  ds_read_b64_tr_b16 a[212:213], v239 offset:12288
  v_mfma_f32_16x16x32_bf16 v[4:7], a[192:195], a[172:175], v[4:7]
  ds_read_b64_tr_b16 a[214:215], v239 offset:14336
  v_mfma_f32_16x16x32_bf16 v[8:11], a[192:195], a[176:179], v[8:11]
  s_waitcnt lgkmcnt(8)
  v_mfma_f32_16x16x32_bf16 v[12:15], a[196:199], a[168:171], v[12:15]
  ds_read_b64_tr_b16 a[216:217], v228 offset:12544
  v_mfma_f32_16x16x32_bf16 v[16:19], a[196:199], a[172:175], v[16:19]
  ds_read_b64_tr_b16 a[218:219], v228 offset:14592
  v_mfma_f32_16x16x32_bf16 v[20:23], a[196:199], a[176:179], v[20:23]
  s_waitcnt lgkmcnt(8)
  v_mfma_f32_16x16x32_bf16 v[24:27], a[200:203], a[168:171], v[24:27]
  ds_read_b64_tr_b16 a[220:221], v239 offset:12544
  v_mfma_f32_16x16x32_bf16 v[28:31], a[200:203], a[172:175], v[28:31]
  ds_read_b64_tr_b16 a[222:223], v239 offset:14592
  v_add_u32 v228, 16384, v229
  v_mfma_f32_16x16x32_bf16 v[32:35], a[200:203], a[176:179], v[32:35]
  s_waitcnt lgkmcnt(8)
  v_xor_b32 v239, 32, v228
  v_mfma_f32_16x16x32_bf16 v[36:39], a[204:207], a[168:171], v[36:39]
  ds_read_b64_tr_b16 a[192:193], v228 offset:0
  v_mfma_f32_16x16x32_bf16 v[40:43], a[204:207], a[172:175], v[40:43]
  ds_read_b64_tr_b16 a[194:195], v228 offset:2048
  v_mfma_f32_16x16x32_bf16 v[44:47], a[204:207], a[176:179], v[44:47]
  s_waitcnt lgkmcnt(8)
  v_mfma_f32_16x16x32_bf16 v[0:3], a[208:211], a[180:183], v[0:3]
  ds_read_b64_tr_b16 a[196:197], v239 offset:0
  v_mfma_f32_16x16x32_bf16 v[4:7], a[208:211], a[184:187], v[4:7]
  ds_read_b64_tr_b16 a[198:199], v239 offset:2048
  v_mfma_f32_16x16x32_bf16 v[8:11], a[208:211], a[188:191], v[8:11]
  s_waitcnt lgkmcnt(8)
  v_mfma_f32_16x16x32_bf16 v[12:15], a[212:215], a[180:183], v[12:15]
  ds_read_b64_tr_b16 a[200:201], v228 offset:256
  v_mfma_f32_16x16x32_bf16 v[16:19], a[212:215], a[184:187], v[16:19]
  ds_read_b64_tr_b16 a[202:203], v228 offset:2304
  v_mfma_f32_16x16x32_bf16 v[20:23], a[212:215], a[188:191], v[20:23]
  s_waitcnt lgkmcnt(8)
  v_mfma_f32_16x16x32_bf16 v[24:27], a[216:219], a[180:183], v[24:27]
  ds_read_b64_tr_b16 a[204:205], v239 offset:256
  v_mfma_f32_16x16x32_bf16 v[28:31], a[216:219], a[184:187], v[28:31]
  ds_read_b64_tr_b16 a[206:207], v239 offset:2304
  v_mfma_f32_16x16x32_bf16 v[32:35], a[216:219], a[188:191], v[32:35]
  s_waitcnt lgkmcnt(8)
  v_mfma_f32_16x16x32_bf16 v[36:39], a[220:223], a[180:183], v[36:39]
  ds_read_b64_tr_b16 a[208:209], v228 offset:4096
  v_mfma_f32_16x16x32_bf16 v[40:43], a[220:223], a[184:187], v[40:43]
  ds_read_b64_tr_b16 a[210:211], v228 offset:6144
  v_mfma_f32_16x16x32_bf16 v[44:47], a[220:223], a[188:191], v[44:47]
  s_cmp_eq_u32 s35, 7
  s_cbranch_scc1 L_sk4
  s_waitcnt vmcnt(63)
  v_mfma_f32_16x16x32_bf16 v[120:123], v[250:253], a[224:227], v[120:123]
  v_mfma_f32_16x16x32_bf16 v[132:135], v[248:251], a[224:227], v[132:135]
  v_mfma_f32_16x16x32_bf16 v[144:147], v[250:253], a[228:231], v[144:147]
  v_mfma_f32_16x16x32_bf16 v[156:159], v[248:251], a[228:231], v[156:159]
  v_mfma_f32_16x16x32_bf16 v[124:127], v[250:253], a[232:235], v[124:127]
  v_mfma_f32_16x16x32_bf16 v[136:139], v[248:251], a[232:235], v[136:139]
  v_mfma_f32_16x16x32_bf16 v[148:151], v[250:253], a[236:239], v[148:151]
  v_mfma_f32_16x16x32_bf16 v[160:163], v[248:251], a[236:239], v[160:163]
  v_mfma_f32_16x16x32_bf16 v[128:131], v[250:253], a[240:243], v[128:131]
  v_mfma_f32_16x16x32_bf16 v[140:143], v[248:251], a[240:243], v[140:143]
  v_mfma_f32_16x16x32_bf16 v[152:155], v[250:253], a[244:247], v[152:155]
  v_mfma_f32_16x16x32_bf16 v[164:167], v[248:251], a[244:247], v[164:167]
L_sk4:
  s_waitcnt lgkmcnt(8)
  v_mfma_f32_16x16x32_bf16 v[0:3], a[192:195], a[0:3], v[0:3]
  s_waitcnt vmcnt(1)
  ds_read_b64_tr_b16 a[212:213], v239 offset:4096
  v_mfma_f32_16x16x32_bf16 v[4:7], a[192:195], a[4:7], v[4:7]
  s_barrier
  ds_read_b64_tr_b16 a[214:215], v239 offset:6144
  v_mfma_f32_16x16x32_bf16 v[8:11], a[192:195], a[8:11], v[8:11]
  s_waitcnt lgkmcnt(8)
  v_mfma_f32_16x16x32_bf16 v[12:15], a[196:199], a[0:3], v[12:15]
  v_cmp_eq_u64 vcc, s[72:73], v[224:225]
  ds_read_b64_tr_b16 a[216:217], v228 offset:4352
  v_mfma_f32_16x16x32_bf16 v[16:19], a[196:199], a[4:7], v[16:19]
  s_and_b32 s74, vcc_lo, 0xff
  ds_read_b64_tr_b16 a[218:219], v228 offset:6400
  v_mfma_f32_16x16x32_bf16 v[20:23], a[196:199], a[8:11], v[20:23]
  s_waitcnt lgkmcnt(8)
  v_mfma_f32_16x16x32_bf16 v[24:27], a[200:203], a[0:3], v[24:27]
  s_cmp_lt_u32 s35, 7
  ds_read_b64_tr_b16 a[220:221], v239 offset:4352
  v_mfma_f32_16x16x32_bf16 v[28:31], a[200:203], a[4:7], v[28:31]
  s_cselect_b32 s74, s74, 0
  ds_read_b64_tr_b16 a[222:223], v239 offset:6400
  v_mfma_f32_16x16x32_bf16 v[32:35], a[200:203], a[8:11], v[32:35]
  s_waitcnt lgkmcnt(8)
  v_mfma_f32_16x16x32_bf16 v[36:39], a[204:207], a[0:3], v[36:39]
  s_and_b32 s74, s74, s87
  ds_read_b64_tr_b16 a[192:193], v228 offset:8192
  v_mfma_f32_16x16x32_bf16 v[40:43], a[204:207], a[4:7], v[40:43]
  s_bitcmp1_b32 s74, 4
  s_cselect_b32 s66, 1376256, 0
  s_cselect_b32 s36, 16, 0
  s_andn2_b32 s87, s87, s36
  buffer_load_dwordx4 v[168:171], v233, s[64:67], s84 offen offset:0 sc1
  v_mfma_f32_16x16x32_bf16 v[44:47], a[204:207], a[8:11], v[44:47]
  s_waitcnt lgkmcnt(7)
  ds_read_b64_tr_b16 a[194:195], v228 offset:10240
  v_mfma_f32_16x16x32_bf16 v[0:3], a[208:211], a[12:15], v[0:3]
  ds_read_b64_tr_b16 a[196:197], v239 offset:8192
  v_mfma_f32_16x16x32_bf16 v[4:7], a[208:211], a[16:19], v[4:7]
  buffer_load_dwordx4 v[172:175], v233, s[64:67], s84 offen offset:1024 sc1
  v_mfma_f32_16x16x32_bf16 v[8:11], a[208:211], a[20:23], v[8:11]
  s_waitcnt lgkmcnt(7)
  ds_read_b64_tr_b16 a[198:199], v239 offset:10240
  v_mfma_f32_16x16x32_bf16 v[12:15], a[212:215], a[12:15], v[12:15]
  ds_read_b64_tr_b16 a[200:201], v228 offset:8448
  v_mfma_f32_16x16x32_bf16 v[16:19], a[212:215], a[16:19], v[16:19]
  buffer_load_dwordx4 v[176:179], v233, s[64:67], s84 offen offset:2048 sc1
  v_mfma_f32_16x16x32_bf16 v[20:23], a[212:215], a[20:23], v[20:23]
  s_waitcnt lgkmcnt(7)
  ds_read_b64_tr_b16 a[202:203], v228 offset:10496
  v_mfma_f32_16x16x32_bf16 v[24:27], a[216:219], a[12:15], v[24:27]
  ds_read_b64_tr_b16 a[204:205], v239 offset:8448
  v_mfma_f32_16x16x32_bf16 v[28:31], a[216:219], a[16:19], v[28:31]
  buffer_load_dwordx4 v[180:183], v233, s[64:67], s84 offen offset:3072 sc1
  v_mfma_f32_16x16x32_bf16 v[32:35], a[216:219], a[20:23], v[32:35]
  s_waitcnt lgkmcnt(7)
  ds_read_b64_tr_b16 a[206:207], v239 offset:10496
  v_mfma_f32_16x16x32_bf16 v[36:39], a[220:223], a[12:15], v[36:39]
  ds_read_b64_tr_b16 a[208:209], v228 offset:12288
  v_mfma_f32_16x16x32_bf16 v[40:43], a[220:223], a[16:19], v[40:43]
  buffer_load_dwordx4 v[184:187], v238, s[64:67], s84 offen offset:0 sc1
  v_mfma_f32_16x16x32_bf16 v[44:47], a[220:223], a[20:23], v[44:47]
  s_waitcnt lgkmcnt(7)
  ds_read_b64_tr_b16 a[210:211], v228 offset:14336
  v_mfma_f32_16x16x32_bf16 v[0:3], a[192:195], a[24:27], v[0:3]
  ds_read_b64_tr_b16 a[212:213], v239 offset:12288
  v_mfma_f32_16x16x32_bf16 v[4:7], a[192:195], a[28:31], v[4:7]
  buffer_load_dwordx4 v[188:191], v238, s[64:67], s84 offen offset:1024 sc1
  v_mfma_f32_16x16x32_bf16 v[8:11], a[192:195], a[32:35], v[8:11]
  s_waitcnt lgkmcnt(7)
  ds_read_b64_tr_b16 a[214:215], v239 offset:14336
  v_mfma_f32_16x16x32_bf16 v[12:15], a[196:199], a[24:27], v[12:15]
  ds_read_b64_tr_b16 a[216:217], v228 offset:12544
  v_mfma_f32_16x16x32_bf16 v[16:19], a[196:199], a[28:31], v[16:19]
  s_bitcmp1_b32 s74, 6
  s_cselect_b32 s66, 1376256, 0
  s_cselect_b32 s36, 64, 0
  s_andn2_b32 s87, s87, s36
  buffer_load_dwordx4 v[192:195], v233, s[64:67], s86 offen offset:0 sc1
  v_mfma_f32_16x16x32_bf16 v[20:23], a[196:199], a[32:35], v[20:23]
  s_waitcnt lgkmcnt(7)
  ds_read_b64_tr_b16 a[218:219], v228 offset:14592
  v_mfma_f32_16x16x32_bf16 v[24:27], a[200:203], a[24:27], v[24:27]
  ds_read_b64_tr_b16 a[220:221], v239 offset:12544
  v_mfma_f32_16x16x32_bf16 v[28:31], a[200:203], a[28:31], v[28:31]
  buffer_load_dwordx4 v[196:199], v233, s[64:67], s86 offen offset:1024 sc1
  v_mfma_f32_16x16x32_bf16 v[32:35], a[200:203], a[32:35], v[32:35]
  s_waitcnt lgkmcnt(7)
  ds_read_b64_tr_b16 a[222:223], v239 offset:14592
  v_add_u32 v228, 114688, v229
  v_mfma_f32_16x16x32_bf16 v[36:39], a[204:207], a[24:27], v[36:39]
  ds_read_b64_tr_b16 a[192:193], v228 offset:0
  v_xor_b32 v239, 32, v228
  v_mfma_f32_16x16x32_bf16 v[40:43], a[204:207], a[28:31], v[40:43]
  buffer_load_dwordx4 v[200:203], v233, s[64:67], s86 offen offset:2048 sc1
  v_mfma_f32_16x16x32_bf16 v[44:47], a[204:207], a[32:35], v[44:47]
  s_waitcnt lgkmcnt(7)
  ds_read_b64_tr_b16 a[194:195], v228 offset:2048
  v_mfma_f32_16x16x32_bf16 v[0:3], a[208:211], a[36:39], v[0:3]
  ds_read_b64_tr_b16 a[196:197], v239 offset:0
  v_mfma_f32_16x16x32_bf16 v[4:7], a[208:211], a[40:43], v[4:7]
  buffer_load_dwordx4 v[204:207], v233, s[64:67], s86 offen offset:3072 sc1
  v_mfma_f32_16x16x32_bf16 v[8:11], a[208:211], a[44:47], v[8:11]
  s_waitcnt lgkmcnt(7)
  ds_read_b64_tr_b16 a[198:199], v239 offset:2048
  v_mfma_f32_16x16x32_bf16 v[12:15], a[212:215], a[36:39], v[12:15]
  ds_read_b64_tr_b16 a[200:201], v228 offset:256
  v_mfma_f32_16x16x32_bf16 v[16:19], a[212:215], a[40:43], v[16:19]
  buffer_load_dwordx4 v[208:211], v238, s[64:67], s86 offen offset:0 sc1
  v_mfma_f32_16x16x32_bf16 v[20:23], a[212:215], a[44:47], v[20:23]
  s_waitcnt lgkmcnt(7)
  ds_read_b64_tr_b16 a[202:203], v228 offset:2304
  v_mfma_f32_16x16x32_bf16 v[24:27], a[216:219], a[36:39], v[24:27]
  ds_read_b64_tr_b16 a[204:205], v239 offset:256
  v_mfma_f32_16x16x32_bf16 v[28:31], a[216:219], a[40:43], v[28:31]
  buffer_load_dwordx4 v[212:215], v238, s[64:67], s86 offen offset:1024 sc1
  v_mfma_f32_16x16x32_bf16 v[32:35], a[216:219], a[44:47], v[32:35]
  s_waitcnt lgkmcnt(7)
  ds_read_b64_tr_b16 a[206:207], v239 offset:2304
  v_mfma_f32_16x16x32_bf16 v[36:39], a[220:223], a[36:39], v[36:39]
  ds_read_b64_tr_b16 a[208:209], v228 offset:4096
  v_mfma_f32_16x16x32_bf16 v[40:43], a[220:223], a[40:43], v[40:43]
  ds_read_b64_tr_b16 a[210:211], v228 offset:6144
  v_mfma_f32_16x16x32_bf16 v[44:47], a[220:223], a[44:47], v[44:47]
  s_waitcnt lgkmcnt(8)
  v_mfma_f32_16x16x32_bf16 v[0:3], a[192:195], a[48:51], v[0:3]
  ds_read_b64_tr_b16 a[212:213], v239 offset:4096
  v_mfma_f32_16x16x32_bf16 v[4:7], a[192:195], a[52:55], v[4:7]
  s_barrier
  ds_read_b64_tr_b16 a[214:215], v239 offset:6144
  v_mfma_f32_16x16x32_bf16 v[8:11], a[192:195], a[56:59], v[8:11]
  s_waitcnt lgkmcnt(8)
  v_mfma_f32_16x16x32_bf16 v[12:15], a[196:199], a[48:51], v[12:15]
  ds_read_b64_tr_b16 a[216:217], v228 offset:4352
  v_mfma_f32_16x16x32_bf16 v[16:19], a[196:199], a[52:55], v[16:19]
  buffer_load_dwordx2 v[224:225], v222, s[76:79], s58 offen offset:0 sc1
  v_mfma_f32_16x16x32_bf16 v[20:23], a[196:199], a[56:59], v[20:23]
  s_waitcnt lgkmcnt(7)
  ds_read_b64_tr_b16 a[218:219], v228 offset:6400
  v_mfma_f32_16x16x32_bf16 v[24:27], a[200:203], a[48:51], v[24:27]
  ds_read_b64_tr_b16 a[220:221], v239 offset:4352
  v_mfma_f32_16x16x32_bf16 v[28:31], a[200:203], a[52:55], v[28:31]
  ds_read_b64_tr_b16 a[222:223], v239 offset:6400
  v_mfma_f32_16x16x32_bf16 v[32:35], a[200:203], a[56:59], v[32:35]
  s_waitcnt lgkmcnt(8)
  v_mfma_f32_16x16x32_bf16 v[36:39], a[204:207], a[48:51], v[36:39]
  ds_read_b64_tr_b16 a[192:193], v228 offset:8192
  v_mfma_f32_16x16x32_bf16 v[40:43], a[204:207], a[52:55], v[40:43]
  ds_read_b64_tr_b16 a[194:195], v228 offset:10240
  v_mfma_f32_16x16x32_bf16 v[44:47], a[204:207], a[56:59], v[44:47]
  s_waitcnt lgkmcnt(8)
  v_mfma_f32_16x16x32_bf16 v[0:3], a[208:211], a[60:63], v[0:3]
  ds_read_b64_tr_b16 a[196:197], v239 offset:8192
  v_mfma_f32_16x16x32_bf16 v[4:7], a[208:211], a[64:67], v[4:7]
  ds_read_b64_tr_b16 a[198:199], v239 offset:10240
  v_mfma_f32_16x16x32_bf16 v[8:11], a[208:211], a[68:71], v[8:11]
  s_waitcnt lgkmcnt(8)
  v_mfma_f32_16x16x32_bf16 v[12:15], a[212:215], a[60:63], v[12:15]
  ds_read_b64_tr_b16 a[200:201], v228 offset:8448
  v_mfma_f32_16x16x32_bf16 v[16:19], a[212:215], a[64:67], v[16:19]
  ds_read_b64_tr_b16 a[202:203], v228 offset:10496
  v_mfma_f32_16x16x32_bf16 v[20:23], a[212:215], a[68:71], v[20:23]
  s_waitcnt lgkmcnt(8)
  v_mfma_f32_16x16x32_bf16 v[24:27], a[216:219], a[60:63], v[24:27]
  ds_read_b64_tr_b16 a[204:205], v239 offset:8448
  v_mfma_f32_16x16x32_bf16 v[28:31], a[216:219], a[64:67], v[28:31]
  ds_read_b64_tr_b16 a[206:207], v239 offset:10496
  v_mfma_f32_16x16x32_bf16 v[32:35], a[216:219], a[68:71], v[32:35]
  s_waitcnt lgkmcnt(8)
  v_mfma_f32_16x16x32_bf16 v[36:39], a[220:223], a[60:63], v[36:39]
  ds_read_b64_tr_b16 a[208:209], v228 offset:12288
  v_mfma_f32_16x16x32_bf16 v[40:43], a[220:223], a[64:67], v[40:43]
  ds_read_b64_tr_b16 a[210:211], v228 offset:14336
  v_mfma_f32_16x16x32_bf16 v[44:47], a[220:223], a[68:71], v[44:47]
  s_waitcnt lgkmcnt(8)
  v_mfma_f32_16x16x32_bf16 v[0:3], a[192:195], a[72:75], v[0:3]
  ds_read_b64_tr_b16 a[212:213], v239 offset:12288
  v_mfma_f32_16x16x32_bf16 v[4:7], a[192:195], a[76:79], v[4:7]
  ds_read_b64_tr_b16 a[214:215], v239 offset:14336
  v_mfma_f32_16x16x32_bf16 v[8:11], a[192:195], a[80:83], v[8:11]
  s_waitcnt lgkmcnt(8)
  v_mfma_f32_16x16x32_bf16 v[12:15], a[196:199], a[72:75], v[12:15]
  ds_read_b64_tr_b16 a[216:217], v228 offset:12544
  v_mfma_f32_16x16x32_bf16 v[16:19], a[196:199], a[76:79], v[16:19]
  s_waitcnt vmcnt(0)
  v_cmp_eq_u64 vcc, s[72:73], v[224:225]
  s_nop 0
  s_and_b32 s74, vcc_lo, 0xff
  s_cmp_lt_u32 s35, 7
  s_cselect_b32 s74, s74, 0
  s_and_b32 s74, s74, s87
  s_bitcmp1_b32 s74, 5
  s_cselect_b32 s66, 1376256, 0
  s_cselect_b32 s36, 32, 0
  s_andn2_b32 s87, s87, s36
  buffer_load_dwordx4 a[224:227], v233, s[64:67], s85 offen offset:0 sc1
  v_mfma_f32_16x16x32_bf16 v[20:23], a[196:199], a[80:83], v[20:23]
  s_waitcnt lgkmcnt(7)
  ds_read_b64_tr_b16 a[218:219], v228 offset:14592
  v_mfma_f32_16x16x32_bf16 v[24:27], a[200:203], a[72:75], v[24:27]
  ds_read_b64_tr_b16 a[220:221], v239 offset:12544
  v_mfma_f32_16x16x32_bf16 v[28:31], a[200:203], a[76:79], v[28:31]
  buffer_load_dwordx4 a[228:231], v233, s[64:67], s85 offen offset:1024 sc1
  v_mfma_f32_16x16x32_bf16 v[32:35], a[200:203], a[80:83], v[32:35]
  s_waitcnt lgkmcnt(7)
  ds_read_b64_tr_b16 a[222:223], v239 offset:14592
  v_mfma_f32_16x16x32_bf16 v[36:39], a[204:207], a[72:75], v[36:39]
  v_mfma_f32_16x16x32_bf16 v[40:43], a[204:207], a[76:79], v[40:43]
  buffer_load_dwordx4 a[232:235], v233, s[64:67], s85 offen offset:2048 sc1
  v_mfma_f32_16x16x32_bf16 v[44:47], a[204:207], a[80:83], v[44:47]
  s_waitcnt lgkmcnt(6)
  v_mfma_f32_16x16x32_bf16 v[48:51], a[208:211], a[84:87], v[0:3]
  v_mfma_f32_16x16x32_bf16 v[52:55], a[208:211], a[88:91], v[4:7]
  buffer_load_dwordx4 a[236:239], v233, s[64:67], s85 offen offset:3072 sc1
  v_mfma_f32_16x16x32_bf16 v[56:59], a[208:211], a[92:95], v[8:11]
  s_waitcnt lgkmcnt(4)
  v_mfma_f32_16x16x32_bf16 v[60:63], a[212:215], a[84:87], v[12:15]
  v_mfma_f32_16x16x32_bf16 v[64:67], a[212:215], a[88:91], v[16:19]
  buffer_load_dwordx4 a[240:243], v238, s[64:67], s85 offen offset:0 sc1
  v_mfma_f32_16x16x32_bf16 v[68:71], a[212:215], a[92:95], v[20:23]
  s_waitcnt lgkmcnt(2)
  v_mfma_f32_16x16x32_bf16 v[72:75], a[216:219], a[84:87], v[24:27]
  v_mfma_f32_16x16x32_bf16 v[76:79], a[216:219], a[88:91], v[28:31]
  buffer_load_dwordx4 a[244:247], v238, s[64:67], s85 offen offset:1024 sc1
  v_mfma_f32_16x16x32_bf16 v[80:83], a[216:219], a[92:95], v[32:35]
  s_waitcnt lgkmcnt(0)
  v_mfma_f32_16x16x32_bf16 v[84:87], a[220:223], a[84:87], v[36:39]
  v_mfma_f32_16x16x32_bf16 v[88:91], a[220:223], a[88:91], v[40:43]
  v_mfma_f32_16x16x32_bf16 v[92:95], a[220:223], a[92:95], v[44:47]
  s_cmp_eq_u32 s35, 7
  s_cbranch_scc1 L_pub
  s_waitcnt vmcnt(63)
  v_mfma_f32_16x16x32_bf16 v[120:123], v[250:253], v[168:171], v[120:123]
  v_mfma_f32_16x16x32_bf16 v[132:135], v[248:251], v[168:171], v[132:135]
  v_mfma_f32_16x16x32_bf16 v[144:147], v[250:253], v[172:175], v[144:147]
  v_mfma_f32_16x16x32_bf16 v[156:159], v[248:251], v[172:175], v[156:159]
  v_mfma_f32_16x16x32_bf16 v[124:127], v[250:253], v[176:179], v[124:127]
  v_mfma_f32_16x16x32_bf16 v[136:139], v[248:251], v[176:179], v[136:139]
  v_mfma_f32_16x16x32_bf16 v[148:151], v[250:253], v[180:183], v[148:151]
  v_mfma_f32_16x16x32_bf16 v[160:163], v[248:251], v[180:183], v[160:163]
  v_mfma_f32_16x16x32_bf16 v[128:131], v[250:253], v[184:187], v[128:131]
  v_mfma_f32_16x16x32_bf16 v[140:143], v[248:251], v[184:187], v[140:143]
  v_mfma_f32_16x16x32_bf16 v[152:155], v[250:253], v[188:191], v[152:155]
  v_mfma_f32_16x16x32_bf16 v[164:167], v[248:251], v[188:191], v[164:167]
  v_mfma_f32_16x16x32_bf16 v[120:123], v[250:253], v[192:195], v[120:123]
  v_mfma_f32_16x16x32_bf16 v[132:135], v[248:251], v[192:195], v[132:135]
  v_mfma_f32_16x16x32_bf16 v[144:147], v[250:253], v[196:199], v[144:147]
  v_mfma_f32_16x16x32_bf16 v[156:159], v[248:251], v[196:199], v[156:159]
  v_mfma_f32_16x16x32_bf16 v[124:127], v[250:253], v[200:203], v[124:127]
  v_mfma_f32_16x16x32_bf16 v[136:139], v[248:251], v[200:203], v[136:139]
  v_mfma_f32_16x16x32_bf16 v[148:151], v[250:253], v[204:207], v[148:151]
  v_mfma_f32_16x16x32_bf16 v[160:163], v[248:251], v[204:207], v[160:163]
  v_mfma_f32_16x16x32_bf16 v[128:131], v[250:253], v[208:211], v[128:131]
  v_mfma_f32_16x16x32_bf16 v[140:143], v[248:251], v[208:211], v[140:143]
  v_mfma_f32_16x16x32_bf16 v[152:155], v[250:253], v[212:215], v[152:155]
  v_mfma_f32_16x16x32_bf16 v[164:167], v[248:251], v[212:215], v[164:167]
  s_bitcmp1_b32 s74, 6
  s_cselect_b32 s66, 1376256, 0
  s_cselect_b32 s36, 64, 0
  s_andn2_b32 s87, s87, s36
  buffer_load_dwordx4 v[168:171], v233, s[64:67], s86 offen offset:0 sc1
  buffer_load_dwordx4 v[172:175], v233, s[64:67], s86 offen offset:1024 sc1
  buffer_load_dwordx4 v[176:179], v233, s[64:67], s86 offen offset:2048 sc1
  buffer_load_dwordx4 v[180:183], v233, s[64:67], s86 offen offset:3072 sc1
  buffer_load_dwordx4 v[184:187], v238, s[64:67], s86 offen offset:0 sc1
  buffer_load_dwordx4 v[188:191], v238, s[64:67], s86 offen offset:1024 sc1
  s_add_u32 s37, s58, 14336
  s_add_u32 s38, s58, 28672
  v_mov_b32 v240, 131072
  s_waitcnt vmcnt(6)
  v_mfma_f32_16x16x32_bf16 v[120:123], v[250:253], a[224:227], v[120:123]
  v_mfma_f32_16x16x32_bf16 v[132:135], v[248:251], a[224:227], v[132:135]
  v_mfma_f32_16x16x32_bf16 v[144:147], v[250:253], a[228:231], v[144:147]
  v_mfma_f32_16x16x32_bf16 v[156:159], v[248:251], a[228:231], v[156:159]
  v_mfma_f32_16x16x32_bf16 v[124:127], v[250:253], a[232:235], v[124:127]
  v_mfma_f32_16x16x32_bf16 v[136:139], v[248:251], a[232:235], v[136:139]
  v_mfma_f32_16x16x32_bf16 v[148:151], v[250:253], a[236:239], v[148:151]
  v_mfma_f32_16x16x32_bf16 v[160:163], v[248:251], a[236:239], v[160:163]
  v_mfma_f32_16x16x32_bf16 v[128:131], v[250:253], a[240:243], v[128:131]
  v_mfma_f32_16x16x32_bf16 v[140:143], v[248:251], a[240:243], v[140:143]
  v_mfma_f32_16x16x32_bf16 v[152:155], v[250:253], a[244:247], v[152:155]
  v_mfma_f32_16x16x32_bf16 v[164:167], v[248:251], a[244:247], v[164:167]
  s_waitcnt vmcnt(0)
  v_mfma_f32_16x16x32_bf16 v[120:123], v[250:253], v[168:171], v[120:123]
  v_mfma_f32_16x16x32_bf16 v[132:135], v[248:251], v[168:171], v[132:135]
  v_mfma_f32_16x16x32_bf16 v[144:147], v[250:253], v[172:175], v[144:147]
  v_mfma_f32_16x16x32_bf16 v[156:159], v[248:251], v[172:175], v[156:159]
  v_mfma_f32_16x16x32_bf16 v[124:127], v[250:253], v[176:179], v[124:127]
  v_mfma_f32_16x16x32_bf16 v[136:139], v[248:251], v[176:179], v[136:139]
  v_mfma_f32_16x16x32_bf16 v[148:151], v[250:253], v[180:183], v[148:151]
  v_mfma_f32_16x16x32_bf16 v[160:163], v[248:251], v[180:183], v[160:163]
  v_mfma_f32_16x16x32_bf16 v[128:131], v[250:253], v[184:187], v[128:131]
  v_mfma_f32_16x16x32_bf16 v[140:143], v[248:251], v[184:187], v[140:143]
  v_mfma_f32_16x16x32_bf16 v[152:155], v[250:253], v[188:191], v[152:155]
  v_mfma_f32_16x16x32_bf16 v[164:167], v[248:251], v[188:191], v[164:167]
  s_cmp_lg_u32 s34, 0
  s_cbranch_scc1 L_dl0
  buffer_load_dwordx2 v[20:21], v222, s[76:79], 0 offen offset:0 sc1
  buffer_load_dwordx2 v[22:23], v222, s[76:79], 0 offen offset:128 sc1
  buffer_load_dwordx2 v[24:25], v222, s[76:79], 0 offen offset:256 sc1
  buffer_load_dwordx2 v[26:27], v222, s[76:79], 0 offen offset:384 sc1
  buffer_load_dwordx2 v[28:29], v222, s[76:79], 0 offen offset:512 sc1
  buffer_load_dwordx2 v[30:31], v222, s[76:79], 0 offen offset:640 sc1
  buffer_load_dwordx2 v[32:33], v222, s[76:79], 0 offen offset:768 sc1
L_dl0:
  s_cmp_lg_u32 s87, 0
  s_cbranch_scc1 L_verdict
L_final:
  s_nop 7
  v_add_f32 v120, v120, v48
  v_add_f32 v121, v121, v49
  v_add_f32 v122, v122, v50
  v_add_f32 v123, v123, v51
  v_add_f32 v132, v132, v60
  v_add_f32 v133, v133, v61
  v_add_f32 v134, v134, v62
  v_add_f32 v135, v135, v63
  v_cvt_pk_bf16_f32 v96, v120, v121
  v_cvt_pk_bf16_f32 v97, v122, v123
  v_cvt_pk_bf16_f32 v98, v132, v133
  v_cvt_pk_bf16_f32 v99, v134, v135
  v_add_f32 v144, v144, v72
  v_add_f32 v145, v145, v73
  v_add_f32 v146, v146, v74
  v_add_f32 v147, v147, v75
  v_permlane32_swap_b32 v96, v98
  v_permlane32_swap_b32 v97, v99
  v_add_f32 v156, v156, v84
  v_add_f32 v157, v157, v85
  v_add_f32 v158, v158, v86
  v_add_f32 v159, v159, v87
  v_cvt_pk_bf16_f32 v100, v144, v145
  v_cvt_pk_bf16_f32 v101, v146, v147
  v_cvt_pk_bf16_f32 v102, v156, v157
  v_cvt_pk_bf16_f32 v103, v158, v159
  v_permlane16_swap_b32 v96, v98
  v_permlane16_swap_b32 v97, v99
  s_nop 0
  buffer_store_dwordx4 v[96:99], v231, s[68:71], s58 offen offset:0
  v_add_f32 v124, v124, v52
  v_add_f32 v125, v125, v53
  v_add_f32 v126, v126, v54
  v_add_f32 v127, v127, v55
  v_permlane32_swap_b32 v100, v102
  v_permlane32_swap_b32 v101, v103
  v_add_f32 v136, v136, v64
  v_add_f32 v137, v137, v65
  v_add_f32 v138, v138, v66
  v_add_f32 v139, v139, v67
  v_cvt_pk_bf16_f32 v104, v124, v125
  v_cvt_pk_bf16_f32 v105, v126, v127
  v_cvt_pk_bf16_f32 v106, v136, v137
  v_cvt_pk_bf16_f32 v107, v138, v139
  v_permlane16_swap_b32 v100, v102
  v_permlane16_swap_b32 v101, v103
  s_nop 0
  buffer_store_dwordx4 v[100:103], v231, s[68:71], s58 offen offset:64
  v_add_f32 v148, v148, v76
  v_add_f32 v149, v149, v77
  v_add_f32 v150, v150, v78
  v_add_f32 v151, v151, v79
  v_permlane32_swap_b32 v104, v106
  v_permlane32_swap_b32 v105, v107
  v_add_f32 v160, v160, v88
  v_add_f32 v161, v161, v89
  v_add_f32 v162, v162, v90
  v_add_f32 v163, v163, v91
  v_cvt_pk_bf16_f32 v108, v148, v149
  v_cvt_pk_bf16_f32 v109, v150, v151
  v_cvt_pk_bf16_f32 v110, v160, v161
  v_cvt_pk_bf16_f32 v111, v162, v163
  v_permlane16_swap_b32 v104, v106
  v_permlane16_swap_b32 v105, v107
  s_nop 0
  buffer_store_dwordx4 v[104:107], v231, s[68:71], s37 offen offset:0
  v_add_f32 v128, v128, v56
  v_add_f32 v129, v129, v57
  v_add_f32 v130, v130, v58
  v_add_f32 v131, v131, v59
  v_permlane32_swap_b32 v108, v110
  v_permlane32_swap_b32 v109, v111
  v_add_f32 v140, v140, v68
  v_add_f32 v141, v141, v69
  v_add_f32 v142, v142, v70
  v_add_f32 v143, v143, v71
  v_cvt_pk_bf16_f32 v112, v128, v129
  v_cvt_pk_bf16_f32 v113, v130, v131
  v_cvt_pk_bf16_f32 v114, v140, v141
  v_cvt_pk_bf16_f32 v115, v142, v143
  v_permlane16_swap_b32 v108, v110
  v_permlane16_swap_b32 v109, v111
  s_nop 0
  buffer_store_dwordx4 v[108:111], v231, s[68:71], s37 offen offset:64
  v_add_f32 v152, v152, v80
  v_add_f32 v153, v153, v81
  v_add_f32 v154, v154, v82
  v_add_f32 v155, v155, v83
  v_permlane32_swap_b32 v112, v114
  v_permlane32_swap_b32 v113, v115
  v_add_f32 v164, v164, v92
  v_add_f32 v165, v165, v93
  v_add_f32 v166, v166, v94
  v_add_f32 v167, v167, v95
  v_cvt_pk_bf16_f32 v116, v152, v153
  v_cvt_pk_bf16_f32 v117, v154, v155
  v_cvt_pk_bf16_f32 v118, v164, v165
  v_cvt_pk_bf16_f32 v119, v166, v167
  v_permlane16_swap_b32 v112, v114
  v_permlane16_swap_b32 v113, v115
  s_nop 0
  buffer_store_dwordx4 v[112:115], v231, s[68:71], s38 offen offset:0
  v_permlane32_swap_b32 v116, v118
  v_permlane32_swap_b32 v117, v119
  s_nop 0
  v_permlane16_swap_b32 v116, v118
  v_permlane16_swap_b32 v117, v119
  s_nop 0
  buffer_store_dwordx4 v[116:119], v231, s[68:71], s38 offen offset:64
  s_cmp_lg_u32 s59, 0
  s_cbranch_scc1 L_duty
  s_mov_b32 s59, 1
L_verdict:
  s_mov_b32 s75, 4096
  s_cmp_lg_u32 s34, 0
  s_cbranch_scc1 L_vjoin
  s_cmp_lg_u32 s59, 0
  s_cbranch_scc1 L_sok
L_spin:
  buffer_load_dwordx2 v[224:225], v222, s[76:79], s58 offen offset:0 sc1
  s_waitcnt vmcnt(0)
  v_cmp_eq_u64 vcc, s[72:73], v[224:225]
  s_nop 0
  s_and_b32 s36, vcc_lo, 0xff
  s_and_b32 s36, s36, 127
  s_cmp_eq_u32 s36, 127
  s_cbranch_scc1 L_sok
  s_sub_u32 s75, s75, 1
  s_cmp_lg_u32 s75, 0
  s_cbranch_scc1 L_spin
L_sok:
  v_mov_b32 v241, s75
  ds_write_b32 v240, v241
  s_waitcnt lgkmcnt(0)
L_vjoin:
  s_barrier
  ds_read_b32 v241, v240 offset:0
  s_waitcnt lgkmcnt(0)
  v_readfirstlane_b32 s36, v241
  s_nop 0
  s_cmp_eq_u32 s36, 0
  s_cbranch_scc1 L_pub
  s_cmp_lg_u32 s59, 0
  s_cbranch_scc1 L_duty
  s_bitcmp1_b32 s87, 6
  s_cselect_b32 s66, 1376256, 0
  buffer_load_dwordx4 v[168:171], v233, s[64:67], s86 offen offset:0 sc1
  buffer_load_dwordx4 v[172:175], v233, s[64:67], s86 offen offset:1024 sc1
  buffer_load_dwordx4 v[176:179], v233, s[64:67], s86 offen offset:2048 sc1
  buffer_load_dwordx4 v[180:183], v233, s[64:67], s86 offen offset:3072 sc1
  buffer_load_dwordx4 v[184:187], v238, s[64:67], s86 offen offset:0 sc1
  buffer_load_dwordx4 v[188:191], v238, s[64:67], s86 offen offset:1024 sc1
  s_bitcmp1_b32 s87, 5
  s_cselect_b32 s66, 1376256, 0
  buffer_load_dwordx4 v[192:195], v233, s[64:67], s85 offen offset:0 sc1
  buffer_load_dwordx4 v[196:199], v233, s[64:67], s85 offen offset:1024 sc1
  buffer_load_dwordx4 v[200:203], v233, s[64:67], s85 offen offset:2048 sc1
  buffer_load_dwordx4 v[204:207], v233, s[64:67], s85 offen offset:3072 sc1
  buffer_load_dwordx4 v[208:211], v238, s[64:67], s85 offen offset:0 sc1
  buffer_load_dwordx4 v[212:215], v238, s[64:67], s85 offen offset:1024 sc1
  s_waitcnt vmcnt(6)
  v_mfma_f32_16x16x32_bf16 v[120:123], v[250:253], v[168:171], v[120:123]
  v_mfma_f32_16x16x32_bf16 v[132:135], v[248:251], v[168:171], v[132:135]
  v_mfma_f32_16x16x32_bf16 v[144:147], v[250:253], v[172:175], v[144:147]
  v_mfma_f32_16x16x32_bf16 v[156:159], v[248:251], v[172:175], v[156:159]
  v_mfma_f32_16x16x32_bf16 v[124:127], v[250:253], v[176:179], v[124:127]
  v_mfma_f32_16x16x32_bf16 v[136:139], v[248:251], v[176:179], v[136:139]
  v_mfma_f32_16x16x32_bf16 v[148:151], v[250:253], v[180:183], v[148:151]
  v_mfma_f32_16x16x32_bf16 v[160:163], v[248:251], v[180:183], v[160:163]
  v_mfma_f32_16x16x32_bf16 v[128:131], v[250:253], v[184:187], v[128:131]
  v_mfma_f32_16x16x32_bf16 v[140:143], v[248:251], v[184:187], v[140:143]
  v_mfma_f32_16x16x32_bf16 v[152:155], v[250:253], v[188:191], v[152:155]
  v_mfma_f32_16x16x32_bf16 v[164:167], v[248:251], v[188:191], v[164:167]
  s_waitcnt vmcnt(0)
  v_mfma_f32_16x16x32_bf16 v[120:123], v[250:253], v[192:195], v[120:123]
  v_mfma_f32_16x16x32_bf16 v[132:135], v[248:251], v[192:195], v[132:135]
  v_mfma_f32_16x16x32_bf16 v[144:147], v[250:253], v[196:199], v[144:147]
  v_mfma_f32_16x16x32_bf16 v[156:159], v[248:251], v[196:199], v[156:159]
  v_mfma_f32_16x16x32_bf16 v[124:127], v[250:253], v[200:203], v[124:127]
  v_mfma_f32_16x16x32_bf16 v[136:139], v[248:251], v[200:203], v[136:139]
  v_mfma_f32_16x16x32_bf16 v[148:151], v[250:253], v[204:207], v[148:151]
  v_mfma_f32_16x16x32_bf16 v[160:163], v[248:251], v[204:207], v[160:163]
  v_mfma_f32_16x16x32_bf16 v[128:131], v[250:253], v[208:211], v[128:131]
  v_mfma_f32_16x16x32_bf16 v[140:143], v[248:251], v[208:211], v[140:143]
  v_mfma_f32_16x16x32_bf16 v[152:155], v[250:253], v[212:215], v[152:155]
  v_mfma_f32_16x16x32_bf16 v[164:167], v[248:251], v[212:215], v[164:167]
  s_mov_b32 s59, 1
  s_and_b32 s36, s87, 31
  s_cmp_eq_u32 s36, 0
  s_cbranch_scc1 L_final
  s_bitcmp1_b32 s87, 0
  s_cselect_b32 s66, 1376256, 0
  s_nop 7
  buffer_load_dwordx4 v[168:171], v233, s[64:67], s80 offen offset:0 sc1
  buffer_load_dwordx4 v[172:175], v233, s[64:67], s80 offen offset:1024 sc1
  buffer_load_dwordx4 v[176:179], v233, s[64:67], s80 offen offset:2048 sc1
  buffer_load_dwordx4 v[180:183], v233, s[64:67], s80 offen offset:3072 sc1
  buffer_load_dwordx4 v[184:187], v238, s[64:67], s80 offen offset:0 sc1
  buffer_load_dwordx4 v[188:191], v238, s[64:67], s80 offen offset:1024 sc1
  s_waitcnt vmcnt(0)
  v_mfma_f32_16x16x32_bf16 v[120:123], v[250:253], v[168:171], v[120:123]
  v_mfma_f32_16x16x32_bf16 v[132:135], v[248:251], v[168:171], v[132:135]
  v_mfma_f32_16x16x32_bf16 v[144:147], v[250:253], v[172:175], v[144:147]
  v_mfma_f32_16x16x32_bf16 v[156:159], v[248:251], v[172:175], v[156:159]
  v_mfma_f32_16x16x32_bf16 v[124:127], v[250:253], v[176:179], v[124:127]
  v_mfma_f32_16x16x32_bf16 v[136:139], v[248:251], v[176:179], v[136:139]
  v_mfma_f32_16x16x32_bf16 v[148:151], v[250:253], v[180:183], v[148:151]
  v_mfma_f32_16x16x32_bf16 v[160:163], v[248:251], v[180:183], v[160:163]
  v_mfma_f32_16x16x32_bf16 v[128:131], v[250:253], v[184:187], v[128:131]
  v_mfma_f32_16x16x32_bf16 v[140:143], v[248:251], v[184:187], v[140:143]
  v_mfma_f32_16x16x32_bf16 v[152:155], v[250:253], v[188:191], v[152:155]
  v_mfma_f32_16x16x32_bf16 v[164:167], v[248:251], v[188:191], v[164:167]
  s_bitcmp1_b32 s87, 1
  s_cselect_b32 s66, 1376256, 0
  s_nop 7
  buffer_load_dwordx4 v[168:171], v233, s[64:67], s81 offen offset:0 sc1
  buffer_load_dwordx4 v[172:175], v233, s[64:67], s81 offen offset:1024 sc1
  buffer_load_dwordx4 v[176:179], v233, s[64:67], s81 offen offset:2048 sc1
  buffer_load_dwordx4 v[180:183], v233, s[64:67], s81 offen offset:3072 sc1
  buffer_load_dwordx4 v[184:187], v238, s[64:67], s81 offen offset:0 sc1
  buffer_load_dwordx4 v[188:191], v238, s[64:67], s81 offen offset:1024 sc1
  s_waitcnt vmcnt(0)
  v_mfma_f32_16x16x32_bf16 v[120:123], v[250:253], v[168:171], v[120:123]
  v_mfma_f32_16x16x32_bf16 v[132:135], v[248:251], v[168:171], v[132:135]
  v_mfma_f32_16x16x32_bf16 v[144:147], v[250:253], v[172:175], v[144:147]
  v_mfma_f32_16x16x32_bf16 v[156:159], v[248:251], v[172:175], v[156:159]
  v_mfma_f32_16x16x32_bf16 v[124:127], v[250:253], v[176:179], v[124:127]
  v_mfma_f32_16x16x32_bf16 v[136:139], v[248:251], v[176:179], v[136:139]
  v_mfma_f32_16x16x32_bf16 v[148:151], v[250:253], v[180:183], v[148:151]
  v_mfma_f32_16x16x32_bf16 v[160:163], v[248:251], v[180:183], v[160:163]
  v_mfma_f32_16x16x32_bf16 v[128:131], v[250:253], v[184:187], v[128:131]
  v_mfma_f32_16x16x32_bf16 v[140:143], v[248:251], v[184:187], v[140:143]
  v_mfma_f32_16x16x32_bf16 v[152:155], v[250:253], v[188:191], v[152:155]
  v_mfma_f32_16x16x32_bf16 v[164:167], v[248:251], v[188:191], v[164:167]
  s_bitcmp1_b32 s87, 2
  s_cselect_b32 s66, 1376256, 0
  s_nop 7
  buffer_load_dwordx4 v[168:171], v233, s[64:67], s82 offen offset:0 sc1
  buffer_load_dwordx4 v[172:175], v233, s[64:67], s82 offen offset:1024 sc1
  buffer_load_dwordx4 v[176:179], v233, s[64:67], s82 offen offset:2048 sc1
  buffer_load_dwordx4 v[180:183], v233, s[64:67], s82 offen offset:3072 sc1
  buffer_load_dwordx4 v[184:187], v238, s[64:67], s82 offen offset:0 sc1
  buffer_load_dwordx4 v[188:191], v238, s[64:67], s82 offen offset:1024 sc1
  s_waitcnt vmcnt(0)
  v_mfma_f32_16x16x32_bf16 v[120:123], v[250:253], v[168:171], v[120:123]
  v_mfma_f32_16x16x32_bf16 v[132:135], v[248:251], v[168:171], v[132:135]
  v_mfma_f32_16x16x32_bf16 v[144:147], v[250:253], v[172:175], v[144:147]
  v_mfma_f32_16x16x32_bf16 v[156:159], v[248:251], v[172:175], v[156:159]
  v_mfma_f32_16x16x32_bf16 v[124:127], v[250:253], v[176:179], v[124:127]
  v_mfma_f32_16x16x32_bf16 v[136:139], v[248:251], v[176:179], v[136:139]
  v_mfma_f32_16x16x32_bf16 v[148:151], v[250:253], v[180:183], v[148:151]
  v_mfma_f32_16x16x32_bf16 v[160:163], v[248:251], v[180:183], v[160:163]
  v_mfma_f32_16x16x32_bf16 v[128:131], v[250:253], v[184:187], v[128:131]
  v_mfma_f32_16x16x32_bf16 v[140:143], v[248:251], v[184:187], v[140:143]
  v_mfma_f32_16x16x32_bf16 v[152:155], v[250:253], v[188:191], v[152:155]
  v_mfma_f32_16x16x32_bf16 v[164:167], v[248:251], v[188:191], v[164:167]
  s_bitcmp1_b32 s87, 3
  s_cselect_b32 s66, 1376256, 0
  s_nop 7
  buffer_load_dwordx4 v[168:171], v233, s[64:67], s83 offen offset:0 sc1
  buffer_load_dwordx4 v[172:175], v233, s[64:67], s83 offen offset:1024 sc1
  buffer_load_dwordx4 v[176:179], v233, s[64:67], s83 offen offset:2048 sc1
  buffer_load_dwordx4 v[180:183], v233, s[64:67], s83 offen offset:3072 sc1
  buffer_load_dwordx4 v[184:187], v238, s[64:67], s83 offen offset:0 sc1
  buffer_load_dwordx4 v[188:191], v238, s[64:67], s83 offen offset:1024 sc1
  s_waitcnt vmcnt(0)
  v_mfma_f32_16x16x32_bf16 v[120:123], v[250:253], v[168:171], v[120:123]
  v_mfma_f32_16x16x32_bf16 v[132:135], v[248:251], v[168:171], v[132:135]
  v_mfma_f32_16x16x32_bf16 v[144:147], v[250:253], v[172:175], v[144:147]
  v_mfma_f32_16x16x32_bf16 v[156:159], v[248:251], v[172:175], v[156:159]
  v_mfma_f32_16x16x32_bf16 v[124:127], v[250:253], v[176:179], v[124:127]
  v_mfma_f32_16x16x32_bf16 v[136:139], v[248:251], v[176:179], v[136:139]
  v_mfma_f32_16x16x32_bf16 v[148:151], v[250:253], v[180:183], v[148:151]
  v_mfma_f32_16x16x32_bf16 v[160:163], v[248:251], v[180:183], v[160:163]
  v_mfma_f32_16x16x32_bf16 v[128:131], v[250:253], v[184:187], v[128:131]
  v_mfma_f32_16x16x32_bf16 v[140:143], v[248:251], v[184:187], v[140:143]
  v_mfma_f32_16x16x32_bf16 v[152:155], v[250:253], v[188:191], v[152:155]
  v_mfma_f32_16x16x32_bf16 v[164:167], v[248:251], v[188:191], v[164:167]
  s_bitcmp1_b32 s87, 4
  s_cselect_b32 s66, 1376256, 0
  s_nop 7
  buffer_load_dwordx4 v[168:171], v233, s[64:67], s84 offen offset:0 sc1
  buffer_load_dwordx4 v[172:175], v233, s[64:67], s84 offen offset:1024 sc1
  buffer_load_dwordx4 v[176:179], v233, s[64:67], s84 offen offset:2048 sc1
  buffer_load_dwordx4 v[180:183], v233, s[64:67], s84 offen offset:3072 sc1
  buffer_load_dwordx4 v[184:187], v238, s[64:67], s84 offen offset:0 sc1
  buffer_load_dwordx4 v[188:191], v238, s[64:67], s84 offen offset:1024 sc1
  s_waitcnt vmcnt(0)
  v_mfma_f32_16x16x32_bf16 v[120:123], v[250:253], v[168:171], v[120:123]
  v_mfma_f32_16x16x32_bf16 v[132:135], v[248:251], v[168:171], v[132:135]
  v_mfma_f32_16x16x32_bf16 v[144:147], v[250:253], v[172:175], v[144:147]
  v_mfma_f32_16x16x32_bf16 v[156:159], v[248:251], v[172:175], v[156:159]
  v_mfma_f32_16x16x32_bf16 v[124:127], v[250:253], v[176:179], v[124:127]
  v_mfma_f32_16x16x32_bf16 v[136:139], v[248:251], v[176:179], v[136:139]
  v_mfma_f32_16x16x32_bf16 v[148:151], v[250:253], v[180:183], v[148:151]
  v_mfma_f32_16x16x32_bf16 v[160:163], v[248:251], v[180:183], v[160:163]
  v_mfma_f32_16x16x32_bf16 v[128:131], v[250:253], v[184:187], v[128:131]
  v_mfma_f32_16x16x32_bf16 v[140:143], v[248:251], v[184:187], v[140:143]
  v_mfma_f32_16x16x32_bf16 v[152:155], v[250:253], v[188:191], v[152:155]
  v_mfma_f32_16x16x32_bf16 v[164:167], v[248:251], v[188:191], v[164:167]
  s_branch L_final
L_pub:
  s_waitcnt vmcnt(6)
  s_nop 7
  s_mul_i32 s50, s58, 192
  s_add_u32 s51, s50, 4096
  v_cvt_pk_bf16_f32 v96, v48, v49
  v_cvt_pk_bf16_f32 v97, v50, v51
  v_cvt_pk_bf16_f32 v98, v60, v61
  v_cvt_pk_bf16_f32 v99, v62, v63
  buffer_store_dwordx4 v[96:99], v233, s[20:23], s50 offen offset:0 sc1
  v_cvt_pk_bf16_f32 v100, v72, v73
  v_cvt_pk_bf16_f32 v101, v74, v75
  v_cvt_pk_bf16_f32 v102, v84, v85
  v_cvt_pk_bf16_f32 v103, v86, v87
  buffer_store_dwordx4 v[100:103], v233, s[20:23], s50 offen offset:1024 sc1
  v_cvt_pk_bf16_f32 v104, v52, v53
  v_cvt_pk_bf16_f32 v105, v54, v55
  v_cvt_pk_bf16_f32 v106, v64, v65
  v_cvt_pk_bf16_f32 v107, v66, v67
  buffer_store_dwordx4 v[104:107], v233, s[20:23], s50 offen offset:2048 sc1
  v_cvt_pk_bf16_f32 v108, v76, v77
  v_cvt_pk_bf16_f32 v109, v78, v79
  v_cvt_pk_bf16_f32 v110, v88, v89
  v_cvt_pk_bf16_f32 v111, v90, v91
  buffer_store_dwordx4 v[108:111], v233, s[20:23], s50 offen offset:3072 sc1
  v_cvt_pk_bf16_f32 v112, v56, v57
  v_cvt_pk_bf16_f32 v113, v58, v59
  v_cvt_pk_bf16_f32 v114, v68, v69
  v_cvt_pk_bf16_f32 v115, v70, v71
  buffer_store_dwordx4 v[112:115], v233, s[20:23], s51 offen offset:0 sc1
  v_cvt_pk_bf16_f32 v116, v80, v81
  v_cvt_pk_bf16_f32 v117, v82, v83
  v_cvt_pk_bf16_f32 v118, v92, v93
  v_cvt_pk_bf16_f32 v119, v94, v95
  buffer_store_dwordx4 v[116:119], v233, s[20:23], s51 offen offset:1024 sc1
  s_waitcnt vmcnt(0)
  s_barrier
  buffer_store_dwordx2 v[226:227], v246, s[76:79], s58 offen offset:0 sc1
  s_waitcnt vmcnt(0)
  s_cmp_lg_u32 s34, 0
  s_cbranch_scc1 L_dl1
  buffer_load_dwordx2 v[20:21], v222, s[76:79], 0 offen offset:0 sc1
  buffer_load_dwordx2 v[22:23], v222, s[76:79], 0 offen offset:128 sc1
  buffer_load_dwordx2 v[24:25], v222, s[76:79], 0 offen offset:256 sc1
  buffer_load_dwordx2 v[26:27], v222, s[76:79], 0 offen offset:384 sc1
  buffer_load_dwordx2 v[28:29], v222, s[76:79], 0 offen offset:512 sc1
  buffer_load_dwordx2 v[30:31], v222, s[76:79], 0 offen offset:640 sc1
  buffer_load_dwordx2 v[32:33], v222, s[76:79], 0 offen offset:768 sc1
L_dl1:
  s_waitcnt vmcnt(0)
L_duty:
  s_cmp_lg_u32 s34, 0
  s_cbranch_scc1 L_fin
  s_waitcnt vmcnt(6)
  s_mov_b32 s75, 0
  v_cmp_eq_u64 vcc, s[72:73], v[20:21]
  s_nop 0
  s_and_b32 s36, vcc_lo, 0xff
  s_cmp_eq_u32 s36, 255
  s_cselect_b32 s36, 1, 0
  s_or_b32 s75, s75, s36
  v_cmp_eq_u64 vcc, s[72:73], v[22:23]
  s_nop 0
  s_and_b32 s36, vcc_lo, 0xff
  s_cmp_eq_u32 s36, 255
  s_cselect_b32 s36, 2, 0
  s_or_b32 s75, s75, s36
  v_cmp_eq_u64 vcc, s[72:73], v[24:25]
  s_nop 0
  s_and_b32 s36, vcc_lo, 0xff
  s_cmp_eq_u32 s36, 255
  s_cselect_b32 s36, 4, 0
  s_or_b32 s75, s75, s36
  v_cmp_eq_u64 vcc, s[72:73], v[26:27]
  s_nop 0
  s_and_b32 s36, vcc_lo, 0xff
  s_cmp_eq_u32 s36, 255
  s_cselect_b32 s36, 8, 0
  s_or_b32 s75, s75, s36
  v_cmp_eq_u64 vcc, s[72:73], v[28:29]
  s_nop 0
  s_and_b32 s36, vcc_lo, 0xff
  s_cmp_eq_u32 s36, 255
  s_cselect_b32 s36, 16, 0
  s_or_b32 s75, s75, s36
  v_cmp_eq_u64 vcc, s[72:73], v[30:31]
  s_nop 0
  s_and_b32 s36, vcc_lo, 0xff
  s_cmp_eq_u32 s36, 255
  s_cselect_b32 s36, 32, 0
  s_or_b32 s75, s75, s36
  v_cmp_eq_u64 vcc, s[72:73], v[32:33]
  s_nop 0
  s_and_b32 s36, vcc_lo, 0xff
  s_cmp_eq_u32 s36, 255
  s_cselect_b32 s36, 64, 0
  s_or_b32 s75, s75, s36
  s_mov_b32 s66, 1376256
L_dloop:
  s_cmp_eq_u32 s75, 0
  s_cbranch_scc1 L_fin
  s_ff1_i32_b32 s36, s75
  s_bitset0_b32 s75, s36
  s_mul_i32 s42, s36, 24576
  s_lshl_b32 s43, s36, 7
  s_mov_b32 s39, 0
  s_mov_b32 s74, 0xffff0000
  v_mbcnt_lo_u32_b32 v0, -1, 0
  v_mbcnt_hi_u32_b32 v0, -1, v0
  v_and_b32 v2, 15, v0
  v_mul_u32_u24 v1, 896, v2
  v_lshrrev_b32 v2, 4, v0
  v_lshl_add_u32 v1, v2, 4, v1
  v_lshlrev_b32 v0, 4, v0
L_dchunk:
  s_add_u32 s36, s42, 0
  buffer_load_dwordx4 v[8:11], v0, s[64:67], s36 offen offset:0 sc1
  s_add_u32 s36, s42, 172032
  buffer_load_dwordx4 v[12:15], v0, s[64:67], s36 offen offset:0 sc1
  s_add_u32 s36, s42, 344064
  buffer_load_dwordx4 v[16:19], v0, s[64:67], s36 offen offset:0 sc1
  s_add_u32 s36, s42, 516096
  buffer_load_dwordx4 v[20:23], v0, s[64:67], s36 offen offset:0 sc1
  s_add_u32 s36, s42, 688128
  buffer_load_dwordx4 v[24:27], v0, s[64:67], s36 offen offset:0 sc1
  s_add_u32 s36, s42, 860160
  buffer_load_dwordx4 v[28:31], v0, s[64:67], s36 offen offset:0 sc1
  s_add_u32 s36, s42, 1032192
  buffer_load_dwordx4 v[32:35], v0, s[64:67], s36 offen offset:0 sc1
  s_add_u32 s36, s42, 1204224
  buffer_load_dwordx4 v[36:39], v0, s[64:67], s36 offen offset:0 sc1
  s_andn2_b32 s37, s39, 1
  s_mul_i32 s37, s37, 7168
  s_and_b32 s38, s39, 1
  s_lshl_b32 s38, s38, 6
  s_add_u32 s37, s37, s38
  s_add_u32 s37, s37, s43
  s_waitcnt vmcnt(0)
  v_lshlrev_b32 v40, 16, v8
  v_and_b32 v41, s74, v8
  v_lshlrev_b32 v42, 16, v9
  v_and_b32 v43, s74, v9
  v_lshlrev_b32 v44, 16, v10
  v_and_b32 v45, s74, v10
  v_lshlrev_b32 v46, 16, v11
  v_and_b32 v47, s74, v11
  v_lshlrev_b32 v48, 16, v12
  v_and_b32 v49, s74, v12
  v_add_f32 v40, v40, v48
  v_add_f32 v41, v41, v49
  v_lshlrev_b32 v48, 16, v13
  v_and_b32 v49, s74, v13
  v_add_f32 v42, v42, v48
  v_add_f32 v43, v43, v49
  v_lshlrev_b32 v48, 16, v14
  v_and_b32 v49, s74, v14
  v_add_f32 v44, v44, v48
  v_add_f32 v45, v45, v49
  v_lshlrev_b32 v48, 16, v15
  v_and_b32 v49, s74, v15
  v_add_f32 v46, v46, v48
  v_add_f32 v47, v47, v49
  v_lshlrev_b32 v48, 16, v16
  v_and_b32 v49, s74, v16
  v_add_f32 v40, v40, v48
  v_add_f32 v41, v41, v49
  v_lshlrev_b32 v48, 16, v17
  v_and_b32 v49, s74, v17
  v_add_f32 v42, v42, v48
  v_add_f32 v43, v43, v49
  v_lshlrev_b32 v48, 16, v18
  v_and_b32 v49, s74, v18
  v_add_f32 v44, v44, v48
  v_add_f32 v45, v45, v49
  v_lshlrev_b32 v48, 16, v19
  v_and_b32 v49, s74, v19
  v_add_f32 v46, v46, v48
  v_add_f32 v47, v47, v49
  v_lshlrev_b32 v48, 16, v20
  v_and_b32 v49, s74, v20
  v_add_f32 v40, v40, v48
  v_add_f32 v41, v41, v49
  v_lshlrev_b32 v48, 16, v21
  v_and_b32 v49, s74, v21
  v_add_f32 v42, v42, v48
  v_add_f32 v43, v43, v49
  v_lshlrev_b32 v48, 16, v22
  v_and_b32 v49, s74, v22
  v_add_f32 v44, v44, v48
  v_add_f32 v45, v45, v49
  v_lshlrev_b32 v48, 16, v23
  v_and_b32 v49, s74, v23
  v_add_f32 v46, v46, v48
  v_add_f32 v47, v47, v49
  v_lshlrev_b32 v48, 16, v24
  v_and_b32 v49, s74, v24
  v_add_f32 v40, v40, v48
  v_add_f32 v41, v41, v49
  v_lshlrev_b32 v48, 16, v25
  v_and_b32 v49, s74, v25
  v_add_f32 v42, v42, v48
  v_add_f32 v43, v43, v49
  v_lshlrev_b32 v48, 16, v26
  v_and_b32 v49, s74, v26
  v_add_f32 v44, v44, v48
  v_add_f32 v45, v45, v49
  v_lshlrev_b32 v48, 16, v27
  v_and_b32 v49, s74, v27
  v_add_f32 v46, v46, v48
  v_add_f32 v47, v47, v49
  v_lshlrev_b32 v48, 16, v28
  v_and_b32 v49, s74, v28
  v_add_f32 v40, v40, v48
  v_add_f32 v41, v41, v49
  v_lshlrev_b32 v48, 16, v29
  v_and_b32 v49, s74, v29
  v_add_f32 v42, v42, v48
  v_add_f32 v43, v43, v49
  v_lshlrev_b32 v48, 16, v30
  v_and_b32 v49, s74, v30
  v_add_f32 v44, v44, v48
  v_add_f32 v45, v45, v49
  v_lshlrev_b32 v48, 16, v31
  v_and_b32 v49, s74, v31
  v_add_f32 v46, v46, v48
  v_add_f32 v47, v47, v49
  v_lshlrev_b32 v48, 16, v32
  v_and_b32 v49, s74, v32
  v_add_f32 v40, v40, v48
  v_add_f32 v41, v41, v49
  v_lshlrev_b32 v48, 16, v33
  v_and_b32 v49, s74, v33
  v_add_f32 v42, v42, v48
  v_add_f32 v43, v43, v49
  v_lshlrev_b32 v48, 16, v34
  v_and_b32 v49, s74, v34
  v_add_f32 v44, v44, v48
  v_add_f32 v45, v45, v49
  v_lshlrev_b32 v48, 16, v35
  v_and_b32 v49, s74, v35
  v_add_f32 v46, v46, v48
  v_add_f32 v47, v47, v49
  v_lshlrev_b32 v48, 16, v36
  v_and_b32 v49, s74, v36
  v_add_f32 v40, v40, v48
  v_add_f32 v41, v41, v49
  v_lshlrev_b32 v48, 16, v37
  v_and_b32 v49, s74, v37
  v_add_f32 v42, v42, v48
  v_add_f32 v43, v43, v49
  v_lshlrev_b32 v48, 16, v38
  v_and_b32 v49, s74, v38
  v_add_f32 v44, v44, v48
  v_add_f32 v45, v45, v49
  v_lshlrev_b32 v48, 16, v39
  v_and_b32 v49, s74, v39
  v_add_f32 v46, v46, v48
  v_add_f32 v47, v47, v49
  v_cvt_pk_bf16_f32 v52, v40, v41
  v_cvt_pk_bf16_f32 v53, v42, v43
  v_cvt_pk_bf16_f32 v54, v44, v45
  v_cvt_pk_bf16_f32 v55, v46, v47
  s_nop 0
  v_permlane32_swap_b32 v52, v54
  v_permlane32_swap_b32 v53, v55
  s_nop 0
  v_permlane16_swap_b32 v52, v54
  v_permlane16_swap_b32 v53, v55
  s_nop 1
  buffer_store_dwordx4 v[52:55], v1, s[68:71], s37 offen offset:0
  s_add_u32 s42, s42, 1024
  s_add_u32 s39, s39, 1
  s_cmp_lt_u32 s39, 24
  s_nop 3
  s_cbranch_scc1 L_dchunk
  s_branch L_dloop
L_fin:
L_end:
  s_endpgm
L_code_end:
L_slow:
  s_waitcnt vmcnt(0)
  s_waitcnt lgkmcnt(0)
  v_mbcnt_lo_u32_b32 v240, -1, 0
  v_mbcnt_hi_u32_b32 v240, -1, v240
  v_and_b32 v243, 15, v240
  v_lshlrev_b32 v241, 9, v243
  v_lshlrev_b32 v242, 1, v243
  v_lshrrev_b32 v243, 4, v240
  v_lshlrev_b32 v240, 4, v243
  v_add_u32 v241, v241, v240
  v_lshlrev_b32 v243, 11, v243
  v_add_u32 v242, v242, v243
  v_mov_b32 v168, 0xff800000
  v_mov_b32 v169, 0xff800000
  v_mov_b32 v170, 0xff800000
  s_add_u32 s42, s33, 3072
  s_mov_b32 s39, 0
L_slow1:
  s_add_u32 s43, s42, 8192
  buffer_load_dwordx4 a[192:195], v241, s[8:11], s42 offen offset:0
  buffer_load_dwordx4 a[196:199], v241, s[8:11], s42 offen offset:64
  buffer_load_dwordx4 a[200:203], v241, s[8:11], s42 offen offset:128
  buffer_load_dwordx4 a[204:207], v241, s[8:11], s42 offen offset:192
  buffer_load_dwordx4 a[208:211], v241, s[8:11], s42 offen offset:256
  buffer_load_dwordx4 a[212:215], v241, s[8:11], s42 offen offset:320
  buffer_load_dwordx4 a[216:219], v241, s[8:11], s42 offen offset:384
  buffer_load_dwordx4 a[220:223], v241, s[8:11], s42 offen offset:448
  s_waitcnt vmcnt(0)
  v_mfma_f32_16x16x32_bf16 v[192:195], a[192:195], a[0:3], 0
  v_mfma_f32_16x16x32_bf16 v[200:203], a[192:195], a[4:7], 0
  v_mfma_f32_16x16x32_bf16 v[208:211], a[192:195], a[8:11], 0
  v_mfma_f32_16x16x32_bf16 v[192:195], a[196:199], a[12:15], v[192:195]
  v_mfma_f32_16x16x32_bf16 v[200:203], a[196:199], a[16:19], v[200:203]
  v_mfma_f32_16x16x32_bf16 v[208:211], a[196:199], a[20:23], v[208:211]
  v_mfma_f32_16x16x32_bf16 v[192:195], a[200:203], a[24:27], v[192:195]
  v_mfma_f32_16x16x32_bf16 v[200:203], a[200:203], a[28:31], v[200:203]
  v_mfma_f32_16x16x32_bf16 v[208:211], a[200:203], a[32:35], v[208:211]
  v_mfma_f32_16x16x32_bf16 v[192:195], a[204:207], a[36:39], v[192:195]
  v_mfma_f32_16x16x32_bf16 v[200:203], a[204:207], a[40:43], v[200:203]
  v_mfma_f32_16x16x32_bf16 v[208:211], a[204:207], a[44:47], v[208:211]
  v_mfma_f32_16x16x32_bf16 v[192:195], a[208:211], a[48:51], v[192:195]
  v_mfma_f32_16x16x32_bf16 v[200:203], a[208:211], a[52:55], v[200:203]
  v_mfma_f32_16x16x32_bf16 v[208:211], a[208:211], a[56:59], v[208:211]
  v_mfma_f32_16x16x32_bf16 v[192:195], a[212:215], a[60:63], v[192:195]
  v_mfma_f32_16x16x32_bf16 v[200:203], a[212:215], a[64:67], v[200:203]
  v_mfma_f32_16x16x32_bf16 v[208:211], a[212:215], a[68:71], v[208:211]
  v_mfma_f32_16x16x32_bf16 v[192:195], a[216:219], a[72:75], v[192:195]
  v_mfma_f32_16x16x32_bf16 v[200:203], a[216:219], a[76:79], v[200:203]
  v_mfma_f32_16x16x32_bf16 v[208:211], a[216:219], a[80:83], v[208:211]
  v_mfma_f32_16x16x32_bf16 v[192:195], a[220:223], a[84:87], v[192:195]
  v_mfma_f32_16x16x32_bf16 v[200:203], a[220:223], a[88:91], v[200:203]
  v_mfma_f32_16x16x32_bf16 v[208:211], a[220:223], a[92:95], v[208:211]
  s_nop 7
  buffer_load_dwordx4 a[192:195], v241, s[8:11], s43 offen offset:0
  buffer_load_dwordx4 a[196:199], v241, s[8:11], s43 offen offset:64
  buffer_load_dwordx4 a[200:203], v241, s[8:11], s43 offen offset:128
  buffer_load_dwordx4 a[204:207], v241, s[8:11], s43 offen offset:192
  buffer_load_dwordx4 a[208:211], v241, s[8:11], s43 offen offset:256
  buffer_load_dwordx4 a[212:215], v241, s[8:11], s43 offen offset:320
  buffer_load_dwordx4 a[216:219], v241, s[8:11], s43 offen offset:384
  buffer_load_dwordx4 a[220:223], v241, s[8:11], s43 offen offset:448
  s_waitcnt vmcnt(0)
  v_mfma_f32_16x16x32_bf16 v[196:199], a[192:195], a[0:3], 0
  v_mfma_f32_16x16x32_bf16 v[204:207], a[192:195], a[4:7], 0
  v_mfma_f32_16x16x32_bf16 v[212:215], a[192:195], a[8:11], 0
  v_mfma_f32_16x16x32_bf16 v[196:199], a[196:199], a[12:15], v[196:199]
  v_mfma_f32_16x16x32_bf16 v[204:207], a[196:199], a[16:19], v[204:207]
  v_mfma_f32_16x16x32_bf16 v[212:215], a[196:199], a[20:23], v[212:215]
  v_mfma_f32_16x16x32_bf16 v[196:199], a[200:203], a[24:27], v[196:199]
  v_mfma_f32_16x16x32_bf16 v[204:207], a[200:203], a[28:31], v[204:207]
  v_mfma_f32_16x16x32_bf16 v[212:215], a[200:203], a[32:35], v[212:215]
  v_mfma_f32_16x16x32_bf16 v[196:199], a[204:207], a[36:39], v[196:199]
  v_mfma_f32_16x16x32_bf16 v[204:207], a[204:207], a[40:43], v[204:207]
  v_mfma_f32_16x16x32_bf16 v[212:215], a[204:207], a[44:47], v[212:215]
  v_mfma_f32_16x16x32_bf16 v[196:199], a[208:211], a[48:51], v[196:199]
  v_mfma_f32_16x16x32_bf16 v[204:207], a[208:211], a[52:55], v[204:207]
  v_mfma_f32_16x16x32_bf16 v[212:215], a[208:211], a[56:59], v[212:215]
  v_mfma_f32_16x16x32_bf16 v[196:199], a[212:215], a[60:63], v[196:199]
  v_mfma_f32_16x16x32_bf16 v[204:207], a[212:215], a[64:67], v[204:207]
  v_mfma_f32_16x16x32_bf16 v[212:215], a[212:215], a[68:71], v[212:215]
  v_mfma_f32_16x16x32_bf16 v[196:199], a[216:219], a[72:75], v[196:199]
  v_mfma_f32_16x16x32_bf16 v[204:207], a[216:219], a[76:79], v[204:207]
  v_mfma_f32_16x16x32_bf16 v[212:215], a[216:219], a[80:83], v[212:215]
  v_mfma_f32_16x16x32_bf16 v[196:199], a[220:223], a[84:87], v[196:199]
  v_mfma_f32_16x16x32_bf16 v[204:207], a[220:223], a[88:91], v[204:207]
  v_mfma_f32_16x16x32_bf16 v[212:215], a[220:223], a[92:95], v[212:215]
  s_nop 7
  s_nop 7
  v_max3_f32 v168, v168, v192, v193
  v_max3_f32 v168, v168, v194, v195
  v_max3_f32 v168, v168, v196, v197
  v_max3_f32 v168, v168, v198, v199
  v_max3_f32 v169, v169, v200, v201
  v_max3_f32 v169, v169, v202, v203
  v_max3_f32 v169, v169, v204, v205
  v_max3_f32 v169, v169, v206, v207
  v_max3_f32 v170, v170, v208, v209
  v_max3_f32 v170, v170, v210, v211
  v_max3_f32 v170, v170, v212, v213
  v_max3_f32 v170, v170, v214, v215
  s_add_u32 s42, s42, 16384
  s_add_u32 s39, s39, 1
  s_cmp_lt_u32 s39, 16
  s_nop 3
  s_cbranch_scc1 L_slow1
  v_mov_b32 v243, v168
  s_nop 1
  v_permlane32_swap_b32 v168, v243
  v_max_f32 v168, v168, v243
  v_mov_b32 v243, v168
  s_nop 1
  v_permlane16_swap_b32 v168, v243
  v_max_f32 v168, v168, v243
  v_sub_f32 v216, 0, v168
  v_sub_f32 v217, 0, v168
  v_sub_f32 v218, 0, v168
  v_sub_f32 v219, 0, v168
  v_mov_b32 v234, 0
  v_mov_b32 v243, v169
  s_nop 1
  v_permlane32_swap_b32 v169, v243
  v_max_f32 v169, v169, v243
  v_mov_b32 v243, v169
  s_nop 1
  v_permlane16_swap_b32 v169, v243
  v_max_f32 v169, v169, v243
  v_sub_f32 v220, 0, v169
  v_sub_f32 v221, 0, v169
  v_sub_f32 v222, 0, v169
  v_sub_f32 v223, 0, v169
  v_mov_b32 v235, 0
  v_mov_b32 v243, v170
  s_nop 1
  v_permlane32_swap_b32 v170, v243
  v_max_f32 v170, v170, v243
  v_mov_b32 v243, v170
  s_nop 1
  v_permlane16_swap_b32 v170, v243
  v_max_f32 v170, v170, v243
  v_sub_f32 v224, 0, v170
  v_sub_f32 v225, 0, v170
  v_sub_f32 v226, 0, v170
  v_sub_f32 v227, 0, v170
  v_mov_b32 v236, 0
  v_mov_b32 v0, 0
  v_mov_b32 v1, 0
  v_mov_b32 v2, 0
  v_mov_b32 v3, 0
  v_mov_b32 v4, 0
  v_mov_b32 v5, 0
  v_mov_b32 v6, 0
  v_mov_b32 v7, 0
  v_mov_b32 v8, 0
  v_mov_b32 v9, 0
  v_mov_b32 v10, 0
  v_mov_b32 v11, 0
  v_mov_b32 v12, 0
  v_mov_b32 v13, 0
  v_mov_b32 v14, 0
  v_mov_b32 v15, 0
  v_mov_b32 v16, 0
  v_mov_b32 v17, 0
  v_mov_b32 v18, 0
  v_mov_b32 v19, 0
  v_mov_b32 v20, 0
  v_mov_b32 v21, 0
  v_mov_b32 v22, 0
  v_mov_b32 v23, 0
  v_mov_b32 v24, 0
  v_mov_b32 v25, 0
  v_mov_b32 v26, 0
  v_mov_b32 v27, 0
  v_mov_b32 v28, 0
  v_mov_b32 v29, 0
  v_mov_b32 v30, 0
  v_mov_b32 v31, 0
  v_mov_b32 v32, 0
  v_mov_b32 v33, 0
  v_mov_b32 v34, 0
  v_mov_b32 v35, 0
  v_mov_b32 v36, 0
  v_mov_b32 v37, 0
  v_mov_b32 v38, 0
  v_mov_b32 v39, 0
  v_mov_b32 v40, 0
  v_mov_b32 v41, 0
  v_mov_b32 v42, 0
  v_mov_b32 v43, 0
  v_mov_b32 v44, 0
  v_mov_b32 v45, 0
  v_mov_b32 v46, 0
  v_mov_b32 v47, 0
  v_mov_b32 v48, 0
  v_mov_b32 v49, 0
  v_mov_b32 v50, 0
  v_mov_b32 v51, 0
  v_mov_b32 v52, 0
  v_mov_b32 v53, 0
  v_mov_b32 v54, 0
  v_mov_b32 v55, 0
  v_mov_b32 v56, 0
  v_mov_b32 v57, 0
  v_mov_b32 v58, 0
  v_mov_b32 v59, 0
  v_mov_b32 v60, 0
  v_mov_b32 v61, 0
  v_mov_b32 v62, 0
  v_mov_b32 v63, 0
  v_mov_b32 v64, 0
  v_mov_b32 v65, 0
  v_mov_b32 v66, 0
  v_mov_b32 v67, 0
  v_mov_b32 v68, 0
  v_mov_b32 v69, 0
  v_mov_b32 v70, 0
  v_mov_b32 v71, 0
  v_mov_b32 v72, 0
  v_mov_b32 v73, 0
  v_mov_b32 v74, 0
  v_mov_b32 v75, 0
  v_mov_b32 v76, 0
  v_mov_b32 v77, 0
  v_mov_b32 v78, 0
  v_mov_b32 v79, 0
  v_mov_b32 v80, 0
  v_mov_b32 v81, 0
  v_mov_b32 v82, 0
  v_mov_b32 v83, 0
  v_mov_b32 v84, 0
  v_mov_b32 v85, 0
  v_mov_b32 v86, 0
  v_mov_b32 v87, 0
  v_mov_b32 v88, 0
  v_mov_b32 v89, 0
  v_mov_b32 v90, 0
  v_mov_b32 v91, 0
  v_mov_b32 v92, 0
  v_mov_b32 v93, 0
  v_mov_b32 v94, 0
  v_mov_b32 v95, 0
  v_mov_b32 v96, 0
  v_mov_b32 v97, 0
  v_mov_b32 v98, 0
  v_mov_b32 v99, 0
  v_mov_b32 v100, 0
  v_mov_b32 v101, 0
  v_mov_b32 v102, 0
  v_mov_b32 v103, 0
  v_mov_b32 v104, 0
  v_mov_b32 v105, 0
  v_mov_b32 v106, 0
  v_mov_b32 v107, 0
  v_mov_b32 v108, 0
  v_mov_b32 v109, 0
  v_mov_b32 v110, 0
  v_mov_b32 v111, 0
  v_mov_b32 v112, 0
  v_mov_b32 v113, 0
  v_mov_b32 v114, 0
  v_mov_b32 v115, 0
  v_mov_b32 v116, 0
  v_mov_b32 v117, 0
  v_mov_b32 v118, 0
  v_mov_b32 v119, 0
  v_mov_b32 v120, 0
  v_mov_b32 v121, 0
  v_mov_b32 v122, 0
  v_mov_b32 v123, 0
  v_mov_b32 v124, 0
  v_mov_b32 v125, 0
  v_mov_b32 v126, 0
  v_mov_b32 v127, 0
  v_mov_b32 v128, 0
  v_mov_b32 v129, 0
  v_mov_b32 v130, 0
  v_mov_b32 v131, 0
  v_mov_b32 v132, 0
  v_mov_b32 v133, 0
  v_mov_b32 v134, 0
  v_mov_b32 v135, 0
  v_mov_b32 v136, 0
  v_mov_b32 v137, 0
  v_mov_b32 v138, 0
  v_mov_b32 v139, 0
  v_mov_b32 v140, 0
  v_mov_b32 v141, 0
  v_mov_b32 v142, 0
  v_mov_b32 v143, 0
  v_mov_b32 v144, 0
  v_mov_b32 v145, 0
  v_mov_b32 v146, 0
  v_mov_b32 v147, 0
  v_mov_b32 v148, 0
  v_mov_b32 v149, 0
  v_mov_b32 v150, 0
  v_mov_b32 v151, 0
  v_mov_b32 v152, 0
  v_mov_b32 v153, 0
  v_mov_b32 v154, 0
  v_mov_b32 v155, 0
  v_mov_b32 v156, 0
  v_mov_b32 v157, 0
  v_mov_b32 v158, 0
  v_mov_b32 v159, 0
  v_mov_b32 v160, 0
  v_mov_b32 v161, 0
  v_mov_b32 v162, 0
  v_mov_b32 v163, 0
  v_mov_b32 v164, 0
  v_mov_b32 v165, 0
  v_mov_b32 v166, 0
  v_mov_b32 v167, 0
  v_accvgpr_write_b32 a224, 0
  v_accvgpr_write_b32 a225, 0
  v_accvgpr_write_b32 a226, 0
  v_accvgpr_write_b32 a227, 0
  v_accvgpr_write_b32 a228, 0
  v_accvgpr_write_b32 a229, 0
  v_accvgpr_write_b32 a230, 0
  v_accvgpr_write_b32 a231, 0
  v_accvgpr_write_b32 a232, 0
  v_accvgpr_write_b32 a233, 0
  v_accvgpr_write_b32 a234, 0
  v_accvgpr_write_b32 a235, 0
  v_accvgpr_write_b32 a236, 0
  v_accvgpr_write_b32 a237, 0
  v_accvgpr_write_b32 a238, 0
  v_accvgpr_write_b32 a239, 0
  v_accvgpr_write_b32 a240, 0
  v_accvgpr_write_b32 a241, 0
  v_accvgpr_write_b32 a242, 0
  v_accvgpr_write_b32 a243, 0
  v_accvgpr_write_b32 a244, 0
  v_accvgpr_write_b32 a245, 0
  v_accvgpr_write_b32 a246, 0
  v_accvgpr_write_b32 a247, 0
  s_add_u32 s42, s33, 3072
  s_mov_b32 s39, 0
  s_nop 3
L_slow2:
  s_add_u32 s43, s42, 8192
  buffer_load_dwordx4 a[192:195], v241, s[8:11], s42 offen offset:0
  buffer_load_dwordx4 a[196:199], v241, s[8:11], s42 offen offset:64
  buffer_load_dwordx4 a[200:203], v241, s[8:11], s42 offen offset:128
  buffer_load_dwordx4 a[204:207], v241, s[8:11], s42 offen offset:192
  buffer_load_dwordx4 a[208:211], v241, s[8:11], s42 offen offset:256
  buffer_load_dwordx4 a[212:215], v241, s[8:11], s42 offen offset:320
  buffer_load_dwordx4 a[216:219], v241, s[8:11], s42 offen offset:384
  buffer_load_dwordx4 a[220:223], v241, s[8:11], s42 offen offset:448
  s_waitcnt vmcnt(0)
  v_mfma_f32_16x16x32_bf16 v[192:195], a[192:195], a[0:3], v[216:219]
  v_mfma_f32_16x16x32_bf16 v[200:203], a[192:195], a[4:7], v[220:223]
  v_mfma_f32_16x16x32_bf16 v[208:211], a[192:195], a[8:11], v[224:227]
  v_mfma_f32_16x16x32_bf16 v[192:195], a[196:199], a[12:15], v[192:195]
  v_mfma_f32_16x16x32_bf16 v[200:203], a[196:199], a[16:19], v[200:203]
  v_mfma_f32_16x16x32_bf16 v[208:211], a[196:199], a[20:23], v[208:211]
  v_mfma_f32_16x16x32_bf16 v[192:195], a[200:203], a[24:27], v[192:195]
  v_mfma_f32_16x16x32_bf16 v[200:203], a[200:203], a[28:31], v[200:203]
  v_mfma_f32_16x16x32_bf16 v[208:211], a[200:203], a[32:35], v[208:211]
  v_mfma_f32_16x16x32_bf16 v[192:195], a[204:207], a[36:39], v[192:195]
  v_mfma_f32_16x16x32_bf16 v[200:203], a[204:207], a[40:43], v[200:203]
  v_mfma_f32_16x16x32_bf16 v[208:211], a[204:207], a[44:47], v[208:211]
  v_mfma_f32_16x16x32_bf16 v[192:195], a[208:211], a[48:51], v[192:195]
  v_mfma_f32_16x16x32_bf16 v[200:203], a[208:211], a[52:55], v[200:203]
  v_mfma_f32_16x16x32_bf16 v[208:211], a[208:211], a[56:59], v[208:211]
  v_mfma_f32_16x16x32_bf16 v[192:195], a[212:215], a[60:63], v[192:195]
  v_mfma_f32_16x16x32_bf16 v[200:203], a[212:215], a[64:67], v[200:203]
  v_mfma_f32_16x16x32_bf16 v[208:211], a[212:215], a[68:71], v[208:211]
  v_mfma_f32_16x16x32_bf16 v[192:195], a[216:219], a[72:75], v[192:195]
  v_mfma_f32_16x16x32_bf16 v[200:203], a[216:219], a[76:79], v[200:203]
  v_mfma_f32_16x16x32_bf16 v[208:211], a[216:219], a[80:83], v[208:211]
  v_mfma_f32_16x16x32_bf16 v[192:195], a[220:223], a[84:87], v[192:195]
  v_mfma_f32_16x16x32_bf16 v[200:203], a[220:223], a[88:91], v[200:203]
  v_mfma_f32_16x16x32_bf16 v[208:211], a[220:223], a[92:95], v[208:211]
  s_nop 7
  buffer_load_dwordx4 a[192:195], v241, s[8:11], s43 offen offset:0
  buffer_load_dwordx4 a[196:199], v241, s[8:11], s43 offen offset:64
  buffer_load_dwordx4 a[200:203], v241, s[8:11], s43 offen offset:128
  buffer_load_dwordx4 a[204:207], v241, s[8:11], s43 offen offset:192
  buffer_load_dwordx4 a[208:211], v241, s[8:11], s43 offen offset:256
  buffer_load_dwordx4 a[212:215], v241, s[8:11], s43 offen offset:320
  buffer_load_dwordx4 a[216:219], v241, s[8:11], s43 offen offset:384
  buffer_load_dwordx4 a[220:223], v241, s[8:11], s43 offen offset:448
  s_waitcnt vmcnt(0)
  v_mfma_f32_16x16x32_bf16 v[196:199], a[192:195], a[0:3], v[216:219]
  v_mfma_f32_16x16x32_bf16 v[204:207], a[192:195], a[4:7], v[220:223]
  v_mfma_f32_16x16x32_bf16 v[212:215], a[192:195], a[8:11], v[224:227]
  v_mfma_f32_16x16x32_bf16 v[196:199], a[196:199], a[12:15], v[196:199]
  v_mfma_f32_16x16x32_bf16 v[204:207], a[196:199], a[16:19], v[204:207]
  v_mfma_f32_16x16x32_bf16 v[212:215], a[196:199], a[20:23], v[212:215]
  v_mfma_f32_16x16x32_bf16 v[196:199], a[200:203], a[24:27], v[196:199]
  v_mfma_f32_16x16x32_bf16 v[204:207], a[200:203], a[28:31], v[204:207]
  v_mfma_f32_16x16x32_bf16 v[212:215], a[200:203], a[32:35], v[212:215]
  v_mfma_f32_16x16x32_bf16 v[196:199], a[204:207], a[36:39], v[196:199]
  v_mfma_f32_16x16x32_bf16 v[204:207], a[204:207], a[40:43], v[204:207]
  v_mfma_f32_16x16x32_bf16 v[212:215], a[204:207], a[44:47], v[212:215]
  v_mfma_f32_16x16x32_bf16 v[196:199], a[208:211], a[48:51], v[196:199]
  v_mfma_f32_16x16x32_bf16 v[204:207], a[208:211], a[52:55], v[204:207]
  v_mfma_f32_16x16x32_bf16 v[212:215], a[208:211], a[56:59], v[212:215]
  v_mfma_f32_16x16x32_bf16 v[196:199], a[212:215], a[60:63], v[196:199]
  v_mfma_f32_16x16x32_bf16 v[204:207], a[212:215], a[64:67], v[204:207]
  v_mfma_f32_16x16x32_bf16 v[212:215], a[212:215], a[68:71], v[212:215]
  v_mfma_f32_16x16x32_bf16 v[196:199], a[216:219], a[72:75], v[196:199]
  v_mfma_f32_16x16x32_bf16 v[204:207], a[216:219], a[76:79], v[204:207]
  v_mfma_f32_16x16x32_bf16 v[212:215], a[216:219], a[80:83], v[212:215]
  v_mfma_f32_16x16x32_bf16 v[196:199], a[220:223], a[84:87], v[196:199]
  v_mfma_f32_16x16x32_bf16 v[204:207], a[220:223], a[88:91], v[204:207]
  v_mfma_f32_16x16x32_bf16 v[212:215], a[220:223], a[92:95], v[212:215]
  s_nop 7
  s_nop 7
  v_exp_f32 v192, v192
  v_exp_f32 v193, v193
  v_exp_f32 v194, v194
  v_exp_f32 v195, v195
  v_add_f32 v234, v192, v234
  v_add_f32 v234, v193, v234
  v_add_f32 v234, v194, v234
  v_add_f32 v234, v195, v234
  v_exp_f32 v196, v196
  v_exp_f32 v197, v197
  v_exp_f32 v198, v198
  v_exp_f32 v199, v199
  v_add_f32 v234, v196, v234
  v_add_f32 v234, v197, v234
  v_add_f32 v234, v198, v234
  v_add_f32 v234, v199, v234
  v_cvt_pk_bf16_f32 v192, v192, v193
  v_cvt_pk_bf16_f32 v193, v194, v195
  v_cvt_pk_bf16_f32 v194, v196, v197
  v_cvt_pk_bf16_f32 v195, v198, v199
  v_exp_f32 v200, v200
  v_exp_f32 v201, v201
  v_exp_f32 v202, v202
  v_exp_f32 v203, v203
  v_add_f32 v235, v200, v235
  v_add_f32 v235, v201, v235
  v_add_f32 v235, v202, v235
  v_add_f32 v235, v203, v235
  v_exp_f32 v204, v204
  v_exp_f32 v205, v205
  v_exp_f32 v206, v206
  v_exp_f32 v207, v207
  v_add_f32 v235, v204, v235
  v_add_f32 v235, v205, v235
  v_add_f32 v235, v206, v235
  v_add_f32 v235, v207, v235
  v_cvt_pk_bf16_f32 v200, v200, v201
  v_cvt_pk_bf16_f32 v201, v202, v203
  v_cvt_pk_bf16_f32 v202, v204, v205
  v_cvt_pk_bf16_f32 v203, v206, v207
  v_exp_f32 v208, v208
  v_exp_f32 v209, v209
  v_exp_f32 v210, v210
  v_exp_f32 v211, v211
  v_add_f32 v236, v208, v236
  v_add_f32 v236, v209, v236
  v_add_f32 v236, v210, v236
  v_add_f32 v236, v211, v236
  v_exp_f32 v212, v212
  v_exp_f32 v213, v213
  v_exp_f32 v214, v214
  v_exp_f32 v215, v215
  v_add_f32 v236, v212, v236
  v_add_f32 v236, v213, v236
  v_add_f32 v236, v214, v236
  v_add_f32 v236, v215, v236
  v_cvt_pk_bf16_f32 v208, v208, v209
  v_cvt_pk_bf16_f32 v209, v210, v211
  v_cvt_pk_bf16_f32 v210, v212, v213
  v_cvt_pk_bf16_f32 v211, v214, v215
  buffer_load_ushort v168, v242, s[12:15], s42 offen offset:0
  buffer_load_ushort v169, v242, s[12:15], s42 offen offset:512
  buffer_load_ushort v170, v242, s[12:15], s42 offen offset:1024
  buffer_load_ushort v171, v242, s[12:15], s42 offen offset:1536
  buffer_load_ushort v172, v242, s[12:15], s43 offen offset:0
  buffer_load_ushort v173, v242, s[12:15], s43 offen offset:512
  buffer_load_ushort v174, v242, s[12:15], s43 offen offset:1024
  buffer_load_ushort v175, v242, s[12:15], s43 offen offset:1536
  buffer_load_ushort v176, v242, s[12:15], s42 offen offset:32
  buffer_load_ushort v177, v242, s[12:15], s42 offen offset:544
  buffer_load_ushort v178, v242, s[12:15], s42 offen offset:1056
  buffer_load_ushort v179, v242, s[12:15], s42 offen offset:1568
  buffer_load_ushort v180, v242, s[12:15], s43 offen offset:32
  buffer_load_ushort v181, v242, s[12:15], s43 offen offset:544
  buffer_load_ushort v182, v242, s[12:15], s43 offen offset:1056
  buffer_load_ushort v183, v242, s[12:15], s43 offen offset:1568
  s_waitcnt vmcnt(0)
  v_lshl_or_b32 v184, v169, 16, v168
  v_lshl_or_b32 v185, v171, 16, v170
  v_lshl_or_b32 v186, v173, 16, v172
  v_lshl_or_b32 v187, v175, 16, v174
  v_lshl_or_b32 v188, v177, 16, v176
  v_lshl_or_b32 v189, v179, 16, v178
  v_lshl_or_b32 v190, v181, 16, v180
  v_lshl_or_b32 v191, v183, 16, v182
  v_mfma_f32_16x16x32_bf16 v[0:3], v[184:187], v[192:195], v[0:3]
  v_mfma_f32_16x16x32_bf16 v[4:7], v[184:187], v[200:203], v[4:7]
  v_mfma_f32_16x16x32_bf16 v[8:11], v[184:187], v[208:211], v[8:11]
  v_mfma_f32_16x16x32_bf16 v[12:15], v[188:191], v[192:195], v[12:15]
  v_mfma_f32_16x16x32_bf16 v[16:19], v[188:191], v[200:203], v[16:19]
  v_mfma_f32_16x16x32_bf16 v[20:23], v[188:191], v[208:211], v[20:23]
  s_nop 7
  buffer_load_ushort v168, v242, s[12:15], s42 offen offset:64
  buffer_load_ushort v169, v242, s[12:15], s42 offen offset:576
  buffer_load_ushort v170, v242, s[12:15], s42 offen offset:1088
  buffer_load_ushort v171, v242, s[12:15], s42 offen offset:1600
  buffer_load_ushort v172, v242, s[12:15], s43 offen offset:64
  buffer_load_ushort v173, v242, s[12:15], s43 offen offset:576
  buffer_load_ushort v174, v242, s[12:15], s43 offen offset:1088
  buffer_load_ushort v175, v242, s[12:15], s43 offen offset:1600
  buffer_load_ushort v176, v242, s[12:15], s42 offen offset:96
  buffer_load_ushort v177, v242, s[12:15], s42 offen offset:608
  buffer_load_ushort v178, v242, s[12:15], s42 offen offset:1120
  buffer_load_ushort v179, v242, s[12:15], s42 offen offset:1632
  buffer_load_ushort v180, v242, s[12:15], s43 offen offset:96
  buffer_load_ushort v181, v242, s[12:15], s43 offen offset:608
  buffer_load_ushort v182, v242, s[12:15], s43 offen offset:1120
  buffer_load_ushort v183, v242, s[12:15], s43 offen offset:1632
  s_waitcnt vmcnt(0)
  v_lshl_or_b32 v184, v169, 16, v168
  v_lshl_or_b32 v185, v171, 16, v170
  v_lshl_or_b32 v186, v173, 16, v172
  v_lshl_or_b32 v187, v175, 16, v174
  v_lshl_or_b32 v188, v177, 16, v176
  v_lshl_or_b32 v189, v179, 16, v178
  v_lshl_or_b32 v190, v181, 16, v180
  v_lshl_or_b32 v191, v183, 16, v182
  v_mfma_f32_16x16x32_bf16 v[24:27], v[184:187], v[192:195], v[24:27]
  v_mfma_f32_16x16x32_bf16 v[28:31], v[184:187], v[200:203], v[28:31]
  v_mfma_f32_16x16x32_bf16 v[32:35], v[184:187], v[208:211], v[32:35]
  v_mfma_f32_16x16x32_bf16 v[36:39], v[188:191], v[192:195], v[36:39]
  v_mfma_f32_16x16x32_bf16 v[40:43], v[188:191], v[200:203], v[40:43]
  v_mfma_f32_16x16x32_bf16 v[44:47], v[188:191], v[208:211], v[44:47]
  s_nop 7
  buffer_load_ushort v168, v242, s[12:15], s42 offen offset:128
  buffer_load_ushort v169, v242, s[12:15], s42 offen offset:640
  buffer_load_ushort v170, v242, s[12:15], s42 offen offset:1152
  buffer_load_ushort v171, v242, s[12:15], s42 offen offset:1664
  buffer_load_ushort v172, v242, s[12:15], s43 offen offset:128
  buffer_load_ushort v173, v242, s[12:15], s43 offen offset:640
  buffer_load_ushort v174, v242, s[12:15], s43 offen offset:1152
  buffer_load_ushort v175, v242, s[12:15], s43 offen offset:1664
  buffer_load_ushort v176, v242, s[12:15], s42 offen offset:160
  buffer_load_ushort v177, v242, s[12:15], s42 offen offset:672
  buffer_load_ushort v178, v242, s[12:15], s42 offen offset:1184
  buffer_load_ushort v179, v242, s[12:15], s42 offen offset:1696
  buffer_load_ushort v180, v242, s[12:15], s43 offen offset:160
  buffer_load_ushort v181, v242, s[12:15], s43 offen offset:672
  buffer_load_ushort v182, v242, s[12:15], s43 offen offset:1184
  buffer_load_ushort v183, v242, s[12:15], s43 offen offset:1696
  s_waitcnt vmcnt(0)
  v_lshl_or_b32 v184, v169, 16, v168
  v_lshl_or_b32 v185, v171, 16, v170
  v_lshl_or_b32 v186, v173, 16, v172
  v_lshl_or_b32 v187, v175, 16, v174
  v_lshl_or_b32 v188, v177, 16, v176
  v_lshl_or_b32 v189, v179, 16, v178
  v_lshl_or_b32 v190, v181, 16, v180
  v_lshl_or_b32 v191, v183, 16, v182
  v_mfma_f32_16x16x32_bf16 v[48:51], v[184:187], v[192:195], v[48:51]
  v_mfma_f32_16x16x32_bf16 v[52:55], v[184:187], v[200:203], v[52:55]
  v_mfma_f32_16x16x32_bf16 v[56:59], v[184:187], v[208:211], v[56:59]
  v_mfma_f32_16x16x32_bf16 v[60:63], v[188:191], v[192:195], v[60:63]
  v_mfma_f32_16x16x32_bf16 v[64:67], v[188:191], v[200:203], v[64:67]
  v_mfma_f32_16x16x32_bf16 v[68:71], v[188:191], v[208:211], v[68:71]
  s_nop 7
  buffer_load_ushort v168, v242, s[12:15], s42 offen offset:192
  buffer_load_ushort v169, v242, s[12:15], s42 offen offset:704
  buffer_load_ushort v170, v242, s[12:15], s42 offen offset:1216
  buffer_load_ushort v171, v242, s[12:15], s42 offen offset:1728
  buffer_load_ushort v172, v242, s[12:15], s43 offen offset:192
  buffer_load_ushort v173, v242, s[12:15], s43 offen offset:704
  buffer_load_ushort v174, v242, s[12:15], s43 offen offset:1216
  buffer_load_ushort v175, v242, s[12:15], s43 offen offset:1728
  buffer_load_ushort v176, v242, s[12:15], s42 offen offset:224
  buffer_load_ushort v177, v242, s[12:15], s42 offen offset:736
  buffer_load_ushort v178, v242, s[12:15], s42 offen offset:1248
  buffer_load_ushort v179, v242, s[12:15], s42 offen offset:1760
  buffer_load_ushort v180, v242, s[12:15], s43 offen offset:224
  buffer_load_ushort v181, v242, s[12:15], s43 offen offset:736
  buffer_load_ushort v182, v242, s[12:15], s43 offen offset:1248
  buffer_load_ushort v183, v242, s[12:15], s43 offen offset:1760
  s_waitcnt vmcnt(0)
  v_lshl_or_b32 v184, v169, 16, v168
  v_lshl_or_b32 v185, v171, 16, v170
  v_lshl_or_b32 v186, v173, 16, v172
  v_lshl_or_b32 v187, v175, 16, v174
  v_lshl_or_b32 v188, v177, 16, v176
  v_lshl_or_b32 v189, v179, 16, v178
  v_lshl_or_b32 v190, v181, 16, v180
  v_lshl_or_b32 v191, v183, 16, v182
  v_mfma_f32_16x16x32_bf16 v[72:75], v[184:187], v[192:195], v[72:75]
  v_mfma_f32_16x16x32_bf16 v[76:79], v[184:187], v[200:203], v[76:79]
  v_mfma_f32_16x16x32_bf16 v[80:83], v[184:187], v[208:211], v[80:83]
  v_mfma_f32_16x16x32_bf16 v[84:87], v[188:191], v[192:195], v[84:87]
  v_mfma_f32_16x16x32_bf16 v[88:91], v[188:191], v[200:203], v[88:91]
  v_mfma_f32_16x16x32_bf16 v[92:95], v[188:191], v[208:211], v[92:95]
  s_nop 7
  buffer_load_ushort v168, v242, s[12:15], s42 offen offset:256
  buffer_load_ushort v169, v242, s[12:15], s42 offen offset:768
  buffer_load_ushort v170, v242, s[12:15], s42 offen offset:1280
  buffer_load_ushort v171, v242, s[12:15], s42 offen offset:1792
  buffer_load_ushort v172, v242, s[12:15], s43 offen offset:256
  buffer_load_ushort v173, v242, s[12:15], s43 offen offset:768
  buffer_load_ushort v174, v242, s[12:15], s43 offen offset:1280
  buffer_load_ushort v175, v242, s[12:15], s43 offen offset:1792
  buffer_load_ushort v176, v242, s[12:15], s42 offen offset:288
  buffer_load_ushort v177, v242, s[12:15], s42 offen offset:800
  buffer_load_ushort v178, v242, s[12:15], s42 offen offset:1312
  buffer_load_ushort v179, v242, s[12:15], s42 offen offset:1824
  buffer_load_ushort v180, v242, s[12:15], s43 offen offset:288
  buffer_load_ushort v181, v242, s[12:15], s43 offen offset:800
  buffer_load_ushort v182, v242, s[12:15], s43 offen offset:1312
  buffer_load_ushort v183, v242, s[12:15], s43 offen offset:1824
  s_waitcnt vmcnt(0)
  v_lshl_or_b32 v184, v169, 16, v168
  v_lshl_or_b32 v185, v171, 16, v170
  v_lshl_or_b32 v186, v173, 16, v172
  v_lshl_or_b32 v187, v175, 16, v174
  v_lshl_or_b32 v188, v177, 16, v176
  v_lshl_or_b32 v189, v179, 16, v178
  v_lshl_or_b32 v190, v181, 16, v180
  v_lshl_or_b32 v191, v183, 16, v182
  v_mfma_f32_16x16x32_bf16 v[96:99], v[184:187], v[192:195], v[96:99]
  v_mfma_f32_16x16x32_bf16 v[100:103], v[184:187], v[200:203], v[100:103]
  v_mfma_f32_16x16x32_bf16 v[104:107], v[184:187], v[208:211], v[104:107]
  v_mfma_f32_16x16x32_bf16 v[108:111], v[188:191], v[192:195], v[108:111]
  v_mfma_f32_16x16x32_bf16 v[112:115], v[188:191], v[200:203], v[112:115]
  v_mfma_f32_16x16x32_bf16 v[116:119], v[188:191], v[208:211], v[116:119]
  s_nop 7
  buffer_load_ushort v168, v242, s[12:15], s42 offen offset:320
  buffer_load_ushort v169, v242, s[12:15], s42 offen offset:832
  buffer_load_ushort v170, v242, s[12:15], s42 offen offset:1344
  buffer_load_ushort v171, v242, s[12:15], s42 offen offset:1856
  buffer_load_ushort v172, v242, s[12:15], s43 offen offset:320
  buffer_load_ushort v173, v242, s[12:15], s43 offen offset:832
  buffer_load_ushort v174, v242, s[12:15], s43 offen offset:1344
  buffer_load_ushort v175, v242, s[12:15], s43 offen offset:1856
  buffer_load_ushort v176, v242, s[12:15], s42 offen offset:352
  buffer_load_ushort v177, v242, s[12:15], s42 offen offset:864
  buffer_load_ushort v178, v242, s[12:15], s42 offen offset:1376
  buffer_load_ushort v179, v242, s[12:15], s42 offen offset:1888
  buffer_load_ushort v180, v242, s[12:15], s43 offen offset:352
  buffer_load_ushort v181, v242, s[12:15], s43 offen offset:864
  buffer_load_ushort v182, v242, s[12:15], s43 offen offset:1376
  buffer_load_ushort v183, v242, s[12:15], s43 offen offset:1888
  s_waitcnt vmcnt(0)
  v_lshl_or_b32 v184, v169, 16, v168
  v_lshl_or_b32 v185, v171, 16, v170
  v_lshl_or_b32 v186, v173, 16, v172
  v_lshl_or_b32 v187, v175, 16, v174
  v_lshl_or_b32 v188, v177, 16, v176
  v_lshl_or_b32 v189, v179, 16, v178
  v_lshl_or_b32 v190, v181, 16, v180
  v_lshl_or_b32 v191, v183, 16, v182
  v_mfma_f32_16x16x32_bf16 v[120:123], v[184:187], v[192:195], v[120:123]
  v_mfma_f32_16x16x32_bf16 v[124:127], v[184:187], v[200:203], v[124:127]
  v_mfma_f32_16x16x32_bf16 v[128:131], v[184:187], v[208:211], v[128:131]
  v_mfma_f32_16x16x32_bf16 v[132:135], v[188:191], v[192:195], v[132:135]
  v_mfma_f32_16x16x32_bf16 v[136:139], v[188:191], v[200:203], v[136:139]
  v_mfma_f32_16x16x32_bf16 v[140:143], v[188:191], v[208:211], v[140:143]
  s_nop 7
  buffer_load_ushort v168, v242, s[12:15], s42 offen offset:384
  buffer_load_ushort v169, v242, s[12:15], s42 offen offset:896
  buffer_load_ushort v170, v242, s[12:15], s42 offen offset:1408
  buffer_load_ushort v171, v242, s[12:15], s42 offen offset:1920
  buffer_load_ushort v172, v242, s[12:15], s43 offen offset:384
  buffer_load_ushort v173, v242, s[12:15], s43 offen offset:896
  buffer_load_ushort v174, v242, s[12:15], s43 offen offset:1408
  buffer_load_ushort v175, v242, s[12:15], s43 offen offset:1920
  buffer_load_ushort v176, v242, s[12:15], s42 offen offset:416
  buffer_load_ushort v177, v242, s[12:15], s42 offen offset:928
  buffer_load_ushort v178, v242, s[12:15], s42 offen offset:1440
  buffer_load_ushort v179, v242, s[12:15], s42 offen offset:1952
  buffer_load_ushort v180, v242, s[12:15], s43 offen offset:416
  buffer_load_ushort v181, v242, s[12:15], s43 offen offset:928
  buffer_load_ushort v182, v242, s[12:15], s43 offen offset:1440
  buffer_load_ushort v183, v242, s[12:15], s43 offen offset:1952
  s_waitcnt vmcnt(0)
  v_lshl_or_b32 v184, v169, 16, v168
  v_lshl_or_b32 v185, v171, 16, v170
  v_lshl_or_b32 v186, v173, 16, v172
  v_lshl_or_b32 v187, v175, 16, v174
  v_lshl_or_b32 v188, v177, 16, v176
  v_lshl_or_b32 v189, v179, 16, v178
  v_lshl_or_b32 v190, v181, 16, v180
  v_lshl_or_b32 v191, v183, 16, v182
  v_mfma_f32_16x16x32_bf16 v[144:147], v[184:187], v[192:195], v[144:147]
  v_mfma_f32_16x16x32_bf16 v[148:151], v[184:187], v[200:203], v[148:151]
  v_mfma_f32_16x16x32_bf16 v[152:155], v[184:187], v[208:211], v[152:155]
  v_mfma_f32_16x16x32_bf16 v[156:159], v[188:191], v[192:195], v[156:159]
  v_mfma_f32_16x16x32_bf16 v[160:163], v[188:191], v[200:203], v[160:163]
  v_mfma_f32_16x16x32_bf16 v[164:167], v[188:191], v[208:211], v[164:167]
  s_nop 7
  buffer_load_ushort v168, v242, s[12:15], s42 offen offset:448
  buffer_load_ushort v169, v242, s[12:15], s42 offen offset:960
  buffer_load_ushort v170, v242, s[12:15], s42 offen offset:1472
  buffer_load_ushort v171, v242, s[12:15], s42 offen offset:1984
  buffer_load_ushort v172, v242, s[12:15], s43 offen offset:448
  buffer_load_ushort v173, v242, s[12:15], s43 offen offset:960
  buffer_load_ushort v174, v242, s[12:15], s43 offen offset:1472
  buffer_load_ushort v175, v242, s[12:15], s43 offen offset:1984
  buffer_load_ushort v176, v242, s[12:15], s42 offen offset:480
  buffer_load_ushort v177, v242, s[12:15], s42 offen offset:992
  buffer_load_ushort v178, v242, s[12:15], s42 offen offset:1504
  buffer_load_ushort v179, v242, s[12:15], s42 offen offset:2016
  buffer_load_ushort v180, v242, s[12:15], s43 offen offset:480
  buffer_load_ushort v181, v242, s[12:15], s43 offen offset:992
  buffer_load_ushort v182, v242, s[12:15], s43 offen offset:1504
  buffer_load_ushort v183, v242, s[12:15], s43 offen offset:2016
  s_waitcnt vmcnt(0)
  v_lshl_or_b32 v184, v169, 16, v168
  v_lshl_or_b32 v185, v171, 16, v170
  v_lshl_or_b32 v186, v173, 16, v172
  v_lshl_or_b32 v187, v175, 16, v174
  v_lshl_or_b32 v188, v177, 16, v176
  v_lshl_or_b32 v189, v179, 16, v178
  v_lshl_or_b32 v190, v181, 16, v180
  v_lshl_or_b32 v191, v183, 16, v182
  v_mfma_f32_16x16x32_bf16 a[224:227], v[184:187], v[192:195], a[224:227]
  v_mfma_f32_16x16x32_bf16 a[228:231], v[184:187], v[200:203], a[228:231]
  v_mfma_f32_16x16x32_bf16 a[232:235], v[184:187], v[208:211], a[232:235]
  v_mfma_f32_16x16x32_bf16 a[236:239], v[188:191], v[192:195], a[236:239]
  v_mfma_f32_16x16x32_bf16 a[240:243], v[188:191], v[200:203], a[240:243]
  v_mfma_f32_16x16x32_bf16 a[244:247], v[188:191], v[208:211], a[244:247]
  s_nop 7
  s_add_u32 s42, s42, 16384
  s_add_u32 s39, s39, 1
  s_cmp_lt_u32 s39, 16
  s_nop 7
  s_cbranch_scc1 L_slow2
  v_mov_b32 v243, v234
  s_nop 1
  v_permlane32_swap_b32 v234, v243
  v_add_f32 v234, v234, v243
  v_mov_b32 v243, v234
  s_nop 1
  v_permlane16_swap_b32 v234, v243
  v_add_f32 v234, v234, v243
  v_mov_b32 v243, v235
  s_nop 1
  v_permlane32_swap_b32 v235, v243
  v_add_f32 v235, v235, v243
  v_mov_b32 v243, v235
  s_nop 1
  v_permlane16_swap_b32 v235, v243
  v_add_f32 v235, v235, v243
  v_mov_b32 v243, v236
  s_nop 1
  v_permlane32_swap_b32 v236, v243
  v_add_f32 v236, v236, v243
  v_mov_b32 v243, v236
  s_nop 1
  v_permlane16_swap_b32 v236, v243
  v_add_f32 v236, v236, v243
  s_nop 3
  s_cmp_eq_u32 s32, 0
  s_cbranch_scc1 L_back0
  s_branch L_back1
.section .rodata,"a"
.p2align 6
.amdhsa_kernel standalone__mha_block_cached__near_ridge_kernel
  .amdhsa_next_free_vgpr 512
  .amdhsa_next_free_sgpr 102
  .amdhsa_accum_offset 256
  .amdhsa_group_segment_fixed_size 0
  .amdhsa_kernarg_size 64
  .amdhsa_user_sgpr_count 2
  .amdhsa_user_sgpr_kernarg_segment_ptr 1
  .amdhsa_system_sgpr_workgroup_id_x 1
  .amdhsa_float_denorm_mode_32 3
.end_amdhsa_kernel
```
